```python
import torch

def _softmax(x, axis=-1):
    return torch.softmax(x, dim=axis)
def _gelu(x):
    return torch.nn.functional.gelu(x, approximate="tanh")
def _silu(x):
    return torch.nn.functional.silu(x)
def _sigmoid(x):
    return torch.sigmoid(x)
def _layernorm(x, axis=-1, eps=1e-5):
    m = x.mean(dim=axis, keepdim=True)
    v = x.var(dim=axis, keepdim=True, unbiased=False)
    return (x - m) / torch.sqrt(v + eps)
def _scatter_add(tgt, idx, src, axis=0):
    return tgt.clone().index_add_(axis, idx, src)
def _segment_sum(src, seg, n):
    out = torch.zeros((n,) + src.shape[1:], dtype=src.dtype)
    return out.index_add_(0, seg, src)
def _pad(x, pw):
    flat = tuple(v for pair in reversed(pw) for v in pair)
    return torch.nn.functional.pad(x, flat)

kernel_name = 'gated_mix__linear_attn_block__moe_arch_mod__prompt'

def setup_inputs():

    _w = (lambda a: (lambda t: t.to(torch.bfloat16) if t.is_floating_point() else t)(torch.as_tensor(a)))
    def _A_setup():
        B, S, D = 1, 2048, 1024
        return {
            "x": _w((lambda *s: torch.randn(*s, dtype=torch.bfloat16) * 0.05)(B, S, D)),
            "wqkv": _w((lambda *s: torch.randn(*s, dtype=torch.bfloat16) * 0.8)(D, 3 * D)),
            "wo": _w((lambda *s: torch.randn(*s, dtype=torch.bfloat16) * 0.1)(D, D)),
        }
    _A_in = _A_setup()

    def _B_setup():
        B, S, D, F, C = 1, 2048, 1024, 3584, 1
        return {
            "x": _w((lambda *s: torch.randn(*s, dtype=torch.bfloat16) * 0.05)(B, S, D)),
            "w_r": _w((lambda *s: torch.randn(*s, dtype=torch.bfloat16) * 1.6)(D)),
            "w_gate": _w((lambda *s: torch.randn(*s, dtype=torch.bfloat16) * 0.1)(D, F)),
            "w_up": _w((lambda *s: torch.randn(*s, dtype=torch.bfloat16) * 0.1)(D, F)),
            "w_down": _w((lambda *s: torch.randn(*s, dtype=torch.bfloat16) * 0.1)(F, D)),
        }
    _B_in = _B_setup()

    return {
        "A_x": _A_in["x"],
        "A_wqkv": _A_in["wqkv"],
        "A_wo": _A_in["wo"],
        "B_x": _B_in["x"],
        "B_w_r": _B_in["w_r"],
        "B_w_gate": _B_in["w_gate"],
        "B_w_up": _B_in["w_up"],
        "B_w_down": _B_in["w_down"],
        "gate_w": _w((lambda *s: torch.randn(*s, dtype=torch.bfloat16) * 0.05)(1024) * 16.0),
    }

def reference(A_x, A_wqkv, A_wo, B_x, B_w_r, B_w_gate, B_w_up, B_w_down, gate_w):
    def _A_ref(x, wqkv, wo):
        B, S, D = x.shape
        H = 32; Dh = D // H
        qkv = (lambda x, *d: x.permute(*d))((x @ wqkv).reshape(B, S, 3, H, Dh), 2, 0, 3, 1, 4)
        q, k, v = qkv[0], qkv[1], qkv[2]
        phi = lambda t: torch.where(t > 0, t + 1, torch.exp(t)) + 1e-6
        pq, pk = phi(q), phi(k)
        kv = torch.einsum("bhsd,bhse->bhde", pk, v)
        z = torch.einsum("bhsd->bhd", pk)
        num = torch.einsum("bhqd,bhde->bhqe", pq, kv)
        den = torch.einsum("bhqd,bhd->bhq", pq, z)[..., None] + 1e-6
        o = num / den
        return (lambda x, *d: x.permute(*d))(o, 0, 2, 1, 3).reshape(B, S, D) @ wo

    def _B_ref(x, w_r, w_gate, w_up, w_down):
        B, S, D = x.shape
        C = 1
        r = x @ w_r
        idx = torch.argsort(-r, axis=-1)[:, :C]
        idx_e = (lambda x, n, axis: torch.repeat_interleave(x, n, dim=axis))(idx.reshape(B, C, 1), D, axis=2)
        x_sel = (lambda x, i, axis: torch.take_along_dim(x, i, dim=axis))(x, idx_e, axis=1)
        g = _silu(x_sel @ w_gate)
        u = x_sel @ w_up
        y = (g * u) @ w_down
        r_sel = _sigmoid((lambda x, i, axis: torch.take_along_dim(x, i, dim=axis))(r, idx, axis=1))
        y = y * r_sel.reshape(B, C, 1)
        b_off = (torch.arange(B) * S).reshape(B, 1)
        flat_idx = (idx + b_off).reshape(B * C)
        zero = (x * 0.0).reshape(B * S, D)
        upd = _scatter_add(zero, flat_idx, y.reshape(B * C, D), axis=0)
        return x + upd.reshape(B, S, D)

    x = A_x
    g = _sigmoid((x * gate_w).sum(-1, keepdims=True))
    a = _A_ref(x, A_wqkv, A_wo)
    b = _B_ref(x, B_w_r, B_w_gate, B_w_up, B_w_down)
    return g * a + (1 - g) * b
```

```asm
; @launch grid=(256,1,1) block=(512,1,1) lds=163840
.amdgcn_target "amdgcn-amd-amdhsa--gfx950"
.text
.globl gated_mix__linear_attn_block__moe_arch_mod__prompt_kernel
.p2align 8
.type gated_mix__linear_attn_block__moe_arch_mod__prompt_kernel,@function
gated_mix__linear_attn_block__moe_arch_mod__prompt_kernel:
    s_load_dwordx16 s[40:55], s[0:1], 0
    s_load_dwordx8 s[56:63], s[0:1], 64
    s_cmp_ge_u32 s2, 256
    s_cbranch_scc1 K_end
    v_lshrrev_b32 v1, 6, v0
    v_and_b32 v2, 63, v0
    s_and_b32 s6, s2, 7
    v_readfirstlane_b32 s3, v1
    s_lshr_b32 s7, s2, 3
    s_and_b32 s4, s6, 1
    s_lshl_b32 s4, s4, 3
    s_and_b32 s64, s7, 7
    s_add_u32 s4, s4, s64
    s_lshr_b32 s5, s6, 1
    s_lshl_b32 s5, s5, 2
    s_lshr_b32 s64, s7, 3
    s_add_u32 s5, s5, s64
    s_lshl_b32 s74, s4, 1
    v_lshrrev_b32 v6, 3, v2
    s_lshl_b32 s65, s3, 3
    v_add_u32 v6, s65, v6
    s_lshl_b32 s64, s4, 7
    v_add_u32 v7, s64, v6
    v_lshlrev_b32 v7, 11, v7
    v_lshrrev_b32 v8, 4, v2
    s_and_b32 s64, s3, 1
    s_lshl_b32 s64, s64, 2
    v_add_u32 v9, s64, v8
    v_and_b32 v10, 7, v2
    v_xor_b32 v9, v9, v10
    v_lshl_add_u32 v7, v9, 4, v7
    v_mul_u32_u24 v6, 6144, v6
    v_and_b32 v9, 1, v8
    v_lshlrev_b32 v9, 2, v9
    v_xor_b32 v9, v9, v10
    v_lshl_add_u32 v6, v9, 4, v6
    s_lshl_b32 s64, s5, 7
    v_add_u32 v6, s64, v6
    s_lshl_b32 s66, s3, 10
    s_mov_b32 s10, 4194304
    s_mov_b32 s11, 0x00020000
    s_mov_b32 s14, 6291456
    s_mov_b32 s15, 0x00020000
    s_add_u32 s65, s74, 0
    s_and_b32 s65, s65, 15
    s_lshl_b32 s67, s65, 7
    s_mul_i32 s65, s65, 393216
    s_waitcnt lgkmcnt(0)
    s_mov_b32 s8, s40
    s_mov_b32 s9, s41
    s_mov_b32 s12, s42
    s_mov_b32 s13, s43
    s_add_u32 m0, s66, 8192
    s_add_u32 s64, s67, 0
    buffer_load_dwordx4 v7, s[8:11], s64 offen lds
    s_add_u32 m0, s66, 16384
    s_add_u32 s64, s67, 131072
    buffer_load_dwordx4 v7, s[8:11], s64 offen lds
    s_add_u32 m0, s66, 24576
    s_add_u32 s64, s65, 0
    buffer_load_dwordx4 v6, s[12:15], s64 offen lds
    s_add_u32 m0, s66, 32768
    s_add_u32 s64, s65, 2048
    buffer_load_dwordx4 v6, s[12:15], s64 offen lds
    s_add_u32 m0, s66, 40960
    s_add_u32 s64, s65, 4096
    buffer_load_dwordx4 v6, s[12:15], s64 offen lds
    s_barrier
    s_mov_b32 s72, 0x3fb8aa3b
    s_mov_b32 s73, 0x358637bd
    s_mov_b32 s16, s62
    s_mov_b32 s17, s63
    s_mov_b32 s18, 0x10000000
    s_mov_b32 s19, 0x00020000
    s_cmp_lt_u32 s3, 4
    s_cbranch_scc1 C_start
    s_sub_u32 s6, s3, 4
    s_lshl_b32 s7, s6, 10
    v_lshrrev_b32 v6, 3, v2
    s_lshl_b32 s64, s4, 7
    s_lshl_b32 s65, s6, 3
    s_add_u32 s64, s64, s65
    v_add_u32 v7, s64, v6
    v_lshlrev_b32 v7, 11, v7
    s_and_b32 s64, s6, 1
    s_lshl_b32 s64, s64, 2
    v_add_u32 v9, s64, v8
    v_xor_b32 v9, v9, v10
    v_lshl_add_u32 v4, v9, 4, v7
    v_add_u32 v7, s65, v6
    v_mul_u32_u24 v7, 6144, v7
    v_and_b32 v9, 1, v8
    v_lshlrev_b32 v9, 2, v9
    v_xor_b32 v9, v9, v10
    v_lshl_add_u32 v7, v9, 4, v7
    s_lshl_b32 s64, s5, 7
    v_add_u32 v5, s64, v7
    v_lshlrev_b32 v6, 4, v2
    s_and_b32 s64, s2, 1
    s_lshl_b32 s68, s64, 10
    s_bfe_u32 s64, s2, 0x20001
    s_lshl_b32 s64, s64, 8
    s_add_u32 s68, s68, s64
    s_and_b32 s64, s2, 0xf8
    s_add_u32 s68, s68, s64
    s_lshl_b32 s64, s6, 1
    s_add_u32 s68, s68, s64
    s_lshl_b32 s64, s68, 11
    v_add_u32 v13, s64, v6
    s_add_u32 s65, s74, 1
    s_and_b32 s65, s65, 15
    s_lshl_b32 s67, s65, 7
    s_mul_i32 s65, s65, 393216
    s_add_u32 m0, s7, 49152
    s_add_u32 s64, s67, 0
    buffer_load_dwordx4 v4, s[8:11], s64 offen lds
    s_add_u32 m0, s7, 53248
    s_add_u32 s64, s67, 65536
    buffer_load_dwordx4 v4, s[8:11], s64 offen lds
    s_add_u32 m0, s7, 57344
    s_add_u32 s64, s67, 131072
    buffer_load_dwordx4 v4, s[8:11], s64 offen lds
    s_add_u32 m0, s7, 61440
    s_add_u32 s64, s67, 196608
    buffer_load_dwordx4 v4, s[8:11], s64 offen lds
    s_add_u32 m0, s7, 65536
    s_add_u32 s64, s65, 0
    buffer_load_dwordx4 v5, s[12:15], s64 offen lds
    s_add_u32 m0, s7, 69632
    s_add_u32 s64, s65, 196608
    buffer_load_dwordx4 v5, s[12:15], s64 offen lds
    s_add_u32 m0, s7, 73728
    s_add_u32 s64, s65, 2048
    buffer_load_dwordx4 v5, s[12:15], s64 offen lds
    s_add_u32 m0, s7, 77824
    s_add_u32 s64, s65, 198656
    buffer_load_dwordx4 v5, s[12:15], s64 offen lds
    s_add_u32 m0, s7, 81920
    s_add_u32 s64, s65, 4096
    buffer_load_dwordx4 v5, s[12:15], s64 offen lds
    s_add_u32 m0, s7, 86016
    s_add_u32 s64, s65, 200704
    buffer_load_dwordx4 v5, s[12:15], s64 offen lds
    s_or_b32 s64, s2, s6
    s_cmp_lg_u32 s64, 0
    s_cbranch_scc1 H_nn
    s_mov_b32 s64, 6717440
    s_load_dwordx2 s[66:67], s[62:63], s64
    s_mov_b32 s20, s60
    s_mov_b32 s21, s61
    s_mov_b32 s22, 0x100
    s_mov_b32 s23, 0x00020000
    s_waitcnt lgkmcnt(0)
    s_xor_b32 s64, s66, s67
    s_add_u32 s64, s64, 1
    s_max_u32 s64, s64, 1
    v_mov_b32 v72, s64
    v_mov_b32 v73, 0
    s_mov_b64 exec, 1
    buffer_store_dword v72, v73, s[20:23], 0 offen sc0 sc1
    s_mov_b64 exec, -1
H_nn:
    s_mov_b32 s20, s60
    s_mov_b32 s21, s61
    s_mov_b32 s22, 0x100
    s_mov_b32 s23, 0x00020000
    s_mov_b32 s24, s48
    s_mov_b32 s25, s49
    s_mov_b32 s26, 0x800
    s_mov_b32 s27, 0x00020000
    s_mov_b32 s28, s56
    s_mov_b32 s29, s57
    s_mov_b32 s30, 0x800
    s_mov_b32 s31, 0x00020000
    s_mov_b32 s32, s50
    s_mov_b32 s33, s51
    s_mov_b32 s34, 0x700000
    s_mov_b32 s35, 0x00020000
    s_mov_b32 s36, s52
    s_mov_b32 s37, s53
    s_mov_b32 s38, 0x700000
    s_mov_b32 s39, 0x00020000
    s_lshr_b32 s69, s2, 3
    s_and_b32 s64, s2, 7
    v_and_b32 v9, 15, v2
    v_min_u32 v9, 13, v9
    s_lshl_b32 s65, s69, 5
    v_lshl_add_u32 v7, v8, 3, s65
    v_mul_u32_u24 v7, 7168, v7
    s_mul_i32 s65, s64, 896
    s_mul_i32 s66, s6, 224
    s_add_u32 s65, s65, s66
    v_lshl_add_u32 v7, v9, 4, v7
    v_add_u32 v11, s65, v7
    v_cmp_le_u32 vcc, 7, v9
    v_mov_b32 v15, 16160
    v_cndmask_b32 v7, 0, v15, vcc
    v_lshl_add_u32 v7, v9, 5, v7
    v_lshrrev_b32 v15, 1, v8
    v_lshl_add_u32 v7, v15, 13, v7
    v_and_b32 v15, 1, v8
    v_lshl_add_u32 v7, v15, 4, v7
    s_lshl_b32 s64, s64, 17
    s_lshl_b32 s65, s6, 15
    s_add_u32 s64, s64, s65
    s_lshl_b32 s65, s69, 8
    s_add_u32 s64, s64, s65
    s_add_u32 s64, s64, 5398528
    v_add_u32 v12, s64, v7
    s_lshl_b32 s70, s5, 2
    s_add_u32 s70, s70, s6
    s_mul_i32 s70, s70, 18432
    s_add_u32 s70, s70, 4194304
    s_mul_i32 s64, s4, 1152
    s_add_u32 s64, s64, s70
    s_mov_b32 s67, s64
    v_lshl_add_u32 v15, v2, 2, s64
    v_add_u32 v15, 960, v15
    s_lshl_b32 s64, s5, 2
    s_add_u32 s64, s64, s6
    s_lshl_b32 s64, s64, 7
    s_add_u32 s64, s64, 5373952
    v_mov_b32 v23, s64
    s_lshl_b32 s65, s4, 10
    s_add_u32 s65, s65, 5382016
    v_lshl_add_u32 v20, v2, 7, s65
    v_cmp_gt_u32 vcc, 16, v2
    s_nop 1
    v_cndmask_b32 v15, v15, v20, vcc
    v_writelane_b32 v15, s64, 0
    s_cmp_eq_u32 s4, 0
    s_cselect_b32 s75, 1, 0
    s_or_b32 s64, s5, s6
    s_cmp_eq_u32 s64, 0
    s_cselect_b32 s64, 0x1fe, 0
    s_or_b32 s75, s75, s64
    s_or_b32 s75, s75, 0xffff0000
    v_add_u32 v22, s67, v6
    v_mov_b32 v16, -1
    v_mov_b32 v17, -1
    v_mov_b32 v18, -1
    v_mov_b32 v19, -1
    v_cndmask_b32 v20, -1, 0, vcc
    s_waitcnt vmcnt(10)
    s_barrier
    s_add_u32 s65, s74, 2
    s_and_b32 s65, s65, 15
    s_lshl_b32 s67, s65, 7
    s_mul_i32 s65, s65, 393216
    s_add_u32 m0, s7, 90112
    s_add_u32 s64, s67, 0
    buffer_load_dwordx4 v4, s[8:11], s64 offen lds
    s_add_u32 m0, s7, 94208
    s_add_u32 s64, s67, 65536
    buffer_load_dwordx4 v4, s[8:11], s64 offen lds
    s_add_u32 m0, s7, 98304
    s_add_u32 s64, s67, 131072
    buffer_load_dwordx4 v4, s[8:11], s64 offen lds
    s_add_u32 m0, s7, 102400
    s_add_u32 s64, s67, 196608
    buffer_load_dwordx4 v4, s[8:11], s64 offen lds
    s_add_u32 m0, s7, 106496
    s_add_u32 s64, s65, 0
    buffer_load_dwordx4 v5, s[12:15], s64 offen lds
    s_add_u32 m0, s7, 110592
    s_add_u32 s64, s65, 196608
    buffer_load_dwordx4 v5, s[12:15], s64 offen lds
    s_add_u32 m0, s7, 114688
    s_add_u32 s64, s65, 2048
    buffer_load_dwordx4 v5, s[12:15], s64 offen lds
    s_add_u32 m0, s7, 118784
    s_add_u32 s64, s65, 198656
    buffer_load_dwordx4 v5, s[12:15], s64 offen lds
    s_add_u32 m0, s7, 122880
    s_add_u32 s64, s65, 4096
    buffer_load_dwordx4 v5, s[12:15], s64 offen lds
    s_add_u32 m0, s7, 126976
    s_add_u32 s64, s65, 200704
    buffer_load_dwordx4 v5, s[12:15], s64 offen lds
    buffer_load_dwordx4 v[24:27], v13, s[8:11], 0 offen offset:0
    buffer_load_dwordx4 v[28:31], v13, s[8:11], 0 offen offset:1024
    buffer_load_dwordx4 v[32:35], v13, s[8:11], 0 offen offset:2048
    buffer_load_dwordx4 v[36:39], v13, s[8:11], 0 offen offset:3072
    buffer_load_dwordx4 v[40:43], v6, s[24:27], 0 offen offset:0
    buffer_load_dwordx4 v[44:47], v6, s[24:27], 0 offen offset:1024
    buffer_load_dwordx4 v[48:51], v6, s[28:31], 0 offen offset:0
    buffer_load_dwordx4 v[52:55], v6, s[28:31], 0 offen offset:1024
    s_waitcnt vmcnt(18)
    s_barrier
    s_add_u32 s65, s74, 3
    s_and_b32 s65, s65, 15
    s_lshl_b32 s67, s65, 7
    s_mul_i32 s65, s65, 393216
    s_add_u32 m0, s7, 8192
    s_add_u32 s64, s67, 0
    buffer_load_dwordx4 v4, s[8:11], s64 offen lds
    s_add_u32 m0, s7, 12288
    s_add_u32 s64, s67, 65536
    buffer_load_dwordx4 v4, s[8:11], s64 offen lds
    s_add_u32 m0, s7, 16384
    s_add_u32 s64, s67, 131072
    buffer_load_dwordx4 v4, s[8:11], s64 offen lds
    s_add_u32 m0, s7, 20480
    s_add_u32 s64, s67, 196608
    buffer_load_dwordx4 v4, s[8:11], s64 offen lds
    s_add_u32 m0, s7, 24576
    s_add_u32 s64, s65, 0
    buffer_load_dwordx4 v5, s[12:15], s64 offen lds
    s_add_u32 m0, s7, 28672
    s_add_u32 s64, s65, 196608
    buffer_load_dwordx4 v5, s[12:15], s64 offen lds
    s_add_u32 m0, s7, 32768
    s_add_u32 s64, s65, 2048
    buffer_load_dwordx4 v5, s[12:15], s64 offen lds
    s_add_u32 m0, s7, 36864
    s_add_u32 s64, s65, 198656
    buffer_load_dwordx4 v5, s[12:15], s64 offen lds
    s_add_u32 m0, s7, 40960
    s_add_u32 s64, s65, 4096
    buffer_load_dwordx4 v5, s[12:15], s64 offen lds
    s_add_u32 m0, s7, 45056
    s_add_u32 s64, s65, 200704
    buffer_load_dwordx4 v5, s[12:15], s64 offen lds
    buffer_store_dwordx4 v[16:19], v22, s[16:19], 0 offen sc0 sc1
    s_mov_b32 exec_lo, s75
    s_mov_b32 exec_hi, 0
    buffer_store_dword v20, v15, s[16:19], 0 offen sc0 sc1
    s_mov_b32 exec_lo, 0x3fff3fff
    s_mov_b32 exec_hi, 0x3fff3fff
    buffer_store_dwordx4 v[16:19], v12, s[16:19], 0 offen sc0 sc1
    s_mov_b64 exec, 0xffff
    s_lshl_b32 s64, s2, 10
    s_lshl_b32 s65, s6, 8
    s_add_u32 s64, s64, s65
    s_add_u32 s64, s64, 6447104
    buffer_store_dwordx4 v[16:19], v6, s[16:19], s64 offen sc0 sc1
    s_mov_b64 exec, -1
    s_waitcnt vmcnt(22)
    s_barrier
    s_add_u32 s65, s74, 4
    s_and_b32 s65, s65, 15
    s_lshl_b32 s67, s65, 7
    s_mul_i32 s65, s65, 393216
    s_add_u32 m0, s7, 49152
    s_add_u32 s64, s67, 0
    buffer_load_dwordx4 v4, s[8:11], s64 offen lds
    s_add_u32 m0, s7, 53248
    s_add_u32 s64, s67, 65536
    buffer_load_dwordx4 v4, s[8:11], s64 offen lds
    s_add_u32 m0, s7, 57344
    s_add_u32 s64, s67, 131072
    buffer_load_dwordx4 v4, s[8:11], s64 offen lds
    s_add_u32 m0, s7, 61440
    s_add_u32 s64, s67, 196608
    buffer_load_dwordx4 v4, s[8:11], s64 offen lds
    s_add_u32 m0, s7, 65536
    s_add_u32 s64, s65, 0
    buffer_load_dwordx4 v5, s[12:15], s64 offen lds
    s_add_u32 m0, s7, 69632
    s_add_u32 s64, s65, 196608
    buffer_load_dwordx4 v5, s[12:15], s64 offen lds
    s_add_u32 m0, s7, 73728
    s_add_u32 s64, s65, 2048
    buffer_load_dwordx4 v5, s[12:15], s64 offen lds
    s_add_u32 m0, s7, 77824
    s_add_u32 s64, s65, 198656
    buffer_load_dwordx4 v5, s[12:15], s64 offen lds
    s_add_u32 m0, s7, 81920
    s_add_u32 s64, s65, 4096
    buffer_load_dwordx4 v5, s[12:15], s64 offen lds
    s_add_u32 m0, s7, 86016
    s_add_u32 s64, s65, 200704
    buffer_load_dwordx4 v5, s[12:15], s64 offen lds
    v_mov_b32 v79, 0
    s_cmp_lg_u32 s6, 0
    s_cbranch_scc1 H_nc
    buffer_load_dword v78, v79, s[20:23], 0 offen sc1
H_nc:
    s_waitcnt vmcnt(14)
    s_barrier
    s_add_u32 s65, s74, 5
    s_and_b32 s65, s65, 15
    s_lshl_b32 s67, s65, 7
    s_mul_i32 s65, s65, 393216
    s_add_u32 m0, s7, 90112
    s_add_u32 s64, s67, 0
    buffer_load_dwordx4 v4, s[8:11], s64 offen lds
    s_add_u32 m0, s7, 94208
    s_add_u32 s64, s67, 65536
    buffer_load_dwordx4 v4, s[8:11], s64 offen lds
    s_add_u32 m0, s7, 98304
    s_add_u32 s64, s67, 131072
    buffer_load_dwordx4 v4, s[8:11], s64 offen lds
    s_add_u32 m0, s7, 102400
    s_add_u32 s64, s67, 196608
    buffer_load_dwordx4 v4, s[8:11], s64 offen lds
    s_add_u32 m0, s7, 106496
    s_add_u32 s64, s65, 0
    buffer_load_dwordx4 v5, s[12:15], s64 offen lds
    s_add_u32 m0, s7, 110592
    s_add_u32 s64, s65, 196608
    buffer_load_dwordx4 v5, s[12:15], s64 offen lds
    s_add_u32 m0, s7, 114688
    s_add_u32 s64, s65, 2048
    buffer_load_dwordx4 v5, s[12:15], s64 offen lds
    s_add_u32 m0, s7, 118784
    s_add_u32 s64, s65, 198656
    buffer_load_dwordx4 v5, s[12:15], s64 offen lds
    s_add_u32 m0, s7, 122880
    s_add_u32 s64, s65, 4096
    buffer_load_dwordx4 v5, s[12:15], s64 offen lds
    s_add_u32 m0, s7, 126976
    s_add_u32 s64, s65, 200704
    buffer_load_dwordx4 v5, s[12:15], s64 offen lds
    v_dot2_f32_bf16 v72, v24, v48, 0
    v_dot2_f32_bf16 v73, v32, v48, 0
    v_dot2_f32_bf16 v74, v24, v40, 0
    v_dot2_f32_bf16 v75, v32, v40, 0
    v_dot2_f32_bf16 v72, v25, v49, v72
    v_dot2_f32_bf16 v73, v33, v49, v73
    v_dot2_f32_bf16 v74, v25, v41, v74
    v_dot2_f32_bf16 v75, v33, v41, v75
    v_dot2_f32_bf16 v72, v26, v50, v72
    v_dot2_f32_bf16 v73, v34, v50, v73
    v_dot2_f32_bf16 v74, v26, v42, v74
    v_dot2_f32_bf16 v75, v34, v42, v75
    v_dot2_f32_bf16 v72, v27, v51, v72
    v_dot2_f32_bf16 v73, v35, v51, v73
    v_dot2_f32_bf16 v74, v27, v43, v74
    v_dot2_f32_bf16 v75, v35, v43, v75
    v_dot2_f32_bf16 v72, v28, v52, v72
    v_dot2_f32_bf16 v73, v36, v52, v73
    v_dot2_f32_bf16 v74, v28, v44, v74
    v_dot2_f32_bf16 v75, v36, v44, v75
    v_dot2_f32_bf16 v72, v29, v53, v72
    v_dot2_f32_bf16 v73, v37, v53, v73
    v_dot2_f32_bf16 v74, v29, v45, v74
    v_dot2_f32_bf16 v75, v37, v45, v75
    v_dot2_f32_bf16 v72, v30, v54, v72
    v_dot2_f32_bf16 v73, v38, v54, v73
    v_dot2_f32_bf16 v74, v30, v46, v74
    v_dot2_f32_bf16 v75, v38, v46, v75
    v_dot2_f32_bf16 v72, v31, v55, v72
    v_dot2_f32_bf16 v73, v39, v55, v73
    v_dot2_f32_bf16 v74, v31, v47, v74
    v_dot2_f32_bf16 v75, v39, v47, v75
    s_waitcnt vmcnt(10)
    s_barrier
    s_add_u32 s65, s74, 6
    s_and_b32 s65, s65, 15
    s_lshl_b32 s67, s65, 7
    s_mul_i32 s65, s65, 393216
    s_add_u32 m0, s7, 8192
    s_add_u32 s64, s67, 0
    buffer_load_dwordx4 v4, s[8:11], s64 offen lds
    s_add_u32 m0, s7, 12288
    s_add_u32 s64, s67, 65536
    buffer_load_dwordx4 v4, s[8:11], s64 offen lds
    s_add_u32 m0, s7, 16384
    s_add_u32 s64, s67, 131072
    buffer_load_dwordx4 v4, s[8:11], s64 offen lds
    s_add_u32 m0, s7, 20480
    s_add_u32 s64, s67, 196608
    buffer_load_dwordx4 v4, s[8:11], s64 offen lds
    s_add_u32 m0, s7, 24576
    s_add_u32 s64, s65, 0
    buffer_load_dwordx4 v5, s[12:15], s64 offen lds
    s_add_u32 m0, s7, 28672
    s_add_u32 s64, s65, 196608
    buffer_load_dwordx4 v5, s[12:15], s64 offen lds
    s_add_u32 m0, s7, 32768
    s_add_u32 s64, s65, 2048
    buffer_load_dwordx4 v5, s[12:15], s64 offen lds
    s_add_u32 m0, s7, 36864
    s_add_u32 s64, s65, 198656
    buffer_load_dwordx4 v5, s[12:15], s64 offen lds
    s_add_u32 m0, s7, 40960
    s_add_u32 s64, s65, 4096
    buffer_load_dwordx4 v5, s[12:15], s64 offen lds
    s_add_u32 m0, s7, 45056
    s_add_u32 s64, s65, 200704
    buffer_load_dwordx4 v5, s[12:15], s64 offen lds
    v_permlane32_swap_b32 v72, v74
    v_permlane32_swap_b32 v73, v75
    v_add_f32 v72, v72, v74
    v_add_f32 v73, v73, v75
    s_lshl_b32 s64, s68, 2
    s_add_u32 s64, s64, 6709248
    v_permlane16_swap_b32 v72, v73
    v_add_f32 v72, v72, v73
    v_and_b32 v75, 1, v8
    v_lshl_add_u32 v76, v75, 2, s64
    v_add_f32_dpp v72, v72, v72 quad_perm:[1,0,3,2] row_mask:0xf bank_mask:0xf
    s_nop 1
    v_add_f32_dpp v72, v72, v72 quad_perm:[2,3,0,1] row_mask:0xf bank_mask:0xf
    s_nop 1
    v_add_f32_dpp v72, v72, v72 row_half_mirror row_mask:0xf bank_mask:0xf
    s_nop 1
    v_add_f32_dpp v72, v72, v72 row_mirror row_mask:0xf bank_mask:0xf
    s_nop 1
    v_cvt_pk_bf16_f32 v72, v72, v72
    s_sub_u32 s64, 34815, s68
    v_lshlrev_b32 v72, 16, v72
    v_ashrrev_i32 v73, 31, v72
    v_sub_u32 v77, s64, v75
    v_or_b32 v73, 0x80000000, v73
    s_lshl_b32 s64, s6, 3
    v_xor_b32 v73, v72, v73
    v_lshl_add_u32 v75, v75, 2, s64
    v_and_b32 v73, 0xffff0000, v73
    v_or_b32 v73, v77, v73
    v_mul_f32 v72, s72, v72
    v_exp_f32 v72, -v72
    s_nop 0
    v_add_f32 v72, 1.0, v72
    v_rcp_f32 v72, v72
    s_nop 0
    v_cvt_pk_bf16_f32 v72, v72, v72
    v_lshlrev_b32 v72, 16, v72
    s_mov_b32 exec_lo, 0
    s_mov_b32 exec_hi, 0x10001
    ds_write_b32 v75, v73 offset:4224
    s_mov_b32 exec_lo, 0x10001
    s_mov_b32 exec_hi, 0
    buffer_store_dword v72, v76, s[16:19], 0 offen sc0 sc1
    s_mov_b64 exec, -1
    s_mov_b32 exec_lo, 0x3fff3fff
    s_mov_b32 exec_hi, 0x3fff3fff
    s_mov_b32 s64, 0
    buffer_load_dwordx4 v[96:99], v11, s[32:35], s64 offen nt
    s_mov_b32 s64, 0
    buffer_load_dwordx4 v[128:131], v11, s[36:39], s64 offen nt
    s_mov_b32 s64, 7168
    buffer_load_dwordx4 v[100:103], v11, s[32:35], s64 offen nt
    s_mov_b32 s64, 7168
    buffer_load_dwordx4 v[132:135], v11, s[36:39], s64 offen nt
    s_mov_b32 s64, 14336
    buffer_load_dwordx4 v[104:107], v11, s[32:35], s64 offen nt
    s_mov_b64 exec, -1
    s_waitcnt vmcnt(16)
    s_waitcnt lgkmcnt(0)
    s_barrier
    s_add_u32 s65, s74, 7
    s_and_b32 s65, s65, 15
    s_lshl_b32 s67, s65, 7
    s_mul_i32 s65, s65, 393216
    s_add_u32 m0, s7, 49152
    s_add_u32 s64, s67, 0
    buffer_load_dwordx4 v4, s[8:11], s64 offen lds
    s_add_u32 m0, s7, 53248
    s_add_u32 s64, s67, 65536
    buffer_load_dwordx4 v4, s[8:11], s64 offen lds
    s_add_u32 m0, s7, 57344
    s_add_u32 s64, s67, 131072
    buffer_load_dwordx4 v4, s[8:11], s64 offen lds
    s_add_u32 m0, s7, 61440
    s_add_u32 s64, s67, 196608
    buffer_load_dwordx4 v4, s[8:11], s64 offen lds
    s_add_u32 m0, s7, 65536
    s_add_u32 s64, s65, 0
    buffer_load_dwordx4 v5, s[12:15], s64 offen lds
    s_add_u32 m0, s7, 69632
    s_add_u32 s64, s65, 196608
    buffer_load_dwordx4 v5, s[12:15], s64 offen lds
    s_add_u32 m0, s7, 73728
    s_add_u32 s64, s65, 2048
    buffer_load_dwordx4 v5, s[12:15], s64 offen lds
    s_add_u32 m0, s7, 77824
    s_add_u32 s64, s65, 198656
    buffer_load_dwordx4 v5, s[12:15], s64 offen lds
    s_add_u32 m0, s7, 81920
    s_add_u32 s64, s65, 4096
    buffer_load_dwordx4 v5, s[12:15], s64 offen lds
    s_add_u32 m0, s7, 86016
    s_add_u32 s64, s65, 200704
    buffer_load_dwordx4 v5, s[12:15], s64 offen lds
    s_waitcnt vmcnt(16)
    s_barrier
    s_add_u32 s65, s74, 8
    s_and_b32 s65, s65, 15
    s_lshl_b32 s67, s65, 7
    s_mul_i32 s65, s65, 393216
    s_add_u32 m0, s7, 90112
    s_add_u32 s64, s67, 0
    buffer_load_dwordx4 v4, s[8:11], s64 offen lds
    s_add_u32 m0, s7, 94208
    s_add_u32 s64, s67, 65536
    buffer_load_dwordx4 v4, s[8:11], s64 offen lds
    s_add_u32 m0, s7, 98304
    s_add_u32 s64, s67, 131072
    buffer_load_dwordx4 v4, s[8:11], s64 offen lds
    s_add_u32 m0, s7, 102400
    s_add_u32 s64, s67, 196608
    buffer_load_dwordx4 v4, s[8:11], s64 offen lds
    s_add_u32 m0, s7, 106496
    s_add_u32 s64, s65, 0
    buffer_load_dwordx4 v5, s[12:15], s64 offen lds
    s_add_u32 m0, s7, 110592
    s_add_u32 s64, s65, 196608
    buffer_load_dwordx4 v5, s[12:15], s64 offen lds
    s_add_u32 m0, s7, 114688
    s_add_u32 s64, s65, 2048
    buffer_load_dwordx4 v5, s[12:15], s64 offen lds
    s_add_u32 m0, s7, 118784
    s_add_u32 s64, s65, 198656
    buffer_load_dwordx4 v5, s[12:15], s64 offen lds
    s_add_u32 m0, s7, 122880
    s_add_u32 s64, s65, 4096
    buffer_load_dwordx4 v5, s[12:15], s64 offen lds
    s_add_u32 m0, s7, 126976
    s_add_u32 s64, s65, 200704
    buffer_load_dwordx4 v5, s[12:15], s64 offen lds
    s_waitcnt vmcnt(10)
    s_barrier
    s_add_u32 s65, s74, 9
    s_and_b32 s65, s65, 15
    s_lshl_b32 s67, s65, 7
    s_mul_i32 s65, s65, 393216
    s_add_u32 m0, s7, 8192
    s_add_u32 s64, s67, 0
    buffer_load_dwordx4 v4, s[8:11], s64 offen lds
    s_add_u32 m0, s7, 12288
    s_add_u32 s64, s67, 65536
    buffer_load_dwordx4 v4, s[8:11], s64 offen lds
    s_add_u32 m0, s7, 16384
    s_add_u32 s64, s67, 131072
    buffer_load_dwordx4 v4, s[8:11], s64 offen lds
    s_add_u32 m0, s7, 20480
    s_add_u32 s64, s67, 196608
    buffer_load_dwordx4 v4, s[8:11], s64 offen lds
    s_add_u32 m0, s7, 24576
    s_add_u32 s64, s65, 0
    buffer_load_dwordx4 v5, s[12:15], s64 offen lds
    s_add_u32 m0, s7, 28672
    s_add_u32 s64, s65, 196608
    buffer_load_dwordx4 v5, s[12:15], s64 offen lds
    s_add_u32 m0, s7, 32768
    s_add_u32 s64, s65, 2048
    buffer_load_dwordx4 v5, s[12:15], s64 offen lds
    s_add_u32 m0, s7, 36864
    s_add_u32 s64, s65, 198656
    buffer_load_dwordx4 v5, s[12:15], s64 offen lds
    s_add_u32 m0, s7, 40960
    s_add_u32 s64, s65, 4096
    buffer_load_dwordx4 v5, s[12:15], s64 offen lds
    s_add_u32 m0, s7, 45056
    s_add_u32 s64, s65, 200704
    buffer_load_dwordx4 v5, s[12:15], s64 offen lds
    s_cmp_lg_u32 s6, 0
    s_cbranch_scc1 H_nk
    v_mov_b32 v76, 4224
    ds_read_b128 v[72:75], v76
    ds_read_b128 v[24:27], v76 offset:16
    s_mov_b32 s65, 0
H_nspin:
    v_readfirstlane_b32 s71, v78
    s_add_u32 s65, s65, 1
    s_cmp_lg_u32 s71, 0
    s_cbranch_scc1 H_nok
    s_cmp_ge_u32 s65, 200000
    s_cbranch_scc1 H_nok
    s_sleep 4
    buffer_load_dword v78, v79, s[20:23], 0 offen sc1
    s_waitcnt vmcnt(0)
    s_branch H_nspin
H_nok:
    s_lshl_b32 s64, s2, 3
    s_add_u32 s64, s64, 6717440
    v_mov_b32 v76, s64
    s_waitcnt lgkmcnt(0)
    v_max3_u32 v72, v72, v73, v74
    v_max3_u32 v24, v24, v25, v26
    v_max3_u32 v72, v72, v75, v27
    v_max_u32 v72, v72, v24
    v_xor_b32 v73, s71, v72
    s_mov_b64 exec, 1
    buffer_store_dwordx2 v[72:73], v76, s[16:19], 0 offen sc0 sc1
    s_mov_b64 exec, -1
H_nk:
    s_mov_b32 exec_lo, 0x3fff3fff
    s_mov_b32 exec_hi, 0x3fff3fff
    s_mov_b32 s64, 14336
    buffer_load_dwordx4 v[136:139], v11, s[36:39], s64 offen nt
    s_mov_b32 s64, 21504
    buffer_load_dwordx4 v[108:111], v11, s[32:35], s64 offen nt
    s_mov_b32 s64, 21504
    buffer_load_dwordx4 v[140:143], v11, s[36:39], s64 offen nt
    s_mov_b32 s64, 28672
    buffer_load_dwordx4 v[112:115], v11, s[32:35], s64 offen nt
    s_mov_b32 s64, 28672
    buffer_load_dwordx4 v[144:147], v11, s[36:39], s64 offen nt
    s_mov_b64 exec, -1
    s_waitcnt vmcnt(15)
    s_barrier
    s_add_u32 s65, s74, 10
    s_and_b32 s65, s65, 15
    s_lshl_b32 s67, s65, 7
    s_mul_i32 s65, s65, 393216
    s_add_u32 m0, s7, 49152
    s_add_u32 s64, s67, 0
    buffer_load_dwordx4 v4, s[8:11], s64 offen lds
    s_add_u32 m0, s7, 53248
    s_add_u32 s64, s67, 65536
    buffer_load_dwordx4 v4, s[8:11], s64 offen lds
    s_add_u32 m0, s7, 57344
    s_add_u32 s64, s67, 131072
    buffer_load_dwordx4 v4, s[8:11], s64 offen lds
    s_add_u32 m0, s7, 61440
    s_add_u32 s64, s67, 196608
    buffer_load_dwordx4 v4, s[8:11], s64 offen lds
    s_add_u32 m0, s7, 65536
    s_add_u32 s64, s65, 0
    buffer_load_dwordx4 v5, s[12:15], s64 offen lds
    s_add_u32 m0, s7, 69632
    s_add_u32 s64, s65, 196608
    buffer_load_dwordx4 v5, s[12:15], s64 offen lds
    s_add_u32 m0, s7, 73728
    s_add_u32 s64, s65, 2048
    buffer_load_dwordx4 v5, s[12:15], s64 offen lds
    s_add_u32 m0, s7, 77824
    s_add_u32 s64, s65, 198656
    buffer_load_dwordx4 v5, s[12:15], s64 offen lds
    s_add_u32 m0, s7, 81920
    s_add_u32 s64, s65, 4096
    buffer_load_dwordx4 v5, s[12:15], s64 offen lds
    s_add_u32 m0, s7, 86016
    s_add_u32 s64, s65, 200704
    buffer_load_dwordx4 v5, s[12:15], s64 offen lds
    s_waitcnt vmcnt(15)
    s_barrier
    s_add_u32 s65, s74, 11
    s_and_b32 s65, s65, 15
    s_lshl_b32 s67, s65, 7
    s_mul_i32 s65, s65, 393216
    s_add_u32 m0, s7, 90112
    s_add_u32 s64, s67, 0
    buffer_load_dwordx4 v4, s[8:11], s64 offen lds
    s_add_u32 m0, s7, 94208
    s_add_u32 s64, s67, 65536
    buffer_load_dwordx4 v4, s[8:11], s64 offen lds
    s_add_u32 m0, s7, 98304
    s_add_u32 s64, s67, 131072
    buffer_load_dwordx4 v4, s[8:11], s64 offen lds
    s_add_u32 m0, s7, 102400
    s_add_u32 s64, s67, 196608
    buffer_load_dwordx4 v4, s[8:11], s64 offen lds
    s_add_u32 m0, s7, 106496
    s_add_u32 s64, s65, 0
    buffer_load_dwordx4 v5, s[12:15], s64 offen lds
    s_add_u32 m0, s7, 110592
    s_add_u32 s64, s65, 196608
    buffer_load_dwordx4 v5, s[12:15], s64 offen lds
    s_add_u32 m0, s7, 114688
    s_add_u32 s64, s65, 2048
    buffer_load_dwordx4 v5, s[12:15], s64 offen lds
    s_add_u32 m0, s7, 118784
    s_add_u32 s64, s65, 198656
    buffer_load_dwordx4 v5, s[12:15], s64 offen lds
    s_add_u32 m0, s7, 122880
    s_add_u32 s64, s65, 4096
    buffer_load_dwordx4 v5, s[12:15], s64 offen lds
    s_add_u32 m0, s7, 126976
    s_add_u32 s64, s65, 200704
    buffer_load_dwordx4 v5, s[12:15], s64 offen lds
    s_waitcnt vmcnt(10)
    s_barrier
    s_add_u32 s65, s74, 12
    s_and_b32 s65, s65, 15
    s_lshl_b32 s67, s65, 7
    s_mul_i32 s65, s65, 393216
    s_add_u32 m0, s7, 8192
    s_add_u32 s64, s67, 0
    buffer_load_dwordx4 v4, s[8:11], s64 offen lds
    s_add_u32 m0, s7, 12288
    s_add_u32 s64, s67, 65536
    buffer_load_dwordx4 v4, s[8:11], s64 offen lds
    s_add_u32 m0, s7, 16384
    s_add_u32 s64, s67, 131072
    buffer_load_dwordx4 v4, s[8:11], s64 offen lds
    s_add_u32 m0, s7, 20480
    s_add_u32 s64, s67, 196608
    buffer_load_dwordx4 v4, s[8:11], s64 offen lds
    s_add_u32 m0, s7, 24576
    s_add_u32 s64, s65, 0
    buffer_load_dwordx4 v5, s[12:15], s64 offen lds
    s_add_u32 m0, s7, 28672
    s_add_u32 s64, s65, 196608
    buffer_load_dwordx4 v5, s[12:15], s64 offen lds
    s_add_u32 m0, s7, 32768
    s_add_u32 s64, s65, 2048
    buffer_load_dwordx4 v5, s[12:15], s64 offen lds
    s_add_u32 m0, s7, 36864
    s_add_u32 s64, s65, 198656
    buffer_load_dwordx4 v5, s[12:15], s64 offen lds
    s_add_u32 m0, s7, 40960
    s_add_u32 s64, s65, 4096
    buffer_load_dwordx4 v5, s[12:15], s64 offen lds
    s_add_u32 m0, s7, 45056
    s_add_u32 s64, s65, 200704
    buffer_load_dwordx4 v5, s[12:15], s64 offen lds
    s_mov_b32 exec_lo, 0x3fff3fff
    s_mov_b32 exec_hi, 0x3fff3fff
    s_mov_b32 s64, 35840
    buffer_load_dwordx4 v[116:119], v11, s[32:35], s64 offen nt
    s_mov_b32 s64, 35840
    buffer_load_dwordx4 v[148:151], v11, s[36:39], s64 offen nt
    s_mov_b32 s64, 43008
    buffer_load_dwordx4 v[120:123], v11, s[32:35], s64 offen nt
    s_mov_b32 s64, 43008
    buffer_load_dwordx4 v[152:155], v11, s[36:39], s64 offen nt
    s_mov_b32 s64, 50176
    buffer_load_dwordx4 v[124:127], v11, s[32:35], s64 offen nt
    s_mov_b32 s64, 50176
    buffer_load_dwordx4 v[156:159], v11, s[36:39], s64 offen nt
    s_mov_b64 exec, -1
    s_waitcnt vmcnt(16)
    s_barrier
    s_add_u32 s65, s74, 13
    s_and_b32 s65, s65, 15
    s_lshl_b32 s67, s65, 7
    s_mul_i32 s65, s65, 393216
    s_add_u32 m0, s7, 49152
    s_add_u32 s64, s67, 0
    buffer_load_dwordx4 v4, s[8:11], s64 offen lds
    s_add_u32 m0, s7, 53248
    s_add_u32 s64, s67, 65536
    buffer_load_dwordx4 v4, s[8:11], s64 offen lds
    s_add_u32 m0, s7, 57344
    s_add_u32 s64, s67, 131072
    buffer_load_dwordx4 v4, s[8:11], s64 offen lds
    s_add_u32 m0, s7, 61440
    s_add_u32 s64, s67, 196608
    buffer_load_dwordx4 v4, s[8:11], s64 offen lds
    s_add_u32 m0, s7, 65536
    s_add_u32 s64, s65, 0
    buffer_load_dwordx4 v5, s[12:15], s64 offen lds
    s_add_u32 m0, s7, 69632
    s_add_u32 s64, s65, 196608
    buffer_load_dwordx4 v5, s[12:15], s64 offen lds
    s_add_u32 m0, s7, 73728
    s_add_u32 s64, s65, 2048
    buffer_load_dwordx4 v5, s[12:15], s64 offen lds
    s_add_u32 m0, s7, 77824
    s_add_u32 s64, s65, 198656
    buffer_load_dwordx4 v5, s[12:15], s64 offen lds
    s_add_u32 m0, s7, 81920
    s_add_u32 s64, s65, 4096
    buffer_load_dwordx4 v5, s[12:15], s64 offen lds
    s_add_u32 m0, s7, 86016
    s_add_u32 s64, s65, 200704
    buffer_load_dwordx4 v5, s[12:15], s64 offen lds
    s_cmp_lg_u32 s6, 0
    s_cbranch_scc1 H_np
    s_mov_b32 s64, 6717440
    buffer_load_dwordx4 v[24:27], v6, s[16:19], s64 offen offset:0 sc1
    buffer_load_dwordx4 v[28:31], v6, s[16:19], s64 offen offset:1024 sc1
H_np:
    s_waitcnt vmcnt(16)
    s_barrier
    s_add_u32 s65, s74, 14
    s_and_b32 s65, s65, 15
    s_lshl_b32 s67, s65, 7
    s_mul_i32 s65, s65, 393216
    s_add_u32 m0, s7, 90112
    s_add_u32 s64, s67, 0
    buffer_load_dwordx4 v4, s[8:11], s64 offen lds
    s_add_u32 m0, s7, 94208
    s_add_u32 s64, s67, 65536
    buffer_load_dwordx4 v4, s[8:11], s64 offen lds
    s_add_u32 m0, s7, 98304
    s_add_u32 s64, s67, 131072
    buffer_load_dwordx4 v4, s[8:11], s64 offen lds
    s_add_u32 m0, s7, 102400
    s_add_u32 s64, s67, 196608
    buffer_load_dwordx4 v4, s[8:11], s64 offen lds
    s_add_u32 m0, s7, 106496
    s_add_u32 s64, s65, 0
    buffer_load_dwordx4 v5, s[12:15], s64 offen lds
    s_add_u32 m0, s7, 110592
    s_add_u32 s64, s65, 196608
    buffer_load_dwordx4 v5, s[12:15], s64 offen lds
    s_add_u32 m0, s7, 114688
    s_add_u32 s64, s65, 2048
    buffer_load_dwordx4 v5, s[12:15], s64 offen lds
    s_add_u32 m0, s7, 118784
    s_add_u32 s64, s65, 198656
    buffer_load_dwordx4 v5, s[12:15], s64 offen lds
    s_add_u32 m0, s7, 122880
    s_add_u32 s64, s65, 4096
    buffer_load_dwordx4 v5, s[12:15], s64 offen lds
    s_add_u32 m0, s7, 126976
    s_add_u32 s64, s65, 200704
    buffer_load_dwordx4 v5, s[12:15], s64 offen lds
    s_cmp_lg_u32 s6, 0
    s_cbranch_scc1 H_nq
    s_waitcnt vmcnt(10)
    s_mov_b32 s65, 0
H_spin:
    v_xor_b32 v25, v24, v25
    v_xor_b32 v27, v26, v27
    v_xor_b32 v29, v28, v29
    v_xor_b32 v31, v30, v31
    v_xor_b32 v80, s71, v25
    v_xor_b32 v81, s71, v27
    v_xor_b32 v25, s71, v29
    v_xor_b32 v27, s71, v31
    v_or3_b32 v80, v80, v81, v25
    v_or_b32 v80, v80, v27
    v_cmp_ne_u32 vcc, 0, v80
    s_cbranch_vccz H_pollok
    s_add_u32 s65, s65, 1
    s_cmp_ge_u32 s65, 200000
    s_cbranch_scc1 H_pollok
    s_sleep 8
    s_mov_b32 s64, 6717440
    buffer_load_dwordx4 v[24:27], v6, s[16:19], s64 offen offset:0 sc1
    buffer_load_dwordx4 v[28:31], v6, s[16:19], s64 offen offset:1024 sc1
    s_waitcnt vmcnt(0)
    s_branch H_spin
H_pollok:
    v_max_u32 v80, v24, v26
    v_max3_u32 v80, v80, v28, v30
    s_nop 1
    v_max_u32_dpp v80, v80, v80 quad_perm:[1,0,3,2] row_mask:0xf bank_mask:0xf
    s_nop 1
    v_max_u32_dpp v80, v80, v80 quad_perm:[2,3,0,1] row_mask:0xf bank_mask:0xf
    s_nop 1
    v_max_u32_dpp v80, v80, v80 row_half_mirror row_mask:0xf bank_mask:0xf
    s_nop 1
    v_max_u32_dpp v80, v80, v80 row_mirror row_mask:0xf bank_mask:0xf
    s_nop 1
    v_mov_b32 v81, v80
    s_nop 1
    v_permlane16_swap_b32 v80, v81
    v_max_u32 v80, v80, v81
    v_mov_b32 v81, v80
    s_nop 1
    v_permlane32_swap_b32 v80, v81
    v_max_u32 v80, v80, v81
    v_mov_b32 v81, 4256
    ds_write_b32 v81, v80
H_nq:
    s_waitcnt vmcnt(10)
    s_waitcnt lgkmcnt(0)
    s_barrier
    s_add_u32 s65, s74, 15
    s_and_b32 s65, s65, 15
    s_lshl_b32 s67, s65, 7
    s_mul_i32 s65, s65, 393216
    s_add_u32 m0, s7, 8192
    s_add_u32 s64, s67, 0
    buffer_load_dwordx4 v4, s[8:11], s64 offen lds
    s_add_u32 m0, s7, 12288
    s_add_u32 s64, s67, 65536
    buffer_load_dwordx4 v4, s[8:11], s64 offen lds
    s_add_u32 m0, s7, 16384
    s_add_u32 s64, s67, 131072
    buffer_load_dwordx4 v4, s[8:11], s64 offen lds
    s_add_u32 m0, s7, 20480
    s_add_u32 s64, s67, 196608
    buffer_load_dwordx4 v4, s[8:11], s64 offen lds
    s_add_u32 m0, s7, 24576
    s_add_u32 s64, s65, 0
    buffer_load_dwordx4 v5, s[12:15], s64 offen lds
    s_add_u32 m0, s7, 28672
    s_add_u32 s64, s65, 196608
    buffer_load_dwordx4 v5, s[12:15], s64 offen lds
    s_add_u32 m0, s7, 32768
    s_add_u32 s64, s65, 2048
    buffer_load_dwordx4 v5, s[12:15], s64 offen lds
    s_add_u32 m0, s7, 36864
    s_add_u32 s64, s65, 198656
    buffer_load_dwordx4 v5, s[12:15], s64 offen lds
    s_add_u32 m0, s7, 40960
    s_add_u32 s64, s65, 4096
    buffer_load_dwordx4 v5, s[12:15], s64 offen lds
    s_add_u32 m0, s7, 45056
    s_add_u32 s64, s65, 200704
    buffer_load_dwordx4 v5, s[12:15], s64 offen lds
    v_mov_b32 v81, 4256
    ds_read_b32 v80, v81
    s_lshl_b32 s65, s69, 6
    v_lshl_add_u32 v81, v8, 4, s65
    s_waitcnt lgkmcnt(0)
    v_readfirstlane_b32 s75, v80
    s_nop 3
    s_and_b32 s64, s75, 0x7ff
    s_sub_u32 s64, 2047, s64
    s_lshl_b32 s64, s64, 11
    buffer_load_dwordx4 v[88:91], v81, s[8:11], s64 offen
    s_mov_b32 s24, s54
    s_mov_b32 s25, s55
    s_mov_b32 s26, 0x700000
    s_mov_b32 s27, 0x00020000
    s_lshr_b32 s64, s2, 2
    s_mul_i32 s64, s64, 114688
    s_and_b32 s65, s2, 3
    s_lshl_b32 s65, s65, 9
    s_add_u32 s64, s64, s65
    s_lshl_b32 s65, s6, 7
    s_add_u32 s64, s64, s65
    v_lshrrev_b32 v7, 3, v2
    v_lshlrev_b32 v7, 11, v7
    v_and_b32 v9, 7, v2
    v_lshl_add_u32 v7, v9, 4, v7
    v_add_u32 v21, s64, v7
    s_mov_b32 s64, 0
    buffer_load_dwordx4 v[192:195], v21, s[24:27], s64 offen nt
    s_mov_b32 s64, 16384
    buffer_load_dwordx4 v[196:199], v21, s[24:27], s64 offen nt
    s_mov_b32 s64, 32768
    buffer_load_dwordx4 v[200:203], v21, s[24:27], s64 offen nt
    s_mov_b32 s64, 49152
    buffer_load_dwordx4 v[204:207], v21, s[24:27], s64 offen nt
    s_mov_b32 s64, 65536
    buffer_load_dwordx4 v[208:211], v21, s[24:27], s64 offen nt
    s_mov_b32 s64, 81920
    buffer_load_dwordx4 v[212:215], v21, s[24:27], s64 offen nt
    s_mov_b32 s64, 98304
    buffer_load_dwordx4 v[216:219], v21, s[24:27], s64 offen nt
    s_waitcnt vmcnt(18)
    s_barrier
    s_and_b32 s64, s2, 7
    s_lshr_b32 s65, s2, 3
    s_and_b32 s4, s64, 3
    s_lshl_b32 s4, s4, 2
    s_and_b32 s66, s65, 3
    s_add_u32 s4, s4, s66
    s_lshr_b32 s5, s64, 2
    s_lshl_b32 s5, s5, 3
    s_lshr_b32 s74, s65, 2
    s_add_u32 s5, s5, s74
    s_mov_b32 s12, s44
    s_mov_b32 s13, s45
    s_mov_b32 s14, 0x200000
    s_mov_b32 s15, 0x00020000
    v_lshrrev_b32 v7, 3, v2
    s_lshl_b32 s64, s6, 3
    v_add_u32 v7, s64, v7
    v_lshlrev_b32 v7, 11, v7
    v_bfe_u32 v9, v2, 4, 1
    v_lshlrev_b32 v9, 2, v9
    v_and_b32 v10, 7, v2
    v_xor_b32 v9, v9, v10
    v_lshl_add_u32 v7, v9, 4, v7
    s_lshl_b32 s64, s5, 7
    v_add_u32 v10, s64, v7
    s_mov_b32 s65, 0
    s_add_u32 m0, s7, 131072
    s_nop 0
    buffer_load_dwordx4 v10, s[12:15], s65 offen lds
    s_add_u32 m0, s7, 135168
    s_add_u32 s65, s65, 65536
    buffer_load_dwordx4 v10, s[12:15], s65 offen lds
    s_mov_b32 s65, 1048576
    s_add_u32 m0, s7, 147456
    s_nop 0
    buffer_load_dwordx4 v10, s[12:15], s65 offen lds
    s_add_u32 m0, s7, 151552
    s_add_u32 s65, s65, 65536
    buffer_load_dwordx4 v10, s[12:15], s65 offen lds
    s_mov_b32 s65, 131072
    s_add_u32 m0, s7, 139264
    s_nop 0
    buffer_load_dwordx4 v10, s[12:15], s65 offen lds
    s_add_u32 m0, s7, 143360
    s_add_u32 s65, s65, 65536
    buffer_load_dwordx4 v10, s[12:15], s65 offen lds
    s_mov_b32 s65, 1179648
    s_add_u32 m0, s7, 155648
    s_nop 0
    buffer_load_dwordx4 v10, s[12:15], s65 offen lds
    s_add_u32 m0, s7, 159744
    s_add_u32 s65, s65, 65536
    buffer_load_dwordx4 v10, s[12:15], s65 offen lds
    s_waitcnt vmcnt(15)
    s_mov_b32 s64, 0x05040100
    s_mov_b32 s65, 0x07060302
    v_perm_b32 v48, v100, v96, s64
    v_perm_b32 v49, v100, v96, s65
    v_dot2_f32_bf16 v32, v48, v88, 0
    v_dot2_f32_bf16 v33, v49, v88, 0
    v_perm_b32 v50, v101, v97, s64
    v_perm_b32 v51, v101, v97, s65
    v_dot2_f32_bf16 v34, v50, v88, 0
    v_dot2_f32_bf16 v35, v51, v88, 0
    v_perm_b32 v48, v102, v98, s64
    v_perm_b32 v49, v102, v98, s65
    v_dot2_f32_bf16 v36, v48, v88, 0
    v_dot2_f32_bf16 v37, v49, v88, 0
    v_perm_b32 v50, v103, v99, s64
    v_perm_b32 v51, v103, v99, s65
    v_dot2_f32_bf16 v38, v50, v88, 0
    v_dot2_f32_bf16 v39, v51, v88, 0
    v_perm_b32 v48, v132, v128, s64
    v_perm_b32 v49, v132, v128, s65
    v_dot2_f32_bf16 v40, v48, v88, 0
    v_dot2_f32_bf16 v41, v49, v88, 0
    v_perm_b32 v50, v133, v129, s64
    v_perm_b32 v51, v133, v129, s65
    v_dot2_f32_bf16 v42, v50, v88, 0
    v_dot2_f32_bf16 v43, v51, v88, 0
    v_perm_b32 v48, v134, v130, s64
    v_perm_b32 v49, v134, v130, s65
    v_dot2_f32_bf16 v44, v48, v88, 0
    v_dot2_f32_bf16 v45, v49, v88, 0
    v_perm_b32 v50, v135, v131, s64
    v_perm_b32 v51, v135, v131, s65
    v_dot2_f32_bf16 v46, v50, v88, 0
    v_dot2_f32_bf16 v47, v51, v88, 0
    v_perm_b32 v48, v108, v104, s64
    v_perm_b32 v49, v108, v104, s65
    v_dot2_f32_bf16 v32, v48, v89, v32
    v_dot2_f32_bf16 v33, v49, v89, v33
    v_perm_b32 v50, v109, v105, s64
    v_perm_b32 v51, v109, v105, s65
    v_dot2_f32_bf16 v34, v50, v89, v34
    v_dot2_f32_bf16 v35, v51, v89, v35
    v_perm_b32 v48, v110, v106, s64
    v_perm_b32 v49, v110, v106, s65
    v_dot2_f32_bf16 v36, v48, v89, v36
    v_dot2_f32_bf16 v37, v49, v89, v37
    v_perm_b32 v50, v111, v107, s64
    v_perm_b32 v51, v111, v107, s65
    v_dot2_f32_bf16 v38, v50, v89, v38
    v_dot2_f32_bf16 v39, v51, v89, v39
    v_perm_b32 v48, v140, v136, s64
    v_perm_b32 v49, v140, v136, s65
    v_dot2_f32_bf16 v40, v48, v89, v40
    v_dot2_f32_bf16 v41, v49, v89, v41
    v_perm_b32 v50, v141, v137, s64
    v_perm_b32 v51, v141, v137, s65
    v_dot2_f32_bf16 v42, v50, v89, v42
    v_dot2_f32_bf16 v43, v51, v89, v43
    v_perm_b32 v48, v142, v138, s64
    v_perm_b32 v49, v142, v138, s65
    v_dot2_f32_bf16 v44, v48, v89, v44
    v_dot2_f32_bf16 v45, v49, v89, v45
    v_perm_b32 v50, v143, v139, s64
    v_perm_b32 v51, v143, v139, s65
    v_dot2_f32_bf16 v46, v50, v89, v46
    v_dot2_f32_bf16 v47, v51, v89, v47
    s_barrier
    s_mov_b32 s65, 262144
    s_add_u32 m0, s7, 73728
    s_nop 0
    buffer_load_dwordx4 v10, s[12:15], s65 offen lds
    s_add_u32 m0, s7, 77824
    s_add_u32 s65, s65, 65536
    buffer_load_dwordx4 v10, s[12:15], s65 offen lds
    s_mov_b32 s65, 1310720
    s_add_u32 m0, s7, 81920
    s_nop 0
    buffer_load_dwordx4 v10, s[12:15], s65 offen lds
    s_add_u32 m0, s7, 86016
    s_add_u32 s65, s65, 65536
    buffer_load_dwordx4 v10, s[12:15], s65 offen lds
    s_mov_b32 s65, 393216
    s_add_u32 m0, s7, 114688
    s_nop 0
    buffer_load_dwordx4 v10, s[12:15], s65 offen lds
    s_add_u32 m0, s7, 118784
    s_add_u32 s65, s65, 65536
    buffer_load_dwordx4 v10, s[12:15], s65 offen lds
    s_mov_b32 s65, 1441792
    s_add_u32 m0, s7, 122880
    s_nop 0
    buffer_load_dwordx4 v10, s[12:15], s65 offen lds
    s_add_u32 m0, s7, 126976
    s_add_u32 s65, s65, 65536
    buffer_load_dwordx4 v10, s[12:15], s65 offen lds
    s_mov_b32 s64, 0x05040100
    s_mov_b32 s65, 0x07060302
    v_perm_b32 v48, v116, v112, s64
    v_perm_b32 v49, v116, v112, s65
    v_dot2_f32_bf16 v32, v48, v90, v32
    v_dot2_f32_bf16 v33, v49, v90, v33
    v_perm_b32 v50, v117, v113, s64
    v_perm_b32 v51, v117, v113, s65
    v_dot2_f32_bf16 v34, v50, v90, v34
    v_dot2_f32_bf16 v35, v51, v90, v35
    v_perm_b32 v48, v118, v114, s64
    v_perm_b32 v49, v118, v114, s65
    v_dot2_f32_bf16 v36, v48, v90, v36
    v_dot2_f32_bf16 v37, v49, v90, v37
    v_perm_b32 v50, v119, v115, s64
    v_perm_b32 v51, v119, v115, s65
    v_dot2_f32_bf16 v38, v50, v90, v38
    v_dot2_f32_bf16 v39, v51, v90, v39
    v_perm_b32 v48, v148, v144, s64
    v_perm_b32 v49, v148, v144, s65
    v_dot2_f32_bf16 v40, v48, v90, v40
    v_dot2_f32_bf16 v41, v49, v90, v41
    v_perm_b32 v50, v149, v145, s64
    v_perm_b32 v51, v149, v145, s65
    v_dot2_f32_bf16 v42, v50, v90, v42
    v_dot2_f32_bf16 v43, v51, v90, v43
    v_perm_b32 v48, v150, v146, s64
    v_perm_b32 v49, v150, v146, s65
    v_dot2_f32_bf16 v44, v48, v90, v44
    v_dot2_f32_bf16 v45, v49, v90, v45
    v_perm_b32 v50, v151, v147, s64
    v_perm_b32 v51, v151, v147, s65
    v_dot2_f32_bf16 v46, v50, v90, v46
    v_dot2_f32_bf16 v47, v51, v90, v47
    v_perm_b32 v48, v124, v120, s64
    v_perm_b32 v49, v124, v120, s65
    v_dot2_f32_bf16 v32, v48, v91, v32
    v_dot2_f32_bf16 v33, v49, v91, v33
    v_perm_b32 v50, v125, v121, s64
    v_perm_b32 v51, v125, v121, s65
    v_dot2_f32_bf16 v34, v50, v91, v34
    v_dot2_f32_bf16 v35, v51, v91, v35
    v_perm_b32 v48, v126, v122, s64
    v_perm_b32 v49, v126, v122, s65
    v_dot2_f32_bf16 v36, v48, v91, v36
    v_dot2_f32_bf16 v37, v49, v91, v37
    v_perm_b32 v50, v127, v123, s64
    v_perm_b32 v51, v127, v123, s65
    v_dot2_f32_bf16 v38, v50, v91, v38
    v_dot2_f32_bf16 v39, v51, v91, v39
    v_perm_b32 v48, v156, v152, s64
    v_perm_b32 v49, v156, v152, s65
    v_dot2_f32_bf16 v40, v48, v91, v40
    v_dot2_f32_bf16 v41, v49, v91, v41
    v_perm_b32 v50, v157, v153, s64
    v_perm_b32 v51, v157, v153, s65
    v_dot2_f32_bf16 v42, v50, v91, v42
    v_dot2_f32_bf16 v43, v51, v91, v43
    v_perm_b32 v48, v158, v154, s64
    v_perm_b32 v49, v158, v154, s65
    v_dot2_f32_bf16 v44, v48, v91, v44
    v_dot2_f32_bf16 v45, v49, v91, v45
    v_perm_b32 v50, v159, v155, s64
    v_perm_b32 v51, v159, v155, s65
    v_dot2_f32_bf16 v46, v50, v91, v46
    v_dot2_f32_bf16 v47, v51, v91, v47
    s_nop 2
    s_nop 1
    v_permlane16_swap_b32 v32, v36
    v_permlane16_swap_b32 v33, v37
    v_permlane16_swap_b32 v34, v38
    v_permlane16_swap_b32 v35, v39
    v_permlane16_swap_b32 v40, v44
    v_permlane16_swap_b32 v41, v45
    v_permlane16_swap_b32 v42, v46
    v_permlane16_swap_b32 v43, v47
    v_add_f32 v32, v32, v36
    v_add_f32 v33, v33, v37
    v_add_f32 v34, v34, v38
    v_add_f32 v35, v35, v39
    v_add_f32 v40, v40, v44
    v_add_f32 v41, v41, v45
    v_add_f32 v42, v42, v46
    v_add_f32 v43, v43, v47
    s_nop 1
    v_permlane32_swap_b32 v32, v40
    v_permlane32_swap_b32 v33, v41
    v_permlane32_swap_b32 v34, v42
    v_permlane32_swap_b32 v35, v43
    v_add_f32 v32, v32, v40
    v_add_f32 v33, v33, v41
    v_add_f32 v34, v34, v42
    v_add_f32 v35, v35, v43
    s_mov_b32 exec_lo, 0x3fff3fff
    s_mov_b32 exec_hi, 0x3fff3fff
    buffer_store_dwordx4 v[32:35], v12, s[16:19], 0 offen sc0 sc1
    s_mov_b64 exec, -1
    s_barrier
    v_lshrrev_b32 v230, 3, v0
    s_lshl_b32 s64, s4, 7
    v_add_u32 v230, s64, v230
    v_lshlrev_b32 v231, 11, v230
    v_and_b32 v3, 7, v0
    v_lshl_add_u32 v231, v3, 4, v231
    s_lshl_b32 s64, s5, 7
    v_add_u32 v231, s64, v231
    s_mov_b32 s64, 131072
    v_lshlrev_b32 v3, 2, v230
    v_add_u32 v3, 6709248, v3
    buffer_load_dwordx4 v[220:223], v231, s[8:11], 0 offen
    buffer_load_dwordx4 v[224:227], v231, s[8:11], s64 offen
    buffer_load_dword v228, v3, s[16:19], 0 offen sc1
    buffer_load_dword v229, v3, s[16:19], 0 offen offset:256 sc1
    s_mov_b32 s65, 524288
    s_add_u32 m0, s7, 40960
    s_nop 0
    buffer_load_dwordx4 v10, s[12:15], s65 offen lds
    s_add_u32 m0, s7, 45056
    s_add_u32 s65, s65, 65536
    buffer_load_dwordx4 v10, s[12:15], s65 offen lds
    s_mov_b32 s65, 1572864
    s_add_u32 m0, s7, 49152
    s_nop 0
    buffer_load_dwordx4 v10, s[12:15], s65 offen lds
    s_add_u32 m0, s7, 53248
    s_add_u32 s65, s65, 65536
    buffer_load_dwordx4 v10, s[12:15], s65 offen lds
    s_mov_b32 s65, 655360
    s_add_u32 m0, s7, 8192
    s_nop 0
    buffer_load_dwordx4 v10, s[12:15], s65 offen lds
    s_add_u32 m0, s7, 12288
    s_add_u32 s65, s65, 65536
    buffer_load_dwordx4 v10, s[12:15], s65 offen lds
    s_mov_b32 s65, 1703936
    s_add_u32 m0, s7, 57344
    s_nop 0
    buffer_load_dwordx4 v10, s[12:15], s65 offen lds
    s_add_u32 m0, s7, 61440
    s_add_u32 s65, s65, 65536
    buffer_load_dwordx4 v10, s[12:15], s65 offen lds
    s_mov_b32 s65, 786432
    s_add_u32 m0, s7, 16384
    s_nop 0
    buffer_load_dwordx4 v10, s[12:15], s65 offen lds
    s_add_u32 m0, s7, 20480
    s_add_u32 s65, s65, 65536
    buffer_load_dwordx4 v10, s[12:15], s65 offen lds
    s_mov_b32 s65, 1835008
    s_add_u32 m0, s7, 65536
    s_nop 0
    buffer_load_dwordx4 v10, s[12:15], s65 offen lds
    s_add_u32 m0, s7, 69632
    s_add_u32 s65, s65, 65536
    buffer_load_dwordx4 v10, s[12:15], s65 offen lds
    s_mov_b32 s65, 917504
    s_add_u32 m0, s7, 24576
    s_nop 0
    buffer_load_dwordx4 v10, s[12:15], s65 offen lds
    s_add_u32 m0, s7, 28672
    s_add_u32 s65, s65, 65536
    buffer_load_dwordx4 v10, s[12:15], s65 offen lds
    s_mov_b32 s65, 1966080
    s_add_u32 m0, s7, 90112
    s_nop 0
    buffer_load_dwordx4 v10, s[12:15], s65 offen lds
    s_add_u32 m0, s7, 94208
    s_add_u32 s65, s65, 65536
    buffer_load_dwordx4 v10, s[12:15], s65 offen lds
    s_mov_b64 exec, 1
    v_mov_b32 v20, 0
    buffer_atomic_or v20, v23, s[16:19], 0 offen sc0
    s_mov_b64 exec, -1
    v_add_u32 v17, s70, v6
    v_lshrrev_b32 v18, 2, v2
    v_mul_u32_u24 v18, 1152, v18
    v_and_b32 v19, 3, v2
    v_lshl_add_u32 v18, v19, 4, v18
    s_add_u32 s64, s70, 1024
    v_add_u32 v18, s64, v18
    v_bfe_u32 v26, v2, 3, 1
    v_lshl_add_u32 v26, v26, 2, v19
    v_bfe_u32 v27, v2, 2, 1
    v_lshrrev_b32 v28, 5, v2
    v_cmp_eq_u32 vcc, v27, v28
    v_and_b32 v27, 16, v2
    v_cmp_eq_u32 s[64:65], 0, v27
    s_and_b64 vcc, vcc, s[64:65]
    v_and_b32 v27, 1, v26
    v_lshlrev_b32 v27, 4, v27
    v_mov_b32 v28, 0x3f80
    v_lshlrev_b32 v27, v27, v28
    v_cndmask_b32 v27, 0, v27, vcc
    v_lshrrev_b32 v26, 1, v26
    v_cmp_eq_u32 vcc, 0, v26
    s_nop 1
    v_cndmask_b32 v48, 0, v27, vcc
    v_cmp_eq_u32 vcc, 1, v26
    s_nop 1
    v_cndmask_b32 v49, 0, v27, vcc
    v_cmp_eq_u32 vcc, 2, v26
    s_nop 1
    v_cndmask_b32 v50, 0, v27, vcc
    v_cmp_eq_u32 vcc, 3, v26
    s_nop 1
    v_cndmask_b32 v51, 0, v27, vcc
    v_mov_b32 v128, 0
    v_mov_b32 v129, 0
    v_mov_b32 v130, 0
    v_mov_b32 v131, 0
    v_mov_b32 v132, 0
    v_mov_b32 v133, 0
    v_mov_b32 v134, 0
    v_mov_b32 v135, 0
    v_mov_b32 v136, 0
    v_mov_b32 v137, 0
    v_mov_b32 v138, 0
    v_mov_b32 v139, 0
    v_mov_b32 v140, 0
    v_mov_b32 v141, 0
    v_mov_b32 v142, 0
    v_mov_b32 v143, 0
    s_mov_b32 s66, 0xffff
    s_mov_b32 s65, 0
    s_waitcnt vmcnt(0)
G_loop:
    v_readfirstlane_b32 s68, v20
    s_and_b32 s68, s68, s66
    s_andn2_b32 s66, s66, s68
    s_bcnt1_i32_b32 s67, s68
    s_cmp_eq_u32 s67, 0
    s_cbranch_scc1 G_l0
    s_cmp_gt_u32 s67, 8
    s_cbranch_scc1 G_lt_1
    s_cmp_gt_u32 s67, 4
    s_cbranch_scc1 G_lt_2
    s_cmp_gt_u32 s67, 2
    s_cbranch_scc1 G_lt_3
    s_cmp_eq_u32 s67, 1
    s_cbranch_scc1 G_l1
    s_branch G_l2
G_lt_3:
    s_cmp_eq_u32 s67, 3
    s_cbranch_scc1 G_l3
    s_branch G_l4
G_lt_2:
    s_cmp_gt_u32 s67, 6
    s_cbranch_scc1 G_lt_4
    s_cmp_eq_u32 s67, 5
    s_cbranch_scc1 G_l5
    s_branch G_l6
G_lt_4:
    s_cmp_eq_u32 s67, 7
    s_cbranch_scc1 G_l7
    s_branch G_l8
G_lt_1:
    s_cmp_gt_u32 s67, 12
    s_cbranch_scc1 G_lt_5
    s_cmp_gt_u32 s67, 10
    s_cbranch_scc1 G_lt_6
    s_cmp_eq_u32 s67, 9
    s_cbranch_scc1 G_l9
    s_branch G_l10
G_lt_6:
    s_cmp_eq_u32 s67, 11
    s_cbranch_scc1 G_l11
    s_branch G_l12
G_lt_5:
    s_cmp_gt_u32 s67, 14
    s_cbranch_scc1 G_lt_7
    s_cmp_eq_u32 s67, 13
    s_cbranch_scc1 G_l13
    s_branch G_l14
G_lt_7:
    s_cmp_eq_u32 s67, 15
    s_cbranch_scc1 G_l15
G_l16:
    s_ff1_i32_b32 s55, s68
    s_bitset0_b32 s68, s55
    s_mul_i32 s64, s55, 1152
    buffer_load_dwordx4 v[124:127], v17, s[16:19], s64 offen sc1
G_l15:
    s_ff1_i32_b32 s54, s68
    s_bitset0_b32 s68, s54
    s_mul_i32 s64, s54, 1152
    buffer_load_dwordx4 v[120:123], v17, s[16:19], s64 offen sc1
G_l14:
    s_ff1_i32_b32 s53, s68
    s_bitset0_b32 s68, s53
    s_mul_i32 s64, s53, 1152
    buffer_load_dwordx4 v[116:119], v17, s[16:19], s64 offen sc1
G_l13:
    s_ff1_i32_b32 s52, s68
    s_bitset0_b32 s68, s52
    s_mul_i32 s64, s52, 1152
    buffer_load_dwordx4 v[112:115], v17, s[16:19], s64 offen sc1
G_l12:
    s_ff1_i32_b32 s51, s68
    s_bitset0_b32 s68, s51
    s_mul_i32 s64, s51, 1152
    buffer_load_dwordx4 v[108:111], v17, s[16:19], s64 offen sc1
G_l11:
    s_ff1_i32_b32 s50, s68
    s_bitset0_b32 s68, s50
    s_mul_i32 s64, s50, 1152
    buffer_load_dwordx4 v[104:107], v17, s[16:19], s64 offen sc1
G_l10:
    s_ff1_i32_b32 s49, s68
    s_bitset0_b32 s68, s49
    s_mul_i32 s64, s49, 1152
    buffer_load_dwordx4 v[100:103], v17, s[16:19], s64 offen sc1
G_l9:
    s_ff1_i32_b32 s48, s68
    s_bitset0_b32 s68, s48
    s_mul_i32 s64, s48, 1152
    buffer_load_dwordx4 v[96:99], v17, s[16:19], s64 offen sc1
G_l8:
    s_ff1_i32_b32 s47, s68
    s_bitset0_b32 s68, s47
    s_mul_i32 s64, s47, 1152
    buffer_load_dwordx4 v[92:95], v17, s[16:19], s64 offen sc1
G_l7:
    s_ff1_i32_b32 s46, s68
    s_bitset0_b32 s68, s46
    s_mul_i32 s64, s46, 1152
    buffer_load_dwordx4 v[88:91], v17, s[16:19], s64 offen sc1
G_l6:
    s_ff1_i32_b32 s45, s68
    s_bitset0_b32 s68, s45
    s_mul_i32 s64, s45, 1152
    buffer_load_dwordx4 v[84:87], v17, s[16:19], s64 offen sc1
G_l5:
    s_ff1_i32_b32 s44, s68
    s_bitset0_b32 s68, s44
    s_mul_i32 s64, s44, 1152
    buffer_load_dwordx4 v[80:83], v17, s[16:19], s64 offen sc1
G_l4:
    s_ff1_i32_b32 s43, s68
    s_bitset0_b32 s68, s43
    s_mul_i32 s64, s43, 1152
    buffer_load_dwordx4 v[76:79], v17, s[16:19], s64 offen sc1
G_l3:
    s_ff1_i32_b32 s42, s68
    s_bitset0_b32 s68, s42
    s_mul_i32 s64, s42, 1152
    buffer_load_dwordx4 v[72:75], v17, s[16:19], s64 offen sc1
G_l2:
    s_ff1_i32_b32 s41, s68
    s_bitset0_b32 s68, s41
    s_mul_i32 s64, s41, 1152
    buffer_load_dwordx4 v[68:71], v17, s[16:19], s64 offen sc1
G_l1:
    s_ff1_i32_b32 s40, s68
    s_bitset0_b32 s68, s40
    s_mul_i32 s64, s40, 1152
    buffer_load_dwordx4 v[64:67], v17, s[16:19], s64 offen sc1
G_l0:
    s_mov_b32 s68, s66
    s_cmp_eq_u32 s66, 0
    s_cbranch_scc1 G_z
    s_cmp_lg_u32 s67, 0
    s_cbranch_scc1 G_p
    s_sleep 2
G_p:
    s_mov_b64 exec, 1
    v_mov_b32 v20, 0
    buffer_atomic_or v20, v23, s[16:19], 0 offen sc0
    s_mov_b64 exec, -1
    s_branch G_proc
G_z:
    buffer_load_dwordx4 v[56:59], v18, s[16:19], 0 offen sc1
G_proc:
    s_cmp_eq_u32 s67, 0
    s_cbranch_scc1 G_q0
    s_cmp_gt_u32 s67, 8
    s_cbranch_scc1 G_qt_8
    s_cmp_gt_u32 s67, 4
    s_cbranch_scc1 G_qt_9
    s_cmp_gt_u32 s67, 2
    s_cbranch_scc1 G_qt_10
    s_cmp_eq_u32 s67, 1
    s_cbranch_scc1 G_q1
    s_branch G_q2
G_qt_10:
    s_cmp_eq_u32 s67, 3
    s_cbranch_scc1 G_q3
    s_branch G_q4
G_qt_9:
    s_cmp_gt_u32 s67, 6
    s_cbranch_scc1 G_qt_11
    s_cmp_eq_u32 s67, 5
    s_cbranch_scc1 G_q5
    s_branch G_q6
G_qt_11:
    s_cmp_eq_u32 s67, 7
    s_cbranch_scc1 G_q7
    s_branch G_q8
G_qt_8:
    s_cmp_gt_u32 s67, 12
    s_cbranch_scc1 G_qt_12
    s_cmp_gt_u32 s67, 10
    s_cbranch_scc1 G_qt_13
    s_cmp_eq_u32 s67, 9
    s_cbranch_scc1 G_q9
    s_branch G_q10
G_qt_13:
    s_cmp_eq_u32 s67, 11
    s_cbranch_scc1 G_q11
    s_branch G_q12
G_qt_12:
    s_cmp_gt_u32 s67, 14
    s_cbranch_scc1 G_qt_14
    s_cmp_eq_u32 s67, 13
    s_cbranch_scc1 G_q13
    s_branch G_q14
G_qt_14:
    s_cmp_eq_u32 s67, 15
    s_cbranch_scc1 G_q15
G_q16:
    s_waitcnt vmcnt(16)
    v_max3_u32 v21, v124, v125, v126
    v_max_u32 v21, v21, v127
    v_cmp_eq_u32 vcc, -1, v21
    s_cbranch_vccnz G_f15
    v_mfma_f32_32x32x16_bf16 v[128:143], v[48:51], v[124:127], v[128:143]
G_q15:
    s_waitcnt vmcnt(15)
    v_max3_u32 v21, v120, v121, v122
    v_max_u32 v21, v21, v123
    v_cmp_eq_u32 vcc, -1, v21
    s_cbranch_vccnz G_f14
    v_mfma_f32_32x32x16_bf16 v[128:143], v[48:51], v[120:123], v[128:143]
G_q14:
    s_waitcnt vmcnt(14)
    v_max3_u32 v21, v116, v117, v118
    v_max_u32 v21, v21, v119
    v_cmp_eq_u32 vcc, -1, v21
    s_cbranch_vccnz G_f13
    v_mfma_f32_32x32x16_bf16 v[128:143], v[48:51], v[116:119], v[128:143]
G_q13:
    s_waitcnt vmcnt(13)
    v_max3_u32 v21, v112, v113, v114
    v_max_u32 v21, v21, v115
    v_cmp_eq_u32 vcc, -1, v21
    s_cbranch_vccnz G_f12
    v_mfma_f32_32x32x16_bf16 v[128:143], v[48:51], v[112:115], v[128:143]
G_q12:
    s_waitcnt vmcnt(12)
    v_max3_u32 v21, v108, v109, v110
    v_max_u32 v21, v21, v111
    v_cmp_eq_u32 vcc, -1, v21
    s_cbranch_vccnz G_f11
    v_mfma_f32_32x32x16_bf16 v[128:143], v[48:51], v[108:111], v[128:143]
G_q11:
    s_waitcnt vmcnt(11)
    v_max3_u32 v21, v104, v105, v106
    v_max_u32 v21, v21, v107
    v_cmp_eq_u32 vcc, -1, v21
    s_cbranch_vccnz G_f10
    v_mfma_f32_32x32x16_bf16 v[128:143], v[48:51], v[104:107], v[128:143]
G_q10:
    s_waitcnt vmcnt(10)
    v_max3_u32 v21, v100, v101, v102
    v_max_u32 v21, v21, v103
    v_cmp_eq_u32 vcc, -1, v21
    s_cbranch_vccnz G_f9
    v_mfma_f32_32x32x16_bf16 v[128:143], v[48:51], v[100:103], v[128:143]
G_q9:
    s_waitcnt vmcnt(9)
    v_max3_u32 v21, v96, v97, v98
    v_max_u32 v21, v21, v99
    v_cmp_eq_u32 vcc, -1, v21
    s_cbranch_vccnz G_f8
    v_mfma_f32_32x32x16_bf16 v[128:143], v[48:51], v[96:99], v[128:143]
G_q8:
    s_waitcnt vmcnt(8)
    v_max3_u32 v21, v92, v93, v94
    v_max_u32 v21, v21, v95
    v_cmp_eq_u32 vcc, -1, v21
    s_cbranch_vccnz G_f7
    v_mfma_f32_32x32x16_bf16 v[128:143], v[48:51], v[92:95], v[128:143]
G_q7:
    s_waitcnt vmcnt(7)
    v_max3_u32 v21, v88, v89, v90
    v_max_u32 v21, v21, v91
    v_cmp_eq_u32 vcc, -1, v21
    s_cbranch_vccnz G_f6
    v_mfma_f32_32x32x16_bf16 v[128:143], v[48:51], v[88:91], v[128:143]
G_q6:
    s_waitcnt vmcnt(6)
    v_max3_u32 v21, v84, v85, v86
    v_max_u32 v21, v21, v87
    v_cmp_eq_u32 vcc, -1, v21
    s_cbranch_vccnz G_f5
    v_mfma_f32_32x32x16_bf16 v[128:143], v[48:51], v[84:87], v[128:143]
G_q5:
    s_waitcnt vmcnt(5)
    v_max3_u32 v21, v80, v81, v82
    v_max_u32 v21, v21, v83
    v_cmp_eq_u32 vcc, -1, v21
    s_cbranch_vccnz G_f4
    v_mfma_f32_32x32x16_bf16 v[128:143], v[48:51], v[80:83], v[128:143]
G_q4:
    s_waitcnt vmcnt(4)
    v_max3_u32 v21, v76, v77, v78
    v_max_u32 v21, v21, v79
    v_cmp_eq_u32 vcc, -1, v21
    s_cbranch_vccnz G_f3
    v_mfma_f32_32x32x16_bf16 v[128:143], v[48:51], v[76:79], v[128:143]
G_q3:
    s_waitcnt vmcnt(3)
    v_max3_u32 v21, v72, v73, v74
    v_max_u32 v21, v21, v75
    v_cmp_eq_u32 vcc, -1, v21
    s_cbranch_vccnz G_f2
    v_mfma_f32_32x32x16_bf16 v[128:143], v[48:51], v[72:75], v[128:143]
G_q2:
    s_waitcnt vmcnt(2)
    v_max3_u32 v21, v68, v69, v70
    v_max_u32 v21, v21, v71
    v_cmp_eq_u32 vcc, -1, v21
    s_cbranch_vccnz G_f1
    v_mfma_f32_32x32x16_bf16 v[128:143], v[48:51], v[68:71], v[128:143]
G_q1:
    s_waitcnt vmcnt(1)
    v_max3_u32 v21, v64, v65, v66
    v_max_u32 v21, v21, v67
    v_cmp_eq_u32 vcc, -1, v21
    s_cbranch_vccnz G_f0
    v_mfma_f32_32x32x16_bf16 v[128:143], v[48:51], v[64:67], v[128:143]
G_q0:
    s_waitcnt vmcnt(0)
    s_add_u32 s65, s65, 1
    s_cmp_ge_u32 s65, 40000
    s_cbranch_scc1 G_done
    s_cmp_lg_u32 s68, 0
    s_cbranch_scc1 G_loop
    v_mov_b32 v20, -1
    s_cmp_lg_u32 s66, 0
    s_cbranch_scc1 G_loop
    v_max3_u32 v21, v56, v57, v58
    v_max_u32 v21, v21, v59
    v_cmp_eq_u32 vcc, -1, v21
    s_cbranch_vccnz G_loop
G_done:
    v_add_u32 v16, s7, v6
    v_add_f32_dpp v56, v56, v56 row_ror:4 row_mask:0xf bank_mask:0xf
    v_add_f32_dpp v57, v57, v57 row_ror:4 row_mask:0xf bank_mask:0xf
    v_add_f32_dpp v58, v58, v58 row_ror:4 row_mask:0xf bank_mask:0xf
    v_add_f32_dpp v59, v59, v59 row_ror:4 row_mask:0xf bank_mask:0xf
    v_add_f32_dpp v56, v56, v56 row_ror:8 row_mask:0xf bank_mask:0xf
    v_add_f32_dpp v57, v57, v57 row_ror:8 row_mask:0xf bank_mask:0xf
    v_add_f32_dpp v58, v58, v58 row_ror:8 row_mask:0xf bank_mask:0xf
    v_add_f32_dpp v59, v59, v59 row_ror:8 row_mask:0xf bank_mask:0xf
    v_mov_b32 v64, v56
    v_mov_b32 v65, v57
    v_mov_b32 v66, v58
    v_mov_b32 v67, v59
    s_nop 0
    v_permlane16_swap_b32 v56, v64
    v_permlane16_swap_b32 v57, v65
    v_permlane16_swap_b32 v58, v66
    v_permlane16_swap_b32 v59, v67
    v_add_f32 v56, v56, v64
    v_add_f32 v57, v57, v65
    v_add_f32 v58, v58, v66
    v_add_f32 v59, v59, v67
    v_mov_b32 v64, v56
    v_mov_b32 v65, v57
    v_mov_b32 v66, v58
    v_mov_b32 v67, v59
    s_nop 0
    v_permlane32_swap_b32 v56, v64
    v_permlane32_swap_b32 v57, v65
    v_permlane32_swap_b32 v58, v66
    v_permlane32_swap_b32 v59, v67
    v_add_f32 v56, v56, v64
    v_add_f32 v57, v57, v65
    v_add_f32 v58, v58, v66
    v_add_f32 v59, v59, v67
    v_cvt_pk_bf16_f32 v60, v128, v129
    v_cvt_pk_bf16_f32 v61, v130, v131
    v_cvt_pk_bf16_f32 v62, v132, v133
    v_cvt_pk_bf16_f32 v63, v134, v135
    ds_write_b128 v16, v[60:63] offset:0
    v_cvt_pk_bf16_f32 v56, v56, v57
    v_cvt_pk_bf16_f32 v57, v58, v59
    v_and_b32 v16, 1, v2
    v_lshlrev_b32 v16, 4, v16
    v_bfe_u32 v17, v2, 1, 1
    v_lshl_add_u32 v16, v17, 3, v16
    s_lshl_b32 s64, s6, 5
    v_add_u32 v16, s64, v16
    s_mov_b64 exec, 15
    ds_write_b64 v16, v[56:57] offset:4096
    s_mov_b64 exec, -1
    s_waitcnt lgkmcnt(0)
    s_barrier
    v_lshrrev_b32 v18, 3, v2
    v_lshlrev_b32 v18, 2, v18
    ds_read_b32 v24, v18 offset:4352
    ds_read_b32 v25, v18 offset:4384
    ds_read_b32 v26, v18 offset:4416
    ds_read_b32 v27, v18 offset:4448
    ds_read_b32 v28, v18 offset:4480
    ds_read_b32 v29, v18 offset:4512
    ds_read_b32 v30, v18 offset:4544
    s_waitcnt lgkmcnt(0)
    v_lshlrev_b32 v48, 16, v192
    v_and_b32 v49, 0xffff0000, v192
    v_mul_f32 v32, v48, v24
    v_mul_f32 v33, v49, v24
    v_lshlrev_b32 v48, 16, v193
    v_and_b32 v49, 0xffff0000, v193
    v_mul_f32 v34, v48, v24
    v_mul_f32 v35, v49, v24
    v_lshlrev_b32 v48, 16, v194
    v_and_b32 v49, 0xffff0000, v194
    v_mul_f32 v36, v48, v24
    v_mul_f32 v37, v49, v24
    v_lshlrev_b32 v48, 16, v195
    v_and_b32 v49, 0xffff0000, v195
    v_mul_f32 v38, v48, v24
    v_mul_f32 v39, v49, v24
    v_lshlrev_b32 v48, 16, v196
    v_and_b32 v49, 0xffff0000, v196
    v_fmac_f32 v32, v48, v25
    v_fmac_f32 v33, v49, v25
    v_lshlrev_b32 v48, 16, v197
    v_and_b32 v49, 0xffff0000, v197
    v_fmac_f32 v34, v48, v25
    v_fmac_f32 v35, v49, v25
    v_lshlrev_b32 v48, 16, v198
    v_and_b32 v49, 0xffff0000, v198
    v_fmac_f32 v36, v48, v25
    v_fmac_f32 v37, v49, v25
    v_lshlrev_b32 v48, 16, v199
    v_and_b32 v49, 0xffff0000, v199
    v_fmac_f32 v38, v48, v25
    v_fmac_f32 v39, v49, v25
    v_lshlrev_b32 v48, 16, v200
    v_and_b32 v49, 0xffff0000, v200
    v_fmac_f32 v32, v48, v26
    v_fmac_f32 v33, v49, v26
    v_lshlrev_b32 v48, 16, v201
    v_and_b32 v49, 0xffff0000, v201
    v_fmac_f32 v34, v48, v26
    v_fmac_f32 v35, v49, v26
    v_lshlrev_b32 v48, 16, v202
    v_and_b32 v49, 0xffff0000, v202
    v_fmac_f32 v36, v48, v26
    v_fmac_f32 v37, v49, v26
    v_lshlrev_b32 v48, 16, v203
    v_and_b32 v49, 0xffff0000, v203
    v_fmac_f32 v38, v48, v26
    v_fmac_f32 v39, v49, v26
    v_lshlrev_b32 v48, 16, v204
    v_and_b32 v49, 0xffff0000, v204
    v_fmac_f32 v32, v48, v27
    v_fmac_f32 v33, v49, v27
    v_lshlrev_b32 v48, 16, v205
    v_and_b32 v49, 0xffff0000, v205
    v_fmac_f32 v34, v48, v27
    v_fmac_f32 v35, v49, v27
    v_lshlrev_b32 v48, 16, v206
    v_and_b32 v49, 0xffff0000, v206
    v_fmac_f32 v36, v48, v27
    v_fmac_f32 v37, v49, v27
    v_lshlrev_b32 v48, 16, v207
    v_and_b32 v49, 0xffff0000, v207
    v_fmac_f32 v38, v48, v27
    v_fmac_f32 v39, v49, v27
    v_lshlrev_b32 v48, 16, v208
    v_and_b32 v49, 0xffff0000, v208
    v_fmac_f32 v32, v48, v28
    v_fmac_f32 v33, v49, v28
    v_lshlrev_b32 v48, 16, v209
    v_and_b32 v49, 0xffff0000, v209
    v_fmac_f32 v34, v48, v28
    v_fmac_f32 v35, v49, v28
    v_lshlrev_b32 v48, 16, v210
    v_and_b32 v49, 0xffff0000, v210
    v_fmac_f32 v36, v48, v28
    v_fmac_f32 v37, v49, v28
    v_lshlrev_b32 v48, 16, v211
    v_and_b32 v49, 0xffff0000, v211
    v_fmac_f32 v38, v48, v28
    v_fmac_f32 v39, v49, v28
    v_lshlrev_b32 v48, 16, v212
    v_and_b32 v49, 0xffff0000, v212
    v_fmac_f32 v32, v48, v29
    v_fmac_f32 v33, v49, v29
    v_lshlrev_b32 v48, 16, v213
    v_and_b32 v49, 0xffff0000, v213
    v_fmac_f32 v34, v48, v29
    v_fmac_f32 v35, v49, v29
    v_lshlrev_b32 v48, 16, v214
    v_and_b32 v49, 0xffff0000, v214
    v_fmac_f32 v36, v48, v29
    v_fmac_f32 v37, v49, v29
    v_lshlrev_b32 v48, 16, v215
    v_and_b32 v49, 0xffff0000, v215
    v_fmac_f32 v38, v48, v29
    v_fmac_f32 v39, v49, v29
    v_lshlrev_b32 v48, 16, v216
    v_and_b32 v49, 0xffff0000, v216
    v_fmac_f32 v32, v48, v30
    v_fmac_f32 v33, v49, v30
    v_lshlrev_b32 v48, 16, v217
    v_and_b32 v49, 0xffff0000, v217
    v_fmac_f32 v34, v48, v30
    v_fmac_f32 v35, v49, v30
    v_lshlrev_b32 v48, 16, v218
    v_and_b32 v49, 0xffff0000, v218
    v_fmac_f32 v36, v48, v30
    v_fmac_f32 v37, v49, v30
    v_lshlrev_b32 v48, 16, v219
    v_and_b32 v49, 0xffff0000, v219
    v_fmac_f32 v38, v48, v30
    v_fmac_f32 v39, v49, v30
    s_nop 1
    v_permlane32_swap_b32 v32, v36
    v_permlane32_swap_b32 v33, v37
    v_permlane32_swap_b32 v34, v38
    v_permlane32_swap_b32 v35, v39
    v_add_f32 v32, v32, v36
    v_add_f32 v33, v33, v37
    v_add_f32 v34, v34, v38
    v_add_f32 v35, v35, v39
    s_nop 1
    v_permlane16_swap_b32 v32, v34
    v_permlane16_swap_b32 v33, v35
    v_add_f32 v32, v32, v34
    v_add_f32 v33, v33, v35
    s_nop 1
    v_add_f32_dpp v32, v32, v32 row_ror:8 row_mask:0xf bank_mask:0xf
    v_add_f32_dpp v33, v33, v33 row_ror:8 row_mask:0xf bank_mask:0xf
    v_and_b32 v16, 7, v2
    v_lshlrev_b32 v16, 5, v16
    v_lshl_add_u32 v16, v8, 3, v16
    s_lshl_b32 s64, s2, 10
    s_lshl_b32 s65, s6, 8
    s_add_u32 s64, s64, s65
    s_add_u32 s64, s64, 6447104
    s_mov_b32 exec_lo, 0x00ff00ff
    s_mov_b32 exec_hi, 0x00ff00ff
    buffer_store_dwordx2 v[32:33], v16, s[16:19], s64 offen sc0 sc1
    s_mov_b64 exec, -1
    v_sub_f32 v248, 1.0, v228
    v_cvt_pk_bf16_f32 v248, v248, v248
    v_lshlrev_b32 v248, 16, v248
    v_lshlrev_b32 v232, 16, v220
    v_and_b32 v233, 0xffff0000, v220
    v_mul_f32 v232, v232, v248
    v_mul_f32 v233, v233, v248
    v_cvt_pk_bf16_f32 v3, v232, v233
    v_lshlrev_b32 v232, 16, v3
    v_and_b32 v233, 0xffff0000, v3
    v_lshlrev_b32 v234, 16, v221
    v_and_b32 v235, 0xffff0000, v221
    v_mul_f32 v234, v234, v248
    v_mul_f32 v235, v235, v248
    v_cvt_pk_bf16_f32 v3, v234, v235
    v_lshlrev_b32 v234, 16, v3
    v_and_b32 v235, 0xffff0000, v3
    v_lshlrev_b32 v236, 16, v222
    v_and_b32 v237, 0xffff0000, v222
    v_mul_f32 v236, v236, v248
    v_mul_f32 v237, v237, v248
    v_cvt_pk_bf16_f32 v3, v236, v237
    v_lshlrev_b32 v236, 16, v3
    v_and_b32 v237, 0xffff0000, v3
    v_lshlrev_b32 v238, 16, v223
    v_and_b32 v239, 0xffff0000, v223
    v_mul_f32 v238, v238, v248
    v_mul_f32 v239, v239, v248
    v_cvt_pk_bf16_f32 v3, v238, v239
    v_lshlrev_b32 v238, 16, v3
    v_and_b32 v239, 0xffff0000, v3
    v_sub_f32 v249, 1.0, v229
    v_cvt_pk_bf16_f32 v249, v249, v249
    v_lshlrev_b32 v249, 16, v249
    v_lshlrev_b32 v240, 16, v224
    v_and_b32 v241, 0xffff0000, v224
    v_mul_f32 v240, v240, v249
    v_mul_f32 v241, v241, v249
    v_cvt_pk_bf16_f32 v3, v240, v241
    v_lshlrev_b32 v240, 16, v3
    v_and_b32 v241, 0xffff0000, v3
    v_lshlrev_b32 v242, 16, v225
    v_and_b32 v243, 0xffff0000, v225
    v_mul_f32 v242, v242, v249
    v_mul_f32 v243, v243, v249
    v_cvt_pk_bf16_f32 v3, v242, v243
    v_lshlrev_b32 v242, 16, v3
    v_and_b32 v243, 0xffff0000, v3
    v_lshlrev_b32 v244, 16, v226
    v_and_b32 v245, 0xffff0000, v226
    v_mul_f32 v244, v244, v249
    v_mul_f32 v245, v245, v249
    v_cvt_pk_bf16_f32 v3, v244, v245
    v_lshlrev_b32 v244, 16, v3
    v_and_b32 v245, 0xffff0000, v3
    v_lshlrev_b32 v246, 16, v227
    v_and_b32 v247, 0xffff0000, v227
    v_mul_f32 v246, v246, v249
    v_mul_f32 v247, v247, v249
    v_cvt_pk_bf16_f32 v3, v246, v247
    v_lshlrev_b32 v246, 16, v3
    v_and_b32 v247, 0xffff0000, v3
    s_branch P2_start
C_start:
    s_getpc_b64 s[68:69]
C_pc:
    s_sub_u32 s68, s68, C_pc-gated_mix__linear_attn_block__moe_arch_mod__prompt_kernel
    s_subb_u32 s69, s69, 0
    s_lshr_b32 s64, s2, 3
    s_lshl_b32 s64, s64, 2
    s_add_u32 s64, s64, s3
    s_mul_i32 s64, s64, 256
    s_mov_b32 s65, CODE_END-gated_mix__linear_attn_block__moe_arch_mod__prompt_kernel-4
    s_min_u32 s66, s64, s65
    s_load_dword s75, s[68:69], s66
    s_add_u32 s64, s64, 64
    s_min_u32 s66, s64, s65
    s_load_dword s75, s[68:69], s66
    s_add_u32 s64, s64, 64
    s_min_u32 s66, s64, s65
    s_load_dword s75, s[68:69], s66
    s_add_u32 s64, s64, 64
    s_min_u32 s66, s64, s65
    s_load_dword s75, s[68:69], s66
    s_add_u32 s64, s64, 64
    s_and_b32 s6, s3, 1
    s_lshr_b32 s7, s3, 1
    v_and_b32 v3, 31, v2
    s_lshl_b32 s64, s6, 6
    v_add_u32 v3, s64, v3
    v_lshlrev_b32 v3, 7, v3
    v_add_u32 v3, 8192, v3
    v_bfe_u32 v9, v2, 1, 3
    v_lshrrev_b32 v15, 5, v2
    v_xor_b32 v9, v9, v15
    v_xor_b32 v56, 0, v9
    v_lshl_add_u32 v4, v56, 4, v3
    v_xor_b32 v56, 2, v9
    v_lshl_add_u32 v5, v56, 4, v3
    v_xor_b32 v56, 4, v9
    v_lshl_add_u32 v6, v56, 4, v3
    v_xor_b32 v56, 6, v9
    v_lshl_add_u32 v7, v56, 4, v3
    v_bfe_u32 v56, v2, 2, 2
    v_lshl_add_u32 v57, v15, 3, v56
    v_lshlrev_b32 v57, 7, v57
    v_lshrrev_b32 v56, 1, v56
    v_xor_b32 v56, s7, v56
    v_lshl_add_u32 v57, v56, 6, v57
    v_bfe_u32 v56, v2, 4, 1
    v_lshl_add_u32 v57, v56, 5, v57
    v_and_b32 v56, 3, v2
    v_lshl_add_u32 v57, v56, 3, v57
    v_add_u32 v8, 24576, v57
    v_mov_b32 v10, v4
    v_mov_b32 v11, v5
    v_mov_b32 v12, v6
    v_mov_b32 v13, v7
    v_mov_b32 v14, v8
    v_mov_b32 v64, 0
    v_mov_b32 v65, 0
    v_mov_b32 v66, 0
    v_mov_b32 v67, 0
    v_mov_b32 v68, 0
    v_mov_b32 v69, 0
    v_mov_b32 v70, 0
    v_mov_b32 v71, 0
    v_mov_b32 v72, 0
    v_mov_b32 v73, 0
    v_mov_b32 v74, 0
    v_mov_b32 v75, 0
    v_mov_b32 v76, 0
    v_mov_b32 v77, 0
    v_mov_b32 v78, 0
    v_mov_b32 v79, 0
    v_mov_b32 v80, 0
    v_mov_b32 v81, 0
    v_mov_b32 v82, 0
    v_mov_b32 v83, 0
    v_mov_b32 v84, 0
    v_mov_b32 v85, 0
    v_mov_b32 v86, 0
    v_mov_b32 v87, 0
    v_mov_b32 v88, 0
    v_mov_b32 v89, 0
    v_mov_b32 v90, 0
    v_mov_b32 v91, 0
    v_mov_b32 v92, 0
    v_mov_b32 v93, 0
    v_mov_b32 v94, 0
    v_mov_b32 v95, 0
    v_mov_b32 v96, 0
    v_mov_b32 v97, 0
    v_mov_b32 v98, 0
    v_mov_b32 v99, 0
    v_mov_b32 v100, 0
    v_mov_b32 v101, 0
    v_mov_b32 v102, 0
    v_mov_b32 v103, 0
    v_mov_b32 v104, 0
    v_mov_b32 v105, 0
    v_mov_b32 v106, 0
    v_mov_b32 v107, 0
    v_mov_b32 v108, 0
    v_mov_b32 v109, 0
    v_mov_b32 v110, 0
    v_mov_b32 v111, 0
    v_mov_b32 v112, 0
    v_mov_b32 v113, 0
    v_mov_b32 v114, 0
    v_mov_b32 v115, 0
    v_mov_b32 v116, 0
    v_mov_b32 v117, 0
    v_mov_b32 v118, 0
    v_mov_b32 v119, 0
    v_mov_b32 v120, 0
    v_mov_b32 v121, 0
    v_mov_b32 v122, 0
    v_mov_b32 v123, 0
    v_mov_b32 v124, 0
    v_mov_b32 v125, 0
    v_mov_b32 v126, 0
    v_mov_b32 v127, 0
    v_mov_b32 v128, 0
    v_mov_b32 v129, 0
    v_mov_b32 v130, 0
    v_mov_b32 v131, 0
    v_mov_b32 v132, 0
    v_mov_b32 v133, 0
    v_mov_b32 v134, 0
    v_mov_b32 v135, 0
    v_mov_b32 v136, 0
    v_mov_b32 v137, 0
    v_mov_b32 v138, 0
    v_mov_b32 v139, 0
    v_mov_b32 v140, 0
    v_mov_b32 v141, 0
    v_mov_b32 v142, 0
    v_mov_b32 v143, 0
    v_mov_b32 v144, 0
    v_mov_b32 v145, 0
    v_mov_b32 v146, 0
    v_mov_b32 v147, 0
    v_mov_b32 v148, 0
    v_mov_b32 v149, 0
    v_mov_b32 v150, 0
    v_mov_b32 v151, 0
    v_mov_b32 v152, 0
    v_mov_b32 v153, 0
    v_mov_b32 v154, 0
    v_mov_b32 v155, 0
    v_mov_b32 v156, 0
    v_mov_b32 v157, 0
    v_mov_b32 v158, 0
    v_mov_b32 v159, 0
    s_mov_b32 s65, 0
    s_mov_b32 s66, 0
    s_lshl_b32 s64, s3, 2
    s_add_u32 s64, s64, 4288
    v_mov_b32 v56, s64
    ds_write_b32 v56, v64
    ds_write_b32 v56, v64 offset:16
    s_waitcnt vmcnt(0) lgkmcnt(0)
    s_barrier
    ds_read_b128 v[16:19], v10
    ds_read_b64_tr_b16 v[24:25], v14 offset:0
    ds_read_b64_tr_b16 v[26:27], v14 offset:512
    ds_read_b64_tr_b16 v[28:29], v14 offset:8192
    ds_read_b64_tr_b16 v[30:31], v14 offset:8704
    ds_read_b64_tr_b16 v[32:33], v14 offset:16384
    ds_read_b64_tr_b16 v[34:35], v14 offset:16896
    ds_read_b128 v[20:23], v10 offset:4096
.p2align 3
C_loop:
    s_waitcnt lgkmcnt(0)
    v_mfma_f32_32x32x16_bf16 v[64:79], v[24:27], v[16:19], v[64:79]
    ds_read_b128 v[36:39], v11
    ds_read_b64_tr_b16 v[44:45], v14 offset:2048
    v_mfma_f32_32x32x16_bf16 v[96:111], v[16:19], v[28:31], v[96:111]
    ds_read_b64_tr_b16 v[46:47], v14 offset:2560
    ds_read_b64_tr_b16 v[48:49], v14 offset:10240
    v_mfma_f32_32x32x16_bf16 v[128:143], v[16:19], v[32:35], v[128:143]
    ds_read_b64_tr_b16 v[50:51], v14 offset:10752
    ds_read_b64_tr_b16 v[52:53], v14 offset:18432
    v_mfma_f32_32x32x16_bf16 v[80:95], v[24:27], v[20:23], v[80:95]
    ds_read_b64_tr_b16 v[54:55], v14 offset:18944
    ds_read_b128 v[40:43], v11 offset:4096
    v_mfma_f32_32x32x16_bf16 v[112:127], v[20:23], v[28:31], v[112:127]
    v_mfma_f32_32x32x16_bf16 v[144:159], v[20:23], v[32:35], v[144:159]
    s_waitcnt lgkmcnt(0)
    v_mfma_f32_32x32x16_bf16 v[64:79], v[44:47], v[36:39], v[64:79]
    ds_read_b128 v[16:19], v12
    ds_read_b64_tr_b16 v[24:25], v14 offset:4096
    v_mfma_f32_32x32x16_bf16 v[96:111], v[36:39], v[48:51], v[96:111]
    ds_read_b64_tr_b16 v[26:27], v14 offset:4608
    ds_read_b64_tr_b16 v[28:29], v14 offset:12288
    v_mfma_f32_32x32x16_bf16 v[128:143], v[36:39], v[52:55], v[128:143]
    ds_read_b64_tr_b16 v[30:31], v14 offset:12800
    ds_read_b64_tr_b16 v[32:33], v14 offset:20480
    v_mfma_f32_32x32x16_bf16 v[80:95], v[44:47], v[40:43], v[80:95]
    ds_read_b64_tr_b16 v[34:35], v14 offset:20992
    ds_read_b128 v[20:23], v12 offset:4096
    v_mfma_f32_32x32x16_bf16 v[112:127], v[40:43], v[48:51], v[112:127]
    v_mfma_f32_32x32x16_bf16 v[144:159], v[40:43], v[52:55], v[144:159]
    s_waitcnt lgkmcnt(0)
    v_mfma_f32_32x32x16_bf16 v[64:79], v[24:27], v[16:19], v[64:79]
    ds_read_b128 v[36:39], v13
    ds_read_b64_tr_b16 v[44:45], v14 offset:6144
    v_mfma_f32_32x32x16_bf16 v[96:111], v[16:19], v[28:31], v[96:111]
    ds_read_b64_tr_b16 v[46:47], v14 offset:6656
    ds_read_b64_tr_b16 v[48:49], v14 offset:14336
    v_mfma_f32_32x32x16_bf16 v[128:143], v[16:19], v[32:35], v[128:143]
    ds_read_b64_tr_b16 v[50:51], v14 offset:14848
    ds_read_b64_tr_b16 v[52:53], v14 offset:22528
    v_mfma_f32_32x32x16_bf16 v[80:95], v[24:27], v[20:23], v[80:95]
    ds_read_b64_tr_b16 v[54:55], v14 offset:23040
    ds_read_b128 v[40:43], v13 offset:4096
    v_mfma_f32_32x32x16_bf16 v[112:127], v[20:23], v[28:31], v[112:127]
    v_mfma_f32_32x32x16_bf16 v[144:159], v[20:23], v[32:35], v[144:159]
    s_waitcnt vmcnt(0) lgkmcnt(0)
    s_barrier
    s_add_u32 s65, s65, 40960
    s_cmp_eq_u32 s65, 122880
    s_cselect_b32 s65, 0, s65
    v_mfma_f32_32x32x16_bf16 v[64:79], v[44:47], v[36:39], v[64:79]
    v_add_u32 v10, s65, v4
    v_add_u32 v11, s65, v5
    v_add_u32 v12, s65, v6
    v_add_u32 v13, s65, v7
    v_add_u32 v14, s65, v8
    ds_read_b128 v[16:19], v10
    ds_read_b64_tr_b16 v[24:25], v14 offset:0
    v_mfma_f32_32x32x16_bf16 v[96:111], v[36:39], v[48:51], v[96:111]
    ds_read_b64_tr_b16 v[26:27], v14 offset:512
    ds_read_b64_tr_b16 v[28:29], v14 offset:8192
    v_mfma_f32_32x32x16_bf16 v[128:143], v[36:39], v[52:55], v[128:143]
    ds_read_b64_tr_b16 v[30:31], v14 offset:8704
    ds_read_b64_tr_b16 v[32:33], v14 offset:16384
    v_mfma_f32_32x32x16_bf16 v[80:95], v[44:47], v[40:43], v[80:95]
    ds_read_b64_tr_b16 v[34:35], v14 offset:16896
    ds_read_b128 v[20:23], v10 offset:4096
    v_mfma_f32_32x32x16_bf16 v[112:127], v[40:43], v[48:51], v[112:127]
    v_mfma_f32_32x32x16_bf16 v[144:159], v[40:43], v[52:55], v[144:159]
    s_add_u32 s66, s66, 1
    s_cmp_lt_u32 s66, 16
    s_cbranch_scc1 C_loop
    s_waitcnt lgkmcnt(0)
    v_mov_b32 v52, 0x3f803f80
    v_mov_b32 v53, 0x3f803f80
    v_mov_b32 v54, 0x3f803f80
    v_mov_b32 v55, 0x3f803f80
    s_nop 4
    v_cvt_pk_bf16_f32 v16, v96, v97
    v_lshlrev_b32 v48, 16, v16
    v_and_b32 v49, 0xffff0000, v16
    v_mul_f32 v50, s72, v48
    v_mul_f32 v51, s72, v49
    v_exp_f32 v50, v50 clamp
    v_exp_f32 v51, v51 clamp
    v_max_f32 v48, 0, v48
    v_max_f32 v49, 0, v49
    v_add_f32 v48, v48, v50
    v_add_f32 v49, v49, v51
    v_min_f32 v56, v48, v49
    v_cvt_pk_bf16_f32 v16, v48, v49
    v_cvt_pk_bf16_f32 v17, v98, v99
    v_lshlrev_b32 v48, 16, v17
    v_and_b32 v49, 0xffff0000, v17
    v_mul_f32 v50, s72, v48
    v_mul_f32 v51, s72, v49
    v_exp_f32 v50, v50 clamp
    v_exp_f32 v51, v51 clamp
    v_max_f32 v48, 0, v48
    v_max_f32 v49, 0, v49
    v_add_f32 v48, v48, v50
    v_add_f32 v49, v49, v51
    v_min3_f32 v56, v48, v49, v56
    v_cvt_pk_bf16_f32 v17, v48, v49
    v_cvt_pk_bf16_f32 v18, v100, v101
    v_lshlrev_b32 v48, 16, v18
    v_and_b32 v49, 0xffff0000, v18
    v_mul_f32 v50, s72, v48
    v_mul_f32 v51, s72, v49
    v_exp_f32 v50, v50 clamp
    v_exp_f32 v51, v51 clamp
    v_max_f32 v48, 0, v48
    v_max_f32 v49, 0, v49
    v_add_f32 v48, v48, v50
    v_add_f32 v49, v49, v51
    v_min3_f32 v56, v48, v49, v56
    v_cvt_pk_bf16_f32 v18, v48, v49
    v_cvt_pk_bf16_f32 v19, v102, v103
    v_lshlrev_b32 v48, 16, v19
    v_and_b32 v49, 0xffff0000, v19
    v_mul_f32 v50, s72, v48
    v_mul_f32 v51, s72, v49
    v_exp_f32 v50, v50 clamp
    v_exp_f32 v51, v51 clamp
    v_max_f32 v48, 0, v48
    v_max_f32 v49, 0, v49
    v_add_f32 v48, v48, v50
    v_add_f32 v49, v49, v51
    v_min3_f32 v56, v48, v49, v56
    v_cvt_pk_bf16_f32 v19, v48, v49
    v_cvt_pk_bf16_f32 v20, v104, v105
    v_lshlrev_b32 v48, 16, v20
    v_and_b32 v49, 0xffff0000, v20
    v_mul_f32 v50, s72, v48
    v_mul_f32 v51, s72, v49
    v_exp_f32 v50, v50 clamp
    v_exp_f32 v51, v51 clamp
    v_max_f32 v48, 0, v48
    v_max_f32 v49, 0, v49
    v_add_f32 v48, v48, v50
    v_add_f32 v49, v49, v51
    v_min3_f32 v56, v48, v49, v56
    v_cvt_pk_bf16_f32 v20, v48, v49
    v_cvt_pk_bf16_f32 v21, v106, v107
    v_lshlrev_b32 v48, 16, v21
    v_and_b32 v49, 0xffff0000, v21
    v_mul_f32 v50, s72, v48
    v_mul_f32 v51, s72, v49
    v_exp_f32 v50, v50 clamp
    v_exp_f32 v51, v51 clamp
    v_max_f32 v48, 0, v48
    v_max_f32 v49, 0, v49
    v_add_f32 v48, v48, v50
    v_add_f32 v49, v49, v51
    v_min3_f32 v56, v48, v49, v56
    v_cvt_pk_bf16_f32 v21, v48, v49
    v_cvt_pk_bf16_f32 v22, v108, v109
    v_lshlrev_b32 v48, 16, v22
    v_and_b32 v49, 0xffff0000, v22
    v_mul_f32 v50, s72, v48
    v_mul_f32 v51, s72, v49
    v_exp_f32 v50, v50 clamp
    v_exp_f32 v51, v51 clamp
    v_max_f32 v48, 0, v48
    v_max_f32 v49, 0, v49
    v_add_f32 v48, v48, v50
    v_add_f32 v49, v49, v51
    v_min3_f32 v56, v48, v49, v56
    v_cvt_pk_bf16_f32 v22, v48, v49
    v_cvt_pk_bf16_f32 v23, v110, v111
    v_lshlrev_b32 v48, 16, v23
    v_and_b32 v49, 0xffff0000, v23
    v_mul_f32 v50, s72, v48
    v_mul_f32 v51, s72, v49
    v_exp_f32 v50, v50 clamp
    v_exp_f32 v51, v51 clamp
    v_max_f32 v48, 0, v48
    v_max_f32 v49, 0, v49
    v_add_f32 v48, v48, v50
    v_add_f32 v49, v49, v51
    v_min3_f32 v56, v48, v49, v56
    v_cvt_pk_bf16_f32 v23, v48, v49
    v_cmp_gt_f32 vcc, 0x3a800000, v56
    s_cbranch_vccnz phi_15_fix
phi_15_done:
    v_cvt_pk_bf16_f32 v32, v128, v129
    v_cvt_pk_bf16_f32 v33, v130, v131
    v_cvt_pk_bf16_f32 v34, v132, v133
    v_cvt_pk_bf16_f32 v35, v134, v135
    v_cvt_pk_bf16_f32 v36, v136, v137
    v_cvt_pk_bf16_f32 v37, v138, v139
    v_cvt_pk_bf16_f32 v38, v140, v141
    v_cvt_pk_bf16_f32 v39, v142, v143
    s_nop 1
    v_mfma_f32_32x32x16_bf16 v[160:175], v[16:19], v[32:35], 0
    v_mfma_f32_32x32x16_bf16 v[176:191], v[52:55], v[16:19], 0
    v_mfma_f32_32x32x16_bf16 v[160:175], v[20:23], v[36:39], v[160:175]
    v_mfma_f32_32x32x16_bf16 v[176:191], v[52:55], v[20:23], v[176:191]
    v_cvt_pk_bf16_f32 v24, v112, v113
    v_lshlrev_b32 v48, 16, v24
    v_and_b32 v49, 0xffff0000, v24
    v_mul_f32 v50, s72, v48
    v_mul_f32 v51, s72, v49
    v_exp_f32 v50, v50 clamp
    v_exp_f32 v51, v51 clamp
    v_max_f32 v48, 0, v48
    v_max_f32 v49, 0, v49
    v_add_f32 v48, v48, v50
    v_add_f32 v49, v49, v51
    v_min_f32 v56, v48, v49
    v_cvt_pk_bf16_f32 v24, v48, v49
    v_cvt_pk_bf16_f32 v25, v114, v115
    v_lshlrev_b32 v48, 16, v25
    v_and_b32 v49, 0xffff0000, v25
    v_mul_f32 v50, s72, v48
    v_mul_f32 v51, s72, v49
    v_exp_f32 v50, v50 clamp
    v_exp_f32 v51, v51 clamp
    v_max_f32 v48, 0, v48
    v_max_f32 v49, 0, v49
    v_add_f32 v48, v48, v50
    v_add_f32 v49, v49, v51
    v_min3_f32 v56, v48, v49, v56
    v_cvt_pk_bf16_f32 v25, v48, v49
    v_cvt_pk_bf16_f32 v26, v116, v117
    v_lshlrev_b32 v48, 16, v26
    v_and_b32 v49, 0xffff0000, v26
    v_mul_f32 v50, s72, v48
    v_mul_f32 v51, s72, v49
    v_exp_f32 v50, v50 clamp
    v_exp_f32 v51, v51 clamp
    v_max_f32 v48, 0, v48
    v_max_f32 v49, 0, v49
    v_add_f32 v48, v48, v50
    v_add_f32 v49, v49, v51
    v_min3_f32 v56, v48, v49, v56
    v_cvt_pk_bf16_f32 v26, v48, v49
    v_cvt_pk_bf16_f32 v27, v118, v119
    v_lshlrev_b32 v48, 16, v27
    v_and_b32 v49, 0xffff0000, v27
    v_mul_f32 v50, s72, v48
    v_mul_f32 v51, s72, v49
    v_exp_f32 v50, v50 clamp
    v_exp_f32 v51, v51 clamp
    v_max_f32 v48, 0, v48
    v_max_f32 v49, 0, v49
    v_add_f32 v48, v48, v50
    v_add_f32 v49, v49, v51
    v_min3_f32 v56, v48, v49, v56
    v_cvt_pk_bf16_f32 v27, v48, v49
    v_cvt_pk_bf16_f32 v28, v120, v121
    v_lshlrev_b32 v48, 16, v28
    v_and_b32 v49, 0xffff0000, v28
    v_mul_f32 v50, s72, v48
    v_mul_f32 v51, s72, v49
    v_exp_f32 v50, v50 clamp
    v_exp_f32 v51, v51 clamp
    v_max_f32 v48, 0, v48
    v_max_f32 v49, 0, v49
    v_add_f32 v48, v48, v50
    v_add_f32 v49, v49, v51
    v_min3_f32 v56, v48, v49, v56
    v_cvt_pk_bf16_f32 v28, v48, v49
    v_cvt_pk_bf16_f32 v29, v122, v123
    v_lshlrev_b32 v48, 16, v29
    v_and_b32 v49, 0xffff0000, v29
    v_mul_f32 v50, s72, v48
    v_mul_f32 v51, s72, v49
    v_exp_f32 v50, v50 clamp
    v_exp_f32 v51, v51 clamp
    v_max_f32 v48, 0, v48
    v_max_f32 v49, 0, v49
    v_add_f32 v48, v48, v50
    v_add_f32 v49, v49, v51
    v_min3_f32 v56, v48, v49, v56
    v_cvt_pk_bf16_f32 v29, v48, v49
    v_cvt_pk_bf16_f32 v30, v124, v125
    v_lshlrev_b32 v48, 16, v30
    v_and_b32 v49, 0xffff0000, v30
    v_mul_f32 v50, s72, v48
    v_mul_f32 v51, s72, v49
    v_exp_f32 v50, v50 clamp
    v_exp_f32 v51, v51 clamp
    v_max_f32 v48, 0, v48
    v_max_f32 v49, 0, v49
    v_add_f32 v48, v48, v50
    v_add_f32 v49, v49, v51
    v_min3_f32 v56, v48, v49, v56
    v_cvt_pk_bf16_f32 v30, v48, v49
    v_cvt_pk_bf16_f32 v31, v126, v127
    v_lshlrev_b32 v48, 16, v31
    v_and_b32 v49, 0xffff0000, v31
    v_mul_f32 v50, s72, v48
    v_mul_f32 v51, s72, v49
    v_exp_f32 v50, v50 clamp
    v_exp_f32 v51, v51 clamp
    v_max_f32 v48, 0, v48
    v_max_f32 v49, 0, v49
    v_add_f32 v48, v48, v50
    v_add_f32 v49, v49, v51
    v_min3_f32 v56, v48, v49, v56
    v_cvt_pk_bf16_f32 v31, v48, v49
    v_cmp_gt_f32 vcc, 0x3a800000, v56
    s_cbranch_vccnz phi_16_fix
phi_16_done:
    v_cvt_pk_bf16_f32 v40, v144, v145
    v_cvt_pk_bf16_f32 v41, v146, v147
    v_cvt_pk_bf16_f32 v42, v148, v149
    v_cvt_pk_bf16_f32 v43, v150, v151
    v_cvt_pk_bf16_f32 v44, v152, v153
    v_cvt_pk_bf16_f32 v45, v154, v155
    v_cvt_pk_bf16_f32 v46, v156, v157
    v_cvt_pk_bf16_f32 v47, v158, v159
    s_nop 1
    v_mfma_f32_32x32x16_bf16 v[160:175], v[24:27], v[40:43], v[160:175]
    v_mfma_f32_32x32x16_bf16 v[176:191], v[52:55], v[24:27], v[176:191]
    v_mfma_f32_32x32x16_bf16 v[160:175], v[28:31], v[44:47], v[160:175]
    v_mfma_f32_32x32x16_bf16 v[176:191], v[52:55], v[28:31], v[176:191]
    v_lshlrev_b32 v3, 4, v2
    s_lshl_b32 s64, s3, 11
    v_add_u32 v4, s64, v3
    s_xor_b32 s67, s3, 1
    s_lshl_b32 s64, s67, 11
    v_add_u32 v5, s64, v3
    v_lshlrev_b32 v6, 2, v2
    s_lshl_b32 s64, s3, 8
    v_add_u32 v7, s64, v6
    s_lshl_b32 s64, s67, 8
    v_add_u32 v8, s64, v6
    s_lshl_b32 s64, s3, 2
    v_mov_b32 v9, s64
    s_lshl_b32 s64, s67, 2
    v_mov_b32 v10, s64
    v_mov_b32 v11, 1
    s_lshl_b32 s68, s5, 2
    s_add_u32 s68, s68, s3
    s_lshl_b32 s68, s68, 4
    s_add_u32 s68, s68, s4
    s_mul_i32 s68, s68, 1152
    s_add_u32 s68, s68, 4194304
    v_and_b32 v12, 15, v2
    v_lshlrev_b32 v12, 2, v12
    s_lshl_b32 s64, 1, s4
    v_mov_b32 v14, s64
    s_lshl_b32 s64, s5, 2
    s_add_u32 s64, s64, s3
    s_lshl_b32 s64, s64, 7
    s_add_u32 s64, s64, 5373952
    v_mov_b32 v15, s64
    ds_write_b32 v7, v176 offset:4608
    s_cmp_eq_u32 s6, 0
    s_cbranch_scc0 C_ex1
    ds_write_b128 v4, v[168:171] offset:32768
    ds_write_b128 v4, v[172:175] offset:33792
    s_mov_b64 s[70:71], 0xffff
    s_branch C_ex2
C_ex1:
    ds_write_b128 v4, v[160:163] offset:32768
    ds_write_b128 v4, v[164:167] offset:33792
    s_mov_b32 s70, 0xffff0000
    s_mov_b32 s71, 0
    s_nop 0
    v_mov_b32 v160, v168
    v_mov_b32 v161, v169
    v_mov_b32 v162, v170
    v_mov_b32 v163, v171
    v_mov_b32 v164, v172
    v_mov_b32 v165, v173
    v_mov_b32 v166, v174
    v_mov_b32 v167, v175
C_ex2:
    s_waitcnt lgkmcnt(0)
    ds_write_b32 v9, v11 offset:4288
C_ps:
    ds_read_b32 v13, v10 offset:4288
    s_waitcnt lgkmcnt(0)
    v_cmp_eq_u32 vcc, 0, v13
    s_cbranch_vccnz C_ps
    ds_read_b128 v[16:19], v5 offset:32768
    ds_read_b128 v[20:23], v5 offset:33792
    ds_read_b32 v24, v8 offset:4608
    s_waitcnt lgkmcnt(0)
    v_add_f32 v16, v16, v160
    v_add_f32 v17, v17, v161
    v_add_f32 v18, v18, v162
    v_add_f32 v19, v19, v163
    v_add_f32 v20, v20, v164
    v_add_f32 v21, v21, v165
    v_add_f32 v22, v22, v166
    v_add_f32 v23, v23, v167
    v_add_f32 v24, v24, v176
    v_cvt_pk_bf16_f32 v28, v16, v17
    v_cvt_pk_bf16_f32 v29, v18, v19
    v_cvt_pk_bf16_f32 v30, v20, v21
    v_cvt_pk_bf16_f32 v31, v22, v23
    buffer_store_dwordx4 v[28:31], v3, s[16:19], s68 offen sc0 sc1
    s_mov_b64 exec, s[70:71]
    buffer_store_dword v24, v12, s[16:19], s68 offen offset:1024 sc0 sc1
    s_mov_b64 exec, 1
    buffer_atomic_or v14, v15, s[16:19], 0 offen
    s_mov_b64 exec, -1
    s_lshl_b32 s69, s4, 2
    s_lshl_b32 s64, s6, 1
    s_add_u32 s69, s69, s64
    s_lshl_b32 s69, s69, 5
    s_lshl_b32 s64, s5, 1
    s_add_u32 s69, s69, s64
    s_add_u32 s69, s69, s7
    s_lshl_b32 s69, s69, 11
    s_and_b32 s64, s5, 7
    s_lshl_b32 s64, s64, 1
    s_add_u32 s64, s64, s7
    s_lshl_b32 s70, 1, s64
    v_mov_b32 v11, s70
    s_lshr_b32 s64, s5, 3
    s_lshl_b32 s64, s64, 1
    s_add_u32 s64, s64, s6
    s_lshl_b32 s64, s64, 8
    s_lshl_b32 s70, s4, 10
    s_add_u32 s70, s70, s64
    s_add_u32 s70, s70, 5382144
    s_and_b32 s64, s2, 7
    s_lshr_b32 s65, s2, 3
    s_and_b32 s4, s64, 3
    s_lshl_b32 s4, s4, 2
    s_and_b32 s66, s65, 3
    s_add_u32 s4, s4, s66
    s_lshr_b32 s5, s64, 2
    s_lshl_b32 s5, s5, 3
    s_lshr_b32 s74, s65, 2
    s_add_u32 s5, s5, s74
    s_mov_b32 s12, s44
    s_mov_b32 s13, s45
    s_mov_b32 s14, 0x200000
    s_mov_b32 s15, 0x00020000
    v_lshrrev_b32 v13, 3, v2
    s_lshl_b32 s64, s3, 3
    v_add_u32 v13, s64, v13
    v_lshlrev_b32 v13, 11, v13
    v_bfe_u32 v14, v2, 4, 1
    v_lshlrev_b32 v14, 2, v14
    v_and_b32 v10, 7, v2
    v_xor_b32 v14, v14, v10
    v_lshl_add_u32 v13, v14, 4, v13
    s_lshl_b32 s64, s5, 7
    v_add_u32 v10, s64, v13
    v_cvt_pk_bf16_f32 v32, v64, v65
    v_lshlrev_b32 v48, 16, v32
    v_and_b32 v49, 0xffff0000, v32
    v_mul_f32 v50, s72, v48
    v_mul_f32 v51, s72, v49
    v_exp_f32 v50, v50 clamp
    v_exp_f32 v51, v51 clamp
    v_max_f32 v48, 0, v48
    v_max_f32 v49, 0, v49
    v_add_f32 v48, v48, v50
    v_add_f32 v49, v49, v51
    v_min_f32 v56, v48, v49
    v_cvt_pk_bf16_f32 v32, v48, v49
    v_cvt_pk_bf16_f32 v33, v66, v67
    v_lshlrev_b32 v48, 16, v33
    v_and_b32 v49, 0xffff0000, v33
    v_mul_f32 v50, s72, v48
    v_mul_f32 v51, s72, v49
    v_exp_f32 v50, v50 clamp
    v_exp_f32 v51, v51 clamp
    v_max_f32 v48, 0, v48
    v_max_f32 v49, 0, v49
    v_add_f32 v48, v48, v50
    v_add_f32 v49, v49, v51
    v_min3_f32 v56, v48, v49, v56
    v_cvt_pk_bf16_f32 v33, v48, v49
    v_cvt_pk_bf16_f32 v34, v68, v69
    v_lshlrev_b32 v48, 16, v34
    v_and_b32 v49, 0xffff0000, v34
    v_mul_f32 v50, s72, v48
    v_mul_f32 v51, s72, v49
    v_exp_f32 v50, v50 clamp
    v_exp_f32 v51, v51 clamp
    v_max_f32 v48, 0, v48
    v_max_f32 v49, 0, v49
    v_add_f32 v48, v48, v50
    v_add_f32 v49, v49, v51
    v_min3_f32 v56, v48, v49, v56
    v_cvt_pk_bf16_f32 v34, v48, v49
    v_cvt_pk_bf16_f32 v35, v70, v71
    v_lshlrev_b32 v48, 16, v35
    v_and_b32 v49, 0xffff0000, v35
    v_mul_f32 v50, s72, v48
    v_mul_f32 v51, s72, v49
    v_exp_f32 v50, v50 clamp
    v_exp_f32 v51, v51 clamp
    v_max_f32 v48, 0, v48
    v_max_f32 v49, 0, v49
    v_add_f32 v48, v48, v50
    v_add_f32 v49, v49, v51
    v_min3_f32 v56, v48, v49, v56
    v_cvt_pk_bf16_f32 v35, v48, v49
    v_cvt_pk_bf16_f32 v36, v72, v73
    v_lshlrev_b32 v48, 16, v36
    v_and_b32 v49, 0xffff0000, v36
    v_mul_f32 v50, s72, v48
    v_mul_f32 v51, s72, v49
    v_exp_f32 v50, v50 clamp
    v_exp_f32 v51, v51 clamp
    v_max_f32 v48, 0, v48
    v_max_f32 v49, 0, v49
    v_add_f32 v48, v48, v50
    v_add_f32 v49, v49, v51
    v_min3_f32 v56, v48, v49, v56
    v_cvt_pk_bf16_f32 v36, v48, v49
    v_cvt_pk_bf16_f32 v37, v74, v75
    v_lshlrev_b32 v48, 16, v37
    v_and_b32 v49, 0xffff0000, v37
    v_mul_f32 v50, s72, v48
    v_mul_f32 v51, s72, v49
    v_exp_f32 v50, v50 clamp
    v_exp_f32 v51, v51 clamp
    v_max_f32 v48, 0, v48
    v_max_f32 v49, 0, v49
    v_add_f32 v48, v48, v50
    v_add_f32 v49, v49, v51
    v_min3_f32 v56, v48, v49, v56
    v_cvt_pk_bf16_f32 v37, v48, v49
    v_cvt_pk_bf16_f32 v38, v76, v77
    v_lshlrev_b32 v48, 16, v38
    v_and_b32 v49, 0xffff0000, v38
    v_mul_f32 v50, s72, v48
    v_mul_f32 v51, s72, v49
    v_exp_f32 v50, v50 clamp
    v_exp_f32 v51, v51 clamp
    v_max_f32 v48, 0, v48
    v_max_f32 v49, 0, v49
    v_add_f32 v48, v48, v50
    v_add_f32 v49, v49, v51
    v_min3_f32 v56, v48, v49, v56
    v_cvt_pk_bf16_f32 v38, v48, v49
    v_cvt_pk_bf16_f32 v39, v78, v79
    v_lshlrev_b32 v48, 16, v39
    v_and_b32 v49, 0xffff0000, v39
    v_mul_f32 v50, s72, v48
    v_mul_f32 v51, s72, v49
    v_exp_f32 v50, v50 clamp
    v_exp_f32 v51, v51 clamp
    v_max_f32 v48, 0, v48
    v_max_f32 v49, 0, v49
    v_add_f32 v48, v48, v50
    v_add_f32 v49, v49, v51
    v_min3_f32 v56, v48, v49, v56
    v_cvt_pk_bf16_f32 v39, v48, v49
    v_cmp_gt_f32 vcc, 0x3a800000, v56
    s_cbranch_vccnz phi_17_fix
phi_17_done:
    v_lshrrev_b32 v230, 3, v0
    s_lshl_b32 s64, s4, 7
    v_add_u32 v230, s64, v230
    v_lshlrev_b32 v231, 11, v230
    v_and_b32 v3, 7, v0
    v_lshl_add_u32 v231, v3, 4, v231
    s_lshl_b32 s64, s5, 7
    v_add_u32 v231, s64, v231
    s_mov_b32 s64, 131072
    v_lshlrev_b32 v3, 2, v230
    v_add_u32 v3, 6709248, v3
    buffer_load_dwordx4 v[220:223], v231, s[8:11], 0 offen
    buffer_load_dwordx4 v[224:227], v231, s[8:11], s64 offen
    buffer_load_dword v228, v3, s[16:19], 0 offen sc1
    buffer_load_dword v229, v3, s[16:19], 0 offen offset:256 sc1
    v_cvt_pk_bf16_f32 v40, v80, v81
    v_lshlrev_b32 v48, 16, v40
    v_and_b32 v49, 0xffff0000, v40
    v_mul_f32 v50, s72, v48
    v_mul_f32 v51, s72, v49
    v_exp_f32 v50, v50 clamp
    v_exp_f32 v51, v51 clamp
    v_max_f32 v48, 0, v48
    v_max_f32 v49, 0, v49
    v_add_f32 v48, v48, v50
    v_add_f32 v49, v49, v51
    v_min_f32 v56, v48, v49
    v_cvt_pk_bf16_f32 v40, v48, v49
    v_cvt_pk_bf16_f32 v41, v82, v83
    v_lshlrev_b32 v48, 16, v41
    v_and_b32 v49, 0xffff0000, v41
    v_mul_f32 v50, s72, v48
    v_mul_f32 v51, s72, v49
    v_exp_f32 v50, v50 clamp
    v_exp_f32 v51, v51 clamp
    v_max_f32 v48, 0, v48
    v_max_f32 v49, 0, v49
    v_add_f32 v48, v48, v50
    v_add_f32 v49, v49, v51
    v_min3_f32 v56, v48, v49, v56
    v_cvt_pk_bf16_f32 v41, v48, v49
    v_cvt_pk_bf16_f32 v42, v84, v85
    v_lshlrev_b32 v48, 16, v42
    v_and_b32 v49, 0xffff0000, v42
    v_mul_f32 v50, s72, v48
    v_mul_f32 v51, s72, v49
    v_exp_f32 v50, v50 clamp
    v_exp_f32 v51, v51 clamp
    v_max_f32 v48, 0, v48
    v_max_f32 v49, 0, v49
    v_add_f32 v48, v48, v50
    v_add_f32 v49, v49, v51
    v_min3_f32 v56, v48, v49, v56
    v_cvt_pk_bf16_f32 v42, v48, v49
    v_cvt_pk_bf16_f32 v43, v86, v87
    v_lshlrev_b32 v48, 16, v43
    v_and_b32 v49, 0xffff0000, v43
    v_mul_f32 v50, s72, v48
    v_mul_f32 v51, s72, v49
    v_exp_f32 v50, v50 clamp
    v_exp_f32 v51, v51 clamp
    v_max_f32 v48, 0, v48
    v_max_f32 v49, 0, v49
    v_add_f32 v48, v48, v50
    v_add_f32 v49, v49, v51
    v_min3_f32 v56, v48, v49, v56
    v_cvt_pk_bf16_f32 v43, v48, v49
    v_cvt_pk_bf16_f32 v44, v88, v89
    v_lshlrev_b32 v48, 16, v44
    v_and_b32 v49, 0xffff0000, v44
    v_mul_f32 v50, s72, v48
    v_mul_f32 v51, s72, v49
    v_exp_f32 v50, v50 clamp
    v_exp_f32 v51, v51 clamp
    v_max_f32 v48, 0, v48
    v_max_f32 v49, 0, v49
    v_add_f32 v48, v48, v50
    v_add_f32 v49, v49, v51
    v_min3_f32 v56, v48, v49, v56
    v_cvt_pk_bf16_f32 v44, v48, v49
    v_cvt_pk_bf16_f32 v45, v90, v91
    v_lshlrev_b32 v48, 16, v45
    v_and_b32 v49, 0xffff0000, v45
    v_mul_f32 v50, s72, v48
    v_mul_f32 v51, s72, v49
    v_exp_f32 v50, v50 clamp
    v_exp_f32 v51, v51 clamp
    v_max_f32 v48, 0, v48
    v_max_f32 v49, 0, v49
    v_add_f32 v48, v48, v50
    v_add_f32 v49, v49, v51
    v_min3_f32 v56, v48, v49, v56
    v_cvt_pk_bf16_f32 v45, v48, v49
    v_cvt_pk_bf16_f32 v46, v92, v93
    v_lshlrev_b32 v48, 16, v46
    v_and_b32 v49, 0xffff0000, v46
    v_mul_f32 v50, s72, v48
    v_mul_f32 v51, s72, v49
    v_exp_f32 v50, v50 clamp
    v_exp_f32 v51, v51 clamp
    v_max_f32 v48, 0, v48
    v_max_f32 v49, 0, v49
    v_add_f32 v48, v48, v50
    v_add_f32 v49, v49, v51
    v_min3_f32 v56, v48, v49, v56
    v_cvt_pk_bf16_f32 v46, v48, v49
    v_cvt_pk_bf16_f32 v47, v94, v95
    v_lshlrev_b32 v48, 16, v47
    v_and_b32 v49, 0xffff0000, v47
    v_mul_f32 v50, s72, v48
    v_mul_f32 v51, s72, v49
    v_exp_f32 v50, v50 clamp
    v_exp_f32 v51, v51 clamp
    v_max_f32 v48, 0, v48
    v_max_f32 v49, 0, v49
    v_add_f32 v48, v48, v50
    v_add_f32 v49, v49, v51
    v_min3_f32 v56, v48, v49, v56
    v_cvt_pk_bf16_f32 v47, v48, v49
    v_cmp_gt_f32 vcc, 0x3a800000, v56
    s_cbranch_vccnz phi_18_fix
phi_18_done:
    v_lshlrev_b32 v3, 4, v2
    s_lshl_b32 s64, s7, 11
    v_add_u32 v4, s64, v3
    v_lshrrev_b32 v5, 5, v2
    v_lshlrev_b32 v5, 4, v5
    s_lshl_b32 s64, s7, 6
    v_add_u32 v5, s64, v5
    v_mov_b32 v6, 4256
    ds_read_b32 v6, v6
    s_lshl_b32 s71, s3, 10
    s_waitcnt lgkmcnt(0)
    v_readfirstlane_b32 s75, v6
    s_waitcnt vmcnt(0)
    v_sub_f32 v248, 1.0, v228
    v_cvt_pk_bf16_f32 v248, v248, v248
    v_lshlrev_b32 v248, 16, v248
    v_lshlrev_b32 v232, 16, v220
    v_and_b32 v233, 0xffff0000, v220
    v_mul_f32 v232, v232, v248
    v_mul_f32 v233, v233, v248
    v_cvt_pk_bf16_f32 v3, v232, v233
    v_lshlrev_b32 v232, 16, v3
    v_and_b32 v233, 0xffff0000, v3
    v_lshlrev_b32 v234, 16, v221
    v_and_b32 v235, 0xffff0000, v221
    v_mul_f32 v234, v234, v248
    v_mul_f32 v235, v235, v248
    v_cvt_pk_bf16_f32 v3, v234, v235
    v_lshlrev_b32 v234, 16, v3
    v_and_b32 v235, 0xffff0000, v3
    v_lshlrev_b32 v236, 16, v222
    v_and_b32 v237, 0xffff0000, v222
    v_mul_f32 v236, v236, v248
    v_mul_f32 v237, v237, v248
    v_cvt_pk_bf16_f32 v3, v236, v237
    v_lshlrev_b32 v236, 16, v3
    v_and_b32 v237, 0xffff0000, v3
    v_lshlrev_b32 v238, 16, v223
    v_and_b32 v239, 0xffff0000, v223
    v_mul_f32 v238, v238, v248
    v_mul_f32 v239, v239, v248
    v_cvt_pk_bf16_f32 v3, v238, v239
    v_lshlrev_b32 v238, 16, v3
    v_and_b32 v239, 0xffff0000, v3
    v_sub_f32 v249, 1.0, v229
    v_cvt_pk_bf16_f32 v249, v249, v249
    v_lshlrev_b32 v249, 16, v249
    v_lshlrev_b32 v240, 16, v224
    v_and_b32 v241, 0xffff0000, v224
    v_mul_f32 v240, v240, v249
    v_mul_f32 v241, v241, v249
    v_cvt_pk_bf16_f32 v3, v240, v241
    v_lshlrev_b32 v240, 16, v3
    v_and_b32 v241, 0xffff0000, v3
    v_lshlrev_b32 v242, 16, v225
    v_and_b32 v243, 0xffff0000, v225
    v_mul_f32 v242, v242, v249
    v_mul_f32 v243, v243, v249
    v_cvt_pk_bf16_f32 v3, v242, v243
    v_lshlrev_b32 v242, 16, v3
    v_and_b32 v243, 0xffff0000, v3
    v_lshlrev_b32 v244, 16, v226
    v_and_b32 v245, 0xffff0000, v226
    v_mul_f32 v244, v244, v249
    v_mul_f32 v245, v245, v249
    v_cvt_pk_bf16_f32 v3, v244, v245
    v_lshlrev_b32 v244, 16, v3
    v_and_b32 v245, 0xffff0000, v3
    v_lshlrev_b32 v246, 16, v227
    v_and_b32 v247, 0xffff0000, v227
    v_mul_f32 v246, v246, v249
    v_mul_f32 v247, v247, v249
    v_cvt_pk_bf16_f32 v3, v246, v247
    v_lshlrev_b32 v246, 16, v3
    v_and_b32 v247, 0xffff0000, v3
    s_cmp_lg_u32 s3, 0
    s_cbranch_scc1 C_nh
    s_lshr_b32 s64, s2, 2
    s_lshl_b32 s64, s64, 14
    s_add_u32 s64, s64, 5398528
    v_lshl_add_u32 v16, v2, 4, s64
    v_lshrrev_b32 v8, 4, v2
    s_mov_b32 s65, 0
H_hl:
    s_mov_b32 s64, 0
    buffer_load_dwordx4 v[64:67], v16, s[16:19], s64 offen offset:0 sc1
    s_mov_b32 s64, 0
    buffer_load_dwordx4 v[68:71], v16, s[16:19], s64 offen offset:1024 sc1
    s_mov_b32 s64, 0
    buffer_load_dwordx4 v[72:75], v16, s[16:19], s64 offen offset:2048 sc1
    s_mov_b32 s64, 0
    buffer_load_dwordx4 v[76:79], v16, s[16:19], s64 offen offset:3072 sc1
    s_mov_b32 s64, 4096
    buffer_load_dwordx4 v[80:83], v16, s[16:19], s64 offen offset:0 sc1
    s_mov_b32 s64, 4096
    buffer_load_dwordx4 v[84:87], v16, s[16:19], s64 offen offset:1024 sc1
    s_mov_b32 s64, 4096
    buffer_load_dwordx4 v[88:91], v16, s[16:19], s64 offen offset:2048 sc1
    s_mov_b32 s64, 4096
    buffer_load_dwordx4 v[92:95], v16, s[16:19], s64 offen offset:3072 sc1
    s_mov_b32 s64, 8192
    buffer_load_dwordx4 v[96:99], v16, s[16:19], s64 offen offset:0 sc1
    s_mov_b32 s64, 8192
    buffer_load_dwordx4 v[100:103], v16, s[16:19], s64 offen offset:1024 sc1
    s_mov_b32 s64, 8192
    buffer_load_dwordx4 v[104:107], v16, s[16:19], s64 offen offset:2048 sc1
    s_mov_b32 s64, 8192
    buffer_load_dwordx4 v[108:111], v16, s[16:19], s64 offen offset:3072 sc1
    s_mov_b32 s64, 12288
    buffer_load_dwordx4 v[112:115], v16, s[16:19], s64 offen offset:0 sc1
    s_mov_b32 s64, 12288
    buffer_load_dwordx4 v[116:119], v16, s[16:19], s64 offen offset:1024 sc1
    s_mov_b32 s64, 12288
    buffer_load_dwordx4 v[120:123], v16, s[16:19], s64 offen offset:2048 sc1
    s_mov_b32 s64, 12288
    buffer_load_dwordx4 v[124:127], v16, s[16:19], s64 offen offset:3072 sc1
    s_waitcnt vmcnt(0)
    v_max3_u32 v17, v64, v65, v66
    v_max3_u32 v17, v67, v68, v17
    v_max3_u32 v17, v69, v70, v17
    v_max3_u32 v17, v71, v72, v17
    v_max3_u32 v17, v73, v74, v17
    v_max3_u32 v17, v75, v76, v17
    v_max3_u32 v17, v77, v78, v17
    v_max3_u32 v17, v79, v80, v17
    v_max3_u32 v17, v81, v82, v17
    v_max3_u32 v17, v83, v84, v17
    v_max3_u32 v17, v85, v86, v17
    v_max3_u32 v17, v87, v88, v17
    v_max3_u32 v17, v89, v90, v17
    v_max3_u32 v17, v91, v92, v17
    v_max3_u32 v17, v93, v94, v17
    v_max3_u32 v17, v95, v96, v17
    v_max3_u32 v17, v97, v98, v17
    v_max3_u32 v17, v99, v100, v17
    v_max3_u32 v17, v101, v102, v17
    v_max3_u32 v17, v103, v104, v17
    v_max3_u32 v17, v105, v106, v17
    v_max3_u32 v17, v107, v108, v17
    v_max3_u32 v17, v109, v110, v17
    v_max3_u32 v17, v111, v112, v17
    v_max3_u32 v17, v113, v114, v17
    v_max3_u32 v17, v115, v116, v17
    v_max3_u32 v17, v117, v118, v17
    v_max3_u32 v17, v119, v120, v17
    v_max3_u32 v17, v121, v122, v17
    v_max3_u32 v17, v123, v124, v17
    v_max3_u32 v17, v125, v126, v17
    v_max_u32 v17, v127, v17
    s_mov_b32 exec_lo, 0x3fff3fff
    s_mov_b32 exec_hi, 0x3fff3fff
    v_cmp_eq_u32 vcc, -1, v17
    s_mov_b64 exec, -1
    s_cbranch_vccz H_hok
    s_add_u32 s65, s65, 1
    s_cmp_ge_u32 s65, 100000
    s_cbranch_scc1 H_hok
    s_sleep 8
    s_branch H_hl
H_hok:
    v_add_f32 v64, v64, v68
    v_add_f32 v65, v65, v69
    v_add_f32 v66, v66, v70
    v_add_f32 v67, v67, v71
    v_add_f32 v64, v64, v72
    v_add_f32 v65, v65, v73
    v_add_f32 v66, v66, v74
    v_add_f32 v67, v67, v75
    v_add_f32 v64, v64, v76
    v_add_f32 v65, v65, v77
    v_add_f32 v66, v66, v78
    v_add_f32 v67, v67, v79
    v_add_f32 v64, v64, v80
    v_add_f32 v65, v65, v81
    v_add_f32 v66, v66, v82
    v_add_f32 v67, v67, v83
    v_add_f32 v64, v64, v84
    v_add_f32 v65, v65, v85
    v_add_f32 v66, v66, v86
    v_add_f32 v67, v67, v87
    v_add_f32 v64, v64, v88
    v_add_f32 v65, v65, v89
    v_add_f32 v66, v66, v90
    v_add_f32 v67, v67, v91
    v_add_f32 v64, v64, v92
    v_add_f32 v65, v65, v93
    v_add_f32 v66, v66, v94
    v_add_f32 v67, v67, v95
    v_add_f32 v96, v96, v100
    v_add_f32 v97, v97, v101
    v_add_f32 v98, v98, v102
    v_add_f32 v99, v99, v103
    v_add_f32 v96, v96, v104
    v_add_f32 v97, v97, v105
    v_add_f32 v98, v98, v106
    v_add_f32 v99, v99, v107
    v_add_f32 v96, v96, v108
    v_add_f32 v97, v97, v109
    v_add_f32 v98, v98, v110
    v_add_f32 v99, v99, v111
    v_add_f32 v96, v96, v112
    v_add_f32 v97, v97, v113
    v_add_f32 v98, v98, v114
    v_add_f32 v99, v99, v115
    v_add_f32 v96, v96, v116
    v_add_f32 v97, v97, v117
    v_add_f32 v98, v98, v118
    v_add_f32 v99, v99, v119
    v_add_f32 v96, v96, v120
    v_add_f32 v97, v97, v121
    v_add_f32 v98, v98, v122
    v_add_f32 v99, v99, v123
    v_add_f32 v96, v96, v124
    v_add_f32 v97, v97, v125
    v_add_f32 v98, v98, v126
    v_add_f32 v99, v99, v127
    s_nop 1
    v_permlane16_swap_b32 v64, v96
    v_permlane16_swap_b32 v65, v97
    v_permlane16_swap_b32 v66, v98
    v_permlane16_swap_b32 v67, v99
    v_add_f32 v64, v64, v96
    v_add_f32 v65, v65, v97
    v_add_f32 v66, v66, v98
    v_add_f32 v67, v67, v99
    s_nop 1
    v_permlane32_swap_b32 v64, v66
    v_permlane32_swap_b32 v65, v67
    v_add_f32 v64, v64, v66
    v_add_f32 v65, v65, v67
    s_nop 1
    v_permlane16_swap_b32 v64, v65
    v_cvt_pk_bf16_f32 v66, v64, v65
    v_lshlrev_b32 v64, 16, v66
    v_and_b32 v65, 0xffff0000, v66
    v_mul_f32 v66, s72, v64
    v_exp_f32 v66, -v66
    v_and_b32 v16, 15, v2
    v_add_f32 v66, 1.0, v66
    v_rcp_f32 v66, v66
    v_lshl_add_u32 v16, v16, 2, v8
    v_mul_f32 v66, v66, v64
    v_cvt_pk_bf16_f32 v66, v66, v66
    v_lshlrev_b32 v66, 16, v66
    v_mul_f32 v66, v66, v65
    v_cvt_pk_bf16_f32 v66, v66, v66
    v_lshlrev_b32 v66, 16, v66
    v_lshlrev_b32 v16, 2, v16
    ds_write_b32 v16, v66 offset:4352
    s_waitcnt lgkmcnt(0)
C_nh:
    v_lshlrev_b32 v3, 4, v2
    s_barrier
    ds_read_b128 v[24:27], v5 offset:4096
    ds_read_b128 v[16:19], v4 offset:0
    ds_read_b128 v[28:31], v5 offset:4128
    ds_read_b128 v[20:23], v4 offset:1024
    s_waitcnt lgkmcnt(3)
    v_mfma_f32_32x32x16_bf16 v[96:111], v[24:27], v[32:35], 0
    s_waitcnt lgkmcnt(2)
    v_mfma_f32_32x32x16_bf16 v[64:79], v[16:19], v[32:35], 0
    s_waitcnt lgkmcnt(1)
    v_mfma_f32_32x32x16_bf16 v[96:111], v[28:31], v[36:39], v[96:111]
    s_waitcnt lgkmcnt(0)
    v_mfma_f32_32x32x16_bf16 v[64:79], v[20:23], v[36:39], v[64:79]
    v_mfma_f32_32x32x16_bf16 v[112:127], v[24:27], v[40:43], 0
    v_mfma_f32_32x32x16_bf16 v[80:95], v[16:19], v[40:43], 0
    v_mfma_f32_32x32x16_bf16 v[112:127], v[28:31], v[44:47], v[112:127]
    v_mfma_f32_32x32x16_bf16 v[80:95], v[20:23], v[44:47], v[80:95]
    s_nop 6
    v_cvt_pk_bf16_f32 v48, v96, v96
    v_lshlrev_b32 v48, 16, v48
    v_add_f32 v48, s73, v48
    v_cvt_pk_bf16_f32 v48, v48, v48
    v_lshlrev_b32 v48, 16, v48
    v_rcp_f32 v48, v48
    s_nop 0
    v_mul_f32 v64, v64, v48
    v_mul_f32 v65, v65, v48
    v_cvt_pk_bf16_f32 v128, v64, v65
    v_mul_f32 v66, v66, v48
    v_mul_f32 v67, v67, v48
    v_cvt_pk_bf16_f32 v129, v66, v67
    v_mul_f32 v68, v68, v48
    v_mul_f32 v69, v69, v48
    v_cvt_pk_bf16_f32 v130, v68, v69
    v_mul_f32 v70, v70, v48
    v_mul_f32 v71, v71, v48
    v_cvt_pk_bf16_f32 v131, v70, v71
    buffer_store_dwordx4 v[128:131], v3, s[16:19], s69 offen offset:0 sc0 sc1
    v_mul_f32 v72, v72, v48
    v_mul_f32 v73, v73, v48
    v_cvt_pk_bf16_f32 v132, v72, v73
    v_mul_f32 v74, v74, v48
    v_mul_f32 v75, v75, v48
    v_cvt_pk_bf16_f32 v133, v74, v75
    v_mul_f32 v76, v76, v48
    v_mul_f32 v77, v77, v48
    v_cvt_pk_bf16_f32 v134, v76, v77
    v_mul_f32 v78, v78, v48
    v_mul_f32 v79, v79, v48
    v_cvt_pk_bf16_f32 v135, v78, v79
    buffer_store_dwordx4 v[132:135], v3, s[16:19], s69 offen offset:1024 sc0 sc1
    s_add_u32 s69, s69, 65536
    s_nop 3
    v_cvt_pk_bf16_f32 v49, v112, v112
    v_lshlrev_b32 v49, 16, v49
    v_add_f32 v49, s73, v49
    v_cvt_pk_bf16_f32 v49, v49, v49
    v_lshlrev_b32 v49, 16, v49
    v_rcp_f32 v49, v49
    s_nop 0
    v_mul_f32 v80, v80, v49
    v_mul_f32 v81, v81, v49
    v_cvt_pk_bf16_f32 v136, v80, v81
    v_mul_f32 v82, v82, v49
    v_mul_f32 v83, v83, v49
    v_cvt_pk_bf16_f32 v137, v82, v83
    v_mul_f32 v84, v84, v49
    v_mul_f32 v85, v85, v49
    v_cvt_pk_bf16_f32 v138, v84, v85
    v_mul_f32 v86, v86, v49
    v_mul_f32 v87, v87, v49
    v_cvt_pk_bf16_f32 v139, v86, v87
    buffer_store_dwordx4 v[136:139], v3, s[16:19], s69 offen offset:0 sc0 sc1
    v_mul_f32 v88, v88, v49
    v_mul_f32 v89, v89, v49
    v_cvt_pk_bf16_f32 v140, v88, v89
    v_mul_f32 v90, v90, v49
    v_mul_f32 v91, v91, v49
    v_cvt_pk_bf16_f32 v141, v90, v91
    v_mul_f32 v92, v92, v49
    v_mul_f32 v93, v93, v49
    v_cvt_pk_bf16_f32 v142, v92, v93
    v_mul_f32 v94, v94, v49
    v_mul_f32 v95, v95, v49
    v_cvt_pk_bf16_f32 v143, v94, v95
    buffer_store_dwordx4 v[140:143], v3, s[16:19], s69 offen offset:1024 sc0 sc1
    v_lshl_add_u32 v12, v2, 7, s70
    s_waitcnt vmcnt(0)
    s_mov_b64 exec, 3
    buffer_atomic_or v11, v12, s[16:19], 0 offen
    s_mov_b64 exec, -1
P2_start:
    s_and_b32 s6, s3, 3
    s_lshr_b32 s7, s3, 2
    s_mov_b32 s20, s58
    s_mov_b32 s21, s59
    s_mov_b32 s22, 0x400000
    s_mov_b32 s23, 0x00020000
    s_and_b32 s67, s75, 0x7ff
    s_sub_u32 s67, 2047, s67
    s_lshl_b32 s64, s4, 2
    s_add_u32 s64, s64, s6
    s_lshl_b32 s64, s64, 16
    s_lshl_b32 s65, s7, 15
    s_add_u32 s64, s64, s65
    v_lshlrev_b32 v4, 4, v2
    v_add_u32 v4, s64, v4
    v_lshrrev_b32 v10, 5, v2
    v_bfe_u32 v11, v2, 2, 2
    v_lshl_add_u32 v12, v10, 2, v11
    v_lshlrev_b32 v12, 7, v12
    v_bfe_u32 v13, v2, 4, 1
    v_lshl_add_u32 v12, v13, 5, v12
    v_and_b32 v13, 3, v2
    v_lshl_add_u32 v12, v13, 3, v12
    v_lshrrev_b32 v11, 1, v11
    v_lshl_add_u32 v5, v11, 6, v12
    v_xor_b32 v11, 1, v11
    v_lshl_add_u32 v6, v11, 6, v12
    s_lshl_b32 s64, s4, 3
    s_add_u32 s64, s64, s3
    s_lshl_b32 s64, s64, 7
    s_add_u32 s64, s64, 5382144
    v_mov_b32 v14, s64
    s_mov_b64 exec, 1
    v_mov_b32 v15, 0
    buffer_atomic_or v15, v14, s[16:19], 0 offen sc0
    s_mov_b64 exec, -1
    s_cmp_eq_u32 s7, 0
    s_mov_b32 s64, 147456
    s_cselect_b32 s64, 131072, s64
    v_writelane_b32 v7, s64, 0
    s_mov_b32 s64, 155648
    s_cselect_b32 s64, 139264, s64
    v_writelane_b32 v7, s64, 2
    s_mov_b32 s64, 81920
    s_cselect_b32 s64, 73728, s64
    v_writelane_b32 v7, s64, 4
    s_mov_b32 s64, 122880
    s_cselect_b32 s64, 114688, s64
    v_writelane_b32 v7, s64, 6
    s_mov_b32 s64, 49152
    s_cselect_b32 s64, 40960, s64
    v_writelane_b32 v7, s64, 8
    s_mov_b32 s64, 57344
    s_cselect_b32 s64, 8192, s64
    v_writelane_b32 v7, s64, 10
    s_mov_b32 s64, 65536
    s_cselect_b32 s64, 16384, s64
    v_writelane_b32 v7, s64, 12
    s_mov_b32 s64, 90112
    s_cselect_b32 s64, 24576, s64
    v_writelane_b32 v7, s64, 14
    v_mov_b32 v16, 0
    v_mov_b32 v17, 0
    v_mov_b32 v18, 0
    v_mov_b32 v19, 0
    v_mov_b32 v20, 0
    v_mov_b32 v21, 0
    v_mov_b32 v22, 0
    v_mov_b32 v23, 0
    v_mov_b32 v24, 0
    v_mov_b32 v25, 0
    v_mov_b32 v26, 0
    v_mov_b32 v27, 0
    v_mov_b32 v28, 0
    v_mov_b32 v29, 0
    v_mov_b32 v30, 0
    v_mov_b32 v31, 0
    v_mov_b32 v32, 0
    v_mov_b32 v33, 0
    v_mov_b32 v34, 0
    v_mov_b32 v35, 0
    v_mov_b32 v36, 0
    v_mov_b32 v37, 0
    v_mov_b32 v38, 0
    v_mov_b32 v39, 0
    v_mov_b32 v40, 0
    v_mov_b32 v41, 0
    v_mov_b32 v42, 0
    v_mov_b32 v43, 0
    v_mov_b32 v44, 0
    v_mov_b32 v45, 0
    v_mov_b32 v46, 0
    v_mov_b32 v47, 0
    s_mov_b32 s66, 0x5555
    s_mov_b32 s65, 0
D_wait:
    s_waitcnt vmcnt(0)
    v_readfirstlane_b32 s68, v15
    s_lshr_b32 s64, s68, 1
    s_and_b32 s68, s68, s64
    s_and_b32 s68, s68, s66
    s_cbranch_scc1 D_go
    s_add_u32 s65, s65, 1
    s_cmp_ge_u32 s65, 40000
    s_cbranch_scc1 D_end
    s_sleep 1
    s_mov_b64 exec, 1
    v_mov_b32 v15, 0
    buffer_atomic_or v15, v14, s[16:19], 0 offen sc0
    s_mov_b64 exec, -1
    s_branch D_wait
D_go:
    s_andn2_b32 s66, s66, s68
    s_lshr_b32 s64, s67, 7
    s_xor_b32 s64, s64, s4
    s_or_b32 s64, s64, s66
    s_cbranch_scc0 P2_yl
P2_nyl:
    s_bcnt1_i32_b32 s70, s68
    s_cmp_gt_u32 s70, 4
    s_cbranch_scc1 D_t58
    s_cmp_gt_u32 s70, 2
    s_cbranch_scc1 D_t34
    s_cmp_eq_u32 s70, 2
    s_cbranch_scc1 D_e2
D_e1:
    s_ff1_i32_b32 s64, s68
    s_bitset0_b32 s68, s64
    v_readlane_b32 s32, v7, s64
    s_lshl_b32 s69, s64, 11
    buffer_load_dwordx4 v[80:83], v4, s[16:19], s69 offen offset:0 sc1
    buffer_load_dwordx4 v[84:87], v4, s[16:19], s69 offen offset:1024 sc1
    buffer_load_dwordx4 v[88:91], v4, s[16:19], s69 offen offset:2048 sc1
    buffer_load_dwordx4 v[92:95], v4, s[16:19], s69 offen offset:3072 sc1
    s_mov_b64 exec, 1
    v_mov_b32 v15, 0
    buffer_atomic_or v15, v14, s[16:19], 0 offen sc0
    s_mov_b64 exec, -1
    v_add_u32 v8, s32, v5
    v_add_u32 v9, s32, v6
    ds_read_b64_tr_b16 v[48:49], v8 offset:0
    ds_read_b64_tr_b16 v[50:51], v8 offset:1024
    ds_read_b64_tr_b16 v[56:57], v9 offset:0
    ds_read_b64_tr_b16 v[58:59], v9 offset:1024
    ds_read_b64_tr_b16 v[52:53], v8 offset:2048
    ds_read_b64_tr_b16 v[54:55], v8 offset:3072
    ds_read_b64_tr_b16 v[60:61], v9 offset:2048
    ds_read_b64_tr_b16 v[62:63], v9 offset:3072
    s_branch D_p0
D_e2:
    s_ff1_i32_b32 s64, s68
    s_bitset0_b32 s68, s64
    v_readlane_b32 s33, v7, s64
    s_lshl_b32 s69, s64, 11
    buffer_load_dwordx4 v[96:99], v4, s[16:19], s69 offen offset:0 sc1
    buffer_load_dwordx4 v[100:103], v4, s[16:19], s69 offen offset:1024 sc1
    buffer_load_dwordx4 v[104:107], v4, s[16:19], s69 offen offset:2048 sc1
    buffer_load_dwordx4 v[108:111], v4, s[16:19], s69 offen offset:3072 sc1
    s_ff1_i32_b32 s64, s68
    s_bitset0_b32 s68, s64
    v_readlane_b32 s32, v7, s64
    s_lshl_b32 s69, s64, 11
    buffer_load_dwordx4 v[80:83], v4, s[16:19], s69 offen offset:0 sc1
    buffer_load_dwordx4 v[84:87], v4, s[16:19], s69 offen offset:1024 sc1
    buffer_load_dwordx4 v[88:91], v4, s[16:19], s69 offen offset:2048 sc1
    buffer_load_dwordx4 v[92:95], v4, s[16:19], s69 offen offset:3072 sc1
    s_mov_b64 exec, 1
    v_mov_b32 v15, 0
    buffer_atomic_or v15, v14, s[16:19], 0 offen sc0
    s_mov_b64 exec, -1
    v_add_u32 v8, s33, v5
    v_add_u32 v9, s33, v6
    ds_read_b64_tr_b16 v[48:49], v8 offset:0
    ds_read_b64_tr_b16 v[50:51], v8 offset:1024
    ds_read_b64_tr_b16 v[56:57], v9 offset:0
    ds_read_b64_tr_b16 v[58:59], v9 offset:1024
    ds_read_b64_tr_b16 v[52:53], v8 offset:2048
    ds_read_b64_tr_b16 v[54:55], v8 offset:3072
    ds_read_b64_tr_b16 v[60:61], v9 offset:2048
    ds_read_b64_tr_b16 v[62:63], v9 offset:3072
    s_branch D_p1
D_t34:
    s_cmp_eq_u32 s70, 4
    s_cbranch_scc1 D_e4
D_e3:
    s_ff1_i32_b32 s64, s68
    s_bitset0_b32 s68, s64
    v_readlane_b32 s34, v7, s64
    s_lshl_b32 s69, s64, 11
    buffer_load_dwordx4 v[112:115], v4, s[16:19], s69 offen offset:0 sc1
    buffer_load_dwordx4 v[116:119], v4, s[16:19], s69 offen offset:1024 sc1
    buffer_load_dwordx4 v[120:123], v4, s[16:19], s69 offen offset:2048 sc1
    buffer_load_dwordx4 v[124:127], v4, s[16:19], s69 offen offset:3072 sc1
    s_ff1_i32_b32 s64, s68
    s_bitset0_b32 s68, s64
    v_readlane_b32 s33, v7, s64
    s_lshl_b32 s69, s64, 11
    buffer_load_dwordx4 v[96:99], v4, s[16:19], s69 offen offset:0 sc1
    buffer_load_dwordx4 v[100:103], v4, s[16:19], s69 offen offset:1024 sc1
    buffer_load_dwordx4 v[104:107], v4, s[16:19], s69 offen offset:2048 sc1
    buffer_load_dwordx4 v[108:111], v4, s[16:19], s69 offen offset:3072 sc1
    v_add_u32 v8, s34, v5
    v_add_u32 v9, s34, v6
    ds_read_b64_tr_b16 v[48:49], v8 offset:0
    ds_read_b64_tr_b16 v[50:51], v8 offset:1024
    ds_read_b64_tr_b16 v[56:57], v9 offset:0
    ds_read_b64_tr_b16 v[58:59], v9 offset:1024
    ds_read_b64_tr_b16 v[52:53], v8 offset:2048
    ds_read_b64_tr_b16 v[54:55], v8 offset:3072
    ds_read_b64_tr_b16 v[60:61], v9 offset:2048
    ds_read_b64_tr_b16 v[62:63], v9 offset:3072
    s_branch D_p2
D_e4:
    s_ff1_i32_b32 s64, s68
    s_bitset0_b32 s68, s64
    v_readlane_b32 s35, v7, s64
    s_lshl_b32 s69, s64, 11
    buffer_load_dwordx4 v[128:131], v4, s[16:19], s69 offen offset:0 sc1
    buffer_load_dwordx4 v[132:135], v4, s[16:19], s69 offen offset:1024 sc1
    buffer_load_dwordx4 v[136:139], v4, s[16:19], s69 offen offset:2048 sc1
    buffer_load_dwordx4 v[140:143], v4, s[16:19], s69 offen offset:3072 sc1
    s_ff1_i32_b32 s64, s68
    s_bitset0_b32 s68, s64
    v_readlane_b32 s34, v7, s64
    s_lshl_b32 s69, s64, 11
    buffer_load_dwordx4 v[112:115], v4, s[16:19], s69 offen offset:0 sc1
    buffer_load_dwordx4 v[116:119], v4, s[16:19], s69 offen offset:1024 sc1
    buffer_load_dwordx4 v[120:123], v4, s[16:19], s69 offen offset:2048 sc1
    buffer_load_dwordx4 v[124:127], v4, s[16:19], s69 offen offset:3072 sc1
    v_add_u32 v8, s35, v5
    v_add_u32 v9, s35, v6
    ds_read_b64_tr_b16 v[48:49], v8 offset:0
    ds_read_b64_tr_b16 v[50:51], v8 offset:1024
    ds_read_b64_tr_b16 v[56:57], v9 offset:0
    ds_read_b64_tr_b16 v[58:59], v9 offset:1024
    ds_read_b64_tr_b16 v[52:53], v8 offset:2048
    ds_read_b64_tr_b16 v[54:55], v8 offset:3072
    ds_read_b64_tr_b16 v[60:61], v9 offset:2048
    ds_read_b64_tr_b16 v[62:63], v9 offset:3072
    s_branch D_p3
D_t58:
    s_cmp_gt_u32 s70, 6
    s_cbranch_scc1 D_t78
    s_cmp_eq_u32 s70, 6
    s_cbranch_scc1 D_e6
D_e5:
    s_ff1_i32_b32 s64, s68
    s_bitset0_b32 s68, s64
    v_readlane_b32 s36, v7, s64
    s_lshl_b32 s69, s64, 11
    buffer_load_dwordx4 v[144:147], v4, s[16:19], s69 offen offset:0 sc1
    buffer_load_dwordx4 v[148:151], v4, s[16:19], s69 offen offset:1024 sc1
    buffer_load_dwordx4 v[152:155], v4, s[16:19], s69 offen offset:2048 sc1
    buffer_load_dwordx4 v[156:159], v4, s[16:19], s69 offen offset:3072 sc1
    s_ff1_i32_b32 s64, s68
    s_bitset0_b32 s68, s64
    v_readlane_b32 s35, v7, s64
    s_lshl_b32 s69, s64, 11
    buffer_load_dwordx4 v[128:131], v4, s[16:19], s69 offen offset:0 sc1
    buffer_load_dwordx4 v[132:135], v4, s[16:19], s69 offen offset:1024 sc1
    buffer_load_dwordx4 v[136:139], v4, s[16:19], s69 offen offset:2048 sc1
    buffer_load_dwordx4 v[140:143], v4, s[16:19], s69 offen offset:3072 sc1
    v_add_u32 v8, s36, v5
    v_add_u32 v9, s36, v6
    ds_read_b64_tr_b16 v[48:49], v8 offset:0
    ds_read_b64_tr_b16 v[50:51], v8 offset:1024
    ds_read_b64_tr_b16 v[56:57], v9 offset:0
    ds_read_b64_tr_b16 v[58:59], v9 offset:1024
    ds_read_b64_tr_b16 v[52:53], v8 offset:2048
    ds_read_b64_tr_b16 v[54:55], v8 offset:3072
    ds_read_b64_tr_b16 v[60:61], v9 offset:2048
    ds_read_b64_tr_b16 v[62:63], v9 offset:3072
    s_branch D_p4
D_e6:
    s_ff1_i32_b32 s64, s68
    s_bitset0_b32 s68, s64
    v_readlane_b32 s37, v7, s64
    s_lshl_b32 s69, s64, 11
    buffer_load_dwordx4 v[160:163], v4, s[16:19], s69 offen offset:0 sc1
    buffer_load_dwordx4 v[164:167], v4, s[16:19], s69 offen offset:1024 sc1
    buffer_load_dwordx4 v[168:171], v4, s[16:19], s69 offen offset:2048 sc1
    buffer_load_dwordx4 v[172:175], v4, s[16:19], s69 offen offset:3072 sc1
    s_ff1_i32_b32 s64, s68
    s_bitset0_b32 s68, s64
    v_readlane_b32 s36, v7, s64
    s_lshl_b32 s69, s64, 11
    buffer_load_dwordx4 v[144:147], v4, s[16:19], s69 offen offset:0 sc1
    buffer_load_dwordx4 v[148:151], v4, s[16:19], s69 offen offset:1024 sc1
    buffer_load_dwordx4 v[152:155], v4, s[16:19], s69 offen offset:2048 sc1
    buffer_load_dwordx4 v[156:159], v4, s[16:19], s69 offen offset:3072 sc1
    v_add_u32 v8, s37, v5
    v_add_u32 v9, s37, v6
    ds_read_b64_tr_b16 v[48:49], v8 offset:0
    ds_read_b64_tr_b16 v[50:51], v8 offset:1024
    ds_read_b64_tr_b16 v[56:57], v9 offset:0
    ds_read_b64_tr_b16 v[58:59], v9 offset:1024
    ds_read_b64_tr_b16 v[52:53], v8 offset:2048
    ds_read_b64_tr_b16 v[54:55], v8 offset:3072
    ds_read_b64_tr_b16 v[60:61], v9 offset:2048
    ds_read_b64_tr_b16 v[62:63], v9 offset:3072
    s_branch D_p5
D_t78:
    s_cmp_eq_u32 s70, 8
    s_cbranch_scc1 D_e8
D_e7:
    s_ff1_i32_b32 s64, s68
    s_bitset0_b32 s68, s64
    v_readlane_b32 s38, v7, s64
    s_lshl_b32 s69, s64, 11
    buffer_load_dwordx4 v[176:179], v4, s[16:19], s69 offen offset:0 sc1
    buffer_load_dwordx4 v[180:183], v4, s[16:19], s69 offen offset:1024 sc1
    buffer_load_dwordx4 v[184:187], v4, s[16:19], s69 offen offset:2048 sc1
    buffer_load_dwordx4 v[188:191], v4, s[16:19], s69 offen offset:3072 sc1
    s_ff1_i32_b32 s64, s68
    s_bitset0_b32 s68, s64
    v_readlane_b32 s37, v7, s64
    s_lshl_b32 s69, s64, 11
    buffer_load_dwordx4 v[160:163], v4, s[16:19], s69 offen offset:0 sc1
    buffer_load_dwordx4 v[164:167], v4, s[16:19], s69 offen offset:1024 sc1
    buffer_load_dwordx4 v[168:171], v4, s[16:19], s69 offen offset:2048 sc1
    buffer_load_dwordx4 v[172:175], v4, s[16:19], s69 offen offset:3072 sc1
    v_add_u32 v8, s38, v5
    v_add_u32 v9, s38, v6
    ds_read_b64_tr_b16 v[48:49], v8 offset:0
    ds_read_b64_tr_b16 v[50:51], v8 offset:1024
    ds_read_b64_tr_b16 v[56:57], v9 offset:0
    ds_read_b64_tr_b16 v[58:59], v9 offset:1024
    ds_read_b64_tr_b16 v[52:53], v8 offset:2048
    ds_read_b64_tr_b16 v[54:55], v8 offset:3072
    ds_read_b64_tr_b16 v[60:61], v9 offset:2048
    ds_read_b64_tr_b16 v[62:63], v9 offset:3072
    s_branch D_p6
D_e8:
    s_ff1_i32_b32 s64, s68
    s_bitset0_b32 s68, s64
    v_readlane_b32 s39, v7, s64
    s_lshl_b32 s69, s64, 11
    buffer_load_dwordx4 v[192:195], v4, s[16:19], s69 offen offset:0 sc1
    buffer_load_dwordx4 v[196:199], v4, s[16:19], s69 offen offset:1024 sc1
    buffer_load_dwordx4 v[200:203], v4, s[16:19], s69 offen offset:2048 sc1
    buffer_load_dwordx4 v[204:207], v4, s[16:19], s69 offen offset:3072 sc1
    s_ff1_i32_b32 s64, s68
    s_bitset0_b32 s68, s64
    v_readlane_b32 s38, v7, s64
    s_lshl_b32 s69, s64, 11
    buffer_load_dwordx4 v[176:179], v4, s[16:19], s69 offen offset:0 sc1
    buffer_load_dwordx4 v[180:183], v4, s[16:19], s69 offen offset:1024 sc1
    buffer_load_dwordx4 v[184:187], v4, s[16:19], s69 offen offset:2048 sc1
    buffer_load_dwordx4 v[188:191], v4, s[16:19], s69 offen offset:3072 sc1
    v_add_u32 v8, s39, v5
    v_add_u32 v9, s39, v6
    ds_read_b64_tr_b16 v[48:49], v8 offset:0
    ds_read_b64_tr_b16 v[50:51], v8 offset:1024
    ds_read_b64_tr_b16 v[56:57], v9 offset:0
    ds_read_b64_tr_b16 v[58:59], v9 offset:1024
    ds_read_b64_tr_b16 v[52:53], v8 offset:2048
    ds_read_b64_tr_b16 v[54:55], v8 offset:3072
    ds_read_b64_tr_b16 v[60:61], v9 offset:2048
    ds_read_b64_tr_b16 v[62:63], v9 offset:3072
D_p7:
    s_waitcnt vmcnt(4) lgkmcnt(0)
    v_mfma_f32_32x32x16_bf16 v[16:31], v[48:51], v[192:195], v[16:31]
    s_ff1_i32_b32 s64, s68
    s_bitset0_b32 s68, s64
    v_readlane_b32 s37, v7, s64
    s_lshl_b32 s69, s64, 11
    buffer_load_dwordx4 v[160:163], v4, s[16:19], s69 offen offset:0 sc1
    ds_read_b64_tr_b16 v[64:65], v8 offset:4096
    ds_read_b64_tr_b16 v[66:67], v8 offset:5120
    ds_read_b64_tr_b16 v[72:73], v9 offset:4096
    v_mfma_f32_32x32x16_bf16 v[32:47], v[56:59], v[192:195], v[32:47]
    ds_read_b64_tr_b16 v[74:75], v9 offset:5120
    ds_read_b64_tr_b16 v[68:69], v8 offset:6144
    ds_read_b64_tr_b16 v[70:71], v8 offset:7168
    v_mfma_f32_32x32x16_bf16 v[16:31], v[52:55], v[196:199], v[16:31]
    buffer_load_dwordx4 v[164:167], v4, s[16:19], s69 offen offset:1024 sc1
    ds_read_b64_tr_b16 v[76:77], v9 offset:6144
    ds_read_b64_tr_b16 v[78:79], v9 offset:7168
    v_mfma_f32_32x32x16_bf16 v[32:47], v[60:63], v[196:199], v[32:47]
    s_waitcnt lgkmcnt(0)
    v_mfma_f32_32x32x16_bf16 v[16:31], v[64:67], v[200:203], v[16:31]
    buffer_load_dwordx4 v[168:171], v4, s[16:19], s69 offen offset:2048 sc1
    v_add_u32 v8, s38, v5
    v_add_u32 v9, s38, v6
    ds_read_b64_tr_b16 v[48:49], v8 offset:0
    ds_read_b64_tr_b16 v[50:51], v8 offset:1024
    v_mfma_f32_32x32x16_bf16 v[32:47], v[72:75], v[200:203], v[32:47]
    ds_read_b64_tr_b16 v[56:57], v9 offset:0
    ds_read_b64_tr_b16 v[58:59], v9 offset:1024
    ds_read_b64_tr_b16 v[52:53], v8 offset:2048
    ds_read_b64_tr_b16 v[54:55], v8 offset:3072
    v_mfma_f32_32x32x16_bf16 v[16:31], v[68:71], v[204:207], v[16:31]
    buffer_load_dwordx4 v[172:175], v4, s[16:19], s69 offen offset:3072 sc1
    ds_read_b64_tr_b16 v[60:61], v9 offset:2048
    ds_read_b64_tr_b16 v[62:63], v9 offset:3072
    v_mfma_f32_32x32x16_bf16 v[32:47], v[76:79], v[204:207], v[32:47]
D_p6:
    s_waitcnt vmcnt(4) lgkmcnt(0)
    v_mfma_f32_32x32x16_bf16 v[16:31], v[48:51], v[176:179], v[16:31]
    s_ff1_i32_b32 s64, s68
    s_bitset0_b32 s68, s64
    v_readlane_b32 s36, v7, s64
    s_lshl_b32 s69, s64, 11
    buffer_load_dwordx4 v[144:147], v4, s[16:19], s69 offen offset:0 sc1
    ds_read_b64_tr_b16 v[64:65], v8 offset:4096
    ds_read_b64_tr_b16 v[66:67], v8 offset:5120
    ds_read_b64_tr_b16 v[72:73], v9 offset:4096
    v_mfma_f32_32x32x16_bf16 v[32:47], v[56:59], v[176:179], v[32:47]
    ds_read_b64_tr_b16 v[74:75], v9 offset:5120
    ds_read_b64_tr_b16 v[68:69], v8 offset:6144
    ds_read_b64_tr_b16 v[70:71], v8 offset:7168
    v_mfma_f32_32x32x16_bf16 v[16:31], v[52:55], v[180:183], v[16:31]
    buffer_load_dwordx4 v[148:151], v4, s[16:19], s69 offen offset:1024 sc1
    ds_read_b64_tr_b16 v[76:77], v9 offset:6144
    ds_read_b64_tr_b16 v[78:79], v9 offset:7168
    v_mfma_f32_32x32x16_bf16 v[32:47], v[60:63], v[180:183], v[32:47]
    s_waitcnt lgkmcnt(0)
    v_mfma_f32_32x32x16_bf16 v[16:31], v[64:67], v[184:187], v[16:31]
    buffer_load_dwordx4 v[152:155], v4, s[16:19], s69 offen offset:2048 sc1
    v_add_u32 v8, s37, v5
    v_add_u32 v9, s37, v6
    ds_read_b64_tr_b16 v[48:49], v8 offset:0
    ds_read_b64_tr_b16 v[50:51], v8 offset:1024
    v_mfma_f32_32x32x16_bf16 v[32:47], v[72:75], v[184:187], v[32:47]
    ds_read_b64_tr_b16 v[56:57], v9 offset:0
    ds_read_b64_tr_b16 v[58:59], v9 offset:1024
    ds_read_b64_tr_b16 v[52:53], v8 offset:2048
    ds_read_b64_tr_b16 v[54:55], v8 offset:3072
    v_mfma_f32_32x32x16_bf16 v[16:31], v[68:71], v[188:191], v[16:31]
    buffer_load_dwordx4 v[156:159], v4, s[16:19], s69 offen offset:3072 sc1
    ds_read_b64_tr_b16 v[60:61], v9 offset:2048
    ds_read_b64_tr_b16 v[62:63], v9 offset:3072
    v_mfma_f32_32x32x16_bf16 v[32:47], v[76:79], v[188:191], v[32:47]
D_p5:
    s_waitcnt vmcnt(4) lgkmcnt(0)
    v_mfma_f32_32x32x16_bf16 v[16:31], v[48:51], v[160:163], v[16:31]
    s_ff1_i32_b32 s64, s68
    s_bitset0_b32 s68, s64
    v_readlane_b32 s35, v7, s64
    s_lshl_b32 s69, s64, 11
    buffer_load_dwordx4 v[128:131], v4, s[16:19], s69 offen offset:0 sc1
    ds_read_b64_tr_b16 v[64:65], v8 offset:4096
    ds_read_b64_tr_b16 v[66:67], v8 offset:5120
    ds_read_b64_tr_b16 v[72:73], v9 offset:4096
    v_mfma_f32_32x32x16_bf16 v[32:47], v[56:59], v[160:163], v[32:47]
    ds_read_b64_tr_b16 v[74:75], v9 offset:5120
    ds_read_b64_tr_b16 v[68:69], v8 offset:6144
    ds_read_b64_tr_b16 v[70:71], v8 offset:7168
    v_mfma_f32_32x32x16_bf16 v[16:31], v[52:55], v[164:167], v[16:31]
    buffer_load_dwordx4 v[132:135], v4, s[16:19], s69 offen offset:1024 sc1
    ds_read_b64_tr_b16 v[76:77], v9 offset:6144
    ds_read_b64_tr_b16 v[78:79], v9 offset:7168
    v_mfma_f32_32x32x16_bf16 v[32:47], v[60:63], v[164:167], v[32:47]
    s_waitcnt lgkmcnt(0)
    v_mfma_f32_32x32x16_bf16 v[16:31], v[64:67], v[168:171], v[16:31]
    buffer_load_dwordx4 v[136:139], v4, s[16:19], s69 offen offset:2048 sc1
    v_add_u32 v8, s36, v5
    v_add_u32 v9, s36, v6
    ds_read_b64_tr_b16 v[48:49], v8 offset:0
    ds_read_b64_tr_b16 v[50:51], v8 offset:1024
    v_mfma_f32_32x32x16_bf16 v[32:47], v[72:75], v[168:171], v[32:47]
    ds_read_b64_tr_b16 v[56:57], v9 offset:0
    ds_read_b64_tr_b16 v[58:59], v9 offset:1024
    ds_read_b64_tr_b16 v[52:53], v8 offset:2048
    ds_read_b64_tr_b16 v[54:55], v8 offset:3072
    v_mfma_f32_32x32x16_bf16 v[16:31], v[68:71], v[172:175], v[16:31]
    buffer_load_dwordx4 v[140:143], v4, s[16:19], s69 offen offset:3072 sc1
    ds_read_b64_tr_b16 v[60:61], v9 offset:2048
    ds_read_b64_tr_b16 v[62:63], v9 offset:3072
    v_mfma_f32_32x32x16_bf16 v[32:47], v[76:79], v[172:175], v[32:47]
D_p4:
    s_waitcnt vmcnt(4) lgkmcnt(0)
    v_mfma_f32_32x32x16_bf16 v[16:31], v[48:51], v[144:147], v[16:31]
    s_ff1_i32_b32 s64, s68
    s_bitset0_b32 s68, s64
    v_readlane_b32 s34, v7, s64
    s_lshl_b32 s69, s64, 11
    buffer_load_dwordx4 v[112:115], v4, s[16:19], s69 offen offset:0 sc1
    ds_read_b64_tr_b16 v[64:65], v8 offset:4096
    ds_read_b64_tr_b16 v[66:67], v8 offset:5120
    ds_read_b64_tr_b16 v[72:73], v9 offset:4096
    v_mfma_f32_32x32x16_bf16 v[32:47], v[56:59], v[144:147], v[32:47]
    ds_read_b64_tr_b16 v[74:75], v9 offset:5120
    ds_read_b64_tr_b16 v[68:69], v8 offset:6144
    ds_read_b64_tr_b16 v[70:71], v8 offset:7168
    v_mfma_f32_32x32x16_bf16 v[16:31], v[52:55], v[148:151], v[16:31]
    buffer_load_dwordx4 v[116:119], v4, s[16:19], s69 offen offset:1024 sc1
    ds_read_b64_tr_b16 v[76:77], v9 offset:6144
    ds_read_b64_tr_b16 v[78:79], v9 offset:7168
    v_mfma_f32_32x32x16_bf16 v[32:47], v[60:63], v[148:151], v[32:47]
    s_waitcnt lgkmcnt(0)
    v_mfma_f32_32x32x16_bf16 v[16:31], v[64:67], v[152:155], v[16:31]
    buffer_load_dwordx4 v[120:123], v4, s[16:19], s69 offen offset:2048 sc1
    v_add_u32 v8, s35, v5
    v_add_u32 v9, s35, v6
    ds_read_b64_tr_b16 v[48:49], v8 offset:0
    ds_read_b64_tr_b16 v[50:51], v8 offset:1024
    v_mfma_f32_32x32x16_bf16 v[32:47], v[72:75], v[152:155], v[32:47]
    ds_read_b64_tr_b16 v[56:57], v9 offset:0
    ds_read_b64_tr_b16 v[58:59], v9 offset:1024
    ds_read_b64_tr_b16 v[52:53], v8 offset:2048
    ds_read_b64_tr_b16 v[54:55], v8 offset:3072
    v_mfma_f32_32x32x16_bf16 v[16:31], v[68:71], v[156:159], v[16:31]
    buffer_load_dwordx4 v[124:127], v4, s[16:19], s69 offen offset:3072 sc1
    ds_read_b64_tr_b16 v[60:61], v9 offset:2048
    ds_read_b64_tr_b16 v[62:63], v9 offset:3072
    v_mfma_f32_32x32x16_bf16 v[32:47], v[76:79], v[156:159], v[32:47]
D_p3:
    s_waitcnt vmcnt(4) lgkmcnt(0)
    v_mfma_f32_32x32x16_bf16 v[16:31], v[48:51], v[128:131], v[16:31]
    s_ff1_i32_b32 s64, s68
    s_bitset0_b32 s68, s64
    v_readlane_b32 s33, v7, s64
    s_lshl_b32 s69, s64, 11
    buffer_load_dwordx4 v[96:99], v4, s[16:19], s69 offen offset:0 sc1
    ds_read_b64_tr_b16 v[64:65], v8 offset:4096
    ds_read_b64_tr_b16 v[66:67], v8 offset:5120
    ds_read_b64_tr_b16 v[72:73], v9 offset:4096
    v_mfma_f32_32x32x16_bf16 v[32:47], v[56:59], v[128:131], v[32:47]
    ds_read_b64_tr_b16 v[74:75], v9 offset:5120
    ds_read_b64_tr_b16 v[68:69], v8 offset:6144
    ds_read_b64_tr_b16 v[70:71], v8 offset:7168
    v_mfma_f32_32x32x16_bf16 v[16:31], v[52:55], v[132:135], v[16:31]
    buffer_load_dwordx4 v[100:103], v4, s[16:19], s69 offen offset:1024 sc1
    ds_read_b64_tr_b16 v[76:77], v9 offset:6144
    ds_read_b64_tr_b16 v[78:79], v9 offset:7168
    v_mfma_f32_32x32x16_bf16 v[32:47], v[60:63], v[132:135], v[32:47]
    s_waitcnt lgkmcnt(0)
    v_mfma_f32_32x32x16_bf16 v[16:31], v[64:67], v[136:139], v[16:31]
    buffer_load_dwordx4 v[104:107], v4, s[16:19], s69 offen offset:2048 sc1
    v_add_u32 v8, s34, v5
    v_add_u32 v9, s34, v6
    ds_read_b64_tr_b16 v[48:49], v8 offset:0
    ds_read_b64_tr_b16 v[50:51], v8 offset:1024
    v_mfma_f32_32x32x16_bf16 v[32:47], v[72:75], v[136:139], v[32:47]
    ds_read_b64_tr_b16 v[56:57], v9 offset:0
    ds_read_b64_tr_b16 v[58:59], v9 offset:1024
    ds_read_b64_tr_b16 v[52:53], v8 offset:2048
    ds_read_b64_tr_b16 v[54:55], v8 offset:3072
    v_mfma_f32_32x32x16_bf16 v[16:31], v[68:71], v[140:143], v[16:31]
    buffer_load_dwordx4 v[108:111], v4, s[16:19], s69 offen offset:3072 sc1
    ds_read_b64_tr_b16 v[60:61], v9 offset:2048
    ds_read_b64_tr_b16 v[62:63], v9 offset:3072
    v_mfma_f32_32x32x16_bf16 v[32:47], v[76:79], v[140:143], v[32:47]
D_p2:
    s_waitcnt vmcnt(4) lgkmcnt(0)
    v_mfma_f32_32x32x16_bf16 v[16:31], v[48:51], v[112:115], v[16:31]
    s_ff1_i32_b32 s64, s68
    s_bitset0_b32 s68, s64
    v_readlane_b32 s32, v7, s64
    s_lshl_b32 s69, s64, 11
    buffer_load_dwordx4 v[80:83], v4, s[16:19], s69 offen offset:0 sc1
    ds_read_b64_tr_b16 v[64:65], v8 offset:4096
    ds_read_b64_tr_b16 v[66:67], v8 offset:5120
    ds_read_b64_tr_b16 v[72:73], v9 offset:4096
    v_mfma_f32_32x32x16_bf16 v[32:47], v[56:59], v[112:115], v[32:47]
    ds_read_b64_tr_b16 v[74:75], v9 offset:5120
    ds_read_b64_tr_b16 v[68:69], v8 offset:6144
    ds_read_b64_tr_b16 v[70:71], v8 offset:7168
    v_mfma_f32_32x32x16_bf16 v[16:31], v[52:55], v[116:119], v[16:31]
    buffer_load_dwordx4 v[84:87], v4, s[16:19], s69 offen offset:1024 sc1
    ds_read_b64_tr_b16 v[76:77], v9 offset:6144
    ds_read_b64_tr_b16 v[78:79], v9 offset:7168
    v_mfma_f32_32x32x16_bf16 v[32:47], v[60:63], v[116:119], v[32:47]
    s_waitcnt lgkmcnt(0)
    v_mfma_f32_32x32x16_bf16 v[16:31], v[64:67], v[120:123], v[16:31]
    buffer_load_dwordx4 v[88:91], v4, s[16:19], s69 offen offset:2048 sc1
    v_add_u32 v8, s33, v5
    v_add_u32 v9, s33, v6
    ds_read_b64_tr_b16 v[48:49], v8 offset:0
    ds_read_b64_tr_b16 v[50:51], v8 offset:1024
    v_mfma_f32_32x32x16_bf16 v[32:47], v[72:75], v[120:123], v[32:47]
    ds_read_b64_tr_b16 v[56:57], v9 offset:0
    ds_read_b64_tr_b16 v[58:59], v9 offset:1024
    ds_read_b64_tr_b16 v[52:53], v8 offset:2048
    ds_read_b64_tr_b16 v[54:55], v8 offset:3072
    v_mfma_f32_32x32x16_bf16 v[16:31], v[68:71], v[124:127], v[16:31]
    buffer_load_dwordx4 v[92:95], v4, s[16:19], s69 offen offset:3072 sc1
    s_mov_b64 exec, 1
    v_mov_b32 v15, 0
    buffer_atomic_or v15, v14, s[16:19], 0 offen sc0
    s_mov_b64 exec, -1
    ds_read_b64_tr_b16 v[60:61], v9 offset:2048
    ds_read_b64_tr_b16 v[62:63], v9 offset:3072
    v_mfma_f32_32x32x16_bf16 v[32:47], v[76:79], v[124:127], v[32:47]
D_p1:
    s_waitcnt vmcnt(5) lgkmcnt(0)
    v_mfma_f32_32x32x16_bf16 v[16:31], v[48:51], v[96:99], v[16:31]
    ds_read_b64_tr_b16 v[64:65], v8 offset:4096
    ds_read_b64_tr_b16 v[66:67], v8 offset:5120
    ds_read_b64_tr_b16 v[72:73], v9 offset:4096
    v_mfma_f32_32x32x16_bf16 v[32:47], v[56:59], v[96:99], v[32:47]
    ds_read_b64_tr_b16 v[74:75], v9 offset:5120
    ds_read_b64_tr_b16 v[68:69], v8 offset:6144
    ds_read_b64_tr_b16 v[70:71], v8 offset:7168
    v_mfma_f32_32x32x16_bf16 v[16:31], v[52:55], v[100:103], v[16:31]
    ds_read_b64_tr_b16 v[76:77], v9 offset:6144
    ds_read_b64_tr_b16 v[78:79], v9 offset:7168
    v_mfma_f32_32x32x16_bf16 v[32:47], v[60:63], v[100:103], v[32:47]
    s_waitcnt lgkmcnt(0)
    v_mfma_f32_32x32x16_bf16 v[16:31], v[64:67], v[104:107], v[16:31]
    v_add_u32 v8, s32, v5
    v_add_u32 v9, s32, v6
    ds_read_b64_tr_b16 v[48:49], v8 offset:0
    ds_read_b64_tr_b16 v[50:51], v8 offset:1024
    v_mfma_f32_32x32x16_bf16 v[32:47], v[72:75], v[104:107], v[32:47]
    ds_read_b64_tr_b16 v[56:57], v9 offset:0
    ds_read_b64_tr_b16 v[58:59], v9 offset:1024
    ds_read_b64_tr_b16 v[52:53], v8 offset:2048
    ds_read_b64_tr_b16 v[54:55], v8 offset:3072
    v_mfma_f32_32x32x16_bf16 v[16:31], v[68:71], v[108:111], v[16:31]
    ds_read_b64_tr_b16 v[60:61], v9 offset:2048
    ds_read_b64_tr_b16 v[62:63], v9 offset:3072
    v_mfma_f32_32x32x16_bf16 v[32:47], v[76:79], v[108:111], v[32:47]
D_p0:
    s_waitcnt vmcnt(1) lgkmcnt(0)
    v_mfma_f32_32x32x16_bf16 v[16:31], v[48:51], v[80:83], v[16:31]
    ds_read_b64_tr_b16 v[64:65], v8 offset:4096
    ds_read_b64_tr_b16 v[66:67], v8 offset:5120
    ds_read_b64_tr_b16 v[72:73], v9 offset:4096
    v_mfma_f32_32x32x16_bf16 v[32:47], v[56:59], v[80:83], v[32:47]
    ds_read_b64_tr_b16 v[74:75], v9 offset:5120
    ds_read_b64_tr_b16 v[68:69], v8 offset:6144
    ds_read_b64_tr_b16 v[70:71], v8 offset:7168
    v_mfma_f32_32x32x16_bf16 v[16:31], v[52:55], v[84:87], v[16:31]
    ds_read_b64_tr_b16 v[76:77], v9 offset:6144
    ds_read_b64_tr_b16 v[78:79], v9 offset:7168
    v_mfma_f32_32x32x16_bf16 v[32:47], v[60:63], v[84:87], v[32:47]
    s_waitcnt lgkmcnt(0)
    v_mfma_f32_32x32x16_bf16 v[16:31], v[64:67], v[88:91], v[16:31]
    v_mfma_f32_32x32x16_bf16 v[32:47], v[72:75], v[88:91], v[32:47]
    v_mfma_f32_32x32x16_bf16 v[16:31], v[68:71], v[92:95], v[16:31]
    v_mfma_f32_32x32x16_bf16 v[32:47], v[76:79], v[92:95], v[32:47]
    s_cmp_lg_u32 s66, 0
    s_cbranch_scc1 D_wait
D_end:
    v_and_b32 v8, 31, v2
    s_lshl_b32 s64, s6, 5
    v_add_u32 v8, s64, v8
    v_mul_u32_u24 v8, 272, v8
    v_lshrrev_b32 v9, 5, v2
    v_lshl_add_u32 v8, v9, 4, v8
    s_mul_i32 s64, s7, 34816
    s_add_u32 s64, s64, 8192
    v_add_u32 v8, s64, v8
    v_lshrrev_b32 v6, 3, v0
    v_mul_u32_u24 v5, 272, v6
    v_and_b32 v6, 7, v0
    v_lshl_add_u32 v5, v6, 5, v5
    v_add_u32 v5, 8192, v5
    v_lshlrev_b32 v9, 5, v6
    s_barrier
    ds_write_b128 v8, v[16:19] offset:0
    ds_write_b128 v8, v[20:23] offset:32
    ds_write_b128 v8, v[24:27] offset:64
    ds_write_b128 v8, v[28:31] offset:96
    ds_write_b128 v8, v[32:35] offset:128
    ds_write_b128 v8, v[36:39] offset:160
    ds_write_b128 v8, v[40:43] offset:192
    ds_write_b128 v8, v[44:47] offset:224
    s_lshr_b32 s64, s67, 7
    s_cmp_lg_u32 s64, s4
    s_cbranch_scc0 P2_y
P2_ny:
    s_waitcnt lgkmcnt(0)
    s_barrier
    ds_read_b128 v[64:67], v5 offset:0
    ds_read_b128 v[68:71], v5 offset:16
    ds_read_b128 v[72:75], v5 offset:34816
    ds_read_b128 v[76:79], v5 offset:34832
    ds_read_b128 v[80:83], v5 offset:17408
    ds_read_b128 v[84:87], v5 offset:17424
    ds_read_b128 v[88:91], v5 offset:52224
    ds_read_b128 v[92:95], v5 offset:52240
    v_add_u32 v9, 5632, v9
    s_mov_b32 s68, 131072
    v_add_u32 v6, 0, v230
    v_cmp_eq_u32 vcc, s67, v6
    s_cbranch_vccnz P2_nr_19_fix
P2_nr_19:
    s_waitcnt lgkmcnt(4)
    v_add_f32 v64, v64, v72
    v_add_f32 v65, v65, v73
    v_cvt_pk_bf16_f32 v116, v64, v65
    v_lshlrev_b32 v64, 16, v116
    v_and_b32 v65, 0xffff0000, v116
    v_mul_f32 v64, v64, v228
    v_mul_f32 v65, v65, v228
    v_cvt_pk_bf16_f32 v116, v64, v65
    v_lshlrev_b32 v64, 16, v116
    v_and_b32 v65, 0xffff0000, v116
    v_add_f32 v64, v64, v232
    v_add_f32 v65, v65, v233
    v_cvt_pk_bf16_f32 v120, v64, v65
    v_add_f32 v66, v66, v74
    v_add_f32 v67, v67, v75
    v_cvt_pk_bf16_f32 v116, v66, v67
    v_lshlrev_b32 v66, 16, v116
    v_and_b32 v67, 0xffff0000, v116
    v_mul_f32 v66, v66, v228
    v_mul_f32 v67, v67, v228
    v_cvt_pk_bf16_f32 v116, v66, v67
    v_lshlrev_b32 v66, 16, v116
    v_and_b32 v67, 0xffff0000, v116
    v_add_f32 v66, v66, v234
    v_add_f32 v67, v67, v235
    v_cvt_pk_bf16_f32 v121, v66, v67
    v_add_f32 v68, v68, v76
    v_add_f32 v69, v69, v77
    v_cvt_pk_bf16_f32 v116, v68, v69
    v_lshlrev_b32 v68, 16, v116
    v_and_b32 v69, 0xffff0000, v116
    v_mul_f32 v68, v68, v228
    v_mul_f32 v69, v69, v228
    v_cvt_pk_bf16_f32 v116, v68, v69
    v_lshlrev_b32 v68, 16, v116
    v_and_b32 v69, 0xffff0000, v116
    v_add_f32 v68, v68, v236
    v_add_f32 v69, v69, v237
    v_cvt_pk_bf16_f32 v122, v68, v69
    v_add_f32 v70, v70, v78
    v_add_f32 v71, v71, v79
    v_cvt_pk_bf16_f32 v116, v70, v71
    v_lshlrev_b32 v70, 16, v116
    v_and_b32 v71, 0xffff0000, v116
    v_mul_f32 v70, v70, v228
    v_mul_f32 v71, v71, v228
    v_cvt_pk_bf16_f32 v116, v70, v71
    v_lshlrev_b32 v70, 16, v116
    v_and_b32 v71, 0xffff0000, v116
    v_add_f32 v70, v70, v238
    v_add_f32 v71, v71, v239
    v_cvt_pk_bf16_f32 v123, v70, v71
    buffer_store_dwordx4 v[120:123], v231, s[20:23], 0 offen nt
    v_add_u32 v6, 64, v230
    v_cmp_eq_u32 vcc, s67, v6
    s_cbranch_vccnz P2_nr_20_fix
P2_nr_20:
    s_waitcnt lgkmcnt(0)
    v_add_f32 v80, v80, v88
    v_add_f32 v81, v81, v89
    v_cvt_pk_bf16_f32 v116, v80, v81
    v_lshlrev_b32 v80, 16, v116
    v_and_b32 v81, 0xffff0000, v116
    v_mul_f32 v80, v80, v229
    v_mul_f32 v81, v81, v229
    v_cvt_pk_bf16_f32 v116, v80, v81
    v_lshlrev_b32 v80, 16, v116
    v_and_b32 v81, 0xffff0000, v116
    v_add_f32 v80, v80, v240
    v_add_f32 v81, v81, v241
    v_cvt_pk_bf16_f32 v124, v80, v81
    v_add_f32 v82, v82, v90
    v_add_f32 v83, v83, v91
    v_cvt_pk_bf16_f32 v116, v82, v83
    v_lshlrev_b32 v82, 16, v116
    v_and_b32 v83, 0xffff0000, v116
    v_mul_f32 v82, v82, v229
    v_mul_f32 v83, v83, v229
    v_cvt_pk_bf16_f32 v116, v82, v83
    v_lshlrev_b32 v82, 16, v116
    v_and_b32 v83, 0xffff0000, v116
    v_add_f32 v82, v82, v242
    v_add_f32 v83, v83, v243
    v_cvt_pk_bf16_f32 v125, v82, v83
    v_add_f32 v84, v84, v92
    v_add_f32 v85, v85, v93
    v_cvt_pk_bf16_f32 v116, v84, v85
    v_lshlrev_b32 v84, 16, v116
    v_and_b32 v85, 0xffff0000, v116
    v_mul_f32 v84, v84, v229
    v_mul_f32 v85, v85, v229
    v_cvt_pk_bf16_f32 v116, v84, v85
    v_lshlrev_b32 v84, 16, v116
    v_and_b32 v85, 0xffff0000, v116
    v_add_f32 v84, v84, v244
    v_add_f32 v85, v85, v245
    v_cvt_pk_bf16_f32 v126, v84, v85
    v_add_f32 v86, v86, v94
    v_add_f32 v87, v87, v95
    v_cvt_pk_bf16_f32 v116, v86, v87
    v_lshlrev_b32 v86, 16, v116
    v_and_b32 v87, 0xffff0000, v116
    v_mul_f32 v86, v86, v229
    v_mul_f32 v87, v87, v229
    v_cvt_pk_bf16_f32 v116, v86, v87
    v_lshlrev_b32 v86, 16, v116
    v_and_b32 v87, 0xffff0000, v116
    v_add_f32 v86, v86, v246
    v_add_f32 v87, v87, v247
    v_cvt_pk_bf16_f32 v127, v86, v87
    buffer_store_dwordx4 v[124:127], v231, s[20:23], s68 offen nt
K_end:
    s_endpgm
G_f15:
    s_bitset1_b32 s66, s55
    s_branch G_q15
G_f14:
    s_bitset1_b32 s66, s54
    s_branch G_q14
G_f13:
    s_bitset1_b32 s66, s53
    s_branch G_q13
G_f12:
    s_bitset1_b32 s66, s52
    s_branch G_q12
G_f11:
    s_bitset1_b32 s66, s51
    s_branch G_q11
G_f10:
    s_bitset1_b32 s66, s50
    s_branch G_q10
G_f9:
    s_bitset1_b32 s66, s49
    s_branch G_q9
G_f8:
    s_bitset1_b32 s66, s48
    s_branch G_q8
G_f7:
    s_bitset1_b32 s66, s47
    s_branch G_q7
G_f6:
    s_bitset1_b32 s66, s46
    s_branch G_q6
G_f5:
    s_bitset1_b32 s66, s45
    s_branch G_q5
G_f4:
    s_bitset1_b32 s66, s44
    s_branch G_q4
G_f3:
    s_bitset1_b32 s66, s43
    s_branch G_q3
G_f2:
    s_bitset1_b32 s66, s42
    s_branch G_q2
G_f1:
    s_bitset1_b32 s66, s41
    s_branch G_q1
G_f0:
    s_bitset1_b32 s66, s40
    s_branch G_q0
phi_15_fix:
    v_lshlrev_b32 v48, 16, v16
    v_and_b32 v49, 0xffff0000, v16
    v_add_f32 v48, s73, v48
    v_add_f32 v49, s73, v49
    v_cvt_pk_bf16_f32 v16, v48, v49
    v_lshlrev_b32 v48, 16, v17
    v_and_b32 v49, 0xffff0000, v17
    v_add_f32 v48, s73, v48
    v_add_f32 v49, s73, v49
    v_cvt_pk_bf16_f32 v17, v48, v49
    v_lshlrev_b32 v48, 16, v18
    v_and_b32 v49, 0xffff0000, v18
    v_add_f32 v48, s73, v48
    v_add_f32 v49, s73, v49
    v_cvt_pk_bf16_f32 v18, v48, v49
    v_lshlrev_b32 v48, 16, v19
    v_and_b32 v49, 0xffff0000, v19
    v_add_f32 v48, s73, v48
    v_add_f32 v49, s73, v49
    v_cvt_pk_bf16_f32 v19, v48, v49
    v_lshlrev_b32 v48, 16, v20
    v_and_b32 v49, 0xffff0000, v20
    v_add_f32 v48, s73, v48
    v_add_f32 v49, s73, v49
    v_cvt_pk_bf16_f32 v20, v48, v49
    v_lshlrev_b32 v48, 16, v21
    v_and_b32 v49, 0xffff0000, v21
    v_add_f32 v48, s73, v48
    v_add_f32 v49, s73, v49
    v_cvt_pk_bf16_f32 v21, v48, v49
    v_lshlrev_b32 v48, 16, v22
    v_and_b32 v49, 0xffff0000, v22
    v_add_f32 v48, s73, v48
    v_add_f32 v49, s73, v49
    v_cvt_pk_bf16_f32 v22, v48, v49
    v_lshlrev_b32 v48, 16, v23
    v_and_b32 v49, 0xffff0000, v23
    v_add_f32 v48, s73, v48
    v_add_f32 v49, s73, v49
    v_cvt_pk_bf16_f32 v23, v48, v49
    s_branch phi_15_done
phi_16_fix:
    v_lshlrev_b32 v48, 16, v24
    v_and_b32 v49, 0xffff0000, v24
    v_add_f32 v48, s73, v48
    v_add_f32 v49, s73, v49
    v_cvt_pk_bf16_f32 v24, v48, v49
    v_lshlrev_b32 v48, 16, v25
    v_and_b32 v49, 0xffff0000, v25
    v_add_f32 v48, s73, v48
    v_add_f32 v49, s73, v49
    v_cvt_pk_bf16_f32 v25, v48, v49
    v_lshlrev_b32 v48, 16, v26
    v_and_b32 v49, 0xffff0000, v26
    v_add_f32 v48, s73, v48
    v_add_f32 v49, s73, v49
    v_cvt_pk_bf16_f32 v26, v48, v49
    v_lshlrev_b32 v48, 16, v27
    v_and_b32 v49, 0xffff0000, v27
    v_add_f32 v48, s73, v48
    v_add_f32 v49, s73, v49
    v_cvt_pk_bf16_f32 v27, v48, v49
    v_lshlrev_b32 v48, 16, v28
    v_and_b32 v49, 0xffff0000, v28
    v_add_f32 v48, s73, v48
    v_add_f32 v49, s73, v49
    v_cvt_pk_bf16_f32 v28, v48, v49
    v_lshlrev_b32 v48, 16, v29
    v_and_b32 v49, 0xffff0000, v29
    v_add_f32 v48, s73, v48
    v_add_f32 v49, s73, v49
    v_cvt_pk_bf16_f32 v29, v48, v49
    v_lshlrev_b32 v48, 16, v30
    v_and_b32 v49, 0xffff0000, v30
    v_add_f32 v48, s73, v48
    v_add_f32 v49, s73, v49
    v_cvt_pk_bf16_f32 v30, v48, v49
    v_lshlrev_b32 v48, 16, v31
    v_and_b32 v49, 0xffff0000, v31
    v_add_f32 v48, s73, v48
    v_add_f32 v49, s73, v49
    v_cvt_pk_bf16_f32 v31, v48, v49
    s_branch phi_16_done
phi_17_fix:
    v_lshlrev_b32 v48, 16, v32
    v_and_b32 v49, 0xffff0000, v32
    v_add_f32 v48, s73, v48
    v_add_f32 v49, s73, v49
    v_cvt_pk_bf16_f32 v32, v48, v49
    v_lshlrev_b32 v48, 16, v33
    v_and_b32 v49, 0xffff0000, v33
    v_add_f32 v48, s73, v48
    v_add_f32 v49, s73, v49
    v_cvt_pk_bf16_f32 v33, v48, v49
    v_lshlrev_b32 v48, 16, v34
    v_and_b32 v49, 0xffff0000, v34
    v_add_f32 v48, s73, v48
    v_add_f32 v49, s73, v49
    v_cvt_pk_bf16_f32 v34, v48, v49
    v_lshlrev_b32 v48, 16, v35
    v_and_b32 v49, 0xffff0000, v35
    v_add_f32 v48, s73, v48
    v_add_f32 v49, s73, v49
    v_cvt_pk_bf16_f32 v35, v48, v49
    v_lshlrev_b32 v48, 16, v36
    v_and_b32 v49, 0xffff0000, v36
    v_add_f32 v48, s73, v48
    v_add_f32 v49, s73, v49
    v_cvt_pk_bf16_f32 v36, v48, v49
    v_lshlrev_b32 v48, 16, v37
    v_and_b32 v49, 0xffff0000, v37
    v_add_f32 v48, s73, v48
    v_add_f32 v49, s73, v49
    v_cvt_pk_bf16_f32 v37, v48, v49
    v_lshlrev_b32 v48, 16, v38
    v_and_b32 v49, 0xffff0000, v38
    v_add_f32 v48, s73, v48
    v_add_f32 v49, s73, v49
    v_cvt_pk_bf16_f32 v38, v48, v49
    v_lshlrev_b32 v48, 16, v39
    v_and_b32 v49, 0xffff0000, v39
    v_add_f32 v48, s73, v48
    v_add_f32 v49, s73, v49
    v_cvt_pk_bf16_f32 v39, v48, v49
    s_branch phi_17_done
phi_18_fix:
    v_lshlrev_b32 v48, 16, v40
    v_and_b32 v49, 0xffff0000, v40
    v_add_f32 v48, s73, v48
    v_add_f32 v49, s73, v49
    v_cvt_pk_bf16_f32 v40, v48, v49
    v_lshlrev_b32 v48, 16, v41
    v_and_b32 v49, 0xffff0000, v41
    v_add_f32 v48, s73, v48
    v_add_f32 v49, s73, v49
    v_cvt_pk_bf16_f32 v41, v48, v49
    v_lshlrev_b32 v48, 16, v42
    v_and_b32 v49, 0xffff0000, v42
    v_add_f32 v48, s73, v48
    v_add_f32 v49, s73, v49
    v_cvt_pk_bf16_f32 v42, v48, v49
    v_lshlrev_b32 v48, 16, v43
    v_and_b32 v49, 0xffff0000, v43
    v_add_f32 v48, s73, v48
    v_add_f32 v49, s73, v49
    v_cvt_pk_bf16_f32 v43, v48, v49
    v_lshlrev_b32 v48, 16, v44
    v_and_b32 v49, 0xffff0000, v44
    v_add_f32 v48, s73, v48
    v_add_f32 v49, s73, v49
    v_cvt_pk_bf16_f32 v44, v48, v49
    v_lshlrev_b32 v48, 16, v45
    v_and_b32 v49, 0xffff0000, v45
    v_add_f32 v48, s73, v48
    v_add_f32 v49, s73, v49
    v_cvt_pk_bf16_f32 v45, v48, v49
    v_lshlrev_b32 v48, 16, v46
    v_and_b32 v49, 0xffff0000, v46
    v_add_f32 v48, s73, v48
    v_add_f32 v49, s73, v49
    v_cvt_pk_bf16_f32 v46, v48, v49
    v_lshlrev_b32 v48, 16, v47
    v_and_b32 v49, 0xffff0000, v47
    v_add_f32 v48, s73, v48
    v_add_f32 v49, s73, v49
    v_cvt_pk_bf16_f32 v47, v48, v49
    s_branch phi_18_done
P2_yl:
    s_lshl_b32 s64, s5, 8
    s_lshl_b32 s69, s3, 15
    s_add_u32 s64, s64, s69
    s_add_u32 s64, s64, 6447104
    v_lshlrev_b32 v13, 2, v2
    v_add_u32 v13, s64, v13
    s_mov_b32 s69, 0
    buffer_load_dword v208, v13, s[16:19], s69 offen sc1
    s_mov_b32 s69, 4096
    buffer_load_dword v209, v13, s[16:19], s69 offen sc1
    s_mov_b32 s69, 8192
    buffer_load_dword v210, v13, s[16:19], s69 offen sc1
    s_mov_b32 s69, 12288
    buffer_load_dword v211, v13, s[16:19], s69 offen sc1
    s_mov_b32 s69, 16384
    buffer_load_dword v212, v13, s[16:19], s69 offen sc1
    s_mov_b32 s69, 20480
    buffer_load_dword v213, v13, s[16:19], s69 offen sc1
    s_mov_b32 s69, 24576
    buffer_load_dword v214, v13, s[16:19], s69 offen sc1
    s_mov_b32 s69, 28672
    buffer_load_dword v215, v13, s[16:19], s69 offen sc1
    s_branch P2_nyl
P2_y:
    s_mov_b32 s66, 0
P2_ychk:
    s_waitcnt vmcnt(0)
    v_max3_u32 v10, v208, v209, v210
    v_max3_u32 v10, v211, v212, v10
    v_max3_u32 v10, v213, v214, v10
    v_max_u32 v10, v215, v10
    v_cmp_eq_u32 vcc, -1, v10
    s_cbranch_vccz P2_yok
    s_add_u32 s66, s66, 1
    s_cmp_ge_u32 s66, 100000
    s_cbranch_scc1 P2_yok
    s_sleep 4
    s_mov_b32 s65, 0
    buffer_load_dword v208, v13, s[16:19], s65 offen sc1
    s_mov_b32 s65, 4096
    buffer_load_dword v209, v13, s[16:19], s65 offen sc1
    s_mov_b32 s65, 8192
    buffer_load_dword v210, v13, s[16:19], s65 offen sc1
    s_mov_b32 s65, 12288
    buffer_load_dword v211, v13, s[16:19], s65 offen sc1
    s_mov_b32 s65, 16384
    buffer_load_dword v212, v13, s[16:19], s65 offen sc1
    s_mov_b32 s65, 20480
    buffer_load_dword v213, v13, s[16:19], s65 offen sc1
    s_mov_b32 s65, 24576
    buffer_load_dword v214, v13, s[16:19], s65 offen sc1
    s_mov_b32 s65, 28672
    buffer_load_dword v215, v13, s[16:19], s65 offen sc1
    s_branch P2_ychk
P2_yok:
    v_add_f32 v208, v208, v209
    v_add_f32 v208, v208, v210
    v_add_f32 v208, v208, v211
    v_add_f32 v208, v208, v212
    v_add_f32 v208, v208, v213
    v_add_f32 v208, v208, v214
    v_add_f32 v208, v208, v215
    v_lshlrev_b32 v7, 2, v2
    s_lshl_b32 s64, s3, 8
    v_add_u32 v7, s64, v7
    v_add_u32 v7, 5632, v7
    ds_write_b32 v7, v208
    s_branch P2_ny
P2_nr_19_fix:
    s_and_saveexec_b64 s[70:71], vcc
    ds_read_b128 v[128:131], v9 offset:0
    ds_read_b128 v[132:135], v9 offset:16
    ds_read_b128 v[136:139], v9 offset:256
    ds_read_b128 v[140:143], v9 offset:272
    ds_read_b128 v[144:147], v9 offset:512
    ds_read_b128 v[148:151], v9 offset:528
    ds_read_b128 v[152:155], v9 offset:768
    ds_read_b128 v[156:159], v9 offset:784
    ds_read_b128 v[160:163], v9 offset:1024
    ds_read_b128 v[164:167], v9 offset:1040
    ds_read_b128 v[168:171], v9 offset:1280
    ds_read_b128 v[172:175], v9 offset:1296
    ds_read_b128 v[176:179], v9 offset:1536
    ds_read_b128 v[180:183], v9 offset:1552
    ds_read_b128 v[184:187], v9 offset:1792
    ds_read_b128 v[188:191], v9 offset:1808
    s_and_b32 s64, s75, 0xffff0000
    s_xor_b32 s65, s64, 0x80000000
    s_not_b32 s66, s64
    s_and_b32 s66, s66, 0xffff0000
    s_cmp_ge_u32 s64, 0x80000000
    s_cselect_b32 s64, s65, s66
    v_mov_b32 v100, s64
    v_mul_f32 v100, s72, v100
    v_exp_f32 v100, -v100
    s_nop 0
    v_add_f32 v100, 1.0, v100
    v_rcp_f32 v100, v100
    s_nop 0
    v_cvt_pk_bf16_f32 v100, v100, v100
    v_lshlrev_b32 v100, 16, v100
    s_waitcnt lgkmcnt(0)
    v_add_f32 v128, v128, v136
    v_add_f32 v129, v129, v137
    v_add_f32 v130, v130, v138
    v_add_f32 v131, v131, v139
    v_add_f32 v132, v132, v140
    v_add_f32 v133, v133, v141
    v_add_f32 v134, v134, v142
    v_add_f32 v135, v135, v143
    v_add_f32 v128, v128, v144
    v_add_f32 v129, v129, v145
    v_add_f32 v130, v130, v146
    v_add_f32 v131, v131, v147
    v_add_f32 v132, v132, v148
    v_add_f32 v133, v133, v149
    v_add_f32 v134, v134, v150
    v_add_f32 v135, v135, v151
    v_add_f32 v128, v128, v152
    v_add_f32 v129, v129, v153
    v_add_f32 v130, v130, v154
    v_add_f32 v131, v131, v155
    v_add_f32 v132, v132, v156
    v_add_f32 v133, v133, v157
    v_add_f32 v134, v134, v158
    v_add_f32 v135, v135, v159
    v_add_f32 v128, v128, v160
    v_add_f32 v129, v129, v161
    v_add_f32 v130, v130, v162
    v_add_f32 v131, v131, v163
    v_add_f32 v132, v132, v164
    v_add_f32 v133, v133, v165
    v_add_f32 v134, v134, v166
    v_add_f32 v135, v135, v167
    v_add_f32 v128, v128, v168
    v_add_f32 v129, v129, v169
    v_add_f32 v130, v130, v170
    v_add_f32 v131, v131, v171
    v_add_f32 v132, v132, v172
    v_add_f32 v133, v133, v173
    v_add_f32 v134, v134, v174
    v_add_f32 v135, v135, v175
    v_add_f32 v128, v128, v176
    v_add_f32 v129, v129, v177
    v_add_f32 v130, v130, v178
    v_add_f32 v131, v131, v179
    v_add_f32 v132, v132, v180
    v_add_f32 v133, v133, v181
    v_add_f32 v134, v134, v182
    v_add_f32 v135, v135, v183
    v_add_f32 v128, v128, v184
    v_add_f32 v129, v129, v185
    v_add_f32 v130, v130, v186
    v_add_f32 v131, v131, v187
    v_add_f32 v132, v132, v188
    v_add_f32 v133, v133, v189
    v_add_f32 v134, v134, v190
    v_add_f32 v135, v135, v191
    v_cvt_pk_bf16_f32 v116, v128, v129
    v_lshlrev_b32 v128, 16, v116
    v_and_b32 v129, 0xffff0000, v116
    v_mul_f32 v128, v128, v100
    v_mul_f32 v129, v129, v100
    v_cvt_pk_bf16_f32 v116, v128, v129
    v_lshlrev_b32 v128, 16, v116
    v_and_b32 v129, 0xffff0000, v116
    v_lshlrev_b32 v232, 16, v220
    v_and_b32 v233, 0xffff0000, v220
    v_add_f32 v232, v232, v128
    v_add_f32 v233, v233, v129
    v_cvt_pk_bf16_f32 v116, v232, v233
    v_lshlrev_b32 v232, 16, v116
    v_and_b32 v233, 0xffff0000, v116
    v_mul_f32 v232, v232, v248
    v_mul_f32 v233, v233, v248
    v_cvt_pk_bf16_f32 v116, v232, v233
    v_lshlrev_b32 v232, 16, v116
    v_and_b32 v233, 0xffff0000, v116
    v_cvt_pk_bf16_f32 v116, v130, v131
    v_lshlrev_b32 v130, 16, v116
    v_and_b32 v131, 0xffff0000, v116
    v_mul_f32 v130, v130, v100
    v_mul_f32 v131, v131, v100
    v_cvt_pk_bf16_f32 v116, v130, v131
    v_lshlrev_b32 v130, 16, v116
    v_and_b32 v131, 0xffff0000, v116
    v_lshlrev_b32 v234, 16, v221
    v_and_b32 v235, 0xffff0000, v221
    v_add_f32 v234, v234, v130
    v_add_f32 v235, v235, v131
    v_cvt_pk_bf16_f32 v116, v234, v235
    v_lshlrev_b32 v234, 16, v116
    v_and_b32 v235, 0xffff0000, v116
    v_mul_f32 v234, v234, v248
    v_mul_f32 v235, v235, v248
    v_cvt_pk_bf16_f32 v116, v234, v235
    v_lshlrev_b32 v234, 16, v116
    v_and_b32 v235, 0xffff0000, v116
    v_cvt_pk_bf16_f32 v116, v132, v133
    v_lshlrev_b32 v132, 16, v116
    v_and_b32 v133, 0xffff0000, v116
    v_mul_f32 v132, v132, v100
    v_mul_f32 v133, v133, v100
    v_cvt_pk_bf16_f32 v116, v132, v133
    v_lshlrev_b32 v132, 16, v116
    v_and_b32 v133, 0xffff0000, v116
    v_lshlrev_b32 v236, 16, v222
    v_and_b32 v237, 0xffff0000, v222
    v_add_f32 v236, v236, v132
    v_add_f32 v237, v237, v133
    v_cvt_pk_bf16_f32 v116, v236, v237
    v_lshlrev_b32 v236, 16, v116
    v_and_b32 v237, 0xffff0000, v116
    v_mul_f32 v236, v236, v248
    v_mul_f32 v237, v237, v248
    v_cvt_pk_bf16_f32 v116, v236, v237
    v_lshlrev_b32 v236, 16, v116
    v_and_b32 v237, 0xffff0000, v116
    v_cvt_pk_bf16_f32 v116, v134, v135
    v_lshlrev_b32 v134, 16, v116
    v_and_b32 v135, 0xffff0000, v116
    v_mul_f32 v134, v134, v100
    v_mul_f32 v135, v135, v100
    v_cvt_pk_bf16_f32 v116, v134, v135
    v_lshlrev_b32 v134, 16, v116
    v_and_b32 v135, 0xffff0000, v116
    v_lshlrev_b32 v238, 16, v223
    v_and_b32 v239, 0xffff0000, v223
    v_add_f32 v238, v238, v134
    v_add_f32 v239, v239, v135
    v_cvt_pk_bf16_f32 v116, v238, v239
    v_lshlrev_b32 v238, 16, v116
    v_and_b32 v239, 0xffff0000, v116
    v_mul_f32 v238, v238, v248
    v_mul_f32 v239, v239, v248
    v_cvt_pk_bf16_f32 v116, v238, v239
    v_lshlrev_b32 v238, 16, v116
    v_and_b32 v239, 0xffff0000, v116
    s_mov_b64 exec, s[70:71]
    s_branch P2_nr_19
P2_nr_20_fix:
    s_and_saveexec_b64 s[70:71], vcc
    ds_read_b128 v[128:131], v9 offset:0
    ds_read_b128 v[132:135], v9 offset:16
    ds_read_b128 v[136:139], v9 offset:256
    ds_read_b128 v[140:143], v9 offset:272
    ds_read_b128 v[144:147], v9 offset:512
    ds_read_b128 v[148:151], v9 offset:528
    ds_read_b128 v[152:155], v9 offset:768
    ds_read_b128 v[156:159], v9 offset:784
    ds_read_b128 v[160:163], v9 offset:1024
    ds_read_b128 v[164:167], v9 offset:1040
    ds_read_b128 v[168:171], v9 offset:1280
    ds_read_b128 v[172:175], v9 offset:1296
    ds_read_b128 v[176:179], v9 offset:1536
    ds_read_b128 v[180:183], v9 offset:1552
    ds_read_b128 v[184:187], v9 offset:1792
    ds_read_b128 v[188:191], v9 offset:1808
    s_and_b32 s64, s75, 0xffff0000
    s_xor_b32 s65, s64, 0x80000000
    s_not_b32 s66, s64
    s_and_b32 s66, s66, 0xffff0000
    s_cmp_ge_u32 s64, 0x80000000
    s_cselect_b32 s64, s65, s66
    v_mov_b32 v100, s64
    v_mul_f32 v100, s72, v100
    v_exp_f32 v100, -v100
    s_nop 0
    v_add_f32 v100, 1.0, v100
    v_rcp_f32 v100, v100
    s_nop 0
    v_cvt_pk_bf16_f32 v100, v100, v100
    v_lshlrev_b32 v100, 16, v100
    s_waitcnt lgkmcnt(0)
    v_add_f32 v128, v128, v136
    v_add_f32 v129, v129, v137
    v_add_f32 v130, v130, v138
    v_add_f32 v131, v131, v139
    v_add_f32 v132, v132, v140
    v_add_f32 v133, v133, v141
    v_add_f32 v134, v134, v142
    v_add_f32 v135, v135, v143
    v_add_f32 v128, v128, v144
    v_add_f32 v129, v129, v145
    v_add_f32 v130, v130, v146
    v_add_f32 v131, v131, v147
    v_add_f32 v132, v132, v148
    v_add_f32 v133, v133, v149
    v_add_f32 v134, v134, v150
    v_add_f32 v135, v135, v151
    v_add_f32 v128, v128, v152
    v_add_f32 v129, v129, v153
    v_add_f32 v130, v130, v154
    v_add_f32 v131, v131, v155
    v_add_f32 v132, v132, v156
    v_add_f32 v133, v133, v157
    v_add_f32 v134, v134, v158
    v_add_f32 v135, v135, v159
    v_add_f32 v128, v128, v160
    v_add_f32 v129, v129, v161
    v_add_f32 v130, v130, v162
    v_add_f32 v131, v131, v163
    v_add_f32 v132, v132, v164
    v_add_f32 v133, v133, v165
    v_add_f32 v134, v134, v166
    v_add_f32 v135, v135, v167
    v_add_f32 v128, v128, v168
    v_add_f32 v129, v129, v169
    v_add_f32 v130, v130, v170
    v_add_f32 v131, v131, v171
    v_add_f32 v132, v132, v172
    v_add_f32 v133, v133, v173
    v_add_f32 v134, v134, v174
    v_add_f32 v135, v135, v175
    v_add_f32 v128, v128, v176
    v_add_f32 v129, v129, v177
    v_add_f32 v130, v130, v178
    v_add_f32 v131, v131, v179
    v_add_f32 v132, v132, v180
    v_add_f32 v133, v133, v181
    v_add_f32 v134, v134, v182
    v_add_f32 v135, v135, v183
    v_add_f32 v128, v128, v184
    v_add_f32 v129, v129, v185
    v_add_f32 v130, v130, v186
    v_add_f32 v131, v131, v187
    v_add_f32 v132, v132, v188
    v_add_f32 v133, v133, v189
    v_add_f32 v134, v134, v190
    v_add_f32 v135, v135, v191
    v_cvt_pk_bf16_f32 v116, v128, v129
    v_lshlrev_b32 v128, 16, v116
    v_and_b32 v129, 0xffff0000, v116
    v_mul_f32 v128, v128, v100
    v_mul_f32 v129, v129, v100
    v_cvt_pk_bf16_f32 v116, v128, v129
    v_lshlrev_b32 v128, 16, v116
    v_and_b32 v129, 0xffff0000, v116
    v_lshlrev_b32 v240, 16, v224
    v_and_b32 v241, 0xffff0000, v224
    v_add_f32 v240, v240, v128
    v_add_f32 v241, v241, v129
    v_cvt_pk_bf16_f32 v116, v240, v241
    v_lshlrev_b32 v240, 16, v116
    v_and_b32 v241, 0xffff0000, v116
    v_mul_f32 v240, v240, v249
    v_mul_f32 v241, v241, v249
    v_cvt_pk_bf16_f32 v116, v240, v241
    v_lshlrev_b32 v240, 16, v116
    v_and_b32 v241, 0xffff0000, v116
    v_cvt_pk_bf16_f32 v116, v130, v131
    v_lshlrev_b32 v130, 16, v116
    v_and_b32 v131, 0xffff0000, v116
    v_mul_f32 v130, v130, v100
    v_mul_f32 v131, v131, v100
    v_cvt_pk_bf16_f32 v116, v130, v131
    v_lshlrev_b32 v130, 16, v116
    v_and_b32 v131, 0xffff0000, v116
    v_lshlrev_b32 v242, 16, v225
    v_and_b32 v243, 0xffff0000, v225
    v_add_f32 v242, v242, v130
    v_add_f32 v243, v243, v131
    v_cvt_pk_bf16_f32 v116, v242, v243
    v_lshlrev_b32 v242, 16, v116
    v_and_b32 v243, 0xffff0000, v116
    v_mul_f32 v242, v242, v249
    v_mul_f32 v243, v243, v249
    v_cvt_pk_bf16_f32 v116, v242, v243
    v_lshlrev_b32 v242, 16, v116
    v_and_b32 v243, 0xffff0000, v116
    v_cvt_pk_bf16_f32 v116, v132, v133
    v_lshlrev_b32 v132, 16, v116
    v_and_b32 v133, 0xffff0000, v116
    v_mul_f32 v132, v132, v100
    v_mul_f32 v133, v133, v100
    v_cvt_pk_bf16_f32 v116, v132, v133
    v_lshlrev_b32 v132, 16, v116
    v_and_b32 v133, 0xffff0000, v116
    v_lshlrev_b32 v244, 16, v226
    v_and_b32 v245, 0xffff0000, v226
    v_add_f32 v244, v244, v132
    v_add_f32 v245, v245, v133
    v_cvt_pk_bf16_f32 v116, v244, v245
    v_lshlrev_b32 v244, 16, v116
    v_and_b32 v245, 0xffff0000, v116
    v_mul_f32 v244, v244, v249
    v_mul_f32 v245, v245, v249
    v_cvt_pk_bf16_f32 v116, v244, v245
    v_lshlrev_b32 v244, 16, v116
    v_and_b32 v245, 0xffff0000, v116
    v_cvt_pk_bf16_f32 v116, v134, v135
    v_lshlrev_b32 v134, 16, v116
    v_and_b32 v135, 0xffff0000, v116
    v_mul_f32 v134, v134, v100
    v_mul_f32 v135, v135, v100
    v_cvt_pk_bf16_f32 v116, v134, v135
    v_lshlrev_b32 v134, 16, v116
    v_and_b32 v135, 0xffff0000, v116
    v_lshlrev_b32 v246, 16, v227
    v_and_b32 v247, 0xffff0000, v227
    v_add_f32 v246, v246, v134
    v_add_f32 v247, v247, v135
    v_cvt_pk_bf16_f32 v116, v246, v247
    v_lshlrev_b32 v246, 16, v116
    v_and_b32 v247, 0xffff0000, v116
    v_mul_f32 v246, v246, v249
    v_mul_f32 v247, v247, v249
    v_cvt_pk_bf16_f32 v116, v246, v247
    v_lshlrev_b32 v246, 16, v116
    v_and_b32 v247, 0xffff0000, v116
    s_mov_b64 exec, s[70:71]
    s_branch P2_nr_20
CODE_END:
.section .rodata,"a"
.p2align 6
.amdhsa_kernel gated_mix__linear_attn_block__moe_arch_mod__prompt_kernel
  .amdhsa_next_free_vgpr 256
  .amdhsa_next_free_sgpr 102
  .amdhsa_accum_offset 256
  .amdhsa_group_segment_fixed_size 0
  .amdhsa_kernarg_size 96
  .amdhsa_user_sgpr_count 2
  .amdhsa_user_sgpr_kernarg_segment_ptr 1
  .amdhsa_system_sgpr_workgroup_id_x 1
.end_amdhsa_kernel
```

```asm
; @launch grid=(256,1,1) block=(512,1,1) lds=163840
.amdgcn_target "amdgcn-amd-amdhsa--gfx950"
.text
.globl gated_mix__linear_attn_block__moe_arch_mod__prompt_kernel
.p2align 8
.type gated_mix__linear_attn_block__moe_arch_mod__prompt_kernel,@function
gated_mix__linear_attn_block__moe_arch_mod__prompt_kernel:
    s_load_dwordx16 s[40:55], s[0:1], 0
    s_load_dwordx8 s[56:63], s[0:1], 64
    s_cmp_ge_u32 s2, 256
    s_cbranch_scc1 K_end
    v_lshrrev_b32 v1, 6, v0
    v_and_b32 v2, 63, v0
    s_and_b32 s6, s2, 7
    v_readfirstlane_b32 s3, v1
    s_lshr_b32 s7, s2, 3
    s_and_b32 s4, s6, 1
    s_lshl_b32 s4, s4, 3
    s_and_b32 s64, s7, 7
    s_add_u32 s4, s4, s64
    s_lshr_b32 s5, s6, 1
    s_lshl_b32 s5, s5, 2
    s_lshr_b32 s64, s7, 3
    s_add_u32 s5, s5, s64
    s_lshl_b32 s74, s4, 1
    v_lshrrev_b32 v6, 3, v2
    s_lshl_b32 s65, s3, 3
    v_add_u32 v6, s65, v6
    s_lshl_b32 s64, s4, 7
    v_add_u32 v7, s64, v6
    v_lshlrev_b32 v7, 11, v7
    v_lshrrev_b32 v8, 4, v2
    s_and_b32 s64, s3, 1
    s_lshl_b32 s64, s64, 2
    v_add_u32 v9, s64, v8
    v_and_b32 v10, 7, v2
    v_xor_b32 v9, v9, v10
    v_lshl_add_u32 v7, v9, 4, v7
    v_mul_u32_u24 v6, 6144, v6
    v_and_b32 v9, 1, v8
    s_lshr_b32 s64, s64, 1
    v_lshl_add_u32 v9, v9, 2, s64
    v_xor_b32 v9, v9, v10
    v_lshl_add_u32 v6, v9, 4, v6
    s_lshl_b32 s64, s5, 7
    v_add_u32 v6, s64, v6
    s_lshl_b32 s66, s3, 10
    s_mov_b32 s10, 4194304
    s_mov_b32 s11, 0x00020000
    s_mov_b32 s14, 6291456
    s_mov_b32 s15, 0x00020000
    s_add_u32 s65, s74, 0
    s_and_b32 s65, s65, 15
    s_lshl_b32 s67, s65, 7
    s_mul_i32 s65, s65, 393216
    s_waitcnt lgkmcnt(0)
    s_mov_b32 s8, s40
    s_mov_b32 s9, s41
    s_mov_b32 s12, s42
    s_mov_b32 s13, s43
    s_add_u32 m0, s66, 8192
    s_add_u32 s64, s67, 0
    buffer_load_dwordx4 v7, s[8:11], s64 offen lds
    s_add_u32 m0, s66, 16384
    s_add_u32 s64, s67, 131072
    buffer_load_dwordx4 v7, s[8:11], s64 offen lds
    s_add_u32 m0, s66, 24576
    s_add_u32 s64, s65, 0
    buffer_load_dwordx4 v6, s[12:15], s64 offen lds
    s_add_u32 m0, s66, 32768
    s_add_u32 s64, s65, 2048
    buffer_load_dwordx4 v6, s[12:15], s64 offen lds
    s_add_u32 m0, s66, 40960
    s_add_u32 s64, s65, 4096
    buffer_load_dwordx4 v6, s[12:15], s64 offen lds
    s_barrier
    s_mov_b32 s72, 0x3fb8aa3b
    s_mov_b32 s73, 0x358637bd
    s_mov_b32 s16, s62
    s_mov_b32 s17, s63
    s_mov_b32 s18, 0x10000000
    s_mov_b32 s19, 0x00020000
    s_cmp_lt_u32 s3, 4
    s_cbranch_scc1 C_start
    s_sub_u32 s6, s3, 4
    s_lshl_b32 s7, s6, 10
    v_lshrrev_b32 v6, 3, v2
    s_lshl_b32 s64, s4, 7
    s_lshl_b32 s65, s6, 3
    s_add_u32 s64, s64, s65
    v_add_u32 v7, s64, v6
    v_lshlrev_b32 v7, 11, v7
    s_and_b32 s64, s6, 1
    s_lshl_b32 s64, s64, 2
    v_add_u32 v9, s64, v8
    v_xor_b32 v9, v9, v10
    v_lshl_add_u32 v4, v9, 4, v7
    v_add_u32 v7, s65, v6
    v_mul_u32_u24 v7, 6144, v7
    v_and_b32 v9, 1, v8
    s_lshr_b32 s64, s64, 1
    v_lshl_add_u32 v9, v9, 2, s64
    v_xor_b32 v9, v9, v10
    v_lshl_add_u32 v7, v9, 4, v7
    s_lshl_b32 s64, s5, 7
    v_add_u32 v5, s64, v7
    v_lshlrev_b32 v6, 4, v2
    s_and_b32 s64, s2, 1
    s_lshl_b32 s68, s64, 10
    s_bfe_u32 s64, s2, 0x20001
    s_lshl_b32 s64, s64, 8
    s_add_u32 s68, s68, s64
    s_and_b32 s64, s2, 0xf8
    s_add_u32 s68, s68, s64
    s_lshl_b32 s64, s6, 1
    s_add_u32 s68, s68, s64
    s_lshl_b32 s64, s68, 11
    v_add_u32 v13, s64, v6
    s_add_u32 s41, s74, 1
    s_and_b32 s41, s41, 15
    s_lshl_b32 s42, s41, 7
    s_mul_i32 s41, s41, 393216
    s_add_u32 m0, s7, 49152
    s_add_u32 s40, s42, 0
    buffer_load_dwordx4 v4, s[8:11], s40 offen lds
    s_add_u32 m0, s7, 53248
    s_add_u32 s40, s42, 65536
    buffer_load_dwordx4 v4, s[8:11], s40 offen lds
    s_add_u32 m0, s7, 57344
    s_add_u32 s40, s42, 131072
    buffer_load_dwordx4 v4, s[8:11], s40 offen lds
    s_add_u32 m0, s7, 61440
    s_add_u32 s40, s42, 196608
    buffer_load_dwordx4 v4, s[8:11], s40 offen lds
    s_add_u32 m0, s7, 65536
    s_add_u32 s40, s41, 0
    buffer_load_dwordx4 v5, s[12:15], s40 offen lds
    s_add_u32 m0, s7, 69632
    s_add_u32 s40, s41, 196608
    buffer_load_dwordx4 v5, s[12:15], s40 offen lds
    s_add_u32 m0, s7, 73728
    s_add_u32 s40, s41, 2048
    buffer_load_dwordx4 v5, s[12:15], s40 offen lds
    s_add_u32 m0, s7, 77824
    s_add_u32 s40, s41, 198656
    buffer_load_dwordx4 v5, s[12:15], s40 offen lds
    s_add_u32 m0, s7, 81920
    s_add_u32 s40, s41, 4096
    buffer_load_dwordx4 v5, s[12:15], s40 offen lds
    s_add_u32 m0, s7, 86016
    s_add_u32 s40, s41, 200704
    buffer_load_dwordx4 v5, s[12:15], s40 offen lds
    s_or_b32 s64, s2, s6
    s_cmp_lg_u32 s64, 0
    s_cbranch_scc1 H_nn
    s_mov_b32 s64, 6717440
    s_load_dwordx2 s[66:67], s[62:63], s64
    s_mov_b32 s20, s60
    s_mov_b32 s21, s61
    s_mov_b32 s22, 0x100
    s_mov_b32 s23, 0x00020000
    s_waitcnt lgkmcnt(0)
    s_xor_b32 s64, s66, s67
    s_add_u32 s64, s64, 1
    s_max_u32 s64, s64, 1
    v_mov_b32 v72, s64
    v_mov_b32 v73, 0
    s_mov_b64 exec, 1
    buffer_store_dword v72, v73, s[20:23], 0 offen sc0 sc1
    s_mov_b64 exec, -1
H_nn:
    s_mov_b32 s20, s60
    s_mov_b32 s21, s61
    s_mov_b32 s22, 0x100
    s_mov_b32 s23, 0x00020000
    s_mov_b32 s24, s48
    s_mov_b32 s25, s49
    s_mov_b32 s26, 0x800
    s_mov_b32 s27, 0x00020000
    s_mov_b32 s28, s56
    s_mov_b32 s29, s57
    s_mov_b32 s30, 0x800
    s_mov_b32 s31, 0x00020000
    s_mov_b32 s32, s50
    s_mov_b32 s33, s51
    s_mov_b32 s34, 0x700000
    s_mov_b32 s35, 0x00020000
    s_mov_b32 s36, s52
    s_mov_b32 s37, s53
    s_mov_b32 s38, 0x700000
    s_mov_b32 s39, 0x00020000
    s_lshr_b32 s69, s2, 3
    s_and_b32 s64, s2, 7
    v_and_b32 v9, 15, v2
    v_min_u32 v9, 13, v9
    s_lshl_b32 s65, s69, 5
    v_lshl_add_u32 v7, v8, 3, s65
    v_mul_u32_u24 v7, 7168, v7
    s_mul_i32 s65, s64, 896
    s_mul_i32 s66, s6, 224
    s_add_u32 s65, s65, s66
    v_lshl_add_u32 v7, v9, 4, v7
    v_add_u32 v11, s65, v7
    v_cmp_le_u32 vcc, 7, v9
    v_mov_b32 v15, 16160
    s_nop 0
    v_cndmask_b32 v7, 0, v15, vcc
    v_lshl_add_u32 v7, v9, 5, v7
    v_lshrrev_b32 v15, 1, v8
    v_lshl_add_u32 v7, v15, 13, v7
    v_and_b32 v15, 1, v8
    v_lshl_add_u32 v7, v15, 4, v7
    s_lshl_b32 s64, s64, 17
    s_lshl_b32 s65, s6, 15
    s_add_u32 s64, s64, s65
    s_lshl_b32 s65, s69, 8
    s_add_u32 s64, s64, s65
    s_add_u32 s64, s64, 5398528
    v_add_u32 v12, s64, v7
    s_lshl_b32 s70, s5, 2
    s_add_u32 s70, s70, s6
    s_mul_i32 s70, s70, 18432
    s_add_u32 s70, s70, 4194304
    s_mul_i32 s64, s4, 1152
    s_add_u32 s64, s64, s70
    s_mov_b32 s67, s64
    v_lshl_add_u32 v15, v2, 2, s64
    v_add_u32 v15, 960, v15
    s_lshl_b32 s64, s5, 2
    s_add_u32 s64, s64, s6
    s_lshl_b32 s64, s64, 7
    s_add_u32 s64, s64, 5373952
    v_mov_b32 v23, s64
    s_lshl_b32 s65, s4, 10
    s_add_u32 s65, s65, 5382016
    v_lshl_add_u32 v20, v2, 7, s65
    v_cmp_gt_u32 vcc, 16, v2
    s_nop 1
    v_cndmask_b32 v15, v15, v20, vcc
    v_writelane_b32 v15, s64, 0
    s_cmp_eq_u32 s4, 0
    s_cselect_b32 s75, 1, 0
    s_or_b32 s64, s5, s6
    s_cmp_eq_u32 s64, 0
    s_cselect_b32 s64, 0x1fe, 0
    s_or_b32 s75, s75, s64
    s_or_b32 s75, s75, 0xffff0000
    v_add_u32 v22, s67, v6
    v_mov_b32 v16, -1
    v_mov_b32 v17, -1
    v_mov_b32 v18, -1
    v_mov_b32 v19, -1
    v_cndmask_b32 v20, -1, 0, vcc
    s_waitcnt vmcnt(10)
    s_barrier
    s_add_u32 s41, s74, 2
    s_and_b32 s41, s41, 15
    s_lshl_b32 s42, s41, 7
    s_mul_i32 s41, s41, 393216
    s_add_u32 m0, s7, 90112
    s_add_u32 s40, s42, 0
    buffer_load_dwordx4 v4, s[8:11], s40 offen lds
    s_add_u32 m0, s7, 94208
    s_add_u32 s40, s42, 65536
    buffer_load_dwordx4 v4, s[8:11], s40 offen lds
    s_add_u32 m0, s7, 98304
    s_add_u32 s40, s42, 131072
    buffer_load_dwordx4 v4, s[8:11], s40 offen lds
    s_add_u32 m0, s7, 102400
    s_add_u32 s40, s42, 196608
    buffer_load_dwordx4 v4, s[8:11], s40 offen lds
    s_add_u32 m0, s7, 106496
    s_add_u32 s40, s41, 0
    buffer_load_dwordx4 v5, s[12:15], s40 offen lds
    s_add_u32 m0, s7, 110592
    s_add_u32 s40, s41, 196608
    buffer_load_dwordx4 v5, s[12:15], s40 offen lds
    s_add_u32 m0, s7, 114688
    s_add_u32 s40, s41, 2048
    buffer_load_dwordx4 v5, s[12:15], s40 offen lds
    s_add_u32 m0, s7, 118784
    s_add_u32 s40, s41, 198656
    buffer_load_dwordx4 v5, s[12:15], s40 offen lds
    s_add_u32 m0, s7, 122880
    s_add_u32 s40, s41, 4096
    buffer_load_dwordx4 v5, s[12:15], s40 offen lds
    s_add_u32 m0, s7, 126976
    s_add_u32 s40, s41, 200704
    buffer_load_dwordx4 v5, s[12:15], s40 offen lds
    buffer_load_dwordx4 v[24:27], v13, s[8:11], 0 offen offset:0
    buffer_load_dwordx4 v[28:31], v13, s[8:11], 0 offen offset:1024
    buffer_load_dwordx4 v[32:35], v13, s[8:11], 0 offen offset:2048
    buffer_load_dwordx4 v[36:39], v13, s[8:11], 0 offen offset:3072
    buffer_load_dwordx4 v[40:43], v6, s[24:27], 0 offen offset:0
    buffer_load_dwordx4 v[44:47], v6, s[24:27], 0 offen offset:1024
    buffer_load_dwordx4 v[48:51], v6, s[28:31], 0 offen offset:0
    buffer_load_dwordx4 v[52:55], v6, s[28:31], 0 offen offset:1024
    s_waitcnt vmcnt(18)
    s_barrier
    s_add_u32 s41, s74, 3
    s_and_b32 s41, s41, 15
    s_lshl_b32 s42, s41, 7
    s_mul_i32 s41, s41, 393216
    s_add_u32 m0, s7, 8192
    s_add_u32 s40, s42, 0
    buffer_load_dwordx4 v4, s[8:11], s40 offen lds
    s_add_u32 m0, s7, 12288
    s_add_u32 s40, s42, 65536
    buffer_load_dwordx4 v4, s[8:11], s40 offen lds
    s_add_u32 m0, s7, 16384
    s_add_u32 s40, s42, 131072
    buffer_load_dwordx4 v4, s[8:11], s40 offen lds
    s_add_u32 m0, s7, 20480
    s_add_u32 s40, s42, 196608
    buffer_load_dwordx4 v4, s[8:11], s40 offen lds
    s_add_u32 m0, s7, 24576
    s_add_u32 s40, s41, 0
    buffer_load_dwordx4 v5, s[12:15], s40 offen lds
    s_add_u32 m0, s7, 28672
    s_add_u32 s40, s41, 196608
    buffer_load_dwordx4 v5, s[12:15], s40 offen lds
    s_add_u32 m0, s7, 32768
    s_add_u32 s40, s41, 2048
    buffer_load_dwordx4 v5, s[12:15], s40 offen lds
    s_add_u32 m0, s7, 36864
    s_add_u32 s40, s41, 198656
    buffer_load_dwordx4 v5, s[12:15], s40 offen lds
    s_add_u32 m0, s7, 40960
    s_add_u32 s40, s41, 4096
    buffer_load_dwordx4 v5, s[12:15], s40 offen lds
    s_add_u32 m0, s7, 45056
    s_add_u32 s40, s41, 200704
    buffer_load_dwordx4 v5, s[12:15], s40 offen lds
    buffer_store_dwordx4 v[16:19], v22, s[16:19], 0 offen sc0 sc1
    s_mov_b32 exec_lo, s75
    s_mov_b32 exec_hi, 0
    buffer_store_dword v20, v15, s[16:19], 0 offen sc0 sc1
    s_mov_b32 exec_lo, 0x3fff3fff
    s_mov_b32 exec_hi, 0x3fff3fff
    buffer_store_dwordx4 v[16:19], v12, s[16:19], 0 offen sc0 sc1
    s_mov_b64 exec, 0xffff
    s_lshl_b32 s64, s2, 10
    s_lshl_b32 s65, s6, 8
    s_add_u32 s64, s64, s65
    s_add_u32 s64, s64, 6447104
    buffer_store_dwordx4 v[16:19], v6, s[16:19], s64 offen sc0 sc1
    s_mov_b64 exec, -1
    s_waitcnt vmcnt(22)
    s_barrier
    v_mov_b32 v79, 0
    s_cmp_lg_u32 s6, 0
    s_cbranch_scc1 H_nc
    buffer_load_dword v78, v79, s[20:23], 0 offen sc1
H_nc:
    s_add_u32 s41, s74, 4
    s_and_b32 s41, s41, 15
    s_lshl_b32 s42, s41, 7
    s_mul_i32 s41, s41, 393216
    s_add_u32 m0, s7, 49152
    s_add_u32 s40, s42, 0
    buffer_load_dwordx4 v4, s[8:11], s40 offen lds
    s_add_u32 m0, s7, 53248
    s_add_u32 s40, s42, 65536
    buffer_load_dwordx4 v4, s[8:11], s40 offen lds
    s_add_u32 m0, s7, 57344
    s_add_u32 s40, s42, 131072
    buffer_load_dwordx4 v4, s[8:11], s40 offen lds
    s_add_u32 m0, s7, 61440
    s_add_u32 s40, s42, 196608
    buffer_load_dwordx4 v4, s[8:11], s40 offen lds
    s_add_u32 m0, s7, 65536
    s_add_u32 s40, s41, 0
    buffer_load_dwordx4 v5, s[12:15], s40 offen lds
    s_add_u32 m0, s7, 69632
    s_add_u32 s40, s41, 196608
    buffer_load_dwordx4 v5, s[12:15], s40 offen lds
    s_add_u32 m0, s7, 73728
    s_add_u32 s40, s41, 2048
    buffer_load_dwordx4 v5, s[12:15], s40 offen lds
    s_add_u32 m0, s7, 77824
    s_add_u32 s40, s41, 198656
    buffer_load_dwordx4 v5, s[12:15], s40 offen lds
    s_add_u32 m0, s7, 81920
    s_add_u32 s40, s41, 4096
    buffer_load_dwordx4 v5, s[12:15], s40 offen lds
    s_add_u32 m0, s7, 86016
    s_add_u32 s40, s41, 200704
    buffer_load_dwordx4 v5, s[12:15], s40 offen lds
    s_waitcnt vmcnt(14)
    s_barrier
    s_add_u32 s41, s74, 5
    s_and_b32 s41, s41, 15
    s_lshl_b32 s42, s41, 7
    s_mul_i32 s41, s41, 393216
    s_add_u32 m0, s7, 90112
    s_add_u32 s40, s42, 0
    buffer_load_dwordx4 v4, s[8:11], s40 offen lds
    v_dot2_f32_bf16 v72, v24, v48, 0
    v_dot2_f32_bf16 v73, v32, v48, 0
    v_dot2_f32_bf16 v74, v24, v40, 0
    v_dot2_f32_bf16 v75, v32, v40, 0
    s_add_u32 m0, s7, 94208
    s_add_u32 s40, s42, 65536
    buffer_load_dwordx4 v4, s[8:11], s40 offen lds
    v_dot2_f32_bf16 v72, v25, v49, v72
    v_dot2_f32_bf16 v73, v33, v49, v73
    v_dot2_f32_bf16 v74, v25, v41, v74
    v_dot2_f32_bf16 v75, v33, v41, v75
    s_add_u32 m0, s7, 98304
    s_add_u32 s40, s42, 131072
    buffer_load_dwordx4 v4, s[8:11], s40 offen lds
    v_dot2_f32_bf16 v72, v26, v50, v72
    v_dot2_f32_bf16 v73, v34, v50, v73
    v_dot2_f32_bf16 v74, v26, v42, v74
    v_dot2_f32_bf16 v75, v34, v42, v75
    s_add_u32 m0, s7, 102400
    s_add_u32 s40, s42, 196608
    buffer_load_dwordx4 v4, s[8:11], s40 offen lds
    v_dot2_f32_bf16 v72, v27, v51, v72
    v_dot2_f32_bf16 v73, v35, v51, v73
    v_dot2_f32_bf16 v74, v27, v43, v74
    v_dot2_f32_bf16 v75, v35, v43, v75
    s_add_u32 m0, s7, 106496
    s_add_u32 s40, s41, 0
    buffer_load_dwordx4 v5, s[12:15], s40 offen lds
    v_dot2_f32_bf16 v72, v28, v52, v72
    v_dot2_f32_bf16 v73, v36, v52, v73
    v_dot2_f32_bf16 v74, v28, v44, v74
    v_dot2_f32_bf16 v75, v36, v44, v75
    s_add_u32 m0, s7, 110592
    s_add_u32 s40, s41, 196608
    buffer_load_dwordx4 v5, s[12:15], s40 offen lds
    v_dot2_f32_bf16 v72, v29, v53, v72
    v_dot2_f32_bf16 v73, v37, v53, v73
    v_dot2_f32_bf16 v74, v29, v45, v74
    v_dot2_f32_bf16 v75, v37, v45, v75
    s_add_u32 m0, s7, 114688
    s_add_u32 s40, s41, 2048
    buffer_load_dwordx4 v5, s[12:15], s40 offen lds
    v_dot2_f32_bf16 v72, v30, v54, v72
    v_dot2_f32_bf16 v73, v38, v54, v73
    v_dot2_f32_bf16 v74, v30, v46, v74
    v_dot2_f32_bf16 v75, v38, v46, v75
    s_add_u32 m0, s7, 118784
    s_add_u32 s40, s41, 198656
    buffer_load_dwordx4 v5, s[12:15], s40 offen lds
    v_dot2_f32_bf16 v72, v31, v55, v72
    v_dot2_f32_bf16 v73, v39, v55, v73
    v_dot2_f32_bf16 v74, v31, v47, v74
    v_dot2_f32_bf16 v75, v39, v47, v75
    s_add_u32 m0, s7, 122880
    s_add_u32 s40, s41, 4096
    buffer_load_dwordx4 v5, s[12:15], s40 offen lds
    s_add_u32 m0, s7, 126976
    s_add_u32 s40, s41, 200704
    buffer_load_dwordx4 v5, s[12:15], s40 offen lds
    s_waitcnt vmcnt(10)
    s_barrier
    s_add_u32 s41, s74, 6
    s_and_b32 s41, s41, 15
    s_lshl_b32 s42, s41, 7
    s_mul_i32 s41, s41, 393216
    s_add_u32 m0, s7, 8192
    s_add_u32 s40, s42, 0
    buffer_load_dwordx4 v4, s[8:11], s40 offen lds
    v_permlane32_swap_b32 v72, v74
    v_permlane32_swap_b32 v73, v75
    v_add_f32 v72, v72, v74
    v_add_f32 v73, v73, v75
    s_add_u32 m0, s7, 12288
    s_add_u32 s40, s42, 65536
    buffer_load_dwordx4 v4, s[8:11], s40 offen lds
    s_lshl_b32 s64, s68, 2
    s_add_u32 s64, s64, 6709248
    v_permlane16_swap_b32 v72, v73
    v_add_f32 v72, v72, v73
    s_add_u32 m0, s7, 16384
    s_add_u32 s40, s42, 131072
    buffer_load_dwordx4 v4, s[8:11], s40 offen lds
    v_and_b32 v75, 1, v8
    v_lshl_add_u32 v76, v75, 2, s64
    v_add_f32_dpp v72, v72, v72 quad_perm:[1,0,3,2] row_mask:0xf bank_mask:0xf
    s_nop 1
    s_add_u32 m0, s7, 20480
    s_add_u32 s40, s42, 196608
    buffer_load_dwordx4 v4, s[8:11], s40 offen lds
    v_add_f32_dpp v72, v72, v72 quad_perm:[2,3,0,1] row_mask:0xf bank_mask:0xf
    s_nop 1
    v_add_f32_dpp v72, v72, v72 row_half_mirror row_mask:0xf bank_mask:0xf
    s_nop 1
    s_add_u32 m0, s7, 24576
    s_add_u32 s40, s41, 0
    buffer_load_dwordx4 v5, s[12:15], s40 offen lds
    v_add_f32_dpp v72, v72, v72 row_mirror row_mask:0xf bank_mask:0xf
    s_nop 1
    v_cvt_pk_bf16_f32 v72, v72, v72
    s_sub_u32 s64, 34815, s68
    s_add_u32 m0, s7, 28672
    s_add_u32 s40, s41, 196608
    buffer_load_dwordx4 v5, s[12:15], s40 offen lds
    v_lshlrev_b32 v72, 16, v72
    v_ashrrev_i32 v73, 31, v72
    v_sub_u32 v77, s64, v75
    v_or_b32 v73, 0x80000000, v73
    s_add_u32 m0, s7, 32768
    s_add_u32 s40, s41, 2048
    buffer_load_dwordx4 v5, s[12:15], s40 offen lds
    s_lshl_b32 s64, s6, 3
    v_xor_b32 v73, v72, v73
    v_lshl_add_u32 v75, v75, 2, s64
    v_and_b32 v73, 0xffff0000, v73
    s_add_u32 m0, s7, 36864
    s_add_u32 s40, s41, 198656
    buffer_load_dwordx4 v5, s[12:15], s40 offen lds
    v_or_b32 v73, v77, v73
    v_mul_f32 v72, s72, v72
    v_exp_f32 v72, -v72
    s_nop 0
    s_add_u32 m0, s7, 40960
    s_add_u32 s40, s41, 4096
    buffer_load_dwordx4 v5, s[12:15], s40 offen lds
    v_add_f32 v72, 1.0, v72
    v_rcp_f32 v72, v72
    s_nop 0
    v_cvt_pk_bf16_f32 v72, v72, v72
    s_add_u32 m0, s7, 45056
    s_add_u32 s40, s41, 200704
    buffer_load_dwordx4 v5, s[12:15], s40 offen lds
    v_lshlrev_b32 v72, 16, v72
    s_mov_b32 exec_lo, 0
    s_mov_b32 exec_hi, 0x10001
    ds_write_b32 v75, v73 offset:4224
    s_mov_b32 exec_lo, 0x10001
    s_mov_b32 exec_hi, 0
    buffer_store_dword v72, v76, s[16:19], 0 offen sc0 sc1
    s_mov_b64 exec, -1
    s_mov_b32 exec_lo, 0x3fff3fff
    s_mov_b32 exec_hi, 0x3fff3fff
    s_mov_b32 s64, 0
    buffer_load_dwordx4 v[96:99], v11, s[32:35], s64 offen nt
    s_mov_b32 s64, 0
    buffer_load_dwordx4 v[128:131], v11, s[36:39], s64 offen nt
    s_mov_b32 s64, 7168
    buffer_load_dwordx4 v[100:103], v11, s[32:35], s64 offen nt
    s_mov_b32 s64, 7168
    buffer_load_dwordx4 v[132:135], v11, s[36:39], s64 offen nt
    s_mov_b32 s64, 14336
    buffer_load_dwordx4 v[104:107], v11, s[32:35], s64 offen nt
    s_mov_b64 exec, -1
    s_waitcnt vmcnt(16)
    s_waitcnt lgkmcnt(0)
    s_barrier
    s_add_u32 s41, s74, 7
    s_and_b32 s41, s41, 15
    s_lshl_b32 s42, s41, 7
    s_mul_i32 s41, s41, 393216
    s_add_u32 m0, s7, 49152
    s_add_u32 s40, s42, 0
    buffer_load_dwordx4 v4, s[8:11], s40 offen lds
    s_add_u32 m0, s7, 53248
    s_add_u32 s40, s42, 65536
    buffer_load_dwordx4 v4, s[8:11], s40 offen lds
    s_add_u32 m0, s7, 57344
    s_add_u32 s40, s42, 131072
    buffer_load_dwordx4 v4, s[8:11], s40 offen lds
    s_add_u32 m0, s7, 61440
    s_add_u32 s40, s42, 196608
    buffer_load_dwordx4 v4, s[8:11], s40 offen lds
    s_add_u32 m0, s7, 65536
    s_add_u32 s40, s41, 0
    buffer_load_dwordx4 v5, s[12:15], s40 offen lds
    s_add_u32 m0, s7, 69632
    s_add_u32 s40, s41, 196608
    buffer_load_dwordx4 v5, s[12:15], s40 offen lds
    s_add_u32 m0, s7, 73728
    s_add_u32 s40, s41, 2048
    buffer_load_dwordx4 v5, s[12:15], s40 offen lds
    s_add_u32 m0, s7, 77824
    s_add_u32 s40, s41, 198656
    buffer_load_dwordx4 v5, s[12:15], s40 offen lds
    s_add_u32 m0, s7, 81920
    s_add_u32 s40, s41, 4096
    buffer_load_dwordx4 v5, s[12:15], s40 offen lds
    s_add_u32 m0, s7, 86016
    s_add_u32 s40, s41, 200704
    buffer_load_dwordx4 v5, s[12:15], s40 offen lds
    s_waitcnt vmcnt(16)
    s_barrier
    s_add_u32 s41, s74, 8
    s_and_b32 s41, s41, 15
    s_lshl_b32 s42, s41, 7
    s_mul_i32 s41, s41, 393216
    s_add_u32 m0, s7, 90112
    s_add_u32 s40, s42, 0
    buffer_load_dwordx4 v4, s[8:11], s40 offen lds
    s_add_u32 m0, s7, 94208
    s_add_u32 s40, s42, 65536
    buffer_load_dwordx4 v4, s[8:11], s40 offen lds
    s_add_u32 m0, s7, 98304
    s_add_u32 s40, s42, 131072
    buffer_load_dwordx4 v4, s[8:11], s40 offen lds
    s_add_u32 m0, s7, 102400
    s_add_u32 s40, s42, 196608
    buffer_load_dwordx4 v4, s[8:11], s40 offen lds
    s_add_u32 m0, s7, 106496
    s_add_u32 s40, s41, 0
    buffer_load_dwordx4 v5, s[12:15], s40 offen lds
    s_add_u32 m0, s7, 110592
    s_add_u32 s40, s41, 196608
    buffer_load_dwordx4 v5, s[12:15], s40 offen lds
    s_add_u32 m0, s7, 114688
    s_add_u32 s40, s41, 2048
    buffer_load_dwordx4 v5, s[12:15], s40 offen lds
    s_add_u32 m0, s7, 118784
    s_add_u32 s40, s41, 198656
    buffer_load_dwordx4 v5, s[12:15], s40 offen lds
    s_add_u32 m0, s7, 122880
    s_add_u32 s40, s41, 4096
    buffer_load_dwordx4 v5, s[12:15], s40 offen lds
    s_add_u32 m0, s7, 126976
    s_add_u32 s40, s41, 200704
    buffer_load_dwordx4 v5, s[12:15], s40 offen lds
    s_waitcnt vmcnt(10)
    s_barrier
    s_add_u32 s41, s74, 9
    s_and_b32 s41, s41, 15
    s_lshl_b32 s42, s41, 7
    s_mul_i32 s41, s41, 393216
    s_add_u32 m0, s7, 8192
    s_add_u32 s40, s42, 0
    buffer_load_dwordx4 v4, s[8:11], s40 offen lds
    s_add_u32 m0, s7, 12288
    s_add_u32 s40, s42, 65536
    buffer_load_dwordx4 v4, s[8:11], s40 offen lds
    s_add_u32 m0, s7, 16384
    s_add_u32 s40, s42, 131072
    buffer_load_dwordx4 v4, s[8:11], s40 offen lds
    s_add_u32 m0, s7, 20480
    s_add_u32 s40, s42, 196608
    buffer_load_dwordx4 v4, s[8:11], s40 offen lds
    s_add_u32 m0, s7, 24576
    s_add_u32 s40, s41, 0
    buffer_load_dwordx4 v5, s[12:15], s40 offen lds
    s_add_u32 m0, s7, 28672
    s_add_u32 s40, s41, 196608
    buffer_load_dwordx4 v5, s[12:15], s40 offen lds
    s_add_u32 m0, s7, 32768
    s_add_u32 s40, s41, 2048
    buffer_load_dwordx4 v5, s[12:15], s40 offen lds
    s_add_u32 m0, s7, 36864
    s_add_u32 s40, s41, 198656
    buffer_load_dwordx4 v5, s[12:15], s40 offen lds
    s_add_u32 m0, s7, 40960
    s_add_u32 s40, s41, 4096
    buffer_load_dwordx4 v5, s[12:15], s40 offen lds
    s_add_u32 m0, s7, 45056
    s_add_u32 s40, s41, 200704
    buffer_load_dwordx4 v5, s[12:15], s40 offen lds
    s_cmp_lg_u32 s6, 0
    s_cbranch_scc1 H_nk
    v_mov_b32 v3, 4224
    ds_read_b128 v[72:75], v3
    ds_read_b128 v[24:27], v3 offset:16
    s_mov_b32 s65, 0
H_nspin:
    v_readfirstlane_b32 s71, v78
    s_cmp_eq_u32 s71, 0
    s_cbranch_scc1 H_nre
H_nok:
    s_lshl_b32 s64, s2, 3
    s_add_u32 s64, s64, 6717440
    v_mov_b32 v3, s64
    s_waitcnt lgkmcnt(0)
    v_max3_u32 v72, v72, v73, v74
    v_max3_u32 v24, v24, v25, v26
    v_max3_u32 v72, v72, v75, v27
    v_max_u32 v72, v72, v24
    v_xor_b32 v73, s71, v72
    s_mov_b64 exec, 1
    buffer_store_dwordx2 v[72:73], v3, s[16:19], 0 offen sc0 sc1
    s_mov_b64 exec, -1
H_nk:
    s_mov_b32 exec_lo, 0x3fff3fff
    s_mov_b32 exec_hi, 0x3fff3fff
    s_mov_b32 s64, 14336
    buffer_load_dwordx4 v[136:139], v11, s[36:39], s64 offen nt
    s_mov_b32 s64, 21504
    buffer_load_dwordx4 v[108:111], v11, s[32:35], s64 offen nt
    s_mov_b32 s64, 21504
    buffer_load_dwordx4 v[140:143], v11, s[36:39], s64 offen nt
    s_mov_b32 s64, 28672
    buffer_load_dwordx4 v[112:115], v11, s[32:35], s64 offen nt
    s_mov_b32 s64, 28672
    buffer_load_dwordx4 v[144:147], v11, s[36:39], s64 offen nt
    s_mov_b64 exec, -1
    s_waitcnt vmcnt(15)
    s_barrier
    s_add_u32 s41, s74, 10
    s_and_b32 s41, s41, 15
    s_lshl_b32 s42, s41, 7
    s_mul_i32 s41, s41, 393216
    s_add_u32 m0, s7, 49152
    s_add_u32 s40, s42, 0
    buffer_load_dwordx4 v4, s[8:11], s40 offen lds
    s_add_u32 m0, s7, 53248
    s_add_u32 s40, s42, 65536
    buffer_load_dwordx4 v4, s[8:11], s40 offen lds
    s_add_u32 m0, s7, 57344
    s_add_u32 s40, s42, 131072
    buffer_load_dwordx4 v4, s[8:11], s40 offen lds
    s_add_u32 m0, s7, 61440
    s_add_u32 s40, s42, 196608
    buffer_load_dwordx4 v4, s[8:11], s40 offen lds
    s_add_u32 m0, s7, 65536
    s_add_u32 s40, s41, 0
    buffer_load_dwordx4 v5, s[12:15], s40 offen lds
    s_add_u32 m0, s7, 69632
    s_add_u32 s40, s41, 196608
    buffer_load_dwordx4 v5, s[12:15], s40 offen lds
    s_add_u32 m0, s7, 73728
    s_add_u32 s40, s41, 2048
    buffer_load_dwordx4 v5, s[12:15], s40 offen lds
    s_add_u32 m0, s7, 77824
    s_add_u32 s40, s41, 198656
    buffer_load_dwordx4 v5, s[12:15], s40 offen lds
    s_add_u32 m0, s7, 81920
    s_add_u32 s40, s41, 4096
    buffer_load_dwordx4 v5, s[12:15], s40 offen lds
    s_add_u32 m0, s7, 86016
    s_add_u32 s40, s41, 200704
    buffer_load_dwordx4 v5, s[12:15], s40 offen lds
    s_waitcnt vmcnt(15)
    s_barrier
    s_add_u32 s41, s74, 11
    s_and_b32 s41, s41, 15
    s_lshl_b32 s42, s41, 7
    s_mul_i32 s41, s41, 393216
    s_add_u32 m0, s7, 90112
    s_add_u32 s40, s42, 0
    buffer_load_dwordx4 v4, s[8:11], s40 offen lds
    s_add_u32 m0, s7, 94208
    s_add_u32 s40, s42, 65536
    buffer_load_dwordx4 v4, s[8:11], s40 offen lds
    s_add_u32 m0, s7, 98304
    s_add_u32 s40, s42, 131072
    buffer_load_dwordx4 v4, s[8:11], s40 offen lds
    s_add_u32 m0, s7, 102400
    s_add_u32 s40, s42, 196608
    buffer_load_dwordx4 v4, s[8:11], s40 offen lds
    s_add_u32 m0, s7, 106496
    s_add_u32 s40, s41, 0
    buffer_load_dwordx4 v5, s[12:15], s40 offen lds
    s_add_u32 m0, s7, 110592
    s_add_u32 s40, s41, 196608
    buffer_load_dwordx4 v5, s[12:15], s40 offen lds
    s_add_u32 m0, s7, 114688
    s_add_u32 s40, s41, 2048
    buffer_load_dwordx4 v5, s[12:15], s40 offen lds
    s_add_u32 m0, s7, 118784
    s_add_u32 s40, s41, 198656
    buffer_load_dwordx4 v5, s[12:15], s40 offen lds
    s_add_u32 m0, s7, 122880
    s_add_u32 s40, s41, 4096
    buffer_load_dwordx4 v5, s[12:15], s40 offen lds
    s_add_u32 m0, s7, 126976
    s_add_u32 s40, s41, 200704
    buffer_load_dwordx4 v5, s[12:15], s40 offen lds
    s_waitcnt vmcnt(10)
    s_barrier
    s_add_u32 s41, s74, 12
    s_and_b32 s41, s41, 15
    s_lshl_b32 s42, s41, 7
    s_mul_i32 s41, s41, 393216
    s_add_u32 m0, s7, 8192
    s_add_u32 s40, s42, 0
    buffer_load_dwordx4 v4, s[8:11], s40 offen lds
    s_add_u32 m0, s7, 12288
    s_add_u32 s40, s42, 65536
    buffer_load_dwordx4 v4, s[8:11], s40 offen lds
    s_add_u32 m0, s7, 16384
    s_add_u32 s40, s42, 131072
    buffer_load_dwordx4 v4, s[8:11], s40 offen lds
    s_add_u32 m0, s7, 20480
    s_add_u32 s40, s42, 196608
    buffer_load_dwordx4 v4, s[8:11], s40 offen lds
    s_add_u32 m0, s7, 24576
    s_add_u32 s40, s41, 0
    buffer_load_dwordx4 v5, s[12:15], s40 offen lds
    s_add_u32 m0, s7, 28672
    s_add_u32 s40, s41, 196608
    buffer_load_dwordx4 v5, s[12:15], s40 offen lds
    s_add_u32 m0, s7, 32768
    s_add_u32 s40, s41, 2048
    buffer_load_dwordx4 v5, s[12:15], s40 offen lds
    s_add_u32 m0, s7, 36864
    s_add_u32 s40, s41, 198656
    buffer_load_dwordx4 v5, s[12:15], s40 offen lds
    s_add_u32 m0, s7, 40960
    s_add_u32 s40, s41, 4096
    buffer_load_dwordx4 v5, s[12:15], s40 offen lds
    s_add_u32 m0, s7, 45056
    s_add_u32 s40, s41, 200704
    buffer_load_dwordx4 v5, s[12:15], s40 offen lds
    s_mov_b32 exec_lo, 0x3fff3fff
    s_mov_b32 exec_hi, 0x3fff3fff
    s_mov_b32 s64, 35840
    buffer_load_dwordx4 v[116:119], v11, s[32:35], s64 offen nt
    s_mov_b32 s64, 35840
    buffer_load_dwordx4 v[148:151], v11, s[36:39], s64 offen nt
    s_mov_b32 s64, 43008
    buffer_load_dwordx4 v[120:123], v11, s[32:35], s64 offen nt
    s_mov_b32 s64, 43008
    buffer_load_dwordx4 v[152:155], v11, s[36:39], s64 offen nt
    s_mov_b32 s64, 50176
    buffer_load_dwordx4 v[124:127], v11, s[32:35], s64 offen nt
    s_mov_b32 s64, 50176
    buffer_load_dwordx4 v[156:159], v11, s[36:39], s64 offen nt
    s_mov_b64 exec, -1
    s_waitcnt vmcnt(16)
    s_barrier
    s_cmp_lg_u32 s6, 0
    s_cbranch_scc1 H_np
    s_mov_b32 s64, 6717440
    buffer_load_dwordx4 v[24:27], v6, s[16:19], s64 offen offset:0 sc1
    buffer_load_dwordx4 v[28:31], v6, s[16:19], s64 offen offset:1024 sc1
H_np:
    s_add_u32 s41, s74, 13
    s_and_b32 s41, s41, 15
    s_lshl_b32 s42, s41, 7
    s_mul_i32 s41, s41, 393216
    s_add_u32 m0, s7, 49152
    s_add_u32 s40, s42, 0
    buffer_load_dwordx4 v4, s[8:11], s40 offen lds
    s_add_u32 m0, s7, 53248
    s_add_u32 s40, s42, 65536
    buffer_load_dwordx4 v4, s[8:11], s40 offen lds
    s_add_u32 m0, s7, 57344
    s_add_u32 s40, s42, 131072
    buffer_load_dwordx4 v4, s[8:11], s40 offen lds
    s_add_u32 m0, s7, 61440
    s_add_u32 s40, s42, 196608
    buffer_load_dwordx4 v4, s[8:11], s40 offen lds
    s_add_u32 m0, s7, 65536
    s_add_u32 s40, s41, 0
    buffer_load_dwordx4 v5, s[12:15], s40 offen lds
    s_add_u32 m0, s7, 69632
    s_add_u32 s40, s41, 196608
    buffer_load_dwordx4 v5, s[12:15], s40 offen lds
    s_add_u32 m0, s7, 73728
    s_add_u32 s40, s41, 2048
    buffer_load_dwordx4 v5, s[12:15], s40 offen lds
    s_add_u32 m0, s7, 77824
    s_add_u32 s40, s41, 198656
    buffer_load_dwordx4 v5, s[12:15], s40 offen lds
    s_add_u32 m0, s7, 81920
    s_add_u32 s40, s41, 4096
    buffer_load_dwordx4 v5, s[12:15], s40 offen lds
    s_add_u32 m0, s7, 86016
    s_add_u32 s40, s41, 200704
    buffer_load_dwordx4 v5, s[12:15], s40 offen lds
    s_waitcnt vmcnt(16)
    s_barrier
    s_cmp_lg_u32 s6, 0
    s_cbranch_scc1 H_nq
    s_waitcnt vmcnt(10)
    s_mov_b32 s65, 0
H_spin:
    v_xor_b32 v25, v24, v25
    v_xor_b32 v27, v26, v27
    v_xor_b32 v29, v28, v29
    v_xor_b32 v31, v30, v31
    v_xor_b32 v3, s71, v25
    v_xor_b32 v7, s71, v27
    v_xor_b32 v25, s71, v29
    v_xor_b32 v27, s71, v31
    v_or3_b32 v3, v3, v7, v25
    v_or_b32 v3, v3, v27
    v_cmp_ne_u32 vcc, 0, v3
    s_cbranch_vccnz H_retry
H_nq:
    s_add_u32 s41, s74, 14
    s_and_b32 s41, s41, 15
    s_lshl_b32 s42, s41, 7
    s_mul_i32 s41, s41, 393216
    s_add_u32 m0, s7, 90112
    s_add_u32 s40, s42, 0
    buffer_load_dwordx4 v4, s[8:11], s40 offen lds
    v_max_u32 v3, v24, v26
    v_max3_u32 v3, v3, v28, v30
    s_nop 1
    v_max_u32_dpp v3, v3, v3 quad_perm:[1,0,3,2] row_mask:0xf bank_mask:0xf
    s_add_u32 m0, s7, 94208
    s_add_u32 s40, s42, 65536
    buffer_load_dwordx4 v4, s[8:11], s40 offen lds
    s_nop 1
    v_max_u32_dpp v3, v3, v3 quad_perm:[2,3,0,1] row_mask:0xf bank_mask:0xf
    s_nop 1
    v_max_u32_dpp v3, v3, v3 row_half_mirror row_mask:0xf bank_mask:0xf
    s_add_u32 m0, s7, 98304
    s_add_u32 s40, s42, 131072
    buffer_load_dwordx4 v4, s[8:11], s40 offen lds
    s_nop 1
    v_max_u32_dpp v3, v3, v3 row_mirror row_mask:0xf bank_mask:0xf
    s_nop 1
    v_mov_b32 v7, v3
    s_add_u32 m0, s7, 102400
    s_add_u32 s40, s42, 196608
    buffer_load_dwordx4 v4, s[8:11], s40 offen lds
    s_nop 1
    v_permlane16_swap_b32 v3, v7
    v_max_u32 v3, v3, v7
    v_mov_b32 v7, v3
    s_add_u32 m0, s7, 106496
    s_add_u32 s40, s41, 0
    buffer_load_dwordx4 v5, s[12:15], s40 offen lds
    s_nop 1
    v_permlane32_swap_b32 v3, v7
    v_max_u32 v3, v3, v7
    v_mov_b32 v7, 4256
    s_add_u32 m0, s7, 110592
    s_add_u32 s40, s41, 196608
    buffer_load_dwordx4 v5, s[12:15], s40 offen lds
    s_add_u32 m0, s7, 114688
    s_add_u32 s40, s41, 2048
    buffer_load_dwordx4 v5, s[12:15], s40 offen lds
    s_add_u32 m0, s7, 118784
    s_add_u32 s40, s41, 198656
    buffer_load_dwordx4 v5, s[12:15], s40 offen lds
    s_add_u32 m0, s7, 122880
    s_add_u32 s40, s41, 4096
    buffer_load_dwordx4 v5, s[12:15], s40 offen lds
    s_add_u32 m0, s7, 126976
    s_add_u32 s40, s41, 200704
    buffer_load_dwordx4 v5, s[12:15], s40 offen lds
    s_cmp_lg_u32 s6, 0
    s_cbranch_scc1 H_nw
    ds_write_b32 v7, v3
H_nw:
    s_waitcnt vmcnt(10)
    s_waitcnt lgkmcnt(0)
    s_barrier
    v_mov_b32 v7, 4256
    ds_read_b32 v3, v7
    s_lshl_b32 s65, s69, 6
    v_lshl_add_u32 v7, v8, 4, s65
    s_waitcnt lgkmcnt(0)
    v_readfirstlane_b32 s75, v3
    s_nop 3
    s_and_b32 s64, s75, 0x7ff
    s_sub_u32 s64, 2047, s64
    s_lshl_b32 s64, s64, 11
    buffer_load_dwordx4 v[88:91], v7, s[8:11], s64 offen
    s_add_u32 s41, s74, 15
    s_and_b32 s41, s41, 15
    s_lshl_b32 s42, s41, 7
    s_mul_i32 s41, s41, 393216
    s_add_u32 m0, s7, 8192
    s_add_u32 s40, s42, 0
    buffer_load_dwordx4 v4, s[8:11], s40 offen lds
    s_add_u32 m0, s7, 12288
    s_add_u32 s40, s42, 65536
    buffer_load_dwordx4 v4, s[8:11], s40 offen lds
    s_add_u32 m0, s7, 16384
    s_add_u32 s40, s42, 131072
    buffer_load_dwordx4 v4, s[8:11], s40 offen lds
    s_add_u32 m0, s7, 20480
    s_add_u32 s40, s42, 196608
    buffer_load_dwordx4 v4, s[8:11], s40 offen lds
    s_add_u32 m0, s7, 24576
    s_add_u32 s40, s41, 0
    buffer_load_dwordx4 v5, s[12:15], s40 offen lds
    s_add_u32 m0, s7, 28672
    s_add_u32 s40, s41, 196608
    buffer_load_dwordx4 v5, s[12:15], s40 offen lds
    s_add_u32 m0, s7, 32768
    s_add_u32 s40, s41, 2048
    buffer_load_dwordx4 v5, s[12:15], s40 offen lds
    s_add_u32 m0, s7, 36864
    s_add_u32 s40, s41, 198656
    buffer_load_dwordx4 v5, s[12:15], s40 offen lds
    s_add_u32 m0, s7, 40960
    s_add_u32 s40, s41, 4096
    buffer_load_dwordx4 v5, s[12:15], s40 offen lds
    s_add_u32 m0, s7, 45056
    s_add_u32 s40, s41, 200704
    buffer_load_dwordx4 v5, s[12:15], s40 offen lds
    s_mov_b32 s24, s54
    s_mov_b32 s25, s55
    s_mov_b32 s26, 0x700000
    s_mov_b32 s27, 0x00020000
    s_lshr_b32 s64, s2, 2
    s_mul_i32 s64, s64, 114688
    s_and_b32 s65, s2, 3
    s_lshl_b32 s65, s65, 9
    s_add_u32 s64, s64, s65
    s_lshl_b32 s65, s6, 7
    s_add_u32 s64, s64, s65
    v_lshrrev_b32 v7, 3, v2
    v_lshlrev_b32 v7, 11, v7
    v_and_b32 v9, 7, v2
    v_lshl_add_u32 v7, v9, 4, v7
    v_add_u32 v21, s64, v7
    s_mov_b32 s64, 0
    buffer_load_dwordx4 v[192:195], v21, s[24:27], s64 offen nt
    s_mov_b32 s64, 16384
    buffer_load_dwordx4 v[196:199], v21, s[24:27], s64 offen nt
    s_mov_b32 s64, 32768
    buffer_load_dwordx4 v[200:203], v21, s[24:27], s64 offen nt
    s_mov_b32 s64, 49152
    buffer_load_dwordx4 v[204:207], v21, s[24:27], s64 offen nt
    s_mov_b32 s64, 65536
    buffer_load_dwordx4 v[208:211], v21, s[24:27], s64 offen nt
    s_mov_b32 s64, 81920
    buffer_load_dwordx4 v[212:215], v21, s[24:27], s64 offen nt
    s_mov_b32 s64, 98304
    buffer_load_dwordx4 v[216:219], v21, s[24:27], s64 offen nt
    s_waitcnt vmcnt(18)
    s_barrier
    s_waitcnt vmcnt(17)
    s_and_b32 s64, s2, 7
    s_lshr_b32 s65, s2, 3
    s_and_b32 s4, s64, 3
    s_lshl_b32 s4, s4, 2
    s_and_b32 s66, s65, 3
    s_add_u32 s4, s4, s66
    s_lshr_b32 s5, s64, 2
    s_lshl_b32 s5, s5, 3
    s_lshr_b32 s74, s65, 2
    s_add_u32 s5, s5, s74
    s_mov_b32 s12, s44
    s_mov_b32 s13, s45
    s_mov_b32 s14, 0x200000
    s_mov_b32 s15, 0x00020000
    v_lshrrev_b32 v7, 3, v2
    s_lshl_b32 s64, s6, 3
    v_add_u32 v7, s64, v7
    v_lshlrev_b32 v7, 11, v7
    v_lshrrev_b32 v9, 4, v2
    v_lshlrev_b32 v9, 1, v9
    v_and_b32 v10, 7, v2
    v_xor_b32 v9, v9, v10
    v_lshl_add_u32 v7, v9, 4, v7
    s_lshl_b32 s64, s5, 7
    v_add_u32 v10, s64, v7
    s_add_u32 m0, s7, 131072
    s_mov_b32 s40, 0
    buffer_load_dwordx4 v10, s[12:15], s40 offen lds
    s_mov_b32 s64, 0x05040100
    s_mov_b32 s65, 0x07060302
    v_perm_b32 v48, v100, v96, s64
    v_perm_b32 v49, v100, v96, s65
    v_dot2_f32_bf16 v32, v48, v88, 0
    v_dot2_f32_bf16 v33, v49, v88, 0
    v_perm_b32 v50, v101, v97, s64
    v_perm_b32 v51, v101, v97, s65
    s_add_u32 m0, s7, 135168
    s_mov_b32 s40, 65536
    buffer_load_dwordx4 v10, s[12:15], s40 offen lds
    v_dot2_f32_bf16 v34, v50, v88, 0
    v_dot2_f32_bf16 v35, v51, v88, 0
    v_perm_b32 v48, v102, v98, s64
    v_perm_b32 v49, v102, v98, s65
    v_dot2_f32_bf16 v36, v48, v88, 0
    v_dot2_f32_bf16 v37, v49, v88, 0
    v_perm_b32 v50, v103, v99, s64
    v_perm_b32 v51, v103, v99, s65
    s_add_u32 m0, s7, 147456
    s_mov_b32 s40, 1048576
    buffer_load_dwordx4 v10, s[12:15], s40 offen lds
    v_dot2_f32_bf16 v38, v50, v88, 0
    v_dot2_f32_bf16 v39, v51, v88, 0
    v_perm_b32 v48, v132, v128, s64
    v_perm_b32 v49, v132, v128, s65
    v_dot2_f32_bf16 v40, v48, v88, 0
    v_dot2_f32_bf16 v41, v49, v88, 0
    v_perm_b32 v50, v133, v129, s64
    v_perm_b32 v51, v133, v129, s65
    s_add_u32 m0, s7, 151552
    s_mov_b32 s40, 1114112
    buffer_load_dwordx4 v10, s[12:15], s40 offen lds
    v_dot2_f32_bf16 v42, v50, v88, 0
    v_dot2_f32_bf16 v43, v51, v88, 0
    v_perm_b32 v48, v134, v130, s64
    v_perm_b32 v49, v134, v130, s65
    v_dot2_f32_bf16 v44, v48, v88, 0
    v_dot2_f32_bf16 v45, v49, v88, 0
    v_perm_b32 v50, v135, v131, s64
    v_perm_b32 v51, v135, v131, s65
    s_add_u32 m0, s7, 139264
    s_mov_b32 s40, 131072
    buffer_load_dwordx4 v10, s[12:15], s40 offen lds
    v_dot2_f32_bf16 v46, v50, v88, 0
    v_dot2_f32_bf16 v47, v51, v88, 0
    v_perm_b32 v48, v108, v104, s64
    v_perm_b32 v49, v108, v104, s65
    v_dot2_f32_bf16 v32, v48, v89, v32
    v_dot2_f32_bf16 v33, v49, v89, v33
    v_perm_b32 v50, v109, v105, s64
    v_perm_b32 v51, v109, v105, s65
    s_add_u32 m0, s7, 143360
    s_mov_b32 s40, 196608
    buffer_load_dwordx4 v10, s[12:15], s40 offen lds
    v_dot2_f32_bf16 v34, v50, v89, v34
    v_dot2_f32_bf16 v35, v51, v89, v35
    v_perm_b32 v48, v110, v106, s64
    v_perm_b32 v49, v110, v106, s65
    v_dot2_f32_bf16 v36, v48, v89, v36
    v_dot2_f32_bf16 v37, v49, v89, v37
    v_perm_b32 v50, v111, v107, s64
    v_perm_b32 v51, v111, v107, s65
    s_add_u32 m0, s7, 155648
    s_mov_b32 s40, 1179648
    buffer_load_dwordx4 v10, s[12:15], s40 offen lds
    v_dot2_f32_bf16 v38, v50, v89, v38
    v_dot2_f32_bf16 v39, v51, v89, v39
    v_perm_b32 v48, v140, v136, s64
    v_perm_b32 v49, v140, v136, s65
    v_dot2_f32_bf16 v40, v48, v89, v40
    v_dot2_f32_bf16 v41, v49, v89, v41
    v_perm_b32 v50, v141, v137, s64
    v_perm_b32 v51, v141, v137, s65
    s_add_u32 m0, s7, 159744
    s_mov_b32 s40, 1245184
    buffer_load_dwordx4 v10, s[12:15], s40 offen lds
    v_dot2_f32_bf16 v42, v50, v89, v42
    v_dot2_f32_bf16 v43, v51, v89, v43
    v_perm_b32 v48, v142, v138, s64
    v_perm_b32 v49, v142, v138, s65
    v_dot2_f32_bf16 v44, v48, v89, v44
    v_dot2_f32_bf16 v45, v49, v89, v45
    v_perm_b32 v50, v143, v139, s64
    v_perm_b32 v51, v143, v139, s65
    s_add_u32 m0, s7, 73728
    s_mov_b32 s40, 262144
    buffer_load_dwordx4 v10, s[12:15], s40 offen lds
    v_dot2_f32_bf16 v46, v50, v89, v46
    v_dot2_f32_bf16 v47, v51, v89, v47
    s_add_u32 m0, s7, 77824
    s_mov_b32 s40, 327680
    buffer_load_dwordx4 v10, s[12:15], s40 offen lds
    s_add_u32 m0, s7, 81920
    s_mov_b32 s40, 1310720
    buffer_load_dwordx4 v10, s[12:15], s40 offen lds
    s_add_u32 m0, s7, 86016
    s_mov_b32 s40, 1376256
    buffer_load_dwordx4 v10, s[12:15], s40 offen lds
    s_waitcnt vmcnt(19)
    s_barrier
    s_add_u32 m0, s7, 114688
    s_mov_b32 s40, 393216
    buffer_load_dwordx4 v10, s[12:15], s40 offen lds
    s_mov_b32 s64, 0x05040100
    s_mov_b32 s65, 0x07060302
    v_perm_b32 v48, v116, v112, s64
    v_perm_b32 v49, v116, v112, s65
    v_dot2_f32_bf16 v32, v48, v90, v32
    v_dot2_f32_bf16 v33, v49, v90, v33
    v_perm_b32 v50, v117, v113, s64
    v_perm_b32 v51, v117, v113, s65
    v_dot2_f32_bf16 v34, v50, v90, v34
    v_dot2_f32_bf16 v35, v51, v90, v35
    v_perm_b32 v48, v118, v114, s64
    v_perm_b32 v49, v118, v114, s65
    v_dot2_f32_bf16 v36, v48, v90, v36
    v_dot2_f32_bf16 v37, v49, v90, v37
    v_perm_b32 v50, v119, v115, s64
    v_perm_b32 v51, v119, v115, s65
    v_dot2_f32_bf16 v38, v50, v90, v38
    v_dot2_f32_bf16 v39, v51, v90, v39
    v_perm_b32 v48, v148, v144, s64
    v_perm_b32 v49, v148, v144, s65
    s_add_u32 m0, s7, 118784
    s_mov_b32 s40, 458752
    buffer_load_dwordx4 v10, s[12:15], s40 offen lds
    v_dot2_f32_bf16 v40, v48, v90, v40
    v_dot2_f32_bf16 v41, v49, v90, v41
    v_perm_b32 v50, v149, v145, s64
    v_perm_b32 v51, v149, v145, s65
    v_dot2_f32_bf16 v42, v50, v90, v42
    v_dot2_f32_bf16 v43, v51, v90, v43
    v_perm_b32 v48, v150, v146, s64
    v_perm_b32 v49, v150, v146, s65
    v_dot2_f32_bf16 v44, v48, v90, v44
    v_dot2_f32_bf16 v45, v49, v90, v45
    v_perm_b32 v50, v151, v147, s64
    v_perm_b32 v51, v151, v147, s65
    v_dot2_f32_bf16 v46, v50, v90, v46
    v_dot2_f32_bf16 v47, v51, v90, v47
    v_perm_b32 v48, v124, v120, s64
    v_perm_b32 v49, v124, v120, s65
    v_dot2_f32_bf16 v32, v48, v91, v32
    v_dot2_f32_bf16 v33, v49, v91, v33
    v_perm_b32 v50, v125, v121, s64
    v_perm_b32 v51, v125, v121, s65
    s_add_u32 m0, s7, 122880
    s_mov_b32 s40, 1441792
    buffer_load_dwordx4 v10, s[12:15], s40 offen lds
    v_dot2_f32_bf16 v34, v50, v91, v34
    v_dot2_f32_bf16 v35, v51, v91, v35
    v_perm_b32 v48, v126, v122, s64
    v_perm_b32 v49, v126, v122, s65
    v_dot2_f32_bf16 v36, v48, v91, v36
    v_dot2_f32_bf16 v37, v49, v91, v37
    v_perm_b32 v50, v127, v123, s64
    v_perm_b32 v51, v127, v123, s65
    v_dot2_f32_bf16 v38, v50, v91, v38
    v_dot2_f32_bf16 v39, v51, v91, v39
    v_perm_b32 v48, v156, v152, s64
    v_perm_b32 v49, v156, v152, s65
    v_dot2_f32_bf16 v40, v48, v91, v40
    v_dot2_f32_bf16 v41, v49, v91, v41
    v_perm_b32 v50, v157, v153, s64
    v_perm_b32 v51, v157, v153, s65
    v_dot2_f32_bf16 v42, v50, v91, v42
    v_dot2_f32_bf16 v43, v51, v91, v43
    v_perm_b32 v48, v158, v154, s64
    v_perm_b32 v49, v158, v154, s65
    s_add_u32 m0, s7, 126976
    s_mov_b32 s40, 1507328
    buffer_load_dwordx4 v10, s[12:15], s40 offen lds
    v_dot2_f32_bf16 v44, v48, v91, v44
    v_dot2_f32_bf16 v45, v49, v91, v45
    v_perm_b32 v50, v159, v155, s64
    v_perm_b32 v51, v159, v155, s65
    v_dot2_f32_bf16 v46, v50, v91, v46
    v_dot2_f32_bf16 v47, v51, v91, v47
    s_nop 2
    s_nop 1
    v_permlane16_swap_b32 v32, v36
    v_permlane16_swap_b32 v33, v37
    v_permlane16_swap_b32 v34, v38
    v_permlane16_swap_b32 v35, v39
    v_permlane16_swap_b32 v40, v44
    v_permlane16_swap_b32 v41, v45
    v_permlane16_swap_b32 v42, v46
    v_permlane16_swap_b32 v43, v47
    v_add_f32 v32, v32, v36
    v_add_f32 v33, v33, v37
    v_add_f32 v34, v34, v38
    v_add_f32 v35, v35, v39
    v_add_f32 v40, v40, v44
    v_add_f32 v41, v41, v45
    v_add_f32 v42, v42, v46
    v_add_f32 v43, v43, v47
    s_nop 1
    v_permlane32_swap_b32 v32, v40
    v_permlane32_swap_b32 v33, v41
    v_permlane32_swap_b32 v34, v42
    v_permlane32_swap_b32 v35, v43
    v_add_f32 v32, v32, v40
    v_add_f32 v33, v33, v41
    v_add_f32 v34, v34, v42
    v_add_f32 v35, v35, v43
    s_mov_b32 exec_lo, 0x3fff3fff
    s_mov_b32 exec_hi, 0x3fff3fff
    buffer_store_dwordx4 v[32:35], v12, s[16:19], 0 offen sc0 sc1
    s_mov_b64 exec, -1
    s_barrier
    v_lshrrev_b32 v230, 3, v0
    s_lshl_b32 s64, s4, 7
    v_add_u32 v230, s64, v230
    v_lshlrev_b32 v231, 11, v230
    v_and_b32 v3, 7, v0
    v_lshl_add_u32 v231, v3, 4, v231
    s_lshl_b32 s64, s5, 7
    v_add_u32 v231, s64, v231
    s_mov_b32 s64, 131072
    v_lshlrev_b32 v3, 2, v230
    v_add_u32 v3, 6709248, v3
    buffer_load_dwordx4 v[220:223], v231, s[8:11], 0 offen
    buffer_load_dwordx4 v[224:227], v231, s[8:11], s64 offen
    buffer_load_dword v228, v3, s[16:19], 0 offen sc1
    buffer_load_dword v229, v3, s[16:19], 0 offen offset:256 sc1
    s_add_u32 m0, s7, 40960
    s_mov_b32 s40, 524288
    buffer_load_dwordx4 v10, s[12:15], s40 offen lds
    s_add_u32 m0, s7, 45056
    s_mov_b32 s40, 589824
    buffer_load_dwordx4 v10, s[12:15], s40 offen lds
    s_add_u32 m0, s7, 49152
    s_mov_b32 s40, 1572864
    buffer_load_dwordx4 v10, s[12:15], s40 offen lds
    s_add_u32 m0, s7, 53248
    s_mov_b32 s40, 1638400
    buffer_load_dwordx4 v10, s[12:15], s40 offen lds
    s_add_u32 m0, s7, 8192
    s_mov_b32 s40, 655360
    buffer_load_dwordx4 v10, s[12:15], s40 offen lds
    s_add_u32 m0, s7, 12288
    s_mov_b32 s40, 720896
    buffer_load_dwordx4 v10, s[12:15], s40 offen lds
    s_add_u32 m0, s7, 57344
    s_mov_b32 s40, 1703936
    buffer_load_dwordx4 v10, s[12:15], s40 offen lds
    s_add_u32 m0, s7, 61440
    s_mov_b32 s40, 1769472
    buffer_load_dwordx4 v10, s[12:15], s40 offen lds
    s_add_u32 m0, s7, 16384
    s_mov_b32 s40, 786432
    buffer_load_dwordx4 v10, s[12:15], s40 offen lds
    s_add_u32 m0, s7, 20480
    s_mov_b32 s40, 851968
    buffer_load_dwordx4 v10, s[12:15], s40 offen lds
    s_add_u32 m0, s7, 65536
    s_mov_b32 s40, 1835008
    buffer_load_dwordx4 v10, s[12:15], s40 offen lds
    s_add_u32 m0, s7, 69632
    s_mov_b32 s40, 1900544
    buffer_load_dwordx4 v10, s[12:15], s40 offen lds
    s_add_u32 m0, s7, 98304
    s_mov_b32 s40, 917504
    buffer_load_dwordx4 v10, s[12:15], s40 offen lds
    s_add_u32 m0, s7, 102400
    s_mov_b32 s40, 983040
    buffer_load_dwordx4 v10, s[12:15], s40 offen lds
    s_add_u32 m0, s7, 90112
    s_mov_b32 s40, 1966080
    buffer_load_dwordx4 v10, s[12:15], s40 offen lds
    s_add_u32 m0, s7, 94208
    s_mov_b32 s40, 2031616
    buffer_load_dwordx4 v10, s[12:15], s40 offen lds
    s_mov_b64 exec, 1
    v_mov_b32 v20, 0
    buffer_atomic_or v20, v23, s[16:19], 0 offen sc0
    s_mov_b64 exec, -1
    v_add_u32 v17, s70, v6
    v_lshrrev_b32 v18, 2, v2
    v_mul_u32_u24 v18, 1152, v18
    v_and_b32 v19, 3, v2
    v_lshl_add_u32 v18, v19, 4, v18
    s_add_u32 s64, s70, 1024
    v_add_u32 v18, s64, v18
    v_bfe_u32 v26, v2, 3, 1
    v_lshl_add_u32 v26, v26, 2, v19
    v_bfe_u32 v27, v2, 2, 1
    v_lshrrev_b32 v28, 5, v2
    v_cmp_eq_u32 vcc, v27, v28
    v_and_b32 v27, 16, v2
    v_cmp_eq_u32 s[64:65], 0, v27
    s_and_b64 vcc, vcc, s[64:65]
    v_and_b32 v27, 1, v26
    v_lshlrev_b32 v27, 4, v27
    v_mov_b32 v28, 0x3f80
    v_lshlrev_b32 v27, v27, v28
    v_cndmask_b32 v27, 0, v27, vcc
    v_lshrrev_b32 v26, 1, v26
    v_cmp_eq_u32 vcc, 0, v26
    s_nop 1
    v_cndmask_b32 v48, 0, v27, vcc
    v_cmp_eq_u32 vcc, 1, v26
    s_nop 1
    v_cndmask_b32 v49, 0, v27, vcc
    v_cmp_eq_u32 vcc, 2, v26
    s_nop 1
    v_cndmask_b32 v50, 0, v27, vcc
    v_cmp_eq_u32 vcc, 3, v26
    s_nop 1
    v_cndmask_b32 v51, 0, v27, vcc
    v_mov_b32 v128, 0
    v_mov_b32 v129, 0
    v_mov_b32 v130, 0
    v_mov_b32 v131, 0
    v_mov_b32 v132, 0
    v_mov_b32 v133, 0
    v_mov_b32 v134, 0
    v_mov_b32 v135, 0
    v_mov_b32 v136, 0
    v_mov_b32 v137, 0
    v_mov_b32 v138, 0
    v_mov_b32 v139, 0
    v_mov_b32 v140, 0
    v_mov_b32 v141, 0
    v_mov_b32 v142, 0
    v_mov_b32 v143, 0
    s_mov_b32 s66, 0xffff
    s_mov_b32 s65, 0
    s_waitcnt vmcnt(0)
G_loop:
    v_readfirstlane_b32 s68, v20
    s_and_b32 s68, s68, s66
    s_andn2_b32 s66, s66, s68
    s_bcnt1_i32_b32 s67, s68
    s_cmp_eq_u32 s67, 0
    s_cbranch_scc1 G_l0
    s_cmp_gt_u32 s67, 8
    s_cbranch_scc1 G_lt_1
    s_cmp_gt_u32 s67, 4
    s_cbranch_scc1 G_lt_2
    s_cmp_gt_u32 s67, 2
    s_cbranch_scc1 G_lt_3
    s_cmp_eq_u32 s67, 1
    s_cbranch_scc1 G_l1
    s_branch G_l2
G_lt_3:
    s_cmp_eq_u32 s67, 3
    s_cbranch_scc1 G_l3
    s_branch G_l4
G_lt_2:
    s_cmp_gt_u32 s67, 6
    s_cbranch_scc1 G_lt_4
    s_cmp_eq_u32 s67, 5
    s_cbranch_scc1 G_l5
    s_branch G_l6
G_lt_4:
    s_cmp_eq_u32 s67, 7
    s_cbranch_scc1 G_l7
    s_branch G_l8
G_lt_1:
    s_cmp_gt_u32 s67, 12
    s_cbranch_scc1 G_lt_5
    s_cmp_gt_u32 s67, 10
    s_cbranch_scc1 G_lt_6
    s_cmp_eq_u32 s67, 9
    s_cbranch_scc1 G_l9
    s_branch G_l10
G_lt_6:
    s_cmp_eq_u32 s67, 11
    s_cbranch_scc1 G_l11
    s_branch G_l12
G_lt_5:
    s_cmp_gt_u32 s67, 14
    s_cbranch_scc1 G_lt_7
    s_cmp_eq_u32 s67, 13
    s_cbranch_scc1 G_l13
    s_branch G_l14
G_lt_7:
    s_cmp_eq_u32 s67, 15
    s_cbranch_scc1 G_l15
G_l16:
    s_ff1_i32_b32 s55, s68
    s_bitset0_b32 s68, s55
    s_mul_i32 s64, s55, 1152
    buffer_load_dwordx4 v[124:127], v17, s[16:19], s64 offen sc1
G_l15:
    s_ff1_i32_b32 s54, s68
    s_bitset0_b32 s68, s54
    s_mul_i32 s64, s54, 1152
    buffer_load_dwordx4 v[120:123], v17, s[16:19], s64 offen sc1
G_l14:
    s_ff1_i32_b32 s53, s68
    s_bitset0_b32 s68, s53
    s_mul_i32 s64, s53, 1152
    buffer_load_dwordx4 v[116:119], v17, s[16:19], s64 offen sc1
G_l13:
    s_ff1_i32_b32 s52, s68
    s_bitset0_b32 s68, s52
    s_mul_i32 s64, s52, 1152
    buffer_load_dwordx4 v[112:115], v17, s[16:19], s64 offen sc1
G_l12:
    s_ff1_i32_b32 s51, s68
    s_bitset0_b32 s68, s51
    s_mul_i32 s64, s51, 1152
    buffer_load_dwordx4 v[108:111], v17, s[16:19], s64 offen sc1
G_l11:
    s_ff1_i32_b32 s50, s68
    s_bitset0_b32 s68, s50
    s_mul_i32 s64, s50, 1152
    buffer_load_dwordx4 v[104:107], v17, s[16:19], s64 offen sc1
G_l10:
    s_ff1_i32_b32 s49, s68
    s_bitset0_b32 s68, s49
    s_mul_i32 s64, s49, 1152
    buffer_load_dwordx4 v[100:103], v17, s[16:19], s64 offen sc1
G_l9:
    s_ff1_i32_b32 s48, s68
    s_bitset0_b32 s68, s48
    s_mul_i32 s64, s48, 1152
    buffer_load_dwordx4 v[96:99], v17, s[16:19], s64 offen sc1
G_l8:
    s_ff1_i32_b32 s47, s68
    s_bitset0_b32 s68, s47
    s_mul_i32 s64, s47, 1152
    buffer_load_dwordx4 v[92:95], v17, s[16:19], s64 offen sc1
G_l7:
    s_ff1_i32_b32 s46, s68
    s_bitset0_b32 s68, s46
    s_mul_i32 s64, s46, 1152
    buffer_load_dwordx4 v[88:91], v17, s[16:19], s64 offen sc1
G_l6:
    s_ff1_i32_b32 s45, s68
    s_bitset0_b32 s68, s45
    s_mul_i32 s64, s45, 1152
    buffer_load_dwordx4 v[84:87], v17, s[16:19], s64 offen sc1
G_l5:
    s_ff1_i32_b32 s44, s68
    s_bitset0_b32 s68, s44
    s_mul_i32 s64, s44, 1152
    buffer_load_dwordx4 v[80:83], v17, s[16:19], s64 offen sc1
G_l4:
    s_ff1_i32_b32 s43, s68
    s_bitset0_b32 s68, s43
    s_mul_i32 s64, s43, 1152
    buffer_load_dwordx4 v[76:79], v17, s[16:19], s64 offen sc1
G_l3:
    s_ff1_i32_b32 s42, s68
    s_bitset0_b32 s68, s42
    s_mul_i32 s64, s42, 1152
    buffer_load_dwordx4 v[72:75], v17, s[16:19], s64 offen sc1
G_l2:
    s_ff1_i32_b32 s41, s68
    s_bitset0_b32 s68, s41
    s_mul_i32 s64, s41, 1152
    buffer_load_dwordx4 v[68:71], v17, s[16:19], s64 offen sc1
G_l1:
    s_ff1_i32_b32 s40, s68
    s_bitset0_b32 s68, s40
    s_mul_i32 s64, s40, 1152
    buffer_load_dwordx4 v[64:67], v17, s[16:19], s64 offen sc1
G_l0:
    s_mov_b32 s68, s66
    s_cmp_eq_u32 s66, 0
    s_cbranch_scc1 G_z
    s_cmp_lg_u32 s67, 0
    s_cbranch_scc1 G_p
    s_sleep 2
G_p:
    s_mov_b64 exec, 1
    v_mov_b32 v20, 0
    buffer_atomic_or v20, v23, s[16:19], 0 offen sc0
    s_mov_b64 exec, -1
    s_branch G_proc
G_z:
    buffer_load_dwordx4 v[56:59], v18, s[16:19], 0 offen sc1
G_proc:
    s_cmp_eq_u32 s67, 0
    s_cbranch_scc1 G_q0
    s_cmp_gt_u32 s67, 8
    s_cbranch_scc1 G_qt_8
    s_cmp_gt_u32 s67, 4
    s_cbranch_scc1 G_qt_9
    s_cmp_gt_u32 s67, 2
    s_cbranch_scc1 G_qt_10
    s_cmp_eq_u32 s67, 1
    s_cbranch_scc1 G_q1
    s_branch G_q2
G_qt_10:
    s_cmp_eq_u32 s67, 3
    s_cbranch_scc1 G_q3
    s_branch G_q4
G_qt_9:
    s_cmp_gt_u32 s67, 6
    s_cbranch_scc1 G_qt_11
    s_cmp_eq_u32 s67, 5
    s_cbranch_scc1 G_q5
    s_branch G_q6
G_qt_11:
    s_cmp_eq_u32 s67, 7
    s_cbranch_scc1 G_q7
    s_branch G_q8
G_qt_8:
    s_cmp_gt_u32 s67, 12
    s_cbranch_scc1 G_qt_12
    s_cmp_gt_u32 s67, 10
    s_cbranch_scc1 G_qt_13
    s_cmp_eq_u32 s67, 9
    s_cbranch_scc1 G_q9
    s_branch G_q10
G_qt_13:
    s_cmp_eq_u32 s67, 11
    s_cbranch_scc1 G_q11
    s_branch G_q12
G_qt_12:
    s_cmp_gt_u32 s67, 14
    s_cbranch_scc1 G_qt_14
    s_cmp_eq_u32 s67, 13
    s_cbranch_scc1 G_q13
    s_branch G_q14
G_qt_14:
    s_cmp_eq_u32 s67, 15
    s_cbranch_scc1 G_q15
G_q16:
    s_waitcnt vmcnt(16)
    v_max3_u32 v21, v124, v125, v126
    v_max_u32 v21, v21, v127
    v_cmp_eq_u32 vcc, -1, v21
    s_cbranch_vccnz G_f15
    v_mfma_f32_32x32x16_bf16 v[128:143], v[48:51], v[124:127], v[128:143]
G_q15:
    s_waitcnt vmcnt(15)
    v_max3_u32 v21, v120, v121, v122
    v_max_u32 v21, v21, v123
    v_cmp_eq_u32 vcc, -1, v21
    s_cbranch_vccnz G_f14
    v_mfma_f32_32x32x16_bf16 v[128:143], v[48:51], v[120:123], v[128:143]
G_q14:
    s_waitcnt vmcnt(14)
    v_max3_u32 v21, v116, v117, v118
    v_max_u32 v21, v21, v119
    v_cmp_eq_u32 vcc, -1, v21
    s_cbranch_vccnz G_f13
    v_mfma_f32_32x32x16_bf16 v[128:143], v[48:51], v[116:119], v[128:143]
G_q13:
    s_waitcnt vmcnt(13)
    v_max3_u32 v21, v112, v113, v114
    v_max_u32 v21, v21, v115
    v_cmp_eq_u32 vcc, -1, v21
    s_cbranch_vccnz G_f12
    v_mfma_f32_32x32x16_bf16 v[128:143], v[48:51], v[112:115], v[128:143]
G_q12:
    s_waitcnt vmcnt(12)
    v_max3_u32 v21, v108, v109, v110
    v_max_u32 v21, v21, v111
    v_cmp_eq_u32 vcc, -1, v21
    s_cbranch_vccnz G_f11
    v_mfma_f32_32x32x16_bf16 v[128:143], v[48:51], v[108:111], v[128:143]
G_q11:
    s_waitcnt vmcnt(11)
    v_max3_u32 v21, v104, v105, v106
    v_max_u32 v21, v21, v107
    v_cmp_eq_u32 vcc, -1, v21
    s_cbranch_vccnz G_f10
    v_mfma_f32_32x32x16_bf16 v[128:143], v[48:51], v[104:107], v[128:143]
G_q10:
    s_waitcnt vmcnt(10)
    v_max3_u32 v21, v100, v101, v102
    v_max_u32 v21, v21, v103
    v_cmp_eq_u32 vcc, -1, v21
    s_cbranch_vccnz G_f9
    v_mfma_f32_32x32x16_bf16 v[128:143], v[48:51], v[100:103], v[128:143]
G_q9:
    s_waitcnt vmcnt(9)
    v_max3_u32 v21, v96, v97, v98
    v_max_u32 v21, v21, v99
    v_cmp_eq_u32 vcc, -1, v21
    s_cbranch_vccnz G_f8
    v_mfma_f32_32x32x16_bf16 v[128:143], v[48:51], v[96:99], v[128:143]
G_q8:
    s_waitcnt vmcnt(8)
    v_max3_u32 v21, v92, v93, v94
    v_max_u32 v21, v21, v95
    v_cmp_eq_u32 vcc, -1, v21
    s_cbranch_vccnz G_f7
    v_mfma_f32_32x32x16_bf16 v[128:143], v[48:51], v[92:95], v[128:143]
G_q7:
    s_waitcnt vmcnt(7)
    v_max3_u32 v21, v88, v89, v90
    v_max_u32 v21, v21, v91
    v_cmp_eq_u32 vcc, -1, v21
    s_cbranch_vccnz G_f6
    v_mfma_f32_32x32x16_bf16 v[128:143], v[48:51], v[88:91], v[128:143]
G_q6:
    s_waitcnt vmcnt(6)
    v_max3_u32 v21, v84, v85, v86
    v_max_u32 v21, v21, v87
    v_cmp_eq_u32 vcc, -1, v21
    s_cbranch_vccnz G_f5
    v_mfma_f32_32x32x16_bf16 v[128:143], v[48:51], v[84:87], v[128:143]
G_q5:
    s_waitcnt vmcnt(5)
    v_max3_u32 v21, v80, v81, v82
    v_max_u32 v21, v21, v83
    v_cmp_eq_u32 vcc, -1, v21
    s_cbranch_vccnz G_f4
    v_mfma_f32_32x32x16_bf16 v[128:143], v[48:51], v[80:83], v[128:143]
G_q4:
    s_waitcnt vmcnt(4)
    v_max3_u32 v21, v76, v77, v78
    v_max_u32 v21, v21, v79
    v_cmp_eq_u32 vcc, -1, v21
    s_cbranch_vccnz G_f3
    v_mfma_f32_32x32x16_bf16 v[128:143], v[48:51], v[76:79], v[128:143]
G_q3:
    s_waitcnt vmcnt(3)
    v_max3_u32 v21, v72, v73, v74
    v_max_u32 v21, v21, v75
    v_cmp_eq_u32 vcc, -1, v21
    s_cbranch_vccnz G_f2
    v_mfma_f32_32x32x16_bf16 v[128:143], v[48:51], v[72:75], v[128:143]
G_q2:
    s_waitcnt vmcnt(2)
    v_max3_u32 v21, v68, v69, v70
    v_max_u32 v21, v21, v71
    v_cmp_eq_u32 vcc, -1, v21
    s_cbranch_vccnz G_f1
    v_mfma_f32_32x32x16_bf16 v[128:143], v[48:51], v[68:71], v[128:143]
G_q1:
    s_waitcnt vmcnt(1)
    v_max3_u32 v21, v64, v65, v66
    v_max_u32 v21, v21, v67
    v_cmp_eq_u32 vcc, -1, v21
    s_cbranch_vccnz G_f0
    v_mfma_f32_32x32x16_bf16 v[128:143], v[48:51], v[64:67], v[128:143]
G_q0:
    s_waitcnt vmcnt(0)
    s_add_u32 s65, s65, 1
    s_cmp_ge_u32 s65, 40000
    s_cbranch_scc1 G_done
    s_cmp_lg_u32 s68, 0
    s_cbranch_scc1 G_loop
    v_mov_b32 v20, -1
    s_cmp_lg_u32 s66, 0
    s_cbranch_scc1 G_loop
    v_max3_u32 v21, v56, v57, v58
    v_max_u32 v21, v21, v59
    v_cmp_eq_u32 vcc, -1, v21
    s_cbranch_vccnz G_loop
G_done:
    v_add_u32 v16, s7, v6
    v_add_f32_dpp v56, v56, v56 row_ror:4 row_mask:0xf bank_mask:0xf
    v_add_f32_dpp v57, v57, v57 row_ror:4 row_mask:0xf bank_mask:0xf
    v_add_f32_dpp v58, v58, v58 row_ror:4 row_mask:0xf bank_mask:0xf
    v_add_f32_dpp v59, v59, v59 row_ror:4 row_mask:0xf bank_mask:0xf
    v_add_f32_dpp v56, v56, v56 row_ror:8 row_mask:0xf bank_mask:0xf
    v_add_f32_dpp v57, v57, v57 row_ror:8 row_mask:0xf bank_mask:0xf
    v_add_f32_dpp v58, v58, v58 row_ror:8 row_mask:0xf bank_mask:0xf
    v_add_f32_dpp v59, v59, v59 row_ror:8 row_mask:0xf bank_mask:0xf
    v_mov_b32 v64, v56
    v_mov_b32 v65, v57
    v_mov_b32 v66, v58
    v_mov_b32 v67, v59
    s_nop 0
    v_permlane16_swap_b32 v56, v64
    v_permlane16_swap_b32 v57, v65
    v_permlane16_swap_b32 v58, v66
    v_permlane16_swap_b32 v59, v67
    v_add_f32 v56, v56, v64
    v_add_f32 v57, v57, v65
    v_add_f32 v58, v58, v66
    v_add_f32 v59, v59, v67
    v_mov_b32 v64, v56
    v_mov_b32 v65, v57
    v_mov_b32 v66, v58
    v_mov_b32 v67, v59
    s_nop 0
    v_permlane32_swap_b32 v56, v64
    v_permlane32_swap_b32 v57, v65
    v_permlane32_swap_b32 v58, v66
    v_permlane32_swap_b32 v59, v67
    v_add_f32 v56, v56, v64
    v_add_f32 v57, v57, v65
    v_add_f32 v58, v58, v66
    v_add_f32 v59, v59, v67
    v_cvt_pk_bf16_f32 v60, v128, v129
    v_cvt_pk_bf16_f32 v61, v130, v131
    v_cvt_pk_bf16_f32 v62, v132, v133
    v_cvt_pk_bf16_f32 v63, v134, v135
    ds_write_b128 v16, v[60:63] offset:0
    v_cvt_pk_bf16_f32 v56, v56, v57
    v_cvt_pk_bf16_f32 v57, v58, v59
    s_lshr_b32 s64, s6, 1
    s_lshl_b32 s64, s64, 6
    s_and_b32 s65, s6, 1
    s_lshl_b32 s65, s65, 3
    s_add_u32 s64, s64, s65
    v_lshl_add_u32 v16, v2, 4, s64
    s_mov_b64 exec, 15
    ds_write_b64 v16, v[56:57] offset:4096
    s_mov_b64 exec, -1
    s_waitcnt lgkmcnt(0)
    s_barrier
    v_lshrrev_b32 v18, 3, v2
    v_lshlrev_b32 v18, 2, v18
    ds_read_b32 v24, v18 offset:4352
    ds_read_b32 v25, v18 offset:4384
    ds_read_b32 v26, v18 offset:4416
    ds_read_b32 v27, v18 offset:4448
    ds_read_b32 v28, v18 offset:4480
    ds_read_b32 v29, v18 offset:4512
    ds_read_b32 v30, v18 offset:4544
    s_waitcnt lgkmcnt(0)
    v_lshlrev_b32 v48, 16, v192
    v_and_b32 v49, 0xffff0000, v192
    v_mul_f32 v32, v48, v24
    v_mul_f32 v33, v49, v24
    v_lshlrev_b32 v48, 16, v193
    v_and_b32 v49, 0xffff0000, v193
    v_mul_f32 v34, v48, v24
    v_mul_f32 v35, v49, v24
    v_lshlrev_b32 v48, 16, v194
    v_and_b32 v49, 0xffff0000, v194
    v_mul_f32 v36, v48, v24
    v_mul_f32 v37, v49, v24
    v_lshlrev_b32 v48, 16, v195
    v_and_b32 v49, 0xffff0000, v195
    v_mul_f32 v38, v48, v24
    v_mul_f32 v39, v49, v24
    v_lshlrev_b32 v48, 16, v196
    v_and_b32 v49, 0xffff0000, v196
    v_fmac_f32 v32, v48, v25
    v_fmac_f32 v33, v49, v25
    v_lshlrev_b32 v48, 16, v197
    v_and_b32 v49, 0xffff0000, v197
    v_fmac_f32 v34, v48, v25
    v_fmac_f32 v35, v49, v25
    v_lshlrev_b32 v48, 16, v198
    v_and_b32 v49, 0xffff0000, v198
    v_fmac_f32 v36, v48, v25
    v_fmac_f32 v37, v49, v25
    v_lshlrev_b32 v48, 16, v199
    v_and_b32 v49, 0xffff0000, v199
    v_fmac_f32 v38, v48, v25
    v_fmac_f32 v39, v49, v25
    v_lshlrev_b32 v48, 16, v200
    v_and_b32 v49, 0xffff0000, v200
    v_fmac_f32 v32, v48, v26
    v_fmac_f32 v33, v49, v26
    v_lshlrev_b32 v48, 16, v201
    v_and_b32 v49, 0xffff0000, v201
    v_fmac_f32 v34, v48, v26
    v_fmac_f32 v35, v49, v26
    v_lshlrev_b32 v48, 16, v202
    v_and_b32 v49, 0xffff0000, v202
    v_fmac_f32 v36, v48, v26
    v_fmac_f32 v37, v49, v26
    v_lshlrev_b32 v48, 16, v203
    v_and_b32 v49, 0xffff0000, v203
    v_fmac_f32 v38, v48, v26
    v_fmac_f32 v39, v49, v26
    v_lshlrev_b32 v48, 16, v204
    v_and_b32 v49, 0xffff0000, v204
    v_fmac_f32 v32, v48, v27
    v_fmac_f32 v33, v49, v27
    v_lshlrev_b32 v48, 16, v205
    v_and_b32 v49, 0xffff0000, v205
    v_fmac_f32 v34, v48, v27
    v_fmac_f32 v35, v49, v27
    v_lshlrev_b32 v48, 16, v206
    v_and_b32 v49, 0xffff0000, v206
    v_fmac_f32 v36, v48, v27
    v_fmac_f32 v37, v49, v27
    v_lshlrev_b32 v48, 16, v207
    v_and_b32 v49, 0xffff0000, v207
    v_fmac_f32 v38, v48, v27
    v_fmac_f32 v39, v49, v27
    v_lshlrev_b32 v48, 16, v208
    v_and_b32 v49, 0xffff0000, v208
    v_fmac_f32 v32, v48, v28
    v_fmac_f32 v33, v49, v28
    v_lshlrev_b32 v48, 16, v209
    v_and_b32 v49, 0xffff0000, v209
    v_fmac_f32 v34, v48, v28
    v_fmac_f32 v35, v49, v28
    v_lshlrev_b32 v48, 16, v210
    v_and_b32 v49, 0xffff0000, v210
    v_fmac_f32 v36, v48, v28
    v_fmac_f32 v37, v49, v28
    v_lshlrev_b32 v48, 16, v211
    v_and_b32 v49, 0xffff0000, v211
    v_fmac_f32 v38, v48, v28
    v_fmac_f32 v39, v49, v28
    v_lshlrev_b32 v48, 16, v212
    v_and_b32 v49, 0xffff0000, v212
    v_fmac_f32 v32, v48, v29
    v_fmac_f32 v33, v49, v29
    v_lshlrev_b32 v48, 16, v213
    v_and_b32 v49, 0xffff0000, v213
    v_fmac_f32 v34, v48, v29
    v_fmac_f32 v35, v49, v29
    v_lshlrev_b32 v48, 16, v214
    v_and_b32 v49, 0xffff0000, v214
    v_fmac_f32 v36, v48, v29
    v_fmac_f32 v37, v49, v29
    v_lshlrev_b32 v48, 16, v215
    v_and_b32 v49, 0xffff0000, v215
    v_fmac_f32 v38, v48, v29
    v_fmac_f32 v39, v49, v29
    v_lshlrev_b32 v48, 16, v216
    v_and_b32 v49, 0xffff0000, v216
    v_fmac_f32 v32, v48, v30
    v_fmac_f32 v33, v49, v30
    v_lshlrev_b32 v48, 16, v217
    v_and_b32 v49, 0xffff0000, v217
    v_fmac_f32 v34, v48, v30
    v_fmac_f32 v35, v49, v30
    v_lshlrev_b32 v48, 16, v218
    v_and_b32 v49, 0xffff0000, v218
    v_fmac_f32 v36, v48, v30
    v_fmac_f32 v37, v49, v30
    v_lshlrev_b32 v48, 16, v219
    v_and_b32 v49, 0xffff0000, v219
    v_fmac_f32 v38, v48, v30
    v_fmac_f32 v39, v49, v30
    s_nop 1
    v_permlane32_swap_b32 v32, v36
    v_permlane32_swap_b32 v33, v37
    v_permlane32_swap_b32 v34, v38
    v_permlane32_swap_b32 v35, v39
    v_add_f32 v32, v32, v36
    v_add_f32 v33, v33, v37
    v_add_f32 v34, v34, v38
    v_add_f32 v35, v35, v39
    s_nop 1
    v_permlane16_swap_b32 v32, v34
    v_permlane16_swap_b32 v33, v35
    v_add_f32 v32, v32, v34
    v_add_f32 v33, v33, v35
    s_nop 1
    v_add_f32_dpp v32, v32, v32 row_ror:8 row_mask:0xf bank_mask:0xf
    v_add_f32_dpp v33, v33, v33 row_ror:8 row_mask:0xf bank_mask:0xf
    v_and_b32 v16, 7, v2
    v_lshlrev_b32 v16, 5, v16
    v_lshl_add_u32 v16, v8, 3, v16
    s_lshl_b32 s64, s2, 10
    s_lshl_b32 s65, s6, 8
    s_add_u32 s64, s64, s65
    s_add_u32 s64, s64, 6447104
    s_mov_b32 exec_lo, 0x00ff00ff
    s_mov_b32 exec_hi, 0x00ff00ff
    buffer_store_dwordx2 v[32:33], v16, s[16:19], s64 offen sc0 sc1
    s_mov_b64 exec, -1
    s_lshl_b32 s64, s4, 3
    s_add_u32 s64, s64, s3
    s_lshl_b32 s64, s64, 7
    s_add_u32 s64, s64, 5382144
    v_mov_b32 v14, s64
    s_mov_b64 exec, 1
    v_mov_b32 v15, 0
    buffer_atomic_or v15, v14, s[16:19], 0 offen sc0
    s_mov_b64 exec, -1
    v_sub_f32 v248, 1.0, v228
    v_cvt_pk_bf16_f32 v248, v248, v248
    v_lshlrev_b32 v248, 16, v248
    v_lshlrev_b32 v232, 16, v220
    v_and_b32 v233, 0xffff0000, v220
    v_mul_f32 v232, v232, v248
    v_mul_f32 v233, v233, v248
    v_cvt_pk_bf16_f32 v3, v232, v233
    v_lshlrev_b32 v232, 16, v3
    v_and_b32 v233, 0xffff0000, v3
    v_lshlrev_b32 v234, 16, v221
    v_and_b32 v235, 0xffff0000, v221
    v_mul_f32 v234, v234, v248
    v_mul_f32 v235, v235, v248
    v_cvt_pk_bf16_f32 v3, v234, v235
    v_lshlrev_b32 v234, 16, v3
    v_and_b32 v235, 0xffff0000, v3
    v_lshlrev_b32 v236, 16, v222
    v_and_b32 v237, 0xffff0000, v222
    v_mul_f32 v236, v236, v248
    v_mul_f32 v237, v237, v248
    v_cvt_pk_bf16_f32 v3, v236, v237
    v_lshlrev_b32 v236, 16, v3
    v_and_b32 v237, 0xffff0000, v3
    v_lshlrev_b32 v238, 16, v223
    v_and_b32 v239, 0xffff0000, v223
    v_mul_f32 v238, v238, v248
    v_mul_f32 v239, v239, v248
    v_cvt_pk_bf16_f32 v3, v238, v239
    v_lshlrev_b32 v238, 16, v3
    v_and_b32 v239, 0xffff0000, v3
    v_sub_f32 v249, 1.0, v229
    v_cvt_pk_bf16_f32 v249, v249, v249
    v_lshlrev_b32 v249, 16, v249
    v_lshlrev_b32 v240, 16, v224
    v_and_b32 v241, 0xffff0000, v224
    v_mul_f32 v240, v240, v249
    v_mul_f32 v241, v241, v249
    v_cvt_pk_bf16_f32 v3, v240, v241
    v_lshlrev_b32 v240, 16, v3
    v_and_b32 v241, 0xffff0000, v3
    v_lshlrev_b32 v242, 16, v225
    v_and_b32 v243, 0xffff0000, v225
    v_mul_f32 v242, v242, v249
    v_mul_f32 v243, v243, v249
    v_cvt_pk_bf16_f32 v3, v242, v243
    v_lshlrev_b32 v242, 16, v3
    v_and_b32 v243, 0xffff0000, v3
    v_lshlrev_b32 v244, 16, v226
    v_and_b32 v245, 0xffff0000, v226
    v_mul_f32 v244, v244, v249
    v_mul_f32 v245, v245, v249
    v_cvt_pk_bf16_f32 v3, v244, v245
    v_lshlrev_b32 v244, 16, v3
    v_and_b32 v245, 0xffff0000, v3
    v_lshlrev_b32 v246, 16, v227
    v_and_b32 v247, 0xffff0000, v227
    v_mul_f32 v246, v246, v249
    v_mul_f32 v247, v247, v249
    v_cvt_pk_bf16_f32 v3, v246, v247
    v_lshlrev_b32 v246, 16, v3
    v_and_b32 v247, 0xffff0000, v3
    s_branch P2_start
C_start:
    s_getpc_b64 s[68:69]
C_pc:
    s_sub_u32 s68, s68, C_pc-gated_mix__linear_attn_block__moe_arch_mod__prompt_kernel
    s_subb_u32 s69, s69, 0
    s_lshr_b32 s64, s2, 3
    s_lshl_b32 s64, s64, 2
    s_add_u32 s64, s64, s3
    s_mul_i32 s64, s64, 256
    s_mov_b32 s65, CODE_END-gated_mix__linear_attn_block__moe_arch_mod__prompt_kernel-4
    s_min_u32 s66, s64, s65
    s_load_dword s75, s[68:69], s66
    s_add_u32 s64, s64, 64
    s_min_u32 s66, s64, s65
    s_load_dword s75, s[68:69], s66
    s_add_u32 s64, s64, 64
    s_min_u32 s66, s64, s65
    s_load_dword s75, s[68:69], s66
    s_add_u32 s64, s64, 64
    s_min_u32 s66, s64, s65
    s_load_dword s75, s[68:69], s66
    s_add_u32 s64, s64, 64
    s_and_b32 s6, s3, 1
    s_lshr_b32 s7, s3, 1
    v_and_b32 v3, 15, v2
    s_lshl_b32 s64, s6, 6
    v_add_u32 v3, s64, v3
    v_lshlrev_b32 v3, 7, v3
    v_add_u32 v3, 8192, v3
    v_bfe_u32 v56, v2, 1, 3
    v_lshrrev_b32 v57, 4, v2
    v_xor_b32 v56, v56, v57
    v_lshl_add_u32 v4, v56, 4, v3
    v_xor_b32 v5, 64, v4
    v_bfe_u32 v56, v2, 2, 2
    v_lshl_add_u32 v58, v57, 3, v56
    v_lshlrev_b32 v58, 7, v58
    v_lshrrev_b32 v56, 1, v56
    v_xor_b32 v56, s7, v56
    v_lshl_add_u32 v58, v56, 6, v58
    v_and_b32 v57, 1, v57
    v_lshl_add_u32 v58, v57, 5, v58
    v_and_b32 v56, 3, v2
    v_lshl_add_u32 v58, v56, 3, v58
    v_add_u32 v6, 24576, v58
    v_xor_b32 v7, 32, v6
    v_mov_b32 v8, v4
    v_mov_b32 v10, v6
    v_mov_b32 v9, v5
    v_mov_b32 v11, v7
    v_mov_b32 v64, 0
    v_mov_b32 v65, 0
    v_mov_b32 v66, 0
    v_mov_b32 v67, 0
    v_mov_b32 v68, 0
    v_mov_b32 v69, 0
    v_mov_b32 v70, 0
    v_mov_b32 v71, 0
    v_mov_b32 v72, 0
    v_mov_b32 v73, 0
    v_mov_b32 v74, 0
    v_mov_b32 v75, 0
    v_mov_b32 v76, 0
    v_mov_b32 v77, 0
    v_mov_b32 v78, 0
    v_mov_b32 v79, 0
    v_mov_b32 v80, 0
    v_mov_b32 v81, 0
    v_mov_b32 v82, 0
    v_mov_b32 v83, 0
    v_mov_b32 v84, 0
    v_mov_b32 v85, 0
    v_mov_b32 v86, 0
    v_mov_b32 v87, 0
    v_mov_b32 v88, 0
    v_mov_b32 v89, 0
    v_mov_b32 v90, 0
    v_mov_b32 v91, 0
    v_mov_b32 v92, 0
    v_mov_b32 v93, 0
    v_mov_b32 v94, 0
    v_mov_b32 v95, 0
    v_mov_b32 v96, 0
    v_mov_b32 v97, 0
    v_mov_b32 v98, 0
    v_mov_b32 v99, 0
    v_mov_b32 v100, 0
    v_mov_b32 v101, 0
    v_mov_b32 v102, 0
    v_mov_b32 v103, 0
    v_mov_b32 v104, 0
    v_mov_b32 v105, 0
    v_mov_b32 v106, 0
    v_mov_b32 v107, 0
    v_mov_b32 v108, 0
    v_mov_b32 v109, 0
    v_mov_b32 v110, 0
    v_mov_b32 v111, 0
    v_mov_b32 v112, 0
    v_mov_b32 v113, 0
    v_mov_b32 v114, 0
    v_mov_b32 v115, 0
    v_mov_b32 v116, 0
    v_mov_b32 v117, 0
    v_mov_b32 v118, 0
    v_mov_b32 v119, 0
    v_mov_b32 v120, 0
    v_mov_b32 v121, 0
    v_mov_b32 v122, 0
    v_mov_b32 v123, 0
    v_mov_b32 v124, 0
    v_mov_b32 v125, 0
    v_mov_b32 v126, 0
    v_mov_b32 v127, 0
    v_mov_b32 v128, 0
    v_mov_b32 v129, 0
    v_mov_b32 v130, 0
    v_mov_b32 v131, 0
    v_mov_b32 v132, 0
    v_mov_b32 v133, 0
    v_mov_b32 v134, 0
    v_mov_b32 v135, 0
    v_mov_b32 v136, 0
    v_mov_b32 v137, 0
    v_mov_b32 v138, 0
    v_mov_b32 v139, 0
    v_mov_b32 v140, 0
    v_mov_b32 v141, 0
    v_mov_b32 v142, 0
    v_mov_b32 v143, 0
    v_mov_b32 v144, 0
    v_mov_b32 v145, 0
    v_mov_b32 v146, 0
    v_mov_b32 v147, 0
    v_mov_b32 v148, 0
    v_mov_b32 v149, 0
    v_mov_b32 v150, 0
    v_mov_b32 v151, 0
    v_mov_b32 v152, 0
    v_mov_b32 v153, 0
    v_mov_b32 v154, 0
    v_mov_b32 v155, 0
    v_mov_b32 v156, 0
    v_mov_b32 v157, 0
    v_mov_b32 v158, 0
    v_mov_b32 v159, 0
    s_lshl_b32 s64, s3, 2
    v_mov_b32 v229, s64
    ds_write_b32 v229, v64 offset:4288
    v_lshlrev_b32 v3, 4, v2
    s_lshl_b32 s64, s3, 11
    v_add_u32 v224, s64, v3
    v_xor_b32 v225, 2048, v224
    s_lshl_b32 s64, s3, 8
    v_lshl_add_u32 v227, v2, 2, s64
    v_xor_b32 v228, 256, v227
    v_xor_b32 v230, 4, v229
    v_mov_b32 v231, 1
    v_lshlrev_b32 v232, 2, v2
    s_lshl_b32 s64, 1, s4
    v_mov_b32 v233, s64
    s_lshl_b32 s43, s5, 2
    s_add_u32 s43, s43, s3
    s_lshl_b32 s64, s43, 7
    s_add_u32 s64, s64, 5373952
    v_mov_b32 v234, s64
    s_lshl_b32 s43, s43, 4
    s_add_u32 s43, s43, s4
    s_mul_i32 s43, s43, 1152
    s_add_u32 s43, s43, 4194304
    s_lshl_b32 s42, s4, 2
    s_lshl_b32 s64, s6, 1
    s_add_u32 s42, s42, s64
    s_lshl_b32 s42, s42, 5
    s_lshl_b32 s64, s5, 1
    s_add_u32 s42, s42, s64
    s_add_u32 s42, s42, s7
    s_lshl_b32 s42, s42, 11
    s_and_b32 s64, s5, 7
    s_lshl_b32 s64, s64, 1
    s_add_u32 s64, s64, s7
    s_lshl_b32 s64, 1, s64
    v_mov_b32 v13, s64
    s_lshr_b32 s64, s5, 3
    s_lshl_b32 s64, s64, 1
    s_add_u32 s64, s64, s6
    s_lshl_b32 s64, s64, 8
    s_lshl_b32 s65, s4, 10
    s_add_u32 s64, s64, s65
    s_add_u32 s64, s64, 5382144
    v_lshl_add_u32 v12, v2, 7, s64
    s_and_b32 s64, s2, 7
    s_lshr_b32 s65, s2, 3
    s_and_b32 s4, s64, 3
    s_lshl_b32 s4, s4, 2
    s_and_b32 s66, s65, 3
    s_add_u32 s4, s4, s66
    s_lshr_b32 s5, s64, 2
    s_lshl_b32 s5, s5, 3
    s_lshr_b32 s74, s65, 2
    s_add_u32 s5, s5, s74
    s_mov_b32 s65, 0
    s_mov_b32 s66, 0
    v_mov_b32 v236, 0x3f803f80
    v_mov_b32 v237, 0x3f803f80
    v_mov_b32 v238, 0x3f803f80
    v_mov_b32 v239, 0x3f803f80
    s_waitcnt vmcnt(0) lgkmcnt(0)
    s_barrier
    ds_read_b64_tr_b16 v[16:17], v10 offset:0
    ds_read_b64_tr_b16 v[18:19], v10 offset:512
    ds_read_b128 v[192:195], v8 offset:0
    ds_read_b128 v[196:199], v8 offset:2048
    ds_read_b128 v[200:203], v8 offset:4096
    ds_read_b128 v[204:207], v8 offset:6144
    ds_read_b64_tr_b16 v[20:21], v11 offset:0
    ds_read_b64_tr_b16 v[22:23], v11 offset:512
    ds_read_b64_tr_b16 v[24:25], v10 offset:8192
    ds_read_b64_tr_b16 v[26:27], v10 offset:8704
    ds_read_b64_tr_b16 v[28:29], v11 offset:8192
    ds_read_b64_tr_b16 v[30:31], v11 offset:8704
    ds_read_b64_tr_b16 v[32:33], v10 offset:16384
    ds_read_b64_tr_b16 v[34:35], v10 offset:16896
    ds_read_b64_tr_b16 v[36:37], v11 offset:16384
    ds_read_b64_tr_b16 v[38:39], v11 offset:16896
.p2align 3
C_loop:
    s_waitcnt lgkmcnt(0)
    v_mfma_f32_16x16x32_bf16 v[64:67], v[16:19], v[192:195], v[64:67]
    ds_read_b64_tr_b16 v[40:41], v10 offset:4096
    v_mfma_f32_16x16x32_bf16 v[72:75], v[16:19], v[196:199], v[72:75]
    ds_read_b64_tr_b16 v[42:43], v10 offset:4608
    v_mfma_f32_16x16x32_bf16 v[80:83], v[16:19], v[200:203], v[80:83]
    ds_read_b128 v[208:211], v9 offset:0
    v_mfma_f32_16x16x32_bf16 v[88:91], v[16:19], v[204:207], v[88:91]
    ds_read_b128 v[212:215], v9 offset:2048
    v_mfma_f32_16x16x32_bf16 v[68:71], v[20:23], v[192:195], v[68:71]
    ds_read_b128 v[216:219], v9 offset:4096
    v_mfma_f32_16x16x32_bf16 v[76:79], v[20:23], v[196:199], v[76:79]
    ds_read_b128 v[220:223], v9 offset:6144
    v_mfma_f32_16x16x32_bf16 v[84:87], v[20:23], v[200:203], v[84:87]
    ds_read_b64_tr_b16 v[44:45], v11 offset:4096
    v_mfma_f32_16x16x32_bf16 v[92:95], v[20:23], v[204:207], v[92:95]
    ds_read_b64_tr_b16 v[46:47], v11 offset:4608
    v_mfma_f32_16x16x32_bf16 v[96:99], v[192:195], v[24:27], v[96:99]
    ds_read_b64_tr_b16 v[48:49], v10 offset:12288
    v_mfma_f32_16x16x32_bf16 v[100:103], v[196:199], v[24:27], v[100:103]
    ds_read_b64_tr_b16 v[50:51], v10 offset:12800
    v_mfma_f32_16x16x32_bf16 v[112:115], v[200:203], v[24:27], v[112:115]
    ds_read_b64_tr_b16 v[52:53], v11 offset:12288
    v_mfma_f32_16x16x32_bf16 v[116:119], v[204:207], v[24:27], v[116:119]
    ds_read_b64_tr_b16 v[54:55], v11 offset:12800
    v_mfma_f32_16x16x32_bf16 v[104:107], v[192:195], v[28:31], v[104:107]
    ds_read_b64_tr_b16 v[56:57], v10 offset:20480
    v_mfma_f32_16x16x32_bf16 v[108:111], v[196:199], v[28:31], v[108:111]
    ds_read_b64_tr_b16 v[58:59], v10 offset:20992
    v_mfma_f32_16x16x32_bf16 v[120:123], v[200:203], v[28:31], v[120:123]
    ds_read_b64_tr_b16 v[60:61], v11 offset:20480
    v_mfma_f32_16x16x32_bf16 v[124:127], v[204:207], v[28:31], v[124:127]
    ds_read_b64_tr_b16 v[62:63], v11 offset:20992
    v_mfma_f32_16x16x32_bf16 v[128:131], v[192:195], v[32:35], v[128:131]
    v_mfma_f32_16x16x32_bf16 v[132:135], v[196:199], v[32:35], v[132:135]
    v_mfma_f32_16x16x32_bf16 v[144:147], v[200:203], v[32:35], v[144:147]
    v_mfma_f32_16x16x32_bf16 v[148:151], v[204:207], v[32:35], v[148:151]
    v_mfma_f32_16x16x32_bf16 v[136:139], v[192:195], v[36:39], v[136:139]
    v_mfma_f32_16x16x32_bf16 v[140:143], v[196:199], v[36:39], v[140:143]
    v_mfma_f32_16x16x32_bf16 v[152:155], v[200:203], v[36:39], v[152:155]
    v_mfma_f32_16x16x32_bf16 v[156:159], v[204:207], v[36:39], v[156:159]
    s_waitcnt lgkmcnt(0)
    s_barrier
    s_add_u32 s65, s65, 40960
    s_cmp_eq_u32 s65, 122880
    s_cselect_b32 s65, 0, s65
    v_mfma_f32_16x16x32_bf16 v[64:67], v[40:43], v[208:211], v[64:67]
    v_add_u32 v10, s65, v6
    v_add_u32 v8, s65, v4
    v_mfma_f32_16x16x32_bf16 v[72:75], v[40:43], v[212:215], v[72:75]
    ds_read_b64_tr_b16 v[16:17], v10 offset:0
    v_mfma_f32_16x16x32_bf16 v[80:83], v[40:43], v[216:219], v[80:83]
    ds_read_b64_tr_b16 v[18:19], v10 offset:512
    v_mfma_f32_16x16x32_bf16 v[88:91], v[40:43], v[220:223], v[88:91]
    ds_read_b128 v[192:195], v8 offset:0
    v_mfma_f32_16x16x32_bf16 v[68:71], v[44:47], v[208:211], v[68:71]
    ds_read_b128 v[196:199], v8 offset:2048
    v_mfma_f32_16x16x32_bf16 v[76:79], v[44:47], v[212:215], v[76:79]
    ds_read_b128 v[200:203], v8 offset:4096
    v_mfma_f32_16x16x32_bf16 v[84:87], v[44:47], v[216:219], v[84:87]
    ds_read_b128 v[204:207], v8 offset:6144
    v_mfma_f32_16x16x32_bf16 v[92:95], v[44:47], v[220:223], v[92:95]
    v_add_u32 v11, s65, v7
    v_mfma_f32_16x16x32_bf16 v[96:99], v[208:211], v[48:51], v[96:99]
    ds_read_b64_tr_b16 v[20:21], v11 offset:0
    v_mfma_f32_16x16x32_bf16 v[100:103], v[212:215], v[48:51], v[100:103]
    ds_read_b64_tr_b16 v[22:23], v11 offset:512
    v_mfma_f32_16x16x32_bf16 v[112:115], v[216:219], v[48:51], v[112:115]
    ds_read_b64_tr_b16 v[24:25], v10 offset:8192
    v_mfma_f32_16x16x32_bf16 v[116:119], v[220:223], v[48:51], v[116:119]
    ds_read_b64_tr_b16 v[26:27], v10 offset:8704
    v_mfma_f32_16x16x32_bf16 v[104:107], v[208:211], v[52:55], v[104:107]
    ds_read_b64_tr_b16 v[28:29], v11 offset:8192
    v_mfma_f32_16x16x32_bf16 v[108:111], v[212:215], v[52:55], v[108:111]
    ds_read_b64_tr_b16 v[30:31], v11 offset:8704
    v_mfma_f32_16x16x32_bf16 v[120:123], v[216:219], v[52:55], v[120:123]
    ds_read_b64_tr_b16 v[32:33], v10 offset:16384
    v_mfma_f32_16x16x32_bf16 v[124:127], v[220:223], v[52:55], v[124:127]
    ds_read_b64_tr_b16 v[34:35], v10 offset:16896
    v_mfma_f32_16x16x32_bf16 v[128:131], v[208:211], v[56:59], v[128:131]
    ds_read_b64_tr_b16 v[36:37], v11 offset:16384
    v_mfma_f32_16x16x32_bf16 v[132:135], v[212:215], v[56:59], v[132:135]
    ds_read_b64_tr_b16 v[38:39], v11 offset:16896
    v_mfma_f32_16x16x32_bf16 v[144:147], v[216:219], v[56:59], v[144:147]
    v_add_u32 v9, s65, v5
    v_mfma_f32_16x16x32_bf16 v[148:151], v[220:223], v[56:59], v[148:151]
    v_mfma_f32_16x16x32_bf16 v[136:139], v[208:211], v[60:63], v[136:139]
    v_mfma_f32_16x16x32_bf16 v[140:143], v[212:215], v[60:63], v[140:143]
    v_mfma_f32_16x16x32_bf16 v[152:155], v[216:219], v[60:63], v[152:155]
    v_mfma_f32_16x16x32_bf16 v[156:159], v[220:223], v[60:63], v[156:159]
    s_add_u32 s66, s66, 1
    s_cmp_lt_u32 s66, 14
    s_cbranch_scc1 C_loop
    s_waitcnt lgkmcnt(0)
    v_mfma_f32_16x16x32_bf16 v[96:99], v[192:195], v[24:27], v[96:99]
    ds_read_b64_tr_b16 v[48:49], v10 offset:12288
    v_mfma_f32_16x16x32_bf16 v[100:103], v[196:199], v[24:27], v[100:103]
    ds_read_b64_tr_b16 v[50:51], v10 offset:12800
    v_mfma_f32_16x16x32_bf16 v[112:115], v[200:203], v[24:27], v[112:115]
    ds_read_b128 v[160:163], v9 offset:0
    v_mfma_f32_16x16x32_bf16 v[116:119], v[204:207], v[24:27], v[116:119]
    ds_read_b128 v[164:167], v9 offset:2048
    v_mfma_f32_16x16x32_bf16 v[104:107], v[192:195], v[28:31], v[104:107]
    ds_read_b128 v[168:171], v9 offset:4096
    v_mfma_f32_16x16x32_bf16 v[108:111], v[196:199], v[28:31], v[108:111]
    ds_read_b128 v[172:175], v9 offset:6144
    v_mfma_f32_16x16x32_bf16 v[120:123], v[200:203], v[28:31], v[120:123]
    ds_read_b64_tr_b16 v[52:53], v11 offset:12288
    v_mfma_f32_16x16x32_bf16 v[124:127], v[204:207], v[28:31], v[124:127]
    ds_read_b64_tr_b16 v[54:55], v11 offset:12800
    v_mfma_f32_16x16x32_bf16 v[128:131], v[192:195], v[32:35], v[128:131]
    ds_read_b64_tr_b16 v[56:57], v10 offset:20480
    v_mfma_f32_16x16x32_bf16 v[132:135], v[196:199], v[32:35], v[132:135]
    ds_read_b64_tr_b16 v[58:59], v10 offset:20992
    v_mfma_f32_16x16x32_bf16 v[144:147], v[200:203], v[32:35], v[144:147]
    ds_read_b64_tr_b16 v[60:61], v11 offset:20480
    v_mfma_f32_16x16x32_bf16 v[148:151], v[204:207], v[32:35], v[148:151]
    ds_read_b64_tr_b16 v[62:63], v11 offset:20992
    v_mfma_f32_16x16x32_bf16 v[136:139], v[192:195], v[36:39], v[136:139]
    v_mfma_f32_16x16x32_bf16 v[140:143], v[196:199], v[36:39], v[140:143]
    v_mfma_f32_16x16x32_bf16 v[152:155], v[200:203], v[36:39], v[152:155]
    v_mfma_f32_16x16x32_bf16 v[156:159], v[204:207], v[36:39], v[156:159]
    s_waitcnt lgkmcnt(0)
    s_barrier
    s_add_u32 s66, s66, 1
    v_mfma_f32_16x16x32_bf16 v[96:99], v[160:163], v[48:51], v[96:99]
    v_mov_b32 v10, v6
    v_mov_b32 v8, v4
    v_mfma_f32_16x16x32_bf16 v[100:103], v[164:167], v[48:51], v[100:103]
    ds_read_b64_tr_b16 v[24:25], v10 offset:8192
    v_mfma_f32_16x16x32_bf16 v[112:115], v[168:171], v[48:51], v[112:115]
    ds_read_b64_tr_b16 v[26:27], v10 offset:8704
    v_mfma_f32_16x16x32_bf16 v[116:119], v[172:175], v[48:51], v[116:119]
    v_mov_b32 v11, v7
    v_mov_b32 v9, v5
    v_mfma_f32_16x16x32_bf16 v[104:107], v[160:163], v[52:55], v[104:107]
    ds_read_b128 v[176:179], v8 offset:0
    v_mfma_f32_16x16x32_bf16 v[108:111], v[164:167], v[52:55], v[108:111]
    ds_read_b128 v[180:183], v8 offset:2048
    v_mfma_f32_16x16x32_bf16 v[120:123], v[168:171], v[52:55], v[120:123]
    ds_read_b128 v[184:187], v8 offset:4096
    v_mfma_f32_16x16x32_bf16 v[124:127], v[172:175], v[52:55], v[124:127]
    ds_read_b128 v[188:191], v8 offset:6144
    v_mfma_f32_16x16x32_bf16 v[128:131], v[160:163], v[56:59], v[128:131]
    ds_read_b64_tr_b16 v[28:29], v11 offset:8192
    v_mfma_f32_16x16x32_bf16 v[132:135], v[164:167], v[56:59], v[132:135]
    ds_read_b64_tr_b16 v[30:31], v11 offset:8704
    v_mfma_f32_16x16x32_bf16 v[144:147], v[168:171], v[56:59], v[144:147]
    ds_read_b64_tr_b16 v[32:33], v10 offset:16384
    v_mfma_f32_16x16x32_bf16 v[148:151], v[172:175], v[56:59], v[148:151]
    ds_read_b64_tr_b16 v[34:35], v10 offset:16896
    v_mfma_f32_16x16x32_bf16 v[136:139], v[160:163], v[60:63], v[136:139]
    ds_read_b64_tr_b16 v[36:37], v11 offset:16384
    v_mfma_f32_16x16x32_bf16 v[140:143], v[164:167], v[60:63], v[140:143]
    ds_read_b64_tr_b16 v[38:39], v11 offset:16896
    v_mfma_f32_16x16x32_bf16 v[152:155], v[168:171], v[60:63], v[152:155]
    v_mfma_f32_16x16x32_bf16 v[156:159], v[172:175], v[60:63], v[156:159]
    s_waitcnt lgkmcnt(0)
    v_mfma_f32_16x16x32_bf16 v[96:99], v[176:179], v[24:27], v[96:99]
    ds_read_b64_tr_b16 v[48:49], v10 offset:12288
    v_mfma_f32_16x16x32_bf16 v[100:103], v[180:183], v[24:27], v[100:103]
    ds_read_b64_tr_b16 v[50:51], v10 offset:12800
    v_mfma_f32_16x16x32_bf16 v[112:115], v[184:187], v[24:27], v[112:115]
    ds_read_b128 v[208:211], v9 offset:0
    v_mfma_f32_16x16x32_bf16 v[116:119], v[188:191], v[24:27], v[116:119]
    ds_read_b128 v[212:215], v9 offset:2048
    v_mfma_f32_16x16x32_bf16 v[104:107], v[176:179], v[28:31], v[104:107]
    ds_read_b128 v[216:219], v9 offset:4096
    v_mfma_f32_16x16x32_bf16 v[108:111], v[180:183], v[28:31], v[108:111]
    ds_read_b128 v[220:223], v9 offset:6144
    v_mfma_f32_16x16x32_bf16 v[120:123], v[184:187], v[28:31], v[120:123]
    ds_read_b64_tr_b16 v[52:53], v11 offset:12288
    v_mfma_f32_16x16x32_bf16 v[124:127], v[188:191], v[28:31], v[124:127]
    ds_read_b64_tr_b16 v[54:55], v11 offset:12800
    v_mfma_f32_16x16x32_bf16 v[128:131], v[176:179], v[32:35], v[128:131]
    ds_read_b64_tr_b16 v[56:57], v10 offset:20480
    v_mfma_f32_16x16x32_bf16 v[132:135], v[180:183], v[32:35], v[132:135]
    ds_read_b64_tr_b16 v[58:59], v10 offset:20992
    v_mfma_f32_16x16x32_bf16 v[144:147], v[184:187], v[32:35], v[144:147]
    ds_read_b64_tr_b16 v[60:61], v11 offset:20480
    v_mfma_f32_16x16x32_bf16 v[148:151], v[188:191], v[32:35], v[148:151]
    ds_read_b64_tr_b16 v[62:63], v11 offset:20992
    v_mfma_f32_16x16x32_bf16 v[136:139], v[176:179], v[36:39], v[136:139]
    v_mfma_f32_16x16x32_bf16 v[140:143], v[180:183], v[36:39], v[140:143]
    v_mfma_f32_16x16x32_bf16 v[152:155], v[184:187], v[36:39], v[152:155]
    v_mfma_f32_16x16x32_bf16 v[156:159], v[188:191], v[36:39], v[156:159]
    s_waitcnt lgkmcnt(0)
    s_barrier
    v_mfma_f32_16x16x32_bf16 v[96:99], v[208:211], v[48:51], v[96:99]
    v_mfma_f32_16x16x32_bf16 v[100:103], v[212:215], v[48:51], v[100:103]
    v_mfma_f32_16x16x32_bf16 v[112:115], v[216:219], v[48:51], v[112:115]
    v_mfma_f32_16x16x32_bf16 v[116:119], v[220:223], v[48:51], v[116:119]
    v_mfma_f32_16x16x32_bf16 v[104:107], v[208:211], v[52:55], v[104:107]
    v_mfma_f32_16x16x32_bf16 v[108:111], v[212:215], v[52:55], v[108:111]
    v_mfma_f32_16x16x32_bf16 v[120:123], v[216:219], v[52:55], v[120:123]
    v_mfma_f32_16x16x32_bf16 v[124:127], v[220:223], v[52:55], v[124:127]
    v_mfma_f32_16x16x32_bf16 v[128:131], v[208:211], v[56:59], v[128:131]
    v_mfma_f32_16x16x32_bf16 v[132:135], v[212:215], v[56:59], v[132:135]
    v_mfma_f32_16x16x32_bf16 v[144:147], v[216:219], v[56:59], v[144:147]
    v_mfma_f32_16x16x32_bf16 v[148:151], v[220:223], v[56:59], v[148:151]
    v_mfma_f32_16x16x32_bf16 v[136:139], v[208:211], v[60:63], v[136:139]
    v_mfma_f32_16x16x32_bf16 v[140:143], v[212:215], v[60:63], v[140:143]
    v_mfma_f32_16x16x32_bf16 v[152:155], v[216:219], v[60:63], v[152:155]
    v_mfma_f32_16x16x32_bf16 v[156:159], v[220:223], v[60:63], v[156:159]
    v_add_u32 v10, 81920, v6
    v_add_u32 v11, 81920, v7
    v_cvt_pk_bf16_f32 v16, v96, v97
    v_lshlrev_b32 v48, 16, v16
    v_and_b32 v49, 0xffff0000, v16
    v_mul_f32 v50, s72, v48
    v_mul_f32 v51, s72, v49
    v_exp_f32 v50, v50 clamp
    v_exp_f32 v51, v51 clamp
    v_max_f32 v48, 0, v48
    v_max_f32 v49, 0, v49
    v_add_f32 v48, v48, v50
    v_add_f32 v49, v49, v51
    v_min_f32 v56, v48, v49
    v_cvt_pk_bf16_f32 v16, v48, v49
    v_cvt_pk_bf16_f32 v17, v98, v99
    v_lshlrev_b32 v48, 16, v17
    v_and_b32 v49, 0xffff0000, v17
    v_mul_f32 v50, s72, v48
    v_mul_f32 v51, s72, v49
    v_exp_f32 v50, v50 clamp
    v_exp_f32 v51, v51 clamp
    v_max_f32 v48, 0, v48
    v_max_f32 v49, 0, v49
    v_add_f32 v48, v48, v50
    v_add_f32 v49, v49, v51
    v_min3_f32 v56, v48, v49, v56
    v_cvt_pk_bf16_f32 v17, v48, v49
    v_cvt_pk_bf16_f32 v18, v100, v101
    v_lshlrev_b32 v48, 16, v18
    v_and_b32 v49, 0xffff0000, v18
    v_mul_f32 v50, s72, v48
    v_mul_f32 v51, s72, v49
    v_exp_f32 v50, v50 clamp
    v_exp_f32 v51, v51 clamp
    v_max_f32 v48, 0, v48
    v_max_f32 v49, 0, v49
    v_add_f32 v48, v48, v50
    v_add_f32 v49, v49, v51
    v_min3_f32 v56, v48, v49, v56
    v_cvt_pk_bf16_f32 v18, v48, v49
    v_cvt_pk_bf16_f32 v19, v102, v103
    v_lshlrev_b32 v48, 16, v19
    v_and_b32 v49, 0xffff0000, v19
    v_mul_f32 v50, s72, v48
    v_mul_f32 v51, s72, v49
    v_exp_f32 v50, v50 clamp
    v_exp_f32 v51, v51 clamp
    v_max_f32 v48, 0, v48
    v_max_f32 v49, 0, v49
    v_add_f32 v48, v48, v50
    v_add_f32 v49, v49, v51
    v_min3_f32 v56, v48, v49, v56
    v_cvt_pk_bf16_f32 v19, v48, v49
    v_cvt_pk_bf16_f32 v20, v104, v105
    v_lshlrev_b32 v48, 16, v20
    v_and_b32 v49, 0xffff0000, v20
    v_mul_f32 v50, s72, v48
    v_mul_f32 v51, s72, v49
    v_exp_f32 v50, v50 clamp
    v_exp_f32 v51, v51 clamp
    v_max_f32 v48, 0, v48
    v_max_f32 v49, 0, v49
    v_add_f32 v48, v48, v50
    v_add_f32 v49, v49, v51
    v_min3_f32 v56, v48, v49, v56
    v_cvt_pk_bf16_f32 v20, v48, v49
    v_cvt_pk_bf16_f32 v21, v106, v107
    v_lshlrev_b32 v48, 16, v21
    v_and_b32 v49, 0xffff0000, v21
    v_mul_f32 v50, s72, v48
    v_mul_f32 v51, s72, v49
    v_exp_f32 v50, v50 clamp
    v_exp_f32 v51, v51 clamp
    v_max_f32 v48, 0, v48
    v_max_f32 v49, 0, v49
    v_add_f32 v48, v48, v50
    v_add_f32 v49, v49, v51
    v_min3_f32 v56, v48, v49, v56
    v_cvt_pk_bf16_f32 v21, v48, v49
    v_cvt_pk_bf16_f32 v22, v108, v109
    v_lshlrev_b32 v48, 16, v22
    v_and_b32 v49, 0xffff0000, v22
    v_mul_f32 v50, s72, v48
    v_mul_f32 v51, s72, v49
    v_exp_f32 v50, v50 clamp
    v_exp_f32 v51, v51 clamp
    v_max_f32 v48, 0, v48
    v_max_f32 v49, 0, v49
    v_add_f32 v48, v48, v50
    v_add_f32 v49, v49, v51
    v_min3_f32 v56, v48, v49, v56
    v_cvt_pk_bf16_f32 v22, v48, v49
    v_cvt_pk_bf16_f32 v23, v110, v111
    v_lshlrev_b32 v48, 16, v23
    v_and_b32 v49, 0xffff0000, v23
    v_mul_f32 v50, s72, v48
    v_mul_f32 v51, s72, v49
    v_exp_f32 v50, v50 clamp
    v_exp_f32 v51, v51 clamp
    v_max_f32 v48, 0, v48
    v_max_f32 v49, 0, v49
    v_add_f32 v48, v48, v50
    v_add_f32 v49, v49, v51
    v_min3_f32 v56, v48, v49, v56
    v_cvt_pk_bf16_f32 v23, v48, v49
    v_cmp_gt_f32 vcc, 0x3a800000, v56
    s_cbranch_vccnz phi_15_fix
phi_15_done:
    v_cvt_pk_bf16_f32 v32, v128, v129
    v_cvt_pk_bf16_f32 v33, v130, v131
    v_mfma_f32_16x16x32_bf16 v[52:55], v[236:239], v[16:19], 0
    v_cvt_pk_bf16_f32 v34, v132, v133
    v_mfma_f32_16x16x32_bf16 v[60:63], v[236:239], v[20:23], 0
    v_cvt_pk_bf16_f32 v35, v134, v135
    v_cvt_pk_bf16_f32 v36, v136, v137
    v_cvt_pk_bf16_f32 v37, v138, v139
    v_mfma_f32_16x16x32_bf16 v[240:243], v[16:19], v[32:35], 0
    v_cvt_pk_bf16_f32 v38, v140, v141
    v_mfma_f32_16x16x32_bf16 v[244:247], v[20:23], v[32:35], 0
    v_cvt_pk_bf16_f32 v39, v142, v143
    s_nop 1
    v_mfma_f32_16x16x32_bf16 v[248:251], v[16:19], v[36:39], 0
    v_mfma_f32_16x16x32_bf16 v[252:255], v[20:23], v[36:39], 0
    v_cvt_pk_bf16_f32 v24, v112, v113
    v_lshlrev_b32 v48, 16, v24
    v_and_b32 v49, 0xffff0000, v24
    v_mul_f32 v50, s72, v48
    v_mul_f32 v51, s72, v49
    v_exp_f32 v50, v50 clamp
    v_exp_f32 v51, v51 clamp
    v_max_f32 v48, 0, v48
    v_max_f32 v49, 0, v49
    v_add_f32 v48, v48, v50
    v_add_f32 v49, v49, v51
    v_min_f32 v56, v48, v49
    v_cvt_pk_bf16_f32 v24, v48, v49
    v_cvt_pk_bf16_f32 v25, v114, v115
    v_lshlrev_b32 v48, 16, v25
    v_and_b32 v49, 0xffff0000, v25
    v_mul_f32 v50, s72, v48
    v_mul_f32 v51, s72, v49
    v_exp_f32 v50, v50 clamp
    v_exp_f32 v51, v51 clamp
    v_max_f32 v48, 0, v48
    v_max_f32 v49, 0, v49
    v_add_f32 v48, v48, v50
    v_add_f32 v49, v49, v51
    v_min3_f32 v56, v48, v49, v56
    v_cvt_pk_bf16_f32 v25, v48, v49
    v_cvt_pk_bf16_f32 v26, v116, v117
    v_lshlrev_b32 v48, 16, v26
    v_and_b32 v49, 0xffff0000, v26
    v_mul_f32 v50, s72, v48
    v_mul_f32 v51, s72, v49
    v_exp_f32 v50, v50 clamp
    v_exp_f32 v51, v51 clamp
    v_max_f32 v48, 0, v48
    v_max_f32 v49, 0, v49
    v_add_f32 v48, v48, v50
    v_add_f32 v49, v49, v51
    v_min3_f32 v56, v48, v49, v56
    v_cvt_pk_bf16_f32 v26, v48, v49
    v_cvt_pk_bf16_f32 v27, v118, v119
    v_lshlrev_b32 v48, 16, v27
    v_and_b32 v49, 0xffff0000, v27
    v_mul_f32 v50, s72, v48
    v_mul_f32 v51, s72, v49
    v_exp_f32 v50, v50 clamp
    v_exp_f32 v51, v51 clamp
    v_max_f32 v48, 0, v48
    v_max_f32 v49, 0, v49
    v_add_f32 v48, v48, v50
    v_add_f32 v49, v49, v51
    v_min3_f32 v56, v48, v49, v56
    v_cvt_pk_bf16_f32 v27, v48, v49
    v_cvt_pk_bf16_f32 v28, v120, v121
    v_lshlrev_b32 v48, 16, v28
    v_and_b32 v49, 0xffff0000, v28
    v_mul_f32 v50, s72, v48
    v_mul_f32 v51, s72, v49
    v_exp_f32 v50, v50 clamp
    v_exp_f32 v51, v51 clamp
    v_max_f32 v48, 0, v48
    v_max_f32 v49, 0, v49
    v_add_f32 v48, v48, v50
    v_add_f32 v49, v49, v51
    v_min3_f32 v56, v48, v49, v56
    v_cvt_pk_bf16_f32 v28, v48, v49
    v_cvt_pk_bf16_f32 v29, v122, v123
    v_lshlrev_b32 v48, 16, v29
    v_and_b32 v49, 0xffff0000, v29
    v_mul_f32 v50, s72, v48
    v_mul_f32 v51, s72, v49
    v_exp_f32 v50, v50 clamp
    v_exp_f32 v51, v51 clamp
    v_max_f32 v48, 0, v48
    v_max_f32 v49, 0, v49
    v_add_f32 v48, v48, v50
    v_add_f32 v49, v49, v51
    v_min3_f32 v56, v48, v49, v56
    v_cvt_pk_bf16_f32 v29, v48, v49
    v_cvt_pk_bf16_f32 v30, v124, v125
    v_lshlrev_b32 v48, 16, v30
    v_and_b32 v49, 0xffff0000, v30
    v_mul_f32 v50, s72, v48
    v_mul_f32 v51, s72, v49
    v_exp_f32 v50, v50 clamp
    v_exp_f32 v51, v51 clamp
    v_max_f32 v48, 0, v48
    v_max_f32 v49, 0, v49
    v_add_f32 v48, v48, v50
    v_add_f32 v49, v49, v51
    v_min3_f32 v56, v48, v49, v56
    v_cvt_pk_bf16_f32 v30, v48, v49
    v_cvt_pk_bf16_f32 v31, v126, v127
    v_lshlrev_b32 v48, 16, v31
    v_and_b32 v49, 0xffff0000, v31
    v_mul_f32 v50, s72, v48
    v_mul_f32 v51, s72, v49
    v_exp_f32 v50, v50 clamp
    v_exp_f32 v51, v51 clamp
    v_max_f32 v48, 0, v48
    v_max_f32 v49, 0, v49
    v_add_f32 v48, v48, v50
    v_add_f32 v49, v49, v51
    v_min3_f32 v56, v48, v49, v56
    v_cvt_pk_bf16_f32 v31, v48, v49
    v_cmp_gt_f32 vcc, 0x3a800000, v56
    s_cbranch_vccnz phi_16_fix
phi_16_done:
    v_cvt_pk_bf16_f32 v40, v144, v145
    v_cvt_pk_bf16_f32 v41, v146, v147
    v_mfma_f32_16x16x32_bf16 v[52:55], v[236:239], v[24:27], v[52:55]
    v_cvt_pk_bf16_f32 v42, v148, v149
    v_mfma_f32_16x16x32_bf16 v[60:63], v[236:239], v[28:31], v[60:63]
    v_cvt_pk_bf16_f32 v43, v150, v151
    v_cvt_pk_bf16_f32 v44, v152, v153
    v_cvt_pk_bf16_f32 v45, v154, v155
    v_mfma_f32_16x16x32_bf16 v[240:243], v[24:27], v[40:43], v[240:243]
    v_cvt_pk_bf16_f32 v46, v156, v157
    v_mfma_f32_16x16x32_bf16 v[244:247], v[28:31], v[40:43], v[244:247]
    v_cvt_pk_bf16_f32 v47, v158, v159
    s_nop 1
    v_mfma_f32_16x16x32_bf16 v[248:251], v[24:27], v[44:47], v[248:251]
    v_mfma_f32_16x16x32_bf16 v[252:255], v[28:31], v[44:47], v[252:255]
    s_cmp_eq_u32 s6, 0
    s_cbranch_scc0 C_ex1
    ds_write_b32 v227, v60 offset:4608
    s_nop 5
    ds_write_b128 v224, v[248:251] offset:32768
    ds_write_b128 v224, v[252:255] offset:33792
C_ex2:
    ds_write_b32 v229, v231 offset:4288
C_ps:
    ds_read_b32 v25, v230 offset:4288
    ds_read_b128 v[16:19], v225 offset:32768
    ds_read_b128 v[20:23], v225 offset:33792
    ds_read_b32 v24, v228 offset:4608
    s_waitcnt lgkmcnt(0)
    v_cmp_eq_u32 vcc, 0, v25
    s_cbranch_vccnz C_ps
    v_add_f32 v16, v16, v240
    v_add_f32 v17, v17, v241
    v_add_f32 v18, v18, v242
    v_add_f32 v19, v19, v243
    v_add_f32 v20, v20, v244
    v_add_f32 v21, v21, v245
    v_add_f32 v22, v22, v246
    v_add_f32 v23, v23, v247
    v_add_f32 v24, v24, v52
    v_cvt_pk_bf16_f32 v28, v16, v17
    v_cvt_pk_bf16_f32 v29, v18, v19
    v_cvt_pk_bf16_f32 v30, v20, v21
    v_cvt_pk_bf16_f32 v31, v22, v23
    buffer_store_dwordx4 v[28:31], v3, s[16:19], s43 offen sc0 sc1
    s_mov_b64 exec, 0xffff
    buffer_store_dword v24, v232, s[16:19], s43 offen offset:1024 sc0 sc1
    s_mov_b64 exec, 1
    buffer_atomic_or v233, v234, s[16:19], 0 offen
    s_mov_b64 exec, -1
    ds_read_b64_tr_b16 v[96:97], v10 offset:0
    ds_read_b64_tr_b16 v[98:99], v10 offset:512
    ds_read_b64_tr_b16 v[100:101], v11 offset:0
    ds_read_b64_tr_b16 v[102:103], v11 offset:512
    ds_read_b64_tr_b16 v[104:105], v10 offset:4096
    ds_read_b64_tr_b16 v[106:107], v10 offset:4608
    ds_read_b64_tr_b16 v[108:109], v11 offset:4096
    ds_read_b64_tr_b16 v[110:111], v11 offset:4608
    ds_read_b64_tr_b16 v[112:113], v6 offset:0
    ds_read_b64_tr_b16 v[114:115], v6 offset:512
    ds_read_b64_tr_b16 v[116:117], v7 offset:0
    ds_read_b64_tr_b16 v[118:119], v7 offset:512
    ds_read_b64_tr_b16 v[120:121], v6 offset:4096
    ds_read_b64_tr_b16 v[122:123], v6 offset:4608
    ds_read_b64_tr_b16 v[124:125], v7 offset:4096
    ds_read_b64_tr_b16 v[126:127], v7 offset:4608
    s_waitcnt lgkmcnt(12)
    v_mfma_f32_16x16x32_bf16 v[64:67], v[96:99], v[192:195], v[64:67]
    v_mfma_f32_16x16x32_bf16 v[72:75], v[96:99], v[196:199], v[72:75]
    v_mfma_f32_16x16x32_bf16 v[80:83], v[96:99], v[200:203], v[80:83]
    v_mfma_f32_16x16x32_bf16 v[88:91], v[96:99], v[204:207], v[88:91]
    v_mfma_f32_16x16x32_bf16 v[68:71], v[100:103], v[192:195], v[68:71]
    v_mfma_f32_16x16x32_bf16 v[76:79], v[100:103], v[196:199], v[76:79]
    v_mfma_f32_16x16x32_bf16 v[84:87], v[100:103], v[200:203], v[84:87]
    v_mfma_f32_16x16x32_bf16 v[92:95], v[100:103], v[204:207], v[92:95]
    s_waitcnt lgkmcnt(8)
    v_mfma_f32_16x16x32_bf16 v[64:67], v[104:107], v[160:163], v[64:67]
    v_mfma_f32_16x16x32_bf16 v[72:75], v[104:107], v[164:167], v[72:75]
    v_mfma_f32_16x16x32_bf16 v[80:83], v[104:107], v[168:171], v[80:83]
    v_mfma_f32_16x16x32_bf16 v[88:91], v[104:107], v[172:175], v[88:91]
    v_mfma_f32_16x16x32_bf16 v[68:71], v[108:111], v[160:163], v[68:71]
    v_mfma_f32_16x16x32_bf16 v[76:79], v[108:111], v[164:167], v[76:79]
    v_mfma_f32_16x16x32_bf16 v[84:87], v[108:111], v[168:171], v[84:87]
    v_mfma_f32_16x16x32_bf16 v[92:95], v[108:111], v[172:175], v[92:95]
    s_waitcnt lgkmcnt(4)
    v_mfma_f32_16x16x32_bf16 v[64:67], v[112:115], v[176:179], v[64:67]
    v_mfma_f32_16x16x32_bf16 v[72:75], v[112:115], v[180:183], v[72:75]
    v_mfma_f32_16x16x32_bf16 v[80:83], v[112:115], v[184:187], v[80:83]
    v_mfma_f32_16x16x32_bf16 v[88:91], v[112:115], v[188:191], v[88:91]
    v_mfma_f32_16x16x32_bf16 v[68:71], v[116:119], v[176:179], v[68:71]
    v_mfma_f32_16x16x32_bf16 v[76:79], v[116:119], v[180:183], v[76:79]
    v_mfma_f32_16x16x32_bf16 v[84:87], v[116:119], v[184:187], v[84:87]
    v_mfma_f32_16x16x32_bf16 v[92:95], v[116:119], v[188:191], v[92:95]
    s_waitcnt lgkmcnt(0)
    v_mfma_f32_16x16x32_bf16 v[64:67], v[120:123], v[208:211], v[64:67]
    v_mfma_f32_16x16x32_bf16 v[72:75], v[120:123], v[212:215], v[72:75]
    v_mfma_f32_16x16x32_bf16 v[80:83], v[120:123], v[216:219], v[80:83]
    v_mfma_f32_16x16x32_bf16 v[88:91], v[120:123], v[220:223], v[88:91]
    v_mfma_f32_16x16x32_bf16 v[68:71], v[124:127], v[208:211], v[68:71]
    v_mfma_f32_16x16x32_bf16 v[76:79], v[124:127], v[212:215], v[76:79]
    v_mfma_f32_16x16x32_bf16 v[84:87], v[124:127], v[216:219], v[84:87]
    v_mfma_f32_16x16x32_bf16 v[92:95], v[124:127], v[220:223], v[92:95]
    v_lshrrev_b32 v230, 3, v0
    s_lshl_b32 s64, s4, 7
    v_add_u32 v230, s64, v230
    v_lshlrev_b32 v231, 11, v230
    v_and_b32 v3, 7, v0
    v_lshl_add_u32 v231, v3, 4, v231
    s_lshl_b32 s64, s5, 7
    v_add_u32 v231, s64, v231
    s_mov_b32 s64, 131072
    v_lshlrev_b32 v3, 2, v230
    v_add_u32 v3, 6709248, v3
    buffer_load_dwordx4 v[220:223], v231, s[8:11], 0 offen
    buffer_load_dwordx4 v[224:227], v231, s[8:11], s64 offen
    buffer_load_dword v228, v3, s[16:19], 0 offen sc1
    buffer_load_dword v229, v3, s[16:19], 0 offen offset:256 sc1
    v_lshlrev_b32 v3, 4, v2
    s_lshl_b32 s64, s7, 11
    v_add_u32 v4, s64, v3
    v_lshrrev_b32 v5, 4, v2
    v_lshlrev_b32 v5, 4, v5
    s_lshl_b32 s64, s7, 6
    v_add_u32 v5, s64, v5
    v_mov_b32 v6, 4256
    ds_read_b32 v6, v6
    v_cvt_pk_bf16_f32 v32, v64, v65
    v_lshlrev_b32 v48, 16, v32
    v_and_b32 v49, 0xffff0000, v32
    v_mul_f32 v50, s72, v48
    v_mul_f32 v51, s72, v49
    v_exp_f32 v50, v50 clamp
    v_exp_f32 v51, v51 clamp
    v_max_f32 v48, 0, v48
    v_max_f32 v49, 0, v49
    v_add_f32 v48, v48, v50
    v_add_f32 v49, v49, v51
    v_min_f32 v56, v48, v49
    v_cvt_pk_bf16_f32 v32, v48, v49
    v_cvt_pk_bf16_f32 v33, v66, v67
    v_lshlrev_b32 v48, 16, v33
    v_and_b32 v49, 0xffff0000, v33
    v_mul_f32 v50, s72, v48
    v_mul_f32 v51, s72, v49
    v_exp_f32 v50, v50 clamp
    v_exp_f32 v51, v51 clamp
    v_max_f32 v48, 0, v48
    v_max_f32 v49, 0, v49
    v_add_f32 v48, v48, v50
    v_add_f32 v49, v49, v51
    v_min3_f32 v56, v48, v49, v56
    v_cvt_pk_bf16_f32 v33, v48, v49
    v_cvt_pk_bf16_f32 v34, v68, v69
    v_lshlrev_b32 v48, 16, v34
    v_and_b32 v49, 0xffff0000, v34
    v_mul_f32 v50, s72, v48
    v_mul_f32 v51, s72, v49
    v_exp_f32 v50, v50 clamp
    v_exp_f32 v51, v51 clamp
    v_max_f32 v48, 0, v48
    v_max_f32 v49, 0, v49
    v_add_f32 v48, v48, v50
    v_add_f32 v49, v49, v51
    v_min3_f32 v56, v48, v49, v56
    v_cvt_pk_bf16_f32 v34, v48, v49
    v_cvt_pk_bf16_f32 v35, v70, v71
    v_lshlrev_b32 v48, 16, v35
    v_and_b32 v49, 0xffff0000, v35
    v_mul_f32 v50, s72, v48
    v_mul_f32 v51, s72, v49
    v_exp_f32 v50, v50 clamp
    v_exp_f32 v51, v51 clamp
    v_max_f32 v48, 0, v48
    v_max_f32 v49, 0, v49
    v_add_f32 v48, v48, v50
    v_add_f32 v49, v49, v51
    v_min3_f32 v56, v48, v49, v56
    v_cvt_pk_bf16_f32 v35, v48, v49
    v_cvt_pk_bf16_f32 v36, v72, v73
    v_lshlrev_b32 v48, 16, v36
    v_and_b32 v49, 0xffff0000, v36
    v_mul_f32 v50, s72, v48
    v_mul_f32 v51, s72, v49
    v_exp_f32 v50, v50 clamp
    v_exp_f32 v51, v51 clamp
    v_max_f32 v48, 0, v48
    v_max_f32 v49, 0, v49
    v_add_f32 v48, v48, v50
    v_add_f32 v49, v49, v51
    v_min3_f32 v56, v48, v49, v56
    v_cvt_pk_bf16_f32 v36, v48, v49
    v_cvt_pk_bf16_f32 v37, v74, v75
    v_lshlrev_b32 v48, 16, v37
    v_and_b32 v49, 0xffff0000, v37
    v_mul_f32 v50, s72, v48
    v_mul_f32 v51, s72, v49
    v_exp_f32 v50, v50 clamp
    v_exp_f32 v51, v51 clamp
    v_max_f32 v48, 0, v48
    v_max_f32 v49, 0, v49
    v_add_f32 v48, v48, v50
    v_add_f32 v49, v49, v51
    v_min3_f32 v56, v48, v49, v56
    v_cvt_pk_bf16_f32 v37, v48, v49
    v_cvt_pk_bf16_f32 v38, v76, v77
    v_lshlrev_b32 v48, 16, v38
    v_and_b32 v49, 0xffff0000, v38
    v_mul_f32 v50, s72, v48
    v_mul_f32 v51, s72, v49
    v_exp_f32 v50, v50 clamp
    v_exp_f32 v51, v51 clamp
    v_max_f32 v48, 0, v48
    v_max_f32 v49, 0, v49
    v_add_f32 v48, v48, v50
    v_add_f32 v49, v49, v51
    v_min3_f32 v56, v48, v49, v56
    v_cvt_pk_bf16_f32 v38, v48, v49
    v_cvt_pk_bf16_f32 v39, v78, v79
    v_lshlrev_b32 v48, 16, v39
    v_and_b32 v49, 0xffff0000, v39
    v_mul_f32 v50, s72, v48
    v_mul_f32 v51, s72, v49
    v_exp_f32 v50, v50 clamp
    v_exp_f32 v51, v51 clamp
    v_max_f32 v48, 0, v48
    v_max_f32 v49, 0, v49
    v_add_f32 v48, v48, v50
    v_add_f32 v49, v49, v51
    v_min3_f32 v56, v48, v49, v56
    v_cvt_pk_bf16_f32 v39, v48, v49
    v_cmp_gt_f32 vcc, 0x3a800000, v56
    s_cbranch_vccnz phi_17_fix
phi_17_done:
    v_cvt_pk_bf16_f32 v40, v80, v81
    v_lshlrev_b32 v48, 16, v40
    v_and_b32 v49, 0xffff0000, v40
    v_mul_f32 v50, s72, v48
    v_mul_f32 v51, s72, v49
    v_exp_f32 v50, v50 clamp
    v_exp_f32 v51, v51 clamp
    v_max_f32 v48, 0, v48
    v_max_f32 v49, 0, v49
    v_add_f32 v48, v48, v50
    v_add_f32 v49, v49, v51
    v_min_f32 v56, v48, v49
    v_cvt_pk_bf16_f32 v40, v48, v49
    v_cvt_pk_bf16_f32 v41, v82, v83
    v_lshlrev_b32 v48, 16, v41
    v_and_b32 v49, 0xffff0000, v41
    v_mul_f32 v50, s72, v48
    v_mul_f32 v51, s72, v49
    v_exp_f32 v50, v50 clamp
    v_exp_f32 v51, v51 clamp
    v_max_f32 v48, 0, v48
    v_max_f32 v49, 0, v49
    v_add_f32 v48, v48, v50
    v_add_f32 v49, v49, v51
    v_min3_f32 v56, v48, v49, v56
    v_cvt_pk_bf16_f32 v41, v48, v49
    v_cvt_pk_bf16_f32 v42, v84, v85
    v_lshlrev_b32 v48, 16, v42
    v_and_b32 v49, 0xffff0000, v42
    v_mul_f32 v50, s72, v48
    v_mul_f32 v51, s72, v49
    v_exp_f32 v50, v50 clamp
    v_exp_f32 v51, v51 clamp
    v_max_f32 v48, 0, v48
    v_max_f32 v49, 0, v49
    v_add_f32 v48, v48, v50
    v_add_f32 v49, v49, v51
    v_min3_f32 v56, v48, v49, v56
    v_cvt_pk_bf16_f32 v42, v48, v49
    v_cvt_pk_bf16_f32 v43, v86, v87
    v_lshlrev_b32 v48, 16, v43
    v_and_b32 v49, 0xffff0000, v43
    v_mul_f32 v50, s72, v48
    v_mul_f32 v51, s72, v49
    v_exp_f32 v50, v50 clamp
    v_exp_f32 v51, v51 clamp
    v_max_f32 v48, 0, v48
    v_max_f32 v49, 0, v49
    v_add_f32 v48, v48, v50
    v_add_f32 v49, v49, v51
    v_min3_f32 v56, v48, v49, v56
    v_cvt_pk_bf16_f32 v43, v48, v49
    v_cvt_pk_bf16_f32 v44, v88, v89
    v_lshlrev_b32 v48, 16, v44
    v_and_b32 v49, 0xffff0000, v44
    v_mul_f32 v50, s72, v48
    v_mul_f32 v51, s72, v49
    v_exp_f32 v50, v50 clamp
    v_exp_f32 v51, v51 clamp
    v_max_f32 v48, 0, v48
    v_max_f32 v49, 0, v49
    v_add_f32 v48, v48, v50
    v_add_f32 v49, v49, v51
    v_min3_f32 v56, v48, v49, v56
    v_cvt_pk_bf16_f32 v44, v48, v49
    v_cvt_pk_bf16_f32 v45, v90, v91
    v_lshlrev_b32 v48, 16, v45
    v_and_b32 v49, 0xffff0000, v45
    v_mul_f32 v50, s72, v48
    v_mul_f32 v51, s72, v49
    v_exp_f32 v50, v50 clamp
    v_exp_f32 v51, v51 clamp
    v_max_f32 v48, 0, v48
    v_max_f32 v49, 0, v49
    v_add_f32 v48, v48, v50
    v_add_f32 v49, v49, v51
    v_min3_f32 v56, v48, v49, v56
    v_cvt_pk_bf16_f32 v45, v48, v49
    v_cvt_pk_bf16_f32 v46, v92, v93
    v_lshlrev_b32 v48, 16, v46
    v_and_b32 v49, 0xffff0000, v46
    v_mul_f32 v50, s72, v48
    v_mul_f32 v51, s72, v49
    v_exp_f32 v50, v50 clamp
    v_exp_f32 v51, v51 clamp
    v_max_f32 v48, 0, v48
    v_max_f32 v49, 0, v49
    v_add_f32 v48, v48, v50
    v_add_f32 v49, v49, v51
    v_min3_f32 v56, v48, v49, v56
    v_cvt_pk_bf16_f32 v46, v48, v49
    v_cvt_pk_bf16_f32 v47, v94, v95
    v_lshlrev_b32 v48, 16, v47
    v_and_b32 v49, 0xffff0000, v47
    v_mul_f32 v50, s72, v48
    v_mul_f32 v51, s72, v49
    v_exp_f32 v50, v50 clamp
    v_exp_f32 v51, v51 clamp
    v_max_f32 v48, 0, v48
    v_max_f32 v49, 0, v49
    v_add_f32 v48, v48, v50
    v_add_f32 v49, v49, v51
    v_min3_f32 v56, v48, v49, v56
    v_cvt_pk_bf16_f32 v47, v48, v49
    v_cmp_gt_f32 vcc, 0x3a800000, v56
    s_cbranch_vccnz phi_18_fix
phi_18_done:
    s_waitcnt lgkmcnt(0)
    v_readfirstlane_b32 s75, v6
    s_waitcnt vmcnt(0)
    v_sub_f32 v248, 1.0, v228
    v_cvt_pk_bf16_f32 v248, v248, v248
    v_lshlrev_b32 v248, 16, v248
    v_lshlrev_b32 v232, 16, v220
    v_and_b32 v233, 0xffff0000, v220
    v_mul_f32 v232, v232, v248
    v_mul_f32 v233, v233, v248
    v_cvt_pk_bf16_f32 v3, v232, v233
    v_lshlrev_b32 v232, 16, v3
    v_and_b32 v233, 0xffff0000, v3
    v_lshlrev_b32 v234, 16, v221
    v_and_b32 v235, 0xffff0000, v221
    v_mul_f32 v234, v234, v248
    v_mul_f32 v235, v235, v248
    v_cvt_pk_bf16_f32 v3, v234, v235
    v_lshlrev_b32 v234, 16, v3
    v_and_b32 v235, 0xffff0000, v3
    v_lshlrev_b32 v236, 16, v222
    v_and_b32 v237, 0xffff0000, v222
    v_mul_f32 v236, v236, v248
    v_mul_f32 v237, v237, v248
    v_cvt_pk_bf16_f32 v3, v236, v237
    v_lshlrev_b32 v236, 16, v3
    v_and_b32 v237, 0xffff0000, v3
    v_lshlrev_b32 v238, 16, v223
    v_and_b32 v239, 0xffff0000, v223
    v_mul_f32 v238, v238, v248
    v_mul_f32 v239, v239, v248
    v_cvt_pk_bf16_f32 v3, v238, v239
    v_lshlrev_b32 v238, 16, v3
    v_and_b32 v239, 0xffff0000, v3
    v_sub_f32 v249, 1.0, v229
    v_cvt_pk_bf16_f32 v249, v249, v249
    v_lshlrev_b32 v249, 16, v249
    v_lshlrev_b32 v240, 16, v224
    v_and_b32 v241, 0xffff0000, v224
    v_mul_f32 v240, v240, v249
    v_mul_f32 v241, v241, v249
    v_cvt_pk_bf16_f32 v3, v240, v241
    v_lshlrev_b32 v240, 16, v3
    v_and_b32 v241, 0xffff0000, v3
    v_lshlrev_b32 v242, 16, v225
    v_and_b32 v243, 0xffff0000, v225
    v_mul_f32 v242, v242, v249
    v_mul_f32 v243, v243, v249
    v_cvt_pk_bf16_f32 v3, v242, v243
    v_lshlrev_b32 v242, 16, v3
    v_and_b32 v243, 0xffff0000, v3
    v_lshlrev_b32 v244, 16, v226
    v_and_b32 v245, 0xffff0000, v226
    v_mul_f32 v244, v244, v249
    v_mul_f32 v245, v245, v249
    v_cvt_pk_bf16_f32 v3, v244, v245
    v_lshlrev_b32 v244, 16, v3
    v_and_b32 v245, 0xffff0000, v3
    v_lshlrev_b32 v246, 16, v227
    v_and_b32 v247, 0xffff0000, v227
    v_mul_f32 v246, v246, v249
    v_mul_f32 v247, v247, v249
    v_cvt_pk_bf16_f32 v3, v246, v247
    v_lshlrev_b32 v246, 16, v3
    v_and_b32 v247, 0xffff0000, v3
    s_cmp_lg_u32 s3, 0
    s_cbranch_scc1 C_nh
    s_lshr_b32 s64, s2, 2
    s_lshl_b32 s64, s64, 14
    s_add_u32 s64, s64, 5398528
    v_lshl_add_u32 v16, v2, 4, s64
    v_lshrrev_b32 v8, 4, v2
    s_mov_b32 s65, 0
H_hl:
    s_mov_b32 s64, 0
    buffer_load_dwordx4 v[64:67], v16, s[16:19], s64 offen offset:0 sc1
    s_mov_b32 s64, 0
    buffer_load_dwordx4 v[68:71], v16, s[16:19], s64 offen offset:1024 sc1
    s_mov_b32 s64, 0
    buffer_load_dwordx4 v[72:75], v16, s[16:19], s64 offen offset:2048 sc1
    s_mov_b32 s64, 0
    buffer_load_dwordx4 v[76:79], v16, s[16:19], s64 offen offset:3072 sc1
    s_mov_b32 s64, 4096
    buffer_load_dwordx4 v[80:83], v16, s[16:19], s64 offen offset:0 sc1
    s_mov_b32 s64, 4096
    buffer_load_dwordx4 v[84:87], v16, s[16:19], s64 offen offset:1024 sc1
    s_mov_b32 s64, 4096
    buffer_load_dwordx4 v[88:91], v16, s[16:19], s64 offen offset:2048 sc1
    s_mov_b32 s64, 4096
    buffer_load_dwordx4 v[92:95], v16, s[16:19], s64 offen offset:3072 sc1
    s_mov_b32 s64, 8192
    buffer_load_dwordx4 v[96:99], v16, s[16:19], s64 offen offset:0 sc1
    s_mov_b32 s64, 8192
    buffer_load_dwordx4 v[100:103], v16, s[16:19], s64 offen offset:1024 sc1
    s_mov_b32 s64, 8192
    buffer_load_dwordx4 v[104:107], v16, s[16:19], s64 offen offset:2048 sc1
    s_mov_b32 s64, 8192
    buffer_load_dwordx4 v[108:111], v16, s[16:19], s64 offen offset:3072 sc1
    s_mov_b32 s64, 12288
    buffer_load_dwordx4 v[112:115], v16, s[16:19], s64 offen offset:0 sc1
    s_mov_b32 s64, 12288
    buffer_load_dwordx4 v[116:119], v16, s[16:19], s64 offen offset:1024 sc1
    s_mov_b32 s64, 12288
    buffer_load_dwordx4 v[120:123], v16, s[16:19], s64 offen offset:2048 sc1
    s_mov_b32 s64, 12288
    buffer_load_dwordx4 v[124:127], v16, s[16:19], s64 offen offset:3072 sc1
    s_waitcnt vmcnt(0)
    v_max3_u32 v17, v64, v65, v66
    v_max3_u32 v17, v67, v68, v17
    v_max3_u32 v17, v69, v70, v17
    v_max3_u32 v17, v71, v72, v17
    v_max3_u32 v17, v73, v74, v17
    v_max3_u32 v17, v75, v76, v17
    v_max3_u32 v17, v77, v78, v17
    v_max3_u32 v17, v79, v80, v17
    v_max3_u32 v17, v81, v82, v17
    v_max3_u32 v17, v83, v84, v17
    v_max3_u32 v17, v85, v86, v17
    v_max3_u32 v17, v87, v88, v17
    v_max3_u32 v17, v89, v90, v17
    v_max3_u32 v17, v91, v92, v17
    v_max3_u32 v17, v93, v94, v17
    v_max3_u32 v17, v95, v96, v17
    v_max3_u32 v17, v97, v98, v17
    v_max3_u32 v17, v99, v100, v17
    v_max3_u32 v17, v101, v102, v17
    v_max3_u32 v17, v103, v104, v17
    v_max3_u32 v17, v105, v106, v17
    v_max3_u32 v17, v107, v108, v17
    v_max3_u32 v17, v109, v110, v17
    v_max3_u32 v17, v111, v112, v17
    v_max3_u32 v17, v113, v114, v17
    v_max3_u32 v17, v115, v116, v17
    v_max3_u32 v17, v117, v118, v17
    v_max3_u32 v17, v119, v120, v17
    v_max3_u32 v17, v121, v122, v17
    v_max3_u32 v17, v123, v124, v17
    v_max3_u32 v17, v125, v126, v17
    v_max_u32 v17, v127, v17
    s_mov_b32 exec_lo, 0x3fff3fff
    s_mov_b32 exec_hi, 0x3fff3fff
    v_cmp_eq_u32 vcc, -1, v17
    s_mov_b64 exec, -1
    s_cbranch_vccz H_hok
    s_add_u32 s65, s65, 1
    s_cmp_ge_u32 s65, 100000
    s_cbranch_scc1 H_hok
    s_sleep 8
    s_branch H_hl
H_hok:
    v_add_f32 v64, v64, v68
    v_add_f32 v65, v65, v69
    v_add_f32 v66, v66, v70
    v_add_f32 v67, v67, v71
    v_add_f32 v64, v64, v72
    v_add_f32 v65, v65, v73
    v_add_f32 v66, v66, v74
    v_add_f32 v67, v67, v75
    v_add_f32 v64, v64, v76
    v_add_f32 v65, v65, v77
    v_add_f32 v66, v66, v78
    v_add_f32 v67, v67, v79
    v_add_f32 v64, v64, v80
    v_add_f32 v65, v65, v81
    v_add_f32 v66, v66, v82
    v_add_f32 v67, v67, v83
    v_add_f32 v64, v64, v84
    v_add_f32 v65, v65, v85
    v_add_f32 v66, v66, v86
    v_add_f32 v67, v67, v87
    v_add_f32 v64, v64, v88
    v_add_f32 v65, v65, v89
    v_add_f32 v66, v66, v90
    v_add_f32 v67, v67, v91
    v_add_f32 v64, v64, v92
    v_add_f32 v65, v65, v93
    v_add_f32 v66, v66, v94
    v_add_f32 v67, v67, v95
    v_add_f32 v96, v96, v100
    v_add_f32 v97, v97, v101
    v_add_f32 v98, v98, v102
    v_add_f32 v99, v99, v103
    v_add_f32 v96, v96, v104
    v_add_f32 v97, v97, v105
    v_add_f32 v98, v98, v106
    v_add_f32 v99, v99, v107
    v_add_f32 v96, v96, v108
    v_add_f32 v97, v97, v109
    v_add_f32 v98, v98, v110
    v_add_f32 v99, v99, v111
    v_add_f32 v96, v96, v112
    v_add_f32 v97, v97, v113
    v_add_f32 v98, v98, v114
    v_add_f32 v99, v99, v115
    v_add_f32 v96, v96, v116
    v_add_f32 v97, v97, v117
    v_add_f32 v98, v98, v118
    v_add_f32 v99, v99, v119
    v_add_f32 v96, v96, v120
    v_add_f32 v97, v97, v121
    v_add_f32 v98, v98, v122
    v_add_f32 v99, v99, v123
    v_add_f32 v96, v96, v124
    v_add_f32 v97, v97, v125
    v_add_f32 v98, v98, v126
    v_add_f32 v99, v99, v127
    s_nop 1
    v_permlane16_swap_b32 v64, v96
    v_permlane16_swap_b32 v65, v97
    v_permlane16_swap_b32 v66, v98
    v_permlane16_swap_b32 v67, v99
    v_add_f32 v64, v64, v96
    v_add_f32 v65, v65, v97
    v_add_f32 v66, v66, v98
    v_add_f32 v67, v67, v99
    s_nop 1
    v_permlane32_swap_b32 v64, v66
    v_permlane32_swap_b32 v65, v67
    v_add_f32 v64, v64, v66
    v_add_f32 v65, v65, v67
    s_nop 1
    v_permlane16_swap_b32 v64, v65
    v_cvt_pk_bf16_f32 v66, v64, v65
    v_lshlrev_b32 v64, 16, v66
    v_and_b32 v65, 0xffff0000, v66
    v_mul_f32 v66, s72, v64
    v_exp_f32 v66, -v66
    v_and_b32 v16, 15, v2
    v_add_f32 v66, 1.0, v66
    v_rcp_f32 v66, v66
    v_lshl_add_u32 v16, v16, 2, v8
    v_mul_f32 v66, v66, v64
    v_cvt_pk_bf16_f32 v66, v66, v66
    v_lshlrev_b32 v66, 16, v66
    v_mul_f32 v66, v66, v65
    v_cvt_pk_bf16_f32 v66, v66, v66
    v_lshlrev_b32 v66, 16, v66
    v_lshlrev_b32 v16, 2, v16
    ds_write_b32 v16, v66 offset:4352
    s_waitcnt lgkmcnt(0)
C_nh:
    v_lshlrev_b32 v3, 4, v2
    s_barrier
    ds_read_b128 v[24:27], v5 offset:4096
    ds_read_b128 v[16:19], v4 offset:0
    ds_read_b128 v[20:23], v4 offset:1024
    s_waitcnt lgkmcnt(2)
    v_mfma_f32_16x16x32_bf16 v[96:99], v[24:27], v[32:35], 0
    v_mfma_f32_16x16x32_bf16 v[100:103], v[24:27], v[36:39], 0
    v_mfma_f32_16x16x32_bf16 v[104:107], v[24:27], v[40:43], 0
    v_mfma_f32_16x16x32_bf16 v[108:111], v[24:27], v[44:47], 0
    s_waitcnt lgkmcnt(0)
    v_mfma_f32_16x16x32_bf16 v[64:67], v[16:19], v[32:35], 0
    v_mfma_f32_16x16x32_bf16 v[68:71], v[20:23], v[32:35], 0
    v_mfma_f32_16x16x32_bf16 v[72:75], v[16:19], v[36:39], 0
    v_mfma_f32_16x16x32_bf16 v[76:79], v[20:23], v[36:39], 0
    v_mfma_f32_16x16x32_bf16 v[80:83], v[16:19], v[40:43], 0
    v_mfma_f32_16x16x32_bf16 v[84:87], v[20:23], v[40:43], 0
    v_mfma_f32_16x16x32_bf16 v[88:91], v[16:19], v[44:47], 0
    v_mfma_f32_16x16x32_bf16 v[92:95], v[20:23], v[44:47], 0
    v_cvt_pk_bf16_f32 v48, v96, v96
    v_cvt_pk_bf16_f32 v49, v100, v100
    v_cvt_pk_bf16_f32 v50, v104, v104
    v_cvt_pk_bf16_f32 v51, v108, v108
    v_lshlrev_b32 v48, 16, v48
    v_lshlrev_b32 v49, 16, v49
    v_lshlrev_b32 v50, 16, v50
    v_lshlrev_b32 v51, 16, v51
    v_add_f32 v48, s73, v48
    v_add_f32 v49, s73, v49
    v_add_f32 v50, s73, v50
    v_add_f32 v51, s73, v51
    v_cvt_pk_bf16_f32 v48, v48, v48
    v_cvt_pk_bf16_f32 v49, v49, v49
    v_cvt_pk_bf16_f32 v50, v50, v50
    v_cvt_pk_bf16_f32 v51, v51, v51
    v_lshlrev_b32 v48, 16, v48
    v_lshlrev_b32 v49, 16, v49
    v_lshlrev_b32 v50, 16, v50
    v_lshlrev_b32 v51, 16, v51
    v_rcp_f32 v48, v48
    v_rcp_f32 v49, v49
    v_rcp_f32 v50, v50
    v_rcp_f32 v51, v51
    s_nop 0
    v_mul_f32 v64, v64, v48
    v_mul_f32 v65, v65, v48
    v_cvt_pk_bf16_f32 v128, v64, v65
    v_mul_f32 v66, v66, v48
    v_mul_f32 v67, v67, v48
    v_cvt_pk_bf16_f32 v129, v66, v67
    v_mul_f32 v68, v68, v48
    v_mul_f32 v69, v69, v48
    v_cvt_pk_bf16_f32 v130, v68, v69
    v_mul_f32 v70, v70, v48
    v_mul_f32 v71, v71, v48
    v_cvt_pk_bf16_f32 v131, v70, v71
    buffer_store_dwordx4 v[128:131], v3, s[16:19], s42 offen offset:0 sc0 sc1
    v_mul_f32 v72, v72, v49
    v_mul_f32 v73, v73, v49
    v_cvt_pk_bf16_f32 v132, v72, v73
    v_mul_f32 v74, v74, v49
    v_mul_f32 v75, v75, v49
    v_cvt_pk_bf16_f32 v133, v74, v75
    v_mul_f32 v76, v76, v49
    v_mul_f32 v77, v77, v49
    v_cvt_pk_bf16_f32 v134, v76, v77
    v_mul_f32 v78, v78, v49
    v_mul_f32 v79, v79, v49
    v_cvt_pk_bf16_f32 v135, v78, v79
    buffer_store_dwordx4 v[132:135], v3, s[16:19], s42 offen offset:1024 sc0 sc1
    s_add_u32 s42, s42, 65536
    v_mul_f32 v80, v80, v50
    v_mul_f32 v81, v81, v50
    v_cvt_pk_bf16_f32 v136, v80, v81
    v_mul_f32 v82, v82, v50
    v_mul_f32 v83, v83, v50
    v_cvt_pk_bf16_f32 v137, v82, v83
    v_mul_f32 v84, v84, v50
    v_mul_f32 v85, v85, v50
    v_cvt_pk_bf16_f32 v138, v84, v85
    v_mul_f32 v86, v86, v50
    v_mul_f32 v87, v87, v50
    v_cvt_pk_bf16_f32 v139, v86, v87
    buffer_store_dwordx4 v[136:139], v3, s[16:19], s42 offen offset:0 sc0 sc1
    v_mul_f32 v88, v88, v51
    v_mul_f32 v89, v89, v51
    v_cvt_pk_bf16_f32 v140, v88, v89
    v_mul_f32 v90, v90, v51
    v_mul_f32 v91, v91, v51
    v_cvt_pk_bf16_f32 v141, v90, v91
    v_mul_f32 v92, v92, v51
    v_mul_f32 v93, v93, v51
    v_cvt_pk_bf16_f32 v142, v92, v93
    v_mul_f32 v94, v94, v51
    v_mul_f32 v95, v95, v51
    v_cvt_pk_bf16_f32 v143, v94, v95
    buffer_store_dwordx4 v[140:143], v3, s[16:19], s42 offen offset:1024 sc0 sc1
    s_lshl_b32 s64, s4, 3
    s_add_u32 s64, s64, s3
    s_lshl_b32 s64, s64, 7
    s_add_u32 s64, s64, 5382144
    v_mov_b32 v14, s64
    s_mov_b64 exec, 1
    v_mov_b32 v15, 0
    buffer_atomic_or v15, v14, s[16:19], 0 offen sc0
    s_mov_b64 exec, -1
    s_waitcnt vmcnt(1)
    s_mov_b64 exec, 3
    buffer_atomic_or v13, v12, s[16:19], 0 offen
    s_mov_b64 exec, -1
P2_start:
    s_and_b32 s6, s3, 3
    s_lshr_b32 s7, s3, 2
    s_mov_b32 s20, s58
    s_mov_b32 s21, s59
    s_mov_b32 s22, 0x400000
    s_mov_b32 s23, 0x00020000
    s_and_b32 s67, s75, 0x7ff
    s_sub_u32 s67, 2047, s67
    s_lshl_b32 s64, s4, 2
    s_add_u32 s64, s64, s6
    s_lshl_b32 s64, s64, 16
    s_lshl_b32 s65, s7, 15
    s_add_u32 s64, s64, s65
    v_lshlrev_b32 v4, 4, v2
    v_add_u32 v4, s64, v4
    v_lshrrev_b32 v10, 4, v2
    v_bfe_u32 v11, v2, 2, 2
    v_lshl_add_u32 v12, v10, 2, v11
    v_bfe_u32 v13, v12, 1, 2
    v_lshlrev_b32 v12, 7, v12
    v_lshl_add_u32 v12, v13, 5, v12
    v_and_b32 v13, 3, v2
    v_lshl_add_u32 v5, v13, 3, v12
    v_xor_b32 v6, 32, v5
    v_xor_b32 v1, 64, v5
    v_xor_b32 v3, 96, v5
    s_lshl_b32 s74, s74, 1
    s_cmp_eq_u32 s7, 0
    s_mov_b32 s64, 147456
    s_cselect_b32 s64, 131072, s64
    s_sub_u32 m0, 16, s74
    s_and_b32 m0, m0, 15
    v_writelane_b32 v7, s64, m0
    s_cmp_eq_u32 s7, 0
    s_mov_b32 s64, 155648
    s_cselect_b32 s64, 139264, s64
    s_sub_u32 m0, 18, s74
    s_and_b32 m0, m0, 15
    v_writelane_b32 v7, s64, m0
    s_cmp_eq_u32 s7, 0
    s_mov_b32 s64, 81920
    s_cselect_b32 s64, 73728, s64
    s_sub_u32 m0, 20, s74
    s_and_b32 m0, m0, 15
    v_writelane_b32 v7, s64, m0
    s_cmp_eq_u32 s7, 0
    s_mov_b32 s64, 122880
    s_cselect_b32 s64, 114688, s64
    s_sub_u32 m0, 22, s74
    s_and_b32 m0, m0, 15
    v_writelane_b32 v7, s64, m0
    s_cmp_eq_u32 s7, 0
    s_mov_b32 s64, 49152
    s_cselect_b32 s64, 40960, s64
    s_sub_u32 m0, 24, s74
    s_and_b32 m0, m0, 15
    v_writelane_b32 v7, s64, m0
    s_cmp_eq_u32 s7, 0
    s_mov_b32 s64, 57344
    s_cselect_b32 s64, 8192, s64
    s_sub_u32 m0, 26, s74
    s_and_b32 m0, m0, 15
    v_writelane_b32 v7, s64, m0
    s_cmp_eq_u32 s7, 0
    s_mov_b32 s64, 65536
    s_cselect_b32 s64, 16384, s64
    s_sub_u32 m0, 28, s74
    s_and_b32 m0, m0, 15
    v_writelane_b32 v7, s64, m0
    s_cmp_eq_u32 s7, 0
    s_mov_b32 s64, 90112
    s_cselect_b32 s64, 98304, s64
    s_sub_u32 m0, 30, s74
    s_and_b32 m0, m0, 15
    v_writelane_b32 v7, s64, m0
    s_cmp_eq_u32 s7, 0
    v_mov_b32 v16, 0
    v_mov_b32 v17, 0
    v_mov_b32 v18, 0
    v_mov_b32 v19, 0
    v_mov_b32 v20, 0
    v_mov_b32 v21, 0
    v_mov_b32 v22, 0
    v_mov_b32 v23, 0
    v_mov_b32 v24, 0
    v_mov_b32 v25, 0
    v_mov_b32 v26, 0
    v_mov_b32 v27, 0
    v_mov_b32 v28, 0
    v_mov_b32 v29, 0
    v_mov_b32 v30, 0
    v_mov_b32 v31, 0
    v_mov_b32 v32, 0
    v_mov_b32 v33, 0
    v_mov_b32 v34, 0
    v_mov_b32 v35, 0
    v_mov_b32 v36, 0
    v_mov_b32 v37, 0
    v_mov_b32 v38, 0
    v_mov_b32 v39, 0
    v_mov_b32 v40, 0
    v_mov_b32 v41, 0
    v_mov_b32 v42, 0
    v_mov_b32 v43, 0
    v_mov_b32 v44, 0
    v_mov_b32 v45, 0
    v_mov_b32 v46, 0
    v_mov_b32 v47, 0
    s_mov_b32 s66, 0x5555
    s_mov_b32 s65, 0
    s_cmp_lt_u32 s3, 4
    s_cbranch_scc0 D_wait
    s_waitcnt vmcnt(1)
    s_branch D_got
D_wait:
    s_waitcnt vmcnt(0)
D_got:
    v_readfirstlane_b32 s68, v15
    s_mul_i32 s68, s68, 0x10001
    s_lshr_b32 s68, s68, s74
    s_lshr_b32 s64, s68, 1
    s_and_b32 s68, s68, s64
    s_and_b32 s68, s68, s66
    s_cbranch_scc1 D_go
    s_add_u32 s65, s65, 1
    s_cmp_ge_u32 s65, 40000
    s_cbranch_scc1 D_end
    s_sleep 1
    s_mov_b64 exec, 1
    v_mov_b32 v15, 0
    buffer_atomic_or v15, v14, s[16:19], 0 offen sc0
    s_mov_b64 exec, -1
    s_branch D_wait
D_go:
    s_andn2_b32 s66, s66, s68
    s_lshr_b32 s64, s67, 7
    s_xor_b32 s64, s64, s4
    s_or_b32 s64, s64, s66
    s_cbranch_scc0 P2_yl
P2_nyl:
    s_bcnt1_i32_b32 s70, s68
    s_cmp_gt_u32 s70, 4
    s_cbranch_scc1 D_t58
    s_cmp_gt_u32 s70, 2
    s_cbranch_scc1 D_t34
    s_cmp_eq_u32 s70, 2
    s_cbranch_scc1 D_e2
D_e1:
    s_ff1_i32_b32 s64, s68
    s_bitset0_b32 s68, s64
    v_readlane_b32 s32, v7, s64
    s_add_u32 s69, s64, s74
    s_and_b32 s69, s69, 15
    s_lshl_b32 s69, s69, 11
    buffer_load_dwordx4 v[80:83], v4, s[16:19], s69 offen offset:0 sc1
    buffer_load_dwordx4 v[84:87], v4, s[16:19], s69 offen offset:1024 sc1
    buffer_load_dwordx4 v[88:91], v4, s[16:19], s69 offen offset:2048 sc1
    buffer_load_dwordx4 v[92:95], v4, s[16:19], s69 offen offset:3072 sc1
    s_mov_b64 exec, 1
    v_mov_b32 v15, 0
    buffer_atomic_or v15, v14, s[16:19], 0 offen sc0
    s_mov_b64 exec, -1
    v_add_u32 v8, s32, v5
    ds_read_b64_tr_b16 v[48:49], v8 offset:0
    ds_read_b64_tr_b16 v[50:51], v8 offset:2048
    v_add_u32 v9, s32, v6
    ds_read_b64_tr_b16 v[52:53], v9 offset:0
    ds_read_b64_tr_b16 v[54:55], v9 offset:2048
    v_add_u32 v10, s32, v1
    ds_read_b64_tr_b16 v[56:57], v10 offset:0
    ds_read_b64_tr_b16 v[58:59], v10 offset:2048
    v_add_u32 v11, s32, v3
    ds_read_b64_tr_b16 v[60:61], v11 offset:0
    ds_read_b64_tr_b16 v[62:63], v11 offset:2048
    s_branch D_p0
D_e2:
    s_ff1_i32_b32 s64, s68
    s_bitset0_b32 s68, s64
    v_readlane_b32 s33, v7, s64
    s_add_u32 s69, s64, s74
    s_and_b32 s69, s69, 15
    s_lshl_b32 s69, s69, 11
    buffer_load_dwordx4 v[96:99], v4, s[16:19], s69 offen offset:0 sc1
    buffer_load_dwordx4 v[100:103], v4, s[16:19], s69 offen offset:1024 sc1
    buffer_load_dwordx4 v[104:107], v4, s[16:19], s69 offen offset:2048 sc1
    buffer_load_dwordx4 v[108:111], v4, s[16:19], s69 offen offset:3072 sc1
    s_ff1_i32_b32 s64, s68
    s_bitset0_b32 s68, s64
    v_readlane_b32 s32, v7, s64
    s_add_u32 s69, s64, s74
    s_and_b32 s69, s69, 15
    s_lshl_b32 s69, s69, 11
    buffer_load_dwordx4 v[80:83], v4, s[16:19], s69 offen offset:0 sc1
    buffer_load_dwordx4 v[84:87], v4, s[16:19], s69 offen offset:1024 sc1
    buffer_load_dwordx4 v[88:91], v4, s[16:19], s69 offen offset:2048 sc1
    buffer_load_dwordx4 v[92:95], v4, s[16:19], s69 offen offset:3072 sc1
    s_mov_b64 exec, 1
    v_mov_b32 v15, 0
    buffer_atomic_or v15, v14, s[16:19], 0 offen sc0
    s_mov_b64 exec, -1
    v_add_u32 v8, s33, v5
    ds_read_b64_tr_b16 v[48:49], v8 offset:0
    ds_read_b64_tr_b16 v[50:51], v8 offset:2048
    v_add_u32 v9, s33, v6
    ds_read_b64_tr_b16 v[52:53], v9 offset:0
    ds_read_b64_tr_b16 v[54:55], v9 offset:2048
    v_add_u32 v10, s33, v1
    ds_read_b64_tr_b16 v[56:57], v10 offset:0
    ds_read_b64_tr_b16 v[58:59], v10 offset:2048
    v_add_u32 v11, s33, v3
    ds_read_b64_tr_b16 v[60:61], v11 offset:0
    ds_read_b64_tr_b16 v[62:63], v11 offset:2048
    s_branch D_p1
D_t34:
    s_cmp_eq_u32 s70, 4
    s_cbranch_scc1 D_e4
D_e3:
    s_ff1_i32_b32 s64, s68
    s_bitset0_b32 s68, s64
    v_readlane_b32 s34, v7, s64
    s_add_u32 s69, s64, s74
    s_and_b32 s69, s69, 15
    s_lshl_b32 s69, s69, 11
    buffer_load_dwordx4 v[112:115], v4, s[16:19], s69 offen offset:0 sc1
    buffer_load_dwordx4 v[116:119], v4, s[16:19], s69 offen offset:1024 sc1
    buffer_load_dwordx4 v[120:123], v4, s[16:19], s69 offen offset:2048 sc1
    buffer_load_dwordx4 v[124:127], v4, s[16:19], s69 offen offset:3072 sc1
    s_ff1_i32_b32 s64, s68
    s_bitset0_b32 s68, s64
    v_readlane_b32 s33, v7, s64
    s_add_u32 s69, s64, s74
    s_and_b32 s69, s69, 15
    s_lshl_b32 s69, s69, 11
    buffer_load_dwordx4 v[96:99], v4, s[16:19], s69 offen offset:0 sc1
    buffer_load_dwordx4 v[100:103], v4, s[16:19], s69 offen offset:1024 sc1
    buffer_load_dwordx4 v[104:107], v4, s[16:19], s69 offen offset:2048 sc1
    buffer_load_dwordx4 v[108:111], v4, s[16:19], s69 offen offset:3072 sc1
    v_add_u32 v8, s34, v5
    ds_read_b64_tr_b16 v[48:49], v8 offset:0
    ds_read_b64_tr_b16 v[50:51], v8 offset:2048
    v_add_u32 v9, s34, v6
    ds_read_b64_tr_b16 v[52:53], v9 offset:0
    ds_read_b64_tr_b16 v[54:55], v9 offset:2048
    v_add_u32 v10, s34, v1
    ds_read_b64_tr_b16 v[56:57], v10 offset:0
    ds_read_b64_tr_b16 v[58:59], v10 offset:2048
    v_add_u32 v11, s34, v3
    ds_read_b64_tr_b16 v[60:61], v11 offset:0
    ds_read_b64_tr_b16 v[62:63], v11 offset:2048
    s_branch D_p2
D_e4:
    s_ff1_i32_b32 s64, s68
    s_bitset0_b32 s68, s64
    v_readlane_b32 s35, v7, s64
    s_add_u32 s69, s64, s74
    s_and_b32 s69, s69, 15
    s_lshl_b32 s69, s69, 11
    buffer_load_dwordx4 v[128:131], v4, s[16:19], s69 offen offset:0 sc1
    buffer_load_dwordx4 v[132:135], v4, s[16:19], s69 offen offset:1024 sc1
    buffer_load_dwordx4 v[136:139], v4, s[16:19], s69 offen offset:2048 sc1
    buffer_load_dwordx4 v[140:143], v4, s[16:19], s69 offen offset:3072 sc1
    s_ff1_i32_b32 s64, s68
    s_bitset0_b32 s68, s64
    v_readlane_b32 s34, v7, s64
    s_add_u32 s69, s64, s74
    s_and_b32 s69, s69, 15
    s_lshl_b32 s69, s69, 11
    buffer_load_dwordx4 v[112:115], v4, s[16:19], s69 offen offset:0 sc1
    buffer_load_dwordx4 v[116:119], v4, s[16:19], s69 offen offset:1024 sc1
    buffer_load_dwordx4 v[120:123], v4, s[16:19], s69 offen offset:2048 sc1
    buffer_load_dwordx4 v[124:127], v4, s[16:19], s69 offen offset:3072 sc1
    v_add_u32 v8, s35, v5
    ds_read_b64_tr_b16 v[48:49], v8 offset:0
    ds_read_b64_tr_b16 v[50:51], v8 offset:2048
    v_add_u32 v9, s35, v6
    ds_read_b64_tr_b16 v[52:53], v9 offset:0
    ds_read_b64_tr_b16 v[54:55], v9 offset:2048
    v_add_u32 v10, s35, v1
    ds_read_b64_tr_b16 v[56:57], v10 offset:0
    ds_read_b64_tr_b16 v[58:59], v10 offset:2048
    v_add_u32 v11, s35, v3
    ds_read_b64_tr_b16 v[60:61], v11 offset:0
    ds_read_b64_tr_b16 v[62:63], v11 offset:2048
    s_branch D_p3
D_t58:
    s_cmp_gt_u32 s70, 6
    s_cbranch_scc1 D_t78
    s_cmp_eq_u32 s70, 6
    s_cbranch_scc1 D_e6
D_e5:
    s_ff1_i32_b32 s64, s68
    s_bitset0_b32 s68, s64
    v_readlane_b32 s36, v7, s64
    s_add_u32 s69, s64, s74
    s_and_b32 s69, s69, 15
    s_lshl_b32 s69, s69, 11
    buffer_load_dwordx4 v[144:147], v4, s[16:19], s69 offen offset:0 sc1
    buffer_load_dwordx4 v[148:151], v4, s[16:19], s69 offen offset:1024 sc1
    buffer_load_dwordx4 v[152:155], v4, s[16:19], s69 offen offset:2048 sc1
    buffer_load_dwordx4 v[156:159], v4, s[16:19], s69 offen offset:3072 sc1
    s_ff1_i32_b32 s64, s68
    s_bitset0_b32 s68, s64
    v_readlane_b32 s35, v7, s64
    s_add_u32 s69, s64, s74
    s_and_b32 s69, s69, 15
    s_lshl_b32 s69, s69, 11
    buffer_load_dwordx4 v[128:131], v4, s[16:19], s69 offen offset:0 sc1
    buffer_load_dwordx4 v[132:135], v4, s[16:19], s69 offen offset:1024 sc1
    buffer_load_dwordx4 v[136:139], v4, s[16:19], s69 offen offset:2048 sc1
    buffer_load_dwordx4 v[140:143], v4, s[16:19], s69 offen offset:3072 sc1
    v_add_u32 v8, s36, v5
    ds_read_b64_tr_b16 v[48:49], v8 offset:0
    ds_read_b64_tr_b16 v[50:51], v8 offset:2048
    v_add_u32 v9, s36, v6
    ds_read_b64_tr_b16 v[52:53], v9 offset:0
    ds_read_b64_tr_b16 v[54:55], v9 offset:2048
    v_add_u32 v10, s36, v1
    ds_read_b64_tr_b16 v[56:57], v10 offset:0
    ds_read_b64_tr_b16 v[58:59], v10 offset:2048
    v_add_u32 v11, s36, v3
    ds_read_b64_tr_b16 v[60:61], v11 offset:0
    ds_read_b64_tr_b16 v[62:63], v11 offset:2048
    s_branch D_p4
D_e6:
    s_ff1_i32_b32 s64, s68
    s_bitset0_b32 s68, s64
    v_readlane_b32 s37, v7, s64
    s_add_u32 s69, s64, s74
    s_and_b32 s69, s69, 15
    s_lshl_b32 s69, s69, 11
    buffer_load_dwordx4 v[160:163], v4, s[16:19], s69 offen offset:0 sc1
    buffer_load_dwordx4 v[164:167], v4, s[16:19], s69 offen offset:1024 sc1
    buffer_load_dwordx4 v[168:171], v4, s[16:19], s69 offen offset:2048 sc1
    buffer_load_dwordx4 v[172:175], v4, s[16:19], s69 offen offset:3072 sc1
    s_ff1_i32_b32 s64, s68
    s_bitset0_b32 s68, s64
    v_readlane_b32 s36, v7, s64
    s_add_u32 s69, s64, s74
    s_and_b32 s69, s69, 15
    s_lshl_b32 s69, s69, 11
    buffer_load_dwordx4 v[144:147], v4, s[16:19], s69 offen offset:0 sc1
    buffer_load_dwordx4 v[148:151], v4, s[16:19], s69 offen offset:1024 sc1
    buffer_load_dwordx4 v[152:155], v4, s[16:19], s69 offen offset:2048 sc1
    buffer_load_dwordx4 v[156:159], v4, s[16:19], s69 offen offset:3072 sc1
    v_add_u32 v8, s37, v5
    ds_read_b64_tr_b16 v[48:49], v8 offset:0
    ds_read_b64_tr_b16 v[50:51], v8 offset:2048
    v_add_u32 v9, s37, v6
    ds_read_b64_tr_b16 v[52:53], v9 offset:0
    ds_read_b64_tr_b16 v[54:55], v9 offset:2048
    v_add_u32 v10, s37, v1
    ds_read_b64_tr_b16 v[56:57], v10 offset:0
    ds_read_b64_tr_b16 v[58:59], v10 offset:2048
    v_add_u32 v11, s37, v3
    ds_read_b64_tr_b16 v[60:61], v11 offset:0
    ds_read_b64_tr_b16 v[62:63], v11 offset:2048
    s_branch D_p5
D_t78:
    s_cmp_eq_u32 s70, 8
    s_cbranch_scc1 D_e8
D_e7:
    s_ff1_i32_b32 s64, s68
    s_bitset0_b32 s68, s64
    v_readlane_b32 s38, v7, s64
    s_add_u32 s69, s64, s74
    s_and_b32 s69, s69, 15
    s_lshl_b32 s69, s69, 11
    buffer_load_dwordx4 v[176:179], v4, s[16:19], s69 offen offset:0 sc1
    buffer_load_dwordx4 v[180:183], v4, s[16:19], s69 offen offset:1024 sc1
    buffer_load_dwordx4 v[184:187], v4, s[16:19], s69 offen offset:2048 sc1
    buffer_load_dwordx4 v[188:191], v4, s[16:19], s69 offen offset:3072 sc1
    s_ff1_i32_b32 s64, s68
    s_bitset0_b32 s68, s64
    v_readlane_b32 s37, v7, s64
    s_add_u32 s69, s64, s74
    s_and_b32 s69, s69, 15
    s_lshl_b32 s69, s69, 11
    buffer_load_dwordx4 v[160:163], v4, s[16:19], s69 offen offset:0 sc1
    buffer_load_dwordx4 v[164:167], v4, s[16:19], s69 offen offset:1024 sc1
    buffer_load_dwordx4 v[168:171], v4, s[16:19], s69 offen offset:2048 sc1
    buffer_load_dwordx4 v[172:175], v4, s[16:19], s69 offen offset:3072 sc1
    v_add_u32 v8, s38, v5
    ds_read_b64_tr_b16 v[48:49], v8 offset:0
    ds_read_b64_tr_b16 v[50:51], v8 offset:2048
    v_add_u32 v9, s38, v6
    ds_read_b64_tr_b16 v[52:53], v9 offset:0
    ds_read_b64_tr_b16 v[54:55], v9 offset:2048
    v_add_u32 v10, s38, v1
    ds_read_b64_tr_b16 v[56:57], v10 offset:0
    ds_read_b64_tr_b16 v[58:59], v10 offset:2048
    v_add_u32 v11, s38, v3
    ds_read_b64_tr_b16 v[60:61], v11 offset:0
    ds_read_b64_tr_b16 v[62:63], v11 offset:2048
    s_branch D_p6
D_e8:
    s_ff1_i32_b32 s64, s68
    s_bitset0_b32 s68, s64
    v_readlane_b32 s39, v7, s64
    s_add_u32 s69, s64, s74
    s_and_b32 s69, s69, 15
    s_lshl_b32 s69, s69, 11
    buffer_load_dwordx4 v[192:195], v4, s[16:19], s69 offen offset:0 sc1
    buffer_load_dwordx4 v[196:199], v4, s[16:19], s69 offen offset:1024 sc1
    buffer_load_dwordx4 v[200:203], v4, s[16:19], s69 offen offset:2048 sc1
    buffer_load_dwordx4 v[204:207], v4, s[16:19], s69 offen offset:3072 sc1
    s_ff1_i32_b32 s64, s68
    s_bitset0_b32 s68, s64
    v_readlane_b32 s38, v7, s64
    s_add_u32 s69, s64, s74
    s_and_b32 s69, s69, 15
    s_lshl_b32 s69, s69, 11
    buffer_load_dwordx4 v[176:179], v4, s[16:19], s69 offen offset:0 sc1
    buffer_load_dwordx4 v[180:183], v4, s[16:19], s69 offen offset:1024 sc1
    buffer_load_dwordx4 v[184:187], v4, s[16:19], s69 offen offset:2048 sc1
    buffer_load_dwordx4 v[188:191], v4, s[16:19], s69 offen offset:3072 sc1
    v_add_u32 v8, s39, v5
    ds_read_b64_tr_b16 v[48:49], v8 offset:0
    ds_read_b64_tr_b16 v[50:51], v8 offset:2048
    v_add_u32 v9, s39, v6
    ds_read_b64_tr_b16 v[52:53], v9 offset:0
    ds_read_b64_tr_b16 v[54:55], v9 offset:2048
    v_add_u32 v10, s39, v1
    ds_read_b64_tr_b16 v[56:57], v10 offset:0
    ds_read_b64_tr_b16 v[58:59], v10 offset:2048
    v_add_u32 v11, s39, v3
    ds_read_b64_tr_b16 v[60:61], v11 offset:0
    ds_read_b64_tr_b16 v[62:63], v11 offset:2048
D_p7:
    s_waitcnt vmcnt(4) lgkmcnt(0)
    v_mfma_f32_16x16x32_bf16 v[16:19], v[48:51], v[192:195], v[16:19]
    ds_read_b64_tr_b16 v[64:65], v8 offset:4096
    ds_read_b64_tr_b16 v[66:67], v8 offset:6144
    v_mfma_f32_16x16x32_bf16 v[32:35], v[48:51], v[196:199], v[32:35]
    ds_read_b64_tr_b16 v[68:69], v9 offset:4096
    ds_read_b64_tr_b16 v[70:71], v9 offset:6144
    v_mfma_f32_16x16x32_bf16 v[20:23], v[52:55], v[192:195], v[20:23]
    ds_read_b64_tr_b16 v[72:73], v10 offset:4096
    ds_read_b64_tr_b16 v[74:75], v10 offset:6144
    v_mfma_f32_16x16x32_bf16 v[36:39], v[52:55], v[196:199], v[36:39]
    ds_read_b64_tr_b16 v[76:77], v11 offset:4096
    ds_read_b64_tr_b16 v[78:79], v11 offset:6144
    s_ff1_i32_b32 s64, s68
    s_bitset0_b32 s68, s64
    v_readlane_b32 s37, v7, s64
    s_add_u32 s69, s64, s74
    s_and_b32 s69, s69, 15
    s_lshl_b32 s69, s69, 11
    buffer_load_dwordx4 v[160:163], v4, s[16:19], s69 offen offset:0 sc1
    v_mfma_f32_16x16x32_bf16 v[24:27], v[56:59], v[192:195], v[24:27]
    v_mfma_f32_16x16x32_bf16 v[40:43], v[56:59], v[196:199], v[40:43]
    v_mfma_f32_16x16x32_bf16 v[28:31], v[60:63], v[192:195], v[28:31]
    buffer_load_dwordx4 v[164:167], v4, s[16:19], s69 offen offset:1024 sc1
    v_mfma_f32_16x16x32_bf16 v[44:47], v[60:63], v[196:199], v[44:47]
    s_waitcnt lgkmcnt(0)
    v_mfma_f32_16x16x32_bf16 v[16:19], v[64:67], v[200:203], v[16:19]
    v_add_u32 v8, s38, v5
    ds_read_b64_tr_b16 v[48:49], v8 offset:0
    v_mfma_f32_16x16x32_bf16 v[32:35], v[64:67], v[204:207], v[32:35]
    ds_read_b64_tr_b16 v[50:51], v8 offset:2048
    v_add_u32 v9, s38, v6
    v_mfma_f32_16x16x32_bf16 v[20:23], v[68:71], v[200:203], v[20:23]
    ds_read_b64_tr_b16 v[52:53], v9 offset:0
    ds_read_b64_tr_b16 v[54:55], v9 offset:2048
    v_mfma_f32_16x16x32_bf16 v[36:39], v[68:71], v[204:207], v[36:39]
    v_add_u32 v10, s38, v1
    ds_read_b64_tr_b16 v[56:57], v10 offset:0
    buffer_load_dwordx4 v[168:171], v4, s[16:19], s69 offen offset:2048 sc1
    v_mfma_f32_16x16x32_bf16 v[24:27], v[72:75], v[200:203], v[24:27]
    ds_read_b64_tr_b16 v[58:59], v10 offset:2048
    v_add_u32 v11, s38, v3
    v_mfma_f32_16x16x32_bf16 v[40:43], v[72:75], v[204:207], v[40:43]
    ds_read_b64_tr_b16 v[60:61], v11 offset:0
    ds_read_b64_tr_b16 v[62:63], v11 offset:2048
    v_mfma_f32_16x16x32_bf16 v[28:31], v[76:79], v[200:203], v[28:31]
    buffer_load_dwordx4 v[172:175], v4, s[16:19], s69 offen offset:3072 sc1
    v_mfma_f32_16x16x32_bf16 v[44:47], v[76:79], v[204:207], v[44:47]
D_p6:
    s_waitcnt vmcnt(4) lgkmcnt(0)
    v_mfma_f32_16x16x32_bf16 v[16:19], v[48:51], v[176:179], v[16:19]
    ds_read_b64_tr_b16 v[64:65], v8 offset:4096
    ds_read_b64_tr_b16 v[66:67], v8 offset:6144
    v_mfma_f32_16x16x32_bf16 v[32:35], v[48:51], v[180:183], v[32:35]
    ds_read_b64_tr_b16 v[68:69], v9 offset:4096
    ds_read_b64_tr_b16 v[70:71], v9 offset:6144
    v_mfma_f32_16x16x32_bf16 v[20:23], v[52:55], v[176:179], v[20:23]
    ds_read_b64_tr_b16 v[72:73], v10 offset:4096
    ds_read_b64_tr_b16 v[74:75], v10 offset:6144
    v_mfma_f32_16x16x32_bf16 v[36:39], v[52:55], v[180:183], v[36:39]
    ds_read_b64_tr_b16 v[76:77], v11 offset:4096
    ds_read_b64_tr_b16 v[78:79], v11 offset:6144
    s_ff1_i32_b32 s64, s68
    s_bitset0_b32 s68, s64
    v_readlane_b32 s36, v7, s64
    s_add_u32 s69, s64, s74
    s_and_b32 s69, s69, 15
    s_lshl_b32 s69, s69, 11
    buffer_load_dwordx4 v[144:147], v4, s[16:19], s69 offen offset:0 sc1
    v_mfma_f32_16x16x32_bf16 v[24:27], v[56:59], v[176:179], v[24:27]
    v_mfma_f32_16x16x32_bf16 v[40:43], v[56:59], v[180:183], v[40:43]
    v_mfma_f32_16x16x32_bf16 v[28:31], v[60:63], v[176:179], v[28:31]
    buffer_load_dwordx4 v[148:151], v4, s[16:19], s69 offen offset:1024 sc1
    v_mfma_f32_16x16x32_bf16 v[44:47], v[60:63], v[180:183], v[44:47]
    s_waitcnt lgkmcnt(0)
    v_mfma_f32_16x16x32_bf16 v[16:19], v[64:67], v[184:187], v[16:19]
    v_add_u32 v8, s37, v5
    ds_read_b64_tr_b16 v[48:49], v8 offset:0
    v_mfma_f32_16x16x32_bf16 v[32:35], v[64:67], v[188:191], v[32:35]
    ds_read_b64_tr_b16 v[50:51], v8 offset:2048
    v_add_u32 v9, s37, v6
    v_mfma_f32_16x16x32_bf16 v[20:23], v[68:71], v[184:187], v[20:23]
    ds_read_b64_tr_b16 v[52:53], v9 offset:0
    ds_read_b64_tr_b16 v[54:55], v9 offset:2048
    v_mfma_f32_16x16x32_bf16 v[36:39], v[68:71], v[188:191], v[36:39]
    v_add_u32 v10, s37, v1
    ds_read_b64_tr_b16 v[56:57], v10 offset:0
    buffer_load_dwordx4 v[152:155], v4, s[16:19], s69 offen offset:2048 sc1
    v_mfma_f32_16x16x32_bf16 v[24:27], v[72:75], v[184:187], v[24:27]
    ds_read_b64_tr_b16 v[58:59], v10 offset:2048
    v_add_u32 v11, s37, v3
    v_mfma_f32_16x16x32_bf16 v[40:43], v[72:75], v[188:191], v[40:43]
    ds_read_b64_tr_b16 v[60:61], v11 offset:0
    ds_read_b64_tr_b16 v[62:63], v11 offset:2048
    v_mfma_f32_16x16x32_bf16 v[28:31], v[76:79], v[184:187], v[28:31]
    buffer_load_dwordx4 v[156:159], v4, s[16:19], s69 offen offset:3072 sc1
    v_mfma_f32_16x16x32_bf16 v[44:47], v[76:79], v[188:191], v[44:47]
D_p5:
    s_waitcnt vmcnt(4) lgkmcnt(0)
    v_mfma_f32_16x16x32_bf16 v[16:19], v[48:51], v[160:163], v[16:19]
    ds_read_b64_tr_b16 v[64:65], v8 offset:4096
    ds_read_b64_tr_b16 v[66:67], v8 offset:6144
    v_mfma_f32_16x16x32_bf16 v[32:35], v[48:51], v[164:167], v[32:35]
    ds_read_b64_tr_b16 v[68:69], v9 offset:4096
    ds_read_b64_tr_b16 v[70:71], v9 offset:6144
    v_mfma_f32_16x16x32_bf16 v[20:23], v[52:55], v[160:163], v[20:23]
    ds_read_b64_tr_b16 v[72:73], v10 offset:4096
    ds_read_b64_tr_b16 v[74:75], v10 offset:6144
    v_mfma_f32_16x16x32_bf16 v[36:39], v[52:55], v[164:167], v[36:39]
    ds_read_b64_tr_b16 v[76:77], v11 offset:4096
    ds_read_b64_tr_b16 v[78:79], v11 offset:6144
    s_ff1_i32_b32 s64, s68
    s_bitset0_b32 s68, s64
    v_readlane_b32 s35, v7, s64
    s_add_u32 s69, s64, s74
    s_and_b32 s69, s69, 15
    s_lshl_b32 s69, s69, 11
    buffer_load_dwordx4 v[128:131], v4, s[16:19], s69 offen offset:0 sc1
    v_mfma_f32_16x16x32_bf16 v[24:27], v[56:59], v[160:163], v[24:27]
    v_mfma_f32_16x16x32_bf16 v[40:43], v[56:59], v[164:167], v[40:43]
    v_mfma_f32_16x16x32_bf16 v[28:31], v[60:63], v[160:163], v[28:31]
    buffer_load_dwordx4 v[132:135], v4, s[16:19], s69 offen offset:1024 sc1
    v_mfma_f32_16x16x32_bf16 v[44:47], v[60:63], v[164:167], v[44:47]
    s_waitcnt lgkmcnt(0)
    v_mfma_f32_16x16x32_bf16 v[16:19], v[64:67], v[168:171], v[16:19]
    v_add_u32 v8, s36, v5
    ds_read_b64_tr_b16 v[48:49], v8 offset:0
    v_mfma_f32_16x16x32_bf16 v[32:35], v[64:67], v[172:175], v[32:35]
    ds_read_b64_tr_b16 v[50:51], v8 offset:2048
    v_add_u32 v9, s36, v6
    v_mfma_f32_16x16x32_bf16 v[20:23], v[68:71], v[168:171], v[20:23]
    ds_read_b64_tr_b16 v[52:53], v9 offset:0
    ds_read_b64_tr_b16 v[54:55], v9 offset:2048
    v_mfma_f32_16x16x32_bf16 v[36:39], v[68:71], v[172:175], v[36:39]
    v_add_u32 v10, s36, v1
    ds_read_b64_tr_b16 v[56:57], v10 offset:0
    buffer_load_dwordx4 v[136:139], v4, s[16:19], s69 offen offset:2048 sc1
    v_mfma_f32_16x16x32_bf16 v[24:27], v[72:75], v[168:171], v[24:27]
    ds_read_b64_tr_b16 v[58:59], v10 offset:2048
    v_add_u32 v11, s36, v3
    v_mfma_f32_16x16x32_bf16 v[40:43], v[72:75], v[172:175], v[40:43]
    ds_read_b64_tr_b16 v[60:61], v11 offset:0
    ds_read_b64_tr_b16 v[62:63], v11 offset:2048
    v_mfma_f32_16x16x32_bf16 v[28:31], v[76:79], v[168:171], v[28:31]
    buffer_load_dwordx4 v[140:143], v4, s[16:19], s69 offen offset:3072 sc1
    v_mfma_f32_16x16x32_bf16 v[44:47], v[76:79], v[172:175], v[44:47]
D_p4:
    s_waitcnt vmcnt(4) lgkmcnt(0)
    v_mfma_f32_16x16x32_bf16 v[16:19], v[48:51], v[144:147], v[16:19]
    ds_read_b64_tr_b16 v[64:65], v8 offset:4096
    ds_read_b64_tr_b16 v[66:67], v8 offset:6144
    v_mfma_f32_16x16x32_bf16 v[32:35], v[48:51], v[148:151], v[32:35]
    ds_read_b64_tr_b16 v[68:69], v9 offset:4096
    ds_read_b64_tr_b16 v[70:71], v9 offset:6144
    v_mfma_f32_16x16x32_bf16 v[20:23], v[52:55], v[144:147], v[20:23]
    ds_read_b64_tr_b16 v[72:73], v10 offset:4096
    ds_read_b64_tr_b16 v[74:75], v10 offset:6144
    v_mfma_f32_16x16x32_bf16 v[36:39], v[52:55], v[148:151], v[36:39]
    ds_read_b64_tr_b16 v[76:77], v11 offset:4096
    ds_read_b64_tr_b16 v[78:79], v11 offset:6144
    s_ff1_i32_b32 s64, s68
    s_bitset0_b32 s68, s64
    v_readlane_b32 s34, v7, s64
    s_add_u32 s69, s64, s74
    s_and_b32 s69, s69, 15
    s_lshl_b32 s69, s69, 11
    buffer_load_dwordx4 v[112:115], v4, s[16:19], s69 offen offset:0 sc1
    v_mfma_f32_16x16x32_bf16 v[24:27], v[56:59], v[144:147], v[24:27]
    v_mfma_f32_16x16x32_bf16 v[40:43], v[56:59], v[148:151], v[40:43]
    v_mfma_f32_16x16x32_bf16 v[28:31], v[60:63], v[144:147], v[28:31]
    buffer_load_dwordx4 v[116:119], v4, s[16:19], s69 offen offset:1024 sc1
    v_mfma_f32_16x16x32_bf16 v[44:47], v[60:63], v[148:151], v[44:47]
    s_waitcnt lgkmcnt(0)
    v_mfma_f32_16x16x32_bf16 v[16:19], v[64:67], v[152:155], v[16:19]
    v_add_u32 v8, s35, v5
    ds_read_b64_tr_b16 v[48:49], v8 offset:0
    v_mfma_f32_16x16x32_bf16 v[32:35], v[64:67], v[156:159], v[32:35]
    ds_read_b64_tr_b16 v[50:51], v8 offset:2048
    v_add_u32 v9, s35, v6
    v_mfma_f32_16x16x32_bf16 v[20:23], v[68:71], v[152:155], v[20:23]
    ds_read_b64_tr_b16 v[52:53], v9 offset:0
    ds_read_b64_tr_b16 v[54:55], v9 offset:2048
    v_mfma_f32_16x16x32_bf16 v[36:39], v[68:71], v[156:159], v[36:39]
    v_add_u32 v10, s35, v1
    ds_read_b64_tr_b16 v[56:57], v10 offset:0
    buffer_load_dwordx4 v[120:123], v4, s[16:19], s69 offen offset:2048 sc1
    v_mfma_f32_16x16x32_bf16 v[24:27], v[72:75], v[152:155], v[24:27]
    ds_read_b64_tr_b16 v[58:59], v10 offset:2048
    v_add_u32 v11, s35, v3
    v_mfma_f32_16x16x32_bf16 v[40:43], v[72:75], v[156:159], v[40:43]
    ds_read_b64_tr_b16 v[60:61], v11 offset:0
    ds_read_b64_tr_b16 v[62:63], v11 offset:2048
    v_mfma_f32_16x16x32_bf16 v[28:31], v[76:79], v[152:155], v[28:31]
    buffer_load_dwordx4 v[124:127], v4, s[16:19], s69 offen offset:3072 sc1
    v_mfma_f32_16x16x32_bf16 v[44:47], v[76:79], v[156:159], v[44:47]
D_p3:
    s_waitcnt vmcnt(4) lgkmcnt(0)
    v_mfma_f32_16x16x32_bf16 v[16:19], v[48:51], v[128:131], v[16:19]
    ds_read_b64_tr_b16 v[64:65], v8 offset:4096
    ds_read_b64_tr_b16 v[66:67], v8 offset:6144
    v_mfma_f32_16x16x32_bf16 v[32:35], v[48:51], v[132:135], v[32:35]
    ds_read_b64_tr_b16 v[68:69], v9 offset:4096
    ds_read_b64_tr_b16 v[70:71], v9 offset:6144
    v_mfma_f32_16x16x32_bf16 v[20:23], v[52:55], v[128:131], v[20:23]
    ds_read_b64_tr_b16 v[72:73], v10 offset:4096
    ds_read_b64_tr_b16 v[74:75], v10 offset:6144
    v_mfma_f32_16x16x32_bf16 v[36:39], v[52:55], v[132:135], v[36:39]
    ds_read_b64_tr_b16 v[76:77], v11 offset:4096
    ds_read_b64_tr_b16 v[78:79], v11 offset:6144
    s_ff1_i32_b32 s64, s68
    s_bitset0_b32 s68, s64
    v_readlane_b32 s33, v7, s64
    s_add_u32 s69, s64, s74
    s_and_b32 s69, s69, 15
    s_lshl_b32 s69, s69, 11
    buffer_load_dwordx4 v[96:99], v4, s[16:19], s69 offen offset:0 sc1
    v_mfma_f32_16x16x32_bf16 v[24:27], v[56:59], v[128:131], v[24:27]
    v_mfma_f32_16x16x32_bf16 v[40:43], v[56:59], v[132:135], v[40:43]
    v_mfma_f32_16x16x32_bf16 v[28:31], v[60:63], v[128:131], v[28:31]
    buffer_load_dwordx4 v[100:103], v4, s[16:19], s69 offen offset:1024 sc1
    v_mfma_f32_16x16x32_bf16 v[44:47], v[60:63], v[132:135], v[44:47]
    s_waitcnt lgkmcnt(0)
    v_mfma_f32_16x16x32_bf16 v[16:19], v[64:67], v[136:139], v[16:19]
    v_add_u32 v8, s34, v5
    ds_read_b64_tr_b16 v[48:49], v8 offset:0
    v_mfma_f32_16x16x32_bf16 v[32:35], v[64:67], v[140:143], v[32:35]
    ds_read_b64_tr_b16 v[50:51], v8 offset:2048
    v_add_u32 v9, s34, v6
    v_mfma_f32_16x16x32_bf16 v[20:23], v[68:71], v[136:139], v[20:23]
    ds_read_b64_tr_b16 v[52:53], v9 offset:0
    ds_read_b64_tr_b16 v[54:55], v9 offset:2048
    v_mfma_f32_16x16x32_bf16 v[36:39], v[68:71], v[140:143], v[36:39]
    v_add_u32 v10, s34, v1
    ds_read_b64_tr_b16 v[56:57], v10 offset:0
    buffer_load_dwordx4 v[104:107], v4, s[16:19], s69 offen offset:2048 sc1
    v_mfma_f32_16x16x32_bf16 v[24:27], v[72:75], v[136:139], v[24:27]
    ds_read_b64_tr_b16 v[58:59], v10 offset:2048
    v_add_u32 v11, s34, v3
    v_mfma_f32_16x16x32_bf16 v[40:43], v[72:75], v[140:143], v[40:43]
    ds_read_b64_tr_b16 v[60:61], v11 offset:0
    ds_read_b64_tr_b16 v[62:63], v11 offset:2048
    v_mfma_f32_16x16x32_bf16 v[28:31], v[76:79], v[136:139], v[28:31]
    buffer_load_dwordx4 v[108:111], v4, s[16:19], s69 offen offset:3072 sc1
    v_mfma_f32_16x16x32_bf16 v[44:47], v[76:79], v[140:143], v[44:47]
D_p2:
    s_waitcnt vmcnt(4) lgkmcnt(0)
    v_mfma_f32_16x16x32_bf16 v[16:19], v[48:51], v[112:115], v[16:19]
    ds_read_b64_tr_b16 v[64:65], v8 offset:4096
    ds_read_b64_tr_b16 v[66:67], v8 offset:6144
    v_mfma_f32_16x16x32_bf16 v[32:35], v[48:51], v[116:119], v[32:35]
    ds_read_b64_tr_b16 v[68:69], v9 offset:4096
    ds_read_b64_tr_b16 v[70:71], v9 offset:6144
    v_mfma_f32_16x16x32_bf16 v[20:23], v[52:55], v[112:115], v[20:23]
    ds_read_b64_tr_b16 v[72:73], v10 offset:4096
    ds_read_b64_tr_b16 v[74:75], v10 offset:6144
    v_mfma_f32_16x16x32_bf16 v[36:39], v[52:55], v[116:119], v[36:39]
    ds_read_b64_tr_b16 v[76:77], v11 offset:4096
    ds_read_b64_tr_b16 v[78:79], v11 offset:6144
    s_ff1_i32_b32 s64, s68
    s_bitset0_b32 s68, s64
    v_readlane_b32 s32, v7, s64
    s_add_u32 s69, s64, s74
    s_and_b32 s69, s69, 15
    s_lshl_b32 s69, s69, 11
    buffer_load_dwordx4 v[80:83], v4, s[16:19], s69 offen offset:0 sc1
    v_mfma_f32_16x16x32_bf16 v[24:27], v[56:59], v[112:115], v[24:27]
    v_mfma_f32_16x16x32_bf16 v[40:43], v[56:59], v[116:119], v[40:43]
    v_mfma_f32_16x16x32_bf16 v[28:31], v[60:63], v[112:115], v[28:31]
    buffer_load_dwordx4 v[84:87], v4, s[16:19], s69 offen offset:1024 sc1
    v_mfma_f32_16x16x32_bf16 v[44:47], v[60:63], v[116:119], v[44:47]
    s_waitcnt lgkmcnt(0)
    v_mfma_f32_16x16x32_bf16 v[16:19], v[64:67], v[120:123], v[16:19]
    v_add_u32 v8, s33, v5
    ds_read_b64_tr_b16 v[48:49], v8 offset:0
    v_mfma_f32_16x16x32_bf16 v[32:35], v[64:67], v[124:127], v[32:35]
    ds_read_b64_tr_b16 v[50:51], v8 offset:2048
    v_add_u32 v9, s33, v6
    v_mfma_f32_16x16x32_bf16 v[20:23], v[68:71], v[120:123], v[20:23]
    ds_read_b64_tr_b16 v[52:53], v9 offset:0
    ds_read_b64_tr_b16 v[54:55], v9 offset:2048
    v_mfma_f32_16x16x32_bf16 v[36:39], v[68:71], v[124:127], v[36:39]
    v_add_u32 v10, s33, v1
    ds_read_b64_tr_b16 v[56:57], v10 offset:0
    buffer_load_dwordx4 v[88:91], v4, s[16:19], s69 offen offset:2048 sc1
    v_mfma_f32_16x16x32_bf16 v[24:27], v[72:75], v[120:123], v[24:27]
    ds_read_b64_tr_b16 v[58:59], v10 offset:2048
    v_add_u32 v11, s33, v3
    v_mfma_f32_16x16x32_bf16 v[40:43], v[72:75], v[124:127], v[40:43]
    ds_read_b64_tr_b16 v[60:61], v11 offset:0
    ds_read_b64_tr_b16 v[62:63], v11 offset:2048
    v_mfma_f32_16x16x32_bf16 v[28:31], v[76:79], v[120:123], v[28:31]
    buffer_load_dwordx4 v[92:95], v4, s[16:19], s69 offen offset:3072 sc1
    s_mov_b64 exec, 1
    v_mov_b32 v15, 0
    buffer_atomic_or v15, v14, s[16:19], 0 offen sc0
    s_mov_b64 exec, -1
    v_mfma_f32_16x16x32_bf16 v[44:47], v[76:79], v[124:127], v[44:47]
D_p1:
    s_waitcnt vmcnt(5) lgkmcnt(0)
    v_mfma_f32_16x16x32_bf16 v[16:19], v[48:51], v[96:99], v[16:19]
    ds_read_b64_tr_b16 v[64:65], v8 offset:4096
    ds_read_b64_tr_b16 v[66:67], v8 offset:6144
    v_mfma_f32_16x16x32_bf16 v[32:35], v[48:51], v[100:103], v[32:35]
    ds_read_b64_tr_b16 v[68:69], v9 offset:4096
    ds_read_b64_tr_b16 v[70:71], v9 offset:6144
    v_mfma_f32_16x16x32_bf16 v[20:23], v[52:55], v[96:99], v[20:23]
    ds_read_b64_tr_b16 v[72:73], v10 offset:4096
    ds_read_b64_tr_b16 v[74:75], v10 offset:6144
    v_mfma_f32_16x16x32_bf16 v[36:39], v[52:55], v[100:103], v[36:39]
    ds_read_b64_tr_b16 v[76:77], v11 offset:4096
    ds_read_b64_tr_b16 v[78:79], v11 offset:6144
    v_mfma_f32_16x16x32_bf16 v[24:27], v[56:59], v[96:99], v[24:27]
    v_mfma_f32_16x16x32_bf16 v[40:43], v[56:59], v[100:103], v[40:43]
    v_mfma_f32_16x16x32_bf16 v[28:31], v[60:63], v[96:99], v[28:31]
    v_mfma_f32_16x16x32_bf16 v[44:47], v[60:63], v[100:103], v[44:47]
    s_waitcnt lgkmcnt(0)
    v_mfma_f32_16x16x32_bf16 v[16:19], v[64:67], v[104:107], v[16:19]
    v_add_u32 v8, s32, v5
    ds_read_b64_tr_b16 v[48:49], v8 offset:0
    v_mfma_f32_16x16x32_bf16 v[32:35], v[64:67], v[108:111], v[32:35]
    ds_read_b64_tr_b16 v[50:51], v8 offset:2048
    v_add_u32 v9, s32, v6
    v_mfma_f32_16x16x32_bf16 v[20:23], v[68:71], v[104:107], v[20:23]
    ds_read_b64_tr_b16 v[52:53], v9 offset:0
    ds_read_b64_tr_b16 v[54:55], v9 offset:2048
    v_mfma_f32_16x16x32_bf16 v[36:39], v[68:71], v[108:111], v[36:39]
    v_add_u32 v10, s32, v1
    ds_read_b64_tr_b16 v[56:57], v10 offset:0
    v_mfma_f32_16x16x32_bf16 v[24:27], v[72:75], v[104:107], v[24:27]
    ds_read_b64_tr_b16 v[58:59], v10 offset:2048
    v_add_u32 v11, s32, v3
    v_mfma_f32_16x16x32_bf16 v[40:43], v[72:75], v[108:111], v[40:43]
    ds_read_b64_tr_b16 v[60:61], v11 offset:0
    ds_read_b64_tr_b16 v[62:63], v11 offset:2048
    v_mfma_f32_16x16x32_bf16 v[28:31], v[76:79], v[104:107], v[28:31]
    v_mfma_f32_16x16x32_bf16 v[44:47], v[76:79], v[108:111], v[44:47]
D_p0:
    s_waitcnt vmcnt(1) lgkmcnt(0)
    v_mfma_f32_16x16x32_bf16 v[16:19], v[48:51], v[80:83], v[16:19]
    ds_read_b64_tr_b16 v[64:65], v8 offset:4096
    ds_read_b64_tr_b16 v[66:67], v8 offset:6144
    v_mfma_f32_16x16x32_bf16 v[32:35], v[48:51], v[84:87], v[32:35]
    ds_read_b64_tr_b16 v[68:69], v9 offset:4096
    ds_read_b64_tr_b16 v[70:71], v9 offset:6144
    v_mfma_f32_16x16x32_bf16 v[20:23], v[52:55], v[80:83], v[20:23]
    ds_read_b64_tr_b16 v[72:73], v10 offset:4096
    ds_read_b64_tr_b16 v[74:75], v10 offset:6144
    v_mfma_f32_16x16x32_bf16 v[36:39], v[52:55], v[84:87], v[36:39]
    ds_read_b64_tr_b16 v[76:77], v11 offset:4096
    ds_read_b64_tr_b16 v[78:79], v11 offset:6144
    v_mfma_f32_16x16x32_bf16 v[24:27], v[56:59], v[80:83], v[24:27]
    v_mfma_f32_16x16x32_bf16 v[40:43], v[56:59], v[84:87], v[40:43]
    v_mfma_f32_16x16x32_bf16 v[28:31], v[60:63], v[80:83], v[28:31]
    v_mfma_f32_16x16x32_bf16 v[44:47], v[60:63], v[84:87], v[44:47]
    s_waitcnt lgkmcnt(0)
    v_mfma_f32_16x16x32_bf16 v[16:19], v[64:67], v[88:91], v[16:19]
    v_mfma_f32_16x16x32_bf16 v[32:35], v[64:67], v[92:95], v[32:35]
    v_mfma_f32_16x16x32_bf16 v[20:23], v[68:71], v[88:91], v[20:23]
    v_mfma_f32_16x16x32_bf16 v[36:39], v[68:71], v[92:95], v[36:39]
    v_mfma_f32_16x16x32_bf16 v[24:27], v[72:75], v[88:91], v[24:27]
    v_mfma_f32_16x16x32_bf16 v[40:43], v[72:75], v[92:95], v[40:43]
    v_mfma_f32_16x16x32_bf16 v[28:31], v[76:79], v[88:91], v[28:31]
    v_mfma_f32_16x16x32_bf16 v[44:47], v[76:79], v[92:95], v[44:47]
    s_cmp_lg_u32 s66, 0
    s_cbranch_scc1 D_wait
D_end:
    v_and_b32 v8, 15, v2
    s_lshl_b32 s64, s6, 5
    v_add_u32 v8, s64, v8
    v_mul_u32_u24 v8, 272, v8
    v_lshrrev_b32 v9, 4, v2
    v_lshl_add_u32 v8, v9, 4, v8
    s_mul_i32 s64, s7, 34816
    s_add_u32 s64, s64, 8192
    v_add_u32 v8, s64, v8
    v_lshrrev_b32 v6, 3, v0
    v_mul_u32_u24 v5, 272, v6
    v_and_b32 v6, 7, v0
    v_lshl_add_u32 v5, v6, 5, v5
    v_add_u32 v5, 8192, v5
    v_lshlrev_b32 v9, 5, v6
    s_barrier
    ds_write_b128 v8, v[16:19] offset:0
    ds_write_b128 v8, v[20:23] offset:64
    ds_write_b128 v8, v[24:27] offset:128
    ds_write_b128 v8, v[28:31] offset:192
    ds_write_b128 v8, v[32:35] offset:4352
    ds_write_b128 v8, v[36:39] offset:4416
    ds_write_b128 v8, v[40:43] offset:4480
    ds_write_b128 v8, v[44:47] offset:4544
    s_lshr_b32 s64, s67, 7
    s_cmp_lg_u32 s64, s4
    s_cbranch_scc0 P2_y
P2_ny:
    s_waitcnt lgkmcnt(0)
    s_barrier
    ds_read_b128 v[64:67], v5 offset:0
    ds_read_b128 v[68:71], v5 offset:16
    ds_read_b128 v[72:75], v5 offset:34816
    ds_read_b128 v[76:79], v5 offset:34832
    ds_read_b128 v[80:83], v5 offset:17408
    ds_read_b128 v[84:87], v5 offset:17424
    ds_read_b128 v[88:91], v5 offset:52224
    ds_read_b128 v[92:95], v5 offset:52240
    v_add_u32 v9, 5632, v9
    s_mov_b32 s68, 131072
    v_add_u32 v6, 0, v230
    v_cmp_eq_u32 vcc, s67, v6
    s_cbranch_vccnz P2_nr_19_fix
P2_nr_19:
    s_waitcnt lgkmcnt(4)
    v_add_f32 v64, v64, v72
    v_add_f32 v65, v65, v73
    v_cvt_pk_bf16_f32 v116, v64, v65
    v_lshlrev_b32 v64, 16, v116
    v_and_b32 v65, 0xffff0000, v116
    v_mul_f32 v64, v64, v228
    v_mul_f32 v65, v65, v228
    v_cvt_pk_bf16_f32 v116, v64, v65
    v_lshlrev_b32 v64, 16, v116
    v_and_b32 v65, 0xffff0000, v116
    v_add_f32 v64, v64, v232
    v_add_f32 v65, v65, v233
    v_cvt_pk_bf16_f32 v120, v64, v65
    v_add_f32 v66, v66, v74
    v_add_f32 v67, v67, v75
    v_cvt_pk_bf16_f32 v116, v66, v67
    v_lshlrev_b32 v66, 16, v116
    v_and_b32 v67, 0xffff0000, v116
    v_mul_f32 v66, v66, v228
    v_mul_f32 v67, v67, v228
    v_cvt_pk_bf16_f32 v116, v66, v67
    v_lshlrev_b32 v66, 16, v116
    v_and_b32 v67, 0xffff0000, v116
    v_add_f32 v66, v66, v234
    v_add_f32 v67, v67, v235
    v_cvt_pk_bf16_f32 v121, v66, v67
    v_add_f32 v68, v68, v76
    v_add_f32 v69, v69, v77
    v_cvt_pk_bf16_f32 v116, v68, v69
    v_lshlrev_b32 v68, 16, v116
    v_and_b32 v69, 0xffff0000, v116
    v_mul_f32 v68, v68, v228
    v_mul_f32 v69, v69, v228
    v_cvt_pk_bf16_f32 v116, v68, v69
    v_lshlrev_b32 v68, 16, v116
    v_and_b32 v69, 0xffff0000, v116
    v_add_f32 v68, v68, v236
    v_add_f32 v69, v69, v237
    v_cvt_pk_bf16_f32 v122, v68, v69
    v_add_f32 v70, v70, v78
    v_add_f32 v71, v71, v79
    v_cvt_pk_bf16_f32 v116, v70, v71
    v_lshlrev_b32 v70, 16, v116
    v_and_b32 v71, 0xffff0000, v116
    v_mul_f32 v70, v70, v228
    v_mul_f32 v71, v71, v228
    v_cvt_pk_bf16_f32 v116, v70, v71
    v_lshlrev_b32 v70, 16, v116
    v_and_b32 v71, 0xffff0000, v116
    v_add_f32 v70, v70, v238
    v_add_f32 v71, v71, v239
    v_cvt_pk_bf16_f32 v123, v70, v71
    buffer_store_dwordx4 v[120:123], v231, s[20:23], 0 offen nt
    v_add_u32 v6, 64, v230
    v_cmp_eq_u32 vcc, s67, v6
    s_cbranch_vccnz P2_nr_20_fix
P2_nr_20:
    s_waitcnt lgkmcnt(0)
    v_add_f32 v80, v80, v88
    v_add_f32 v81, v81, v89
    v_cvt_pk_bf16_f32 v116, v80, v81
    v_lshlrev_b32 v80, 16, v116
    v_and_b32 v81, 0xffff0000, v116
    v_mul_f32 v80, v80, v229
    v_mul_f32 v81, v81, v229
    v_cvt_pk_bf16_f32 v116, v80, v81
    v_lshlrev_b32 v80, 16, v116
    v_and_b32 v81, 0xffff0000, v116
    v_add_f32 v80, v80, v240
    v_add_f32 v81, v81, v241
    v_cvt_pk_bf16_f32 v124, v80, v81
    v_add_f32 v82, v82, v90
    v_add_f32 v83, v83, v91
    v_cvt_pk_bf16_f32 v116, v82, v83
    v_lshlrev_b32 v82, 16, v116
    v_and_b32 v83, 0xffff0000, v116
    v_mul_f32 v82, v82, v229
    v_mul_f32 v83, v83, v229
    v_cvt_pk_bf16_f32 v116, v82, v83
    v_lshlrev_b32 v82, 16, v116
    v_and_b32 v83, 0xffff0000, v116
    v_add_f32 v82, v82, v242
    v_add_f32 v83, v83, v243
    v_cvt_pk_bf16_f32 v125, v82, v83
    v_add_f32 v84, v84, v92
    v_add_f32 v85, v85, v93
    v_cvt_pk_bf16_f32 v116, v84, v85
    v_lshlrev_b32 v84, 16, v116
    v_and_b32 v85, 0xffff0000, v116
    v_mul_f32 v84, v84, v229
    v_mul_f32 v85, v85, v229
    v_cvt_pk_bf16_f32 v116, v84, v85
    v_lshlrev_b32 v84, 16, v116
    v_and_b32 v85, 0xffff0000, v116
    v_add_f32 v84, v84, v244
    v_add_f32 v85, v85, v245
    v_cvt_pk_bf16_f32 v126, v84, v85
    v_add_f32 v86, v86, v94
    v_add_f32 v87, v87, v95
    v_cvt_pk_bf16_f32 v116, v86, v87
    v_lshlrev_b32 v86, 16, v116
    v_and_b32 v87, 0xffff0000, v116
    v_mul_f32 v86, v86, v229
    v_mul_f32 v87, v87, v229
    v_cvt_pk_bf16_f32 v116, v86, v87
    v_lshlrev_b32 v86, 16, v116
    v_and_b32 v87, 0xffff0000, v116
    v_add_f32 v86, v86, v246
    v_add_f32 v87, v87, v247
    v_cvt_pk_bf16_f32 v127, v86, v87
    buffer_store_dwordx4 v[124:127], v231, s[20:23], s68 offen nt
K_end:
    s_endpgm
H_nre:
    s_add_u32 s65, s65, 1
    s_cmp_ge_u32 s65, 200000
    s_cbranch_scc1 H_nok
    s_sleep 4
    buffer_load_dword v78, v79, s[20:23], 0 offen sc1
    s_waitcnt vmcnt(0)
    s_branch H_nspin
H_retry:
    s_add_u32 s65, s65, 1
    s_cmp_ge_u32 s65, 200000
    s_cbranch_scc1 H_nq
    s_sleep 8
    s_mov_b32 s64, 6717440
    buffer_load_dwordx4 v[24:27], v6, s[16:19], s64 offen offset:0 sc1
    buffer_load_dwordx4 v[28:31], v6, s[16:19], s64 offen offset:1024 sc1
    s_waitcnt vmcnt(0)
    s_branch H_spin
G_f15:
    s_bitset1_b32 s66, s55
    s_branch G_q15
G_f14:
    s_bitset1_b32 s66, s54
    s_branch G_q14
G_f13:
    s_bitset1_b32 s66, s53
    s_branch G_q13
G_f12:
    s_bitset1_b32 s66, s52
    s_branch G_q12
G_f11:
    s_bitset1_b32 s66, s51
    s_branch G_q11
G_f10:
    s_bitset1_b32 s66, s50
    s_branch G_q10
G_f9:
    s_bitset1_b32 s66, s49
    s_branch G_q9
G_f8:
    s_bitset1_b32 s66, s48
    s_branch G_q8
G_f7:
    s_bitset1_b32 s66, s47
    s_branch G_q7
G_f6:
    s_bitset1_b32 s66, s46
    s_branch G_q6
G_f5:
    s_bitset1_b32 s66, s45
    s_branch G_q5
G_f4:
    s_bitset1_b32 s66, s44
    s_branch G_q4
G_f3:
    s_bitset1_b32 s66, s43
    s_branch G_q3
G_f2:
    s_bitset1_b32 s66, s42
    s_branch G_q2
G_f1:
    s_bitset1_b32 s66, s41
    s_branch G_q1
G_f0:
    s_bitset1_b32 s66, s40
    s_branch G_q0
phi_15_fix:
    v_lshlrev_b32 v48, 16, v16
    v_and_b32 v49, 0xffff0000, v16
    v_add_f32 v48, s73, v48
    v_add_f32 v49, s73, v49
    v_cvt_pk_bf16_f32 v16, v48, v49
    v_lshlrev_b32 v48, 16, v17
    v_and_b32 v49, 0xffff0000, v17
    v_add_f32 v48, s73, v48
    v_add_f32 v49, s73, v49
    v_cvt_pk_bf16_f32 v17, v48, v49
    v_lshlrev_b32 v48, 16, v18
    v_and_b32 v49, 0xffff0000, v18
    v_add_f32 v48, s73, v48
    v_add_f32 v49, s73, v49
    v_cvt_pk_bf16_f32 v18, v48, v49
    v_lshlrev_b32 v48, 16, v19
    v_and_b32 v49, 0xffff0000, v19
    v_add_f32 v48, s73, v48
    v_add_f32 v49, s73, v49
    v_cvt_pk_bf16_f32 v19, v48, v49
    v_lshlrev_b32 v48, 16, v20
    v_and_b32 v49, 0xffff0000, v20
    v_add_f32 v48, s73, v48
    v_add_f32 v49, s73, v49
    v_cvt_pk_bf16_f32 v20, v48, v49
    v_lshlrev_b32 v48, 16, v21
    v_and_b32 v49, 0xffff0000, v21
    v_add_f32 v48, s73, v48
    v_add_f32 v49, s73, v49
    v_cvt_pk_bf16_f32 v21, v48, v49
    v_lshlrev_b32 v48, 16, v22
    v_and_b32 v49, 0xffff0000, v22
    v_add_f32 v48, s73, v48
    v_add_f32 v49, s73, v49
    v_cvt_pk_bf16_f32 v22, v48, v49
    v_lshlrev_b32 v48, 16, v23
    v_and_b32 v49, 0xffff0000, v23
    v_add_f32 v48, s73, v48
    v_add_f32 v49, s73, v49
    v_cvt_pk_bf16_f32 v23, v48, v49
    s_branch phi_15_done
phi_16_fix:
    v_lshlrev_b32 v48, 16, v24
    v_and_b32 v49, 0xffff0000, v24
    v_add_f32 v48, s73, v48
    v_add_f32 v49, s73, v49
    v_cvt_pk_bf16_f32 v24, v48, v49
    v_lshlrev_b32 v48, 16, v25
    v_and_b32 v49, 0xffff0000, v25
    v_add_f32 v48, s73, v48
    v_add_f32 v49, s73, v49
    v_cvt_pk_bf16_f32 v25, v48, v49
    v_lshlrev_b32 v48, 16, v26
    v_and_b32 v49, 0xffff0000, v26
    v_add_f32 v48, s73, v48
    v_add_f32 v49, s73, v49
    v_cvt_pk_bf16_f32 v26, v48, v49
    v_lshlrev_b32 v48, 16, v27
    v_and_b32 v49, 0xffff0000, v27
    v_add_f32 v48, s73, v48
    v_add_f32 v49, s73, v49
    v_cvt_pk_bf16_f32 v27, v48, v49
    v_lshlrev_b32 v48, 16, v28
    v_and_b32 v49, 0xffff0000, v28
    v_add_f32 v48, s73, v48
    v_add_f32 v49, s73, v49
    v_cvt_pk_bf16_f32 v28, v48, v49
    v_lshlrev_b32 v48, 16, v29
    v_and_b32 v49, 0xffff0000, v29
    v_add_f32 v48, s73, v48
    v_add_f32 v49, s73, v49
    v_cvt_pk_bf16_f32 v29, v48, v49
    v_lshlrev_b32 v48, 16, v30
    v_and_b32 v49, 0xffff0000, v30
    v_add_f32 v48, s73, v48
    v_add_f32 v49, s73, v49
    v_cvt_pk_bf16_f32 v30, v48, v49
    v_lshlrev_b32 v48, 16, v31
    v_and_b32 v49, 0xffff0000, v31
    v_add_f32 v48, s73, v48
    v_add_f32 v49, s73, v49
    v_cvt_pk_bf16_f32 v31, v48, v49
    s_branch phi_16_done
C_ex1:
    ds_write_b32 v227, v52 offset:4608
    ds_write_b128 v224, v[240:243] offset:32768
    ds_write_b128 v224, v[244:247] offset:33792
    s_nop 4
    v_mov_b32 v52, v60
    v_mov_b32 v240, v248
    v_mov_b32 v241, v249
    v_mov_b32 v242, v250
    v_mov_b32 v243, v251
    v_mov_b32 v244, v252
    v_mov_b32 v245, v253
    v_mov_b32 v246, v254
    v_mov_b32 v247, v255
    s_branch C_ex2
phi_17_fix:
    v_lshlrev_b32 v48, 16, v32
    v_and_b32 v49, 0xffff0000, v32
    v_add_f32 v48, s73, v48
    v_add_f32 v49, s73, v49
    v_cvt_pk_bf16_f32 v32, v48, v49
    v_lshlrev_b32 v48, 16, v33
    v_and_b32 v49, 0xffff0000, v33
    v_add_f32 v48, s73, v48
    v_add_f32 v49, s73, v49
    v_cvt_pk_bf16_f32 v33, v48, v49
    v_lshlrev_b32 v48, 16, v34
    v_and_b32 v49, 0xffff0000, v34
    v_add_f32 v48, s73, v48
    v_add_f32 v49, s73, v49
    v_cvt_pk_bf16_f32 v34, v48, v49
    v_lshlrev_b32 v48, 16, v35
    v_and_b32 v49, 0xffff0000, v35
    v_add_f32 v48, s73, v48
    v_add_f32 v49, s73, v49
    v_cvt_pk_bf16_f32 v35, v48, v49
    v_lshlrev_b32 v48, 16, v36
    v_and_b32 v49, 0xffff0000, v36
    v_add_f32 v48, s73, v48
    v_add_f32 v49, s73, v49
    v_cvt_pk_bf16_f32 v36, v48, v49
    v_lshlrev_b32 v48, 16, v37
    v_and_b32 v49, 0xffff0000, v37
    v_add_f32 v48, s73, v48
    v_add_f32 v49, s73, v49
    v_cvt_pk_bf16_f32 v37, v48, v49
    v_lshlrev_b32 v48, 16, v38
    v_and_b32 v49, 0xffff0000, v38
    v_add_f32 v48, s73, v48
    v_add_f32 v49, s73, v49
    v_cvt_pk_bf16_f32 v38, v48, v49
    v_lshlrev_b32 v48, 16, v39
    v_and_b32 v49, 0xffff0000, v39
    v_add_f32 v48, s73, v48
    v_add_f32 v49, s73, v49
    v_cvt_pk_bf16_f32 v39, v48, v49
    s_branch phi_17_done
phi_18_fix:
    v_lshlrev_b32 v48, 16, v40
    v_and_b32 v49, 0xffff0000, v40
    v_add_f32 v48, s73, v48
    v_add_f32 v49, s73, v49
    v_cvt_pk_bf16_f32 v40, v48, v49
    v_lshlrev_b32 v48, 16, v41
    v_and_b32 v49, 0xffff0000, v41
    v_add_f32 v48, s73, v48
    v_add_f32 v49, s73, v49
    v_cvt_pk_bf16_f32 v41, v48, v49
    v_lshlrev_b32 v48, 16, v42
    v_and_b32 v49, 0xffff0000, v42
    v_add_f32 v48, s73, v48
    v_add_f32 v49, s73, v49
    v_cvt_pk_bf16_f32 v42, v48, v49
    v_lshlrev_b32 v48, 16, v43
    v_and_b32 v49, 0xffff0000, v43
    v_add_f32 v48, s73, v48
    v_add_f32 v49, s73, v49
    v_cvt_pk_bf16_f32 v43, v48, v49
    v_lshlrev_b32 v48, 16, v44
    v_and_b32 v49, 0xffff0000, v44
    v_add_f32 v48, s73, v48
    v_add_f32 v49, s73, v49
    v_cvt_pk_bf16_f32 v44, v48, v49
    v_lshlrev_b32 v48, 16, v45
    v_and_b32 v49, 0xffff0000, v45
    v_add_f32 v48, s73, v48
    v_add_f32 v49, s73, v49
    v_cvt_pk_bf16_f32 v45, v48, v49
    v_lshlrev_b32 v48, 16, v46
    v_and_b32 v49, 0xffff0000, v46
    v_add_f32 v48, s73, v48
    v_add_f32 v49, s73, v49
    v_cvt_pk_bf16_f32 v46, v48, v49
    v_lshlrev_b32 v48, 16, v47
    v_and_b32 v49, 0xffff0000, v47
    v_add_f32 v48, s73, v48
    v_add_f32 v49, s73, v49
    v_cvt_pk_bf16_f32 v47, v48, v49
    s_branch phi_18_done
P2_yl:
    s_lshl_b32 s64, s5, 8
    s_lshl_b32 s69, s3, 15
    s_add_u32 s64, s64, s69
    s_add_u32 s64, s64, 6447104
    v_lshlrev_b32 v13, 2, v2
    v_add_u32 v13, s64, v13
    s_mov_b32 s69, 0
    buffer_load_dword v208, v13, s[16:19], s69 offen sc1
    s_mov_b32 s69, 4096
    buffer_load_dword v209, v13, s[16:19], s69 offen sc1
    s_mov_b32 s69, 8192
    buffer_load_dword v210, v13, s[16:19], s69 offen sc1
    s_mov_b32 s69, 12288
    buffer_load_dword v211, v13, s[16:19], s69 offen sc1
    s_mov_b32 s69, 16384
    buffer_load_dword v212, v13, s[16:19], s69 offen sc1
    s_mov_b32 s69, 20480
    buffer_load_dword v213, v13, s[16:19], s69 offen sc1
    s_mov_b32 s69, 24576
    buffer_load_dword v214, v13, s[16:19], s69 offen sc1
    s_mov_b32 s69, 28672
    buffer_load_dword v215, v13, s[16:19], s69 offen sc1
    s_branch P2_nyl
P2_y:
    s_mov_b32 s66, 0
P2_ychk:
    s_waitcnt vmcnt(0)
    v_max3_u32 v10, v208, v209, v210
    v_max3_u32 v10, v211, v212, v10
    v_max3_u32 v10, v213, v214, v10
    v_max_u32 v10, v215, v10
    v_cmp_eq_u32 vcc, -1, v10
    s_cbranch_vccz P2_yok
    s_add_u32 s66, s66, 1
    s_cmp_ge_u32 s66, 100000
    s_cbranch_scc1 P2_yok
    s_sleep 4
    s_mov_b32 s65, 0
    buffer_load_dword v208, v13, s[16:19], s65 offen sc1
    s_mov_b32 s65, 4096
    buffer_load_dword v209, v13, s[16:19], s65 offen sc1
    s_mov_b32 s65, 8192
    buffer_load_dword v210, v13, s[16:19], s65 offen sc1
    s_mov_b32 s65, 12288
    buffer_load_dword v211, v13, s[16:19], s65 offen sc1
    s_mov_b32 s65, 16384
    buffer_load_dword v212, v13, s[16:19], s65 offen sc1
    s_mov_b32 s65, 20480
    buffer_load_dword v213, v13, s[16:19], s65 offen sc1
    s_mov_b32 s65, 24576
    buffer_load_dword v214, v13, s[16:19], s65 offen sc1
    s_mov_b32 s65, 28672
    buffer_load_dword v215, v13, s[16:19], s65 offen sc1
    s_branch P2_ychk
P2_yok:
    v_add_f32 v208, v208, v209
    v_add_f32 v208, v208, v210
    v_add_f32 v208, v208, v211
    v_add_f32 v208, v208, v212
    v_add_f32 v208, v208, v213
    v_add_f32 v208, v208, v214
    v_add_f32 v208, v208, v215
    v_lshlrev_b32 v7, 2, v2
    s_lshl_b32 s64, s3, 8
    v_add_u32 v7, s64, v7
    v_add_u32 v7, 5632, v7
    ds_write_b32 v7, v208
    s_branch P2_ny
P2_nr_19_fix:
    s_and_saveexec_b64 s[70:71], vcc
    ds_read_b128 v[128:131], v9 offset:0
    ds_read_b128 v[132:135], v9 offset:16
    ds_read_b128 v[136:139], v9 offset:256
    ds_read_b128 v[140:143], v9 offset:272
    ds_read_b128 v[144:147], v9 offset:512
    ds_read_b128 v[148:151], v9 offset:528
    ds_read_b128 v[152:155], v9 offset:768
    ds_read_b128 v[156:159], v9 offset:784
    ds_read_b128 v[160:163], v9 offset:1024
    ds_read_b128 v[164:167], v9 offset:1040
    ds_read_b128 v[168:171], v9 offset:1280
    ds_read_b128 v[172:175], v9 offset:1296
    ds_read_b128 v[176:179], v9 offset:1536
    ds_read_b128 v[180:183], v9 offset:1552
    ds_read_b128 v[184:187], v9 offset:1792
    ds_read_b128 v[188:191], v9 offset:1808
    s_and_b32 s64, s75, 0xffff0000
    s_xor_b32 s65, s64, 0x80000000
    s_not_b32 s66, s64
    s_and_b32 s66, s66, 0xffff0000
    s_cmp_ge_u32 s64, 0x80000000
    s_cselect_b32 s64, s65, s66
    v_mov_b32 v100, s64
    v_mul_f32 v100, s72, v100
    v_exp_f32 v100, -v100
    s_nop 0
    v_add_f32 v100, 1.0, v100
    v_rcp_f32 v100, v100
    s_nop 0
    v_cvt_pk_bf16_f32 v100, v100, v100
    v_lshlrev_b32 v100, 16, v100
    s_waitcnt lgkmcnt(0)
    v_add_f32 v128, v128, v136
    v_add_f32 v129, v129, v137
    v_add_f32 v130, v130, v138
    v_add_f32 v131, v131, v139
    v_add_f32 v132, v132, v140
    v_add_f32 v133, v133, v141
    v_add_f32 v134, v134, v142
    v_add_f32 v135, v135, v143
    v_add_f32 v128, v128, v144
    v_add_f32 v129, v129, v145
    v_add_f32 v130, v130, v146
    v_add_f32 v131, v131, v147
    v_add_f32 v132, v132, v148
    v_add_f32 v133, v133, v149
    v_add_f32 v134, v134, v150
    v_add_f32 v135, v135, v151
    v_add_f32 v128, v128, v152
    v_add_f32 v129, v129, v153
    v_add_f32 v130, v130, v154
    v_add_f32 v131, v131, v155
    v_add_f32 v132, v132, v156
    v_add_f32 v133, v133, v157
    v_add_f32 v134, v134, v158
    v_add_f32 v135, v135, v159
    v_add_f32 v128, v128, v160
    v_add_f32 v129, v129, v161
    v_add_f32 v130, v130, v162
    v_add_f32 v131, v131, v163
    v_add_f32 v132, v132, v164
    v_add_f32 v133, v133, v165
    v_add_f32 v134, v134, v166
    v_add_f32 v135, v135, v167
    v_add_f32 v128, v128, v168
    v_add_f32 v129, v129, v169
    v_add_f32 v130, v130, v170
    v_add_f32 v131, v131, v171
    v_add_f32 v132, v132, v172
    v_add_f32 v133, v133, v173
    v_add_f32 v134, v134, v174
    v_add_f32 v135, v135, v175
    v_add_f32 v128, v128, v176
    v_add_f32 v129, v129, v177
    v_add_f32 v130, v130, v178
    v_add_f32 v131, v131, v179
    v_add_f32 v132, v132, v180
    v_add_f32 v133, v133, v181
    v_add_f32 v134, v134, v182
    v_add_f32 v135, v135, v183
    v_add_f32 v128, v128, v184
    v_add_f32 v129, v129, v185
    v_add_f32 v130, v130, v186
    v_add_f32 v131, v131, v187
    v_add_f32 v132, v132, v188
    v_add_f32 v133, v133, v189
    v_add_f32 v134, v134, v190
    v_add_f32 v135, v135, v191
    v_cvt_pk_bf16_f32 v116, v128, v129
    v_lshlrev_b32 v128, 16, v116
    v_and_b32 v129, 0xffff0000, v116
    v_mul_f32 v128, v128, v100
    v_mul_f32 v129, v129, v100
    v_cvt_pk_bf16_f32 v116, v128, v129
    v_lshlrev_b32 v128, 16, v116
    v_and_b32 v129, 0xffff0000, v116
    v_lshlrev_b32 v232, 16, v220
    v_and_b32 v233, 0xffff0000, v220
    v_add_f32 v232, v232, v128
    v_add_f32 v233, v233, v129
    v_cvt_pk_bf16_f32 v116, v232, v233
    v_lshlrev_b32 v232, 16, v116
    v_and_b32 v233, 0xffff0000, v116
    v_mul_f32 v232, v232, v248
    v_mul_f32 v233, v233, v248
    v_cvt_pk_bf16_f32 v116, v232, v233
    v_lshlrev_b32 v232, 16, v116
    v_and_b32 v233, 0xffff0000, v116
    v_cvt_pk_bf16_f32 v116, v130, v131
    v_lshlrev_b32 v130, 16, v116
    v_and_b32 v131, 0xffff0000, v116
    v_mul_f32 v130, v130, v100
    v_mul_f32 v131, v131, v100
    v_cvt_pk_bf16_f32 v116, v130, v131
    v_lshlrev_b32 v130, 16, v116
    v_and_b32 v131, 0xffff0000, v116
    v_lshlrev_b32 v234, 16, v221
    v_and_b32 v235, 0xffff0000, v221
    v_add_f32 v234, v234, v130
    v_add_f32 v235, v235, v131
    v_cvt_pk_bf16_f32 v116, v234, v235
    v_lshlrev_b32 v234, 16, v116
    v_and_b32 v235, 0xffff0000, v116
    v_mul_f32 v234, v234, v248
    v_mul_f32 v235, v235, v248
    v_cvt_pk_bf16_f32 v116, v234, v235
    v_lshlrev_b32 v234, 16, v116
    v_and_b32 v235, 0xffff0000, v116
    v_cvt_pk_bf16_f32 v116, v132, v133
    v_lshlrev_b32 v132, 16, v116
    v_and_b32 v133, 0xffff0000, v116
    v_mul_f32 v132, v132, v100
    v_mul_f32 v133, v133, v100
    v_cvt_pk_bf16_f32 v116, v132, v133
    v_lshlrev_b32 v132, 16, v116
    v_and_b32 v133, 0xffff0000, v116
    v_lshlrev_b32 v236, 16, v222
    v_and_b32 v237, 0xffff0000, v222
    v_add_f32 v236, v236, v132
    v_add_f32 v237, v237, v133
    v_cvt_pk_bf16_f32 v116, v236, v237
    v_lshlrev_b32 v236, 16, v116
    v_and_b32 v237, 0xffff0000, v116
    v_mul_f32 v236, v236, v248
    v_mul_f32 v237, v237, v248
    v_cvt_pk_bf16_f32 v116, v236, v237
    v_lshlrev_b32 v236, 16, v116
    v_and_b32 v237, 0xffff0000, v116
    v_cvt_pk_bf16_f32 v116, v134, v135
    v_lshlrev_b32 v134, 16, v116
    v_and_b32 v135, 0xffff0000, v116
    v_mul_f32 v134, v134, v100
    v_mul_f32 v135, v135, v100
    v_cvt_pk_bf16_f32 v116, v134, v135
    v_lshlrev_b32 v134, 16, v116
    v_and_b32 v135, 0xffff0000, v116
    v_lshlrev_b32 v238, 16, v223
    v_and_b32 v239, 0xffff0000, v223
    v_add_f32 v238, v238, v134
    v_add_f32 v239, v239, v135
    v_cvt_pk_bf16_f32 v116, v238, v239
    v_lshlrev_b32 v238, 16, v116
    v_and_b32 v239, 0xffff0000, v116
    v_mul_f32 v238, v238, v248
    v_mul_f32 v239, v239, v248
    v_cvt_pk_bf16_f32 v116, v238, v239
    v_lshlrev_b32 v238, 16, v116
    v_and_b32 v239, 0xffff0000, v116
    s_mov_b64 exec, s[70:71]
    s_branch P2_nr_19
P2_nr_20_fix:
    s_and_saveexec_b64 s[70:71], vcc
    ds_read_b128 v[128:131], v9 offset:0
    ds_read_b128 v[132:135], v9 offset:16
    ds_read_b128 v[136:139], v9 offset:256
    ds_read_b128 v[140:143], v9 offset:272
    ds_read_b128 v[144:147], v9 offset:512
    ds_read_b128 v[148:151], v9 offset:528
    ds_read_b128 v[152:155], v9 offset:768
    ds_read_b128 v[156:159], v9 offset:784
    ds_read_b128 v[160:163], v9 offset:1024
    ds_read_b128 v[164:167], v9 offset:1040
    ds_read_b128 v[168:171], v9 offset:1280
    ds_read_b128 v[172:175], v9 offset:1296
    ds_read_b128 v[176:179], v9 offset:1536
    ds_read_b128 v[180:183], v9 offset:1552
    ds_read_b128 v[184:187], v9 offset:1792
    ds_read_b128 v[188:191], v9 offset:1808
    s_and_b32 s64, s75, 0xffff0000
    s_xor_b32 s65, s64, 0x80000000
    s_not_b32 s66, s64
    s_and_b32 s66, s66, 0xffff0000
    s_cmp_ge_u32 s64, 0x80000000
    s_cselect_b32 s64, s65, s66
    v_mov_b32 v100, s64
    v_mul_f32 v100, s72, v100
    v_exp_f32 v100, -v100
    s_nop 0
    v_add_f32 v100, 1.0, v100
    v_rcp_f32 v100, v100
    s_nop 0
    v_cvt_pk_bf16_f32 v100, v100, v100
    v_lshlrev_b32 v100, 16, v100
    s_waitcnt lgkmcnt(0)
    v_add_f32 v128, v128, v136
    v_add_f32 v129, v129, v137
    v_add_f32 v130, v130, v138
    v_add_f32 v131, v131, v139
    v_add_f32 v132, v132, v140
    v_add_f32 v133, v133, v141
    v_add_f32 v134, v134, v142
    v_add_f32 v135, v135, v143
    v_add_f32 v128, v128, v144
    v_add_f32 v129, v129, v145
    v_add_f32 v130, v130, v146
    v_add_f32 v131, v131, v147
    v_add_f32 v132, v132, v148
    v_add_f32 v133, v133, v149
    v_add_f32 v134, v134, v150
    v_add_f32 v135, v135, v151
    v_add_f32 v128, v128, v152
    v_add_f32 v129, v129, v153
    v_add_f32 v130, v130, v154
    v_add_f32 v131, v131, v155
    v_add_f32 v132, v132, v156
    v_add_f32 v133, v133, v157
    v_add_f32 v134, v134, v158
    v_add_f32 v135, v135, v159
    v_add_f32 v128, v128, v160
    v_add_f32 v129, v129, v161
    v_add_f32 v130, v130, v162
    v_add_f32 v131, v131, v163
    v_add_f32 v132, v132, v164
    v_add_f32 v133, v133, v165
    v_add_f32 v134, v134, v166
    v_add_f32 v135, v135, v167
    v_add_f32 v128, v128, v168
    v_add_f32 v129, v129, v169
    v_add_f32 v130, v130, v170
    v_add_f32 v131, v131, v171
    v_add_f32 v132, v132, v172
    v_add_f32 v133, v133, v173
    v_add_f32 v134, v134, v174
    v_add_f32 v135, v135, v175
    v_add_f32 v128, v128, v176
    v_add_f32 v129, v129, v177
    v_add_f32 v130, v130, v178
    v_add_f32 v131, v131, v179
    v_add_f32 v132, v132, v180
    v_add_f32 v133, v133, v181
    v_add_f32 v134, v134, v182
    v_add_f32 v135, v135, v183
    v_add_f32 v128, v128, v184
    v_add_f32 v129, v129, v185
    v_add_f32 v130, v130, v186
    v_add_f32 v131, v131, v187
    v_add_f32 v132, v132, v188
    v_add_f32 v133, v133, v189
    v_add_f32 v134, v134, v190
    v_add_f32 v135, v135, v191
    v_cvt_pk_bf16_f32 v116, v128, v129
    v_lshlrev_b32 v128, 16, v116
    v_and_b32 v129, 0xffff0000, v116
    v_mul_f32 v128, v128, v100
    v_mul_f32 v129, v129, v100
    v_cvt_pk_bf16_f32 v116, v128, v129
    v_lshlrev_b32 v128, 16, v116
    v_and_b32 v129, 0xffff0000, v116
    v_lshlrev_b32 v240, 16, v224
    v_and_b32 v241, 0xffff0000, v224
    v_add_f32 v240, v240, v128
    v_add_f32 v241, v241, v129
    v_cvt_pk_bf16_f32 v116, v240, v241
    v_lshlrev_b32 v240, 16, v116
    v_and_b32 v241, 0xffff0000, v116
    v_mul_f32 v240, v240, v249
    v_mul_f32 v241, v241, v249
    v_cvt_pk_bf16_f32 v116, v240, v241
    v_lshlrev_b32 v240, 16, v116
    v_and_b32 v241, 0xffff0000, v116
    v_cvt_pk_bf16_f32 v116, v130, v131
    v_lshlrev_b32 v130, 16, v116
    v_and_b32 v131, 0xffff0000, v116
    v_mul_f32 v130, v130, v100
    v_mul_f32 v131, v131, v100
    v_cvt_pk_bf16_f32 v116, v130, v131
    v_lshlrev_b32 v130, 16, v116
    v_and_b32 v131, 0xffff0000, v116
    v_lshlrev_b32 v242, 16, v225
    v_and_b32 v243, 0xffff0000, v225
    v_add_f32 v242, v242, v130
    v_add_f32 v243, v243, v131
    v_cvt_pk_bf16_f32 v116, v242, v243
    v_lshlrev_b32 v242, 16, v116
    v_and_b32 v243, 0xffff0000, v116
    v_mul_f32 v242, v242, v249
    v_mul_f32 v243, v243, v249
    v_cvt_pk_bf16_f32 v116, v242, v243
    v_lshlrev_b32 v242, 16, v116
    v_and_b32 v243, 0xffff0000, v116
    v_cvt_pk_bf16_f32 v116, v132, v133
    v_lshlrev_b32 v132, 16, v116
    v_and_b32 v133, 0xffff0000, v116
    v_mul_f32 v132, v132, v100
    v_mul_f32 v133, v133, v100
    v_cvt_pk_bf16_f32 v116, v132, v133
    v_lshlrev_b32 v132, 16, v116
    v_and_b32 v133, 0xffff0000, v116
    v_lshlrev_b32 v244, 16, v226
    v_and_b32 v245, 0xffff0000, v226
    v_add_f32 v244, v244, v132
    v_add_f32 v245, v245, v133
    v_cvt_pk_bf16_f32 v116, v244, v245
    v_lshlrev_b32 v244, 16, v116
    v_and_b32 v245, 0xffff0000, v116
    v_mul_f32 v244, v244, v249
    v_mul_f32 v245, v245, v249
    v_cvt_pk_bf16_f32 v116, v244, v245
    v_lshlrev_b32 v244, 16, v116
    v_and_b32 v245, 0xffff0000, v116
    v_cvt_pk_bf16_f32 v116, v134, v135
    v_lshlrev_b32 v134, 16, v116
    v_and_b32 v135, 0xffff0000, v116
    v_mul_f32 v134, v134, v100
    v_mul_f32 v135, v135, v100
    v_cvt_pk_bf16_f32 v116, v134, v135
    v_lshlrev_b32 v134, 16, v116
    v_and_b32 v135, 0xffff0000, v116
    v_lshlrev_b32 v246, 16, v227
    v_and_b32 v247, 0xffff0000, v227
    v_add_f32 v246, v246, v134
    v_add_f32 v247, v247, v135
    v_cvt_pk_bf16_f32 v116, v246, v247
    v_lshlrev_b32 v246, 16, v116
    v_and_b32 v247, 0xffff0000, v116
    v_mul_f32 v246, v246, v249
    v_mul_f32 v247, v247, v249
    v_cvt_pk_bf16_f32 v116, v246, v247
    v_lshlrev_b32 v246, 16, v116
    v_and_b32 v247, 0xffff0000, v116
    s_mov_b64 exec, s[70:71]
    s_branch P2_nr_20
CODE_END:
.section .rodata,"a"
.p2align 6
.amdhsa_kernel gated_mix__linear_attn_block__moe_arch_mod__prompt_kernel
  .amdhsa_next_free_vgpr 256
  .amdhsa_next_free_sgpr 102
  .amdhsa_accum_offset 256
  .amdhsa_group_segment_fixed_size 0
  .amdhsa_kernarg_size 96
  .amdhsa_user_sgpr_count 2
  .amdhsa_user_sgpr_kernarg_segment_ptr 1
  .amdhsa_system_sgpr_workgroup_id_x 1
.end_amdhsa_kernel
```

```asm
; @launch grid=(256,1,1) block=(512,1,1) lds=163840
.amdgcn_target "amdgcn-amd-amdhsa--gfx950"
.text
.globl gated_mix__linear_attn_block__moe_arch_mod__prompt_kernel
.p2align 8
.type gated_mix__linear_attn_block__moe_arch_mod__prompt_kernel,@function
gated_mix__linear_attn_block__moe_arch_mod__prompt_kernel:
    s_load_dwordx16 s[40:55], s[0:1], 0
    s_load_dwordx8 s[56:63], s[0:1], 64
    s_cmp_ge_u32 s2, 256
    s_cbranch_scc1 K_end
    v_lshrrev_b32 v1, 6, v0
    v_and_b32 v2, 63, v0
    s_and_b32 s6, s2, 7
    v_readfirstlane_b32 s3, v1
    s_lshr_b32 s7, s2, 3
    s_and_b32 s4, s6, 1
    s_lshl_b32 s4, s4, 3
    s_and_b32 s64, s7, 7
    s_add_u32 s4, s4, s64
    s_lshr_b32 s5, s6, 1
    s_lshl_b32 s5, s5, 2
    s_lshr_b32 s64, s7, 3
    s_add_u32 s5, s5, s64
    s_lshl_b32 s74, s4, 1
    v_lshrrev_b32 v6, 3, v2
    s_lshl_b32 s65, s3, 3
    v_add_u32 v6, s65, v6
    s_lshl_b32 s64, s4, 7
    v_add_u32 v7, s64, v6
    v_lshlrev_b32 v7, 11, v7
    v_lshrrev_b32 v8, 4, v2
    s_and_b32 s64, s3, 1
    s_lshl_b32 s64, s64, 2
    v_add_u32 v9, s64, v8
    v_and_b32 v10, 7, v2
    v_xor_b32 v9, v9, v10
    v_lshl_add_u32 v7, v9, 4, v7
    v_mul_u32_u24 v6, 6144, v6
    v_and_b32 v9, 1, v8
    s_lshr_b32 s64, s64, 1
    v_lshl_add_u32 v9, v9, 2, s64
    v_xor_b32 v9, v9, v10
    v_lshl_add_u32 v6, v9, 4, v6
    s_lshl_b32 s64, s5, 7
    v_add_u32 v6, s64, v6
    s_lshl_b32 s66, s3, 10
    s_mov_b32 s10, 4194304
    s_mov_b32 s11, 0x00020000
    s_mov_b32 s14, 6291456
    s_mov_b32 s15, 0x00020000
    s_add_u32 s65, s74, 0
    s_and_b32 s65, s65, 15
    s_lshl_b32 s67, s65, 7
    s_mul_i32 s65, s65, 393216
    s_waitcnt lgkmcnt(0)
    s_mov_b32 s8, s40
    s_mov_b32 s9, s41
    s_mov_b32 s12, s42
    s_mov_b32 s13, s43
    s_add_u32 m0, s66, 8192
    s_add_u32 s64, s67, 0
    buffer_load_dwordx4 v7, s[8:11], s64 offen lds
    s_add_u32 m0, s66, 16384
    s_add_u32 s64, s67, 131072
    buffer_load_dwordx4 v7, s[8:11], s64 offen lds
    s_add_u32 m0, s66, 24576
    s_add_u32 s64, s65, 0
    buffer_load_dwordx4 v6, s[12:15], s64 offen lds
    s_add_u32 m0, s66, 32768
    s_add_u32 s64, s65, 2048
    buffer_load_dwordx4 v6, s[12:15], s64 offen lds
    s_add_u32 m0, s66, 40960
    s_add_u32 s64, s65, 4096
    buffer_load_dwordx4 v6, s[12:15], s64 offen lds
    s_barrier
    s_mov_b32 s72, 0x3fb8aa3b
    s_mov_b32 s73, 0x358637bd
    s_mov_b32 s16, s62
    s_mov_b32 s17, s63
    s_mov_b32 s18, 0x10000000
    s_mov_b32 s19, 0x00020000
    s_cmp_lt_u32 s3, 4
    s_cbranch_scc1 C_start
    s_sub_u32 s6, s3, 4
    s_lshl_b32 s7, s6, 10
    v_lshrrev_b32 v6, 3, v2
    s_lshl_b32 s64, s4, 7
    s_lshl_b32 s65, s6, 3
    s_add_u32 s64, s64, s65
    v_add_u32 v7, s64, v6
    v_lshlrev_b32 v7, 11, v7
    s_and_b32 s64, s6, 1
    s_lshl_b32 s64, s64, 2
    v_add_u32 v9, s64, v8
    v_xor_b32 v9, v9, v10
    v_lshl_add_u32 v4, v9, 4, v7
    v_add_u32 v7, s65, v6
    v_mul_u32_u24 v7, 6144, v7
    v_and_b32 v9, 1, v8
    s_lshr_b32 s64, s64, 1
    v_lshl_add_u32 v9, v9, 2, s64
    v_xor_b32 v9, v9, v10
    v_lshl_add_u32 v7, v9, 4, v7
    s_lshl_b32 s64, s5, 7
    v_add_u32 v5, s64, v7
    v_lshlrev_b32 v6, 4, v2
    s_and_b32 s64, s2, 1
    s_lshl_b32 s68, s64, 10
    s_bfe_u32 s64, s2, 0x20001
    s_lshl_b32 s64, s64, 8
    s_add_u32 s68, s68, s64
    s_and_b32 s64, s2, 0xf8
    s_add_u32 s68, s68, s64
    s_lshl_b32 s64, s6, 1
    s_add_u32 s68, s68, s64
    s_lshl_b32 s64, s68, 11
    v_add_u32 v13, s64, v6
    s_add_u32 s41, s74, 1
    s_and_b32 s41, s41, 15
    s_lshl_b32 s42, s41, 7
    s_mul_i32 s41, s41, 393216
    s_add_u32 m0, s7, 49152
    s_add_u32 s40, s42, 0
    buffer_load_dwordx4 v4, s[8:11], s40 offen lds
    s_add_u32 m0, s7, 53248
    s_add_u32 s40, s42, 65536
    buffer_load_dwordx4 v4, s[8:11], s40 offen lds
    s_add_u32 m0, s7, 57344
    s_add_u32 s40, s42, 131072
    buffer_load_dwordx4 v4, s[8:11], s40 offen lds
    s_add_u32 m0, s7, 61440
    s_add_u32 s40, s42, 196608
    buffer_load_dwordx4 v4, s[8:11], s40 offen lds
    s_add_u32 m0, s7, 65536
    s_add_u32 s40, s41, 0
    buffer_load_dwordx4 v5, s[12:15], s40 offen lds
    s_add_u32 m0, s7, 69632
    s_add_u32 s40, s41, 196608
    buffer_load_dwordx4 v5, s[12:15], s40 offen lds
    s_add_u32 m0, s7, 73728
    s_add_u32 s40, s41, 2048
    buffer_load_dwordx4 v5, s[12:15], s40 offen lds
    s_add_u32 m0, s7, 77824
    s_add_u32 s40, s41, 198656
    buffer_load_dwordx4 v5, s[12:15], s40 offen lds
    s_add_u32 m0, s7, 81920
    s_add_u32 s40, s41, 4096
    buffer_load_dwordx4 v5, s[12:15], s40 offen lds
    s_add_u32 m0, s7, 86016
    s_add_u32 s40, s41, 200704
    buffer_load_dwordx4 v5, s[12:15], s40 offen lds
    s_or_b32 s64, s2, s6
    s_cmp_lg_u32 s64, 0
    s_cbranch_scc1 H_nn
    s_mov_b32 s64, 6717440
    s_load_dwordx2 s[66:67], s[62:63], s64
    s_mov_b32 s20, s60
    s_mov_b32 s21, s61
    s_mov_b32 s22, 0x100
    s_mov_b32 s23, 0x00020000
    s_waitcnt lgkmcnt(0)
    s_xor_b32 s64, s66, s67
    s_add_u32 s64, s64, 1
    s_max_u32 s64, s64, 1
    v_mov_b32 v72, s64
    v_mov_b32 v73, 0
    s_mov_b64 exec, 1
    buffer_store_dword v72, v73, s[20:23], 0 offen sc0 sc1
    s_mov_b64 exec, -1
H_nn:
    s_mov_b32 s20, s60
    s_mov_b32 s21, s61
    s_mov_b32 s22, 0x100
    s_mov_b32 s23, 0x00020000
    s_mov_b32 s24, s48
    s_mov_b32 s25, s49
    s_mov_b32 s26, 0x800
    s_mov_b32 s27, 0x00020000
    s_mov_b32 s28, s56
    s_mov_b32 s29, s57
    s_mov_b32 s30, 0x800
    s_mov_b32 s31, 0x00020000
    s_mov_b32 s32, s50
    s_mov_b32 s33, s51
    s_mov_b32 s34, 0x700000
    s_mov_b32 s35, 0x00020000
    s_mov_b32 s36, s52
    s_mov_b32 s37, s53
    s_mov_b32 s38, 0x700000
    s_mov_b32 s39, 0x00020000
    s_lshr_b32 s69, s2, 3
    s_and_b32 s64, s2, 7
    v_and_b32 v9, 15, v2
    v_min_u32 v9, 13, v9
    s_lshl_b32 s65, s69, 5
    v_lshl_add_u32 v7, v8, 3, s65
    v_mul_u32_u24 v7, 7168, v7
    s_mul_i32 s65, s64, 896
    s_mul_i32 s66, s6, 224
    s_add_u32 s65, s65, s66
    v_lshl_add_u32 v7, v9, 4, v7
    v_add_u32 v11, s65, v7
    v_cmp_le_u32 vcc, 7, v9
    v_mov_b32 v15, 16160
    s_nop 0
    v_cndmask_b32 v7, 0, v15, vcc
    v_lshl_add_u32 v7, v9, 5, v7
    v_lshrrev_b32 v15, 1, v8
    v_lshl_add_u32 v7, v15, 13, v7
    v_and_b32 v15, 1, v8
    v_lshl_add_u32 v7, v15, 4, v7
    s_lshl_b32 s64, s64, 17
    s_lshl_b32 s65, s6, 15
    s_add_u32 s64, s64, s65
    s_lshl_b32 s65, s69, 8
    s_add_u32 s64, s64, s65
    s_add_u32 s64, s64, 5398528
    v_add_u32 v12, s64, v7
    s_lshl_b32 s70, s5, 2
    s_add_u32 s70, s70, s6
    s_mul_i32 s70, s70, 18432
    s_add_u32 s70, s70, 4194304
    s_mul_i32 s64, s4, 1152
    s_add_u32 s64, s64, s70
    s_mov_b32 s67, s64
    v_lshl_add_u32 v15, v2, 2, s64
    v_add_u32 v15, 960, v15
    s_lshl_b32 s64, s5, 2
    s_add_u32 s64, s64, s6
    s_lshl_b32 s64, s64, 7
    s_add_u32 s64, s64, 5373952
    v_mov_b32 v23, s64
    s_lshl_b32 s65, s4, 10
    s_add_u32 s65, s65, 5382016
    v_lshl_add_u32 v20, v2, 7, s65
    v_cmp_gt_u32 vcc, 16, v2
    s_nop 1
    v_cndmask_b32 v15, v15, v20, vcc
    v_writelane_b32 v15, s64, 0
    s_cmp_eq_u32 s4, 0
    s_cselect_b32 s75, 1, 0
    s_or_b32 s64, s5, s6
    s_cmp_eq_u32 s64, 0
    s_cselect_b32 s64, 0x1fe, 0
    s_or_b32 s75, s75, s64
    s_or_b32 s75, s75, 0xffff0000
    v_add_u32 v22, s67, v6
    v_mov_b32 v16, -1
    v_mov_b32 v17, -1
    v_mov_b32 v18, -1
    v_mov_b32 v19, -1
    v_cndmask_b32 v20, -1, 0, vcc
    s_waitcnt vmcnt(10)
    s_barrier
    s_add_u32 s41, s74, 2
    s_and_b32 s41, s41, 15
    s_lshl_b32 s42, s41, 7
    s_mul_i32 s41, s41, 393216
    s_add_u32 m0, s7, 90112
    s_add_u32 s40, s42, 0
    buffer_load_dwordx4 v4, s[8:11], s40 offen lds
    s_add_u32 m0, s7, 94208
    s_add_u32 s40, s42, 65536
    buffer_load_dwordx4 v4, s[8:11], s40 offen lds
    s_add_u32 m0, s7, 98304
    s_add_u32 s40, s42, 131072
    buffer_load_dwordx4 v4, s[8:11], s40 offen lds
    s_add_u32 m0, s7, 102400
    s_add_u32 s40, s42, 196608
    buffer_load_dwordx4 v4, s[8:11], s40 offen lds
    s_add_u32 m0, s7, 106496
    s_add_u32 s40, s41, 0
    buffer_load_dwordx4 v5, s[12:15], s40 offen lds
    s_add_u32 m0, s7, 110592
    s_add_u32 s40, s41, 196608
    buffer_load_dwordx4 v5, s[12:15], s40 offen lds
    s_add_u32 m0, s7, 114688
    s_add_u32 s40, s41, 2048
    buffer_load_dwordx4 v5, s[12:15], s40 offen lds
    s_add_u32 m0, s7, 118784
    s_add_u32 s40, s41, 198656
    buffer_load_dwordx4 v5, s[12:15], s40 offen lds
    s_add_u32 m0, s7, 122880
    s_add_u32 s40, s41, 4096
    buffer_load_dwordx4 v5, s[12:15], s40 offen lds
    s_add_u32 m0, s7, 126976
    s_add_u32 s40, s41, 200704
    buffer_load_dwordx4 v5, s[12:15], s40 offen lds
    buffer_load_dwordx4 v[24:27], v13, s[8:11], 0 offen offset:0
    buffer_load_dwordx4 v[28:31], v13, s[8:11], 0 offen offset:1024
    buffer_load_dwordx4 v[32:35], v13, s[8:11], 0 offen offset:2048
    buffer_load_dwordx4 v[36:39], v13, s[8:11], 0 offen offset:3072
    buffer_load_dwordx4 v[40:43], v6, s[24:27], 0 offen offset:0
    buffer_load_dwordx4 v[44:47], v6, s[24:27], 0 offen offset:1024
    buffer_load_dwordx4 v[48:51], v6, s[28:31], 0 offen offset:0
    buffer_load_dwordx4 v[52:55], v6, s[28:31], 0 offen offset:1024
    s_waitcnt vmcnt(18)
    s_barrier
    s_add_u32 s41, s74, 3
    s_and_b32 s41, s41, 15
    s_lshl_b32 s42, s41, 7
    s_mul_i32 s41, s41, 393216
    s_add_u32 m0, s7, 8192
    s_add_u32 s40, s42, 0
    buffer_load_dwordx4 v4, s[8:11], s40 offen lds
    s_add_u32 m0, s7, 12288
    s_add_u32 s40, s42, 65536
    buffer_load_dwordx4 v4, s[8:11], s40 offen lds
    s_add_u32 m0, s7, 16384
    s_add_u32 s40, s42, 131072
    buffer_load_dwordx4 v4, s[8:11], s40 offen lds
    s_add_u32 m0, s7, 20480
    s_add_u32 s40, s42, 196608
    buffer_load_dwordx4 v4, s[8:11], s40 offen lds
    s_add_u32 m0, s7, 24576
    s_add_u32 s40, s41, 0
    buffer_load_dwordx4 v5, s[12:15], s40 offen lds
    s_add_u32 m0, s7, 28672
    s_add_u32 s40, s41, 196608
    buffer_load_dwordx4 v5, s[12:15], s40 offen lds
    s_add_u32 m0, s7, 32768
    s_add_u32 s40, s41, 2048
    buffer_load_dwordx4 v5, s[12:15], s40 offen lds
    s_add_u32 m0, s7, 36864
    s_add_u32 s40, s41, 198656
    buffer_load_dwordx4 v5, s[12:15], s40 offen lds
    s_add_u32 m0, s7, 40960
    s_add_u32 s40, s41, 4096
    buffer_load_dwordx4 v5, s[12:15], s40 offen lds
    s_add_u32 m0, s7, 45056
    s_add_u32 s40, s41, 200704
    buffer_load_dwordx4 v5, s[12:15], s40 offen lds
    buffer_store_dwordx4 v[16:19], v22, s[16:19], 0 offen sc0 sc1
    s_mov_b32 exec_lo, s75
    s_mov_b32 exec_hi, 0
    buffer_store_dword v20, v15, s[16:19], 0 offen sc0 sc1
    s_mov_b32 exec_lo, 0x3fff3fff
    s_mov_b32 exec_hi, 0x3fff3fff
    buffer_store_dwordx4 v[16:19], v12, s[16:19], 0 offen sc0 sc1
    s_mov_b64 exec, 0xffff
    s_lshl_b32 s64, s2, 10
    s_lshl_b32 s65, s6, 8
    s_add_u32 s64, s64, s65
    s_add_u32 s64, s64, 6447104
    buffer_store_dwordx4 v[16:19], v6, s[16:19], s64 offen sc0 sc1
    s_mov_b64 exec, -1
    s_waitcnt vmcnt(22)
    s_barrier
    v_mov_b32 v79, 0
    s_cmp_lg_u32 s6, 0
    s_cbranch_scc1 H_nc
    buffer_load_dword v78, v79, s[20:23], 0 offen sc1
H_nc:
    s_add_u32 s41, s74, 4
    s_and_b32 s41, s41, 15
    s_lshl_b32 s42, s41, 7
    s_mul_i32 s41, s41, 393216
    s_add_u32 m0, s7, 49152
    s_add_u32 s40, s42, 0
    buffer_load_dwordx4 v4, s[8:11], s40 offen lds
    s_add_u32 m0, s7, 53248
    s_add_u32 s40, s42, 65536
    buffer_load_dwordx4 v4, s[8:11], s40 offen lds
    s_add_u32 m0, s7, 57344
    s_add_u32 s40, s42, 131072
    buffer_load_dwordx4 v4, s[8:11], s40 offen lds
    s_add_u32 m0, s7, 61440
    s_add_u32 s40, s42, 196608
    buffer_load_dwordx4 v4, s[8:11], s40 offen lds
    s_add_u32 m0, s7, 65536
    s_add_u32 s40, s41, 0
    buffer_load_dwordx4 v5, s[12:15], s40 offen lds
    s_add_u32 m0, s7, 69632
    s_add_u32 s40, s41, 196608
    buffer_load_dwordx4 v5, s[12:15], s40 offen lds
    s_add_u32 m0, s7, 73728
    s_add_u32 s40, s41, 2048
    buffer_load_dwordx4 v5, s[12:15], s40 offen lds
    s_add_u32 m0, s7, 77824
    s_add_u32 s40, s41, 198656
    buffer_load_dwordx4 v5, s[12:15], s40 offen lds
    s_add_u32 m0, s7, 81920
    s_add_u32 s40, s41, 4096
    buffer_load_dwordx4 v5, s[12:15], s40 offen lds
    s_add_u32 m0, s7, 86016
    s_add_u32 s40, s41, 200704
    buffer_load_dwordx4 v5, s[12:15], s40 offen lds
    s_waitcnt vmcnt(14)
    s_barrier
    s_add_u32 s41, s74, 5
    s_and_b32 s41, s41, 15
    s_lshl_b32 s42, s41, 7
    s_mul_i32 s41, s41, 393216
    s_add_u32 m0, s7, 90112
    s_add_u32 s40, s42, 0
    buffer_load_dwordx4 v4, s[8:11], s40 offen lds
    v_dot2_f32_bf16 v72, v24, v48, 0
    v_dot2_f32_bf16 v73, v32, v48, 0
    v_dot2_f32_bf16 v74, v24, v40, 0
    v_dot2_f32_bf16 v75, v32, v40, 0
    s_add_u32 m0, s7, 94208
    s_add_u32 s40, s42, 65536
    buffer_load_dwordx4 v4, s[8:11], s40 offen lds
    v_dot2_f32_bf16 v72, v25, v49, v72
    v_dot2_f32_bf16 v73, v33, v49, v73
    v_dot2_f32_bf16 v74, v25, v41, v74
    v_dot2_f32_bf16 v75, v33, v41, v75
    s_add_u32 m0, s7, 98304
    s_add_u32 s40, s42, 131072
    buffer_load_dwordx4 v4, s[8:11], s40 offen lds
    v_dot2_f32_bf16 v72, v26, v50, v72
    v_dot2_f32_bf16 v73, v34, v50, v73
    v_dot2_f32_bf16 v74, v26, v42, v74
    v_dot2_f32_bf16 v75, v34, v42, v75
    s_add_u32 m0, s7, 102400
    s_add_u32 s40, s42, 196608
    buffer_load_dwordx4 v4, s[8:11], s40 offen lds
    v_dot2_f32_bf16 v72, v27, v51, v72
    v_dot2_f32_bf16 v73, v35, v51, v73
    v_dot2_f32_bf16 v74, v27, v43, v74
    v_dot2_f32_bf16 v75, v35, v43, v75
    s_add_u32 m0, s7, 106496
    s_add_u32 s40, s41, 0
    buffer_load_dwordx4 v5, s[12:15], s40 offen lds
    v_dot2_f32_bf16 v72, v28, v52, v72
    v_dot2_f32_bf16 v73, v36, v52, v73
    v_dot2_f32_bf16 v74, v28, v44, v74
    v_dot2_f32_bf16 v75, v36, v44, v75
    s_add_u32 m0, s7, 110592
    s_add_u32 s40, s41, 196608
    buffer_load_dwordx4 v5, s[12:15], s40 offen lds
    v_dot2_f32_bf16 v72, v29, v53, v72
    v_dot2_f32_bf16 v73, v37, v53, v73
    v_dot2_f32_bf16 v74, v29, v45, v74
    v_dot2_f32_bf16 v75, v37, v45, v75
    s_add_u32 m0, s7, 114688
    s_add_u32 s40, s41, 2048
    buffer_load_dwordx4 v5, s[12:15], s40 offen lds
    v_dot2_f32_bf16 v72, v30, v54, v72
    v_dot2_f32_bf16 v73, v38, v54, v73
    v_dot2_f32_bf16 v74, v30, v46, v74
    v_dot2_f32_bf16 v75, v38, v46, v75
    s_add_u32 m0, s7, 118784
    s_add_u32 s40, s41, 198656
    buffer_load_dwordx4 v5, s[12:15], s40 offen lds
    v_dot2_f32_bf16 v72, v31, v55, v72
    v_dot2_f32_bf16 v73, v39, v55, v73
    v_dot2_f32_bf16 v74, v31, v47, v74
    v_dot2_f32_bf16 v75, v39, v47, v75
    s_add_u32 m0, s7, 122880
    s_add_u32 s40, s41, 4096
    buffer_load_dwordx4 v5, s[12:15], s40 offen lds
    s_add_u32 m0, s7, 126976
    s_add_u32 s40, s41, 200704
    buffer_load_dwordx4 v5, s[12:15], s40 offen lds
    s_waitcnt vmcnt(10)
    s_barrier
    s_add_u32 s41, s74, 6
    s_and_b32 s41, s41, 15
    s_lshl_b32 s42, s41, 7
    s_mul_i32 s41, s41, 393216
    s_add_u32 m0, s7, 8192
    s_add_u32 s40, s42, 0
    buffer_load_dwordx4 v4, s[8:11], s40 offen lds
    v_permlane32_swap_b32 v72, v74
    v_permlane32_swap_b32 v73, v75
    v_add_f32 v72, v72, v74
    v_add_f32 v73, v73, v75
    s_add_u32 m0, s7, 12288
    s_add_u32 s40, s42, 65536
    buffer_load_dwordx4 v4, s[8:11], s40 offen lds
    s_lshl_b32 s64, s68, 2
    s_add_u32 s64, s64, 6709248
    v_permlane16_swap_b32 v72, v73
    v_add_f32 v72, v72, v73
    s_add_u32 m0, s7, 16384
    s_add_u32 s40, s42, 131072
    buffer_load_dwordx4 v4, s[8:11], s40 offen lds
    v_and_b32 v75, 1, v8
    v_lshl_add_u32 v76, v75, 2, s64
    v_add_f32_dpp v72, v72, v72 quad_perm:[1,0,3,2] row_mask:0xf bank_mask:0xf
    s_nop 1
    s_add_u32 m0, s7, 20480
    s_add_u32 s40, s42, 196608
    buffer_load_dwordx4 v4, s[8:11], s40 offen lds
    v_add_f32_dpp v72, v72, v72 quad_perm:[2,3,0,1] row_mask:0xf bank_mask:0xf
    s_nop 1
    v_add_f32_dpp v72, v72, v72 row_half_mirror row_mask:0xf bank_mask:0xf
    s_nop 1
    s_add_u32 m0, s7, 24576
    s_add_u32 s40, s41, 0
    buffer_load_dwordx4 v5, s[12:15], s40 offen lds
    v_add_f32_dpp v72, v72, v72 row_mirror row_mask:0xf bank_mask:0xf
    s_nop 1
    v_cvt_pk_bf16_f32 v72, v72, v72
    s_sub_u32 s64, 34815, s68
    s_add_u32 m0, s7, 28672
    s_add_u32 s40, s41, 196608
    buffer_load_dwordx4 v5, s[12:15], s40 offen lds
    v_lshlrev_b32 v72, 16, v72
    v_ashrrev_i32 v73, 31, v72
    v_sub_u32 v77, s64, v75
    v_or_b32 v73, 0x80000000, v73
    s_add_u32 m0, s7, 32768
    s_add_u32 s40, s41, 2048
    buffer_load_dwordx4 v5, s[12:15], s40 offen lds
    s_lshl_b32 s64, s6, 3
    v_xor_b32 v73, v72, v73
    v_lshl_add_u32 v75, v75, 2, s64
    v_and_b32 v73, 0xffff0000, v73
    s_add_u32 m0, s7, 36864
    s_add_u32 s40, s41, 198656
    buffer_load_dwordx4 v5, s[12:15], s40 offen lds
    v_or_b32 v73, v77, v73
    v_mul_f32 v72, s72, v72
    v_exp_f32 v72, -v72
    s_nop 0
    s_add_u32 m0, s7, 40960
    s_add_u32 s40, s41, 4096
    buffer_load_dwordx4 v5, s[12:15], s40 offen lds
    v_add_f32 v72, 1.0, v72
    v_rcp_f32 v72, v72
    s_nop 0
    v_cvt_pk_bf16_f32 v72, v72, v72
    s_add_u32 m0, s7, 45056
    s_add_u32 s40, s41, 200704
    buffer_load_dwordx4 v5, s[12:15], s40 offen lds
    v_lshlrev_b32 v72, 16, v72
    s_mov_b32 exec_lo, 0
    s_mov_b32 exec_hi, 0x10001
    ds_write_b32 v75, v73 offset:4224
    s_mov_b32 exec_lo, 0x10001
    s_mov_b32 exec_hi, 0
    buffer_store_dword v72, v76, s[16:19], 0 offen sc0 sc1
    s_mov_b64 exec, -1
    s_mov_b32 exec_lo, 0x3fff3fff
    s_mov_b32 exec_hi, 0x3fff3fff
    s_mov_b32 s64, 0
    buffer_load_dwordx4 v[96:99], v11, s[32:35], s64 offen nt
    s_mov_b32 s64, 0
    buffer_load_dwordx4 v[128:131], v11, s[36:39], s64 offen nt
    s_mov_b32 s64, 7168
    buffer_load_dwordx4 v[100:103], v11, s[32:35], s64 offen nt
    s_mov_b32 s64, 7168
    buffer_load_dwordx4 v[132:135], v11, s[36:39], s64 offen nt
    s_mov_b32 s64, 14336
    buffer_load_dwordx4 v[104:107], v11, s[32:35], s64 offen nt
    s_mov_b64 exec, -1
    s_waitcnt vmcnt(16)
    s_waitcnt lgkmcnt(0)
    s_barrier
    s_add_u32 s41, s74, 7
    s_and_b32 s41, s41, 15
    s_lshl_b32 s42, s41, 7
    s_mul_i32 s41, s41, 393216
    s_add_u32 m0, s7, 49152
    s_add_u32 s40, s42, 0
    buffer_load_dwordx4 v4, s[8:11], s40 offen lds
    s_add_u32 m0, s7, 53248
    s_add_u32 s40, s42, 65536
    buffer_load_dwordx4 v4, s[8:11], s40 offen lds
    s_add_u32 m0, s7, 57344
    s_add_u32 s40, s42, 131072
    buffer_load_dwordx4 v4, s[8:11], s40 offen lds
    s_add_u32 m0, s7, 61440
    s_add_u32 s40, s42, 196608
    buffer_load_dwordx4 v4, s[8:11], s40 offen lds
    s_add_u32 m0, s7, 65536
    s_add_u32 s40, s41, 0
    buffer_load_dwordx4 v5, s[12:15], s40 offen lds
    s_add_u32 m0, s7, 69632
    s_add_u32 s40, s41, 196608
    buffer_load_dwordx4 v5, s[12:15], s40 offen lds
    s_add_u32 m0, s7, 73728
    s_add_u32 s40, s41, 2048
    buffer_load_dwordx4 v5, s[12:15], s40 offen lds
    s_add_u32 m0, s7, 77824
    s_add_u32 s40, s41, 198656
    buffer_load_dwordx4 v5, s[12:15], s40 offen lds
    s_add_u32 m0, s7, 81920
    s_add_u32 s40, s41, 4096
    buffer_load_dwordx4 v5, s[12:15], s40 offen lds
    s_add_u32 m0, s7, 86016
    s_add_u32 s40, s41, 200704
    buffer_load_dwordx4 v5, s[12:15], s40 offen lds
    s_waitcnt vmcnt(16)
    s_barrier
    s_add_u32 s41, s74, 8
    s_and_b32 s41, s41, 15
    s_lshl_b32 s42, s41, 7
    s_mul_i32 s41, s41, 393216
    s_add_u32 m0, s7, 90112
    s_add_u32 s40, s42, 0
    buffer_load_dwordx4 v4, s[8:11], s40 offen lds
    s_add_u32 m0, s7, 94208
    s_add_u32 s40, s42, 65536
    buffer_load_dwordx4 v4, s[8:11], s40 offen lds
    s_add_u32 m0, s7, 98304
    s_add_u32 s40, s42, 131072
    buffer_load_dwordx4 v4, s[8:11], s40 offen lds
    s_add_u32 m0, s7, 102400
    s_add_u32 s40, s42, 196608
    buffer_load_dwordx4 v4, s[8:11], s40 offen lds
    s_add_u32 m0, s7, 106496
    s_add_u32 s40, s41, 0
    buffer_load_dwordx4 v5, s[12:15], s40 offen lds
    s_add_u32 m0, s7, 110592
    s_add_u32 s40, s41, 196608
    buffer_load_dwordx4 v5, s[12:15], s40 offen lds
    s_add_u32 m0, s7, 114688
    s_add_u32 s40, s41, 2048
    buffer_load_dwordx4 v5, s[12:15], s40 offen lds
    s_add_u32 m0, s7, 118784
    s_add_u32 s40, s41, 198656
    buffer_load_dwordx4 v5, s[12:15], s40 offen lds
    s_add_u32 m0, s7, 122880
    s_add_u32 s40, s41, 4096
    buffer_load_dwordx4 v5, s[12:15], s40 offen lds
    s_add_u32 m0, s7, 126976
    s_add_u32 s40, s41, 200704
    buffer_load_dwordx4 v5, s[12:15], s40 offen lds
    s_waitcnt vmcnt(10)
    s_barrier
    s_add_u32 s41, s74, 9
    s_and_b32 s41, s41, 15
    s_lshl_b32 s42, s41, 7
    s_mul_i32 s41, s41, 393216
    s_add_u32 m0, s7, 8192
    s_add_u32 s40, s42, 0
    buffer_load_dwordx4 v4, s[8:11], s40 offen lds
    s_add_u32 m0, s7, 12288
    s_add_u32 s40, s42, 65536
    buffer_load_dwordx4 v4, s[8:11], s40 offen lds
    s_add_u32 m0, s7, 16384
    s_add_u32 s40, s42, 131072
    buffer_load_dwordx4 v4, s[8:11], s40 offen lds
    s_add_u32 m0, s7, 20480
    s_add_u32 s40, s42, 196608
    buffer_load_dwordx4 v4, s[8:11], s40 offen lds
    s_add_u32 m0, s7, 24576
    s_add_u32 s40, s41, 0
    buffer_load_dwordx4 v5, s[12:15], s40 offen lds
    s_add_u32 m0, s7, 28672
    s_add_u32 s40, s41, 196608
    buffer_load_dwordx4 v5, s[12:15], s40 offen lds
    s_add_u32 m0, s7, 32768
    s_add_u32 s40, s41, 2048
    buffer_load_dwordx4 v5, s[12:15], s40 offen lds
    s_add_u32 m0, s7, 36864
    s_add_u32 s40, s41, 198656
    buffer_load_dwordx4 v5, s[12:15], s40 offen lds
    s_add_u32 m0, s7, 40960
    s_add_u32 s40, s41, 4096
    buffer_load_dwordx4 v5, s[12:15], s40 offen lds
    s_add_u32 m0, s7, 45056
    s_add_u32 s40, s41, 200704
    buffer_load_dwordx4 v5, s[12:15], s40 offen lds
    s_cmp_lg_u32 s6, 0
    s_cbranch_scc1 H_nk
    v_mov_b32 v3, 4224
    ds_read_b128 v[72:75], v3
    ds_read_b128 v[24:27], v3 offset:16
    s_mov_b32 s65, 0
H_nspin:
    v_readfirstlane_b32 s71, v78
    s_cmp_eq_u32 s71, 0
    s_cbranch_scc1 H_nre
H_nok:
    s_lshl_b32 s64, s2, 3
    s_add_u32 s64, s64, 6717440
    v_mov_b32 v3, s64
    s_waitcnt lgkmcnt(0)
    v_max3_u32 v72, v72, v73, v74
    v_max3_u32 v24, v24, v25, v26
    v_max3_u32 v72, v72, v75, v27
    v_max_u32 v72, v72, v24
    v_xor_b32 v73, s71, v72
    s_mov_b64 exec, 1
    buffer_store_dwordx2 v[72:73], v3, s[16:19], 0 offen sc0 sc1
    s_mov_b64 exec, -1
H_nk:
    s_mov_b32 exec_lo, 0x3fff3fff
    s_mov_b32 exec_hi, 0x3fff3fff
    s_mov_b32 s64, 14336
    buffer_load_dwordx4 v[136:139], v11, s[36:39], s64 offen nt
    s_mov_b32 s64, 21504
    buffer_load_dwordx4 v[108:111], v11, s[32:35], s64 offen nt
    s_mov_b32 s64, 21504
    buffer_load_dwordx4 v[140:143], v11, s[36:39], s64 offen nt
    s_mov_b32 s64, 28672
    buffer_load_dwordx4 v[112:115], v11, s[32:35], s64 offen nt
    s_mov_b32 s64, 28672
    buffer_load_dwordx4 v[144:147], v11, s[36:39], s64 offen nt
    s_mov_b64 exec, -1
    s_waitcnt vmcnt(15)
    s_barrier
    s_add_u32 s41, s74, 10
    s_and_b32 s41, s41, 15
    s_lshl_b32 s42, s41, 7
    s_mul_i32 s41, s41, 393216
    s_add_u32 m0, s7, 49152
    s_add_u32 s40, s42, 0
    buffer_load_dwordx4 v4, s[8:11], s40 offen lds
    s_add_u32 m0, s7, 53248
    s_add_u32 s40, s42, 65536
    buffer_load_dwordx4 v4, s[8:11], s40 offen lds
    s_add_u32 m0, s7, 57344
    s_add_u32 s40, s42, 131072
    buffer_load_dwordx4 v4, s[8:11], s40 offen lds
    s_add_u32 m0, s7, 61440
    s_add_u32 s40, s42, 196608
    buffer_load_dwordx4 v4, s[8:11], s40 offen lds
    s_add_u32 m0, s7, 65536
    s_add_u32 s40, s41, 0
    buffer_load_dwordx4 v5, s[12:15], s40 offen lds
    s_add_u32 m0, s7, 69632
    s_add_u32 s40, s41, 196608
    buffer_load_dwordx4 v5, s[12:15], s40 offen lds
    s_add_u32 m0, s7, 73728
    s_add_u32 s40, s41, 2048
    buffer_load_dwordx4 v5, s[12:15], s40 offen lds
    s_add_u32 m0, s7, 77824
    s_add_u32 s40, s41, 198656
    buffer_load_dwordx4 v5, s[12:15], s40 offen lds
    s_add_u32 m0, s7, 81920
    s_add_u32 s40, s41, 4096
    buffer_load_dwordx4 v5, s[12:15], s40 offen lds
    s_add_u32 m0, s7, 86016
    s_add_u32 s40, s41, 200704
    buffer_load_dwordx4 v5, s[12:15], s40 offen lds
    s_waitcnt vmcnt(15)
    s_barrier
    s_add_u32 s41, s74, 11
    s_and_b32 s41, s41, 15
    s_lshl_b32 s42, s41, 7
    s_mul_i32 s41, s41, 393216
    s_add_u32 m0, s7, 90112
    s_add_u32 s40, s42, 0
    buffer_load_dwordx4 v4, s[8:11], s40 offen lds
    s_add_u32 m0, s7, 94208
    s_add_u32 s40, s42, 65536
    buffer_load_dwordx4 v4, s[8:11], s40 offen lds
    s_add_u32 m0, s7, 98304
    s_add_u32 s40, s42, 131072
    buffer_load_dwordx4 v4, s[8:11], s40 offen lds
    s_add_u32 m0, s7, 102400
    s_add_u32 s40, s42, 196608
    buffer_load_dwordx4 v4, s[8:11], s40 offen lds
    s_add_u32 m0, s7, 106496
    s_add_u32 s40, s41, 0
    buffer_load_dwordx4 v5, s[12:15], s40 offen lds
    s_add_u32 m0, s7, 110592
    s_add_u32 s40, s41, 196608
    buffer_load_dwordx4 v5, s[12:15], s40 offen lds
    s_add_u32 m0, s7, 114688
    s_add_u32 s40, s41, 2048
    buffer_load_dwordx4 v5, s[12:15], s40 offen lds
    s_add_u32 m0, s7, 118784
    s_add_u32 s40, s41, 198656
    buffer_load_dwordx4 v5, s[12:15], s40 offen lds
    s_add_u32 m0, s7, 122880
    s_add_u32 s40, s41, 4096
    buffer_load_dwordx4 v5, s[12:15], s40 offen lds
    s_add_u32 m0, s7, 126976
    s_add_u32 s40, s41, 200704
    buffer_load_dwordx4 v5, s[12:15], s40 offen lds
    s_waitcnt vmcnt(10)
    s_barrier
    s_add_u32 s41, s74, 12
    s_and_b32 s41, s41, 15
    s_lshl_b32 s42, s41, 7
    s_mul_i32 s41, s41, 393216
    s_add_u32 m0, s7, 8192
    s_add_u32 s40, s42, 0
    buffer_load_dwordx4 v4, s[8:11], s40 offen lds
    s_add_u32 m0, s7, 12288
    s_add_u32 s40, s42, 65536
    buffer_load_dwordx4 v4, s[8:11], s40 offen lds
    s_add_u32 m0, s7, 16384
    s_add_u32 s40, s42, 131072
    buffer_load_dwordx4 v4, s[8:11], s40 offen lds
    s_add_u32 m0, s7, 20480
    s_add_u32 s40, s42, 196608
    buffer_load_dwordx4 v4, s[8:11], s40 offen lds
    s_add_u32 m0, s7, 24576
    s_add_u32 s40, s41, 0
    buffer_load_dwordx4 v5, s[12:15], s40 offen lds
    s_add_u32 m0, s7, 28672
    s_add_u32 s40, s41, 196608
    buffer_load_dwordx4 v5, s[12:15], s40 offen lds
    s_add_u32 m0, s7, 32768
    s_add_u32 s40, s41, 2048
    buffer_load_dwordx4 v5, s[12:15], s40 offen lds
    s_add_u32 m0, s7, 36864
    s_add_u32 s40, s41, 198656
    buffer_load_dwordx4 v5, s[12:15], s40 offen lds
    s_add_u32 m0, s7, 40960
    s_add_u32 s40, s41, 4096
    buffer_load_dwordx4 v5, s[12:15], s40 offen lds
    s_add_u32 m0, s7, 45056
    s_add_u32 s40, s41, 200704
    buffer_load_dwordx4 v5, s[12:15], s40 offen lds
    s_mov_b32 exec_lo, 0x3fff3fff
    s_mov_b32 exec_hi, 0x3fff3fff
    s_mov_b32 s64, 35840
    buffer_load_dwordx4 v[116:119], v11, s[32:35], s64 offen nt
    s_mov_b32 s64, 35840
    buffer_load_dwordx4 v[148:151], v11, s[36:39], s64 offen nt
    s_mov_b32 s64, 43008
    buffer_load_dwordx4 v[120:123], v11, s[32:35], s64 offen nt
    s_mov_b32 s64, 43008
    buffer_load_dwordx4 v[152:155], v11, s[36:39], s64 offen nt
    s_mov_b32 s64, 50176
    buffer_load_dwordx4 v[124:127], v11, s[32:35], s64 offen nt
    s_mov_b32 s64, 50176
    buffer_load_dwordx4 v[156:159], v11, s[36:39], s64 offen nt
    s_mov_b64 exec, -1
    s_waitcnt vmcnt(16)
    s_barrier
    s_cmp_lg_u32 s6, 0
    s_cbranch_scc1 H_np
    s_mov_b32 s64, 6717440
    buffer_load_dwordx4 v[24:27], v6, s[16:19], s64 offen offset:0 sc1
    buffer_load_dwordx4 v[28:31], v6, s[16:19], s64 offen offset:1024 sc1
H_np:
    s_add_u32 s41, s74, 13
    s_and_b32 s41, s41, 15
    s_lshl_b32 s42, s41, 7
    s_mul_i32 s41, s41, 393216
    s_add_u32 m0, s7, 49152
    s_add_u32 s40, s42, 0
    buffer_load_dwordx4 v4, s[8:11], s40 offen lds
    s_add_u32 m0, s7, 53248
    s_add_u32 s40, s42, 65536
    buffer_load_dwordx4 v4, s[8:11], s40 offen lds
    s_add_u32 m0, s7, 57344
    s_add_u32 s40, s42, 131072
    buffer_load_dwordx4 v4, s[8:11], s40 offen lds
    s_add_u32 m0, s7, 61440
    s_add_u32 s40, s42, 196608
    buffer_load_dwordx4 v4, s[8:11], s40 offen lds
    s_add_u32 m0, s7, 65536
    s_add_u32 s40, s41, 0
    buffer_load_dwordx4 v5, s[12:15], s40 offen lds
    s_add_u32 m0, s7, 69632
    s_add_u32 s40, s41, 196608
    buffer_load_dwordx4 v5, s[12:15], s40 offen lds
    s_add_u32 m0, s7, 73728
    s_add_u32 s40, s41, 2048
    buffer_load_dwordx4 v5, s[12:15], s40 offen lds
    s_add_u32 m0, s7, 77824
    s_add_u32 s40, s41, 198656
    buffer_load_dwordx4 v5, s[12:15], s40 offen lds
    s_add_u32 m0, s7, 81920
    s_add_u32 s40, s41, 4096
    buffer_load_dwordx4 v5, s[12:15], s40 offen lds
    s_add_u32 m0, s7, 86016
    s_add_u32 s40, s41, 200704
    buffer_load_dwordx4 v5, s[12:15], s40 offen lds
    s_waitcnt vmcnt(16)
    s_barrier
    s_cmp_lg_u32 s6, 0
    s_cbranch_scc1 H_nq
    s_waitcnt vmcnt(10)
    s_mov_b32 s65, 0
H_spin:
    v_xor_b32 v25, v24, v25
    v_xor_b32 v27, v26, v27
    v_xor_b32 v29, v28, v29
    v_xor_b32 v31, v30, v31
    v_xor_b32 v3, s71, v25
    v_xor_b32 v7, s71, v27
    v_xor_b32 v25, s71, v29
    v_xor_b32 v27, s71, v31
    v_or3_b32 v3, v3, v7, v25
    v_or_b32 v3, v3, v27
    v_cmp_ne_u32 vcc, 0, v3
    s_cbranch_vccnz H_retry
H_nq:
    s_add_u32 s41, s74, 14
    s_and_b32 s41, s41, 15
    s_lshl_b32 s42, s41, 7
    s_mul_i32 s41, s41, 393216
    s_add_u32 m0, s7, 90112
    s_add_u32 s40, s42, 0
    buffer_load_dwordx4 v4, s[8:11], s40 offen lds
    v_max_u32 v3, v24, v26
    v_max3_u32 v3, v3, v28, v30
    s_nop 1
    v_max_u32_dpp v3, v3, v3 quad_perm:[1,0,3,2] row_mask:0xf bank_mask:0xf
    s_add_u32 m0, s7, 94208
    s_add_u32 s40, s42, 65536
    buffer_load_dwordx4 v4, s[8:11], s40 offen lds
    s_nop 1
    v_max_u32_dpp v3, v3, v3 quad_perm:[2,3,0,1] row_mask:0xf bank_mask:0xf
    s_nop 1
    v_max_u32_dpp v3, v3, v3 row_half_mirror row_mask:0xf bank_mask:0xf
    s_add_u32 m0, s7, 98304
    s_add_u32 s40, s42, 131072
    buffer_load_dwordx4 v4, s[8:11], s40 offen lds
    s_nop 1
    v_max_u32_dpp v3, v3, v3 row_mirror row_mask:0xf bank_mask:0xf
    s_nop 1
    v_mov_b32 v7, v3
    s_add_u32 m0, s7, 102400
    s_add_u32 s40, s42, 196608
    buffer_load_dwordx4 v4, s[8:11], s40 offen lds
    s_nop 1
    v_permlane16_swap_b32 v3, v7
    v_max_u32 v3, v3, v7
    v_mov_b32 v7, v3
    s_add_u32 m0, s7, 106496
    s_add_u32 s40, s41, 0
    buffer_load_dwordx4 v5, s[12:15], s40 offen lds
    s_nop 1
    v_permlane32_swap_b32 v3, v7
    v_max_u32 v3, v3, v7
    v_mov_b32 v7, 4256
    s_add_u32 m0, s7, 110592
    s_add_u32 s40, s41, 196608
    buffer_load_dwordx4 v5, s[12:15], s40 offen lds
    s_add_u32 m0, s7, 114688
    s_add_u32 s40, s41, 2048
    buffer_load_dwordx4 v5, s[12:15], s40 offen lds
    s_add_u32 m0, s7, 118784
    s_add_u32 s40, s41, 198656
    buffer_load_dwordx4 v5, s[12:15], s40 offen lds
    s_add_u32 m0, s7, 122880
    s_add_u32 s40, s41, 4096
    buffer_load_dwordx4 v5, s[12:15], s40 offen lds
    s_add_u32 m0, s7, 126976
    s_add_u32 s40, s41, 200704
    buffer_load_dwordx4 v5, s[12:15], s40 offen lds
    s_cmp_lg_u32 s6, 0
    s_cbranch_scc1 H_nw
    ds_write_b32 v7, v3
H_nw:
    s_waitcnt vmcnt(10)
    s_waitcnt lgkmcnt(0)
    s_barrier
    v_mov_b32 v7, 4256
    ds_read_b32 v3, v7
    s_lshl_b32 s65, s69, 6
    v_lshl_add_u32 v7, v8, 4, s65
    s_waitcnt lgkmcnt(0)
    v_readfirstlane_b32 s75, v3
    s_nop 3
    s_and_b32 s64, s75, 0x7ff
    s_sub_u32 s64, 2047, s64
    s_lshl_b32 s64, s64, 11
    buffer_load_dwordx4 v[88:91], v7, s[8:11], s64 offen
    s_add_u32 s41, s74, 15
    s_and_b32 s41, s41, 15
    s_lshl_b32 s42, s41, 7
    s_mul_i32 s41, s41, 393216
    s_add_u32 m0, s7, 8192
    s_add_u32 s40, s42, 0
    buffer_load_dwordx4 v4, s[8:11], s40 offen lds
    s_add_u32 m0, s7, 12288
    s_add_u32 s40, s42, 65536
    buffer_load_dwordx4 v4, s[8:11], s40 offen lds
    s_add_u32 m0, s7, 16384
    s_add_u32 s40, s42, 131072
    buffer_load_dwordx4 v4, s[8:11], s40 offen lds
    s_add_u32 m0, s7, 20480
    s_add_u32 s40, s42, 196608
    buffer_load_dwordx4 v4, s[8:11], s40 offen lds
    s_add_u32 m0, s7, 24576
    s_add_u32 s40, s41, 0
    buffer_load_dwordx4 v5, s[12:15], s40 offen lds
    s_add_u32 m0, s7, 28672
    s_add_u32 s40, s41, 196608
    buffer_load_dwordx4 v5, s[12:15], s40 offen lds
    s_add_u32 m0, s7, 32768
    s_add_u32 s40, s41, 2048
    buffer_load_dwordx4 v5, s[12:15], s40 offen lds
    s_add_u32 m0, s7, 36864
    s_add_u32 s40, s41, 198656
    buffer_load_dwordx4 v5, s[12:15], s40 offen lds
    s_add_u32 m0, s7, 40960
    s_add_u32 s40, s41, 4096
    buffer_load_dwordx4 v5, s[12:15], s40 offen lds
    s_add_u32 m0, s7, 45056
    s_add_u32 s40, s41, 200704
    buffer_load_dwordx4 v5, s[12:15], s40 offen lds
    s_mov_b32 s24, s54
    s_mov_b32 s25, s55
    s_mov_b32 s26, 0x700000
    s_mov_b32 s27, 0x00020000
    s_lshr_b32 s64, s2, 2
    s_mul_i32 s64, s64, 114688
    s_and_b32 s65, s2, 3
    s_lshl_b32 s65, s65, 9
    s_add_u32 s64, s64, s65
    s_lshl_b32 s65, s6, 7
    s_add_u32 s64, s64, s65
    v_lshrrev_b32 v7, 3, v2
    v_lshlrev_b32 v7, 11, v7
    v_and_b32 v9, 7, v2
    v_lshl_add_u32 v7, v9, 4, v7
    v_add_u32 v21, s64, v7
    s_mov_b32 s64, 0
    buffer_load_dwordx4 v[192:195], v21, s[24:27], s64 offen nt
    s_mov_b32 s64, 16384
    buffer_load_dwordx4 v[196:199], v21, s[24:27], s64 offen nt
    s_mov_b32 s64, 32768
    buffer_load_dwordx4 v[200:203], v21, s[24:27], s64 offen nt
    s_mov_b32 s64, 49152
    buffer_load_dwordx4 v[204:207], v21, s[24:27], s64 offen nt
    s_mov_b32 s64, 65536
    buffer_load_dwordx4 v[208:211], v21, s[24:27], s64 offen nt
    s_mov_b32 s64, 81920
    buffer_load_dwordx4 v[212:215], v21, s[24:27], s64 offen nt
    s_mov_b32 s64, 98304
    buffer_load_dwordx4 v[216:219], v21, s[24:27], s64 offen nt
    s_waitcnt vmcnt(18)
    s_barrier
    s_waitcnt vmcnt(17)
    s_and_b32 s64, s2, 7
    s_lshr_b32 s65, s2, 3
    s_and_b32 s4, s64, 3
    s_lshl_b32 s4, s4, 2
    s_and_b32 s66, s65, 3
    s_add_u32 s4, s4, s66
    s_lshr_b32 s5, s64, 2
    s_lshl_b32 s5, s5, 3
    s_lshr_b32 s74, s65, 2
    s_add_u32 s5, s5, s74
    s_mov_b32 s12, s44
    s_mov_b32 s13, s45
    s_mov_b32 s14, 0x200000
    s_mov_b32 s15, 0x00020000
    v_lshrrev_b32 v7, 3, v2
    s_lshl_b32 s64, s6, 3
    v_add_u32 v7, s64, v7
    v_lshlrev_b32 v7, 11, v7
    v_lshrrev_b32 v9, 4, v2
    v_lshlrev_b32 v9, 1, v9
    v_and_b32 v10, 7, v2
    v_xor_b32 v9, v9, v10
    v_lshl_add_u32 v7, v9, 4, v7
    s_lshl_b32 s64, s5, 7
    v_add_u32 v10, s64, v7
    s_add_u32 m0, s7, 131072
    s_mov_b32 s40, 0
    buffer_load_dwordx4 v10, s[12:15], s40 offen lds
    v_and_b32 v48, 15, v2
    v_and_b32 v49, 1, v2
    v_lshlrev_b32 v49, 4, v49
    v_mov_b32 v50, 0xffff
    v_lshlrev_b32 v49, v49, v50
    v_lshrrev_b32 v48, 1, v48
    v_cmp_eq_u32 vcc, 0, v48
    s_nop 1
    s_add_u32 m0, s7, 135168
    s_mov_b32 s40, 65536
    buffer_load_dwordx4 v10, s[12:15], s40 offen lds
    v_cndmask_b32 v40, 0, v49, vcc
    v_cmp_eq_u32 vcc, 1, v48
    s_nop 1
    v_cndmask_b32 v41, 0, v49, vcc
    v_cmp_eq_u32 vcc, 2, v48
    s_nop 1
    v_cndmask_b32 v42, 0, v49, vcc
    v_cmp_eq_u32 vcc, 3, v48
    s_add_u32 m0, s7, 147456
    s_mov_b32 s40, 1048576
    buffer_load_dwordx4 v10, s[12:15], s40 offen lds
    s_nop 1
    v_cndmask_b32 v43, 0, v49, vcc
    s_mov_b32 s64, 0x01000100
    s_mov_b32 s65, 0x03020302
    v_perm_b32 v48, v88, v88, s64
    v_and_b32 v44, v48, v40
    v_and_b32 v45, v48, v41
    v_and_b32 v46, v48, v42
    s_add_u32 m0, s7, 151552
    s_mov_b32 s40, 1114112
    buffer_load_dwordx4 v10, s[12:15], s40 offen lds
    v_and_b32 v47, v48, v43
    s_nop 1
    v_mfma_f32_16x16x32_bf16 v[32:35], v[44:47], v[96:99], 0
    v_mfma_f32_16x16x32_bf16 v[36:39], v[44:47], v[128:131], 0
    v_perm_b32 v48, v88, v88, s65
    v_and_b32 v52, v48, v40
    v_and_b32 v53, v48, v41
    v_and_b32 v54, v48, v42
    s_add_u32 m0, s7, 139264
    s_mov_b32 s40, 131072
    buffer_load_dwordx4 v10, s[12:15], s40 offen lds
    v_and_b32 v55, v48, v43
    s_nop 1
    v_mfma_f32_16x16x32_bf16 v[32:35], v[52:55], v[100:103], v[32:35]
    v_mfma_f32_16x16x32_bf16 v[36:39], v[52:55], v[132:135], v[36:39]
    v_perm_b32 v48, v89, v89, s64
    v_and_b32 v44, v48, v40
    v_and_b32 v45, v48, v41
    v_and_b32 v46, v48, v42
    s_add_u32 m0, s7, 143360
    s_mov_b32 s40, 196608
    buffer_load_dwordx4 v10, s[12:15], s40 offen lds
    v_and_b32 v47, v48, v43
    s_nop 1
    v_mfma_f32_16x16x32_bf16 v[32:35], v[44:47], v[104:107], v[32:35]
    v_mfma_f32_16x16x32_bf16 v[36:39], v[44:47], v[136:139], v[36:39]
    v_perm_b32 v48, v89, v89, s65
    v_and_b32 v52, v48, v40
    v_and_b32 v53, v48, v41
    v_and_b32 v54, v48, v42
    s_add_u32 m0, s7, 155648
    s_mov_b32 s40, 1179648
    buffer_load_dwordx4 v10, s[12:15], s40 offen lds
    v_and_b32 v55, v48, v43
    s_nop 1
    v_mfma_f32_16x16x32_bf16 v[32:35], v[52:55], v[108:111], v[32:35]
    v_mfma_f32_16x16x32_bf16 v[36:39], v[52:55], v[140:143], v[36:39]
    v_perm_b32 v48, v90, v90, s64
    v_and_b32 v44, v48, v40
    v_and_b32 v45, v48, v41
    v_and_b32 v46, v48, v42
    s_add_u32 m0, s7, 159744
    s_mov_b32 s40, 1245184
    buffer_load_dwordx4 v10, s[12:15], s40 offen lds
    v_and_b32 v47, v48, v43
    s_nop 1
    v_mfma_f32_16x16x32_bf16 v[32:35], v[44:47], v[112:115], v[32:35]
    v_mfma_f32_16x16x32_bf16 v[36:39], v[44:47], v[144:147], v[36:39]
    v_perm_b32 v48, v90, v90, s65
    v_and_b32 v52, v48, v40
    v_and_b32 v53, v48, v41
    v_and_b32 v54, v48, v42
    s_add_u32 m0, s7, 73728
    s_mov_b32 s40, 262144
    buffer_load_dwordx4 v10, s[12:15], s40 offen lds
    v_and_b32 v55, v48, v43
    s_nop 1
    v_mfma_f32_16x16x32_bf16 v[32:35], v[52:55], v[116:119], v[32:35]
    v_mfma_f32_16x16x32_bf16 v[36:39], v[52:55], v[148:151], v[36:39]
    v_perm_b32 v48, v91, v91, s64
    v_and_b32 v44, v48, v40
    v_and_b32 v45, v48, v41
    v_and_b32 v46, v48, v42
    s_add_u32 m0, s7, 77824
    s_mov_b32 s40, 327680
    buffer_load_dwordx4 v10, s[12:15], s40 offen lds
    v_and_b32 v47, v48, v43
    s_nop 1
    v_mfma_f32_16x16x32_bf16 v[32:35], v[44:47], v[120:123], v[32:35]
    v_mfma_f32_16x16x32_bf16 v[36:39], v[44:47], v[152:155], v[36:39]
    v_perm_b32 v48, v91, v91, s65
    v_and_b32 v52, v48, v40
    v_and_b32 v53, v48, v41
    v_and_b32 v54, v48, v42
    s_add_u32 m0, s7, 81920
    s_mov_b32 s40, 1310720
    buffer_load_dwordx4 v10, s[12:15], s40 offen lds
    v_and_b32 v55, v48, v43
    s_nop 1
    v_mfma_f32_16x16x32_bf16 v[32:35], v[52:55], v[124:127], v[32:35]
    v_mfma_f32_16x16x32_bf16 v[36:39], v[52:55], v[156:159], v[36:39]
    s_add_u32 m0, s7, 86016
    s_mov_b32 s40, 1376256
    buffer_load_dwordx4 v10, s[12:15], s40 offen lds
    s_nop 7
    v_permlane32_swap_b32 v32, v36
    v_permlane32_swap_b32 v33, v37
    v_permlane32_swap_b32 v34, v38
    v_permlane32_swap_b32 v35, v39
    s_mov_b32 exec_lo, 0x3fff3fff
    s_mov_b32 exec_hi, 0x3fff3fff
    buffer_store_dwordx4 v[32:35], v12, s[16:19], 0 offen sc0 sc1
    s_mov_b64 exec, -1
    s_waitcnt vmcnt(20)
    s_barrier
    s_add_u32 m0, s7, 114688
    s_mov_b32 s40, 393216
    buffer_load_dwordx4 v10, s[12:15], s40 offen lds
    s_add_u32 m0, s7, 118784
    s_mov_b32 s40, 458752
    buffer_load_dwordx4 v10, s[12:15], s40 offen lds
    s_add_u32 m0, s7, 122880
    s_mov_b32 s40, 1441792
    buffer_load_dwordx4 v10, s[12:15], s40 offen lds
    s_add_u32 m0, s7, 126976
    s_mov_b32 s40, 1507328
    buffer_load_dwordx4 v10, s[12:15], s40 offen lds
    s_barrier
    s_and_b32 s64, s3, 3
    s_lshl_b32 s64, s64, 1
    s_lshr_b32 s65, s3, 2
    s_add_u32 s64, s64, s65
    s_lshl_b32 s64, s64, 4
    s_lshl_b32 s65, s4, 7
    s_add_u32 s64, s64, s65
    v_and_b32 v230, 15, v2
    v_add_u32 v230, s64, v230
    v_bfe_u32 v3, v2, 4, 1
    v_lshlrev_b32 v229, 5, v3
    v_lshrrev_b32 v3, 5, v2
    v_lshl_add_u32 v229, v3, 4, v229
    v_lshl_add_u32 v231, v230, 11, v229
    s_lshl_b32 s64, s5, 7
    v_add_u32 v231, s64, v231
    v_lshlrev_b32 v3, 2, v230
    v_add_u32 v3, 6709248, v3
    buffer_load_dwordx4 v[220:223], v231, s[8:11], 0 offen
    buffer_load_dwordx4 v[224:227], v231, s[8:11], 0 offen offset:64
    buffer_load_dword v228, v3, s[16:19], 0 offen sc1
    s_add_u32 m0, s7, 40960
    s_mov_b32 s40, 524288
    buffer_load_dwordx4 v10, s[12:15], s40 offen lds
    s_add_u32 m0, s7, 45056
    s_mov_b32 s40, 589824
    buffer_load_dwordx4 v10, s[12:15], s40 offen lds
    s_add_u32 m0, s7, 49152
    s_mov_b32 s40, 1572864
    buffer_load_dwordx4 v10, s[12:15], s40 offen lds
    s_add_u32 m0, s7, 53248
    s_mov_b32 s40, 1638400
    buffer_load_dwordx4 v10, s[12:15], s40 offen lds
    s_add_u32 m0, s7, 8192
    s_mov_b32 s40, 655360
    buffer_load_dwordx4 v10, s[12:15], s40 offen lds
    s_add_u32 m0, s7, 12288
    s_mov_b32 s40, 720896
    buffer_load_dwordx4 v10, s[12:15], s40 offen lds
    s_add_u32 m0, s7, 57344
    s_mov_b32 s40, 1703936
    buffer_load_dwordx4 v10, s[12:15], s40 offen lds
    s_add_u32 m0, s7, 61440
    s_mov_b32 s40, 1769472
    buffer_load_dwordx4 v10, s[12:15], s40 offen lds
    s_add_u32 m0, s7, 16384
    s_mov_b32 s40, 786432
    buffer_load_dwordx4 v10, s[12:15], s40 offen lds
    s_add_u32 m0, s7, 20480
    s_mov_b32 s40, 851968
    buffer_load_dwordx4 v10, s[12:15], s40 offen lds
    s_add_u32 m0, s7, 65536
    s_mov_b32 s40, 1835008
    buffer_load_dwordx4 v10, s[12:15], s40 offen lds
    s_add_u32 m0, s7, 69632
    s_mov_b32 s40, 1900544
    buffer_load_dwordx4 v10, s[12:15], s40 offen lds
    s_add_u32 m0, s7, 98304
    s_mov_b32 s40, 917504
    buffer_load_dwordx4 v10, s[12:15], s40 offen lds
    s_add_u32 m0, s7, 102400
    s_mov_b32 s40, 983040
    buffer_load_dwordx4 v10, s[12:15], s40 offen lds
    s_add_u32 m0, s7, 90112
    s_mov_b32 s40, 1966080
    buffer_load_dwordx4 v10, s[12:15], s40 offen lds
    s_add_u32 m0, s7, 94208
    s_mov_b32 s40, 2031616
    buffer_load_dwordx4 v10, s[12:15], s40 offen lds
    s_mov_b64 exec, 1
    v_mov_b32 v20, 0
    buffer_atomic_or v20, v23, s[16:19], 0 offen sc0
    s_mov_b64 exec, -1
    v_add_u32 v17, s70, v6
    v_lshrrev_b32 v18, 2, v2
    v_mul_u32_u24 v18, 1152, v18
    v_and_b32 v19, 3, v2
    v_lshl_add_u32 v18, v19, 4, v18
    s_add_u32 s64, s70, 1024
    v_add_u32 v18, s64, v18
    v_bfe_u32 v26, v2, 3, 1
    v_lshl_add_u32 v26, v26, 2, v19
    v_bfe_u32 v27, v2, 2, 1
    v_lshrrev_b32 v28, 5, v2
    v_cmp_eq_u32 vcc, v27, v28
    v_and_b32 v27, 16, v2
    v_cmp_eq_u32 s[64:65], 0, v27
    s_and_b64 vcc, vcc, s[64:65]
    v_and_b32 v27, 1, v26
    v_lshlrev_b32 v27, 4, v27
    v_mov_b32 v28, 0x3f80
    v_lshlrev_b32 v27, v27, v28
    v_cndmask_b32 v27, 0, v27, vcc
    v_lshrrev_b32 v26, 1, v26
    v_cmp_eq_u32 vcc, 0, v26
    s_nop 1
    v_cndmask_b32 v48, 0, v27, vcc
    v_cmp_eq_u32 vcc, 1, v26
    s_nop 1
    v_cndmask_b32 v49, 0, v27, vcc
    v_cmp_eq_u32 vcc, 2, v26
    s_nop 1
    v_cndmask_b32 v50, 0, v27, vcc
    v_cmp_eq_u32 vcc, 3, v26
    s_nop 1
    v_cndmask_b32 v51, 0, v27, vcc
    v_mov_b32 v128, 0
    v_mov_b32 v129, 0
    v_mov_b32 v130, 0
    v_mov_b32 v131, 0
    v_mov_b32 v132, 0
    v_mov_b32 v133, 0
    v_mov_b32 v134, 0
    v_mov_b32 v135, 0
    v_mov_b32 v136, 0
    v_mov_b32 v137, 0
    v_mov_b32 v138, 0
    v_mov_b32 v139, 0
    v_mov_b32 v140, 0
    v_mov_b32 v141, 0
    v_mov_b32 v142, 0
    v_mov_b32 v143, 0
    s_mov_b32 s66, 0xffff
    s_mov_b32 s65, 0
    s_waitcnt vmcnt(0)
G_loop:
    v_readfirstlane_b32 s68, v20
    s_and_b32 s68, s68, s66
    s_andn2_b32 s66, s66, s68
    s_bcnt1_i32_b32 s67, s68
    s_cmp_eq_u32 s67, 0
    s_cbranch_scc1 G_l0
    s_cmp_gt_u32 s67, 8
    s_cbranch_scc1 G_lt_1
    s_cmp_gt_u32 s67, 4
    s_cbranch_scc1 G_lt_2
    s_cmp_gt_u32 s67, 2
    s_cbranch_scc1 G_lt_3
    s_cmp_eq_u32 s67, 1
    s_cbranch_scc1 G_l1
    s_branch G_l2
G_lt_3:
    s_cmp_eq_u32 s67, 3
    s_cbranch_scc1 G_l3
    s_branch G_l4
G_lt_2:
    s_cmp_gt_u32 s67, 6
    s_cbranch_scc1 G_lt_4
    s_cmp_eq_u32 s67, 5
    s_cbranch_scc1 G_l5
    s_branch G_l6
G_lt_4:
    s_cmp_eq_u32 s67, 7
    s_cbranch_scc1 G_l7
    s_branch G_l8
G_lt_1:
    s_cmp_gt_u32 s67, 12
    s_cbranch_scc1 G_lt_5
    s_cmp_gt_u32 s67, 10
    s_cbranch_scc1 G_lt_6
    s_cmp_eq_u32 s67, 9
    s_cbranch_scc1 G_l9
    s_branch G_l10
G_lt_6:
    s_cmp_eq_u32 s67, 11
    s_cbranch_scc1 G_l11
    s_branch G_l12
G_lt_5:
    s_cmp_gt_u32 s67, 14
    s_cbranch_scc1 G_lt_7
    s_cmp_eq_u32 s67, 13
    s_cbranch_scc1 G_l13
    s_branch G_l14
G_lt_7:
    s_cmp_eq_u32 s67, 15
    s_cbranch_scc1 G_l15
G_l16:
    s_ff1_i32_b32 s55, s68
    s_bitset0_b32 s68, s55
    s_mul_i32 s64, s55, 1152
    buffer_load_dwordx4 v[124:127], v17, s[16:19], s64 offen sc1
G_l15:
    s_ff1_i32_b32 s54, s68
    s_bitset0_b32 s68, s54
    s_mul_i32 s64, s54, 1152
    buffer_load_dwordx4 v[120:123], v17, s[16:19], s64 offen sc1
G_l14:
    s_ff1_i32_b32 s53, s68
    s_bitset0_b32 s68, s53
    s_mul_i32 s64, s53, 1152
    buffer_load_dwordx4 v[116:119], v17, s[16:19], s64 offen sc1
G_l13:
    s_ff1_i32_b32 s52, s68
    s_bitset0_b32 s68, s52
    s_mul_i32 s64, s52, 1152
    buffer_load_dwordx4 v[112:115], v17, s[16:19], s64 offen sc1
G_l12:
    s_ff1_i32_b32 s51, s68
    s_bitset0_b32 s68, s51
    s_mul_i32 s64, s51, 1152
    buffer_load_dwordx4 v[108:111], v17, s[16:19], s64 offen sc1
G_l11:
    s_ff1_i32_b32 s50, s68
    s_bitset0_b32 s68, s50
    s_mul_i32 s64, s50, 1152
    buffer_load_dwordx4 v[104:107], v17, s[16:19], s64 offen sc1
G_l10:
    s_ff1_i32_b32 s49, s68
    s_bitset0_b32 s68, s49
    s_mul_i32 s64, s49, 1152
    buffer_load_dwordx4 v[100:103], v17, s[16:19], s64 offen sc1
G_l9:
    s_ff1_i32_b32 s48, s68
    s_bitset0_b32 s68, s48
    s_mul_i32 s64, s48, 1152
    buffer_load_dwordx4 v[96:99], v17, s[16:19], s64 offen sc1
G_l8:
    s_ff1_i32_b32 s47, s68
    s_bitset0_b32 s68, s47
    s_mul_i32 s64, s47, 1152
    buffer_load_dwordx4 v[92:95], v17, s[16:19], s64 offen sc1
G_l7:
    s_ff1_i32_b32 s46, s68
    s_bitset0_b32 s68, s46
    s_mul_i32 s64, s46, 1152
    buffer_load_dwordx4 v[88:91], v17, s[16:19], s64 offen sc1
G_l6:
    s_ff1_i32_b32 s45, s68
    s_bitset0_b32 s68, s45
    s_mul_i32 s64, s45, 1152
    buffer_load_dwordx4 v[84:87], v17, s[16:19], s64 offen sc1
G_l5:
    s_ff1_i32_b32 s44, s68
    s_bitset0_b32 s68, s44
    s_mul_i32 s64, s44, 1152
    buffer_load_dwordx4 v[80:83], v17, s[16:19], s64 offen sc1
G_l4:
    s_ff1_i32_b32 s43, s68
    s_bitset0_b32 s68, s43
    s_mul_i32 s64, s43, 1152
    buffer_load_dwordx4 v[76:79], v17, s[16:19], s64 offen sc1
G_l3:
    s_ff1_i32_b32 s42, s68
    s_bitset0_b32 s68, s42
    s_mul_i32 s64, s42, 1152
    buffer_load_dwordx4 v[72:75], v17, s[16:19], s64 offen sc1
G_l2:
    s_ff1_i32_b32 s41, s68
    s_bitset0_b32 s68, s41
    s_mul_i32 s64, s41, 1152
    buffer_load_dwordx4 v[68:71], v17, s[16:19], s64 offen sc1
G_l1:
    s_ff1_i32_b32 s40, s68
    s_bitset0_b32 s68, s40
    s_mul_i32 s64, s40, 1152
    buffer_load_dwordx4 v[64:67], v17, s[16:19], s64 offen sc1
G_l0:
    s_mov_b32 s68, s66
    s_cmp_eq_u32 s66, 0
    s_cbranch_scc1 G_z
    s_cmp_lg_u32 s67, 0
    s_cbranch_scc1 G_p
    s_sleep 2
G_p:
    s_mov_b64 exec, 1
    v_mov_b32 v20, 0
    buffer_atomic_or v20, v23, s[16:19], 0 offen sc0
    s_mov_b64 exec, -1
    s_branch G_proc
G_z:
    buffer_load_dwordx4 v[56:59], v18, s[16:19], 0 offen sc1
G_proc:
    s_cmp_eq_u32 s67, 0
    s_cbranch_scc1 G_q0
    s_cmp_gt_u32 s67, 8
    s_cbranch_scc1 G_qt_8
    s_cmp_gt_u32 s67, 4
    s_cbranch_scc1 G_qt_9
    s_cmp_gt_u32 s67, 2
    s_cbranch_scc1 G_qt_10
    s_cmp_eq_u32 s67, 1
    s_cbranch_scc1 G_q1
    s_branch G_q2
G_qt_10:
    s_cmp_eq_u32 s67, 3
    s_cbranch_scc1 G_q3
    s_branch G_q4
G_qt_9:
    s_cmp_gt_u32 s67, 6
    s_cbranch_scc1 G_qt_11
    s_cmp_eq_u32 s67, 5
    s_cbranch_scc1 G_q5
    s_branch G_q6
G_qt_11:
    s_cmp_eq_u32 s67, 7
    s_cbranch_scc1 G_q7
    s_branch G_q8
G_qt_8:
    s_cmp_gt_u32 s67, 12
    s_cbranch_scc1 G_qt_12
    s_cmp_gt_u32 s67, 10
    s_cbranch_scc1 G_qt_13
    s_cmp_eq_u32 s67, 9
    s_cbranch_scc1 G_q9
    s_branch G_q10
G_qt_13:
    s_cmp_eq_u32 s67, 11
    s_cbranch_scc1 G_q11
    s_branch G_q12
G_qt_12:
    s_cmp_gt_u32 s67, 14
    s_cbranch_scc1 G_qt_14
    s_cmp_eq_u32 s67, 13
    s_cbranch_scc1 G_q13
    s_branch G_q14
G_qt_14:
    s_cmp_eq_u32 s67, 15
    s_cbranch_scc1 G_q15
G_q16:
    s_waitcnt vmcnt(16)
    v_max3_u32 v21, v124, v125, v126
    v_max_u32 v21, v21, v127
    v_cmp_eq_u32 vcc, -1, v21
    s_cbranch_vccnz G_f15
    v_mfma_f32_32x32x16_bf16 v[128:143], v[48:51], v[124:127], v[128:143]
G_q15:
    s_waitcnt vmcnt(15)
    v_max3_u32 v21, v120, v121, v122
    v_max_u32 v21, v21, v123
    v_cmp_eq_u32 vcc, -1, v21
    s_cbranch_vccnz G_f14
    v_mfma_f32_32x32x16_bf16 v[128:143], v[48:51], v[120:123], v[128:143]
G_q14:
    s_waitcnt vmcnt(14)
    v_max3_u32 v21, v116, v117, v118
    v_max_u32 v21, v21, v119
    v_cmp_eq_u32 vcc, -1, v21
    s_cbranch_vccnz G_f13
    v_mfma_f32_32x32x16_bf16 v[128:143], v[48:51], v[116:119], v[128:143]
G_q13:
    s_waitcnt vmcnt(13)
    v_max3_u32 v21, v112, v113, v114
    v_max_u32 v21, v21, v115
    v_cmp_eq_u32 vcc, -1, v21
    s_cbranch_vccnz G_f12
    v_mfma_f32_32x32x16_bf16 v[128:143], v[48:51], v[112:115], v[128:143]
G_q12:
    s_waitcnt vmcnt(12)
    v_max3_u32 v21, v108, v109, v110
    v_max_u32 v21, v21, v111
    v_cmp_eq_u32 vcc, -1, v21
    s_cbranch_vccnz G_f11
    v_mfma_f32_32x32x16_bf16 v[128:143], v[48:51], v[108:111], v[128:143]
G_q11:
    s_waitcnt vmcnt(11)
    v_max3_u32 v21, v104, v105, v106
    v_max_u32 v21, v21, v107
    v_cmp_eq_u32 vcc, -1, v21
    s_cbranch_vccnz G_f10
    v_mfma_f32_32x32x16_bf16 v[128:143], v[48:51], v[104:107], v[128:143]
G_q10:
    s_waitcnt vmcnt(10)
    v_max3_u32 v21, v100, v101, v102
    v_max_u32 v21, v21, v103
    v_cmp_eq_u32 vcc, -1, v21
    s_cbranch_vccnz G_f9
    v_mfma_f32_32x32x16_bf16 v[128:143], v[48:51], v[100:103], v[128:143]
G_q9:
    s_waitcnt vmcnt(9)
    v_max3_u32 v21, v96, v97, v98
    v_max_u32 v21, v21, v99
    v_cmp_eq_u32 vcc, -1, v21
    s_cbranch_vccnz G_f8
    v_mfma_f32_32x32x16_bf16 v[128:143], v[48:51], v[96:99], v[128:143]
G_q8:
    s_waitcnt vmcnt(8)
    v_max3_u32 v21, v92, v93, v94
    v_max_u32 v21, v21, v95
    v_cmp_eq_u32 vcc, -1, v21
    s_cbranch_vccnz G_f7
    v_mfma_f32_32x32x16_bf16 v[128:143], v[48:51], v[92:95], v[128:143]
G_q7:
    s_waitcnt vmcnt(7)
    v_max3_u32 v21, v88, v89, v90
    v_max_u32 v21, v21, v91
    v_cmp_eq_u32 vcc, -1, v21
    s_cbranch_vccnz G_f6
    v_mfma_f32_32x32x16_bf16 v[128:143], v[48:51], v[88:91], v[128:143]
G_q6:
    s_waitcnt vmcnt(6)
    v_max3_u32 v21, v84, v85, v86
    v_max_u32 v21, v21, v87
    v_cmp_eq_u32 vcc, -1, v21
    s_cbranch_vccnz G_f5
    v_mfma_f32_32x32x16_bf16 v[128:143], v[48:51], v[84:87], v[128:143]
G_q5:
    s_waitcnt vmcnt(5)
    v_max3_u32 v21, v80, v81, v82
    v_max_u32 v21, v21, v83
    v_cmp_eq_u32 vcc, -1, v21
    s_cbranch_vccnz G_f4
    v_mfma_f32_32x32x16_bf16 v[128:143], v[48:51], v[80:83], v[128:143]
G_q4:
    s_waitcnt vmcnt(4)
    v_max3_u32 v21, v76, v77, v78
    v_max_u32 v21, v21, v79
    v_cmp_eq_u32 vcc, -1, v21
    s_cbranch_vccnz G_f3
    v_mfma_f32_32x32x16_bf16 v[128:143], v[48:51], v[76:79], v[128:143]
G_q3:
    s_waitcnt vmcnt(3)
    v_max3_u32 v21, v72, v73, v74
    v_max_u32 v21, v21, v75
    v_cmp_eq_u32 vcc, -1, v21
    s_cbranch_vccnz G_f2
    v_mfma_f32_32x32x16_bf16 v[128:143], v[48:51], v[72:75], v[128:143]
G_q2:
    s_waitcnt vmcnt(2)
    v_max3_u32 v21, v68, v69, v70
    v_max_u32 v21, v21, v71
    v_cmp_eq_u32 vcc, -1, v21
    s_cbranch_vccnz G_f1
    v_mfma_f32_32x32x16_bf16 v[128:143], v[48:51], v[68:71], v[128:143]
G_q1:
    s_waitcnt vmcnt(1)
    v_max3_u32 v21, v64, v65, v66
    v_max_u32 v21, v21, v67
    v_cmp_eq_u32 vcc, -1, v21
    s_cbranch_vccnz G_f0
    v_mfma_f32_32x32x16_bf16 v[128:143], v[48:51], v[64:67], v[128:143]
G_q0:
    s_waitcnt vmcnt(0)
    s_add_u32 s65, s65, 1
    s_cmp_ge_u32 s65, 40000
    s_cbranch_scc1 G_done
    s_cmp_lg_u32 s68, 0
    s_cbranch_scc1 G_loop
    v_mov_b32 v20, -1
    s_cmp_lg_u32 s66, 0
    s_cbranch_scc1 G_loop
    v_max3_u32 v21, v56, v57, v58
    v_max_u32 v21, v21, v59
    v_cmp_eq_u32 vcc, -1, v21
    s_cbranch_vccnz G_loop
G_done:
    v_add_u32 v16, s7, v6
    v_add_f32_dpp v56, v56, v56 row_ror:4 row_mask:0xf bank_mask:0xf
    v_add_f32_dpp v57, v57, v57 row_ror:4 row_mask:0xf bank_mask:0xf
    v_add_f32_dpp v58, v58, v58 row_ror:4 row_mask:0xf bank_mask:0xf
    v_add_f32_dpp v59, v59, v59 row_ror:4 row_mask:0xf bank_mask:0xf
    v_add_f32_dpp v56, v56, v56 row_ror:8 row_mask:0xf bank_mask:0xf
    v_add_f32_dpp v57, v57, v57 row_ror:8 row_mask:0xf bank_mask:0xf
    v_add_f32_dpp v58, v58, v58 row_ror:8 row_mask:0xf bank_mask:0xf
    v_add_f32_dpp v59, v59, v59 row_ror:8 row_mask:0xf bank_mask:0xf
    v_mov_b32 v64, v56
    v_mov_b32 v65, v57
    v_mov_b32 v66, v58
    v_mov_b32 v67, v59
    s_nop 0
    v_permlane16_swap_b32 v56, v64
    v_permlane16_swap_b32 v57, v65
    v_permlane16_swap_b32 v58, v66
    v_permlane16_swap_b32 v59, v67
    v_add_f32 v56, v56, v64
    v_add_f32 v57, v57, v65
    v_add_f32 v58, v58, v66
    v_add_f32 v59, v59, v67
    v_mov_b32 v64, v56
    v_mov_b32 v65, v57
    v_mov_b32 v66, v58
    v_mov_b32 v67, v59
    s_nop 0
    v_permlane32_swap_b32 v56, v64
    v_permlane32_swap_b32 v57, v65
    v_permlane32_swap_b32 v58, v66
    v_permlane32_swap_b32 v59, v67
    v_add_f32 v56, v56, v64
    v_add_f32 v57, v57, v65
    v_add_f32 v58, v58, v66
    v_add_f32 v59, v59, v67
    v_cvt_pk_bf16_f32 v60, v128, v129
    v_cvt_pk_bf16_f32 v61, v130, v131
    v_cvt_pk_bf16_f32 v62, v132, v133
    v_cvt_pk_bf16_f32 v63, v134, v135
    ds_write_b128 v16, v[60:63] offset:0
    v_cvt_pk_bf16_f32 v56, v56, v57
    v_cvt_pk_bf16_f32 v57, v58, v59
    s_lshr_b32 s64, s6, 1
    s_lshl_b32 s64, s64, 6
    s_and_b32 s65, s6, 1
    s_lshl_b32 s65, s65, 3
    s_add_u32 s64, s64, s65
    v_lshl_add_u32 v16, v2, 4, s64
    s_mov_b64 exec, 15
    ds_write_b64 v16, v[56:57] offset:4096
    s_mov_b64 exec, -1
    s_waitcnt lgkmcnt(0)
    s_barrier
    v_lshrrev_b32 v18, 3, v2
    v_lshlrev_b32 v18, 2, v18
    ds_read_b32 v24, v18 offset:4352
    ds_read_b32 v25, v18 offset:4384
    ds_read_b32 v26, v18 offset:4416
    ds_read_b32 v27, v18 offset:4448
    ds_read_b32 v28, v18 offset:4480
    ds_read_b32 v29, v18 offset:4512
    ds_read_b32 v30, v18 offset:4544
    s_waitcnt lgkmcnt(0)
    v_lshlrev_b32 v48, 16, v192
    v_and_b32 v49, 0xffff0000, v192
    v_mul_f32 v32, v48, v24
    v_mul_f32 v33, v49, v24
    v_lshlrev_b32 v48, 16, v193
    v_and_b32 v49, 0xffff0000, v193
    v_mul_f32 v34, v48, v24
    v_mul_f32 v35, v49, v24
    v_lshlrev_b32 v48, 16, v194
    v_and_b32 v49, 0xffff0000, v194
    v_mul_f32 v36, v48, v24
    v_mul_f32 v37, v49, v24
    v_lshlrev_b32 v48, 16, v195
    v_and_b32 v49, 0xffff0000, v195
    v_mul_f32 v38, v48, v24
    v_mul_f32 v39, v49, v24
    v_lshlrev_b32 v48, 16, v196
    v_and_b32 v49, 0xffff0000, v196
    v_fmac_f32 v32, v48, v25
    v_fmac_f32 v33, v49, v25
    v_lshlrev_b32 v48, 16, v197
    v_and_b32 v49, 0xffff0000, v197
    v_fmac_f32 v34, v48, v25
    v_fmac_f32 v35, v49, v25
    v_lshlrev_b32 v48, 16, v198
    v_and_b32 v49, 0xffff0000, v198
    v_fmac_f32 v36, v48, v25
    v_fmac_f32 v37, v49, v25
    v_lshlrev_b32 v48, 16, v199
    v_and_b32 v49, 0xffff0000, v199
    v_fmac_f32 v38, v48, v25
    v_fmac_f32 v39, v49, v25
    v_lshlrev_b32 v48, 16, v200
    v_and_b32 v49, 0xffff0000, v200
    v_fmac_f32 v32, v48, v26
    v_fmac_f32 v33, v49, v26
    v_lshlrev_b32 v48, 16, v201
    v_and_b32 v49, 0xffff0000, v201
    v_fmac_f32 v34, v48, v26
    v_fmac_f32 v35, v49, v26
    v_lshlrev_b32 v48, 16, v202
    v_and_b32 v49, 0xffff0000, v202
    v_fmac_f32 v36, v48, v26
    v_fmac_f32 v37, v49, v26
    v_lshlrev_b32 v48, 16, v203
    v_and_b32 v49, 0xffff0000, v203
    v_fmac_f32 v38, v48, v26
    v_fmac_f32 v39, v49, v26
    v_lshlrev_b32 v48, 16, v204
    v_and_b32 v49, 0xffff0000, v204
    v_fmac_f32 v32, v48, v27
    v_fmac_f32 v33, v49, v27
    v_lshlrev_b32 v48, 16, v205
    v_and_b32 v49, 0xffff0000, v205
    v_fmac_f32 v34, v48, v27
    v_fmac_f32 v35, v49, v27
    v_lshlrev_b32 v48, 16, v206
    v_and_b32 v49, 0xffff0000, v206
    v_fmac_f32 v36, v48, v27
    v_fmac_f32 v37, v49, v27
    v_lshlrev_b32 v48, 16, v207
    v_and_b32 v49, 0xffff0000, v207
    v_fmac_f32 v38, v48, v27
    v_fmac_f32 v39, v49, v27
    v_lshlrev_b32 v48, 16, v208
    v_and_b32 v49, 0xffff0000, v208
    v_fmac_f32 v32, v48, v28
    v_fmac_f32 v33, v49, v28
    v_lshlrev_b32 v48, 16, v209
    v_and_b32 v49, 0xffff0000, v209
    v_fmac_f32 v34, v48, v28
    v_fmac_f32 v35, v49, v28
    v_lshlrev_b32 v48, 16, v210
    v_and_b32 v49, 0xffff0000, v210
    v_fmac_f32 v36, v48, v28
    v_fmac_f32 v37, v49, v28
    v_lshlrev_b32 v48, 16, v211
    v_and_b32 v49, 0xffff0000, v211
    v_fmac_f32 v38, v48, v28
    v_fmac_f32 v39, v49, v28
    v_lshlrev_b32 v48, 16, v212
    v_and_b32 v49, 0xffff0000, v212
    v_fmac_f32 v32, v48, v29
    v_fmac_f32 v33, v49, v29
    v_lshlrev_b32 v48, 16, v213
    v_and_b32 v49, 0xffff0000, v213
    v_fmac_f32 v34, v48, v29
    v_fmac_f32 v35, v49, v29
    v_lshlrev_b32 v48, 16, v214
    v_and_b32 v49, 0xffff0000, v214
    v_fmac_f32 v36, v48, v29
    v_fmac_f32 v37, v49, v29
    v_lshlrev_b32 v48, 16, v215
    v_and_b32 v49, 0xffff0000, v215
    v_fmac_f32 v38, v48, v29
    v_fmac_f32 v39, v49, v29
    v_lshlrev_b32 v48, 16, v216
    v_and_b32 v49, 0xffff0000, v216
    v_fmac_f32 v32, v48, v30
    v_fmac_f32 v33, v49, v30
    v_lshlrev_b32 v48, 16, v217
    v_and_b32 v49, 0xffff0000, v217
    v_fmac_f32 v34, v48, v30
    v_fmac_f32 v35, v49, v30
    v_lshlrev_b32 v48, 16, v218
    v_and_b32 v49, 0xffff0000, v218
    v_fmac_f32 v36, v48, v30
    v_fmac_f32 v37, v49, v30
    v_lshlrev_b32 v48, 16, v219
    v_and_b32 v49, 0xffff0000, v219
    v_fmac_f32 v38, v48, v30
    v_fmac_f32 v39, v49, v30
    s_nop 1
    v_permlane32_swap_b32 v32, v36
    v_permlane32_swap_b32 v33, v37
    v_permlane32_swap_b32 v34, v38
    v_permlane32_swap_b32 v35, v39
    v_add_f32 v32, v32, v36
    v_add_f32 v33, v33, v37
    v_add_f32 v34, v34, v38
    v_add_f32 v35, v35, v39
    s_nop 1
    v_permlane16_swap_b32 v32, v34
    v_permlane16_swap_b32 v33, v35
    v_add_f32 v32, v32, v34
    v_add_f32 v33, v33, v35
    s_nop 1
    v_add_f32_dpp v32, v32, v32 row_ror:8 row_mask:0xf bank_mask:0xf
    v_add_f32_dpp v33, v33, v33 row_ror:8 row_mask:0xf bank_mask:0xf
    v_and_b32 v16, 7, v2
    v_lshlrev_b32 v16, 5, v16
    v_lshl_add_u32 v16, v8, 3, v16
    s_lshl_b32 s64, s2, 10
    s_lshl_b32 s65, s6, 8
    s_add_u32 s64, s64, s65
    s_add_u32 s64, s64, 6447104
    s_mov_b32 exec_lo, 0x00ff00ff
    s_mov_b32 exec_hi, 0x00ff00ff
    buffer_store_dwordx2 v[32:33], v16, s[16:19], s64 offen sc0 sc1
    s_mov_b64 exec, -1
    s_lshl_b32 s64, s4, 3
    s_add_u32 s64, s64, s3
    s_lshl_b32 s64, s64, 7
    s_add_u32 s64, s64, 5382144
    v_mov_b32 v14, s64
    s_mov_b64 exec, 1
    v_mov_b32 v15, 0
    buffer_atomic_or v15, v14, s[16:19], 0 offen sc0
    s_mov_b64 exec, -1
    v_sub_f32 v248, 1.0, v228
    v_cvt_pk_bf16_f32 v248, v248, v248
    v_lshlrev_b32 v248, 16, v248
    v_lshlrev_b32 v232, 16, v220
    v_and_b32 v233, 0xffff0000, v220
    v_mul_f32 v232, v232, v248
    v_mul_f32 v233, v233, v248
    v_cvt_pk_bf16_f32 v3, v232, v233
    v_lshlrev_b32 v232, 16, v3
    v_and_b32 v233, 0xffff0000, v3
    v_lshlrev_b32 v234, 16, v221
    v_and_b32 v235, 0xffff0000, v221
    v_mul_f32 v234, v234, v248
    v_mul_f32 v235, v235, v248
    v_cvt_pk_bf16_f32 v3, v234, v235
    v_lshlrev_b32 v234, 16, v3
    v_and_b32 v235, 0xffff0000, v3
    v_lshlrev_b32 v236, 16, v222
    v_and_b32 v237, 0xffff0000, v222
    v_mul_f32 v236, v236, v248
    v_mul_f32 v237, v237, v248
    v_cvt_pk_bf16_f32 v3, v236, v237
    v_lshlrev_b32 v236, 16, v3
    v_and_b32 v237, 0xffff0000, v3
    v_lshlrev_b32 v238, 16, v223
    v_and_b32 v239, 0xffff0000, v223
    v_mul_f32 v238, v238, v248
    v_mul_f32 v239, v239, v248
    v_cvt_pk_bf16_f32 v3, v238, v239
    v_lshlrev_b32 v238, 16, v3
    v_and_b32 v239, 0xffff0000, v3
    v_lshlrev_b32 v240, 16, v224
    v_and_b32 v241, 0xffff0000, v224
    v_mul_f32 v240, v240, v248
    v_mul_f32 v241, v241, v248
    v_cvt_pk_bf16_f32 v3, v240, v241
    v_lshlrev_b32 v240, 16, v3
    v_and_b32 v241, 0xffff0000, v3
    v_lshlrev_b32 v242, 16, v225
    v_and_b32 v243, 0xffff0000, v225
    v_mul_f32 v242, v242, v248
    v_mul_f32 v243, v243, v248
    v_cvt_pk_bf16_f32 v3, v242, v243
    v_lshlrev_b32 v242, 16, v3
    v_and_b32 v243, 0xffff0000, v3
    v_lshlrev_b32 v244, 16, v226
    v_and_b32 v245, 0xffff0000, v226
    v_mul_f32 v244, v244, v248
    v_mul_f32 v245, v245, v248
    v_cvt_pk_bf16_f32 v3, v244, v245
    v_lshlrev_b32 v244, 16, v3
    v_and_b32 v245, 0xffff0000, v3
    v_lshlrev_b32 v246, 16, v227
    v_and_b32 v247, 0xffff0000, v227
    v_mul_f32 v246, v246, v248
    v_mul_f32 v247, v247, v248
    v_cvt_pk_bf16_f32 v3, v246, v247
    v_lshlrev_b32 v246, 16, v3
    v_and_b32 v247, 0xffff0000, v3
    s_branch P2_start
C_start:
    s_getpc_b64 s[68:69]
C_pc:
    s_sub_u32 s68, s68, C_pc-gated_mix__linear_attn_block__moe_arch_mod__prompt_kernel
    s_subb_u32 s69, s69, 0
    s_lshr_b32 s64, s2, 3
    s_lshl_b32 s64, s64, 2
    s_add_u32 s64, s64, s3
    s_mul_i32 s64, s64, 256
    s_mov_b32 s65, CODE_END-gated_mix__linear_attn_block__moe_arch_mod__prompt_kernel-4
    s_min_u32 s66, s64, s65
    s_load_dword s75, s[68:69], s66
    s_add_u32 s64, s64, 64
    s_min_u32 s66, s64, s65
    s_load_dword s75, s[68:69], s66
    s_add_u32 s64, s64, 64
    s_min_u32 s66, s64, s65
    s_load_dword s75, s[68:69], s66
    s_add_u32 s64, s64, 64
    s_min_u32 s66, s64, s65
    s_load_dword s75, s[68:69], s66
    s_add_u32 s64, s64, 64
    s_and_b32 s6, s3, 1
    s_lshr_b32 s7, s3, 1
    v_and_b32 v3, 15, v2
    s_lshl_b32 s64, s6, 6
    v_add_u32 v3, s64, v3
    v_lshlrev_b32 v3, 7, v3
    v_add_u32 v3, 8192, v3
    v_bfe_u32 v56, v2, 1, 3
    v_lshrrev_b32 v57, 4, v2
    v_xor_b32 v56, v56, v57
    v_lshl_add_u32 v4, v56, 4, v3
    v_xor_b32 v5, 64, v4
    v_bfe_u32 v56, v2, 2, 2
    v_lshl_add_u32 v58, v57, 3, v56
    v_lshlrev_b32 v58, 7, v58
    v_lshrrev_b32 v56, 1, v56
    v_xor_b32 v56, s7, v56
    v_lshl_add_u32 v58, v56, 6, v58
    v_and_b32 v57, 1, v57
    v_lshl_add_u32 v58, v57, 5, v58
    v_and_b32 v56, 3, v2
    v_lshl_add_u32 v58, v56, 3, v58
    v_add_u32 v6, 24576, v58
    v_xor_b32 v7, 32, v6
    v_mov_b32 v8, v4
    v_mov_b32 v10, v6
    v_mov_b32 v9, v5
    v_mov_b32 v11, v7
    v_mov_b32 v64, 0
    v_mov_b32 v65, 0
    v_mov_b32 v66, 0
    v_mov_b32 v67, 0
    v_mov_b32 v68, 0
    v_mov_b32 v69, 0
    v_mov_b32 v70, 0
    v_mov_b32 v71, 0
    v_mov_b32 v72, 0
    v_mov_b32 v73, 0
    v_mov_b32 v74, 0
    v_mov_b32 v75, 0
    v_mov_b32 v76, 0
    v_mov_b32 v77, 0
    v_mov_b32 v78, 0
    v_mov_b32 v79, 0
    v_mov_b32 v80, 0
    v_mov_b32 v81, 0
    v_mov_b32 v82, 0
    v_mov_b32 v83, 0
    v_mov_b32 v84, 0
    v_mov_b32 v85, 0
    v_mov_b32 v86, 0
    v_mov_b32 v87, 0
    v_mov_b32 v88, 0
    v_mov_b32 v89, 0
    v_mov_b32 v90, 0
    v_mov_b32 v91, 0
    v_mov_b32 v92, 0
    v_mov_b32 v93, 0
    v_mov_b32 v94, 0
    v_mov_b32 v95, 0
    v_mov_b32 v96, 0
    v_mov_b32 v97, 0
    v_mov_b32 v98, 0
    v_mov_b32 v99, 0
    v_mov_b32 v100, 0
    v_mov_b32 v101, 0
    v_mov_b32 v102, 0
    v_mov_b32 v103, 0
    v_mov_b32 v104, 0
    v_mov_b32 v105, 0
    v_mov_b32 v106, 0
    v_mov_b32 v107, 0
    v_mov_b32 v108, 0
    v_mov_b32 v109, 0
    v_mov_b32 v110, 0
    v_mov_b32 v111, 0
    v_mov_b32 v112, 0
    v_mov_b32 v113, 0
    v_mov_b32 v114, 0
    v_mov_b32 v115, 0
    v_mov_b32 v116, 0
    v_mov_b32 v117, 0
    v_mov_b32 v118, 0
    v_mov_b32 v119, 0
    v_mov_b32 v120, 0
    v_mov_b32 v121, 0
    v_mov_b32 v122, 0
    v_mov_b32 v123, 0
    v_mov_b32 v124, 0
    v_mov_b32 v125, 0
    v_mov_b32 v126, 0
    v_mov_b32 v127, 0
    v_mov_b32 v128, 0
    v_mov_b32 v129, 0
    v_mov_b32 v130, 0
    v_mov_b32 v131, 0
    v_mov_b32 v132, 0
    v_mov_b32 v133, 0
    v_mov_b32 v134, 0
    v_mov_b32 v135, 0
    v_mov_b32 v136, 0
    v_mov_b32 v137, 0
    v_mov_b32 v138, 0
    v_mov_b32 v139, 0
    v_mov_b32 v140, 0
    v_mov_b32 v141, 0
    v_mov_b32 v142, 0
    v_mov_b32 v143, 0
    v_mov_b32 v144, 0
    v_mov_b32 v145, 0
    v_mov_b32 v146, 0
    v_mov_b32 v147, 0
    v_mov_b32 v148, 0
    v_mov_b32 v149, 0
    v_mov_b32 v150, 0
    v_mov_b32 v151, 0
    v_mov_b32 v152, 0
    v_mov_b32 v153, 0
    v_mov_b32 v154, 0
    v_mov_b32 v155, 0
    v_mov_b32 v156, 0
    v_mov_b32 v157, 0
    v_mov_b32 v158, 0
    v_mov_b32 v159, 0
    s_lshl_b32 s64, s3, 2
    v_mov_b32 v229, s64
    ds_write_b32 v229, v64 offset:4288
    v_lshlrev_b32 v3, 4, v2
    s_lshl_b32 s64, s3, 11
    v_add_u32 v224, s64, v3
    v_xor_b32 v225, 2048, v224
    s_lshl_b32 s64, s3, 8
    v_lshl_add_u32 v227, v2, 2, s64
    v_xor_b32 v228, 256, v227
    v_xor_b32 v230, 4, v229
    v_mov_b32 v231, 1
    v_lshlrev_b32 v232, 2, v2
    s_lshl_b32 s64, 1, s4
    v_mov_b32 v233, s64
    s_lshl_b32 s43, s5, 2
    s_add_u32 s43, s43, s3
    s_lshl_b32 s64, s43, 7
    s_add_u32 s64, s64, 5373952
    v_mov_b32 v234, s64
    s_lshl_b32 s43, s43, 4
    s_add_u32 s43, s43, s4
    s_mul_i32 s43, s43, 1152
    s_add_u32 s43, s43, 4194304
    s_lshl_b32 s42, s4, 2
    s_lshl_b32 s64, s6, 1
    s_add_u32 s42, s42, s64
    s_lshl_b32 s42, s42, 5
    s_lshl_b32 s64, s5, 1
    s_add_u32 s42, s42, s64
    s_add_u32 s42, s42, s7
    s_lshl_b32 s42, s42, 11
    s_and_b32 s64, s5, 7
    s_lshl_b32 s64, s64, 1
    s_add_u32 s64, s64, s7
    s_lshl_b32 s64, 1, s64
    v_mov_b32 v13, s64
    s_lshr_b32 s64, s5, 3
    s_lshl_b32 s64, s64, 1
    s_add_u32 s64, s64, s6
    s_lshl_b32 s64, s64, 8
    s_lshl_b32 s65, s4, 10
    s_add_u32 s64, s64, s65
    s_add_u32 s64, s64, 5382144
    v_lshl_add_u32 v12, v2, 7, s64
    s_and_b32 s64, s2, 7
    s_lshr_b32 s65, s2, 3
    s_and_b32 s4, s64, 3
    s_lshl_b32 s4, s4, 2
    s_and_b32 s66, s65, 3
    s_add_u32 s4, s4, s66
    s_lshr_b32 s5, s64, 2
    s_lshl_b32 s5, s5, 3
    s_lshr_b32 s74, s65, 2
    s_add_u32 s5, s5, s74
    s_mov_b32 s65, 0
    s_mov_b32 s66, 0
    v_mov_b32 v236, 0x3f803f80
    v_mov_b32 v237, 0x3f803f80
    v_mov_b32 v238, 0x3f803f80
    v_mov_b32 v239, 0x3f803f80
    s_waitcnt vmcnt(0) lgkmcnt(0)
    s_barrier
    ds_read_b64_tr_b16 v[16:17], v10 offset:0
    ds_read_b64_tr_b16 v[18:19], v10 offset:512
    ds_read_b128 v[192:195], v8 offset:0
    ds_read_b128 v[196:199], v8 offset:2048
    ds_read_b128 v[200:203], v8 offset:4096
    ds_read_b128 v[204:207], v8 offset:6144
    ds_read_b64_tr_b16 v[20:21], v11 offset:0
    ds_read_b64_tr_b16 v[22:23], v11 offset:512
    ds_read_b64_tr_b16 v[24:25], v10 offset:8192
    ds_read_b64_tr_b16 v[26:27], v10 offset:8704
    ds_read_b64_tr_b16 v[28:29], v11 offset:8192
    ds_read_b64_tr_b16 v[30:31], v11 offset:8704
    ds_read_b64_tr_b16 v[32:33], v10 offset:16384
    ds_read_b64_tr_b16 v[34:35], v10 offset:16896
    ds_read_b64_tr_b16 v[36:37], v11 offset:16384
    ds_read_b64_tr_b16 v[38:39], v11 offset:16896
.p2align 3
C_loop:
    s_waitcnt lgkmcnt(0)
    v_mfma_f32_16x16x32_bf16 v[64:67], v[16:19], v[192:195], v[64:67]
    ds_read_b64_tr_b16 v[40:41], v10 offset:4096
    v_mfma_f32_16x16x32_bf16 v[72:75], v[16:19], v[196:199], v[72:75]
    ds_read_b64_tr_b16 v[42:43], v10 offset:4608
    v_mfma_f32_16x16x32_bf16 v[80:83], v[16:19], v[200:203], v[80:83]
    ds_read_b128 v[208:211], v9 offset:0
    v_mfma_f32_16x16x32_bf16 v[88:91], v[16:19], v[204:207], v[88:91]
    ds_read_b128 v[212:215], v9 offset:2048
    v_mfma_f32_16x16x32_bf16 v[68:71], v[20:23], v[192:195], v[68:71]
    ds_read_b128 v[216:219], v9 offset:4096
    v_mfma_f32_16x16x32_bf16 v[76:79], v[20:23], v[196:199], v[76:79]
    ds_read_b128 v[220:223], v9 offset:6144
    v_mfma_f32_16x16x32_bf16 v[84:87], v[20:23], v[200:203], v[84:87]
    ds_read_b64_tr_b16 v[44:45], v11 offset:4096
    v_mfma_f32_16x16x32_bf16 v[92:95], v[20:23], v[204:207], v[92:95]
    ds_read_b64_tr_b16 v[46:47], v11 offset:4608
    v_mfma_f32_16x16x32_bf16 v[96:99], v[192:195], v[24:27], v[96:99]
    ds_read_b64_tr_b16 v[48:49], v10 offset:12288
    v_mfma_f32_16x16x32_bf16 v[100:103], v[196:199], v[24:27], v[100:103]
    ds_read_b64_tr_b16 v[50:51], v10 offset:12800
    v_mfma_f32_16x16x32_bf16 v[112:115], v[200:203], v[24:27], v[112:115]
    ds_read_b64_tr_b16 v[52:53], v11 offset:12288
    v_mfma_f32_16x16x32_bf16 v[116:119], v[204:207], v[24:27], v[116:119]
    ds_read_b64_tr_b16 v[54:55], v11 offset:12800
    v_mfma_f32_16x16x32_bf16 v[104:107], v[192:195], v[28:31], v[104:107]
    ds_read_b64_tr_b16 v[56:57], v10 offset:20480
    v_mfma_f32_16x16x32_bf16 v[108:111], v[196:199], v[28:31], v[108:111]
    ds_read_b64_tr_b16 v[58:59], v10 offset:20992
    v_mfma_f32_16x16x32_bf16 v[120:123], v[200:203], v[28:31], v[120:123]
    ds_read_b64_tr_b16 v[60:61], v11 offset:20480
    v_mfma_f32_16x16x32_bf16 v[124:127], v[204:207], v[28:31], v[124:127]
    ds_read_b64_tr_b16 v[62:63], v11 offset:20992
    v_mfma_f32_16x16x32_bf16 v[128:131], v[192:195], v[32:35], v[128:131]
    v_mfma_f32_16x16x32_bf16 v[132:135], v[196:199], v[32:35], v[132:135]
    v_mfma_f32_16x16x32_bf16 v[144:147], v[200:203], v[32:35], v[144:147]
    v_mfma_f32_16x16x32_bf16 v[148:151], v[204:207], v[32:35], v[148:151]
    v_mfma_f32_16x16x32_bf16 v[136:139], v[192:195], v[36:39], v[136:139]
    v_mfma_f32_16x16x32_bf16 v[140:143], v[196:199], v[36:39], v[140:143]
    v_mfma_f32_16x16x32_bf16 v[152:155], v[200:203], v[36:39], v[152:155]
    v_mfma_f32_16x16x32_bf16 v[156:159], v[204:207], v[36:39], v[156:159]
    s_waitcnt lgkmcnt(0)
    s_barrier
    s_add_u32 s65, s65, 40960
    s_cmp_eq_u32 s65, 122880
    s_cselect_b32 s65, 0, s65
    v_mfma_f32_16x16x32_bf16 v[64:67], v[40:43], v[208:211], v[64:67]
    v_add_u32 v10, s65, v6
    v_add_u32 v8, s65, v4
    v_mfma_f32_16x16x32_bf16 v[72:75], v[40:43], v[212:215], v[72:75]
    ds_read_b64_tr_b16 v[16:17], v10 offset:0
    v_mfma_f32_16x16x32_bf16 v[80:83], v[40:43], v[216:219], v[80:83]
    ds_read_b64_tr_b16 v[18:19], v10 offset:512
    v_mfma_f32_16x16x32_bf16 v[88:91], v[40:43], v[220:223], v[88:91]
    ds_read_b128 v[192:195], v8 offset:0
    v_mfma_f32_16x16x32_bf16 v[68:71], v[44:47], v[208:211], v[68:71]
    ds_read_b128 v[196:199], v8 offset:2048
    v_mfma_f32_16x16x32_bf16 v[76:79], v[44:47], v[212:215], v[76:79]
    ds_read_b128 v[200:203], v8 offset:4096
    v_mfma_f32_16x16x32_bf16 v[84:87], v[44:47], v[216:219], v[84:87]
    ds_read_b128 v[204:207], v8 offset:6144
    v_mfma_f32_16x16x32_bf16 v[92:95], v[44:47], v[220:223], v[92:95]
    v_add_u32 v11, s65, v7
    v_mfma_f32_16x16x32_bf16 v[96:99], v[208:211], v[48:51], v[96:99]
    ds_read_b64_tr_b16 v[20:21], v11 offset:0
    v_mfma_f32_16x16x32_bf16 v[100:103], v[212:215], v[48:51], v[100:103]
    ds_read_b64_tr_b16 v[22:23], v11 offset:512
    v_mfma_f32_16x16x32_bf16 v[112:115], v[216:219], v[48:51], v[112:115]
    ds_read_b64_tr_b16 v[24:25], v10 offset:8192
    v_mfma_f32_16x16x32_bf16 v[116:119], v[220:223], v[48:51], v[116:119]
    ds_read_b64_tr_b16 v[26:27], v10 offset:8704
    v_mfma_f32_16x16x32_bf16 v[104:107], v[208:211], v[52:55], v[104:107]
    ds_read_b64_tr_b16 v[28:29], v11 offset:8192
    v_mfma_f32_16x16x32_bf16 v[108:111], v[212:215], v[52:55], v[108:111]
    ds_read_b64_tr_b16 v[30:31], v11 offset:8704
    v_mfma_f32_16x16x32_bf16 v[120:123], v[216:219], v[52:55], v[120:123]
    ds_read_b64_tr_b16 v[32:33], v10 offset:16384
    v_mfma_f32_16x16x32_bf16 v[124:127], v[220:223], v[52:55], v[124:127]
    ds_read_b64_tr_b16 v[34:35], v10 offset:16896
    v_mfma_f32_16x16x32_bf16 v[128:131], v[208:211], v[56:59], v[128:131]
    ds_read_b64_tr_b16 v[36:37], v11 offset:16384
    v_mfma_f32_16x16x32_bf16 v[132:135], v[212:215], v[56:59], v[132:135]
    ds_read_b64_tr_b16 v[38:39], v11 offset:16896
    v_mfma_f32_16x16x32_bf16 v[144:147], v[216:219], v[56:59], v[144:147]
    v_add_u32 v9, s65, v5
    v_mfma_f32_16x16x32_bf16 v[148:151], v[220:223], v[56:59], v[148:151]
    v_mfma_f32_16x16x32_bf16 v[136:139], v[208:211], v[60:63], v[136:139]
    v_mfma_f32_16x16x32_bf16 v[140:143], v[212:215], v[60:63], v[140:143]
    v_mfma_f32_16x16x32_bf16 v[152:155], v[216:219], v[60:63], v[152:155]
    v_mfma_f32_16x16x32_bf16 v[156:159], v[220:223], v[60:63], v[156:159]
    s_add_u32 s66, s66, 1
    s_cmp_lt_u32 s66, 14
    s_cbranch_scc1 C_loop
    s_waitcnt lgkmcnt(0)
    v_mfma_f32_16x16x32_bf16 v[96:99], v[192:195], v[24:27], v[96:99]
    ds_read_b64_tr_b16 v[48:49], v10 offset:12288
    v_mfma_f32_16x16x32_bf16 v[100:103], v[196:199], v[24:27], v[100:103]
    ds_read_b64_tr_b16 v[50:51], v10 offset:12800
    v_mfma_f32_16x16x32_bf16 v[112:115], v[200:203], v[24:27], v[112:115]
    ds_read_b128 v[160:163], v9 offset:0
    v_mfma_f32_16x16x32_bf16 v[116:119], v[204:207], v[24:27], v[116:119]
    ds_read_b128 v[164:167], v9 offset:2048
    v_mfma_f32_16x16x32_bf16 v[104:107], v[192:195], v[28:31], v[104:107]
    ds_read_b128 v[168:171], v9 offset:4096
    v_mfma_f32_16x16x32_bf16 v[108:111], v[196:199], v[28:31], v[108:111]
    ds_read_b128 v[172:175], v9 offset:6144
    v_mfma_f32_16x16x32_bf16 v[120:123], v[200:203], v[28:31], v[120:123]
    ds_read_b64_tr_b16 v[52:53], v11 offset:12288
    v_mfma_f32_16x16x32_bf16 v[124:127], v[204:207], v[28:31], v[124:127]
    ds_read_b64_tr_b16 v[54:55], v11 offset:12800
    v_mfma_f32_16x16x32_bf16 v[128:131], v[192:195], v[32:35], v[128:131]
    ds_read_b64_tr_b16 v[56:57], v10 offset:20480
    v_mfma_f32_16x16x32_bf16 v[132:135], v[196:199], v[32:35], v[132:135]
    ds_read_b64_tr_b16 v[58:59], v10 offset:20992
    v_mfma_f32_16x16x32_bf16 v[144:147], v[200:203], v[32:35], v[144:147]
    ds_read_b64_tr_b16 v[60:61], v11 offset:20480
    v_mfma_f32_16x16x32_bf16 v[148:151], v[204:207], v[32:35], v[148:151]
    ds_read_b64_tr_b16 v[62:63], v11 offset:20992
    v_mfma_f32_16x16x32_bf16 v[136:139], v[192:195], v[36:39], v[136:139]
    v_mfma_f32_16x16x32_bf16 v[140:143], v[196:199], v[36:39], v[140:143]
    v_mfma_f32_16x16x32_bf16 v[152:155], v[200:203], v[36:39], v[152:155]
    v_mfma_f32_16x16x32_bf16 v[156:159], v[204:207], v[36:39], v[156:159]
    s_waitcnt lgkmcnt(0)
    s_barrier
    s_add_u32 s66, s66, 1
    v_mfma_f32_16x16x32_bf16 v[96:99], v[160:163], v[48:51], v[96:99]
    v_mov_b32 v10, v6
    v_mov_b32 v8, v4
    v_mfma_f32_16x16x32_bf16 v[100:103], v[164:167], v[48:51], v[100:103]
    ds_read_b64_tr_b16 v[24:25], v10 offset:8192
    v_mfma_f32_16x16x32_bf16 v[112:115], v[168:171], v[48:51], v[112:115]
    ds_read_b64_tr_b16 v[26:27], v10 offset:8704
    v_mfma_f32_16x16x32_bf16 v[116:119], v[172:175], v[48:51], v[116:119]
    v_mov_b32 v11, v7
    v_mov_b32 v9, v5
    v_mfma_f32_16x16x32_bf16 v[104:107], v[160:163], v[52:55], v[104:107]
    ds_read_b128 v[176:179], v8 offset:0
    v_mfma_f32_16x16x32_bf16 v[108:111], v[164:167], v[52:55], v[108:111]
    ds_read_b128 v[180:183], v8 offset:2048
    v_mfma_f32_16x16x32_bf16 v[120:123], v[168:171], v[52:55], v[120:123]
    ds_read_b128 v[184:187], v8 offset:4096
    v_mfma_f32_16x16x32_bf16 v[124:127], v[172:175], v[52:55], v[124:127]
    ds_read_b128 v[188:191], v8 offset:6144
    v_mfma_f32_16x16x32_bf16 v[128:131], v[160:163], v[56:59], v[128:131]
    ds_read_b64_tr_b16 v[28:29], v11 offset:8192
    v_mfma_f32_16x16x32_bf16 v[132:135], v[164:167], v[56:59], v[132:135]
    ds_read_b64_tr_b16 v[30:31], v11 offset:8704
    v_mfma_f32_16x16x32_bf16 v[144:147], v[168:171], v[56:59], v[144:147]
    ds_read_b64_tr_b16 v[32:33], v10 offset:16384
    v_mfma_f32_16x16x32_bf16 v[148:151], v[172:175], v[56:59], v[148:151]
    ds_read_b64_tr_b16 v[34:35], v10 offset:16896
    v_mfma_f32_16x16x32_bf16 v[136:139], v[160:163], v[60:63], v[136:139]
    ds_read_b64_tr_b16 v[36:37], v11 offset:16384
    v_mfma_f32_16x16x32_bf16 v[140:143], v[164:167], v[60:63], v[140:143]
    ds_read_b64_tr_b16 v[38:39], v11 offset:16896
    v_mfma_f32_16x16x32_bf16 v[152:155], v[168:171], v[60:63], v[152:155]
    v_mfma_f32_16x16x32_bf16 v[156:159], v[172:175], v[60:63], v[156:159]
    s_waitcnt lgkmcnt(0)
    v_mfma_f32_16x16x32_bf16 v[96:99], v[176:179], v[24:27], v[96:99]
    ds_read_b64_tr_b16 v[48:49], v10 offset:12288
    v_mfma_f32_16x16x32_bf16 v[100:103], v[180:183], v[24:27], v[100:103]
    ds_read_b64_tr_b16 v[50:51], v10 offset:12800
    v_mfma_f32_16x16x32_bf16 v[112:115], v[184:187], v[24:27], v[112:115]
    ds_read_b128 v[208:211], v9 offset:0
    v_mfma_f32_16x16x32_bf16 v[116:119], v[188:191], v[24:27], v[116:119]
    ds_read_b128 v[212:215], v9 offset:2048
    v_mfma_f32_16x16x32_bf16 v[104:107], v[176:179], v[28:31], v[104:107]
    ds_read_b128 v[216:219], v9 offset:4096
    v_mfma_f32_16x16x32_bf16 v[108:111], v[180:183], v[28:31], v[108:111]
    ds_read_b128 v[220:223], v9 offset:6144
    v_mfma_f32_16x16x32_bf16 v[120:123], v[184:187], v[28:31], v[120:123]
    ds_read_b64_tr_b16 v[52:53], v11 offset:12288
    v_mfma_f32_16x16x32_bf16 v[124:127], v[188:191], v[28:31], v[124:127]
    ds_read_b64_tr_b16 v[54:55], v11 offset:12800
    v_mfma_f32_16x16x32_bf16 v[128:131], v[176:179], v[32:35], v[128:131]
    ds_read_b64_tr_b16 v[56:57], v10 offset:20480
    v_mfma_f32_16x16x32_bf16 v[132:135], v[180:183], v[32:35], v[132:135]
    ds_read_b64_tr_b16 v[58:59], v10 offset:20992
    v_mfma_f32_16x16x32_bf16 v[144:147], v[184:187], v[32:35], v[144:147]
    ds_read_b64_tr_b16 v[60:61], v11 offset:20480
    v_mfma_f32_16x16x32_bf16 v[148:151], v[188:191], v[32:35], v[148:151]
    ds_read_b64_tr_b16 v[62:63], v11 offset:20992
    v_mfma_f32_16x16x32_bf16 v[136:139], v[176:179], v[36:39], v[136:139]
    v_mfma_f32_16x16x32_bf16 v[140:143], v[180:183], v[36:39], v[140:143]
    v_mfma_f32_16x16x32_bf16 v[152:155], v[184:187], v[36:39], v[152:155]
    v_mfma_f32_16x16x32_bf16 v[156:159], v[188:191], v[36:39], v[156:159]
    s_waitcnt lgkmcnt(0)
    s_barrier
    v_mfma_f32_16x16x32_bf16 v[96:99], v[208:211], v[48:51], v[96:99]
    v_mfma_f32_16x16x32_bf16 v[100:103], v[212:215], v[48:51], v[100:103]
    v_mfma_f32_16x16x32_bf16 v[112:115], v[216:219], v[48:51], v[112:115]
    v_mfma_f32_16x16x32_bf16 v[116:119], v[220:223], v[48:51], v[116:119]
    v_mfma_f32_16x16x32_bf16 v[104:107], v[208:211], v[52:55], v[104:107]
    v_mfma_f32_16x16x32_bf16 v[108:111], v[212:215], v[52:55], v[108:111]
    v_mfma_f32_16x16x32_bf16 v[120:123], v[216:219], v[52:55], v[120:123]
    v_mfma_f32_16x16x32_bf16 v[124:127], v[220:223], v[52:55], v[124:127]
    v_mfma_f32_16x16x32_bf16 v[128:131], v[208:211], v[56:59], v[128:131]
    v_mfma_f32_16x16x32_bf16 v[132:135], v[212:215], v[56:59], v[132:135]
    v_mfma_f32_16x16x32_bf16 v[144:147], v[216:219], v[56:59], v[144:147]
    v_mfma_f32_16x16x32_bf16 v[148:151], v[220:223], v[56:59], v[148:151]
    v_mfma_f32_16x16x32_bf16 v[136:139], v[208:211], v[60:63], v[136:139]
    v_mfma_f32_16x16x32_bf16 v[140:143], v[212:215], v[60:63], v[140:143]
    v_mfma_f32_16x16x32_bf16 v[152:155], v[216:219], v[60:63], v[152:155]
    v_mfma_f32_16x16x32_bf16 v[156:159], v[220:223], v[60:63], v[156:159]
    v_add_u32 v10, 81920, v6
    v_add_u32 v11, 81920, v7
    v_cvt_pk_bf16_f32 v16, v96, v97
    v_lshlrev_b32 v48, 16, v16
    v_and_b32 v49, 0xffff0000, v16
    v_mul_f32 v50, s72, v48
    v_mul_f32 v51, s72, v49
    v_exp_f32 v50, v50 clamp
    v_exp_f32 v51, v51 clamp
    v_max_f32 v48, 0, v48
    v_max_f32 v49, 0, v49
    v_add_f32 v48, v48, v50
    v_add_f32 v49, v49, v51
    v_min_f32 v56, v48, v49
    v_cvt_pk_bf16_f32 v16, v48, v49
    v_cvt_pk_bf16_f32 v17, v98, v99
    v_lshlrev_b32 v48, 16, v17
    v_and_b32 v49, 0xffff0000, v17
    v_mul_f32 v50, s72, v48
    v_mul_f32 v51, s72, v49
    v_exp_f32 v50, v50 clamp
    v_exp_f32 v51, v51 clamp
    v_max_f32 v48, 0, v48
    v_max_f32 v49, 0, v49
    v_add_f32 v48, v48, v50
    v_add_f32 v49, v49, v51
    v_min3_f32 v56, v48, v49, v56
    v_cvt_pk_bf16_f32 v17, v48, v49
    v_cvt_pk_bf16_f32 v18, v100, v101
    v_lshlrev_b32 v48, 16, v18
    v_and_b32 v49, 0xffff0000, v18
    v_mul_f32 v50, s72, v48
    v_mul_f32 v51, s72, v49
    v_exp_f32 v50, v50 clamp
    v_exp_f32 v51, v51 clamp
    v_max_f32 v48, 0, v48
    v_max_f32 v49, 0, v49
    v_add_f32 v48, v48, v50
    v_add_f32 v49, v49, v51
    v_min3_f32 v56, v48, v49, v56
    v_cvt_pk_bf16_f32 v18, v48, v49
    v_cvt_pk_bf16_f32 v19, v102, v103
    v_lshlrev_b32 v48, 16, v19
    v_and_b32 v49, 0xffff0000, v19
    v_mul_f32 v50, s72, v48
    v_mul_f32 v51, s72, v49
    v_exp_f32 v50, v50 clamp
    v_exp_f32 v51, v51 clamp
    v_max_f32 v48, 0, v48
    v_max_f32 v49, 0, v49
    v_add_f32 v48, v48, v50
    v_add_f32 v49, v49, v51
    v_min3_f32 v56, v48, v49, v56
    v_cvt_pk_bf16_f32 v19, v48, v49
    v_cvt_pk_bf16_f32 v20, v104, v105
    v_lshlrev_b32 v48, 16, v20
    v_and_b32 v49, 0xffff0000, v20
    v_mul_f32 v50, s72, v48
    v_mul_f32 v51, s72, v49
    v_exp_f32 v50, v50 clamp
    v_exp_f32 v51, v51 clamp
    v_max_f32 v48, 0, v48
    v_max_f32 v49, 0, v49
    v_add_f32 v48, v48, v50
    v_add_f32 v49, v49, v51
    v_min3_f32 v56, v48, v49, v56
    v_cvt_pk_bf16_f32 v20, v48, v49
    v_cvt_pk_bf16_f32 v21, v106, v107
    v_lshlrev_b32 v48, 16, v21
    v_and_b32 v49, 0xffff0000, v21
    v_mul_f32 v50, s72, v48
    v_mul_f32 v51, s72, v49
    v_exp_f32 v50, v50 clamp
    v_exp_f32 v51, v51 clamp
    v_max_f32 v48, 0, v48
    v_max_f32 v49, 0, v49
    v_add_f32 v48, v48, v50
    v_add_f32 v49, v49, v51
    v_min3_f32 v56, v48, v49, v56
    v_cvt_pk_bf16_f32 v21, v48, v49
    v_cvt_pk_bf16_f32 v22, v108, v109
    v_lshlrev_b32 v48, 16, v22
    v_and_b32 v49, 0xffff0000, v22
    v_mul_f32 v50, s72, v48
    v_mul_f32 v51, s72, v49
    v_exp_f32 v50, v50 clamp
    v_exp_f32 v51, v51 clamp
    v_max_f32 v48, 0, v48
    v_max_f32 v49, 0, v49
    v_add_f32 v48, v48, v50
    v_add_f32 v49, v49, v51
    v_min3_f32 v56, v48, v49, v56
    v_cvt_pk_bf16_f32 v22, v48, v49
    v_cvt_pk_bf16_f32 v23, v110, v111
    v_lshlrev_b32 v48, 16, v23
    v_and_b32 v49, 0xffff0000, v23
    v_mul_f32 v50, s72, v48
    v_mul_f32 v51, s72, v49
    v_exp_f32 v50, v50 clamp
    v_exp_f32 v51, v51 clamp
    v_max_f32 v48, 0, v48
    v_max_f32 v49, 0, v49
    v_add_f32 v48, v48, v50
    v_add_f32 v49, v49, v51
    v_min3_f32 v56, v48, v49, v56
    v_cvt_pk_bf16_f32 v23, v48, v49
    v_cmp_gt_f32 vcc, 0x3a800000, v56
    s_cbranch_vccnz phi_15_fix
phi_15_done:
    v_cvt_pk_bf16_f32 v32, v128, v129
    v_cvt_pk_bf16_f32 v33, v130, v131
    v_mfma_f32_16x16x32_bf16 v[52:55], v[236:239], v[16:19], 0
    v_cvt_pk_bf16_f32 v34, v132, v133
    v_mfma_f32_16x16x32_bf16 v[60:63], v[236:239], v[20:23], 0
    v_cvt_pk_bf16_f32 v35, v134, v135
    v_cvt_pk_bf16_f32 v36, v136, v137
    v_cvt_pk_bf16_f32 v37, v138, v139
    v_mfma_f32_16x16x32_bf16 v[240:243], v[16:19], v[32:35], 0
    v_cvt_pk_bf16_f32 v38, v140, v141
    v_mfma_f32_16x16x32_bf16 v[244:247], v[20:23], v[32:35], 0
    v_cvt_pk_bf16_f32 v39, v142, v143
    s_nop 1
    v_mfma_f32_16x16x32_bf16 v[248:251], v[16:19], v[36:39], 0
    v_mfma_f32_16x16x32_bf16 v[252:255], v[20:23], v[36:39], 0
    v_cvt_pk_bf16_f32 v24, v112, v113
    v_lshlrev_b32 v48, 16, v24
    v_and_b32 v49, 0xffff0000, v24
    v_mul_f32 v50, s72, v48
    v_mul_f32 v51, s72, v49
    v_exp_f32 v50, v50 clamp
    v_exp_f32 v51, v51 clamp
    v_max_f32 v48, 0, v48
    v_max_f32 v49, 0, v49
    v_add_f32 v48, v48, v50
    v_add_f32 v49, v49, v51
    v_min_f32 v56, v48, v49
    v_cvt_pk_bf16_f32 v24, v48, v49
    v_cvt_pk_bf16_f32 v25, v114, v115
    v_lshlrev_b32 v48, 16, v25
    v_and_b32 v49, 0xffff0000, v25
    v_mul_f32 v50, s72, v48
    v_mul_f32 v51, s72, v49
    v_exp_f32 v50, v50 clamp
    v_exp_f32 v51, v51 clamp
    v_max_f32 v48, 0, v48
    v_max_f32 v49, 0, v49
    v_add_f32 v48, v48, v50
    v_add_f32 v49, v49, v51
    v_min3_f32 v56, v48, v49, v56
    v_cvt_pk_bf16_f32 v25, v48, v49
    v_cvt_pk_bf16_f32 v26, v116, v117
    v_lshlrev_b32 v48, 16, v26
    v_and_b32 v49, 0xffff0000, v26
    v_mul_f32 v50, s72, v48
    v_mul_f32 v51, s72, v49
    v_exp_f32 v50, v50 clamp
    v_exp_f32 v51, v51 clamp
    v_max_f32 v48, 0, v48
    v_max_f32 v49, 0, v49
    v_add_f32 v48, v48, v50
    v_add_f32 v49, v49, v51
    v_min3_f32 v56, v48, v49, v56
    v_cvt_pk_bf16_f32 v26, v48, v49
    v_cvt_pk_bf16_f32 v27, v118, v119
    v_lshlrev_b32 v48, 16, v27
    v_and_b32 v49, 0xffff0000, v27
    v_mul_f32 v50, s72, v48
    v_mul_f32 v51, s72, v49
    v_exp_f32 v50, v50 clamp
    v_exp_f32 v51, v51 clamp
    v_max_f32 v48, 0, v48
    v_max_f32 v49, 0, v49
    v_add_f32 v48, v48, v50
    v_add_f32 v49, v49, v51
    v_min3_f32 v56, v48, v49, v56
    v_cvt_pk_bf16_f32 v27, v48, v49
    v_cvt_pk_bf16_f32 v28, v120, v121
    v_lshlrev_b32 v48, 16, v28
    v_and_b32 v49, 0xffff0000, v28
    v_mul_f32 v50, s72, v48
    v_mul_f32 v51, s72, v49
    v_exp_f32 v50, v50 clamp
    v_exp_f32 v51, v51 clamp
    v_max_f32 v48, 0, v48
    v_max_f32 v49, 0, v49
    v_add_f32 v48, v48, v50
    v_add_f32 v49, v49, v51
    v_min3_f32 v56, v48, v49, v56
    v_cvt_pk_bf16_f32 v28, v48, v49
    v_cvt_pk_bf16_f32 v29, v122, v123
    v_lshlrev_b32 v48, 16, v29
    v_and_b32 v49, 0xffff0000, v29
    v_mul_f32 v50, s72, v48
    v_mul_f32 v51, s72, v49
    v_exp_f32 v50, v50 clamp
    v_exp_f32 v51, v51 clamp
    v_max_f32 v48, 0, v48
    v_max_f32 v49, 0, v49
    v_add_f32 v48, v48, v50
    v_add_f32 v49, v49, v51
    v_min3_f32 v56, v48, v49, v56
    v_cvt_pk_bf16_f32 v29, v48, v49
    v_cvt_pk_bf16_f32 v30, v124, v125
    v_lshlrev_b32 v48, 16, v30
    v_and_b32 v49, 0xffff0000, v30
    v_mul_f32 v50, s72, v48
    v_mul_f32 v51, s72, v49
    v_exp_f32 v50, v50 clamp
    v_exp_f32 v51, v51 clamp
    v_max_f32 v48, 0, v48
    v_max_f32 v49, 0, v49
    v_add_f32 v48, v48, v50
    v_add_f32 v49, v49, v51
    v_min3_f32 v56, v48, v49, v56
    v_cvt_pk_bf16_f32 v30, v48, v49
    v_cvt_pk_bf16_f32 v31, v126, v127
    v_lshlrev_b32 v48, 16, v31
    v_and_b32 v49, 0xffff0000, v31
    v_mul_f32 v50, s72, v48
    v_mul_f32 v51, s72, v49
    v_exp_f32 v50, v50 clamp
    v_exp_f32 v51, v51 clamp
    v_max_f32 v48, 0, v48
    v_max_f32 v49, 0, v49
    v_add_f32 v48, v48, v50
    v_add_f32 v49, v49, v51
    v_min3_f32 v56, v48, v49, v56
    v_cvt_pk_bf16_f32 v31, v48, v49
    v_cmp_gt_f32 vcc, 0x3a800000, v56
    s_cbranch_vccnz phi_16_fix
phi_16_done:
    v_cvt_pk_bf16_f32 v40, v144, v145
    v_cvt_pk_bf16_f32 v41, v146, v147
    v_mfma_f32_16x16x32_bf16 v[52:55], v[236:239], v[24:27], v[52:55]
    v_cvt_pk_bf16_f32 v42, v148, v149
    v_mfma_f32_16x16x32_bf16 v[60:63], v[236:239], v[28:31], v[60:63]
    v_cvt_pk_bf16_f32 v43, v150, v151
    v_cvt_pk_bf16_f32 v44, v152, v153
    v_cvt_pk_bf16_f32 v45, v154, v155
    v_mfma_f32_16x16x32_bf16 v[240:243], v[24:27], v[40:43], v[240:243]
    v_cvt_pk_bf16_f32 v46, v156, v157
    v_mfma_f32_16x16x32_bf16 v[244:247], v[28:31], v[40:43], v[244:247]
    v_cvt_pk_bf16_f32 v47, v158, v159
    s_nop 1
    v_mfma_f32_16x16x32_bf16 v[248:251], v[24:27], v[44:47], v[248:251]
    v_mfma_f32_16x16x32_bf16 v[252:255], v[28:31], v[44:47], v[252:255]
    s_cmp_eq_u32 s6, 0
    s_cbranch_scc0 C_ex1
    ds_write_b32 v227, v60 offset:4608
    s_nop 5
    ds_write_b128 v224, v[248:251] offset:32768
    ds_write_b128 v224, v[252:255] offset:33792
C_ex2:
    ds_write_b32 v229, v231 offset:4288
C_ps:
    ds_read_b32 v25, v230 offset:4288
    ds_read_b128 v[16:19], v225 offset:32768
    ds_read_b128 v[20:23], v225 offset:33792
    ds_read_b32 v24, v228 offset:4608
    s_waitcnt lgkmcnt(0)
    v_cmp_eq_u32 vcc, 0, v25
    s_cbranch_vccnz C_ps
    v_add_f32 v16, v16, v240
    v_add_f32 v17, v17, v241
    v_add_f32 v18, v18, v242
    v_add_f32 v19, v19, v243
    v_add_f32 v20, v20, v244
    v_add_f32 v21, v21, v245
    v_add_f32 v22, v22, v246
    v_add_f32 v23, v23, v247
    v_add_f32 v24, v24, v52
    v_cvt_pk_bf16_f32 v28, v16, v17
    v_cvt_pk_bf16_f32 v29, v18, v19
    v_cvt_pk_bf16_f32 v30, v20, v21
    v_cvt_pk_bf16_f32 v31, v22, v23
    buffer_store_dwordx4 v[28:31], v3, s[16:19], s43 offen sc0 sc1
    s_mov_b64 exec, 0xffff
    buffer_store_dword v24, v232, s[16:19], s43 offen offset:1024 sc0 sc1
    s_mov_b64 exec, 1
    buffer_atomic_or v233, v234, s[16:19], 0 offen
    s_mov_b64 exec, -1
    ds_read_b64_tr_b16 v[96:97], v10 offset:0
    ds_read_b64_tr_b16 v[98:99], v10 offset:512
    ds_read_b64_tr_b16 v[100:101], v11 offset:0
    ds_read_b64_tr_b16 v[102:103], v11 offset:512
    ds_read_b64_tr_b16 v[104:105], v10 offset:4096
    ds_read_b64_tr_b16 v[106:107], v10 offset:4608
    ds_read_b64_tr_b16 v[108:109], v11 offset:4096
    ds_read_b64_tr_b16 v[110:111], v11 offset:4608
    ds_read_b64_tr_b16 v[112:113], v6 offset:0
    ds_read_b64_tr_b16 v[114:115], v6 offset:512
    ds_read_b64_tr_b16 v[116:117], v7 offset:0
    ds_read_b64_tr_b16 v[118:119], v7 offset:512
    ds_read_b64_tr_b16 v[120:121], v6 offset:4096
    ds_read_b64_tr_b16 v[122:123], v6 offset:4608
    ds_read_b64_tr_b16 v[124:125], v7 offset:4096
    ds_read_b64_tr_b16 v[126:127], v7 offset:4608
    s_waitcnt lgkmcnt(12)
    v_mfma_f32_16x16x32_bf16 v[64:67], v[96:99], v[192:195], v[64:67]
    v_mfma_f32_16x16x32_bf16 v[72:75], v[96:99], v[196:199], v[72:75]
    v_mfma_f32_16x16x32_bf16 v[80:83], v[96:99], v[200:203], v[80:83]
    v_mfma_f32_16x16x32_bf16 v[88:91], v[96:99], v[204:207], v[88:91]
    v_mfma_f32_16x16x32_bf16 v[68:71], v[100:103], v[192:195], v[68:71]
    v_mfma_f32_16x16x32_bf16 v[76:79], v[100:103], v[196:199], v[76:79]
    v_mfma_f32_16x16x32_bf16 v[84:87], v[100:103], v[200:203], v[84:87]
    v_mfma_f32_16x16x32_bf16 v[92:95], v[100:103], v[204:207], v[92:95]
    s_waitcnt lgkmcnt(8)
    v_mfma_f32_16x16x32_bf16 v[64:67], v[104:107], v[160:163], v[64:67]
    v_mfma_f32_16x16x32_bf16 v[72:75], v[104:107], v[164:167], v[72:75]
    v_mfma_f32_16x16x32_bf16 v[80:83], v[104:107], v[168:171], v[80:83]
    v_mfma_f32_16x16x32_bf16 v[88:91], v[104:107], v[172:175], v[88:91]
    v_mfma_f32_16x16x32_bf16 v[68:71], v[108:111], v[160:163], v[68:71]
    v_mfma_f32_16x16x32_bf16 v[76:79], v[108:111], v[164:167], v[76:79]
    v_mfma_f32_16x16x32_bf16 v[84:87], v[108:111], v[168:171], v[84:87]
    v_mfma_f32_16x16x32_bf16 v[92:95], v[108:111], v[172:175], v[92:95]
    s_waitcnt lgkmcnt(4)
    v_mfma_f32_16x16x32_bf16 v[64:67], v[112:115], v[176:179], v[64:67]
    v_mfma_f32_16x16x32_bf16 v[72:75], v[112:115], v[180:183], v[72:75]
    v_mfma_f32_16x16x32_bf16 v[80:83], v[112:115], v[184:187], v[80:83]
    v_mfma_f32_16x16x32_bf16 v[88:91], v[112:115], v[188:191], v[88:91]
    v_mfma_f32_16x16x32_bf16 v[68:71], v[116:119], v[176:179], v[68:71]
    v_mfma_f32_16x16x32_bf16 v[76:79], v[116:119], v[180:183], v[76:79]
    v_mfma_f32_16x16x32_bf16 v[84:87], v[116:119], v[184:187], v[84:87]
    v_mfma_f32_16x16x32_bf16 v[92:95], v[116:119], v[188:191], v[92:95]
    s_waitcnt lgkmcnt(0)
    v_mfma_f32_16x16x32_bf16 v[64:67], v[120:123], v[208:211], v[64:67]
    v_mfma_f32_16x16x32_bf16 v[72:75], v[120:123], v[212:215], v[72:75]
    v_mfma_f32_16x16x32_bf16 v[80:83], v[120:123], v[216:219], v[80:83]
    v_mfma_f32_16x16x32_bf16 v[88:91], v[120:123], v[220:223], v[88:91]
    v_mfma_f32_16x16x32_bf16 v[68:71], v[124:127], v[208:211], v[68:71]
    v_mfma_f32_16x16x32_bf16 v[76:79], v[124:127], v[212:215], v[76:79]
    v_mfma_f32_16x16x32_bf16 v[84:87], v[124:127], v[216:219], v[84:87]
    v_mfma_f32_16x16x32_bf16 v[92:95], v[124:127], v[220:223], v[92:95]
    s_and_b32 s64, s3, 3
    s_lshl_b32 s64, s64, 1
    s_lshr_b32 s65, s3, 2
    s_add_u32 s64, s64, s65
    s_lshl_b32 s64, s64, 4
    s_lshl_b32 s65, s4, 7
    s_add_u32 s64, s64, s65
    v_and_b32 v230, 15, v2
    v_add_u32 v230, s64, v230
    v_bfe_u32 v3, v2, 4, 1
    v_lshlrev_b32 v229, 5, v3
    v_lshrrev_b32 v3, 5, v2
    v_lshl_add_u32 v229, v3, 4, v229
    v_lshl_add_u32 v231, v230, 11, v229
    s_lshl_b32 s64, s5, 7
    v_add_u32 v231, s64, v231
    v_lshlrev_b32 v3, 2, v230
    v_add_u32 v3, 6709248, v3
    buffer_load_dwordx4 v[220:223], v231, s[8:11], 0 offen
    buffer_load_dwordx4 v[224:227], v231, s[8:11], 0 offen offset:64
    buffer_load_dword v228, v3, s[16:19], 0 offen sc1
    v_lshlrev_b32 v3, 4, v2
    s_lshl_b32 s64, s7, 11
    v_add_u32 v4, s64, v3
    v_lshrrev_b32 v5, 4, v2
    v_lshlrev_b32 v5, 4, v5
    s_lshl_b32 s64, s7, 6
    v_add_u32 v5, s64, v5
    v_mov_b32 v6, 4256
    ds_read_b32 v6, v6
    v_cvt_pk_bf16_f32 v32, v64, v65
    v_lshlrev_b32 v48, 16, v32
    v_and_b32 v49, 0xffff0000, v32
    v_mul_f32 v50, s72, v48
    v_mul_f32 v51, s72, v49
    v_exp_f32 v50, v50 clamp
    v_exp_f32 v51, v51 clamp
    v_max_f32 v48, 0, v48
    v_max_f32 v49, 0, v49
    v_add_f32 v48, v48, v50
    v_add_f32 v49, v49, v51
    v_min_f32 v56, v48, v49
    v_cvt_pk_bf16_f32 v32, v48, v49
    v_cvt_pk_bf16_f32 v33, v66, v67
    v_lshlrev_b32 v48, 16, v33
    v_and_b32 v49, 0xffff0000, v33
    v_mul_f32 v50, s72, v48
    v_mul_f32 v51, s72, v49
    v_exp_f32 v50, v50 clamp
    v_exp_f32 v51, v51 clamp
    v_max_f32 v48, 0, v48
    v_max_f32 v49, 0, v49
    v_add_f32 v48, v48, v50
    v_add_f32 v49, v49, v51
    v_min3_f32 v56, v48, v49, v56
    v_cvt_pk_bf16_f32 v33, v48, v49
    v_cvt_pk_bf16_f32 v34, v68, v69
    v_lshlrev_b32 v48, 16, v34
    v_and_b32 v49, 0xffff0000, v34
    v_mul_f32 v50, s72, v48
    v_mul_f32 v51, s72, v49
    v_exp_f32 v50, v50 clamp
    v_exp_f32 v51, v51 clamp
    v_max_f32 v48, 0, v48
    v_max_f32 v49, 0, v49
    v_add_f32 v48, v48, v50
    v_add_f32 v49, v49, v51
    v_min3_f32 v56, v48, v49, v56
    v_cvt_pk_bf16_f32 v34, v48, v49
    v_cvt_pk_bf16_f32 v35, v70, v71
    v_lshlrev_b32 v48, 16, v35
    v_and_b32 v49, 0xffff0000, v35
    v_mul_f32 v50, s72, v48
    v_mul_f32 v51, s72, v49
    v_exp_f32 v50, v50 clamp
    v_exp_f32 v51, v51 clamp
    v_max_f32 v48, 0, v48
    v_max_f32 v49, 0, v49
    v_add_f32 v48, v48, v50
    v_add_f32 v49, v49, v51
    v_min3_f32 v56, v48, v49, v56
    v_cvt_pk_bf16_f32 v35, v48, v49
    v_cvt_pk_bf16_f32 v36, v72, v73
    v_lshlrev_b32 v48, 16, v36
    v_and_b32 v49, 0xffff0000, v36
    v_mul_f32 v50, s72, v48
    v_mul_f32 v51, s72, v49
    v_exp_f32 v50, v50 clamp
    v_exp_f32 v51, v51 clamp
    v_max_f32 v48, 0, v48
    v_max_f32 v49, 0, v49
    v_add_f32 v48, v48, v50
    v_add_f32 v49, v49, v51
    v_min3_f32 v56, v48, v49, v56
    v_cvt_pk_bf16_f32 v36, v48, v49
    v_cvt_pk_bf16_f32 v37, v74, v75
    v_lshlrev_b32 v48, 16, v37
    v_and_b32 v49, 0xffff0000, v37
    v_mul_f32 v50, s72, v48
    v_mul_f32 v51, s72, v49
    v_exp_f32 v50, v50 clamp
    v_exp_f32 v51, v51 clamp
    v_max_f32 v48, 0, v48
    v_max_f32 v49, 0, v49
    v_add_f32 v48, v48, v50
    v_add_f32 v49, v49, v51
    v_min3_f32 v56, v48, v49, v56
    v_cvt_pk_bf16_f32 v37, v48, v49
    v_cvt_pk_bf16_f32 v38, v76, v77
    v_lshlrev_b32 v48, 16, v38
    v_and_b32 v49, 0xffff0000, v38
    v_mul_f32 v50, s72, v48
    v_mul_f32 v51, s72, v49
    v_exp_f32 v50, v50 clamp
    v_exp_f32 v51, v51 clamp
    v_max_f32 v48, 0, v48
    v_max_f32 v49, 0, v49
    v_add_f32 v48, v48, v50
    v_add_f32 v49, v49, v51
    v_min3_f32 v56, v48, v49, v56
    v_cvt_pk_bf16_f32 v38, v48, v49
    v_cvt_pk_bf16_f32 v39, v78, v79
    v_lshlrev_b32 v48, 16, v39
    v_and_b32 v49, 0xffff0000, v39
    v_mul_f32 v50, s72, v48
    v_mul_f32 v51, s72, v49
    v_exp_f32 v50, v50 clamp
    v_exp_f32 v51, v51 clamp
    v_max_f32 v48, 0, v48
    v_max_f32 v49, 0, v49
    v_add_f32 v48, v48, v50
    v_add_f32 v49, v49, v51
    v_min3_f32 v56, v48, v49, v56
    v_cvt_pk_bf16_f32 v39, v48, v49
    v_cmp_gt_f32 vcc, 0x3a800000, v56
    s_cbranch_vccnz phi_17_fix
phi_17_done:
    v_cvt_pk_bf16_f32 v40, v80, v81
    v_lshlrev_b32 v48, 16, v40
    v_and_b32 v49, 0xffff0000, v40
    v_mul_f32 v50, s72, v48
    v_mul_f32 v51, s72, v49
    v_exp_f32 v50, v50 clamp
    v_exp_f32 v51, v51 clamp
    v_max_f32 v48, 0, v48
    v_max_f32 v49, 0, v49
    v_add_f32 v48, v48, v50
    v_add_f32 v49, v49, v51
    v_min_f32 v56, v48, v49
    v_cvt_pk_bf16_f32 v40, v48, v49
    v_cvt_pk_bf16_f32 v41, v82, v83
    v_lshlrev_b32 v48, 16, v41
    v_and_b32 v49, 0xffff0000, v41
    v_mul_f32 v50, s72, v48
    v_mul_f32 v51, s72, v49
    v_exp_f32 v50, v50 clamp
    v_exp_f32 v51, v51 clamp
    v_max_f32 v48, 0, v48
    v_max_f32 v49, 0, v49
    v_add_f32 v48, v48, v50
    v_add_f32 v49, v49, v51
    v_min3_f32 v56, v48, v49, v56
    v_cvt_pk_bf16_f32 v41, v48, v49
    v_cvt_pk_bf16_f32 v42, v84, v85
    v_lshlrev_b32 v48, 16, v42
    v_and_b32 v49, 0xffff0000, v42
    v_mul_f32 v50, s72, v48
    v_mul_f32 v51, s72, v49
    v_exp_f32 v50, v50 clamp
    v_exp_f32 v51, v51 clamp
    v_max_f32 v48, 0, v48
    v_max_f32 v49, 0, v49
    v_add_f32 v48, v48, v50
    v_add_f32 v49, v49, v51
    v_min3_f32 v56, v48, v49, v56
    v_cvt_pk_bf16_f32 v42, v48, v49
    v_cvt_pk_bf16_f32 v43, v86, v87
    v_lshlrev_b32 v48, 16, v43
    v_and_b32 v49, 0xffff0000, v43
    v_mul_f32 v50, s72, v48
    v_mul_f32 v51, s72, v49
    v_exp_f32 v50, v50 clamp
    v_exp_f32 v51, v51 clamp
    v_max_f32 v48, 0, v48
    v_max_f32 v49, 0, v49
    v_add_f32 v48, v48, v50
    v_add_f32 v49, v49, v51
    v_min3_f32 v56, v48, v49, v56
    v_cvt_pk_bf16_f32 v43, v48, v49
    v_cvt_pk_bf16_f32 v44, v88, v89
    v_lshlrev_b32 v48, 16, v44
    v_and_b32 v49, 0xffff0000, v44
    v_mul_f32 v50, s72, v48
    v_mul_f32 v51, s72, v49
    v_exp_f32 v50, v50 clamp
    v_exp_f32 v51, v51 clamp
    v_max_f32 v48, 0, v48
    v_max_f32 v49, 0, v49
    v_add_f32 v48, v48, v50
    v_add_f32 v49, v49, v51
    v_min3_f32 v56, v48, v49, v56
    v_cvt_pk_bf16_f32 v44, v48, v49
    v_cvt_pk_bf16_f32 v45, v90, v91
    v_lshlrev_b32 v48, 16, v45
    v_and_b32 v49, 0xffff0000, v45
    v_mul_f32 v50, s72, v48
    v_mul_f32 v51, s72, v49
    v_exp_f32 v50, v50 clamp
    v_exp_f32 v51, v51 clamp
    v_max_f32 v48, 0, v48
    v_max_f32 v49, 0, v49
    v_add_f32 v48, v48, v50
    v_add_f32 v49, v49, v51
    v_min3_f32 v56, v48, v49, v56
    v_cvt_pk_bf16_f32 v45, v48, v49
    v_cvt_pk_bf16_f32 v46, v92, v93
    v_lshlrev_b32 v48, 16, v46
    v_and_b32 v49, 0xffff0000, v46
    v_mul_f32 v50, s72, v48
    v_mul_f32 v51, s72, v49
    v_exp_f32 v50, v50 clamp
    v_exp_f32 v51, v51 clamp
    v_max_f32 v48, 0, v48
    v_max_f32 v49, 0, v49
    v_add_f32 v48, v48, v50
    v_add_f32 v49, v49, v51
    v_min3_f32 v56, v48, v49, v56
    v_cvt_pk_bf16_f32 v46, v48, v49
    v_cvt_pk_bf16_f32 v47, v94, v95
    v_lshlrev_b32 v48, 16, v47
    v_and_b32 v49, 0xffff0000, v47
    v_mul_f32 v50, s72, v48
    v_mul_f32 v51, s72, v49
    v_exp_f32 v50, v50 clamp
    v_exp_f32 v51, v51 clamp
    v_max_f32 v48, 0, v48
    v_max_f32 v49, 0, v49
    v_add_f32 v48, v48, v50
    v_add_f32 v49, v49, v51
    v_min3_f32 v56, v48, v49, v56
    v_cvt_pk_bf16_f32 v47, v48, v49
    v_cmp_gt_f32 vcc, 0x3a800000, v56
    s_cbranch_vccnz phi_18_fix
phi_18_done:
    s_waitcnt lgkmcnt(0)
    v_readfirstlane_b32 s75, v6
    s_waitcnt vmcnt(0)
    v_sub_f32 v248, 1.0, v228
    v_cvt_pk_bf16_f32 v248, v248, v248
    v_lshlrev_b32 v248, 16, v248
    v_lshlrev_b32 v232, 16, v220
    v_and_b32 v233, 0xffff0000, v220
    v_mul_f32 v232, v232, v248
    v_mul_f32 v233, v233, v248
    v_cvt_pk_bf16_f32 v3, v232, v233
    v_lshlrev_b32 v232, 16, v3
    v_and_b32 v233, 0xffff0000, v3
    v_lshlrev_b32 v234, 16, v221
    v_and_b32 v235, 0xffff0000, v221
    v_mul_f32 v234, v234, v248
    v_mul_f32 v235, v235, v248
    v_cvt_pk_bf16_f32 v3, v234, v235
    v_lshlrev_b32 v234, 16, v3
    v_and_b32 v235, 0xffff0000, v3
    v_lshlrev_b32 v236, 16, v222
    v_and_b32 v237, 0xffff0000, v222
    v_mul_f32 v236, v236, v248
    v_mul_f32 v237, v237, v248
    v_cvt_pk_bf16_f32 v3, v236, v237
    v_lshlrev_b32 v236, 16, v3
    v_and_b32 v237, 0xffff0000, v3
    v_lshlrev_b32 v238, 16, v223
    v_and_b32 v239, 0xffff0000, v223
    v_mul_f32 v238, v238, v248
    v_mul_f32 v239, v239, v248
    v_cvt_pk_bf16_f32 v3, v238, v239
    v_lshlrev_b32 v238, 16, v3
    v_and_b32 v239, 0xffff0000, v3
    v_lshlrev_b32 v240, 16, v224
    v_and_b32 v241, 0xffff0000, v224
    v_mul_f32 v240, v240, v248
    v_mul_f32 v241, v241, v248
    v_cvt_pk_bf16_f32 v3, v240, v241
    v_lshlrev_b32 v240, 16, v3
    v_and_b32 v241, 0xffff0000, v3
    v_lshlrev_b32 v242, 16, v225
    v_and_b32 v243, 0xffff0000, v225
    v_mul_f32 v242, v242, v248
    v_mul_f32 v243, v243, v248
    v_cvt_pk_bf16_f32 v3, v242, v243
    v_lshlrev_b32 v242, 16, v3
    v_and_b32 v243, 0xffff0000, v3
    v_lshlrev_b32 v244, 16, v226
    v_and_b32 v245, 0xffff0000, v226
    v_mul_f32 v244, v244, v248
    v_mul_f32 v245, v245, v248
    v_cvt_pk_bf16_f32 v3, v244, v245
    v_lshlrev_b32 v244, 16, v3
    v_and_b32 v245, 0xffff0000, v3
    v_lshlrev_b32 v246, 16, v227
    v_and_b32 v247, 0xffff0000, v227
    v_mul_f32 v246, v246, v248
    v_mul_f32 v247, v247, v248
    v_cvt_pk_bf16_f32 v3, v246, v247
    v_lshlrev_b32 v246, 16, v3
    v_and_b32 v247, 0xffff0000, v3
    s_cmp_lg_u32 s3, 0
    s_cbranch_scc1 C_nh
    s_lshr_b32 s64, s2, 2
    s_lshl_b32 s64, s64, 14
    s_add_u32 s64, s64, 5398528
    v_lshl_add_u32 v16, v2, 4, s64
    v_lshrrev_b32 v8, 4, v2
    s_mov_b32 s65, 0
H_hl:
    s_mov_b32 s64, 0
    buffer_load_dwordx4 v[64:67], v16, s[16:19], s64 offen offset:0 sc1
    s_mov_b32 s64, 0
    buffer_load_dwordx4 v[68:71], v16, s[16:19], s64 offen offset:1024 sc1
    s_mov_b32 s64, 0
    buffer_load_dwordx4 v[72:75], v16, s[16:19], s64 offen offset:2048 sc1
    s_mov_b32 s64, 0
    buffer_load_dwordx4 v[76:79], v16, s[16:19], s64 offen offset:3072 sc1
    s_mov_b32 s64, 4096
    buffer_load_dwordx4 v[80:83], v16, s[16:19], s64 offen offset:0 sc1
    s_mov_b32 s64, 4096
    buffer_load_dwordx4 v[84:87], v16, s[16:19], s64 offen offset:1024 sc1
    s_mov_b32 s64, 4096
    buffer_load_dwordx4 v[88:91], v16, s[16:19], s64 offen offset:2048 sc1
    s_mov_b32 s64, 4096
    buffer_load_dwordx4 v[92:95], v16, s[16:19], s64 offen offset:3072 sc1
    s_mov_b32 s64, 8192
    buffer_load_dwordx4 v[96:99], v16, s[16:19], s64 offen offset:0 sc1
    s_mov_b32 s64, 8192
    buffer_load_dwordx4 v[100:103], v16, s[16:19], s64 offen offset:1024 sc1
    s_mov_b32 s64, 8192
    buffer_load_dwordx4 v[104:107], v16, s[16:19], s64 offen offset:2048 sc1
    s_mov_b32 s64, 8192
    buffer_load_dwordx4 v[108:111], v16, s[16:19], s64 offen offset:3072 sc1
    s_mov_b32 s64, 12288
    buffer_load_dwordx4 v[112:115], v16, s[16:19], s64 offen offset:0 sc1
    s_mov_b32 s64, 12288
    buffer_load_dwordx4 v[116:119], v16, s[16:19], s64 offen offset:1024 sc1
    s_mov_b32 s64, 12288
    buffer_load_dwordx4 v[120:123], v16, s[16:19], s64 offen offset:2048 sc1
    s_mov_b32 s64, 12288
    buffer_load_dwordx4 v[124:127], v16, s[16:19], s64 offen offset:3072 sc1
    s_waitcnt vmcnt(0)
    v_max3_u32 v17, v64, v65, v66
    v_max3_u32 v17, v67, v68, v17
    v_max3_u32 v17, v69, v70, v17
    v_max3_u32 v17, v71, v72, v17
    v_max3_u32 v17, v73, v74, v17
    v_max3_u32 v17, v75, v76, v17
    v_max3_u32 v17, v77, v78, v17
    v_max3_u32 v17, v79, v80, v17
    v_max3_u32 v17, v81, v82, v17
    v_max3_u32 v17, v83, v84, v17
    v_max3_u32 v17, v85, v86, v17
    v_max3_u32 v17, v87, v88, v17
    v_max3_u32 v17, v89, v90, v17
    v_max3_u32 v17, v91, v92, v17
    v_max3_u32 v17, v93, v94, v17
    v_max3_u32 v17, v95, v96, v17
    v_max3_u32 v17, v97, v98, v17
    v_max3_u32 v17, v99, v100, v17
    v_max3_u32 v17, v101, v102, v17
    v_max3_u32 v17, v103, v104, v17
    v_max3_u32 v17, v105, v106, v17
    v_max3_u32 v17, v107, v108, v17
    v_max3_u32 v17, v109, v110, v17
    v_max3_u32 v17, v111, v112, v17
    v_max3_u32 v17, v113, v114, v17
    v_max3_u32 v17, v115, v116, v17
    v_max3_u32 v17, v117, v118, v17
    v_max3_u32 v17, v119, v120, v17
    v_max3_u32 v17, v121, v122, v17
    v_max3_u32 v17, v123, v124, v17
    v_max3_u32 v17, v125, v126, v17
    v_max_u32 v17, v127, v17
    s_mov_b32 exec_lo, 0x3fff3fff
    s_mov_b32 exec_hi, 0x3fff3fff
    v_cmp_eq_u32 vcc, -1, v17
    s_mov_b64 exec, -1
    s_cbranch_vccz H_hok
    s_add_u32 s65, s65, 1
    s_cmp_ge_u32 s65, 100000
    s_cbranch_scc1 H_hok
    s_sleep 8
    s_branch H_hl
H_hok:
    v_add_f32 v64, v64, v68
    v_add_f32 v65, v65, v69
    v_add_f32 v66, v66, v70
    v_add_f32 v67, v67, v71
    v_add_f32 v64, v64, v72
    v_add_f32 v65, v65, v73
    v_add_f32 v66, v66, v74
    v_add_f32 v67, v67, v75
    v_add_f32 v64, v64, v76
    v_add_f32 v65, v65, v77
    v_add_f32 v66, v66, v78
    v_add_f32 v67, v67, v79
    v_add_f32 v64, v64, v80
    v_add_f32 v65, v65, v81
    v_add_f32 v66, v66, v82
    v_add_f32 v67, v67, v83
    v_add_f32 v64, v64, v84
    v_add_f32 v65, v65, v85
    v_add_f32 v66, v66, v86
    v_add_f32 v67, v67, v87
    v_add_f32 v64, v64, v88
    v_add_f32 v65, v65, v89
    v_add_f32 v66, v66, v90
    v_add_f32 v67, v67, v91
    v_add_f32 v64, v64, v92
    v_add_f32 v65, v65, v93
    v_add_f32 v66, v66, v94
    v_add_f32 v67, v67, v95
    v_add_f32 v96, v96, v100
    v_add_f32 v97, v97, v101
    v_add_f32 v98, v98, v102
    v_add_f32 v99, v99, v103
    v_add_f32 v96, v96, v104
    v_add_f32 v97, v97, v105
    v_add_f32 v98, v98, v106
    v_add_f32 v99, v99, v107
    v_add_f32 v96, v96, v108
    v_add_f32 v97, v97, v109
    v_add_f32 v98, v98, v110
    v_add_f32 v99, v99, v111
    v_add_f32 v96, v96, v112
    v_add_f32 v97, v97, v113
    v_add_f32 v98, v98, v114
    v_add_f32 v99, v99, v115
    v_add_f32 v96, v96, v116
    v_add_f32 v97, v97, v117
    v_add_f32 v98, v98, v118
    v_add_f32 v99, v99, v119
    v_add_f32 v96, v96, v120
    v_add_f32 v97, v97, v121
    v_add_f32 v98, v98, v122
    v_add_f32 v99, v99, v123
    v_add_f32 v96, v96, v124
    v_add_f32 v97, v97, v125
    v_add_f32 v98, v98, v126
    v_add_f32 v99, v99, v127
    s_nop 1
    v_permlane16_swap_b32 v64, v96
    v_permlane16_swap_b32 v65, v97
    v_permlane16_swap_b32 v66, v98
    v_permlane16_swap_b32 v67, v99
    v_add_f32 v64, v64, v96
    v_add_f32 v65, v65, v97
    v_add_f32 v66, v66, v98
    v_add_f32 v67, v67, v99
    s_nop 1
    v_permlane32_swap_b32 v64, v66
    v_permlane32_swap_b32 v65, v67
    v_add_f32 v64, v64, v66
    v_add_f32 v65, v65, v67
    s_nop 1
    v_permlane16_swap_b32 v64, v65
    v_cvt_pk_bf16_f32 v66, v64, v65
    v_lshlrev_b32 v64, 16, v66
    v_and_b32 v65, 0xffff0000, v66
    v_mul_f32 v66, s72, v64
    v_exp_f32 v66, -v66
    v_and_b32 v16, 15, v2
    v_add_f32 v66, 1.0, v66
    v_rcp_f32 v66, v66
    v_lshl_add_u32 v16, v16, 2, v8
    v_mul_f32 v66, v66, v64
    v_cvt_pk_bf16_f32 v66, v66, v66
    v_lshlrev_b32 v66, 16, v66
    v_mul_f32 v66, v66, v65
    v_cvt_pk_bf16_f32 v66, v66, v66
    v_lshlrev_b32 v66, 16, v66
    v_lshlrev_b32 v16, 2, v16
    ds_write_b32 v16, v66 offset:4352
    s_waitcnt lgkmcnt(0)
C_nh:
    v_lshlrev_b32 v3, 4, v2
    s_barrier
    ds_read_b128 v[24:27], v5 offset:4096
    ds_read_b128 v[16:19], v4 offset:0
    ds_read_b128 v[20:23], v4 offset:1024
    s_waitcnt lgkmcnt(2)
    v_mfma_f32_16x16x32_bf16 v[96:99], v[24:27], v[32:35], 0
    v_mfma_f32_16x16x32_bf16 v[100:103], v[24:27], v[36:39], 0
    v_mfma_f32_16x16x32_bf16 v[104:107], v[24:27], v[40:43], 0
    v_mfma_f32_16x16x32_bf16 v[108:111], v[24:27], v[44:47], 0
    s_waitcnt lgkmcnt(0)
    v_mfma_f32_16x16x32_bf16 v[64:67], v[16:19], v[32:35], 0
    v_mfma_f32_16x16x32_bf16 v[68:71], v[20:23], v[32:35], 0
    v_mfma_f32_16x16x32_bf16 v[72:75], v[16:19], v[36:39], 0
    v_mfma_f32_16x16x32_bf16 v[76:79], v[20:23], v[36:39], 0
    v_mfma_f32_16x16x32_bf16 v[80:83], v[16:19], v[40:43], 0
    v_mfma_f32_16x16x32_bf16 v[84:87], v[20:23], v[40:43], 0
    v_mfma_f32_16x16x32_bf16 v[88:91], v[16:19], v[44:47], 0
    v_mfma_f32_16x16x32_bf16 v[92:95], v[20:23], v[44:47], 0
    v_cvt_pk_bf16_f32 v48, v96, v96
    v_cvt_pk_bf16_f32 v49, v100, v100
    v_cvt_pk_bf16_f32 v50, v104, v104
    v_cvt_pk_bf16_f32 v51, v108, v108
    v_lshlrev_b32 v48, 16, v48
    v_lshlrev_b32 v49, 16, v49
    v_lshlrev_b32 v50, 16, v50
    v_lshlrev_b32 v51, 16, v51
    v_add_f32 v48, s73, v48
    v_add_f32 v49, s73, v49
    v_add_f32 v50, s73, v50
    v_add_f32 v51, s73, v51
    v_cvt_pk_bf16_f32 v48, v48, v48
    v_cvt_pk_bf16_f32 v49, v49, v49
    v_cvt_pk_bf16_f32 v50, v50, v50
    v_cvt_pk_bf16_f32 v51, v51, v51
    v_lshlrev_b32 v48, 16, v48
    v_lshlrev_b32 v49, 16, v49
    v_lshlrev_b32 v50, 16, v50
    v_lshlrev_b32 v51, 16, v51
    v_rcp_f32 v48, v48
    v_rcp_f32 v49, v49
    v_rcp_f32 v50, v50
    v_rcp_f32 v51, v51
    s_nop 0
    v_mul_f32 v64, v64, v48
    v_mul_f32 v65, v65, v48
    v_cvt_pk_bf16_f32 v128, v64, v65
    v_mul_f32 v66, v66, v48
    v_mul_f32 v67, v67, v48
    v_cvt_pk_bf16_f32 v129, v66, v67
    v_mul_f32 v68, v68, v48
    v_mul_f32 v69, v69, v48
    v_cvt_pk_bf16_f32 v130, v68, v69
    v_mul_f32 v70, v70, v48
    v_mul_f32 v71, v71, v48
    v_cvt_pk_bf16_f32 v131, v70, v71
    buffer_store_dwordx4 v[128:131], v3, s[16:19], s42 offen offset:0 sc0 sc1
    v_mul_f32 v72, v72, v49
    v_mul_f32 v73, v73, v49
    v_cvt_pk_bf16_f32 v132, v72, v73
    v_mul_f32 v74, v74, v49
    v_mul_f32 v75, v75, v49
    v_cvt_pk_bf16_f32 v133, v74, v75
    v_mul_f32 v76, v76, v49
    v_mul_f32 v77, v77, v49
    v_cvt_pk_bf16_f32 v134, v76, v77
    v_mul_f32 v78, v78, v49
    v_mul_f32 v79, v79, v49
    v_cvt_pk_bf16_f32 v135, v78, v79
    buffer_store_dwordx4 v[132:135], v3, s[16:19], s42 offen offset:1024 sc0 sc1
    s_add_u32 s42, s42, 65536
    v_mul_f32 v80, v80, v50
    v_mul_f32 v81, v81, v50
    v_cvt_pk_bf16_f32 v136, v80, v81
    v_mul_f32 v82, v82, v50
    v_mul_f32 v83, v83, v50
    v_cvt_pk_bf16_f32 v137, v82, v83
    v_mul_f32 v84, v84, v50
    v_mul_f32 v85, v85, v50
    v_cvt_pk_bf16_f32 v138, v84, v85
    v_mul_f32 v86, v86, v50
    v_mul_f32 v87, v87, v50
    v_cvt_pk_bf16_f32 v139, v86, v87
    buffer_store_dwordx4 v[136:139], v3, s[16:19], s42 offen offset:0 sc0 sc1
    v_mul_f32 v88, v88, v51
    v_mul_f32 v89, v89, v51
    v_cvt_pk_bf16_f32 v140, v88, v89
    v_mul_f32 v90, v90, v51
    v_mul_f32 v91, v91, v51
    v_cvt_pk_bf16_f32 v141, v90, v91
    v_mul_f32 v92, v92, v51
    v_mul_f32 v93, v93, v51
    v_cvt_pk_bf16_f32 v142, v92, v93
    v_mul_f32 v94, v94, v51
    v_mul_f32 v95, v95, v51
    v_cvt_pk_bf16_f32 v143, v94, v95
    buffer_store_dwordx4 v[140:143], v3, s[16:19], s42 offen offset:1024 sc0 sc1
    s_lshl_b32 s64, s4, 3
    s_add_u32 s64, s64, s3
    s_lshl_b32 s64, s64, 7
    s_add_u32 s64, s64, 5382144
    v_mov_b32 v14, s64
    s_mov_b64 exec, 1
    v_mov_b32 v15, 0
    buffer_atomic_or v15, v14, s[16:19], 0 offen sc0
    s_mov_b64 exec, -1
    s_waitcnt vmcnt(1)
    s_mov_b64 exec, 3
    buffer_atomic_or v13, v12, s[16:19], 0 offen
    s_mov_b64 exec, -1
P2_start:
    s_and_b32 s6, s3, 3
    s_lshr_b32 s7, s3, 2
    s_mov_b32 s20, s58
    s_mov_b32 s21, s59
    s_mov_b32 s22, 0x400000
    s_mov_b32 s23, 0x00020000
    s_and_b32 s67, s75, 0x7ff
    s_sub_u32 s67, 2047, s67
    s_lshl_b32 s64, s4, 2
    s_add_u32 s64, s64, s6
    s_lshl_b32 s64, s64, 16
    s_lshl_b32 s65, s7, 15
    s_add_u32 s64, s64, s65
    s_lshl_b32 s65, s7, 10
    s_add_u32 s66, s64, s65
    s_sub_u32 s64, s64, s65
    v_lshl_add_u32 v4, v2, 4, s66
    v_lshl_add_u32 v12, v2, 4, s64
    v_lshrrev_b32 v10, 4, v2
    v_bfe_u32 v11, v2, 2, 2
    v_lshl_add_u32 v10, v10, 2, v11
    v_bfe_u32 v13, v10, 1, 2
    v_lshlrev_b32 v10, 7, v10
    v_lshl_add_u32 v10, v13, 5, v10
    v_and_b32 v13, 3, v2
    v_lshl_add_u32 v5, v13, 3, v10
    v_xor_b32 v6, 32, v5
    v_xor_b32 v1, 64, v5
    v_xor_b32 v3, 96, v5
    s_lshl_b32 s74, s74, 1
    s_cmp_eq_u32 s7, 0
    s_mov_b32 s64, 147456
    s_cselect_b32 s64, 131072, s64
    s_sub_u32 m0, 16, s74
    s_and_b32 m0, m0, 15
    v_writelane_b32 v7, s64, m0
    s_cmp_eq_u32 s7, 0
    s_mov_b32 s64, 155648
    s_cselect_b32 s64, 139264, s64
    s_sub_u32 m0, 18, s74
    s_and_b32 m0, m0, 15
    v_writelane_b32 v7, s64, m0
    s_cmp_eq_u32 s7, 0
    s_mov_b32 s64, 81920
    s_cselect_b32 s64, 73728, s64
    s_sub_u32 m0, 20, s74
    s_and_b32 m0, m0, 15
    v_writelane_b32 v7, s64, m0
    s_cmp_eq_u32 s7, 0
    s_mov_b32 s64, 122880
    s_cselect_b32 s64, 114688, s64
    s_sub_u32 m0, 22, s74
    s_and_b32 m0, m0, 15
    v_writelane_b32 v7, s64, m0
    s_cmp_eq_u32 s7, 0
    s_mov_b32 s64, 49152
    s_cselect_b32 s64, 40960, s64
    s_sub_u32 m0, 24, s74
    s_and_b32 m0, m0, 15
    v_writelane_b32 v7, s64, m0
    s_cmp_eq_u32 s7, 0
    s_mov_b32 s64, 57344
    s_cselect_b32 s64, 8192, s64
    s_sub_u32 m0, 26, s74
    s_and_b32 m0, m0, 15
    v_writelane_b32 v7, s64, m0
    s_cmp_eq_u32 s7, 0
    s_mov_b32 s64, 65536
    s_cselect_b32 s64, 16384, s64
    s_sub_u32 m0, 28, s74
    s_and_b32 m0, m0, 15
    v_writelane_b32 v7, s64, m0
    s_cmp_eq_u32 s7, 0
    s_mov_b32 s64, 90112
    s_cselect_b32 s64, 98304, s64
    s_sub_u32 m0, 30, s74
    s_and_b32 m0, m0, 15
    v_writelane_b32 v7, s64, m0
    s_cmp_eq_u32 s7, 0
    v_mov_b32 v16, 0
    v_mov_b32 v17, 0
    v_mov_b32 v18, 0
    v_mov_b32 v19, 0
    v_mov_b32 v20, 0
    v_mov_b32 v21, 0
    v_mov_b32 v22, 0
    v_mov_b32 v23, 0
    v_mov_b32 v24, 0
    v_mov_b32 v25, 0
    v_mov_b32 v26, 0
    v_mov_b32 v27, 0
    v_mov_b32 v28, 0
    v_mov_b32 v29, 0
    v_mov_b32 v30, 0
    v_mov_b32 v31, 0
    v_mov_b32 v32, 0
    v_mov_b32 v33, 0
    v_mov_b32 v34, 0
    v_mov_b32 v35, 0
    v_mov_b32 v36, 0
    v_mov_b32 v37, 0
    v_mov_b32 v38, 0
    v_mov_b32 v39, 0
    v_mov_b32 v40, 0
    v_mov_b32 v41, 0
    v_mov_b32 v42, 0
    v_mov_b32 v43, 0
    v_mov_b32 v44, 0
    v_mov_b32 v45, 0
    v_mov_b32 v46, 0
    v_mov_b32 v47, 0
    s_lshr_b32 s46, s67, 7
    s_xor_b32 s46, s46, s4
    s_or_b32 s46, s46, s3
    s_mov_b32 s47, 0
    s_cbranch_scc0 P2_ys
P2_ysd:
    s_mov_b32 s66, 0x5555
    s_mov_b32 s65, 0
    s_cmp_lt_u32 s3, 4
    s_cbranch_scc0 D_wait
    s_waitcnt vmcnt(1)
    s_branch D_got
D_wait:
    s_waitcnt vmcnt(0)
D_got:
    v_readfirstlane_b32 s68, v15
    s_mul_i32 s68, s68, 0x10001
    s_lshr_b32 s68, s68, s74
    s_lshr_b32 s64, s68, 1
    s_and_b32 s68, s68, s64
    s_and_b32 s68, s68, s66
    s_cbranch_scc1 D_go
    s_add_u32 s65, s65, 1
    s_cmp_ge_u32 s65, 40000
    s_cbranch_scc1 D_end
    s_sleep 1
    s_mov_b64 exec, 1
    v_mov_b32 v15, 0
    buffer_atomic_or v15, v14, s[16:19], 0 offen sc0
    s_mov_b64 exec, -1
    s_branch D_wait
D_go:
    s_andn2_b32 s66, s66, s68
    s_bcnt1_i32_b32 s70, s68
    s_or_b32 s64, s46, s66
    s_cbranch_scc0 P2_yl
P2_nyl:
    s_cmp_gt_u32 s70, 4
    s_cbranch_scc1 D_t58
    s_cmp_gt_u32 s70, 2
    s_cbranch_scc1 D_t34
    s_cmp_eq_u32 s70, 2
    s_cbranch_scc1 D_e2
D_e1:
    s_ff1_i32_b32 s64, s68
    s_bitset0_b32 s68, s64
    v_readlane_b32 s32, v7, s64
    s_add_u32 s69, s64, s74
    s_and_b32 s69, s69, 15
    s_lshl_b32 s69, s69, 11
    buffer_load_dwordx4 v[80:83], v4, s[16:19], s69 offen offset:0 sc1
    buffer_load_dwordx4 v[84:87], v12, s[16:19], s69 offen offset:1024 sc1
    buffer_load_dwordx4 v[88:91], v4, s[16:19], s69 offen offset:2048 sc1
    buffer_load_dwordx4 v[92:95], v12, s[16:19], s69 offen offset:3072 sc1
    s_mov_b64 exec, 1
    v_mov_b32 v15, 0
    buffer_atomic_or v15, v14, s[16:19], 0 offen sc0
    s_mov_b64 exec, -1
    v_add_u32 v8, s32, v5
    ds_read_b64_tr_b16 v[48:49], v8 offset:0
    ds_read_b64_tr_b16 v[50:51], v8 offset:2048
    v_add_u32 v9, s32, v6
    ds_read_b64_tr_b16 v[52:53], v9 offset:0
    ds_read_b64_tr_b16 v[54:55], v9 offset:2048
    v_add_u32 v10, s32, v1
    ds_read_b64_tr_b16 v[56:57], v10 offset:0
    ds_read_b64_tr_b16 v[58:59], v10 offset:2048
    v_add_u32 v11, s32, v3
    ds_read_b64_tr_b16 v[60:61], v11 offset:0
    ds_read_b64_tr_b16 v[62:63], v11 offset:2048
    s_branch D_p0
D_e2:
    s_ff1_i32_b32 s64, s68
    s_bitset0_b32 s68, s64
    v_readlane_b32 s33, v7, s64
    s_add_u32 s69, s64, s74
    s_and_b32 s69, s69, 15
    s_lshl_b32 s69, s69, 11
    buffer_load_dwordx4 v[96:99], v4, s[16:19], s69 offen offset:0 sc1
    buffer_load_dwordx4 v[100:103], v12, s[16:19], s69 offen offset:1024 sc1
    buffer_load_dwordx4 v[104:107], v4, s[16:19], s69 offen offset:2048 sc1
    buffer_load_dwordx4 v[108:111], v12, s[16:19], s69 offen offset:3072 sc1
    s_ff1_i32_b32 s64, s68
    s_bitset0_b32 s68, s64
    v_readlane_b32 s32, v7, s64
    s_add_u32 s69, s64, s74
    s_and_b32 s69, s69, 15
    s_lshl_b32 s69, s69, 11
    buffer_load_dwordx4 v[80:83], v4, s[16:19], s69 offen offset:0 sc1
    buffer_load_dwordx4 v[84:87], v12, s[16:19], s69 offen offset:1024 sc1
    buffer_load_dwordx4 v[88:91], v4, s[16:19], s69 offen offset:2048 sc1
    buffer_load_dwordx4 v[92:95], v12, s[16:19], s69 offen offset:3072 sc1
    s_mov_b64 exec, 1
    v_mov_b32 v15, 0
    buffer_atomic_or v15, v14, s[16:19], 0 offen sc0
    s_mov_b64 exec, -1
    v_add_u32 v8, s33, v5
    ds_read_b64_tr_b16 v[48:49], v8 offset:0
    ds_read_b64_tr_b16 v[50:51], v8 offset:2048
    v_add_u32 v9, s33, v6
    ds_read_b64_tr_b16 v[52:53], v9 offset:0
    ds_read_b64_tr_b16 v[54:55], v9 offset:2048
    v_add_u32 v10, s33, v1
    ds_read_b64_tr_b16 v[56:57], v10 offset:0
    ds_read_b64_tr_b16 v[58:59], v10 offset:2048
    v_add_u32 v11, s33, v3
    ds_read_b64_tr_b16 v[60:61], v11 offset:0
    ds_read_b64_tr_b16 v[62:63], v11 offset:2048
    s_branch D_p1
D_t34:
    s_cmp_eq_u32 s70, 4
    s_cbranch_scc1 D_e4
D_e3:
    s_ff1_i32_b32 s64, s68
    s_bitset0_b32 s68, s64
    v_readlane_b32 s34, v7, s64
    s_add_u32 s69, s64, s74
    s_and_b32 s69, s69, 15
    s_lshl_b32 s69, s69, 11
    buffer_load_dwordx4 v[112:115], v4, s[16:19], s69 offen offset:0 sc1
    buffer_load_dwordx4 v[116:119], v12, s[16:19], s69 offen offset:1024 sc1
    buffer_load_dwordx4 v[120:123], v4, s[16:19], s69 offen offset:2048 sc1
    buffer_load_dwordx4 v[124:127], v12, s[16:19], s69 offen offset:3072 sc1
    s_ff1_i32_b32 s64, s68
    s_bitset0_b32 s68, s64
    v_readlane_b32 s33, v7, s64
    s_add_u32 s69, s64, s74
    s_and_b32 s69, s69, 15
    s_lshl_b32 s69, s69, 11
    buffer_load_dwordx4 v[96:99], v4, s[16:19], s69 offen offset:0 sc1
    buffer_load_dwordx4 v[100:103], v12, s[16:19], s69 offen offset:1024 sc1
    buffer_load_dwordx4 v[104:107], v4, s[16:19], s69 offen offset:2048 sc1
    buffer_load_dwordx4 v[108:111], v12, s[16:19], s69 offen offset:3072 sc1
    v_add_u32 v8, s34, v5
    ds_read_b64_tr_b16 v[48:49], v8 offset:0
    ds_read_b64_tr_b16 v[50:51], v8 offset:2048
    v_add_u32 v9, s34, v6
    ds_read_b64_tr_b16 v[52:53], v9 offset:0
    ds_read_b64_tr_b16 v[54:55], v9 offset:2048
    v_add_u32 v10, s34, v1
    ds_read_b64_tr_b16 v[56:57], v10 offset:0
    ds_read_b64_tr_b16 v[58:59], v10 offset:2048
    v_add_u32 v11, s34, v3
    ds_read_b64_tr_b16 v[60:61], v11 offset:0
    ds_read_b64_tr_b16 v[62:63], v11 offset:2048
    s_branch D_p2
D_e4:
    s_ff1_i32_b32 s64, s68
    s_bitset0_b32 s68, s64
    v_readlane_b32 s35, v7, s64
    s_add_u32 s69, s64, s74
    s_and_b32 s69, s69, 15
    s_lshl_b32 s69, s69, 11
    buffer_load_dwordx4 v[128:131], v4, s[16:19], s69 offen offset:0 sc1
    buffer_load_dwordx4 v[132:135], v12, s[16:19], s69 offen offset:1024 sc1
    buffer_load_dwordx4 v[136:139], v4, s[16:19], s69 offen offset:2048 sc1
    buffer_load_dwordx4 v[140:143], v12, s[16:19], s69 offen offset:3072 sc1
    s_ff1_i32_b32 s64, s68
    s_bitset0_b32 s68, s64
    v_readlane_b32 s34, v7, s64
    s_add_u32 s69, s64, s74
    s_and_b32 s69, s69, 15
    s_lshl_b32 s69, s69, 11
    buffer_load_dwordx4 v[112:115], v4, s[16:19], s69 offen offset:0 sc1
    buffer_load_dwordx4 v[116:119], v12, s[16:19], s69 offen offset:1024 sc1
    buffer_load_dwordx4 v[120:123], v4, s[16:19], s69 offen offset:2048 sc1
    buffer_load_dwordx4 v[124:127], v12, s[16:19], s69 offen offset:3072 sc1
    v_add_u32 v8, s35, v5
    ds_read_b64_tr_b16 v[48:49], v8 offset:0
    ds_read_b64_tr_b16 v[50:51], v8 offset:2048
    v_add_u32 v9, s35, v6
    ds_read_b64_tr_b16 v[52:53], v9 offset:0
    ds_read_b64_tr_b16 v[54:55], v9 offset:2048
    v_add_u32 v10, s35, v1
    ds_read_b64_tr_b16 v[56:57], v10 offset:0
    ds_read_b64_tr_b16 v[58:59], v10 offset:2048
    v_add_u32 v11, s35, v3
    ds_read_b64_tr_b16 v[60:61], v11 offset:0
    ds_read_b64_tr_b16 v[62:63], v11 offset:2048
    s_branch D_p3
D_t58:
    s_cmp_gt_u32 s70, 6
    s_cbranch_scc1 D_t78
    s_cmp_eq_u32 s70, 6
    s_cbranch_scc1 D_e6
D_e5:
    s_ff1_i32_b32 s64, s68
    s_bitset0_b32 s68, s64
    v_readlane_b32 s36, v7, s64
    s_add_u32 s69, s64, s74
    s_and_b32 s69, s69, 15
    s_lshl_b32 s69, s69, 11
    buffer_load_dwordx4 v[144:147], v4, s[16:19], s69 offen offset:0 sc1
    buffer_load_dwordx4 v[148:151], v12, s[16:19], s69 offen offset:1024 sc1
    buffer_load_dwordx4 v[152:155], v4, s[16:19], s69 offen offset:2048 sc1
    buffer_load_dwordx4 v[156:159], v12, s[16:19], s69 offen offset:3072 sc1
    s_ff1_i32_b32 s64, s68
    s_bitset0_b32 s68, s64
    v_readlane_b32 s35, v7, s64
    s_add_u32 s69, s64, s74
    s_and_b32 s69, s69, 15
    s_lshl_b32 s69, s69, 11
    buffer_load_dwordx4 v[128:131], v4, s[16:19], s69 offen offset:0 sc1
    buffer_load_dwordx4 v[132:135], v12, s[16:19], s69 offen offset:1024 sc1
    buffer_load_dwordx4 v[136:139], v4, s[16:19], s69 offen offset:2048 sc1
    buffer_load_dwordx4 v[140:143], v12, s[16:19], s69 offen offset:3072 sc1
    v_add_u32 v8, s36, v5
    ds_read_b64_tr_b16 v[48:49], v8 offset:0
    ds_read_b64_tr_b16 v[50:51], v8 offset:2048
    v_add_u32 v9, s36, v6
    ds_read_b64_tr_b16 v[52:53], v9 offset:0
    ds_read_b64_tr_b16 v[54:55], v9 offset:2048
    v_add_u32 v10, s36, v1
    ds_read_b64_tr_b16 v[56:57], v10 offset:0
    ds_read_b64_tr_b16 v[58:59], v10 offset:2048
    v_add_u32 v11, s36, v3
    ds_read_b64_tr_b16 v[60:61], v11 offset:0
    ds_read_b64_tr_b16 v[62:63], v11 offset:2048
    s_branch D_p4
D_e6:
    s_ff1_i32_b32 s64, s68
    s_bitset0_b32 s68, s64
    v_readlane_b32 s37, v7, s64
    s_add_u32 s69, s64, s74
    s_and_b32 s69, s69, 15
    s_lshl_b32 s69, s69, 11
    buffer_load_dwordx4 v[160:163], v4, s[16:19], s69 offen offset:0 sc1
    buffer_load_dwordx4 v[164:167], v12, s[16:19], s69 offen offset:1024 sc1
    buffer_load_dwordx4 v[168:171], v4, s[16:19], s69 offen offset:2048 sc1
    buffer_load_dwordx4 v[172:175], v12, s[16:19], s69 offen offset:3072 sc1
    s_ff1_i32_b32 s64, s68
    s_bitset0_b32 s68, s64
    v_readlane_b32 s36, v7, s64
    s_add_u32 s69, s64, s74
    s_and_b32 s69, s69, 15
    s_lshl_b32 s69, s69, 11
    buffer_load_dwordx4 v[144:147], v4, s[16:19], s69 offen offset:0 sc1
    buffer_load_dwordx4 v[148:151], v12, s[16:19], s69 offen offset:1024 sc1
    buffer_load_dwordx4 v[152:155], v4, s[16:19], s69 offen offset:2048 sc1
    buffer_load_dwordx4 v[156:159], v12, s[16:19], s69 offen offset:3072 sc1
    v_add_u32 v8, s37, v5
    ds_read_b64_tr_b16 v[48:49], v8 offset:0
    ds_read_b64_tr_b16 v[50:51], v8 offset:2048
    v_add_u32 v9, s37, v6
    ds_read_b64_tr_b16 v[52:53], v9 offset:0
    ds_read_b64_tr_b16 v[54:55], v9 offset:2048
    v_add_u32 v10, s37, v1
    ds_read_b64_tr_b16 v[56:57], v10 offset:0
    ds_read_b64_tr_b16 v[58:59], v10 offset:2048
    v_add_u32 v11, s37, v3
    ds_read_b64_tr_b16 v[60:61], v11 offset:0
    ds_read_b64_tr_b16 v[62:63], v11 offset:2048
    s_branch D_p5
D_t78:
    s_cmp_eq_u32 s70, 8
    s_cbranch_scc1 D_e8
D_e7:
    s_ff1_i32_b32 s64, s68
    s_bitset0_b32 s68, s64
    v_readlane_b32 s38, v7, s64
    s_add_u32 s69, s64, s74
    s_and_b32 s69, s69, 15
    s_lshl_b32 s69, s69, 11
    buffer_load_dwordx4 v[176:179], v4, s[16:19], s69 offen offset:0 sc1
    buffer_load_dwordx4 v[180:183], v12, s[16:19], s69 offen offset:1024 sc1
    buffer_load_dwordx4 v[184:187], v4, s[16:19], s69 offen offset:2048 sc1
    buffer_load_dwordx4 v[188:191], v12, s[16:19], s69 offen offset:3072 sc1
    s_ff1_i32_b32 s64, s68
    s_bitset0_b32 s68, s64
    v_readlane_b32 s37, v7, s64
    s_add_u32 s69, s64, s74
    s_and_b32 s69, s69, 15
    s_lshl_b32 s69, s69, 11
    buffer_load_dwordx4 v[160:163], v4, s[16:19], s69 offen offset:0 sc1
    buffer_load_dwordx4 v[164:167], v12, s[16:19], s69 offen offset:1024 sc1
    buffer_load_dwordx4 v[168:171], v4, s[16:19], s69 offen offset:2048 sc1
    buffer_load_dwordx4 v[172:175], v12, s[16:19], s69 offen offset:3072 sc1
    v_add_u32 v8, s38, v5
    ds_read_b64_tr_b16 v[48:49], v8 offset:0
    ds_read_b64_tr_b16 v[50:51], v8 offset:2048
    v_add_u32 v9, s38, v6
    ds_read_b64_tr_b16 v[52:53], v9 offset:0
    ds_read_b64_tr_b16 v[54:55], v9 offset:2048
    v_add_u32 v10, s38, v1
    ds_read_b64_tr_b16 v[56:57], v10 offset:0
    ds_read_b64_tr_b16 v[58:59], v10 offset:2048
    v_add_u32 v11, s38, v3
    ds_read_b64_tr_b16 v[60:61], v11 offset:0
    ds_read_b64_tr_b16 v[62:63], v11 offset:2048
    s_branch D_p6
D_e8:
    s_ff1_i32_b32 s64, s68
    s_bitset0_b32 s68, s64
    v_readlane_b32 s39, v7, s64
    s_add_u32 s69, s64, s74
    s_and_b32 s69, s69, 15
    s_lshl_b32 s69, s69, 11
    buffer_load_dwordx4 v[192:195], v4, s[16:19], s69 offen offset:0 sc1
    buffer_load_dwordx4 v[196:199], v12, s[16:19], s69 offen offset:1024 sc1
    buffer_load_dwordx4 v[200:203], v4, s[16:19], s69 offen offset:2048 sc1
    buffer_load_dwordx4 v[204:207], v12, s[16:19], s69 offen offset:3072 sc1
    s_ff1_i32_b32 s64, s68
    s_bitset0_b32 s68, s64
    v_readlane_b32 s38, v7, s64
    s_add_u32 s69, s64, s74
    s_and_b32 s69, s69, 15
    s_lshl_b32 s69, s69, 11
    buffer_load_dwordx4 v[176:179], v4, s[16:19], s69 offen offset:0 sc1
    buffer_load_dwordx4 v[180:183], v12, s[16:19], s69 offen offset:1024 sc1
    buffer_load_dwordx4 v[184:187], v4, s[16:19], s69 offen offset:2048 sc1
    buffer_load_dwordx4 v[188:191], v12, s[16:19], s69 offen offset:3072 sc1
    v_add_u32 v8, s39, v5
    ds_read_b64_tr_b16 v[48:49], v8 offset:0
    ds_read_b64_tr_b16 v[50:51], v8 offset:2048
    v_add_u32 v9, s39, v6
    ds_read_b64_tr_b16 v[52:53], v9 offset:0
    ds_read_b64_tr_b16 v[54:55], v9 offset:2048
    v_add_u32 v10, s39, v1
    ds_read_b64_tr_b16 v[56:57], v10 offset:0
    ds_read_b64_tr_b16 v[58:59], v10 offset:2048
    v_add_u32 v11, s39, v3
    ds_read_b64_tr_b16 v[60:61], v11 offset:0
    ds_read_b64_tr_b16 v[62:63], v11 offset:2048
D_p7:
    s_waitcnt vmcnt(4) lgkmcnt(0)
    v_mfma_f32_16x16x32_bf16 v[16:19], v[48:51], v[192:195], v[16:19]
    ds_read_b64_tr_b16 v[64:65], v8 offset:4096
    ds_read_b64_tr_b16 v[66:67], v8 offset:6144
    v_mfma_f32_16x16x32_bf16 v[32:35], v[48:51], v[196:199], v[32:35]
    ds_read_b64_tr_b16 v[68:69], v9 offset:4096
    ds_read_b64_tr_b16 v[70:71], v9 offset:6144
    v_mfma_f32_16x16x32_bf16 v[20:23], v[52:55], v[192:195], v[20:23]
    ds_read_b64_tr_b16 v[72:73], v10 offset:4096
    ds_read_b64_tr_b16 v[74:75], v10 offset:6144
    v_mfma_f32_16x16x32_bf16 v[36:39], v[52:55], v[196:199], v[36:39]
    ds_read_b64_tr_b16 v[76:77], v11 offset:4096
    ds_read_b64_tr_b16 v[78:79], v11 offset:6144
    s_ff1_i32_b32 s64, s68
    s_bitset0_b32 s68, s64
    v_readlane_b32 s37, v7, s64
    s_add_u32 s69, s64, s74
    s_and_b32 s69, s69, 15
    s_lshl_b32 s69, s69, 11
    buffer_load_dwordx4 v[160:163], v4, s[16:19], s69 offen offset:0 sc1
    v_mfma_f32_16x16x32_bf16 v[24:27], v[56:59], v[192:195], v[24:27]
    v_mfma_f32_16x16x32_bf16 v[40:43], v[56:59], v[196:199], v[40:43]
    v_mfma_f32_16x16x32_bf16 v[28:31], v[60:63], v[192:195], v[28:31]
    buffer_load_dwordx4 v[164:167], v12, s[16:19], s69 offen offset:1024 sc1
    v_mfma_f32_16x16x32_bf16 v[44:47], v[60:63], v[196:199], v[44:47]
    s_waitcnt lgkmcnt(0)
    v_mfma_f32_16x16x32_bf16 v[16:19], v[64:67], v[200:203], v[16:19]
    v_add_u32 v8, s38, v5
    ds_read_b64_tr_b16 v[48:49], v8 offset:0
    v_mfma_f32_16x16x32_bf16 v[32:35], v[64:67], v[204:207], v[32:35]
    ds_read_b64_tr_b16 v[50:51], v8 offset:2048
    v_add_u32 v9, s38, v6
    v_mfma_f32_16x16x32_bf16 v[20:23], v[68:71], v[200:203], v[20:23]
    ds_read_b64_tr_b16 v[52:53], v9 offset:0
    ds_read_b64_tr_b16 v[54:55], v9 offset:2048
    v_mfma_f32_16x16x32_bf16 v[36:39], v[68:71], v[204:207], v[36:39]
    v_add_u32 v10, s38, v1
    ds_read_b64_tr_b16 v[56:57], v10 offset:0
    buffer_load_dwordx4 v[168:171], v4, s[16:19], s69 offen offset:2048 sc1
    v_mfma_f32_16x16x32_bf16 v[24:27], v[72:75], v[200:203], v[24:27]
    ds_read_b64_tr_b16 v[58:59], v10 offset:2048
    v_add_u32 v11, s38, v3
    v_mfma_f32_16x16x32_bf16 v[40:43], v[72:75], v[204:207], v[40:43]
    ds_read_b64_tr_b16 v[60:61], v11 offset:0
    ds_read_b64_tr_b16 v[62:63], v11 offset:2048
    v_mfma_f32_16x16x32_bf16 v[28:31], v[76:79], v[200:203], v[28:31]
    buffer_load_dwordx4 v[172:175], v12, s[16:19], s69 offen offset:3072 sc1
    v_mfma_f32_16x16x32_bf16 v[44:47], v[76:79], v[204:207], v[44:47]
D_p6:
    s_waitcnt vmcnt(4) lgkmcnt(0)
    v_mfma_f32_16x16x32_bf16 v[16:19], v[48:51], v[176:179], v[16:19]
    ds_read_b64_tr_b16 v[64:65], v8 offset:4096
    ds_read_b64_tr_b16 v[66:67], v8 offset:6144
    v_mfma_f32_16x16x32_bf16 v[32:35], v[48:51], v[180:183], v[32:35]
    ds_read_b64_tr_b16 v[68:69], v9 offset:4096
    ds_read_b64_tr_b16 v[70:71], v9 offset:6144
    v_mfma_f32_16x16x32_bf16 v[20:23], v[52:55], v[176:179], v[20:23]
    ds_read_b64_tr_b16 v[72:73], v10 offset:4096
    ds_read_b64_tr_b16 v[74:75], v10 offset:6144
    v_mfma_f32_16x16x32_bf16 v[36:39], v[52:55], v[180:183], v[36:39]
    ds_read_b64_tr_b16 v[76:77], v11 offset:4096
    ds_read_b64_tr_b16 v[78:79], v11 offset:6144
    s_ff1_i32_b32 s64, s68
    s_bitset0_b32 s68, s64
    v_readlane_b32 s36, v7, s64
    s_add_u32 s69, s64, s74
    s_and_b32 s69, s69, 15
    s_lshl_b32 s69, s69, 11
    buffer_load_dwordx4 v[144:147], v4, s[16:19], s69 offen offset:0 sc1
    v_mfma_f32_16x16x32_bf16 v[24:27], v[56:59], v[176:179], v[24:27]
    v_mfma_f32_16x16x32_bf16 v[40:43], v[56:59], v[180:183], v[40:43]
    v_mfma_f32_16x16x32_bf16 v[28:31], v[60:63], v[176:179], v[28:31]
    buffer_load_dwordx4 v[148:151], v12, s[16:19], s69 offen offset:1024 sc1
    v_mfma_f32_16x16x32_bf16 v[44:47], v[60:63], v[180:183], v[44:47]
    s_waitcnt lgkmcnt(0)
    v_mfma_f32_16x16x32_bf16 v[16:19], v[64:67], v[184:187], v[16:19]
    v_add_u32 v8, s37, v5
    ds_read_b64_tr_b16 v[48:49], v8 offset:0
    v_mfma_f32_16x16x32_bf16 v[32:35], v[64:67], v[188:191], v[32:35]
    ds_read_b64_tr_b16 v[50:51], v8 offset:2048
    v_add_u32 v9, s37, v6
    v_mfma_f32_16x16x32_bf16 v[20:23], v[68:71], v[184:187], v[20:23]
    ds_read_b64_tr_b16 v[52:53], v9 offset:0
    ds_read_b64_tr_b16 v[54:55], v9 offset:2048
    v_mfma_f32_16x16x32_bf16 v[36:39], v[68:71], v[188:191], v[36:39]
    v_add_u32 v10, s37, v1
    ds_read_b64_tr_b16 v[56:57], v10 offset:0
    buffer_load_dwordx4 v[152:155], v4, s[16:19], s69 offen offset:2048 sc1
    v_mfma_f32_16x16x32_bf16 v[24:27], v[72:75], v[184:187], v[24:27]
    ds_read_b64_tr_b16 v[58:59], v10 offset:2048
    v_add_u32 v11, s37, v3
    v_mfma_f32_16x16x32_bf16 v[40:43], v[72:75], v[188:191], v[40:43]
    ds_read_b64_tr_b16 v[60:61], v11 offset:0
    ds_read_b64_tr_b16 v[62:63], v11 offset:2048
    v_mfma_f32_16x16x32_bf16 v[28:31], v[76:79], v[184:187], v[28:31]
    buffer_load_dwordx4 v[156:159], v12, s[16:19], s69 offen offset:3072 sc1
    v_mfma_f32_16x16x32_bf16 v[44:47], v[76:79], v[188:191], v[44:47]
D_p5:
    s_waitcnt vmcnt(4) lgkmcnt(0)
    v_mfma_f32_16x16x32_bf16 v[16:19], v[48:51], v[160:163], v[16:19]
    ds_read_b64_tr_b16 v[64:65], v8 offset:4096
    ds_read_b64_tr_b16 v[66:67], v8 offset:6144
    v_mfma_f32_16x16x32_bf16 v[32:35], v[48:51], v[164:167], v[32:35]
    ds_read_b64_tr_b16 v[68:69], v9 offset:4096
    ds_read_b64_tr_b16 v[70:71], v9 offset:6144
    v_mfma_f32_16x16x32_bf16 v[20:23], v[52:55], v[160:163], v[20:23]
    ds_read_b64_tr_b16 v[72:73], v10 offset:4096
    ds_read_b64_tr_b16 v[74:75], v10 offset:6144
    v_mfma_f32_16x16x32_bf16 v[36:39], v[52:55], v[164:167], v[36:39]
    ds_read_b64_tr_b16 v[76:77], v11 offset:4096
    ds_read_b64_tr_b16 v[78:79], v11 offset:6144
    s_ff1_i32_b32 s64, s68
    s_bitset0_b32 s68, s64
    v_readlane_b32 s35, v7, s64
    s_add_u32 s69, s64, s74
    s_and_b32 s69, s69, 15
    s_lshl_b32 s69, s69, 11
    buffer_load_dwordx4 v[128:131], v4, s[16:19], s69 offen offset:0 sc1
    v_mfma_f32_16x16x32_bf16 v[24:27], v[56:59], v[160:163], v[24:27]
    v_mfma_f32_16x16x32_bf16 v[40:43], v[56:59], v[164:167], v[40:43]
    v_mfma_f32_16x16x32_bf16 v[28:31], v[60:63], v[160:163], v[28:31]
    buffer_load_dwordx4 v[132:135], v12, s[16:19], s69 offen offset:1024 sc1
    v_mfma_f32_16x16x32_bf16 v[44:47], v[60:63], v[164:167], v[44:47]
    s_waitcnt lgkmcnt(0)
    v_mfma_f32_16x16x32_bf16 v[16:19], v[64:67], v[168:171], v[16:19]
    v_add_u32 v8, s36, v5
    ds_read_b64_tr_b16 v[48:49], v8 offset:0
    v_mfma_f32_16x16x32_bf16 v[32:35], v[64:67], v[172:175], v[32:35]
    ds_read_b64_tr_b16 v[50:51], v8 offset:2048
    v_add_u32 v9, s36, v6
    v_mfma_f32_16x16x32_bf16 v[20:23], v[68:71], v[168:171], v[20:23]
    ds_read_b64_tr_b16 v[52:53], v9 offset:0
    ds_read_b64_tr_b16 v[54:55], v9 offset:2048
    v_mfma_f32_16x16x32_bf16 v[36:39], v[68:71], v[172:175], v[36:39]
    v_add_u32 v10, s36, v1
    ds_read_b64_tr_b16 v[56:57], v10 offset:0
    buffer_load_dwordx4 v[136:139], v4, s[16:19], s69 offen offset:2048 sc1
    v_mfma_f32_16x16x32_bf16 v[24:27], v[72:75], v[168:171], v[24:27]
    ds_read_b64_tr_b16 v[58:59], v10 offset:2048
    v_add_u32 v11, s36, v3
    v_mfma_f32_16x16x32_bf16 v[40:43], v[72:75], v[172:175], v[40:43]
    ds_read_b64_tr_b16 v[60:61], v11 offset:0
    ds_read_b64_tr_b16 v[62:63], v11 offset:2048
    v_mfma_f32_16x16x32_bf16 v[28:31], v[76:79], v[168:171], v[28:31]
    buffer_load_dwordx4 v[140:143], v12, s[16:19], s69 offen offset:3072 sc1
    v_mfma_f32_16x16x32_bf16 v[44:47], v[76:79], v[172:175], v[44:47]
D_p4:
    s_waitcnt vmcnt(4) lgkmcnt(0)
    v_mfma_f32_16x16x32_bf16 v[16:19], v[48:51], v[144:147], v[16:19]
    ds_read_b64_tr_b16 v[64:65], v8 offset:4096
    ds_read_b64_tr_b16 v[66:67], v8 offset:6144
    v_mfma_f32_16x16x32_bf16 v[32:35], v[48:51], v[148:151], v[32:35]
    ds_read_b64_tr_b16 v[68:69], v9 offset:4096
    ds_read_b64_tr_b16 v[70:71], v9 offset:6144
    v_mfma_f32_16x16x32_bf16 v[20:23], v[52:55], v[144:147], v[20:23]
    ds_read_b64_tr_b16 v[72:73], v10 offset:4096
    ds_read_b64_tr_b16 v[74:75], v10 offset:6144
    v_mfma_f32_16x16x32_bf16 v[36:39], v[52:55], v[148:151], v[36:39]
    ds_read_b64_tr_b16 v[76:77], v11 offset:4096
    ds_read_b64_tr_b16 v[78:79], v11 offset:6144
    s_ff1_i32_b32 s64, s68
    s_bitset0_b32 s68, s64
    v_readlane_b32 s34, v7, s64
    s_add_u32 s69, s64, s74
    s_and_b32 s69, s69, 15
    s_lshl_b32 s69, s69, 11
    buffer_load_dwordx4 v[112:115], v4, s[16:19], s69 offen offset:0 sc1
    v_mfma_f32_16x16x32_bf16 v[24:27], v[56:59], v[144:147], v[24:27]
    v_mfma_f32_16x16x32_bf16 v[40:43], v[56:59], v[148:151], v[40:43]
    v_mfma_f32_16x16x32_bf16 v[28:31], v[60:63], v[144:147], v[28:31]
    buffer_load_dwordx4 v[116:119], v12, s[16:19], s69 offen offset:1024 sc1
    v_mfma_f32_16x16x32_bf16 v[44:47], v[60:63], v[148:151], v[44:47]
    s_waitcnt lgkmcnt(0)
    v_mfma_f32_16x16x32_bf16 v[16:19], v[64:67], v[152:155], v[16:19]
    v_add_u32 v8, s35, v5
    ds_read_b64_tr_b16 v[48:49], v8 offset:0
    v_mfma_f32_16x16x32_bf16 v[32:35], v[64:67], v[156:159], v[32:35]
    ds_read_b64_tr_b16 v[50:51], v8 offset:2048
    v_add_u32 v9, s35, v6
    v_mfma_f32_16x16x32_bf16 v[20:23], v[68:71], v[152:155], v[20:23]
    ds_read_b64_tr_b16 v[52:53], v9 offset:0
    ds_read_b64_tr_b16 v[54:55], v9 offset:2048
    v_mfma_f32_16x16x32_bf16 v[36:39], v[68:71], v[156:159], v[36:39]
    v_add_u32 v10, s35, v1
    ds_read_b64_tr_b16 v[56:57], v10 offset:0
    buffer_load_dwordx4 v[120:123], v4, s[16:19], s69 offen offset:2048 sc1
    v_mfma_f32_16x16x32_bf16 v[24:27], v[72:75], v[152:155], v[24:27]
    ds_read_b64_tr_b16 v[58:59], v10 offset:2048
    v_add_u32 v11, s35, v3
    v_mfma_f32_16x16x32_bf16 v[40:43], v[72:75], v[156:159], v[40:43]
    ds_read_b64_tr_b16 v[60:61], v11 offset:0
    ds_read_b64_tr_b16 v[62:63], v11 offset:2048
    v_mfma_f32_16x16x32_bf16 v[28:31], v[76:79], v[152:155], v[28:31]
    buffer_load_dwordx4 v[124:127], v12, s[16:19], s69 offen offset:3072 sc1
    v_mfma_f32_16x16x32_bf16 v[44:47], v[76:79], v[156:159], v[44:47]
D_p3:
    s_waitcnt vmcnt(4) lgkmcnt(0)
    v_mfma_f32_16x16x32_bf16 v[16:19], v[48:51], v[128:131], v[16:19]
    ds_read_b64_tr_b16 v[64:65], v8 offset:4096
    ds_read_b64_tr_b16 v[66:67], v8 offset:6144
    v_mfma_f32_16x16x32_bf16 v[32:35], v[48:51], v[132:135], v[32:35]
    ds_read_b64_tr_b16 v[68:69], v9 offset:4096
    ds_read_b64_tr_b16 v[70:71], v9 offset:6144
    v_mfma_f32_16x16x32_bf16 v[20:23], v[52:55], v[128:131], v[20:23]
    ds_read_b64_tr_b16 v[72:73], v10 offset:4096
    ds_read_b64_tr_b16 v[74:75], v10 offset:6144
    v_mfma_f32_16x16x32_bf16 v[36:39], v[52:55], v[132:135], v[36:39]
    ds_read_b64_tr_b16 v[76:77], v11 offset:4096
    ds_read_b64_tr_b16 v[78:79], v11 offset:6144
    s_ff1_i32_b32 s64, s68
    s_bitset0_b32 s68, s64
    v_readlane_b32 s33, v7, s64
    s_add_u32 s69, s64, s74
    s_and_b32 s69, s69, 15
    s_lshl_b32 s69, s69, 11
    buffer_load_dwordx4 v[96:99], v4, s[16:19], s69 offen offset:0 sc1
    v_mfma_f32_16x16x32_bf16 v[24:27], v[56:59], v[128:131], v[24:27]
    v_mfma_f32_16x16x32_bf16 v[40:43], v[56:59], v[132:135], v[40:43]
    v_mfma_f32_16x16x32_bf16 v[28:31], v[60:63], v[128:131], v[28:31]
    buffer_load_dwordx4 v[100:103], v12, s[16:19], s69 offen offset:1024 sc1
    v_mfma_f32_16x16x32_bf16 v[44:47], v[60:63], v[132:135], v[44:47]
    s_waitcnt lgkmcnt(0)
    v_mfma_f32_16x16x32_bf16 v[16:19], v[64:67], v[136:139], v[16:19]
    v_add_u32 v8, s34, v5
    ds_read_b64_tr_b16 v[48:49], v8 offset:0
    v_mfma_f32_16x16x32_bf16 v[32:35], v[64:67], v[140:143], v[32:35]
    ds_read_b64_tr_b16 v[50:51], v8 offset:2048
    v_add_u32 v9, s34, v6
    v_mfma_f32_16x16x32_bf16 v[20:23], v[68:71], v[136:139], v[20:23]
    ds_read_b64_tr_b16 v[52:53], v9 offset:0
    ds_read_b64_tr_b16 v[54:55], v9 offset:2048
    v_mfma_f32_16x16x32_bf16 v[36:39], v[68:71], v[140:143], v[36:39]
    v_add_u32 v10, s34, v1
    ds_read_b64_tr_b16 v[56:57], v10 offset:0
    buffer_load_dwordx4 v[104:107], v4, s[16:19], s69 offen offset:2048 sc1
    v_mfma_f32_16x16x32_bf16 v[24:27], v[72:75], v[136:139], v[24:27]
    ds_read_b64_tr_b16 v[58:59], v10 offset:2048
    v_add_u32 v11, s34, v3
    v_mfma_f32_16x16x32_bf16 v[40:43], v[72:75], v[140:143], v[40:43]
    ds_read_b64_tr_b16 v[60:61], v11 offset:0
    ds_read_b64_tr_b16 v[62:63], v11 offset:2048
    v_mfma_f32_16x16x32_bf16 v[28:31], v[76:79], v[136:139], v[28:31]
    buffer_load_dwordx4 v[108:111], v12, s[16:19], s69 offen offset:3072 sc1
    v_mfma_f32_16x16x32_bf16 v[44:47], v[76:79], v[140:143], v[44:47]
D_p2:
    s_waitcnt vmcnt(4) lgkmcnt(0)
    v_mfma_f32_16x16x32_bf16 v[16:19], v[48:51], v[112:115], v[16:19]
    ds_read_b64_tr_b16 v[64:65], v8 offset:4096
    ds_read_b64_tr_b16 v[66:67], v8 offset:6144
    v_mfma_f32_16x16x32_bf16 v[32:35], v[48:51], v[116:119], v[32:35]
    ds_read_b64_tr_b16 v[68:69], v9 offset:4096
    ds_read_b64_tr_b16 v[70:71], v9 offset:6144
    v_mfma_f32_16x16x32_bf16 v[20:23], v[52:55], v[112:115], v[20:23]
    ds_read_b64_tr_b16 v[72:73], v10 offset:4096
    ds_read_b64_tr_b16 v[74:75], v10 offset:6144
    v_mfma_f32_16x16x32_bf16 v[36:39], v[52:55], v[116:119], v[36:39]
    ds_read_b64_tr_b16 v[76:77], v11 offset:4096
    ds_read_b64_tr_b16 v[78:79], v11 offset:6144
    s_ff1_i32_b32 s64, s68
    s_bitset0_b32 s68, s64
    v_readlane_b32 s32, v7, s64
    s_add_u32 s69, s64, s74
    s_and_b32 s69, s69, 15
    s_lshl_b32 s69, s69, 11
    buffer_load_dwordx4 v[80:83], v4, s[16:19], s69 offen offset:0 sc1
    v_mfma_f32_16x16x32_bf16 v[24:27], v[56:59], v[112:115], v[24:27]
    v_mfma_f32_16x16x32_bf16 v[40:43], v[56:59], v[116:119], v[40:43]
    v_mfma_f32_16x16x32_bf16 v[28:31], v[60:63], v[112:115], v[28:31]
    buffer_load_dwordx4 v[84:87], v12, s[16:19], s69 offen offset:1024 sc1
    v_mfma_f32_16x16x32_bf16 v[44:47], v[60:63], v[116:119], v[44:47]
    s_waitcnt lgkmcnt(0)
    v_mfma_f32_16x16x32_bf16 v[16:19], v[64:67], v[120:123], v[16:19]
    v_add_u32 v8, s33, v5
    ds_read_b64_tr_b16 v[48:49], v8 offset:0
    v_mfma_f32_16x16x32_bf16 v[32:35], v[64:67], v[124:127], v[32:35]
    ds_read_b64_tr_b16 v[50:51], v8 offset:2048
    v_add_u32 v9, s33, v6
    v_mfma_f32_16x16x32_bf16 v[20:23], v[68:71], v[120:123], v[20:23]
    ds_read_b64_tr_b16 v[52:53], v9 offset:0
    ds_read_b64_tr_b16 v[54:55], v9 offset:2048
    v_mfma_f32_16x16x32_bf16 v[36:39], v[68:71], v[124:127], v[36:39]
    v_add_u32 v10, s33, v1
    ds_read_b64_tr_b16 v[56:57], v10 offset:0
    buffer_load_dwordx4 v[88:91], v4, s[16:19], s69 offen offset:2048 sc1
    v_mfma_f32_16x16x32_bf16 v[24:27], v[72:75], v[120:123], v[24:27]
    ds_read_b64_tr_b16 v[58:59], v10 offset:2048
    v_add_u32 v11, s33, v3
    v_mfma_f32_16x16x32_bf16 v[40:43], v[72:75], v[124:127], v[40:43]
    ds_read_b64_tr_b16 v[60:61], v11 offset:0
    ds_read_b64_tr_b16 v[62:63], v11 offset:2048
    v_mfma_f32_16x16x32_bf16 v[28:31], v[76:79], v[120:123], v[28:31]
    buffer_load_dwordx4 v[92:95], v12, s[16:19], s69 offen offset:3072 sc1
    s_mov_b64 exec, 1
    v_mov_b32 v15, 0
    buffer_atomic_or v15, v14, s[16:19], 0 offen sc0
    s_mov_b64 exec, -1
    v_mfma_f32_16x16x32_bf16 v[44:47], v[76:79], v[124:127], v[44:47]
D_p1:
    s_waitcnt vmcnt(5) lgkmcnt(0)
    v_mfma_f32_16x16x32_bf16 v[16:19], v[48:51], v[96:99], v[16:19]
    ds_read_b64_tr_b16 v[64:65], v8 offset:4096
    ds_read_b64_tr_b16 v[66:67], v8 offset:6144
    v_mfma_f32_16x16x32_bf16 v[32:35], v[48:51], v[100:103], v[32:35]
    ds_read_b64_tr_b16 v[68:69], v9 offset:4096
    ds_read_b64_tr_b16 v[70:71], v9 offset:6144
    v_mfma_f32_16x16x32_bf16 v[20:23], v[52:55], v[96:99], v[20:23]
    ds_read_b64_tr_b16 v[72:73], v10 offset:4096
    ds_read_b64_tr_b16 v[74:75], v10 offset:6144
    v_mfma_f32_16x16x32_bf16 v[36:39], v[52:55], v[100:103], v[36:39]
    ds_read_b64_tr_b16 v[76:77], v11 offset:4096
    ds_read_b64_tr_b16 v[78:79], v11 offset:6144
    v_mfma_f32_16x16x32_bf16 v[24:27], v[56:59], v[96:99], v[24:27]
    v_mfma_f32_16x16x32_bf16 v[40:43], v[56:59], v[100:103], v[40:43]
    v_mfma_f32_16x16x32_bf16 v[28:31], v[60:63], v[96:99], v[28:31]
    v_mfma_f32_16x16x32_bf16 v[44:47], v[60:63], v[100:103], v[44:47]
    s_waitcnt lgkmcnt(0)
    v_mfma_f32_16x16x32_bf16 v[16:19], v[64:67], v[104:107], v[16:19]
    v_add_u32 v8, s32, v5
    ds_read_b64_tr_b16 v[48:49], v8 offset:0
    v_mfma_f32_16x16x32_bf16 v[32:35], v[64:67], v[108:111], v[32:35]
    ds_read_b64_tr_b16 v[50:51], v8 offset:2048
    v_add_u32 v9, s32, v6
    v_mfma_f32_16x16x32_bf16 v[20:23], v[68:71], v[104:107], v[20:23]
    ds_read_b64_tr_b16 v[52:53], v9 offset:0
    ds_read_b64_tr_b16 v[54:55], v9 offset:2048
    v_mfma_f32_16x16x32_bf16 v[36:39], v[68:71], v[108:111], v[36:39]
    v_add_u32 v10, s32, v1
    ds_read_b64_tr_b16 v[56:57], v10 offset:0
    v_mfma_f32_16x16x32_bf16 v[24:27], v[72:75], v[104:107], v[24:27]
    ds_read_b64_tr_b16 v[58:59], v10 offset:2048
    v_add_u32 v11, s32, v3
    v_mfma_f32_16x16x32_bf16 v[40:43], v[72:75], v[108:111], v[40:43]
    ds_read_b64_tr_b16 v[60:61], v11 offset:0
    ds_read_b64_tr_b16 v[62:63], v11 offset:2048
    v_mfma_f32_16x16x32_bf16 v[28:31], v[76:79], v[104:107], v[28:31]
    v_mfma_f32_16x16x32_bf16 v[44:47], v[76:79], v[108:111], v[44:47]
D_p0:
    s_waitcnt vmcnt(1) lgkmcnt(0)
    v_mfma_f32_16x16x32_bf16 v[16:19], v[48:51], v[80:83], v[16:19]
    ds_read_b64_tr_b16 v[64:65], v8 offset:4096
    ds_read_b64_tr_b16 v[66:67], v8 offset:6144
    v_mfma_f32_16x16x32_bf16 v[32:35], v[48:51], v[84:87], v[32:35]
    ds_read_b64_tr_b16 v[68:69], v9 offset:4096
    ds_read_b64_tr_b16 v[70:71], v9 offset:6144
    v_mfma_f32_16x16x32_bf16 v[20:23], v[52:55], v[80:83], v[20:23]
    ds_read_b64_tr_b16 v[72:73], v10 offset:4096
    ds_read_b64_tr_b16 v[74:75], v10 offset:6144
    v_mfma_f32_16x16x32_bf16 v[36:39], v[52:55], v[84:87], v[36:39]
    ds_read_b64_tr_b16 v[76:77], v11 offset:4096
    ds_read_b64_tr_b16 v[78:79], v11 offset:6144
    v_mfma_f32_16x16x32_bf16 v[24:27], v[56:59], v[80:83], v[24:27]
    v_mfma_f32_16x16x32_bf16 v[40:43], v[56:59], v[84:87], v[40:43]
    v_mfma_f32_16x16x32_bf16 v[28:31], v[60:63], v[80:83], v[28:31]
    v_mfma_f32_16x16x32_bf16 v[44:47], v[60:63], v[84:87], v[44:47]
    s_waitcnt lgkmcnt(0)
    v_mfma_f32_16x16x32_bf16 v[16:19], v[64:67], v[88:91], v[16:19]
    v_mfma_f32_16x16x32_bf16 v[32:35], v[64:67], v[92:95], v[32:35]
    v_mfma_f32_16x16x32_bf16 v[20:23], v[68:71], v[88:91], v[20:23]
    v_mfma_f32_16x16x32_bf16 v[36:39], v[68:71], v[92:95], v[36:39]
    v_mfma_f32_16x16x32_bf16 v[24:27], v[72:75], v[88:91], v[24:27]
    v_mfma_f32_16x16x32_bf16 v[40:43], v[72:75], v[92:95], v[40:43]
    v_mfma_f32_16x16x32_bf16 v[28:31], v[76:79], v[88:91], v[28:31]
    v_mfma_f32_16x16x32_bf16 v[44:47], v[76:79], v[92:95], v[44:47]
    s_cmp_lg_u32 s66, 0
    s_cbranch_scc1 D_wait
D_end:
    s_lshl_b32 s64, s3, 12
    s_add_u32 s64, s64, 8192
    v_lshl_add_u32 v8, v2, 4, s64
    s_xor_b32 s65, s3, 4
    s_lshl_b32 s65, s65, 12
    s_add_u32 s65, s65, 8192
    v_lshl_add_u32 v5, v2, 4, s65
    v_lshlrev_b32 v9, 1, v229
    v_cmp_eq_u32 s[70:71], s67, v230
    s_cmp_eq_u32 s46, 0
    s_cbranch_scc1 P2_y
P2_ny:
    s_barrier
    ds_write_b128 v8, v[32:35] offset:0
    ds_write_b128 v8, v[36:39] offset:1024
    ds_write_b128 v8, v[40:43] offset:2048
    ds_write_b128 v8, v[44:47] offset:3072
    s_cmp_lg_u64 s[70:71], 0
    s_cbranch_scc1 P2_fix
P2_nr:
    s_waitcnt lgkmcnt(0)
    s_barrier
    ds_read_b128 v[64:67], v5 offset:0
    ds_read_b128 v[68:71], v5 offset:1024
    ds_read_b128 v[72:75], v5 offset:2048
    ds_read_b128 v[76:79], v5 offset:3072
    s_waitcnt lgkmcnt(2)
    v_pk_add_f32 v[16:17], v[16:17], v[64:65]
    v_pk_add_f32 v[18:19], v[18:19], v[66:67]
    v_pk_add_f32 v[20:21], v[20:21], v[68:69]
    v_pk_add_f32 v[22:23], v[22:23], v[70:71]
    v_cvt_pk_bf16_f32 v48, v16, v17
    v_cvt_pk_bf16_f32 v49, v18, v19
    v_cvt_pk_bf16_f32 v50, v20, v21
    v_cvt_pk_bf16_f32 v51, v22, v23
    s_nop 0
    v_permlane16_swap_b32 v48, v50
    v_permlane16_swap_b32 v49, v51
    v_lshlrev_b32 v16, 16, v48
    v_and_b32 v17, 0xffff0000, v48
    v_lshlrev_b32 v18, 16, v49
    v_and_b32 v19, 0xffff0000, v49
    v_lshlrev_b32 v20, 16, v50
    v_and_b32 v21, 0xffff0000, v50
    v_lshlrev_b32 v22, 16, v51
    v_and_b32 v23, 0xffff0000, v51
    v_pk_mul_f32 v[16:17], v[16:17], v[228:229] op_sel_hi:[1,0]
    v_pk_mul_f32 v[18:19], v[18:19], v[228:229] op_sel_hi:[1,0]
    v_pk_mul_f32 v[20:21], v[20:21], v[228:229] op_sel_hi:[1,0]
    v_pk_mul_f32 v[22:23], v[22:23], v[228:229] op_sel_hi:[1,0]
    v_cvt_pk_bf16_f32 v48, v16, v17
    v_cvt_pk_bf16_f32 v49, v18, v19
    v_cvt_pk_bf16_f32 v50, v20, v21
    v_cvt_pk_bf16_f32 v51, v22, v23
    v_lshlrev_b32 v16, 16, v48
    v_and_b32 v17, 0xffff0000, v48
    v_lshlrev_b32 v18, 16, v49
    v_and_b32 v19, 0xffff0000, v49
    v_lshlrev_b32 v20, 16, v50
    v_and_b32 v21, 0xffff0000, v50
    v_lshlrev_b32 v22, 16, v51
    v_and_b32 v23, 0xffff0000, v51
    v_pk_add_f32 v[16:17], v[16:17], v[232:233]
    v_pk_add_f32 v[18:19], v[18:19], v[234:235]
    v_pk_add_f32 v[20:21], v[20:21], v[236:237]
    v_pk_add_f32 v[22:23], v[22:23], v[238:239]
    v_cvt_pk_bf16_f32 v120, v16, v17
    v_cvt_pk_bf16_f32 v121, v18, v19
    v_cvt_pk_bf16_f32 v122, v20, v21
    v_cvt_pk_bf16_f32 v123, v22, v23
    v_and_b32 v6, 1, v2
    v_mul_u32_u24 v6, 1984, v6
    v_sub_u32 v231, v231, v6
    s_mov_b32 vcc_lo, 0x55555555
    s_mov_b32 vcc_hi, 0x55555555
    s_waitcnt lgkmcnt(0)
    v_pk_add_f32 v[24:25], v[24:25], v[72:73]
    v_pk_add_f32 v[26:27], v[26:27], v[74:75]
    v_pk_add_f32 v[28:29], v[28:29], v[76:77]
    v_pk_add_f32 v[30:31], v[30:31], v[78:79]
    v_cvt_pk_bf16_f32 v52, v24, v25
    v_cvt_pk_bf16_f32 v53, v26, v27
    v_cvt_pk_bf16_f32 v54, v28, v29
    v_cvt_pk_bf16_f32 v55, v30, v31
    s_nop 0
    v_permlane16_swap_b32 v52, v54
    v_permlane16_swap_b32 v53, v55
    v_lshlrev_b32 v24, 16, v52
    v_and_b32 v25, 0xffff0000, v52
    v_lshlrev_b32 v26, 16, v53
    v_and_b32 v27, 0xffff0000, v53
    v_lshlrev_b32 v28, 16, v54
    v_and_b32 v29, 0xffff0000, v54
    v_lshlrev_b32 v30, 16, v55
    v_and_b32 v31, 0xffff0000, v55
    v_pk_mul_f32 v[24:25], v[24:25], v[228:229] op_sel_hi:[1,0]
    v_pk_mul_f32 v[26:27], v[26:27], v[228:229] op_sel_hi:[1,0]
    v_pk_mul_f32 v[28:29], v[28:29], v[228:229] op_sel_hi:[1,0]
    v_pk_mul_f32 v[30:31], v[30:31], v[228:229] op_sel_hi:[1,0]
    v_cvt_pk_bf16_f32 v52, v24, v25
    v_cvt_pk_bf16_f32 v53, v26, v27
    v_cvt_pk_bf16_f32 v54, v28, v29
    v_cvt_pk_bf16_f32 v55, v30, v31
    v_lshlrev_b32 v24, 16, v52
    v_and_b32 v25, 0xffff0000, v52
    v_lshlrev_b32 v26, 16, v53
    v_and_b32 v27, 0xffff0000, v53
    v_lshlrev_b32 v28, 16, v54
    v_and_b32 v29, 0xffff0000, v54
    v_lshlrev_b32 v30, 16, v55
    v_and_b32 v31, 0xffff0000, v55
    v_pk_add_f32 v[24:25], v[24:25], v[240:241]
    v_pk_add_f32 v[26:27], v[26:27], v[242:243]
    v_pk_add_f32 v[28:29], v[28:29], v[244:245]
    v_pk_add_f32 v[30:31], v[30:31], v[246:247]
    v_cvt_pk_bf16_f32 v124, v24, v25
    v_cvt_pk_bf16_f32 v125, v26, v27
    v_cvt_pk_bf16_f32 v126, v28, v29
    v_cvt_pk_bf16_f32 v127, v30, v31
    s_nop 1
    v_cndmask_b32_dpp v56, v124, v120, vcc quad_perm:[1,0,3,2] row_mask:0xf bank_mask:0xf
    v_cndmask_b32_dpp v57, v125, v121, vcc quad_perm:[1,0,3,2] row_mask:0xf bank_mask:0xf
    v_cndmask_b32_dpp v58, v126, v122, vcc quad_perm:[1,0,3,2] row_mask:0xf bank_mask:0xf
    v_cndmask_b32_dpp v59, v127, v123, vcc quad_perm:[1,0,3,2] row_mask:0xf bank_mask:0xf
    buffer_store_dwordx4 v[56:59], v231, s[20:23], 0 offen nt
    s_not_b64 vcc, vcc
    v_cndmask_b32_dpp v60, v120, v124, vcc quad_perm:[1,0,3,2] row_mask:0xf bank_mask:0xf
    v_cndmask_b32_dpp v61, v121, v125, vcc quad_perm:[1,0,3,2] row_mask:0xf bank_mask:0xf
    v_cndmask_b32_dpp v62, v122, v126, vcc quad_perm:[1,0,3,2] row_mask:0xf bank_mask:0xf
    v_cndmask_b32_dpp v63, v123, v127, vcc quad_perm:[1,0,3,2] row_mask:0xf bank_mask:0xf
    buffer_store_dwordx4 v[60:63], v231, s[20:23], 0 offen offset:2048 nt
K_end:
    s_endpgm
H_nre:
    s_add_u32 s65, s65, 1
    s_cmp_ge_u32 s65, 200000
    s_cbranch_scc1 H_nok
    s_sleep 4
    buffer_load_dword v78, v79, s[20:23], 0 offen sc1
    s_waitcnt vmcnt(0)
    s_branch H_nspin
H_retry:
    s_add_u32 s65, s65, 1
    s_cmp_ge_u32 s65, 200000
    s_cbranch_scc1 H_nq
    s_sleep 8
    s_mov_b32 s64, 6717440
    buffer_load_dwordx4 v[24:27], v6, s[16:19], s64 offen offset:0 sc1
    buffer_load_dwordx4 v[28:31], v6, s[16:19], s64 offen offset:1024 sc1
    s_waitcnt vmcnt(0)
    s_branch H_spin
G_f15:
    s_bitset1_b32 s66, s55
    s_branch G_q15
G_f14:
    s_bitset1_b32 s66, s54
    s_branch G_q14
G_f13:
    s_bitset1_b32 s66, s53
    s_branch G_q13
G_f12:
    s_bitset1_b32 s66, s52
    s_branch G_q12
G_f11:
    s_bitset1_b32 s66, s51
    s_branch G_q11
G_f10:
    s_bitset1_b32 s66, s50
    s_branch G_q10
G_f9:
    s_bitset1_b32 s66, s49
    s_branch G_q9
G_f8:
    s_bitset1_b32 s66, s48
    s_branch G_q8
G_f7:
    s_bitset1_b32 s66, s47
    s_branch G_q7
G_f6:
    s_bitset1_b32 s66, s46
    s_branch G_q6
G_f5:
    s_bitset1_b32 s66, s45
    s_branch G_q5
G_f4:
    s_bitset1_b32 s66, s44
    s_branch G_q4
G_f3:
    s_bitset1_b32 s66, s43
    s_branch G_q3
G_f2:
    s_bitset1_b32 s66, s42
    s_branch G_q2
G_f1:
    s_bitset1_b32 s66, s41
    s_branch G_q1
G_f0:
    s_bitset1_b32 s66, s40
    s_branch G_q0
phi_15_fix:
    v_lshlrev_b32 v48, 16, v16
    v_and_b32 v49, 0xffff0000, v16
    v_add_f32 v48, s73, v48
    v_add_f32 v49, s73, v49
    v_cvt_pk_bf16_f32 v16, v48, v49
    v_lshlrev_b32 v48, 16, v17
    v_and_b32 v49, 0xffff0000, v17
    v_add_f32 v48, s73, v48
    v_add_f32 v49, s73, v49
    v_cvt_pk_bf16_f32 v17, v48, v49
    v_lshlrev_b32 v48, 16, v18
    v_and_b32 v49, 0xffff0000, v18
    v_add_f32 v48, s73, v48
    v_add_f32 v49, s73, v49
    v_cvt_pk_bf16_f32 v18, v48, v49
    v_lshlrev_b32 v48, 16, v19
    v_and_b32 v49, 0xffff0000, v19
    v_add_f32 v48, s73, v48
    v_add_f32 v49, s73, v49
    v_cvt_pk_bf16_f32 v19, v48, v49
    v_lshlrev_b32 v48, 16, v20
    v_and_b32 v49, 0xffff0000, v20
    v_add_f32 v48, s73, v48
    v_add_f32 v49, s73, v49
    v_cvt_pk_bf16_f32 v20, v48, v49
    v_lshlrev_b32 v48, 16, v21
    v_and_b32 v49, 0xffff0000, v21
    v_add_f32 v48, s73, v48
    v_add_f32 v49, s73, v49
    v_cvt_pk_bf16_f32 v21, v48, v49
    v_lshlrev_b32 v48, 16, v22
    v_and_b32 v49, 0xffff0000, v22
    v_add_f32 v48, s73, v48
    v_add_f32 v49, s73, v49
    v_cvt_pk_bf16_f32 v22, v48, v49
    v_lshlrev_b32 v48, 16, v23
    v_and_b32 v49, 0xffff0000, v23
    v_add_f32 v48, s73, v48
    v_add_f32 v49, s73, v49
    v_cvt_pk_bf16_f32 v23, v48, v49
    s_branch phi_15_done
phi_16_fix:
    v_lshlrev_b32 v48, 16, v24
    v_and_b32 v49, 0xffff0000, v24
    v_add_f32 v48, s73, v48
    v_add_f32 v49, s73, v49
    v_cvt_pk_bf16_f32 v24, v48, v49
    v_lshlrev_b32 v48, 16, v25
    v_and_b32 v49, 0xffff0000, v25
    v_add_f32 v48, s73, v48
    v_add_f32 v49, s73, v49
    v_cvt_pk_bf16_f32 v25, v48, v49
    v_lshlrev_b32 v48, 16, v26
    v_and_b32 v49, 0xffff0000, v26
    v_add_f32 v48, s73, v48
    v_add_f32 v49, s73, v49
    v_cvt_pk_bf16_f32 v26, v48, v49
    v_lshlrev_b32 v48, 16, v27
    v_and_b32 v49, 0xffff0000, v27
    v_add_f32 v48, s73, v48
    v_add_f32 v49, s73, v49
    v_cvt_pk_bf16_f32 v27, v48, v49
    v_lshlrev_b32 v48, 16, v28
    v_and_b32 v49, 0xffff0000, v28
    v_add_f32 v48, s73, v48
    v_add_f32 v49, s73, v49
    v_cvt_pk_bf16_f32 v28, v48, v49
    v_lshlrev_b32 v48, 16, v29
    v_and_b32 v49, 0xffff0000, v29
    v_add_f32 v48, s73, v48
    v_add_f32 v49, s73, v49
    v_cvt_pk_bf16_f32 v29, v48, v49
    v_lshlrev_b32 v48, 16, v30
    v_and_b32 v49, 0xffff0000, v30
    v_add_f32 v48, s73, v48
    v_add_f32 v49, s73, v49
    v_cvt_pk_bf16_f32 v30, v48, v49
    v_lshlrev_b32 v48, 16, v31
    v_and_b32 v49, 0xffff0000, v31
    v_add_f32 v48, s73, v48
    v_add_f32 v49, s73, v49
    v_cvt_pk_bf16_f32 v31, v48, v49
    s_branch phi_16_done
C_ex1:
    ds_write_b32 v227, v52 offset:4608
    ds_write_b128 v224, v[240:243] offset:32768
    ds_write_b128 v224, v[244:247] offset:33792
    s_nop 4
    v_mov_b32 v52, v60
    v_mov_b32 v240, v248
    v_mov_b32 v241, v249
    v_mov_b32 v242, v250
    v_mov_b32 v243, v251
    v_mov_b32 v244, v252
    v_mov_b32 v245, v253
    v_mov_b32 v246, v254
    v_mov_b32 v247, v255
    s_branch C_ex2
phi_17_fix:
    v_lshlrev_b32 v48, 16, v32
    v_and_b32 v49, 0xffff0000, v32
    v_add_f32 v48, s73, v48
    v_add_f32 v49, s73, v49
    v_cvt_pk_bf16_f32 v32, v48, v49
    v_lshlrev_b32 v48, 16, v33
    v_and_b32 v49, 0xffff0000, v33
    v_add_f32 v48, s73, v48
    v_add_f32 v49, s73, v49
    v_cvt_pk_bf16_f32 v33, v48, v49
    v_lshlrev_b32 v48, 16, v34
    v_and_b32 v49, 0xffff0000, v34
    v_add_f32 v48, s73, v48
    v_add_f32 v49, s73, v49
    v_cvt_pk_bf16_f32 v34, v48, v49
    v_lshlrev_b32 v48, 16, v35
    v_and_b32 v49, 0xffff0000, v35
    v_add_f32 v48, s73, v48
    v_add_f32 v49, s73, v49
    v_cvt_pk_bf16_f32 v35, v48, v49
    v_lshlrev_b32 v48, 16, v36
    v_and_b32 v49, 0xffff0000, v36
    v_add_f32 v48, s73, v48
    v_add_f32 v49, s73, v49
    v_cvt_pk_bf16_f32 v36, v48, v49
    v_lshlrev_b32 v48, 16, v37
    v_and_b32 v49, 0xffff0000, v37
    v_add_f32 v48, s73, v48
    v_add_f32 v49, s73, v49
    v_cvt_pk_bf16_f32 v37, v48, v49
    v_lshlrev_b32 v48, 16, v38
    v_and_b32 v49, 0xffff0000, v38
    v_add_f32 v48, s73, v48
    v_add_f32 v49, s73, v49
    v_cvt_pk_bf16_f32 v38, v48, v49
    v_lshlrev_b32 v48, 16, v39
    v_and_b32 v49, 0xffff0000, v39
    v_add_f32 v48, s73, v48
    v_add_f32 v49, s73, v49
    v_cvt_pk_bf16_f32 v39, v48, v49
    s_branch phi_17_done
phi_18_fix:
    v_lshlrev_b32 v48, 16, v40
    v_and_b32 v49, 0xffff0000, v40
    v_add_f32 v48, s73, v48
    v_add_f32 v49, s73, v49
    v_cvt_pk_bf16_f32 v40, v48, v49
    v_lshlrev_b32 v48, 16, v41
    v_and_b32 v49, 0xffff0000, v41
    v_add_f32 v48, s73, v48
    v_add_f32 v49, s73, v49
    v_cvt_pk_bf16_f32 v41, v48, v49
    v_lshlrev_b32 v48, 16, v42
    v_and_b32 v49, 0xffff0000, v42
    v_add_f32 v48, s73, v48
    v_add_f32 v49, s73, v49
    v_cvt_pk_bf16_f32 v42, v48, v49
    v_lshlrev_b32 v48, 16, v43
    v_and_b32 v49, 0xffff0000, v43
    v_add_f32 v48, s73, v48
    v_add_f32 v49, s73, v49
    v_cvt_pk_bf16_f32 v43, v48, v49
    v_lshlrev_b32 v48, 16, v44
    v_and_b32 v49, 0xffff0000, v44
    v_add_f32 v48, s73, v48
    v_add_f32 v49, s73, v49
    v_cvt_pk_bf16_f32 v44, v48, v49
    v_lshlrev_b32 v48, 16, v45
    v_and_b32 v49, 0xffff0000, v45
    v_add_f32 v48, s73, v48
    v_add_f32 v49, s73, v49
    v_cvt_pk_bf16_f32 v45, v48, v49
    v_lshlrev_b32 v48, 16, v46
    v_and_b32 v49, 0xffff0000, v46
    v_add_f32 v48, s73, v48
    v_add_f32 v49, s73, v49
    v_cvt_pk_bf16_f32 v46, v48, v49
    v_lshlrev_b32 v48, 16, v47
    v_and_b32 v49, 0xffff0000, v47
    v_add_f32 v48, s73, v48
    v_add_f32 v49, s73, v49
    v_cvt_pk_bf16_f32 v47, v48, v49
    s_branch phi_18_done
P2_ys:
    v_lshrrev_b32 v13, 4, v2
    v_lshlrev_b32 v13, 12, v13
    v_and_b32 v208, 15, v2
    v_lshl_add_u32 v13, v208, 4, v13
    s_lshl_b32 s64, s5, 8
    v_add_u32 v13, s64, v13
    s_lshl_b32 s64, s67, 11
    s_lshl_b32 s65, s5, 7
    s_add_u32 s64, s64, s65
    v_lshl_add_u32 v209, v208, 3, s64
    s_lshl_b32 s64, s67, 2
    s_add_u32 s64, s64, 6709248
    v_mov_b32 v215, s64
    s_branch P2_ysd
P2_yl:
    s_cmp_gt_u32 s70, 4
    s_cbranch_scc1 P2_nyl
    buffer_load_dwordx2 v[210:211], v209, s[8:11], 0 offen
    buffer_load_dword v212, v215, s[16:19], 0 offen sc1
    s_mov_b32 s69, 6447104
    buffer_load_dwordx4 v[144:147], v13, s[16:19], s69 offen sc1
    s_mov_b32 s69, 6463488
    buffer_load_dwordx4 v[148:151], v13, s[16:19], s69 offen sc1
    s_mov_b32 s69, 6479872
    buffer_load_dwordx4 v[152:155], v13, s[16:19], s69 offen sc1
    s_mov_b32 s69, 6496256
    buffer_load_dwordx4 v[156:159], v13, s[16:19], s69 offen sc1
    s_mov_b32 s69, 6512640
    buffer_load_dwordx4 v[160:163], v13, s[16:19], s69 offen sc1
    s_mov_b32 s69, 6529024
    buffer_load_dwordx4 v[164:167], v13, s[16:19], s69 offen sc1
    s_mov_b32 s69, 6545408
    buffer_load_dwordx4 v[168:171], v13, s[16:19], s69 offen sc1
    s_mov_b32 s69, 6561792
    buffer_load_dwordx4 v[172:175], v13, s[16:19], s69 offen sc1
    s_mov_b32 s69, 6578176
    buffer_load_dwordx4 v[176:179], v13, s[16:19], s69 offen sc1
    s_mov_b32 s69, 6594560
    buffer_load_dwordx4 v[180:183], v13, s[16:19], s69 offen sc1
    s_mov_b32 s69, 6610944
    buffer_load_dwordx4 v[184:187], v13, s[16:19], s69 offen sc1
    s_mov_b32 s69, 6627328
    buffer_load_dwordx4 v[188:191], v13, s[16:19], s69 offen sc1
    s_mov_b32 s69, 6643712
    buffer_load_dwordx4 v[192:195], v13, s[16:19], s69 offen sc1
    s_mov_b32 s69, 6660096
    buffer_load_dwordx4 v[196:199], v13, s[16:19], s69 offen sc1
    s_mov_b32 s69, 6676480
    buffer_load_dwordx4 v[200:203], v13, s[16:19], s69 offen sc1
    s_mov_b32 s69, 6692864
    buffer_load_dwordx4 v[204:207], v13, s[16:19], s69 offen sc1
    s_mov_b32 s47, 1
    s_branch P2_nyl
P2_y:
    s_mov_b32 s66, 0
    s_cmp_lg_u32 s47, 0
    s_cbranch_scc1 P2_ychk
P2_yre:
    buffer_load_dwordx2 v[210:211], v209, s[8:11], 0 offen
    buffer_load_dword v212, v215, s[16:19], 0 offen sc1
    s_mov_b32 s69, 6447104
    buffer_load_dwordx4 v[144:147], v13, s[16:19], s69 offen sc1
    s_mov_b32 s69, 6463488
    buffer_load_dwordx4 v[148:151], v13, s[16:19], s69 offen sc1
    s_mov_b32 s69, 6479872
    buffer_load_dwordx4 v[152:155], v13, s[16:19], s69 offen sc1
    s_mov_b32 s69, 6496256
    buffer_load_dwordx4 v[156:159], v13, s[16:19], s69 offen sc1
    s_mov_b32 s69, 6512640
    buffer_load_dwordx4 v[160:163], v13, s[16:19], s69 offen sc1
    s_mov_b32 s69, 6529024
    buffer_load_dwordx4 v[164:167], v13, s[16:19], s69 offen sc1
    s_mov_b32 s69, 6545408
    buffer_load_dwordx4 v[168:171], v13, s[16:19], s69 offen sc1
    s_mov_b32 s69, 6561792
    buffer_load_dwordx4 v[172:175], v13, s[16:19], s69 offen sc1
    s_mov_b32 s69, 6578176
    buffer_load_dwordx4 v[176:179], v13, s[16:19], s69 offen sc1
    s_mov_b32 s69, 6594560
    buffer_load_dwordx4 v[180:183], v13, s[16:19], s69 offen sc1
    s_mov_b32 s69, 6610944
    buffer_load_dwordx4 v[184:187], v13, s[16:19], s69 offen sc1
    s_mov_b32 s69, 6627328
    buffer_load_dwordx4 v[188:191], v13, s[16:19], s69 offen sc1
    s_mov_b32 s69, 6643712
    buffer_load_dwordx4 v[192:195], v13, s[16:19], s69 offen sc1
    s_mov_b32 s69, 6660096
    buffer_load_dwordx4 v[196:199], v13, s[16:19], s69 offen sc1
    s_mov_b32 s69, 6676480
    buffer_load_dwordx4 v[200:203], v13, s[16:19], s69 offen sc1
    s_mov_b32 s69, 6692864
    buffer_load_dwordx4 v[204:207], v13, s[16:19], s69 offen sc1
P2_ychk:
    s_and_b32 s64, s75, 0xffff0000
    s_xor_b32 s65, s64, 0x80000000
    s_not_b32 s69, s64
    s_and_b32 s69, s69, 0xffff0000
    s_cmp_ge_u32 s64, 0x80000000
    s_cselect_b32 s64, s65, s69
    v_mov_b32 v213, s64
    v_mul_f32 v213, s72, v213
    v_exp_f32 v213, -v213
    s_nop 0
    v_add_f32 v213, 1.0, v213
    v_rcp_f32 v213, v213
    s_nop 0
    v_cvt_pk_bf16_f32 v213, v213, v213
    v_lshlrev_b32 v213, 16, v213
    s_waitcnt vmcnt(0)
    v_sub_f32 v214, 1.0, v212
    v_cvt_pk_bf16_f32 v214, v214, v214
    v_lshlrev_b32 v214, 16, v214
    v_max3_u32 v10, v144, v145, v146
    v_max3_u32 v10, v147, v148, v10
    v_max3_u32 v10, v149, v150, v10
    v_max3_u32 v10, v151, v152, v10
    v_max3_u32 v10, v153, v154, v10
    v_max3_u32 v10, v155, v156, v10
    v_max3_u32 v10, v157, v158, v10
    v_max3_u32 v10, v159, v160, v10
    v_max3_u32 v10, v161, v162, v10
    v_max3_u32 v10, v163, v164, v10
    v_max3_u32 v10, v165, v166, v10
    v_max3_u32 v10, v167, v168, v10
    v_max3_u32 v10, v169, v170, v10
    v_max3_u32 v10, v171, v172, v10
    v_max3_u32 v10, v173, v174, v10
    v_max3_u32 v10, v175, v176, v10
    v_max3_u32 v10, v177, v178, v10
    v_max3_u32 v10, v179, v180, v10
    v_max3_u32 v10, v181, v182, v10
    v_max3_u32 v10, v183, v184, v10
    v_max3_u32 v10, v185, v186, v10
    v_max3_u32 v10, v187, v188, v10
    v_max3_u32 v10, v189, v190, v10
    v_max3_u32 v10, v191, v192, v10
    v_max3_u32 v10, v193, v194, v10
    v_max3_u32 v10, v195, v196, v10
    v_max3_u32 v10, v197, v198, v10
    v_max3_u32 v10, v199, v200, v10
    v_max3_u32 v10, v201, v202, v10
    v_max3_u32 v10, v203, v204, v10
    v_max3_u32 v10, v205, v206, v10
    v_max_u32 v10, v207, v10
    v_cmp_eq_u32 vcc, -1, v10
    s_cbranch_vccz P2_yok
    s_add_u32 s66, s66, 1
    s_cmp_ge_u32 s66, 40000
    s_cbranch_scc1 P2_yok
    s_sleep 4
    s_branch P2_yre
P2_yok:
    v_pk_add_f32 v[144:145], v[144:145], v[176:177]
    v_pk_add_f32 v[146:147], v[146:147], v[178:179]
    v_pk_add_f32 v[148:149], v[148:149], v[180:181]
    v_pk_add_f32 v[150:151], v[150:151], v[182:183]
    v_pk_add_f32 v[152:153], v[152:153], v[184:185]
    v_pk_add_f32 v[154:155], v[154:155], v[186:187]
    v_pk_add_f32 v[156:157], v[156:157], v[188:189]
    v_pk_add_f32 v[158:159], v[158:159], v[190:191]
    v_pk_add_f32 v[160:161], v[160:161], v[192:193]
    v_pk_add_f32 v[162:163], v[162:163], v[194:195]
    v_pk_add_f32 v[164:165], v[164:165], v[196:197]
    v_pk_add_f32 v[166:167], v[166:167], v[198:199]
    v_pk_add_f32 v[168:169], v[168:169], v[200:201]
    v_pk_add_f32 v[170:171], v[170:171], v[202:203]
    v_pk_add_f32 v[172:173], v[172:173], v[204:205]
    v_pk_add_f32 v[174:175], v[174:175], v[206:207]
    v_pk_add_f32 v[144:145], v[144:145], v[160:161]
    v_pk_add_f32 v[146:147], v[146:147], v[162:163]
    v_pk_add_f32 v[148:149], v[148:149], v[164:165]
    v_pk_add_f32 v[150:151], v[150:151], v[166:167]
    v_pk_add_f32 v[152:153], v[152:153], v[168:169]
    v_pk_add_f32 v[154:155], v[154:155], v[170:171]
    v_pk_add_f32 v[156:157], v[156:157], v[172:173]
    v_pk_add_f32 v[158:159], v[158:159], v[174:175]
    v_pk_add_f32 v[144:145], v[144:145], v[152:153]
    v_pk_add_f32 v[146:147], v[146:147], v[154:155]
    v_pk_add_f32 v[148:149], v[148:149], v[156:157]
    v_pk_add_f32 v[150:151], v[150:151], v[158:159]
    v_pk_add_f32 v[144:145], v[144:145], v[148:149]
    v_pk_add_f32 v[146:147], v[146:147], v[150:151]
    v_mov_b32 v148, v144
    v_mov_b32 v149, v145
    v_mov_b32 v150, v146
    v_mov_b32 v151, v147
    s_nop 0
    v_permlane16_swap_b32 v144, v148
    v_permlane16_swap_b32 v145, v149
    v_permlane16_swap_b32 v146, v150
    v_permlane16_swap_b32 v147, v151
    v_add_f32 v144, v144, v148
    v_add_f32 v145, v145, v149
    v_add_f32 v146, v146, v150
    v_add_f32 v147, v147, v151
    v_mov_b32 v148, v144
    v_mov_b32 v149, v145
    v_mov_b32 v150, v146
    v_mov_b32 v151, v147
    s_nop 0
    v_permlane32_swap_b32 v144, v148
    v_permlane32_swap_b32 v145, v149
    v_permlane32_swap_b32 v146, v150
    v_permlane32_swap_b32 v147, v151
    v_add_f32 v144, v144, v148
    v_add_f32 v145, v145, v149
    v_add_f32 v146, v146, v150
    v_add_f32 v147, v147, v151
    v_cvt_pk_bf16_f32 v152, v144, v145
    v_lshlrev_b32 v144, 16, v152
    v_and_b32 v145, 0xffff0000, v152
    v_mul_f32 v144, v144, v213
    v_mul_f32 v145, v145, v213
    v_cvt_pk_bf16_f32 v152, v144, v145
    v_lshlrev_b32 v144, 16, v152
    v_and_b32 v145, 0xffff0000, v152
    v_lshlrev_b32 v148, 16, v210
    v_and_b32 v149, 0xffff0000, v210
    v_add_f32 v144, v148, v144
    v_add_f32 v145, v149, v145
    v_cvt_pk_bf16_f32 v152, v144, v145
    v_lshlrev_b32 v144, 16, v152
    v_and_b32 v145, 0xffff0000, v152
    v_mul_f32 v144, v144, v214
    v_mul_f32 v145, v145, v214
    v_cvt_pk_bf16_f32 v152, v144, v145
    v_lshlrev_b32 v144, 16, v152
    v_and_b32 v145, 0xffff0000, v152
    v_cvt_pk_bf16_f32 v152, v146, v147
    v_lshlrev_b32 v146, 16, v152
    v_and_b32 v147, 0xffff0000, v152
    v_mul_f32 v146, v146, v213
    v_mul_f32 v147, v147, v213
    v_cvt_pk_bf16_f32 v152, v146, v147
    v_lshlrev_b32 v146, 16, v152
    v_and_b32 v147, 0xffff0000, v152
    v_lshlrev_b32 v150, 16, v211
    v_and_b32 v151, 0xffff0000, v211
    v_add_f32 v146, v150, v146
    v_add_f32 v147, v151, v147
    v_cvt_pk_bf16_f32 v152, v146, v147
    v_lshlrev_b32 v146, 16, v152
    v_and_b32 v147, 0xffff0000, v152
    v_mul_f32 v146, v146, v214
    v_mul_f32 v147, v147, v214
    v_cvt_pk_bf16_f32 v152, v146, v147
    v_lshlrev_b32 v146, 16, v152
    v_and_b32 v147, 0xffff0000, v152
    v_lshlrev_b32 v208, 4, v208
    ds_write_b128 v208, v[144:147] offset:5632
    s_waitcnt lgkmcnt(0)
    s_branch P2_ny
P2_fix:
    s_mov_b64 exec, s[70:71]
    ds_read_b128 v[232:235], v9 offset:5632
    ds_read_b128 v[236:239], v9 offset:5648
    ds_read_b128 v[240:243], v9 offset:5760
    ds_read_b128 v[244:247], v9 offset:5776
    s_mov_b64 exec, -1
    s_branch P2_nr
CODE_END:
.section .rodata,"a"
.p2align 6
.amdhsa_kernel gated_mix__linear_attn_block__moe_arch_mod__prompt_kernel
  .amdhsa_next_free_vgpr 256
  .amdhsa_next_free_sgpr 102
  .amdhsa_accum_offset 256
  .amdhsa_group_segment_fixed_size 0
  .amdhsa_kernarg_size 96
  .amdhsa_user_sgpr_count 2
  .amdhsa_user_sgpr_kernarg_segment_ptr 1
  .amdhsa_system_sgpr_workgroup_id_x 1
.end_amdhsa_kernel
```

```asm
; @launch grid=(256,1,1) block=(512,1,1) lds=163840
.amdgcn_target "amdgcn-amd-amdhsa--gfx950"
.text
.globl gated_mix__linear_attn_block__moe_arch_mod__prompt_kernel
.p2align 8
.type gated_mix__linear_attn_block__moe_arch_mod__prompt_kernel,@function
gated_mix__linear_attn_block__moe_arch_mod__prompt_kernel:
    s_load_dwordx16 s[40:55], s[0:1], 0
    s_load_dwordx8 s[56:63], s[0:1], 64
    s_cmp_ge_u32 s2, 256
    s_cbranch_scc1 K_end
    v_lshrrev_b32 v1, 6, v0
    v_and_b32 v2, 63, v0
    s_and_b32 s6, s2, 7
    v_readfirstlane_b32 s3, v1
    s_lshr_b32 s7, s2, 3
    s_and_b32 s4, s6, 1
    s_lshl_b32 s4, s4, 3
    s_and_b32 s64, s7, 7
    s_add_u32 s4, s4, s64
    s_lshr_b32 s5, s6, 1
    s_lshl_b32 s5, s5, 2
    s_lshr_b32 s64, s7, 3
    s_add_u32 s5, s5, s64
    s_lshl_b32 s74, s4, 1
    v_lshrrev_b32 v6, 3, v2
    s_lshl_b32 s65, s3, 3
    v_add_u32 v6, s65, v6
    s_lshl_b32 s64, s4, 7
    v_add_u32 v7, s64, v6
    v_lshlrev_b32 v7, 11, v7
    v_lshrrev_b32 v8, 4, v2
    s_and_b32 s64, s3, 1
    s_lshl_b32 s64, s64, 2
    v_add_u32 v9, s64, v8
    v_and_b32 v10, 7, v2
    v_xor_b32 v9, v9, v10
    v_lshl_add_u32 v7, v9, 4, v7
    v_mul_u32_u24 v6, 6144, v6
    v_and_b32 v9, 1, v8
    s_lshr_b32 s64, s64, 1
    v_lshl_add_u32 v9, v9, 2, s64
    v_xor_b32 v9, v9, v10
    v_lshl_add_u32 v6, v9, 4, v6
    s_lshl_b32 s64, s5, 7
    v_add_u32 v6, s64, v6
    s_lshl_b32 s66, s3, 10
    s_mov_b32 s10, 4194304
    s_mov_b32 s11, 0x00020000
    s_mov_b32 s14, 6291456
    s_mov_b32 s15, 0x00020000
    s_add_u32 s65, s74, 0
    s_and_b32 s65, s65, 15
    s_lshl_b32 s67, s65, 7
    s_mul_i32 s65, s65, 393216
    s_waitcnt lgkmcnt(0)
    s_mov_b32 s8, s40
    s_mov_b32 s9, s41
    s_mov_b32 s12, s42
    s_mov_b32 s13, s43
    s_add_u32 m0, s66, 8192
    s_add_u32 s64, s67, 0
    buffer_load_dwordx4 v7, s[8:11], s64 offen lds
    s_add_u32 m0, s66, 16384
    s_add_u32 s64, s67, 131072
    buffer_load_dwordx4 v7, s[8:11], s64 offen lds
    s_add_u32 m0, s66, 24576
    s_add_u32 s64, s65, 0
    buffer_load_dwordx4 v6, s[12:15], s64 offen lds
    s_add_u32 m0, s66, 32768
    s_add_u32 s64, s65, 2048
    buffer_load_dwordx4 v6, s[12:15], s64 offen lds
    s_add_u32 m0, s66, 40960
    s_add_u32 s64, s65, 4096
    buffer_load_dwordx4 v6, s[12:15], s64 offen lds
    s_barrier
    s_mov_b32 s72, 0x3fb8aa3b
    s_mov_b32 s73, 0x358637bd
    s_mov_b32 s16, s62
    s_mov_b32 s17, s63
    s_mov_b32 s18, 0x10000000
    s_mov_b32 s19, 0x00020000
    s_cmp_lt_u32 s3, 4
    s_cbranch_scc1 C_start
    s_sub_u32 s6, s3, 4
    s_lshl_b32 s7, s6, 10
    v_lshrrev_b32 v6, 3, v2
    s_lshl_b32 s64, s4, 7
    s_lshl_b32 s65, s6, 3
    s_add_u32 s64, s64, s65
    v_add_u32 v7, s64, v6
    v_lshlrev_b32 v7, 11, v7
    s_and_b32 s64, s6, 1
    s_lshl_b32 s64, s64, 2
    v_add_u32 v9, s64, v8
    v_xor_b32 v9, v9, v10
    v_lshl_add_u32 v4, v9, 4, v7
    v_add_u32 v7, s65, v6
    v_mul_u32_u24 v7, 6144, v7
    v_and_b32 v9, 1, v8
    s_lshr_b32 s64, s64, 1
    v_lshl_add_u32 v9, v9, 2, s64
    v_xor_b32 v9, v9, v10
    v_lshl_add_u32 v7, v9, 4, v7
    s_lshl_b32 s64, s5, 7
    v_add_u32 v5, s64, v7
    v_lshlrev_b32 v6, 4, v2
    s_and_b32 s64, s2, 1
    s_lshl_b32 s68, s64, 10
    s_bfe_u32 s64, s2, 0x20001
    s_lshl_b32 s64, s64, 8
    s_add_u32 s68, s68, s64
    s_and_b32 s64, s2, 0xf8
    s_add_u32 s68, s68, s64
    s_lshl_b32 s64, s6, 1
    s_add_u32 s68, s68, s64
    s_lshl_b32 s64, s68, 11
    v_add_u32 v13, s64, v6
    s_add_u32 s41, s74, 1
    s_and_b32 s41, s41, 15
    s_lshl_b32 s42, s41, 7
    s_mul_i32 s41, s41, 393216
    s_add_u32 m0, s7, 49152
    s_add_u32 s40, s42, 0
    buffer_load_dwordx4 v4, s[8:11], s40 offen lds
    s_add_u32 m0, s7, 53248
    s_add_u32 s40, s42, 65536
    buffer_load_dwordx4 v4, s[8:11], s40 offen lds
    s_add_u32 m0, s7, 57344
    s_add_u32 s40, s42, 131072
    buffer_load_dwordx4 v4, s[8:11], s40 offen lds
    s_add_u32 m0, s7, 61440
    s_add_u32 s40, s42, 196608
    buffer_load_dwordx4 v4, s[8:11], s40 offen lds
    s_add_u32 m0, s7, 65536
    s_add_u32 s40, s41, 0
    buffer_load_dwordx4 v5, s[12:15], s40 offen lds
    s_add_u32 m0, s7, 69632
    s_add_u32 s40, s41, 196608
    buffer_load_dwordx4 v5, s[12:15], s40 offen lds
    s_add_u32 m0, s7, 73728
    s_add_u32 s40, s41, 2048
    buffer_load_dwordx4 v5, s[12:15], s40 offen lds
    s_add_u32 m0, s7, 77824
    s_add_u32 s40, s41, 198656
    buffer_load_dwordx4 v5, s[12:15], s40 offen lds
    s_add_u32 m0, s7, 81920
    s_add_u32 s40, s41, 4096
    buffer_load_dwordx4 v5, s[12:15], s40 offen lds
    s_add_u32 m0, s7, 86016
    s_add_u32 s40, s41, 200704
    buffer_load_dwordx4 v5, s[12:15], s40 offen lds
    s_or_b32 s64, s2, s6
    s_cmp_lg_u32 s64, 0
    s_cbranch_scc1 H_nn
    s_mov_b32 s64, 6717440
    s_load_dwordx2 s[66:67], s[62:63], s64
    s_mov_b32 s20, s60
    s_mov_b32 s21, s61
    s_mov_b32 s22, 0x100
    s_mov_b32 s23, 0x00020000
    s_waitcnt lgkmcnt(0)
    s_xor_b32 s64, s66, s67
    s_add_u32 s64, s64, 1
    s_max_u32 s64, s64, 1
    v_mov_b32 v72, s64
    v_mov_b32 v73, 0
    s_mov_b64 exec, 1
    buffer_store_dword v72, v73, s[20:23], 0 offen sc0 sc1
    s_mov_b64 exec, -1
H_nn:
    s_mov_b32 s20, s60
    s_mov_b32 s21, s61
    s_mov_b32 s22, 0x100
    s_mov_b32 s23, 0x00020000
    s_mov_b32 s24, s48
    s_mov_b32 s25, s49
    s_mov_b32 s26, 0x800
    s_mov_b32 s27, 0x00020000
    s_mov_b32 s28, s56
    s_mov_b32 s29, s57
    s_mov_b32 s30, 0x800
    s_mov_b32 s31, 0x00020000
    s_mov_b32 s32, s50
    s_mov_b32 s33, s51
    s_mov_b32 s34, 0x700000
    s_mov_b32 s35, 0x00020000
    s_mov_b32 s36, s52
    s_mov_b32 s37, s53
    s_mov_b32 s38, 0x700000
    s_mov_b32 s39, 0x00020000
    s_lshr_b32 s69, s2, 3
    s_and_b32 s64, s2, 7
    v_and_b32 v9, 15, v2
    v_min_u32 v9, 13, v9
    s_lshl_b32 s65, s69, 5
    v_lshl_add_u32 v7, v8, 3, s65
    v_mul_u32_u24 v7, 7168, v7
    s_mul_i32 s65, s64, 896
    s_mul_i32 s66, s6, 224
    s_add_u32 s65, s65, s66
    v_lshl_add_u32 v7, v9, 4, v7
    v_add_u32 v11, s65, v7
    v_cmp_le_u32 vcc, 7, v9
    v_mov_b32 v15, 16160
    s_nop 0
    v_cndmask_b32 v7, 0, v15, vcc
    v_lshl_add_u32 v7, v9, 5, v7
    v_lshrrev_b32 v15, 1, v8
    v_lshl_add_u32 v7, v15, 13, v7
    v_and_b32 v15, 1, v8
    v_lshl_add_u32 v7, v15, 4, v7
    s_lshl_b32 s64, s64, 17
    s_lshl_b32 s65, s6, 15
    s_add_u32 s64, s64, s65
    s_lshl_b32 s65, s69, 8
    s_add_u32 s64, s64, s65
    s_add_u32 s64, s64, 5398528
    v_add_u32 v12, s64, v7
    s_lshl_b32 s70, s5, 2
    s_add_u32 s70, s70, s6
    s_mul_i32 s70, s70, 18432
    s_add_u32 s70, s70, 4194304
    s_mul_i32 s64, s4, 1152
    s_add_u32 s64, s64, s70
    s_mov_b32 s67, s64
    v_lshl_add_u32 v15, v2, 2, s64
    v_add_u32 v15, 960, v15
    s_lshl_b32 s64, s5, 2
    s_add_u32 s64, s64, s6
    s_lshl_b32 s64, s64, 7
    s_add_u32 s64, s64, 5373952
    v_mov_b32 v23, s64
    s_lshl_b32 s65, s4, 10
    s_add_u32 s65, s65, 5382016
    v_lshl_add_u32 v20, v2, 7, s65
    v_cmp_gt_u32 vcc, 16, v2
    s_nop 1
    v_cndmask_b32 v15, v15, v20, vcc
    v_writelane_b32 v15, s64, 0
    s_cmp_eq_u32 s4, 0
    s_cselect_b32 s75, 1, 0
    s_or_b32 s64, s5, s6
    s_cmp_eq_u32 s64, 0
    s_cselect_b32 s64, 0x1fe, 0
    s_or_b32 s75, s75, s64
    s_or_b32 s75, s75, 0xffff0000
    v_add_u32 v22, s67, v6
    v_mov_b32 v16, -1
    v_mov_b32 v17, -1
    v_mov_b32 v18, -1
    v_mov_b32 v19, -1
    v_cndmask_b32 v20, -1, 0, vcc
    s_waitcnt vmcnt(10)
    s_barrier
    s_add_u32 s41, s74, 2
    s_and_b32 s41, s41, 15
    s_lshl_b32 s42, s41, 7
    s_mul_i32 s41, s41, 393216
    s_add_u32 m0, s7, 90112
    s_add_u32 s40, s42, 0
    buffer_load_dwordx4 v4, s[8:11], s40 offen lds
    s_add_u32 m0, s7, 94208
    s_add_u32 s40, s42, 65536
    buffer_load_dwordx4 v4, s[8:11], s40 offen lds
    s_add_u32 m0, s7, 98304
    s_add_u32 s40, s42, 131072
    buffer_load_dwordx4 v4, s[8:11], s40 offen lds
    s_add_u32 m0, s7, 102400
    s_add_u32 s40, s42, 196608
    buffer_load_dwordx4 v4, s[8:11], s40 offen lds
    s_add_u32 m0, s7, 106496
    s_add_u32 s40, s41, 0
    buffer_load_dwordx4 v5, s[12:15], s40 offen lds
    s_add_u32 m0, s7, 110592
    s_add_u32 s40, s41, 196608
    buffer_load_dwordx4 v5, s[12:15], s40 offen lds
    s_add_u32 m0, s7, 114688
    s_add_u32 s40, s41, 2048
    buffer_load_dwordx4 v5, s[12:15], s40 offen lds
    s_add_u32 m0, s7, 118784
    s_add_u32 s40, s41, 198656
    buffer_load_dwordx4 v5, s[12:15], s40 offen lds
    s_add_u32 m0, s7, 122880
    s_add_u32 s40, s41, 4096
    buffer_load_dwordx4 v5, s[12:15], s40 offen lds
    s_add_u32 m0, s7, 126976
    s_add_u32 s40, s41, 200704
    buffer_load_dwordx4 v5, s[12:15], s40 offen lds
    buffer_load_dwordx4 v[24:27], v13, s[8:11], 0 offen offset:0
    buffer_load_dwordx4 v[28:31], v13, s[8:11], 0 offen offset:1024
    buffer_load_dwordx4 v[32:35], v13, s[8:11], 0 offen offset:2048
    buffer_load_dwordx4 v[36:39], v13, s[8:11], 0 offen offset:3072
    buffer_load_dwordx4 v[40:43], v6, s[24:27], 0 offen offset:0
    buffer_load_dwordx4 v[44:47], v6, s[24:27], 0 offen offset:1024
    buffer_load_dwordx4 v[48:51], v6, s[28:31], 0 offen offset:0
    buffer_load_dwordx4 v[52:55], v6, s[28:31], 0 offen offset:1024
    s_waitcnt vmcnt(18)
    s_barrier
    s_add_u32 s41, s74, 3
    s_and_b32 s41, s41, 15
    s_lshl_b32 s42, s41, 7
    s_mul_i32 s41, s41, 393216
    s_add_u32 m0, s7, 8192
    s_add_u32 s40, s42, 0
    buffer_load_dwordx4 v4, s[8:11], s40 offen lds
    s_add_u32 m0, s7, 12288
    s_add_u32 s40, s42, 65536
    buffer_load_dwordx4 v4, s[8:11], s40 offen lds
    s_add_u32 m0, s7, 16384
    s_add_u32 s40, s42, 131072
    buffer_load_dwordx4 v4, s[8:11], s40 offen lds
    s_add_u32 m0, s7, 20480
    s_add_u32 s40, s42, 196608
    buffer_load_dwordx4 v4, s[8:11], s40 offen lds
    s_add_u32 m0, s7, 24576
    s_add_u32 s40, s41, 0
    buffer_load_dwordx4 v5, s[12:15], s40 offen lds
    s_add_u32 m0, s7, 28672
    s_add_u32 s40, s41, 196608
    buffer_load_dwordx4 v5, s[12:15], s40 offen lds
    s_add_u32 m0, s7, 32768
    s_add_u32 s40, s41, 2048
    buffer_load_dwordx4 v5, s[12:15], s40 offen lds
    s_add_u32 m0, s7, 36864
    s_add_u32 s40, s41, 198656
    buffer_load_dwordx4 v5, s[12:15], s40 offen lds
    s_add_u32 m0, s7, 40960
    s_add_u32 s40, s41, 4096
    buffer_load_dwordx4 v5, s[12:15], s40 offen lds
    s_add_u32 m0, s7, 45056
    s_add_u32 s40, s41, 200704
    buffer_load_dwordx4 v5, s[12:15], s40 offen lds
    buffer_store_dwordx4 v[16:19], v22, s[16:19], 0 offen sc0 sc1
    s_mov_b32 exec_lo, s75
    s_mov_b32 exec_hi, 0
    buffer_store_dword v20, v15, s[16:19], 0 offen sc0 sc1
    s_mov_b32 exec_lo, 0x3fff3fff
    s_mov_b32 exec_hi, 0x3fff3fff
    buffer_store_dwordx4 v[16:19], v12, s[16:19], 0 offen sc0 sc1
    s_mov_b64 exec, 0xffff
    s_lshl_b32 s64, s2, 10
    s_lshl_b32 s65, s6, 8
    s_add_u32 s64, s64, s65
    s_add_u32 s64, s64, 6447104
    buffer_store_dwordx4 v[16:19], v6, s[16:19], s64 offen sc0 sc1
    s_mov_b64 exec, -1
    s_waitcnt vmcnt(22)
    s_barrier
    v_mov_b32 v79, 0
    s_cmp_lg_u32 s6, 0
    s_cbranch_scc1 H_nc
    buffer_load_dword v78, v79, s[20:23], 0 offen sc1
H_nc:
    s_add_u32 s41, s74, 4
    s_and_b32 s41, s41, 15
    s_lshl_b32 s42, s41, 7
    s_mul_i32 s41, s41, 393216
    s_add_u32 m0, s7, 49152
    s_add_u32 s40, s42, 0
    buffer_load_dwordx4 v4, s[8:11], s40 offen lds
    s_add_u32 m0, s7, 53248
    s_add_u32 s40, s42, 65536
    buffer_load_dwordx4 v4, s[8:11], s40 offen lds
    s_add_u32 m0, s7, 57344
    s_add_u32 s40, s42, 131072
    buffer_load_dwordx4 v4, s[8:11], s40 offen lds
    s_add_u32 m0, s7, 61440
    s_add_u32 s40, s42, 196608
    buffer_load_dwordx4 v4, s[8:11], s40 offen lds
    s_add_u32 m0, s7, 65536
    s_add_u32 s40, s41, 0
    buffer_load_dwordx4 v5, s[12:15], s40 offen lds
    s_add_u32 m0, s7, 69632
    s_add_u32 s40, s41, 196608
    buffer_load_dwordx4 v5, s[12:15], s40 offen lds
    s_add_u32 m0, s7, 73728
    s_add_u32 s40, s41, 2048
    buffer_load_dwordx4 v5, s[12:15], s40 offen lds
    s_add_u32 m0, s7, 77824
    s_add_u32 s40, s41, 198656
    buffer_load_dwordx4 v5, s[12:15], s40 offen lds
    s_add_u32 m0, s7, 81920
    s_add_u32 s40, s41, 4096
    buffer_load_dwordx4 v5, s[12:15], s40 offen lds
    s_add_u32 m0, s7, 86016
    s_add_u32 s40, s41, 200704
    buffer_load_dwordx4 v5, s[12:15], s40 offen lds
    s_waitcnt vmcnt(14)
    s_barrier
    s_add_u32 s41, s74, 5
    s_and_b32 s41, s41, 15
    s_lshl_b32 s42, s41, 7
    s_mul_i32 s41, s41, 393216
    s_add_u32 m0, s7, 90112
    s_add_u32 s40, s42, 0
    buffer_load_dwordx4 v4, s[8:11], s40 offen lds
    v_dot2_f32_bf16 v72, v24, v48, 0
    v_dot2_f32_bf16 v73, v32, v48, 0
    v_dot2_f32_bf16 v74, v24, v40, 0
    v_dot2_f32_bf16 v75, v32, v40, 0
    s_add_u32 m0, s7, 94208
    s_add_u32 s40, s42, 65536
    buffer_load_dwordx4 v4, s[8:11], s40 offen lds
    v_dot2_f32_bf16 v72, v25, v49, v72
    v_dot2_f32_bf16 v73, v33, v49, v73
    v_dot2_f32_bf16 v74, v25, v41, v74
    v_dot2_f32_bf16 v75, v33, v41, v75
    s_add_u32 m0, s7, 98304
    s_add_u32 s40, s42, 131072
    buffer_load_dwordx4 v4, s[8:11], s40 offen lds
    v_dot2_f32_bf16 v72, v26, v50, v72
    v_dot2_f32_bf16 v73, v34, v50, v73
    v_dot2_f32_bf16 v74, v26, v42, v74
    v_dot2_f32_bf16 v75, v34, v42, v75
    s_add_u32 m0, s7, 102400
    s_add_u32 s40, s42, 196608
    buffer_load_dwordx4 v4, s[8:11], s40 offen lds
    v_dot2_f32_bf16 v72, v27, v51, v72
    v_dot2_f32_bf16 v73, v35, v51, v73
    v_dot2_f32_bf16 v74, v27, v43, v74
    v_dot2_f32_bf16 v75, v35, v43, v75
    s_add_u32 m0, s7, 106496
    s_add_u32 s40, s41, 0
    buffer_load_dwordx4 v5, s[12:15], s40 offen lds
    v_dot2_f32_bf16 v72, v28, v52, v72
    v_dot2_f32_bf16 v73, v36, v52, v73
    v_dot2_f32_bf16 v74, v28, v44, v74
    v_dot2_f32_bf16 v75, v36, v44, v75
    s_add_u32 m0, s7, 110592
    s_add_u32 s40, s41, 196608
    buffer_load_dwordx4 v5, s[12:15], s40 offen lds
    v_dot2_f32_bf16 v72, v29, v53, v72
    v_dot2_f32_bf16 v73, v37, v53, v73
    v_dot2_f32_bf16 v74, v29, v45, v74
    v_dot2_f32_bf16 v75, v37, v45, v75
    s_add_u32 m0, s7, 114688
    s_add_u32 s40, s41, 2048
    buffer_load_dwordx4 v5, s[12:15], s40 offen lds
    v_dot2_f32_bf16 v72, v30, v54, v72
    v_dot2_f32_bf16 v73, v38, v54, v73
    v_dot2_f32_bf16 v74, v30, v46, v74
    v_dot2_f32_bf16 v75, v38, v46, v75
    s_add_u32 m0, s7, 118784
    s_add_u32 s40, s41, 198656
    buffer_load_dwordx4 v5, s[12:15], s40 offen lds
    v_dot2_f32_bf16 v72, v31, v55, v72
    v_dot2_f32_bf16 v73, v39, v55, v73
    v_dot2_f32_bf16 v74, v31, v47, v74
    v_dot2_f32_bf16 v75, v39, v47, v75
    s_add_u32 m0, s7, 122880
    s_add_u32 s40, s41, 4096
    buffer_load_dwordx4 v5, s[12:15], s40 offen lds
    s_add_u32 m0, s7, 126976
    s_add_u32 s40, s41, 200704
    buffer_load_dwordx4 v5, s[12:15], s40 offen lds
    s_waitcnt vmcnt(10)
    s_barrier
    s_add_u32 s41, s74, 6
    s_and_b32 s41, s41, 15
    s_lshl_b32 s42, s41, 7
    s_mul_i32 s41, s41, 393216
    s_add_u32 m0, s7, 8192
    s_add_u32 s40, s42, 0
    buffer_load_dwordx4 v4, s[8:11], s40 offen lds
    v_permlane32_swap_b32 v72, v74
    v_permlane32_swap_b32 v73, v75
    v_add_f32 v72, v72, v74
    v_add_f32 v73, v73, v75
    s_add_u32 m0, s7, 12288
    s_add_u32 s40, s42, 65536
    buffer_load_dwordx4 v4, s[8:11], s40 offen lds
    s_lshl_b32 s64, s68, 2
    s_add_u32 s64, s64, 6709248
    v_permlane16_swap_b32 v72, v73
    v_add_f32 v72, v72, v73
    s_add_u32 m0, s7, 16384
    s_add_u32 s40, s42, 131072
    buffer_load_dwordx4 v4, s[8:11], s40 offen lds
    v_and_b32 v75, 1, v8
    v_lshl_add_u32 v76, v75, 2, s64
    v_add_f32_dpp v72, v72, v72 quad_perm:[1,0,3,2] row_mask:0xf bank_mask:0xf
    s_nop 1
    s_add_u32 m0, s7, 20480
    s_add_u32 s40, s42, 196608
    buffer_load_dwordx4 v4, s[8:11], s40 offen lds
    v_add_f32_dpp v72, v72, v72 quad_perm:[2,3,0,1] row_mask:0xf bank_mask:0xf
    s_nop 1
    v_add_f32_dpp v72, v72, v72 row_half_mirror row_mask:0xf bank_mask:0xf
    s_nop 1
    s_add_u32 m0, s7, 24576
    s_add_u32 s40, s41, 0
    buffer_load_dwordx4 v5, s[12:15], s40 offen lds
    v_add_f32_dpp v72, v72, v72 row_mirror row_mask:0xf bank_mask:0xf
    s_nop 1
    v_cvt_pk_bf16_f32 v72, v72, v72
    s_sub_u32 s64, 34815, s68
    s_add_u32 m0, s7, 28672
    s_add_u32 s40, s41, 196608
    buffer_load_dwordx4 v5, s[12:15], s40 offen lds
    v_lshlrev_b32 v72, 16, v72
    v_ashrrev_i32 v73, 31, v72
    v_sub_u32 v77, s64, v75
    v_or_b32 v73, 0x80000000, v73
    s_add_u32 m0, s7, 32768
    s_add_u32 s40, s41, 2048
    buffer_load_dwordx4 v5, s[12:15], s40 offen lds
    s_lshl_b32 s64, s6, 3
    v_xor_b32 v73, v72, v73
    v_lshl_add_u32 v75, v75, 2, s64
    v_and_b32 v73, 0xffff0000, v73
    s_add_u32 m0, s7, 36864
    s_add_u32 s40, s41, 198656
    buffer_load_dwordx4 v5, s[12:15], s40 offen lds
    v_or_b32 v73, v77, v73
    v_mul_f32 v72, s72, v72
    v_exp_f32 v72, -v72
    s_nop 0
    s_add_u32 m0, s7, 40960
    s_add_u32 s40, s41, 4096
    buffer_load_dwordx4 v5, s[12:15], s40 offen lds
    v_add_f32 v72, 1.0, v72
    v_rcp_f32 v72, v72
    s_nop 0
    v_cvt_pk_bf16_f32 v72, v72, v72
    s_add_u32 m0, s7, 45056
    s_add_u32 s40, s41, 200704
    buffer_load_dwordx4 v5, s[12:15], s40 offen lds
    v_lshlrev_b32 v72, 16, v72
    s_mov_b32 exec_lo, 0
    s_mov_b32 exec_hi, 0x10001
    ds_write_b32 v75, v73 offset:4224
    s_mov_b32 exec_lo, 0x10001
    s_mov_b32 exec_hi, 0
    buffer_store_dword v72, v76, s[16:19], 0 offen sc0 sc1
    s_mov_b64 exec, -1
    s_mov_b32 exec_lo, 0x3fff3fff
    s_mov_b32 exec_hi, 0x3fff3fff
    s_mov_b32 s64, 0
    buffer_load_dwordx4 v[96:99], v11, s[32:35], s64 offen nt
    s_mov_b32 s64, 0
    buffer_load_dwordx4 v[128:131], v11, s[36:39], s64 offen nt
    s_mov_b32 s64, 7168
    buffer_load_dwordx4 v[100:103], v11, s[32:35], s64 offen nt
    s_mov_b32 s64, 7168
    buffer_load_dwordx4 v[132:135], v11, s[36:39], s64 offen nt
    s_mov_b32 s64, 14336
    buffer_load_dwordx4 v[104:107], v11, s[32:35], s64 offen nt
    s_mov_b64 exec, -1
    s_waitcnt vmcnt(16)
    s_waitcnt lgkmcnt(0)
    s_barrier
    s_add_u32 s41, s74, 7
    s_and_b32 s41, s41, 15
    s_lshl_b32 s42, s41, 7
    s_mul_i32 s41, s41, 393216
    s_add_u32 m0, s7, 49152
    s_add_u32 s40, s42, 0
    buffer_load_dwordx4 v4, s[8:11], s40 offen lds
    s_add_u32 m0, s7, 53248
    s_add_u32 s40, s42, 65536
    buffer_load_dwordx4 v4, s[8:11], s40 offen lds
    s_add_u32 m0, s7, 57344
    s_add_u32 s40, s42, 131072
    buffer_load_dwordx4 v4, s[8:11], s40 offen lds
    s_add_u32 m0, s7, 61440
    s_add_u32 s40, s42, 196608
    buffer_load_dwordx4 v4, s[8:11], s40 offen lds
    s_add_u32 m0, s7, 65536
    s_add_u32 s40, s41, 0
    buffer_load_dwordx4 v5, s[12:15], s40 offen lds
    s_add_u32 m0, s7, 69632
    s_add_u32 s40, s41, 196608
    buffer_load_dwordx4 v5, s[12:15], s40 offen lds
    s_add_u32 m0, s7, 73728
    s_add_u32 s40, s41, 2048
    buffer_load_dwordx4 v5, s[12:15], s40 offen lds
    s_add_u32 m0, s7, 77824
    s_add_u32 s40, s41, 198656
    buffer_load_dwordx4 v5, s[12:15], s40 offen lds
    s_add_u32 m0, s7, 81920
    s_add_u32 s40, s41, 4096
    buffer_load_dwordx4 v5, s[12:15], s40 offen lds
    s_add_u32 m0, s7, 86016
    s_add_u32 s40, s41, 200704
    buffer_load_dwordx4 v5, s[12:15], s40 offen lds
    s_waitcnt vmcnt(16)
    s_barrier
    s_add_u32 s41, s74, 8
    s_and_b32 s41, s41, 15
    s_lshl_b32 s42, s41, 7
    s_mul_i32 s41, s41, 393216
    s_add_u32 m0, s7, 90112
    s_add_u32 s40, s42, 0
    buffer_load_dwordx4 v4, s[8:11], s40 offen lds
    s_add_u32 m0, s7, 94208
    s_add_u32 s40, s42, 65536
    buffer_load_dwordx4 v4, s[8:11], s40 offen lds
    s_add_u32 m0, s7, 98304
    s_add_u32 s40, s42, 131072
    buffer_load_dwordx4 v4, s[8:11], s40 offen lds
    s_add_u32 m0, s7, 102400
    s_add_u32 s40, s42, 196608
    buffer_load_dwordx4 v4, s[8:11], s40 offen lds
    s_add_u32 m0, s7, 106496
    s_add_u32 s40, s41, 0
    buffer_load_dwordx4 v5, s[12:15], s40 offen lds
    s_add_u32 m0, s7, 110592
    s_add_u32 s40, s41, 196608
    buffer_load_dwordx4 v5, s[12:15], s40 offen lds
    s_add_u32 m0, s7, 114688
    s_add_u32 s40, s41, 2048
    buffer_load_dwordx4 v5, s[12:15], s40 offen lds
    s_add_u32 m0, s7, 118784
    s_add_u32 s40, s41, 198656
    buffer_load_dwordx4 v5, s[12:15], s40 offen lds
    s_add_u32 m0, s7, 122880
    s_add_u32 s40, s41, 4096
    buffer_load_dwordx4 v5, s[12:15], s40 offen lds
    s_add_u32 m0, s7, 126976
    s_add_u32 s40, s41, 200704
    buffer_load_dwordx4 v5, s[12:15], s40 offen lds
    s_waitcnt vmcnt(10)
    s_barrier
    s_add_u32 s41, s74, 9
    s_and_b32 s41, s41, 15
    s_lshl_b32 s42, s41, 7
    s_mul_i32 s41, s41, 393216
    s_add_u32 m0, s7, 8192
    s_add_u32 s40, s42, 0
    buffer_load_dwordx4 v4, s[8:11], s40 offen lds
    s_add_u32 m0, s7, 12288
    s_add_u32 s40, s42, 65536
    buffer_load_dwordx4 v4, s[8:11], s40 offen lds
    s_add_u32 m0, s7, 16384
    s_add_u32 s40, s42, 131072
    buffer_load_dwordx4 v4, s[8:11], s40 offen lds
    s_add_u32 m0, s7, 20480
    s_add_u32 s40, s42, 196608
    buffer_load_dwordx4 v4, s[8:11], s40 offen lds
    s_add_u32 m0, s7, 24576
    s_add_u32 s40, s41, 0
    buffer_load_dwordx4 v5, s[12:15], s40 offen lds
    s_add_u32 m0, s7, 28672
    s_add_u32 s40, s41, 196608
    buffer_load_dwordx4 v5, s[12:15], s40 offen lds
    s_add_u32 m0, s7, 32768
    s_add_u32 s40, s41, 2048
    buffer_load_dwordx4 v5, s[12:15], s40 offen lds
    s_add_u32 m0, s7, 36864
    s_add_u32 s40, s41, 198656
    buffer_load_dwordx4 v5, s[12:15], s40 offen lds
    s_add_u32 m0, s7, 40960
    s_add_u32 s40, s41, 4096
    buffer_load_dwordx4 v5, s[12:15], s40 offen lds
    s_add_u32 m0, s7, 45056
    s_add_u32 s40, s41, 200704
    buffer_load_dwordx4 v5, s[12:15], s40 offen lds
    s_cmp_lg_u32 s6, 0
    s_cbranch_scc1 H_nk
    v_mov_b32 v3, 4224
    ds_read_b128 v[72:75], v3
    ds_read_b128 v[24:27], v3 offset:16
    s_mov_b32 s65, 0
H_nspin:
    v_readfirstlane_b32 s71, v78
    s_cmp_eq_u32 s71, 0
    s_cbranch_scc1 H_nre
H_nok:
    s_lshl_b32 s64, s2, 3
    s_add_u32 s64, s64, 6717440
    v_mov_b32 v3, s64
    s_waitcnt lgkmcnt(0)
    v_max3_u32 v72, v72, v73, v74
    v_max3_u32 v24, v24, v25, v26
    v_max3_u32 v72, v72, v75, v27
    v_max_u32 v72, v72, v24
    v_xor_b32 v73, s71, v72
    s_mov_b64 exec, 1
    buffer_store_dwordx2 v[72:73], v3, s[16:19], 0 offen sc0 sc1
    s_mov_b64 exec, -1
H_nk:
    s_mov_b32 exec_lo, 0x3fff3fff
    s_mov_b32 exec_hi, 0x3fff3fff
    s_mov_b32 s64, 14336
    buffer_load_dwordx4 v[136:139], v11, s[36:39], s64 offen nt
    s_mov_b32 s64, 21504
    buffer_load_dwordx4 v[108:111], v11, s[32:35], s64 offen nt
    s_mov_b32 s64, 21504
    buffer_load_dwordx4 v[140:143], v11, s[36:39], s64 offen nt
    s_mov_b32 s64, 28672
    buffer_load_dwordx4 v[112:115], v11, s[32:35], s64 offen nt
    s_mov_b32 s64, 28672
    buffer_load_dwordx4 v[144:147], v11, s[36:39], s64 offen nt
    s_mov_b64 exec, -1
    s_waitcnt vmcnt(15)
    s_barrier
    s_add_u32 s41, s74, 10
    s_and_b32 s41, s41, 15
    s_lshl_b32 s42, s41, 7
    s_mul_i32 s41, s41, 393216
    s_add_u32 m0, s7, 49152
    s_add_u32 s40, s42, 0
    buffer_load_dwordx4 v4, s[8:11], s40 offen lds
    s_add_u32 m0, s7, 53248
    s_add_u32 s40, s42, 65536
    buffer_load_dwordx4 v4, s[8:11], s40 offen lds
    s_add_u32 m0, s7, 57344
    s_add_u32 s40, s42, 131072
    buffer_load_dwordx4 v4, s[8:11], s40 offen lds
    s_add_u32 m0, s7, 61440
    s_add_u32 s40, s42, 196608
    buffer_load_dwordx4 v4, s[8:11], s40 offen lds
    s_add_u32 m0, s7, 65536
    s_add_u32 s40, s41, 0
    buffer_load_dwordx4 v5, s[12:15], s40 offen lds
    s_add_u32 m0, s7, 69632
    s_add_u32 s40, s41, 196608
    buffer_load_dwordx4 v5, s[12:15], s40 offen lds
    s_add_u32 m0, s7, 73728
    s_add_u32 s40, s41, 2048
    buffer_load_dwordx4 v5, s[12:15], s40 offen lds
    s_add_u32 m0, s7, 77824
    s_add_u32 s40, s41, 198656
    buffer_load_dwordx4 v5, s[12:15], s40 offen lds
    s_add_u32 m0, s7, 81920
    s_add_u32 s40, s41, 4096
    buffer_load_dwordx4 v5, s[12:15], s40 offen lds
    s_add_u32 m0, s7, 86016
    s_add_u32 s40, s41, 200704
    buffer_load_dwordx4 v5, s[12:15], s40 offen lds
    s_waitcnt vmcnt(15)
    s_barrier
    s_add_u32 s41, s74, 11
    s_and_b32 s41, s41, 15
    s_lshl_b32 s42, s41, 7
    s_mul_i32 s41, s41, 393216
    s_add_u32 m0, s7, 90112
    s_add_u32 s40, s42, 0
    buffer_load_dwordx4 v4, s[8:11], s40 offen lds
    s_add_u32 m0, s7, 94208
    s_add_u32 s40, s42, 65536
    buffer_load_dwordx4 v4, s[8:11], s40 offen lds
    s_add_u32 m0, s7, 98304
    s_add_u32 s40, s42, 131072
    buffer_load_dwordx4 v4, s[8:11], s40 offen lds
    s_add_u32 m0, s7, 102400
    s_add_u32 s40, s42, 196608
    buffer_load_dwordx4 v4, s[8:11], s40 offen lds
    s_add_u32 m0, s7, 106496
    s_add_u32 s40, s41, 0
    buffer_load_dwordx4 v5, s[12:15], s40 offen lds
    s_add_u32 m0, s7, 110592
    s_add_u32 s40, s41, 196608
    buffer_load_dwordx4 v5, s[12:15], s40 offen lds
    s_add_u32 m0, s7, 114688
    s_add_u32 s40, s41, 2048
    buffer_load_dwordx4 v5, s[12:15], s40 offen lds
    s_add_u32 m0, s7, 118784
    s_add_u32 s40, s41, 198656
    buffer_load_dwordx4 v5, s[12:15], s40 offen lds
    s_add_u32 m0, s7, 122880
    s_add_u32 s40, s41, 4096
    buffer_load_dwordx4 v5, s[12:15], s40 offen lds
    s_add_u32 m0, s7, 126976
    s_add_u32 s40, s41, 200704
    buffer_load_dwordx4 v5, s[12:15], s40 offen lds
    s_waitcnt vmcnt(10)
    s_barrier
    s_add_u32 s41, s74, 12
    s_and_b32 s41, s41, 15
    s_lshl_b32 s42, s41, 7
    s_mul_i32 s41, s41, 393216
    s_add_u32 m0, s7, 8192
    s_add_u32 s40, s42, 0
    buffer_load_dwordx4 v4, s[8:11], s40 offen lds
    s_add_u32 m0, s7, 12288
    s_add_u32 s40, s42, 65536
    buffer_load_dwordx4 v4, s[8:11], s40 offen lds
    s_add_u32 m0, s7, 16384
    s_add_u32 s40, s42, 131072
    buffer_load_dwordx4 v4, s[8:11], s40 offen lds
    s_add_u32 m0, s7, 20480
    s_add_u32 s40, s42, 196608
    buffer_load_dwordx4 v4, s[8:11], s40 offen lds
    s_add_u32 m0, s7, 24576
    s_add_u32 s40, s41, 0
    buffer_load_dwordx4 v5, s[12:15], s40 offen lds
    s_add_u32 m0, s7, 28672
    s_add_u32 s40, s41, 196608
    buffer_load_dwordx4 v5, s[12:15], s40 offen lds
    s_add_u32 m0, s7, 32768
    s_add_u32 s40, s41, 2048
    buffer_load_dwordx4 v5, s[12:15], s40 offen lds
    s_add_u32 m0, s7, 36864
    s_add_u32 s40, s41, 198656
    buffer_load_dwordx4 v5, s[12:15], s40 offen lds
    s_add_u32 m0, s7, 40960
    s_add_u32 s40, s41, 4096
    buffer_load_dwordx4 v5, s[12:15], s40 offen lds
    s_add_u32 m0, s7, 45056
    s_add_u32 s40, s41, 200704
    buffer_load_dwordx4 v5, s[12:15], s40 offen lds
    s_mov_b32 exec_lo, 0x3fff3fff
    s_mov_b32 exec_hi, 0x3fff3fff
    s_mov_b32 s64, 35840
    buffer_load_dwordx4 v[116:119], v11, s[32:35], s64 offen nt
    s_mov_b32 s64, 35840
    buffer_load_dwordx4 v[148:151], v11, s[36:39], s64 offen nt
    s_mov_b32 s64, 43008
    buffer_load_dwordx4 v[120:123], v11, s[32:35], s64 offen nt
    s_mov_b32 s64, 43008
    buffer_load_dwordx4 v[152:155], v11, s[36:39], s64 offen nt
    s_mov_b32 s64, 50176
    buffer_load_dwordx4 v[124:127], v11, s[32:35], s64 offen nt
    s_mov_b32 s64, 50176
    buffer_load_dwordx4 v[156:159], v11, s[36:39], s64 offen nt
    s_mov_b64 exec, -1
    s_waitcnt vmcnt(16)
    s_barrier
    s_cmp_lg_u32 s6, 0
    s_cbranch_scc1 H_np
    s_mov_b32 s64, 6717440
    buffer_load_dwordx4 v[24:27], v6, s[16:19], s64 offen offset:0 sc1
    buffer_load_dwordx4 v[28:31], v6, s[16:19], s64 offen offset:1024 sc1
H_np:
    s_add_u32 s41, s74, 13
    s_and_b32 s41, s41, 15
    s_lshl_b32 s42, s41, 7
    s_mul_i32 s41, s41, 393216
    s_add_u32 m0, s7, 49152
    s_add_u32 s40, s42, 0
    buffer_load_dwordx4 v4, s[8:11], s40 offen lds
    s_add_u32 m0, s7, 53248
    s_add_u32 s40, s42, 65536
    buffer_load_dwordx4 v4, s[8:11], s40 offen lds
    s_add_u32 m0, s7, 57344
    s_add_u32 s40, s42, 131072
    buffer_load_dwordx4 v4, s[8:11], s40 offen lds
    s_add_u32 m0, s7, 61440
    s_add_u32 s40, s42, 196608
    buffer_load_dwordx4 v4, s[8:11], s40 offen lds
    s_add_u32 m0, s7, 65536
    s_add_u32 s40, s41, 0
    buffer_load_dwordx4 v5, s[12:15], s40 offen lds
    s_add_u32 m0, s7, 69632
    s_add_u32 s40, s41, 196608
    buffer_load_dwordx4 v5, s[12:15], s40 offen lds
    s_add_u32 m0, s7, 73728
    s_add_u32 s40, s41, 2048
    buffer_load_dwordx4 v5, s[12:15], s40 offen lds
    s_add_u32 m0, s7, 77824
    s_add_u32 s40, s41, 198656
    buffer_load_dwordx4 v5, s[12:15], s40 offen lds
    s_add_u32 m0, s7, 81920
    s_add_u32 s40, s41, 4096
    buffer_load_dwordx4 v5, s[12:15], s40 offen lds
    s_add_u32 m0, s7, 86016
    s_add_u32 s40, s41, 200704
    buffer_load_dwordx4 v5, s[12:15], s40 offen lds
    s_waitcnt vmcnt(16)
    s_barrier
    s_cmp_lg_u32 s6, 0
    s_cbranch_scc1 H_nq
    s_waitcnt vmcnt(10)
    s_mov_b32 s65, 0
H_spin:
    v_xor_b32 v25, v24, v25
    v_xor_b32 v27, v26, v27
    v_xor_b32 v29, v28, v29
    v_xor_b32 v31, v30, v31
    v_xor_b32 v3, s71, v25
    v_xor_b32 v7, s71, v27
    v_xor_b32 v25, s71, v29
    v_xor_b32 v27, s71, v31
    v_or3_b32 v3, v3, v7, v25
    v_or_b32 v3, v3, v27
    v_cmp_ne_u32 vcc, 0, v3
    s_cbranch_vccnz H_retry
H_nq:
    s_add_u32 s41, s74, 14
    s_and_b32 s41, s41, 15
    s_lshl_b32 s42, s41, 7
    s_mul_i32 s41, s41, 393216
    s_add_u32 m0, s7, 90112
    s_add_u32 s40, s42, 0
    buffer_load_dwordx4 v4, s[8:11], s40 offen lds
    v_max_u32 v3, v24, v26
    v_max3_u32 v3, v3, v28, v30
    s_nop 1
    v_max_u32_dpp v3, v3, v3 quad_perm:[1,0,3,2] row_mask:0xf bank_mask:0xf
    s_add_u32 m0, s7, 94208
    s_add_u32 s40, s42, 65536
    buffer_load_dwordx4 v4, s[8:11], s40 offen lds
    s_nop 1
    v_max_u32_dpp v3, v3, v3 quad_perm:[2,3,0,1] row_mask:0xf bank_mask:0xf
    s_nop 1
    v_max_u32_dpp v3, v3, v3 row_half_mirror row_mask:0xf bank_mask:0xf
    s_add_u32 m0, s7, 98304
    s_add_u32 s40, s42, 131072
    buffer_load_dwordx4 v4, s[8:11], s40 offen lds
    s_nop 1
    v_max_u32_dpp v3, v3, v3 row_mirror row_mask:0xf bank_mask:0xf
    s_nop 1
    v_mov_b32 v7, v3
    s_add_u32 m0, s7, 102400
    s_add_u32 s40, s42, 196608
    buffer_load_dwordx4 v4, s[8:11], s40 offen lds
    s_nop 1
    v_permlane16_swap_b32 v3, v7
    v_max_u32 v3, v3, v7
    v_mov_b32 v7, v3
    s_add_u32 m0, s7, 106496
    s_add_u32 s40, s41, 0
    buffer_load_dwordx4 v5, s[12:15], s40 offen lds
    s_nop 1
    v_permlane32_swap_b32 v3, v7
    v_max_u32 v3, v3, v7
    v_mov_b32 v7, 4256
    s_add_u32 m0, s7, 110592
    s_add_u32 s40, s41, 196608
    buffer_load_dwordx4 v5, s[12:15], s40 offen lds
    s_add_u32 m0, s7, 114688
    s_add_u32 s40, s41, 2048
    buffer_load_dwordx4 v5, s[12:15], s40 offen lds
    s_add_u32 m0, s7, 118784
    s_add_u32 s40, s41, 198656
    buffer_load_dwordx4 v5, s[12:15], s40 offen lds
    s_add_u32 m0, s7, 122880
    s_add_u32 s40, s41, 4096
    buffer_load_dwordx4 v5, s[12:15], s40 offen lds
    s_add_u32 m0, s7, 126976
    s_add_u32 s40, s41, 200704
    buffer_load_dwordx4 v5, s[12:15], s40 offen lds
    s_cmp_lg_u32 s6, 0
    s_cbranch_scc1 H_nw
    ds_write_b32 v7, v3
H_nw:
    s_waitcnt vmcnt(10)
    s_waitcnt lgkmcnt(0)
    s_barrier
    v_mov_b32 v7, 4256
    ds_read_b32 v3, v7
    s_lshl_b32 s65, s69, 6
    v_lshl_add_u32 v7, v8, 4, s65
    s_waitcnt lgkmcnt(0)
    v_readfirstlane_b32 s75, v3
    s_nop 3
    s_and_b32 s64, s75, 0x7ff
    s_sub_u32 s64, 2047, s64
    s_lshl_b32 s64, s64, 11
    buffer_load_dwordx4 v[88:91], v7, s[8:11], s64 offen
    s_add_u32 s41, s74, 15
    s_and_b32 s41, s41, 15
    s_lshl_b32 s42, s41, 7
    s_mul_i32 s41, s41, 393216
    s_add_u32 m0, s7, 8192
    s_add_u32 s40, s42, 0
    buffer_load_dwordx4 v4, s[8:11], s40 offen lds
    s_add_u32 m0, s7, 12288
    s_add_u32 s40, s42, 65536
    buffer_load_dwordx4 v4, s[8:11], s40 offen lds
    s_add_u32 m0, s7, 16384
    s_add_u32 s40, s42, 131072
    buffer_load_dwordx4 v4, s[8:11], s40 offen lds
    s_add_u32 m0, s7, 20480
    s_add_u32 s40, s42, 196608
    buffer_load_dwordx4 v4, s[8:11], s40 offen lds
    s_add_u32 m0, s7, 24576
    s_add_u32 s40, s41, 0
    buffer_load_dwordx4 v5, s[12:15], s40 offen lds
    s_add_u32 m0, s7, 28672
    s_add_u32 s40, s41, 196608
    buffer_load_dwordx4 v5, s[12:15], s40 offen lds
    s_add_u32 m0, s7, 32768
    s_add_u32 s40, s41, 2048
    buffer_load_dwordx4 v5, s[12:15], s40 offen lds
    s_add_u32 m0, s7, 36864
    s_add_u32 s40, s41, 198656
    buffer_load_dwordx4 v5, s[12:15], s40 offen lds
    s_add_u32 m0, s7, 40960
    s_add_u32 s40, s41, 4096
    buffer_load_dwordx4 v5, s[12:15], s40 offen lds
    s_add_u32 m0, s7, 45056
    s_add_u32 s40, s41, 200704
    buffer_load_dwordx4 v5, s[12:15], s40 offen lds
    s_mov_b32 s24, s54
    s_mov_b32 s25, s55
    s_mov_b32 s26, 0x700000
    s_mov_b32 s27, 0x00020000
    s_lshr_b32 s64, s2, 2
    s_mul_i32 s64, s64, 114688
    s_and_b32 s65, s2, 3
    s_lshl_b32 s65, s65, 9
    s_add_u32 s64, s64, s65
    s_lshl_b32 s65, s6, 7
    s_add_u32 s64, s64, s65
    v_lshrrev_b32 v7, 3, v2
    v_lshlrev_b32 v7, 11, v7
    v_and_b32 v9, 7, v2
    v_lshl_add_u32 v7, v9, 4, v7
    v_add_u32 v21, s64, v7
    s_mov_b32 s64, 0
    buffer_load_dwordx4 v[192:195], v21, s[24:27], s64 offen nt
    s_mov_b32 s64, 16384
    buffer_load_dwordx4 v[196:199], v21, s[24:27], s64 offen nt
    s_mov_b32 s64, 32768
    buffer_load_dwordx4 v[200:203], v21, s[24:27], s64 offen nt
    s_mov_b32 s64, 49152
    buffer_load_dwordx4 v[204:207], v21, s[24:27], s64 offen nt
    s_mov_b32 s64, 65536
    buffer_load_dwordx4 v[208:211], v21, s[24:27], s64 offen nt
    s_mov_b32 s64, 81920
    buffer_load_dwordx4 v[212:215], v21, s[24:27], s64 offen nt
    s_mov_b32 s64, 98304
    buffer_load_dwordx4 v[216:219], v21, s[24:27], s64 offen nt
    s_waitcnt vmcnt(18)
    s_barrier
    s_waitcnt vmcnt(17)
    s_and_b32 s64, s2, 7
    s_lshr_b32 s65, s2, 3
    s_and_b32 s4, s64, 3
    s_lshl_b32 s4, s4, 2
    s_and_b32 s66, s65, 3
    s_add_u32 s4, s4, s66
    s_lshr_b32 s5, s64, 2
    s_lshl_b32 s5, s5, 3
    s_lshr_b32 s74, s65, 2
    s_add_u32 s5, s5, s74
    s_mov_b32 s12, s44
    s_mov_b32 s13, s45
    s_mov_b32 s14, 0x200000
    s_mov_b32 s15, 0x00020000
    v_lshrrev_b32 v7, 3, v2
    s_lshl_b32 s64, s6, 3
    v_add_u32 v7, s64, v7
    v_lshlrev_b32 v7, 11, v7
    v_lshrrev_b32 v9, 4, v2
    v_lshlrev_b32 v9, 1, v9
    v_and_b32 v10, 7, v2
    v_xor_b32 v9, v9, v10
    v_lshl_add_u32 v7, v9, 4, v7
    s_lshl_b32 s64, s5, 7
    v_add_u32 v10, s64, v7
    s_add_u32 m0, s7, 131072
    s_mov_b32 s40, 0
    buffer_load_dwordx4 v10, s[12:15], s40 offen lds
    v_and_b32 v48, 15, v2
    v_and_b32 v49, 1, v2
    v_lshlrev_b32 v49, 4, v49
    v_mov_b32 v50, 0xffff
    v_lshlrev_b32 v49, v49, v50
    v_lshrrev_b32 v48, 1, v48
    v_cmp_eq_u32 vcc, 0, v48
    s_nop 1
    v_cndmask_b32 v40, 0, v49, vcc
    v_cmp_eq_u32 vcc, 1, v48
    s_nop 1
    v_cndmask_b32 v41, 0, v49, vcc
    v_cmp_eq_u32 vcc, 2, v48
    s_nop 1
    v_cndmask_b32 v42, 0, v49, vcc
    v_cmp_eq_u32 vcc, 3, v48
    s_nop 1
    v_cndmask_b32 v43, 0, v49, vcc
    s_mov_b32 s64, 0x01000100
    s_mov_b32 s65, 0x03020302
    v_perm_b32 v48, v88, v88, s64
    v_and_b32 v44, v48, v40
    v_and_b32 v45, v48, v41
    v_and_b32 v46, v48, v42
    s_add_u32 m0, s7, 135168
    s_mov_b32 s40, 65536
    buffer_load_dwordx4 v10, s[12:15], s40 offen lds
    v_and_b32 v47, v48, v43
    s_nop 1
    v_mfma_f32_16x16x32_bf16 v[32:35], v[44:47], v[96:99], 0
    v_mfma_f32_16x16x32_bf16 v[36:39], v[44:47], v[128:131], 0
    v_perm_b32 v48, v88, v88, s65
    v_and_b32 v52, v48, v40
    v_and_b32 v53, v48, v41
    v_and_b32 v54, v48, v42
    v_and_b32 v55, v48, v43
    s_nop 1
    v_mfma_f32_16x16x32_bf16 v[32:35], v[52:55], v[100:103], v[32:35]
    v_mfma_f32_16x16x32_bf16 v[36:39], v[52:55], v[132:135], v[36:39]
    v_perm_b32 v48, v89, v89, s64
    v_and_b32 v44, v48, v40
    v_and_b32 v45, v48, v41
    v_and_b32 v46, v48, v42
    v_and_b32 v47, v48, v43
    s_nop 1
    v_mfma_f32_16x16x32_bf16 v[32:35], v[44:47], v[104:107], v[32:35]
    v_mfma_f32_16x16x32_bf16 v[36:39], v[44:47], v[136:139], v[36:39]
    v_perm_b32 v48, v89, v89, s65
    v_and_b32 v52, v48, v40
    v_and_b32 v53, v48, v41
    v_and_b32 v54, v48, v42
    s_add_u32 m0, s7, 147456
    s_mov_b32 s40, 1048576
    buffer_load_dwordx4 v10, s[12:15], s40 offen lds
    v_and_b32 v55, v48, v43
    s_nop 1
    v_mfma_f32_16x16x32_bf16 v[32:35], v[52:55], v[108:111], v[32:35]
    v_mfma_f32_16x16x32_bf16 v[36:39], v[52:55], v[140:143], v[36:39]
    v_perm_b32 v48, v90, v90, s64
    v_and_b32 v44, v48, v40
    v_and_b32 v45, v48, v41
    v_and_b32 v46, v48, v42
    v_and_b32 v47, v48, v43
    s_nop 1
    v_mfma_f32_16x16x32_bf16 v[32:35], v[44:47], v[112:115], v[32:35]
    v_mfma_f32_16x16x32_bf16 v[36:39], v[44:47], v[144:147], v[36:39]
    v_perm_b32 v48, v90, v90, s65
    v_and_b32 v52, v48, v40
    v_and_b32 v53, v48, v41
    v_and_b32 v54, v48, v42
    v_and_b32 v55, v48, v43
    s_nop 1
    v_mfma_f32_16x16x32_bf16 v[32:35], v[52:55], v[116:119], v[32:35]
    v_mfma_f32_16x16x32_bf16 v[36:39], v[52:55], v[148:151], v[36:39]
    v_perm_b32 v48, v91, v91, s64
    v_and_b32 v44, v48, v40
    v_and_b32 v45, v48, v41
    v_and_b32 v46, v48, v42
    s_add_u32 m0, s7, 151552
    s_mov_b32 s40, 1114112
    buffer_load_dwordx4 v10, s[12:15], s40 offen lds
    v_and_b32 v47, v48, v43
    s_nop 1
    v_mfma_f32_16x16x32_bf16 v[32:35], v[44:47], v[120:123], v[32:35]
    v_mfma_f32_16x16x32_bf16 v[36:39], v[44:47], v[152:155], v[36:39]
    v_perm_b32 v48, v91, v91, s65
    v_and_b32 v52, v48, v40
    v_and_b32 v53, v48, v41
    v_and_b32 v54, v48, v42
    v_and_b32 v55, v48, v43
    s_nop 1
    v_mfma_f32_16x16x32_bf16 v[32:35], v[52:55], v[124:127], v[32:35]
    v_mfma_f32_16x16x32_bf16 v[36:39], v[52:55], v[156:159], v[36:39]
    s_nop 7
    v_permlane32_swap_b32 v32, v36
    v_permlane32_swap_b32 v33, v37
    v_permlane32_swap_b32 v34, v38
    v_permlane32_swap_b32 v35, v39
    s_mov_b32 exec_lo, 0x3fff3fff
    s_mov_b32 exec_hi, 0x3fff3fff
    buffer_store_dwordx4 v[32:35], v12, s[16:19], 0 offen sc0 sc1
    s_mov_b64 exec, -1
    s_waitcnt vmcnt(12)
    s_barrier
    s_add_u32 m0, s7, 139264
    s_mov_b32 s40, 131072
    buffer_load_dwordx4 v10, s[12:15], s40 offen lds
    s_add_u32 m0, s7, 143360
    s_mov_b32 s40, 196608
    buffer_load_dwordx4 v10, s[12:15], s40 offen lds
    s_add_u32 m0, s7, 155648
    s_mov_b32 s40, 1179648
    buffer_load_dwordx4 v10, s[12:15], s40 offen lds
    s_add_u32 m0, s7, 159744
    s_mov_b32 s40, 1245184
    buffer_load_dwordx4 v10, s[12:15], s40 offen lds
    s_add_u32 m0, s7, 73728
    s_mov_b32 s40, 262144
    buffer_load_dwordx4 v10, s[12:15], s40 offen lds
    s_add_u32 m0, s7, 77824
    s_mov_b32 s40, 327680
    buffer_load_dwordx4 v10, s[12:15], s40 offen lds
    s_add_u32 m0, s7, 81920
    s_mov_b32 s40, 1310720
    buffer_load_dwordx4 v10, s[12:15], s40 offen lds
    s_add_u32 m0, s7, 86016
    s_mov_b32 s40, 1376256
    buffer_load_dwordx4 v10, s[12:15], s40 offen lds
    s_barrier
    s_and_b32 s64, s3, 3
    s_lshl_b32 s64, s64, 1
    s_lshr_b32 s65, s3, 2
    s_add_u32 s64, s64, s65
    s_lshl_b32 s64, s64, 4
    s_lshl_b32 s65, s4, 7
    s_add_u32 s64, s64, s65
    v_and_b32 v230, 15, v2
    v_add_u32 v230, s64, v230
    v_bfe_u32 v3, v2, 4, 1
    v_lshlrev_b32 v229, 5, v3
    v_lshrrev_b32 v3, 5, v2
    v_lshl_add_u32 v229, v3, 4, v229
    v_lshl_add_u32 v231, v230, 11, v229
    s_lshl_b32 s64, s5, 7
    v_add_u32 v231, s64, v231
    v_lshlrev_b32 v3, 2, v230
    v_add_u32 v3, 6709248, v3
    buffer_load_dwordx4 v[220:223], v231, s[8:11], 0 offen
    buffer_load_dwordx4 v[224:227], v231, s[8:11], 0 offen offset:64
    buffer_load_dword v228, v3, s[16:19], 0 offen sc1
    s_add_u32 m0, s7, 114688
    s_mov_b32 s40, 393216
    buffer_load_dwordx4 v10, s[12:15], s40 offen lds
    s_add_u32 m0, s7, 118784
    s_mov_b32 s40, 458752
    buffer_load_dwordx4 v10, s[12:15], s40 offen lds
    s_add_u32 m0, s7, 122880
    s_mov_b32 s40, 1441792
    buffer_load_dwordx4 v10, s[12:15], s40 offen lds
    s_add_u32 m0, s7, 126976
    s_mov_b32 s40, 1507328
    buffer_load_dwordx4 v10, s[12:15], s40 offen lds
    s_add_u32 m0, s7, 40960
    s_mov_b32 s40, 524288
    buffer_load_dwordx4 v10, s[12:15], s40 offen lds
    s_add_u32 m0, s7, 45056
    s_mov_b32 s40, 589824
    buffer_load_dwordx4 v10, s[12:15], s40 offen lds
    s_add_u32 m0, s7, 49152
    s_mov_b32 s40, 1572864
    buffer_load_dwordx4 v10, s[12:15], s40 offen lds
    s_add_u32 m0, s7, 53248
    s_mov_b32 s40, 1638400
    buffer_load_dwordx4 v10, s[12:15], s40 offen lds
    s_add_u32 m0, s7, 8192
    s_mov_b32 s40, 655360
    buffer_load_dwordx4 v10, s[12:15], s40 offen lds
    s_add_u32 m0, s7, 12288
    s_mov_b32 s40, 720896
    buffer_load_dwordx4 v10, s[12:15], s40 offen lds
    s_add_u32 m0, s7, 57344
    s_mov_b32 s40, 1703936
    buffer_load_dwordx4 v10, s[12:15], s40 offen lds
    s_add_u32 m0, s7, 61440
    s_mov_b32 s40, 1769472
    buffer_load_dwordx4 v10, s[12:15], s40 offen lds
    s_add_u32 m0, s7, 16384
    s_mov_b32 s40, 786432
    buffer_load_dwordx4 v10, s[12:15], s40 offen lds
    s_add_u32 m0, s7, 20480
    s_mov_b32 s40, 851968
    buffer_load_dwordx4 v10, s[12:15], s40 offen lds
    s_add_u32 m0, s7, 65536
    s_mov_b32 s40, 1835008
    buffer_load_dwordx4 v10, s[12:15], s40 offen lds
    s_add_u32 m0, s7, 69632
    s_mov_b32 s40, 1900544
    buffer_load_dwordx4 v10, s[12:15], s40 offen lds
    s_add_u32 m0, s7, 98304
    s_mov_b32 s40, 917504
    buffer_load_dwordx4 v10, s[12:15], s40 offen lds
    s_add_u32 m0, s7, 102400
    s_mov_b32 s40, 983040
    buffer_load_dwordx4 v10, s[12:15], s40 offen lds
    s_add_u32 m0, s7, 90112
    s_mov_b32 s40, 1966080
    buffer_load_dwordx4 v10, s[12:15], s40 offen lds
    s_add_u32 m0, s7, 94208
    s_mov_b32 s40, 2031616
    buffer_load_dwordx4 v10, s[12:15], s40 offen lds
    s_mov_b64 exec, 1
    v_mov_b32 v20, 0
    buffer_atomic_or v20, v23, s[16:19], 0 offen sc0
    s_mov_b64 exec, -1
    v_add_u32 v17, s70, v6
    v_lshrrev_b32 v18, 2, v2
    v_mul_u32_u24 v18, 1152, v18
    v_and_b32 v19, 3, v2
    v_lshl_add_u32 v18, v19, 4, v18
    s_add_u32 s64, s70, 1024
    v_add_u32 v18, s64, v18
    v_bfe_u32 v26, v2, 3, 1
    v_lshl_add_u32 v26, v26, 2, v19
    v_bfe_u32 v27, v2, 2, 1
    v_lshrrev_b32 v28, 5, v2
    v_cmp_eq_u32 vcc, v27, v28
    v_and_b32 v27, 16, v2
    v_cmp_eq_u32 s[64:65], 0, v27
    s_and_b64 vcc, vcc, s[64:65]
    v_and_b32 v27, 1, v26
    v_lshlrev_b32 v27, 4, v27
    v_mov_b32 v28, 0x3f80
    v_lshlrev_b32 v27, v27, v28
    v_cndmask_b32 v27, 0, v27, vcc
    v_lshrrev_b32 v26, 1, v26
    v_cmp_eq_u32 vcc, 0, v26
    s_nop 1
    v_cndmask_b32 v48, 0, v27, vcc
    v_cmp_eq_u32 vcc, 1, v26
    s_nop 1
    v_cndmask_b32 v49, 0, v27, vcc
    v_cmp_eq_u32 vcc, 2, v26
    s_nop 1
    v_cndmask_b32 v50, 0, v27, vcc
    v_cmp_eq_u32 vcc, 3, v26
    s_nop 1
    v_cndmask_b32 v51, 0, v27, vcc
    v_mov_b32 v128, 0
    v_mov_b32 v129, 0
    v_mov_b32 v130, 0
    v_mov_b32 v131, 0
    v_mov_b32 v132, 0
    v_mov_b32 v133, 0
    v_mov_b32 v134, 0
    v_mov_b32 v135, 0
    v_mov_b32 v136, 0
    v_mov_b32 v137, 0
    v_mov_b32 v138, 0
    v_mov_b32 v139, 0
    v_mov_b32 v140, 0
    v_mov_b32 v141, 0
    v_mov_b32 v142, 0
    v_mov_b32 v143, 0
    s_mov_b32 s66, 0xffff
    s_mov_b32 s65, 0
    s_waitcnt vmcnt(0)
G_loop:
    v_readfirstlane_b32 s68, v20
    s_and_b32 s68, s68, s66
    s_andn2_b32 s66, s66, s68
    s_bcnt1_i32_b32 s67, s68
    s_cmp_eq_u32 s67, 0
    s_cbranch_scc1 G_l0
    s_cmp_gt_u32 s67, 8
    s_cbranch_scc1 G_lt_1
    s_cmp_gt_u32 s67, 4
    s_cbranch_scc1 G_lt_2
    s_cmp_gt_u32 s67, 2
    s_cbranch_scc1 G_lt_3
    s_cmp_eq_u32 s67, 1
    s_cbranch_scc1 G_l1
    s_branch G_l2
G_lt_3:
    s_cmp_eq_u32 s67, 3
    s_cbranch_scc1 G_l3
    s_branch G_l4
G_lt_2:
    s_cmp_gt_u32 s67, 6
    s_cbranch_scc1 G_lt_4
    s_cmp_eq_u32 s67, 5
    s_cbranch_scc1 G_l5
    s_branch G_l6
G_lt_4:
    s_cmp_eq_u32 s67, 7
    s_cbranch_scc1 G_l7
    s_branch G_l8
G_lt_1:
    s_cmp_gt_u32 s67, 12
    s_cbranch_scc1 G_lt_5
    s_cmp_gt_u32 s67, 10
    s_cbranch_scc1 G_lt_6
    s_cmp_eq_u32 s67, 9
    s_cbranch_scc1 G_l9
    s_branch G_l10
G_lt_6:
    s_cmp_eq_u32 s67, 11
    s_cbranch_scc1 G_l11
    s_branch G_l12
G_lt_5:
    s_cmp_gt_u32 s67, 14
    s_cbranch_scc1 G_lt_7
    s_cmp_eq_u32 s67, 13
    s_cbranch_scc1 G_l13
    s_branch G_l14
G_lt_7:
    s_cmp_eq_u32 s67, 15
    s_cbranch_scc1 G_l15
G_l16:
    s_ff1_i32_b32 s55, s68
    s_bitset0_b32 s68, s55
    s_mul_i32 s64, s55, 1152
    buffer_load_dwordx4 v[124:127], v17, s[16:19], s64 offen sc1
G_l15:
    s_ff1_i32_b32 s54, s68
    s_bitset0_b32 s68, s54
    s_mul_i32 s64, s54, 1152
    buffer_load_dwordx4 v[120:123], v17, s[16:19], s64 offen sc1
G_l14:
    s_ff1_i32_b32 s53, s68
    s_bitset0_b32 s68, s53
    s_mul_i32 s64, s53, 1152
    buffer_load_dwordx4 v[116:119], v17, s[16:19], s64 offen sc1
G_l13:
    s_ff1_i32_b32 s52, s68
    s_bitset0_b32 s68, s52
    s_mul_i32 s64, s52, 1152
    buffer_load_dwordx4 v[112:115], v17, s[16:19], s64 offen sc1
G_l12:
    s_ff1_i32_b32 s51, s68
    s_bitset0_b32 s68, s51
    s_mul_i32 s64, s51, 1152
    buffer_load_dwordx4 v[108:111], v17, s[16:19], s64 offen sc1
G_l11:
    s_ff1_i32_b32 s50, s68
    s_bitset0_b32 s68, s50
    s_mul_i32 s64, s50, 1152
    buffer_load_dwordx4 v[104:107], v17, s[16:19], s64 offen sc1
G_l10:
    s_ff1_i32_b32 s49, s68
    s_bitset0_b32 s68, s49
    s_mul_i32 s64, s49, 1152
    buffer_load_dwordx4 v[100:103], v17, s[16:19], s64 offen sc1
G_l9:
    s_ff1_i32_b32 s48, s68
    s_bitset0_b32 s68, s48
    s_mul_i32 s64, s48, 1152
    buffer_load_dwordx4 v[96:99], v17, s[16:19], s64 offen sc1
G_l8:
    s_ff1_i32_b32 s47, s68
    s_bitset0_b32 s68, s47
    s_mul_i32 s64, s47, 1152
    buffer_load_dwordx4 v[92:95], v17, s[16:19], s64 offen sc1
G_l7:
    s_ff1_i32_b32 s46, s68
    s_bitset0_b32 s68, s46
    s_mul_i32 s64, s46, 1152
    buffer_load_dwordx4 v[88:91], v17, s[16:19], s64 offen sc1
G_l6:
    s_ff1_i32_b32 s45, s68
    s_bitset0_b32 s68, s45
    s_mul_i32 s64, s45, 1152
    buffer_load_dwordx4 v[84:87], v17, s[16:19], s64 offen sc1
G_l5:
    s_ff1_i32_b32 s44, s68
    s_bitset0_b32 s68, s44
    s_mul_i32 s64, s44, 1152
    buffer_load_dwordx4 v[80:83], v17, s[16:19], s64 offen sc1
G_l4:
    s_ff1_i32_b32 s43, s68
    s_bitset0_b32 s68, s43
    s_mul_i32 s64, s43, 1152
    buffer_load_dwordx4 v[76:79], v17, s[16:19], s64 offen sc1
G_l3:
    s_ff1_i32_b32 s42, s68
    s_bitset0_b32 s68, s42
    s_mul_i32 s64, s42, 1152
    buffer_load_dwordx4 v[72:75], v17, s[16:19], s64 offen sc1
G_l2:
    s_ff1_i32_b32 s41, s68
    s_bitset0_b32 s68, s41
    s_mul_i32 s64, s41, 1152
    buffer_load_dwordx4 v[68:71], v17, s[16:19], s64 offen sc1
G_l1:
    s_ff1_i32_b32 s40, s68
    s_bitset0_b32 s68, s40
    s_mul_i32 s64, s40, 1152
    buffer_load_dwordx4 v[64:67], v17, s[16:19], s64 offen sc1
G_l0:
    s_mov_b32 s68, s66
    s_cmp_eq_u32 s66, 0
    s_cbranch_scc1 G_z
    s_cmp_lg_u32 s67, 0
    s_cbranch_scc1 G_p
    s_sleep 2
G_p:
    s_mov_b64 exec, 1
    v_mov_b32 v20, 0
    buffer_atomic_or v20, v23, s[16:19], 0 offen sc0
    s_mov_b64 exec, -1
    s_branch G_proc
G_z:
    buffer_load_dwordx4 v[56:59], v18, s[16:19], 0 offen sc1
G_proc:
    s_cmp_eq_u32 s67, 0
    s_cbranch_scc1 G_q0
    s_cmp_gt_u32 s67, 8
    s_cbranch_scc1 G_qt_8
    s_cmp_gt_u32 s67, 4
    s_cbranch_scc1 G_qt_9
    s_cmp_gt_u32 s67, 2
    s_cbranch_scc1 G_qt_10
    s_cmp_eq_u32 s67, 1
    s_cbranch_scc1 G_q1
    s_branch G_q2
G_qt_10:
    s_cmp_eq_u32 s67, 3
    s_cbranch_scc1 G_q3
    s_branch G_q4
G_qt_9:
    s_cmp_gt_u32 s67, 6
    s_cbranch_scc1 G_qt_11
    s_cmp_eq_u32 s67, 5
    s_cbranch_scc1 G_q5
    s_branch G_q6
G_qt_11:
    s_cmp_eq_u32 s67, 7
    s_cbranch_scc1 G_q7
    s_branch G_q8
G_qt_8:
    s_cmp_gt_u32 s67, 12
    s_cbranch_scc1 G_qt_12
    s_cmp_gt_u32 s67, 10
    s_cbranch_scc1 G_qt_13
    s_cmp_eq_u32 s67, 9
    s_cbranch_scc1 G_q9
    s_branch G_q10
G_qt_13:
    s_cmp_eq_u32 s67, 11
    s_cbranch_scc1 G_q11
    s_branch G_q12
G_qt_12:
    s_cmp_gt_u32 s67, 14
    s_cbranch_scc1 G_qt_14
    s_cmp_eq_u32 s67, 13
    s_cbranch_scc1 G_q13
    s_branch G_q14
G_qt_14:
    s_cmp_eq_u32 s67, 15
    s_cbranch_scc1 G_q15
G_q16:
    s_waitcnt vmcnt(16)
    v_max3_u32 v21, v124, v125, v126
    v_max_u32 v21, v21, v127
    v_cmp_eq_u32 vcc, -1, v21
    s_cbranch_vccnz G_f15
    v_mfma_f32_32x32x16_bf16 v[128:143], v[48:51], v[124:127], v[128:143]
G_q15:
    s_waitcnt vmcnt(15)
    v_max3_u32 v21, v120, v121, v122
    v_max_u32 v21, v21, v123
    v_cmp_eq_u32 vcc, -1, v21
    s_cbranch_vccnz G_f14
    v_mfma_f32_32x32x16_bf16 v[128:143], v[48:51], v[120:123], v[128:143]
G_q14:
    s_waitcnt vmcnt(14)
    v_max3_u32 v21, v116, v117, v118
    v_max_u32 v21, v21, v119
    v_cmp_eq_u32 vcc, -1, v21
    s_cbranch_vccnz G_f13
    v_mfma_f32_32x32x16_bf16 v[128:143], v[48:51], v[116:119], v[128:143]
G_q13:
    s_waitcnt vmcnt(13)
    v_max3_u32 v21, v112, v113, v114
    v_max_u32 v21, v21, v115
    v_cmp_eq_u32 vcc, -1, v21
    s_cbranch_vccnz G_f12
    v_mfma_f32_32x32x16_bf16 v[128:143], v[48:51], v[112:115], v[128:143]
G_q12:
    s_waitcnt vmcnt(12)
    v_max3_u32 v21, v108, v109, v110
    v_max_u32 v21, v21, v111
    v_cmp_eq_u32 vcc, -1, v21
    s_cbranch_vccnz G_f11
    v_mfma_f32_32x32x16_bf16 v[128:143], v[48:51], v[108:111], v[128:143]
G_q11:
    s_waitcnt vmcnt(11)
    v_max3_u32 v21, v104, v105, v106
    v_max_u32 v21, v21, v107
    v_cmp_eq_u32 vcc, -1, v21
    s_cbranch_vccnz G_f10
    v_mfma_f32_32x32x16_bf16 v[128:143], v[48:51], v[104:107], v[128:143]
G_q10:
    s_waitcnt vmcnt(10)
    v_max3_u32 v21, v100, v101, v102
    v_max_u32 v21, v21, v103
    v_cmp_eq_u32 vcc, -1, v21
    s_cbranch_vccnz G_f9
    v_mfma_f32_32x32x16_bf16 v[128:143], v[48:51], v[100:103], v[128:143]
G_q9:
    s_waitcnt vmcnt(9)
    v_max3_u32 v21, v96, v97, v98
    v_max_u32 v21, v21, v99
    v_cmp_eq_u32 vcc, -1, v21
    s_cbranch_vccnz G_f8
    v_mfma_f32_32x32x16_bf16 v[128:143], v[48:51], v[96:99], v[128:143]
G_q8:
    s_waitcnt vmcnt(8)
    v_max3_u32 v21, v92, v93, v94
    v_max_u32 v21, v21, v95
    v_cmp_eq_u32 vcc, -1, v21
    s_cbranch_vccnz G_f7
    v_mfma_f32_32x32x16_bf16 v[128:143], v[48:51], v[92:95], v[128:143]
G_q7:
    s_waitcnt vmcnt(7)
    v_max3_u32 v21, v88, v89, v90
    v_max_u32 v21, v21, v91
    v_cmp_eq_u32 vcc, -1, v21
    s_cbranch_vccnz G_f6
    v_mfma_f32_32x32x16_bf16 v[128:143], v[48:51], v[88:91], v[128:143]
G_q6:
    s_waitcnt vmcnt(6)
    v_max3_u32 v21, v84, v85, v86
    v_max_u32 v21, v21, v87
    v_cmp_eq_u32 vcc, -1, v21
    s_cbranch_vccnz G_f5
    v_mfma_f32_32x32x16_bf16 v[128:143], v[48:51], v[84:87], v[128:143]
G_q5:
    s_waitcnt vmcnt(5)
    v_max3_u32 v21, v80, v81, v82
    v_max_u32 v21, v21, v83
    v_cmp_eq_u32 vcc, -1, v21
    s_cbranch_vccnz G_f4
    v_mfma_f32_32x32x16_bf16 v[128:143], v[48:51], v[80:83], v[128:143]
G_q4:
    s_waitcnt vmcnt(4)
    v_max3_u32 v21, v76, v77, v78
    v_max_u32 v21, v21, v79
    v_cmp_eq_u32 vcc, -1, v21
    s_cbranch_vccnz G_f3
    v_mfma_f32_32x32x16_bf16 v[128:143], v[48:51], v[76:79], v[128:143]
G_q3:
    s_waitcnt vmcnt(3)
    v_max3_u32 v21, v72, v73, v74
    v_max_u32 v21, v21, v75
    v_cmp_eq_u32 vcc, -1, v21
    s_cbranch_vccnz G_f2
    v_mfma_f32_32x32x16_bf16 v[128:143], v[48:51], v[72:75], v[128:143]
G_q2:
    s_waitcnt vmcnt(2)
    v_max3_u32 v21, v68, v69, v70
    v_max_u32 v21, v21, v71
    v_cmp_eq_u32 vcc, -1, v21
    s_cbranch_vccnz G_f1
    v_mfma_f32_32x32x16_bf16 v[128:143], v[48:51], v[68:71], v[128:143]
G_q1:
    s_waitcnt vmcnt(1)
    v_max3_u32 v21, v64, v65, v66
    v_max_u32 v21, v21, v67
    v_cmp_eq_u32 vcc, -1, v21
    s_cbranch_vccnz G_f0
    v_mfma_f32_32x32x16_bf16 v[128:143], v[48:51], v[64:67], v[128:143]
G_q0:
    s_waitcnt vmcnt(0)
    s_add_u32 s65, s65, 1
    s_cmp_ge_u32 s65, 40000
    s_cbranch_scc1 G_done
    s_cmp_lg_u32 s68, 0
    s_cbranch_scc1 G_loop
    v_mov_b32 v20, -1
    s_cmp_lg_u32 s66, 0
    s_cbranch_scc1 G_loop
    v_max3_u32 v21, v56, v57, v58
    v_max_u32 v21, v21, v59
    v_cmp_eq_u32 vcc, -1, v21
    s_cbranch_vccnz G_loop
G_done:
    v_add_u32 v16, s7, v6
    v_add_f32_dpp v56, v56, v56 row_ror:4 row_mask:0xf bank_mask:0xf
    v_add_f32_dpp v57, v57, v57 row_ror:4 row_mask:0xf bank_mask:0xf
    v_add_f32_dpp v58, v58, v58 row_ror:4 row_mask:0xf bank_mask:0xf
    v_add_f32_dpp v59, v59, v59 row_ror:4 row_mask:0xf bank_mask:0xf
    v_add_f32_dpp v56, v56, v56 row_ror:8 row_mask:0xf bank_mask:0xf
    v_add_f32_dpp v57, v57, v57 row_ror:8 row_mask:0xf bank_mask:0xf
    v_add_f32_dpp v58, v58, v58 row_ror:8 row_mask:0xf bank_mask:0xf
    v_add_f32_dpp v59, v59, v59 row_ror:8 row_mask:0xf bank_mask:0xf
    v_mov_b32 v64, v56
    v_mov_b32 v65, v57
    v_mov_b32 v66, v58
    v_mov_b32 v67, v59
    s_nop 0
    v_permlane16_swap_b32 v56, v64
    v_permlane16_swap_b32 v57, v65
    v_permlane16_swap_b32 v58, v66
    v_permlane16_swap_b32 v59, v67
    v_add_f32 v56, v56, v64
    v_add_f32 v57, v57, v65
    v_add_f32 v58, v58, v66
    v_add_f32 v59, v59, v67
    v_mov_b32 v64, v56
    v_mov_b32 v65, v57
    v_mov_b32 v66, v58
    v_mov_b32 v67, v59
    s_nop 0
    v_permlane32_swap_b32 v56, v64
    v_permlane32_swap_b32 v57, v65
    v_permlane32_swap_b32 v58, v66
    v_permlane32_swap_b32 v59, v67
    v_add_f32 v56, v56, v64
    v_add_f32 v57, v57, v65
    v_add_f32 v58, v58, v66
    v_add_f32 v59, v59, v67
    v_cvt_pk_bf16_f32 v60, v128, v129
    v_cvt_pk_bf16_f32 v61, v130, v131
    v_cvt_pk_bf16_f32 v62, v132, v133
    v_cvt_pk_bf16_f32 v63, v134, v135
    ds_write_b128 v16, v[60:63] offset:0
    v_cvt_pk_bf16_f32 v56, v56, v57
    v_cvt_pk_bf16_f32 v57, v58, v59
    s_lshr_b32 s64, s6, 1
    s_lshl_b32 s64, s64, 6
    s_and_b32 s65, s6, 1
    s_lshl_b32 s65, s65, 3
    s_add_u32 s64, s64, s65
    v_lshl_add_u32 v16, v2, 4, s64
    s_mov_b64 exec, 15
    ds_write_b64 v16, v[56:57] offset:4096
    s_mov_b64 exec, -1
    s_waitcnt lgkmcnt(0)
    s_barrier
    v_lshrrev_b32 v18, 3, v2
    v_lshlrev_b32 v18, 2, v18
    ds_read_b32 v24, v18 offset:4352
    ds_read_b32 v25, v18 offset:4384
    ds_read_b32 v26, v18 offset:4416
    ds_read_b32 v27, v18 offset:4448
    ds_read_b32 v28, v18 offset:4480
    ds_read_b32 v29, v18 offset:4512
    ds_read_b32 v30, v18 offset:4544
    s_waitcnt lgkmcnt(0)
    v_lshlrev_b32 v48, 16, v192
    v_and_b32 v49, 0xffff0000, v192
    v_mul_f32 v32, v48, v24
    v_mul_f32 v33, v49, v24
    v_lshlrev_b32 v48, 16, v193
    v_and_b32 v49, 0xffff0000, v193
    v_mul_f32 v34, v48, v24
    v_mul_f32 v35, v49, v24
    v_lshlrev_b32 v48, 16, v194
    v_and_b32 v49, 0xffff0000, v194
    v_mul_f32 v36, v48, v24
    v_mul_f32 v37, v49, v24
    v_lshlrev_b32 v48, 16, v195
    v_and_b32 v49, 0xffff0000, v195
    v_mul_f32 v38, v48, v24
    v_mul_f32 v39, v49, v24
    v_lshlrev_b32 v48, 16, v196
    v_and_b32 v49, 0xffff0000, v196
    v_fmac_f32 v32, v48, v25
    v_fmac_f32 v33, v49, v25
    v_lshlrev_b32 v48, 16, v197
    v_and_b32 v49, 0xffff0000, v197
    v_fmac_f32 v34, v48, v25
    v_fmac_f32 v35, v49, v25
    v_lshlrev_b32 v48, 16, v198
    v_and_b32 v49, 0xffff0000, v198
    v_fmac_f32 v36, v48, v25
    v_fmac_f32 v37, v49, v25
    v_lshlrev_b32 v48, 16, v199
    v_and_b32 v49, 0xffff0000, v199
    v_fmac_f32 v38, v48, v25
    v_fmac_f32 v39, v49, v25
    v_lshlrev_b32 v48, 16, v200
    v_and_b32 v49, 0xffff0000, v200
    v_fmac_f32 v32, v48, v26
    v_fmac_f32 v33, v49, v26
    v_lshlrev_b32 v48, 16, v201
    v_and_b32 v49, 0xffff0000, v201
    v_fmac_f32 v34, v48, v26
    v_fmac_f32 v35, v49, v26
    v_lshlrev_b32 v48, 16, v202
    v_and_b32 v49, 0xffff0000, v202
    v_fmac_f32 v36, v48, v26
    v_fmac_f32 v37, v49, v26
    v_lshlrev_b32 v48, 16, v203
    v_and_b32 v49, 0xffff0000, v203
    v_fmac_f32 v38, v48, v26
    v_fmac_f32 v39, v49, v26
    v_lshlrev_b32 v48, 16, v204
    v_and_b32 v49, 0xffff0000, v204
    v_fmac_f32 v32, v48, v27
    v_fmac_f32 v33, v49, v27
    v_lshlrev_b32 v48, 16, v205
    v_and_b32 v49, 0xffff0000, v205
    v_fmac_f32 v34, v48, v27
    v_fmac_f32 v35, v49, v27
    v_lshlrev_b32 v48, 16, v206
    v_and_b32 v49, 0xffff0000, v206
    v_fmac_f32 v36, v48, v27
    v_fmac_f32 v37, v49, v27
    v_lshlrev_b32 v48, 16, v207
    v_and_b32 v49, 0xffff0000, v207
    v_fmac_f32 v38, v48, v27
    v_fmac_f32 v39, v49, v27
    v_lshlrev_b32 v48, 16, v208
    v_and_b32 v49, 0xffff0000, v208
    v_fmac_f32 v32, v48, v28
    v_fmac_f32 v33, v49, v28
    v_lshlrev_b32 v48, 16, v209
    v_and_b32 v49, 0xffff0000, v209
    v_fmac_f32 v34, v48, v28
    v_fmac_f32 v35, v49, v28
    v_lshlrev_b32 v48, 16, v210
    v_and_b32 v49, 0xffff0000, v210
    v_fmac_f32 v36, v48, v28
    v_fmac_f32 v37, v49, v28
    v_lshlrev_b32 v48, 16, v211
    v_and_b32 v49, 0xffff0000, v211
    v_fmac_f32 v38, v48, v28
    v_fmac_f32 v39, v49, v28
    v_lshlrev_b32 v48, 16, v212
    v_and_b32 v49, 0xffff0000, v212
    v_fmac_f32 v32, v48, v29
    v_fmac_f32 v33, v49, v29
    v_lshlrev_b32 v48, 16, v213
    v_and_b32 v49, 0xffff0000, v213
    v_fmac_f32 v34, v48, v29
    v_fmac_f32 v35, v49, v29
    v_lshlrev_b32 v48, 16, v214
    v_and_b32 v49, 0xffff0000, v214
    v_fmac_f32 v36, v48, v29
    v_fmac_f32 v37, v49, v29
    v_lshlrev_b32 v48, 16, v215
    v_and_b32 v49, 0xffff0000, v215
    v_fmac_f32 v38, v48, v29
    v_fmac_f32 v39, v49, v29
    v_lshlrev_b32 v48, 16, v216
    v_and_b32 v49, 0xffff0000, v216
    v_fmac_f32 v32, v48, v30
    v_fmac_f32 v33, v49, v30
    v_lshlrev_b32 v48, 16, v217
    v_and_b32 v49, 0xffff0000, v217
    v_fmac_f32 v34, v48, v30
    v_fmac_f32 v35, v49, v30
    v_lshlrev_b32 v48, 16, v218
    v_and_b32 v49, 0xffff0000, v218
    v_fmac_f32 v36, v48, v30
    v_fmac_f32 v37, v49, v30
    v_lshlrev_b32 v48, 16, v219
    v_and_b32 v49, 0xffff0000, v219
    v_fmac_f32 v38, v48, v30
    v_fmac_f32 v39, v49, v30
    s_nop 1
    v_permlane32_swap_b32 v32, v36
    v_permlane32_swap_b32 v33, v37
    v_permlane32_swap_b32 v34, v38
    v_permlane32_swap_b32 v35, v39
    v_add_f32 v32, v32, v36
    v_add_f32 v33, v33, v37
    v_add_f32 v34, v34, v38
    v_add_f32 v35, v35, v39
    s_nop 1
    v_permlane16_swap_b32 v32, v34
    v_permlane16_swap_b32 v33, v35
    v_add_f32 v32, v32, v34
    v_add_f32 v33, v33, v35
    s_nop 1
    v_add_f32_dpp v32, v32, v32 row_ror:8 row_mask:0xf bank_mask:0xf
    v_add_f32_dpp v33, v33, v33 row_ror:8 row_mask:0xf bank_mask:0xf
    v_and_b32 v16, 7, v2
    v_lshlrev_b32 v16, 5, v16
    v_lshl_add_u32 v16, v8, 3, v16
    s_lshl_b32 s64, s2, 10
    s_lshl_b32 s65, s6, 8
    s_add_u32 s64, s64, s65
    s_add_u32 s64, s64, 6447104
    s_mov_b32 exec_lo, 0x00ff00ff
    s_mov_b32 exec_hi, 0x00ff00ff
    buffer_store_dwordx2 v[32:33], v16, s[16:19], s64 offen sc0 sc1
    s_mov_b64 exec, -1
    s_lshl_b32 s64, s4, 3
    s_add_u32 s64, s64, s3
    s_lshl_b32 s64, s64, 7
    s_add_u32 s64, s64, 5382144
    v_mov_b32 v14, s64
    s_mov_b64 exec, 1
    v_mov_b32 v15, 0
    buffer_atomic_or v15, v14, s[16:19], 0 offen sc0
    s_mov_b64 exec, -1
    v_sub_f32 v248, 1.0, v228
    v_cvt_pk_bf16_f32 v248, v248, v248
    v_lshlrev_b32 v248, 16, v248
    v_lshlrev_b32 v232, 16, v220
    v_and_b32 v233, 0xffff0000, v220
    v_mul_f32 v232, v232, v248
    v_mul_f32 v233, v233, v248
    v_cvt_pk_bf16_f32 v3, v232, v233
    v_lshlrev_b32 v232, 16, v3
    v_and_b32 v233, 0xffff0000, v3
    v_lshlrev_b32 v234, 16, v221
    v_and_b32 v235, 0xffff0000, v221
    v_mul_f32 v234, v234, v248
    v_mul_f32 v235, v235, v248
    v_cvt_pk_bf16_f32 v3, v234, v235
    v_lshlrev_b32 v234, 16, v3
    v_and_b32 v235, 0xffff0000, v3
    v_lshlrev_b32 v236, 16, v222
    v_and_b32 v237, 0xffff0000, v222
    v_mul_f32 v236, v236, v248
    v_mul_f32 v237, v237, v248
    v_cvt_pk_bf16_f32 v3, v236, v237
    v_lshlrev_b32 v236, 16, v3
    v_and_b32 v237, 0xffff0000, v3
    v_lshlrev_b32 v238, 16, v223
    v_and_b32 v239, 0xffff0000, v223
    v_mul_f32 v238, v238, v248
    v_mul_f32 v239, v239, v248
    v_cvt_pk_bf16_f32 v3, v238, v239
    v_lshlrev_b32 v238, 16, v3
    v_and_b32 v239, 0xffff0000, v3
    v_lshlrev_b32 v240, 16, v224
    v_and_b32 v241, 0xffff0000, v224
    v_mul_f32 v240, v240, v248
    v_mul_f32 v241, v241, v248
    v_cvt_pk_bf16_f32 v3, v240, v241
    v_lshlrev_b32 v240, 16, v3
    v_and_b32 v241, 0xffff0000, v3
    v_lshlrev_b32 v242, 16, v225
    v_and_b32 v243, 0xffff0000, v225
    v_mul_f32 v242, v242, v248
    v_mul_f32 v243, v243, v248
    v_cvt_pk_bf16_f32 v3, v242, v243
    v_lshlrev_b32 v242, 16, v3
    v_and_b32 v243, 0xffff0000, v3
    v_lshlrev_b32 v244, 16, v226
    v_and_b32 v245, 0xffff0000, v226
    v_mul_f32 v244, v244, v248
    v_mul_f32 v245, v245, v248
    v_cvt_pk_bf16_f32 v3, v244, v245
    v_lshlrev_b32 v244, 16, v3
    v_and_b32 v245, 0xffff0000, v3
    v_lshlrev_b32 v246, 16, v227
    v_and_b32 v247, 0xffff0000, v227
    v_mul_f32 v246, v246, v248
    v_mul_f32 v247, v247, v248
    v_cvt_pk_bf16_f32 v3, v246, v247
    v_lshlrev_b32 v246, 16, v3
    v_and_b32 v247, 0xffff0000, v3
    s_branch P2_start
C_start:
    s_getpc_b64 s[68:69]
C_pc:
    s_sub_u32 s68, s68, C_pc-gated_mix__linear_attn_block__moe_arch_mod__prompt_kernel
    s_subb_u32 s69, s69, 0
    s_lshr_b32 s64, s2, 3
    s_lshl_b32 s64, s64, 2
    s_add_u32 s64, s64, s3
    s_mul_i32 s64, s64, 256
    s_mov_b32 s65, CODE_END-gated_mix__linear_attn_block__moe_arch_mod__prompt_kernel-4
    s_min_u32 s66, s64, s65
    s_load_dword s75, s[68:69], s66
    s_add_u32 s64, s64, 64
    s_min_u32 s66, s64, s65
    s_load_dword s75, s[68:69], s66
    s_add_u32 s64, s64, 64
    s_min_u32 s66, s64, s65
    s_load_dword s75, s[68:69], s66
    s_add_u32 s64, s64, 64
    s_min_u32 s66, s64, s65
    s_load_dword s75, s[68:69], s66
    s_add_u32 s64, s64, 64
    s_and_b32 s6, s3, 1
    s_lshr_b32 s7, s3, 1
    v_and_b32 v3, 15, v2
    s_lshl_b32 s64, s6, 6
    v_add_u32 v3, s64, v3
    v_lshlrev_b32 v3, 7, v3
    v_add_u32 v3, 8192, v3
    v_bfe_u32 v56, v2, 1, 3
    v_lshrrev_b32 v57, 4, v2
    v_xor_b32 v56, v56, v57
    v_lshl_add_u32 v4, v56, 4, v3
    v_xor_b32 v5, 64, v4
    v_bfe_u32 v56, v2, 2, 2
    v_lshl_add_u32 v58, v57, 3, v56
    v_lshlrev_b32 v58, 7, v58
    v_lshrrev_b32 v56, 1, v56
    v_xor_b32 v56, s7, v56
    v_lshl_add_u32 v58, v56, 6, v58
    v_and_b32 v57, 1, v57
    v_lshl_add_u32 v58, v57, 5, v58
    v_and_b32 v56, 3, v2
    v_lshl_add_u32 v58, v56, 3, v58
    v_add_u32 v6, 24576, v58
    v_xor_b32 v7, 32, v6
    v_mov_b32 v8, v4
    v_mov_b32 v10, v6
    v_mov_b32 v9, v5
    v_mov_b32 v11, v7
    v_mov_b32 v64, 0
    v_mov_b32 v65, 0
    v_mov_b32 v66, 0
    v_mov_b32 v67, 0
    v_mov_b32 v68, 0
    v_mov_b32 v69, 0
    v_mov_b32 v70, 0
    v_mov_b32 v71, 0
    v_mov_b32 v72, 0
    v_mov_b32 v73, 0
    v_mov_b32 v74, 0
    v_mov_b32 v75, 0
    v_mov_b32 v76, 0
    v_mov_b32 v77, 0
    v_mov_b32 v78, 0
    v_mov_b32 v79, 0
    v_mov_b32 v80, 0
    v_mov_b32 v81, 0
    v_mov_b32 v82, 0
    v_mov_b32 v83, 0
    v_mov_b32 v84, 0
    v_mov_b32 v85, 0
    v_mov_b32 v86, 0
    v_mov_b32 v87, 0
    v_mov_b32 v88, 0
    v_mov_b32 v89, 0
    v_mov_b32 v90, 0
    v_mov_b32 v91, 0
    v_mov_b32 v92, 0
    v_mov_b32 v93, 0
    v_mov_b32 v94, 0
    v_mov_b32 v95, 0
    v_mov_b32 v96, 0
    v_mov_b32 v97, 0
    v_mov_b32 v98, 0
    v_mov_b32 v99, 0
    v_mov_b32 v100, 0
    v_mov_b32 v101, 0
    v_mov_b32 v102, 0
    v_mov_b32 v103, 0
    v_mov_b32 v104, 0
    v_mov_b32 v105, 0
    v_mov_b32 v106, 0
    v_mov_b32 v107, 0
    v_mov_b32 v108, 0
    v_mov_b32 v109, 0
    v_mov_b32 v110, 0
    v_mov_b32 v111, 0
    v_mov_b32 v112, 0
    v_mov_b32 v113, 0
    v_mov_b32 v114, 0
    v_mov_b32 v115, 0
    v_mov_b32 v116, 0
    v_mov_b32 v117, 0
    v_mov_b32 v118, 0
    v_mov_b32 v119, 0
    v_mov_b32 v120, 0
    v_mov_b32 v121, 0
    v_mov_b32 v122, 0
    v_mov_b32 v123, 0
    v_mov_b32 v124, 0
    v_mov_b32 v125, 0
    v_mov_b32 v126, 0
    v_mov_b32 v127, 0
    v_mov_b32 v128, 0
    v_mov_b32 v129, 0
    v_mov_b32 v130, 0
    v_mov_b32 v131, 0
    v_mov_b32 v132, 0
    v_mov_b32 v133, 0
    v_mov_b32 v134, 0
    v_mov_b32 v135, 0
    v_mov_b32 v136, 0
    v_mov_b32 v137, 0
    v_mov_b32 v138, 0
    v_mov_b32 v139, 0
    v_mov_b32 v140, 0
    v_mov_b32 v141, 0
    v_mov_b32 v142, 0
    v_mov_b32 v143, 0
    v_mov_b32 v144, 0
    v_mov_b32 v145, 0
    v_mov_b32 v146, 0
    v_mov_b32 v147, 0
    v_mov_b32 v148, 0
    v_mov_b32 v149, 0
    v_mov_b32 v150, 0
    v_mov_b32 v151, 0
    v_mov_b32 v152, 0
    v_mov_b32 v153, 0
    v_mov_b32 v154, 0
    v_mov_b32 v155, 0
    v_mov_b32 v156, 0
    v_mov_b32 v157, 0
    v_mov_b32 v158, 0
    v_mov_b32 v159, 0
    s_lshl_b32 s64, s3, 2
    v_mov_b32 v229, s64
    ds_write_b32 v229, v64 offset:4288
    v_lshlrev_b32 v3, 4, v2
    s_lshl_b32 s64, s3, 11
    v_add_u32 v224, s64, v3
    v_xor_b32 v225, 2048, v224
    s_lshl_b32 s64, s3, 8
    v_lshl_add_u32 v227, v2, 2, s64
    v_xor_b32 v228, 256, v227
    v_xor_b32 v230, 4, v229
    v_mov_b32 v231, 1
    v_lshlrev_b32 v232, 2, v2
    s_lshl_b32 s64, 1, s4
    v_mov_b32 v233, s64
    s_lshl_b32 s43, s5, 2
    s_add_u32 s43, s43, s3
    s_lshl_b32 s64, s43, 7
    s_add_u32 s64, s64, 5373952
    v_mov_b32 v234, s64
    s_lshl_b32 s43, s43, 4
    s_add_u32 s43, s43, s4
    s_mul_i32 s43, s43, 1152
    s_add_u32 s43, s43, 4194304
    s_lshl_b32 s42, s4, 2
    s_lshl_b32 s64, s6, 1
    s_add_u32 s42, s42, s64
    s_lshl_b32 s42, s42, 5
    s_lshl_b32 s64, s5, 1
    s_add_u32 s42, s42, s64
    s_add_u32 s42, s42, s7
    s_lshl_b32 s42, s42, 11
    s_and_b32 s64, s5, 7
    s_lshl_b32 s64, s64, 1
    s_add_u32 s64, s64, s7
    s_lshl_b32 s64, 1, s64
    v_mov_b32 v13, s64
    s_lshr_b32 s64, s5, 3
    s_lshl_b32 s64, s64, 1
    s_add_u32 s64, s64, s6
    s_lshl_b32 s64, s64, 8
    s_lshl_b32 s65, s4, 10
    s_add_u32 s64, s64, s65
    s_add_u32 s64, s64, 5382144
    v_lshl_add_u32 v12, v2, 7, s64
    s_and_b32 s64, s2, 7
    s_lshr_b32 s65, s2, 3
    s_and_b32 s4, s64, 3
    s_lshl_b32 s4, s4, 2
    s_and_b32 s66, s65, 3
    s_add_u32 s4, s4, s66
    s_lshr_b32 s5, s64, 2
    s_lshl_b32 s5, s5, 3
    s_lshr_b32 s74, s65, 2
    s_add_u32 s5, s5, s74
    s_mov_b32 s65, 0
    s_mov_b32 s66, 0
    v_mov_b32 v236, 0x3f803f80
    v_mov_b32 v237, 0x3f803f80
    v_mov_b32 v238, 0x3f803f80
    v_mov_b32 v239, 0x3f803f80
    s_waitcnt vmcnt(0) lgkmcnt(0)
    s_barrier
    ds_read_b64_tr_b16 v[16:17], v10 offset:0
    ds_read_b64_tr_b16 v[18:19], v10 offset:512
    ds_read_b128 v[192:195], v8 offset:0
    ds_read_b128 v[196:199], v8 offset:2048
    ds_read_b128 v[200:203], v8 offset:4096
    ds_read_b128 v[204:207], v8 offset:6144
    ds_read_b64_tr_b16 v[20:21], v11 offset:0
    ds_read_b64_tr_b16 v[22:23], v11 offset:512
    ds_read_b64_tr_b16 v[24:25], v10 offset:8192
    ds_read_b64_tr_b16 v[26:27], v10 offset:8704
    ds_read_b64_tr_b16 v[28:29], v11 offset:8192
    ds_read_b64_tr_b16 v[30:31], v11 offset:8704
    ds_read_b64_tr_b16 v[32:33], v10 offset:16384
    ds_read_b64_tr_b16 v[34:35], v10 offset:16896
    ds_read_b64_tr_b16 v[36:37], v11 offset:16384
    ds_read_b64_tr_b16 v[38:39], v11 offset:16896
.p2align 3
C_loop:
    s_waitcnt lgkmcnt(0)
    v_mfma_f32_16x16x32_bf16 v[64:67], v[16:19], v[192:195], v[64:67]
    ds_read_b64_tr_b16 v[40:41], v10 offset:4096
    v_mfma_f32_16x16x32_bf16 v[72:75], v[16:19], v[196:199], v[72:75]
    ds_read_b64_tr_b16 v[42:43], v10 offset:4608
    v_mfma_f32_16x16x32_bf16 v[80:83], v[16:19], v[200:203], v[80:83]
    ds_read_b128 v[208:211], v9 offset:0
    v_mfma_f32_16x16x32_bf16 v[88:91], v[16:19], v[204:207], v[88:91]
    ds_read_b128 v[212:215], v9 offset:2048
    v_mfma_f32_16x16x32_bf16 v[68:71], v[20:23], v[192:195], v[68:71]
    ds_read_b128 v[216:219], v9 offset:4096
    v_mfma_f32_16x16x32_bf16 v[76:79], v[20:23], v[196:199], v[76:79]
    ds_read_b128 v[220:223], v9 offset:6144
    v_mfma_f32_16x16x32_bf16 v[84:87], v[20:23], v[200:203], v[84:87]
    ds_read_b64_tr_b16 v[44:45], v11 offset:4096
    v_mfma_f32_16x16x32_bf16 v[92:95], v[20:23], v[204:207], v[92:95]
    ds_read_b64_tr_b16 v[46:47], v11 offset:4608
    v_mfma_f32_16x16x32_bf16 v[96:99], v[192:195], v[24:27], v[96:99]
    ds_read_b64_tr_b16 v[48:49], v10 offset:12288
    v_mfma_f32_16x16x32_bf16 v[100:103], v[196:199], v[24:27], v[100:103]
    ds_read_b64_tr_b16 v[50:51], v10 offset:12800
    v_mfma_f32_16x16x32_bf16 v[112:115], v[200:203], v[24:27], v[112:115]
    ds_read_b64_tr_b16 v[52:53], v11 offset:12288
    v_mfma_f32_16x16x32_bf16 v[116:119], v[204:207], v[24:27], v[116:119]
    ds_read_b64_tr_b16 v[54:55], v11 offset:12800
    v_mfma_f32_16x16x32_bf16 v[104:107], v[192:195], v[28:31], v[104:107]
    ds_read_b64_tr_b16 v[56:57], v10 offset:20480
    v_mfma_f32_16x16x32_bf16 v[108:111], v[196:199], v[28:31], v[108:111]
    ds_read_b64_tr_b16 v[58:59], v10 offset:20992
    v_mfma_f32_16x16x32_bf16 v[120:123], v[200:203], v[28:31], v[120:123]
    ds_read_b64_tr_b16 v[60:61], v11 offset:20480
    v_mfma_f32_16x16x32_bf16 v[124:127], v[204:207], v[28:31], v[124:127]
    ds_read_b64_tr_b16 v[62:63], v11 offset:20992
    v_mfma_f32_16x16x32_bf16 v[128:131], v[192:195], v[32:35], v[128:131]
    v_mfma_f32_16x16x32_bf16 v[132:135], v[196:199], v[32:35], v[132:135]
    v_mfma_f32_16x16x32_bf16 v[144:147], v[200:203], v[32:35], v[144:147]
    v_mfma_f32_16x16x32_bf16 v[148:151], v[204:207], v[32:35], v[148:151]
    v_mfma_f32_16x16x32_bf16 v[136:139], v[192:195], v[36:39], v[136:139]
    v_mfma_f32_16x16x32_bf16 v[140:143], v[196:199], v[36:39], v[140:143]
    v_mfma_f32_16x16x32_bf16 v[152:155], v[200:203], v[36:39], v[152:155]
    v_mfma_f32_16x16x32_bf16 v[156:159], v[204:207], v[36:39], v[156:159]
    s_waitcnt lgkmcnt(0)
    s_barrier
    s_add_u32 s65, s65, 40960
    s_cmp_eq_u32 s65, 122880
    s_cselect_b32 s65, 0, s65
    v_mfma_f32_16x16x32_bf16 v[64:67], v[40:43], v[208:211], v[64:67]
    v_add_u32 v10, s65, v6
    v_add_u32 v8, s65, v4
    v_mfma_f32_16x16x32_bf16 v[72:75], v[40:43], v[212:215], v[72:75]
    ds_read_b64_tr_b16 v[16:17], v10 offset:0
    v_mfma_f32_16x16x32_bf16 v[80:83], v[40:43], v[216:219], v[80:83]
    ds_read_b64_tr_b16 v[18:19], v10 offset:512
    v_mfma_f32_16x16x32_bf16 v[88:91], v[40:43], v[220:223], v[88:91]
    ds_read_b128 v[192:195], v8 offset:0
    v_mfma_f32_16x16x32_bf16 v[68:71], v[44:47], v[208:211], v[68:71]
    ds_read_b128 v[196:199], v8 offset:2048
    v_mfma_f32_16x16x32_bf16 v[76:79], v[44:47], v[212:215], v[76:79]
    ds_read_b128 v[200:203], v8 offset:4096
    v_mfma_f32_16x16x32_bf16 v[84:87], v[44:47], v[216:219], v[84:87]
    ds_read_b128 v[204:207], v8 offset:6144
    v_mfma_f32_16x16x32_bf16 v[92:95], v[44:47], v[220:223], v[92:95]
    v_add_u32 v11, s65, v7
    v_mfma_f32_16x16x32_bf16 v[96:99], v[208:211], v[48:51], v[96:99]
    ds_read_b64_tr_b16 v[20:21], v11 offset:0
    v_mfma_f32_16x16x32_bf16 v[100:103], v[212:215], v[48:51], v[100:103]
    ds_read_b64_tr_b16 v[22:23], v11 offset:512
    v_mfma_f32_16x16x32_bf16 v[112:115], v[216:219], v[48:51], v[112:115]
    ds_read_b64_tr_b16 v[24:25], v10 offset:8192
    v_mfma_f32_16x16x32_bf16 v[116:119], v[220:223], v[48:51], v[116:119]
    ds_read_b64_tr_b16 v[26:27], v10 offset:8704
    v_mfma_f32_16x16x32_bf16 v[104:107], v[208:211], v[52:55], v[104:107]
    ds_read_b64_tr_b16 v[28:29], v11 offset:8192
    v_mfma_f32_16x16x32_bf16 v[108:111], v[212:215], v[52:55], v[108:111]
    ds_read_b64_tr_b16 v[30:31], v11 offset:8704
    v_mfma_f32_16x16x32_bf16 v[120:123], v[216:219], v[52:55], v[120:123]
    ds_read_b64_tr_b16 v[32:33], v10 offset:16384
    v_mfma_f32_16x16x32_bf16 v[124:127], v[220:223], v[52:55], v[124:127]
    ds_read_b64_tr_b16 v[34:35], v10 offset:16896
    v_mfma_f32_16x16x32_bf16 v[128:131], v[208:211], v[56:59], v[128:131]
    ds_read_b64_tr_b16 v[36:37], v11 offset:16384
    v_mfma_f32_16x16x32_bf16 v[132:135], v[212:215], v[56:59], v[132:135]
    ds_read_b64_tr_b16 v[38:39], v11 offset:16896
    v_mfma_f32_16x16x32_bf16 v[144:147], v[216:219], v[56:59], v[144:147]
    v_add_u32 v9, s65, v5
    v_mfma_f32_16x16x32_bf16 v[148:151], v[220:223], v[56:59], v[148:151]
    v_mfma_f32_16x16x32_bf16 v[136:139], v[208:211], v[60:63], v[136:139]
    v_mfma_f32_16x16x32_bf16 v[140:143], v[212:215], v[60:63], v[140:143]
    v_mfma_f32_16x16x32_bf16 v[152:155], v[216:219], v[60:63], v[152:155]
    v_mfma_f32_16x16x32_bf16 v[156:159], v[220:223], v[60:63], v[156:159]
    s_add_u32 s66, s66, 1
    s_cmp_lt_u32 s66, 14
    s_cbranch_scc1 C_loop
    s_waitcnt lgkmcnt(0)
    v_mfma_f32_16x16x32_bf16 v[96:99], v[192:195], v[24:27], v[96:99]
    ds_read_b64_tr_b16 v[48:49], v10 offset:12288
    v_mfma_f32_16x16x32_bf16 v[100:103], v[196:199], v[24:27], v[100:103]
    ds_read_b64_tr_b16 v[50:51], v10 offset:12800
    v_mfma_f32_16x16x32_bf16 v[112:115], v[200:203], v[24:27], v[112:115]
    ds_read_b128 v[160:163], v9 offset:0
    v_mfma_f32_16x16x32_bf16 v[116:119], v[204:207], v[24:27], v[116:119]
    ds_read_b128 v[164:167], v9 offset:2048
    v_mfma_f32_16x16x32_bf16 v[104:107], v[192:195], v[28:31], v[104:107]
    ds_read_b128 v[168:171], v9 offset:4096
    v_mfma_f32_16x16x32_bf16 v[108:111], v[196:199], v[28:31], v[108:111]
    ds_read_b128 v[172:175], v9 offset:6144
    v_mfma_f32_16x16x32_bf16 v[120:123], v[200:203], v[28:31], v[120:123]
    ds_read_b64_tr_b16 v[52:53], v11 offset:12288
    v_mfma_f32_16x16x32_bf16 v[124:127], v[204:207], v[28:31], v[124:127]
    ds_read_b64_tr_b16 v[54:55], v11 offset:12800
    v_mfma_f32_16x16x32_bf16 v[128:131], v[192:195], v[32:35], v[128:131]
    ds_read_b64_tr_b16 v[56:57], v10 offset:20480
    v_mfma_f32_16x16x32_bf16 v[132:135], v[196:199], v[32:35], v[132:135]
    ds_read_b64_tr_b16 v[58:59], v10 offset:20992
    v_mfma_f32_16x16x32_bf16 v[144:147], v[200:203], v[32:35], v[144:147]
    ds_read_b64_tr_b16 v[60:61], v11 offset:20480
    v_mfma_f32_16x16x32_bf16 v[148:151], v[204:207], v[32:35], v[148:151]
    ds_read_b64_tr_b16 v[62:63], v11 offset:20992
    v_mfma_f32_16x16x32_bf16 v[136:139], v[192:195], v[36:39], v[136:139]
    v_mfma_f32_16x16x32_bf16 v[140:143], v[196:199], v[36:39], v[140:143]
    v_mfma_f32_16x16x32_bf16 v[152:155], v[200:203], v[36:39], v[152:155]
    v_mfma_f32_16x16x32_bf16 v[156:159], v[204:207], v[36:39], v[156:159]
    s_waitcnt lgkmcnt(0)
    s_barrier
    s_add_u32 s66, s66, 1
    v_mfma_f32_16x16x32_bf16 v[96:99], v[160:163], v[48:51], v[96:99]
    v_mov_b32 v10, v6
    v_mov_b32 v8, v4
    v_mfma_f32_16x16x32_bf16 v[100:103], v[164:167], v[48:51], v[100:103]
    ds_read_b64_tr_b16 v[24:25], v10 offset:8192
    v_mfma_f32_16x16x32_bf16 v[112:115], v[168:171], v[48:51], v[112:115]
    ds_read_b64_tr_b16 v[26:27], v10 offset:8704
    v_mfma_f32_16x16x32_bf16 v[116:119], v[172:175], v[48:51], v[116:119]
    v_mov_b32 v11, v7
    v_mov_b32 v9, v5
    v_mfma_f32_16x16x32_bf16 v[104:107], v[160:163], v[52:55], v[104:107]
    ds_read_b128 v[176:179], v8 offset:0
    v_mfma_f32_16x16x32_bf16 v[108:111], v[164:167], v[52:55], v[108:111]
    ds_read_b128 v[180:183], v8 offset:2048
    v_mfma_f32_16x16x32_bf16 v[120:123], v[168:171], v[52:55], v[120:123]
    ds_read_b128 v[184:187], v8 offset:4096
    v_mfma_f32_16x16x32_bf16 v[124:127], v[172:175], v[52:55], v[124:127]
    ds_read_b128 v[188:191], v8 offset:6144
    v_mfma_f32_16x16x32_bf16 v[128:131], v[160:163], v[56:59], v[128:131]
    ds_read_b64_tr_b16 v[28:29], v11 offset:8192
    v_mfma_f32_16x16x32_bf16 v[132:135], v[164:167], v[56:59], v[132:135]
    ds_read_b64_tr_b16 v[30:31], v11 offset:8704
    v_mfma_f32_16x16x32_bf16 v[144:147], v[168:171], v[56:59], v[144:147]
    ds_read_b64_tr_b16 v[32:33], v10 offset:16384
    v_mfma_f32_16x16x32_bf16 v[148:151], v[172:175], v[56:59], v[148:151]
    ds_read_b64_tr_b16 v[34:35], v10 offset:16896
    v_mfma_f32_16x16x32_bf16 v[136:139], v[160:163], v[60:63], v[136:139]
    ds_read_b64_tr_b16 v[36:37], v11 offset:16384
    v_mfma_f32_16x16x32_bf16 v[140:143], v[164:167], v[60:63], v[140:143]
    ds_read_b64_tr_b16 v[38:39], v11 offset:16896
    v_mfma_f32_16x16x32_bf16 v[152:155], v[168:171], v[60:63], v[152:155]
    v_mfma_f32_16x16x32_bf16 v[156:159], v[172:175], v[60:63], v[156:159]
    s_waitcnt lgkmcnt(0)
    v_mfma_f32_16x16x32_bf16 v[96:99], v[176:179], v[24:27], v[96:99]
    ds_read_b64_tr_b16 v[48:49], v10 offset:12288
    v_mfma_f32_16x16x32_bf16 v[100:103], v[180:183], v[24:27], v[100:103]
    ds_read_b64_tr_b16 v[50:51], v10 offset:12800
    v_mfma_f32_16x16x32_bf16 v[112:115], v[184:187], v[24:27], v[112:115]
    ds_read_b128 v[208:211], v9 offset:0
    v_mfma_f32_16x16x32_bf16 v[116:119], v[188:191], v[24:27], v[116:119]
    ds_read_b128 v[212:215], v9 offset:2048
    v_mfma_f32_16x16x32_bf16 v[104:107], v[176:179], v[28:31], v[104:107]
    ds_read_b128 v[216:219], v9 offset:4096
    v_mfma_f32_16x16x32_bf16 v[108:111], v[180:183], v[28:31], v[108:111]
    ds_read_b128 v[220:223], v9 offset:6144
    v_mfma_f32_16x16x32_bf16 v[120:123], v[184:187], v[28:31], v[120:123]
    ds_read_b64_tr_b16 v[52:53], v11 offset:12288
    v_mfma_f32_16x16x32_bf16 v[124:127], v[188:191], v[28:31], v[124:127]
    ds_read_b64_tr_b16 v[54:55], v11 offset:12800
    v_mfma_f32_16x16x32_bf16 v[128:131], v[176:179], v[32:35], v[128:131]
    ds_read_b64_tr_b16 v[56:57], v10 offset:20480
    v_mfma_f32_16x16x32_bf16 v[132:135], v[180:183], v[32:35], v[132:135]
    ds_read_b64_tr_b16 v[58:59], v10 offset:20992
    v_mfma_f32_16x16x32_bf16 v[144:147], v[184:187], v[32:35], v[144:147]
    ds_read_b64_tr_b16 v[60:61], v11 offset:20480
    v_mfma_f32_16x16x32_bf16 v[148:151], v[188:191], v[32:35], v[148:151]
    ds_read_b64_tr_b16 v[62:63], v11 offset:20992
    v_mfma_f32_16x16x32_bf16 v[136:139], v[176:179], v[36:39], v[136:139]
    v_mfma_f32_16x16x32_bf16 v[140:143], v[180:183], v[36:39], v[140:143]
    v_mfma_f32_16x16x32_bf16 v[152:155], v[184:187], v[36:39], v[152:155]
    v_mfma_f32_16x16x32_bf16 v[156:159], v[188:191], v[36:39], v[156:159]
    s_waitcnt lgkmcnt(0)
    s_barrier
    v_mfma_f32_16x16x32_bf16 v[96:99], v[208:211], v[48:51], v[96:99]
    v_mfma_f32_16x16x32_bf16 v[100:103], v[212:215], v[48:51], v[100:103]
    v_mfma_f32_16x16x32_bf16 v[112:115], v[216:219], v[48:51], v[112:115]
    v_mfma_f32_16x16x32_bf16 v[116:119], v[220:223], v[48:51], v[116:119]
    v_mfma_f32_16x16x32_bf16 v[104:107], v[208:211], v[52:55], v[104:107]
    v_mfma_f32_16x16x32_bf16 v[108:111], v[212:215], v[52:55], v[108:111]
    v_mfma_f32_16x16x32_bf16 v[120:123], v[216:219], v[52:55], v[120:123]
    v_mfma_f32_16x16x32_bf16 v[124:127], v[220:223], v[52:55], v[124:127]
    v_mfma_f32_16x16x32_bf16 v[128:131], v[208:211], v[56:59], v[128:131]
    v_mfma_f32_16x16x32_bf16 v[132:135], v[212:215], v[56:59], v[132:135]
    v_mfma_f32_16x16x32_bf16 v[144:147], v[216:219], v[56:59], v[144:147]
    v_mfma_f32_16x16x32_bf16 v[148:151], v[220:223], v[56:59], v[148:151]
    v_mfma_f32_16x16x32_bf16 v[136:139], v[208:211], v[60:63], v[136:139]
    v_mfma_f32_16x16x32_bf16 v[140:143], v[212:215], v[60:63], v[140:143]
    v_mfma_f32_16x16x32_bf16 v[152:155], v[216:219], v[60:63], v[152:155]
    v_mfma_f32_16x16x32_bf16 v[156:159], v[220:223], v[60:63], v[156:159]
    v_add_u32 v10, 81920, v6
    v_add_u32 v11, 81920, v7
    v_cvt_pk_bf16_f32 v16, v96, v97
    v_lshlrev_b32 v48, 16, v16
    v_and_b32 v49, 0xffff0000, v16
    v_mul_f32 v50, s72, v48
    v_mul_f32 v51, s72, v49
    v_exp_f32 v50, v50 clamp
    v_exp_f32 v51, v51 clamp
    v_max_f32 v48, 0, v48
    v_max_f32 v49, 0, v49
    v_add_f32 v48, v48, v50
    v_add_f32 v49, v49, v51
    v_min_f32 v56, v48, v49
    v_cvt_pk_bf16_f32 v16, v48, v49
    v_cvt_pk_bf16_f32 v17, v98, v99
    v_lshlrev_b32 v48, 16, v17
    v_and_b32 v49, 0xffff0000, v17
    v_mul_f32 v50, s72, v48
    v_mul_f32 v51, s72, v49
    v_exp_f32 v50, v50 clamp
    v_exp_f32 v51, v51 clamp
    v_max_f32 v48, 0, v48
    v_max_f32 v49, 0, v49
    v_add_f32 v48, v48, v50
    v_add_f32 v49, v49, v51
    v_min3_f32 v56, v48, v49, v56
    v_cvt_pk_bf16_f32 v17, v48, v49
    v_cvt_pk_bf16_f32 v18, v100, v101
    v_lshlrev_b32 v48, 16, v18
    v_and_b32 v49, 0xffff0000, v18
    v_mul_f32 v50, s72, v48
    v_mul_f32 v51, s72, v49
    v_exp_f32 v50, v50 clamp
    v_exp_f32 v51, v51 clamp
    v_max_f32 v48, 0, v48
    v_max_f32 v49, 0, v49
    v_add_f32 v48, v48, v50
    v_add_f32 v49, v49, v51
    v_min3_f32 v56, v48, v49, v56
    v_cvt_pk_bf16_f32 v18, v48, v49
    v_cvt_pk_bf16_f32 v19, v102, v103
    v_lshlrev_b32 v48, 16, v19
    v_and_b32 v49, 0xffff0000, v19
    v_mul_f32 v50, s72, v48
    v_mul_f32 v51, s72, v49
    v_exp_f32 v50, v50 clamp
    v_exp_f32 v51, v51 clamp
    v_max_f32 v48, 0, v48
    v_max_f32 v49, 0, v49
    v_add_f32 v48, v48, v50
    v_add_f32 v49, v49, v51
    v_min3_f32 v56, v48, v49, v56
    v_cvt_pk_bf16_f32 v19, v48, v49
    v_cvt_pk_bf16_f32 v20, v104, v105
    v_lshlrev_b32 v48, 16, v20
    v_and_b32 v49, 0xffff0000, v20
    v_mul_f32 v50, s72, v48
    v_mul_f32 v51, s72, v49
    v_exp_f32 v50, v50 clamp
    v_exp_f32 v51, v51 clamp
    v_max_f32 v48, 0, v48
    v_max_f32 v49, 0, v49
    v_add_f32 v48, v48, v50
    v_add_f32 v49, v49, v51
    v_min3_f32 v56, v48, v49, v56
    v_cvt_pk_bf16_f32 v20, v48, v49
    v_cvt_pk_bf16_f32 v21, v106, v107
    v_lshlrev_b32 v48, 16, v21
    v_and_b32 v49, 0xffff0000, v21
    v_mul_f32 v50, s72, v48
    v_mul_f32 v51, s72, v49
    v_exp_f32 v50, v50 clamp
    v_exp_f32 v51, v51 clamp
    v_max_f32 v48, 0, v48
    v_max_f32 v49, 0, v49
    v_add_f32 v48, v48, v50
    v_add_f32 v49, v49, v51
    v_min3_f32 v56, v48, v49, v56
    v_cvt_pk_bf16_f32 v21, v48, v49
    v_cvt_pk_bf16_f32 v22, v108, v109
    v_lshlrev_b32 v48, 16, v22
    v_and_b32 v49, 0xffff0000, v22
    v_mul_f32 v50, s72, v48
    v_mul_f32 v51, s72, v49
    v_exp_f32 v50, v50 clamp
    v_exp_f32 v51, v51 clamp
    v_max_f32 v48, 0, v48
    v_max_f32 v49, 0, v49
    v_add_f32 v48, v48, v50
    v_add_f32 v49, v49, v51
    v_min3_f32 v56, v48, v49, v56
    v_cvt_pk_bf16_f32 v22, v48, v49
    v_cvt_pk_bf16_f32 v23, v110, v111
    v_lshlrev_b32 v48, 16, v23
    v_and_b32 v49, 0xffff0000, v23
    v_mul_f32 v50, s72, v48
    v_mul_f32 v51, s72, v49
    v_exp_f32 v50, v50 clamp
    v_exp_f32 v51, v51 clamp
    v_max_f32 v48, 0, v48
    v_max_f32 v49, 0, v49
    v_add_f32 v48, v48, v50
    v_add_f32 v49, v49, v51
    v_min3_f32 v56, v48, v49, v56
    v_cvt_pk_bf16_f32 v23, v48, v49
    v_cmp_gt_f32 vcc, 0x3a800000, v56
    s_cbranch_vccnz phi_15_fix
phi_15_done:
    v_cvt_pk_bf16_f32 v32, v128, v129
    v_cvt_pk_bf16_f32 v33, v130, v131
    v_mfma_f32_16x16x32_bf16 v[52:55], v[236:239], v[16:19], 0
    v_cvt_pk_bf16_f32 v34, v132, v133
    v_mfma_f32_16x16x32_bf16 v[60:63], v[236:239], v[20:23], 0
    v_cvt_pk_bf16_f32 v35, v134, v135
    v_cvt_pk_bf16_f32 v36, v136, v137
    v_cvt_pk_bf16_f32 v37, v138, v139
    v_mfma_f32_16x16x32_bf16 v[240:243], v[16:19], v[32:35], 0
    v_cvt_pk_bf16_f32 v38, v140, v141
    v_mfma_f32_16x16x32_bf16 v[244:247], v[20:23], v[32:35], 0
    v_cvt_pk_bf16_f32 v39, v142, v143
    s_nop 1
    v_mfma_f32_16x16x32_bf16 v[248:251], v[16:19], v[36:39], 0
    v_mfma_f32_16x16x32_bf16 v[252:255], v[20:23], v[36:39], 0
    v_cvt_pk_bf16_f32 v24, v112, v113
    v_lshlrev_b32 v48, 16, v24
    v_and_b32 v49, 0xffff0000, v24
    v_mul_f32 v50, s72, v48
    v_mul_f32 v51, s72, v49
    v_exp_f32 v50, v50 clamp
    v_exp_f32 v51, v51 clamp
    v_max_f32 v48, 0, v48
    v_max_f32 v49, 0, v49
    v_add_f32 v48, v48, v50
    v_add_f32 v49, v49, v51
    v_min_f32 v56, v48, v49
    v_cvt_pk_bf16_f32 v24, v48, v49
    v_cvt_pk_bf16_f32 v25, v114, v115
    v_lshlrev_b32 v48, 16, v25
    v_and_b32 v49, 0xffff0000, v25
    v_mul_f32 v50, s72, v48
    v_mul_f32 v51, s72, v49
    v_exp_f32 v50, v50 clamp
    v_exp_f32 v51, v51 clamp
    v_max_f32 v48, 0, v48
    v_max_f32 v49, 0, v49
    v_add_f32 v48, v48, v50
    v_add_f32 v49, v49, v51
    v_min3_f32 v56, v48, v49, v56
    v_cvt_pk_bf16_f32 v25, v48, v49
    v_cvt_pk_bf16_f32 v26, v116, v117
    v_lshlrev_b32 v48, 16, v26
    v_and_b32 v49, 0xffff0000, v26
    v_mul_f32 v50, s72, v48
    v_mul_f32 v51, s72, v49
    v_exp_f32 v50, v50 clamp
    v_exp_f32 v51, v51 clamp
    v_max_f32 v48, 0, v48
    v_max_f32 v49, 0, v49
    v_add_f32 v48, v48, v50
    v_add_f32 v49, v49, v51
    v_min3_f32 v56, v48, v49, v56
    v_cvt_pk_bf16_f32 v26, v48, v49
    v_cvt_pk_bf16_f32 v27, v118, v119
    v_lshlrev_b32 v48, 16, v27
    v_and_b32 v49, 0xffff0000, v27
    v_mul_f32 v50, s72, v48
    v_mul_f32 v51, s72, v49
    v_exp_f32 v50, v50 clamp
    v_exp_f32 v51, v51 clamp
    v_max_f32 v48, 0, v48
    v_max_f32 v49, 0, v49
    v_add_f32 v48, v48, v50
    v_add_f32 v49, v49, v51
    v_min3_f32 v56, v48, v49, v56
    v_cvt_pk_bf16_f32 v27, v48, v49
    v_cvt_pk_bf16_f32 v28, v120, v121
    v_lshlrev_b32 v48, 16, v28
    v_and_b32 v49, 0xffff0000, v28
    v_mul_f32 v50, s72, v48
    v_mul_f32 v51, s72, v49
    v_exp_f32 v50, v50 clamp
    v_exp_f32 v51, v51 clamp
    v_max_f32 v48, 0, v48
    v_max_f32 v49, 0, v49
    v_add_f32 v48, v48, v50
    v_add_f32 v49, v49, v51
    v_min3_f32 v56, v48, v49, v56
    v_cvt_pk_bf16_f32 v28, v48, v49
    v_cvt_pk_bf16_f32 v29, v122, v123
    v_lshlrev_b32 v48, 16, v29
    v_and_b32 v49, 0xffff0000, v29
    v_mul_f32 v50, s72, v48
    v_mul_f32 v51, s72, v49
    v_exp_f32 v50, v50 clamp
    v_exp_f32 v51, v51 clamp
    v_max_f32 v48, 0, v48
    v_max_f32 v49, 0, v49
    v_add_f32 v48, v48, v50
    v_add_f32 v49, v49, v51
    v_min3_f32 v56, v48, v49, v56
    v_cvt_pk_bf16_f32 v29, v48, v49
    v_cvt_pk_bf16_f32 v30, v124, v125
    v_lshlrev_b32 v48, 16, v30
    v_and_b32 v49, 0xffff0000, v30
    v_mul_f32 v50, s72, v48
    v_mul_f32 v51, s72, v49
    v_exp_f32 v50, v50 clamp
    v_exp_f32 v51, v51 clamp
    v_max_f32 v48, 0, v48
    v_max_f32 v49, 0, v49
    v_add_f32 v48, v48, v50
    v_add_f32 v49, v49, v51
    v_min3_f32 v56, v48, v49, v56
    v_cvt_pk_bf16_f32 v30, v48, v49
    v_cvt_pk_bf16_f32 v31, v126, v127
    v_lshlrev_b32 v48, 16, v31
    v_and_b32 v49, 0xffff0000, v31
    v_mul_f32 v50, s72, v48
    v_mul_f32 v51, s72, v49
    v_exp_f32 v50, v50 clamp
    v_exp_f32 v51, v51 clamp
    v_max_f32 v48, 0, v48
    v_max_f32 v49, 0, v49
    v_add_f32 v48, v48, v50
    v_add_f32 v49, v49, v51
    v_min3_f32 v56, v48, v49, v56
    v_cvt_pk_bf16_f32 v31, v48, v49
    v_cmp_gt_f32 vcc, 0x3a800000, v56
    s_cbranch_vccnz phi_16_fix
phi_16_done:
    v_cvt_pk_bf16_f32 v40, v144, v145
    v_cvt_pk_bf16_f32 v41, v146, v147
    v_mfma_f32_16x16x32_bf16 v[52:55], v[236:239], v[24:27], v[52:55]
    v_cvt_pk_bf16_f32 v42, v148, v149
    v_mfma_f32_16x16x32_bf16 v[60:63], v[236:239], v[28:31], v[60:63]
    v_cvt_pk_bf16_f32 v43, v150, v151
    v_cvt_pk_bf16_f32 v44, v152, v153
    v_cvt_pk_bf16_f32 v45, v154, v155
    v_mfma_f32_16x16x32_bf16 v[240:243], v[24:27], v[40:43], v[240:243]
    v_cvt_pk_bf16_f32 v46, v156, v157
    v_mfma_f32_16x16x32_bf16 v[244:247], v[28:31], v[40:43], v[244:247]
    v_cvt_pk_bf16_f32 v47, v158, v159
    s_nop 1
    v_mfma_f32_16x16x32_bf16 v[248:251], v[24:27], v[44:47], v[248:251]
    v_mfma_f32_16x16x32_bf16 v[252:255], v[28:31], v[44:47], v[252:255]
    s_cmp_eq_u32 s6, 0
    s_cbranch_scc0 C_ex1
    ds_write_b32 v227, v60 offset:4608
    s_nop 5
    ds_write_b128 v224, v[248:251] offset:32768
    ds_write_b128 v224, v[252:255] offset:33792
C_ex2:
    ds_write_b32 v229, v231 offset:4288
C_ps:
    ds_read_b32 v25, v230 offset:4288
    ds_read_b128 v[16:19], v225 offset:32768
    ds_read_b128 v[20:23], v225 offset:33792
    ds_read_b32 v24, v228 offset:4608
    s_waitcnt lgkmcnt(0)
    v_cmp_eq_u32 vcc, 0, v25
    s_cbranch_vccnz C_ps
    v_add_f32 v16, v16, v240
    v_add_f32 v17, v17, v241
    v_add_f32 v18, v18, v242
    v_add_f32 v19, v19, v243
    v_add_f32 v20, v20, v244
    v_add_f32 v21, v21, v245
    v_add_f32 v22, v22, v246
    v_add_f32 v23, v23, v247
    v_add_f32 v24, v24, v52
    v_cvt_pk_bf16_f32 v28, v16, v17
    v_cvt_pk_bf16_f32 v29, v18, v19
    v_cvt_pk_bf16_f32 v30, v20, v21
    v_cvt_pk_bf16_f32 v31, v22, v23
    buffer_store_dwordx4 v[28:31], v3, s[16:19], s43 offen sc0 sc1
    s_mov_b64 exec, 0xffff
    buffer_store_dword v24, v232, s[16:19], s43 offen offset:1024 sc0 sc1
    s_mov_b64 exec, 1
    buffer_atomic_or v233, v234, s[16:19], 0 offen
    s_mov_b64 exec, -1
    ds_read_b64_tr_b16 v[96:97], v10 offset:0
    ds_read_b64_tr_b16 v[98:99], v10 offset:512
    ds_read_b64_tr_b16 v[100:101], v11 offset:0
    ds_read_b64_tr_b16 v[102:103], v11 offset:512
    ds_read_b64_tr_b16 v[104:105], v10 offset:4096
    ds_read_b64_tr_b16 v[106:107], v10 offset:4608
    ds_read_b64_tr_b16 v[108:109], v11 offset:4096
    ds_read_b64_tr_b16 v[110:111], v11 offset:4608
    ds_read_b64_tr_b16 v[112:113], v6 offset:0
    ds_read_b64_tr_b16 v[114:115], v6 offset:512
    ds_read_b64_tr_b16 v[116:117], v7 offset:0
    ds_read_b64_tr_b16 v[118:119], v7 offset:512
    ds_read_b64_tr_b16 v[120:121], v6 offset:4096
    ds_read_b64_tr_b16 v[122:123], v6 offset:4608
    ds_read_b64_tr_b16 v[124:125], v7 offset:4096
    ds_read_b64_tr_b16 v[126:127], v7 offset:4608
    s_waitcnt lgkmcnt(12)
    v_mfma_f32_16x16x32_bf16 v[64:67], v[96:99], v[192:195], v[64:67]
    v_mfma_f32_16x16x32_bf16 v[72:75], v[96:99], v[196:199], v[72:75]
    v_mfma_f32_16x16x32_bf16 v[80:83], v[96:99], v[200:203], v[80:83]
    v_mfma_f32_16x16x32_bf16 v[88:91], v[96:99], v[204:207], v[88:91]
    v_mfma_f32_16x16x32_bf16 v[68:71], v[100:103], v[192:195], v[68:71]
    v_mfma_f32_16x16x32_bf16 v[76:79], v[100:103], v[196:199], v[76:79]
    v_mfma_f32_16x16x32_bf16 v[84:87], v[100:103], v[200:203], v[84:87]
    v_mfma_f32_16x16x32_bf16 v[92:95], v[100:103], v[204:207], v[92:95]
    s_waitcnt lgkmcnt(8)
    v_mfma_f32_16x16x32_bf16 v[64:67], v[104:107], v[160:163], v[64:67]
    v_mfma_f32_16x16x32_bf16 v[72:75], v[104:107], v[164:167], v[72:75]
    v_mfma_f32_16x16x32_bf16 v[80:83], v[104:107], v[168:171], v[80:83]
    v_mfma_f32_16x16x32_bf16 v[88:91], v[104:107], v[172:175], v[88:91]
    v_mfma_f32_16x16x32_bf16 v[68:71], v[108:111], v[160:163], v[68:71]
    v_mfma_f32_16x16x32_bf16 v[76:79], v[108:111], v[164:167], v[76:79]
    v_mfma_f32_16x16x32_bf16 v[84:87], v[108:111], v[168:171], v[84:87]
    v_mfma_f32_16x16x32_bf16 v[92:95], v[108:111], v[172:175], v[92:95]
    s_waitcnt lgkmcnt(4)
    v_mfma_f32_16x16x32_bf16 v[64:67], v[112:115], v[176:179], v[64:67]
    v_mfma_f32_16x16x32_bf16 v[72:75], v[112:115], v[180:183], v[72:75]
    v_mfma_f32_16x16x32_bf16 v[80:83], v[112:115], v[184:187], v[80:83]
    v_mfma_f32_16x16x32_bf16 v[88:91], v[112:115], v[188:191], v[88:91]
    v_mfma_f32_16x16x32_bf16 v[68:71], v[116:119], v[176:179], v[68:71]
    v_mfma_f32_16x16x32_bf16 v[76:79], v[116:119], v[180:183], v[76:79]
    v_mfma_f32_16x16x32_bf16 v[84:87], v[116:119], v[184:187], v[84:87]
    v_mfma_f32_16x16x32_bf16 v[92:95], v[116:119], v[188:191], v[92:95]
    s_waitcnt lgkmcnt(0)
    v_mfma_f32_16x16x32_bf16 v[64:67], v[120:123], v[208:211], v[64:67]
    v_mfma_f32_16x16x32_bf16 v[72:75], v[120:123], v[212:215], v[72:75]
    v_mfma_f32_16x16x32_bf16 v[80:83], v[120:123], v[216:219], v[80:83]
    v_mfma_f32_16x16x32_bf16 v[88:91], v[120:123], v[220:223], v[88:91]
    v_mfma_f32_16x16x32_bf16 v[68:71], v[124:127], v[208:211], v[68:71]
    v_mfma_f32_16x16x32_bf16 v[76:79], v[124:127], v[212:215], v[76:79]
    v_mfma_f32_16x16x32_bf16 v[84:87], v[124:127], v[216:219], v[84:87]
    v_mfma_f32_16x16x32_bf16 v[92:95], v[124:127], v[220:223], v[92:95]
    s_and_b32 s64, s3, 3
    s_lshl_b32 s64, s64, 1
    s_lshr_b32 s65, s3, 2
    s_add_u32 s64, s64, s65
    s_lshl_b32 s64, s64, 4
    s_lshl_b32 s65, s4, 7
    s_add_u32 s64, s64, s65
    v_and_b32 v230, 15, v2
    v_add_u32 v230, s64, v230
    v_bfe_u32 v3, v2, 4, 1
    v_lshlrev_b32 v229, 5, v3
    v_lshrrev_b32 v3, 5, v2
    v_lshl_add_u32 v229, v3, 4, v229
    v_lshl_add_u32 v231, v230, 11, v229
    s_lshl_b32 s64, s5, 7
    v_add_u32 v231, s64, v231
    v_lshlrev_b32 v3, 2, v230
    v_add_u32 v3, 6709248, v3
    buffer_load_dwordx4 v[220:223], v231, s[8:11], 0 offen
    buffer_load_dwordx4 v[224:227], v231, s[8:11], 0 offen offset:64
    buffer_load_dword v228, v3, s[16:19], 0 offen sc1
    v_lshlrev_b32 v3, 4, v2
    s_lshl_b32 s64, s7, 11
    v_add_u32 v4, s64, v3
    v_lshrrev_b32 v5, 4, v2
    v_lshlrev_b32 v5, 4, v5
    s_lshl_b32 s64, s7, 6
    v_add_u32 v5, s64, v5
    v_mov_b32 v6, 4256
    ds_read_b32 v6, v6
    v_cvt_pk_bf16_f32 v32, v64, v65
    v_lshlrev_b32 v48, 16, v32
    v_and_b32 v49, 0xffff0000, v32
    v_mul_f32 v50, s72, v48
    v_mul_f32 v51, s72, v49
    v_exp_f32 v50, v50 clamp
    v_exp_f32 v51, v51 clamp
    v_max_f32 v48, 0, v48
    v_max_f32 v49, 0, v49
    v_add_f32 v48, v48, v50
    v_add_f32 v49, v49, v51
    v_min_f32 v56, v48, v49
    v_cvt_pk_bf16_f32 v32, v48, v49
    v_cvt_pk_bf16_f32 v33, v66, v67
    v_lshlrev_b32 v48, 16, v33
    v_and_b32 v49, 0xffff0000, v33
    v_mul_f32 v50, s72, v48
    v_mul_f32 v51, s72, v49
    v_exp_f32 v50, v50 clamp
    v_exp_f32 v51, v51 clamp
    v_max_f32 v48, 0, v48
    v_max_f32 v49, 0, v49
    v_add_f32 v48, v48, v50
    v_add_f32 v49, v49, v51
    v_min3_f32 v56, v48, v49, v56
    v_cvt_pk_bf16_f32 v33, v48, v49
    v_cvt_pk_bf16_f32 v34, v68, v69
    v_lshlrev_b32 v48, 16, v34
    v_and_b32 v49, 0xffff0000, v34
    v_mul_f32 v50, s72, v48
    v_mul_f32 v51, s72, v49
    v_exp_f32 v50, v50 clamp
    v_exp_f32 v51, v51 clamp
    v_max_f32 v48, 0, v48
    v_max_f32 v49, 0, v49
    v_add_f32 v48, v48, v50
    v_add_f32 v49, v49, v51
    v_min3_f32 v56, v48, v49, v56
    v_cvt_pk_bf16_f32 v34, v48, v49
    v_cvt_pk_bf16_f32 v35, v70, v71
    v_lshlrev_b32 v48, 16, v35
    v_and_b32 v49, 0xffff0000, v35
    v_mul_f32 v50, s72, v48
    v_mul_f32 v51, s72, v49
    v_exp_f32 v50, v50 clamp
    v_exp_f32 v51, v51 clamp
    v_max_f32 v48, 0, v48
    v_max_f32 v49, 0, v49
    v_add_f32 v48, v48, v50
    v_add_f32 v49, v49, v51
    v_min3_f32 v56, v48, v49, v56
    v_cvt_pk_bf16_f32 v35, v48, v49
    v_cvt_pk_bf16_f32 v36, v72, v73
    v_lshlrev_b32 v48, 16, v36
    v_and_b32 v49, 0xffff0000, v36
    v_mul_f32 v50, s72, v48
    v_mul_f32 v51, s72, v49
    v_exp_f32 v50, v50 clamp
    v_exp_f32 v51, v51 clamp
    v_max_f32 v48, 0, v48
    v_max_f32 v49, 0, v49
    v_add_f32 v48, v48, v50
    v_add_f32 v49, v49, v51
    v_min3_f32 v56, v48, v49, v56
    v_cvt_pk_bf16_f32 v36, v48, v49
    v_cvt_pk_bf16_f32 v37, v74, v75
    v_lshlrev_b32 v48, 16, v37
    v_and_b32 v49, 0xffff0000, v37
    v_mul_f32 v50, s72, v48
    v_mul_f32 v51, s72, v49
    v_exp_f32 v50, v50 clamp
    v_exp_f32 v51, v51 clamp
    v_max_f32 v48, 0, v48
    v_max_f32 v49, 0, v49
    v_add_f32 v48, v48, v50
    v_add_f32 v49, v49, v51
    v_min3_f32 v56, v48, v49, v56
    v_cvt_pk_bf16_f32 v37, v48, v49
    v_cvt_pk_bf16_f32 v38, v76, v77
    v_lshlrev_b32 v48, 16, v38
    v_and_b32 v49, 0xffff0000, v38
    v_mul_f32 v50, s72, v48
    v_mul_f32 v51, s72, v49
    v_exp_f32 v50, v50 clamp
    v_exp_f32 v51, v51 clamp
    v_max_f32 v48, 0, v48
    v_max_f32 v49, 0, v49
    v_add_f32 v48, v48, v50
    v_add_f32 v49, v49, v51
    v_min3_f32 v56, v48, v49, v56
    v_cvt_pk_bf16_f32 v38, v48, v49
    v_cvt_pk_bf16_f32 v39, v78, v79
    v_lshlrev_b32 v48, 16, v39
    v_and_b32 v49, 0xffff0000, v39
    v_mul_f32 v50, s72, v48
    v_mul_f32 v51, s72, v49
    v_exp_f32 v50, v50 clamp
    v_exp_f32 v51, v51 clamp
    v_max_f32 v48, 0, v48
    v_max_f32 v49, 0, v49
    v_add_f32 v48, v48, v50
    v_add_f32 v49, v49, v51
    v_min3_f32 v56, v48, v49, v56
    v_cvt_pk_bf16_f32 v39, v48, v49
    v_cmp_gt_f32 vcc, 0x3a800000, v56
    s_cbranch_vccnz phi_17_fix
phi_17_done:
    v_cvt_pk_bf16_f32 v40, v80, v81
    v_lshlrev_b32 v48, 16, v40
    v_and_b32 v49, 0xffff0000, v40
    v_mul_f32 v50, s72, v48
    v_mul_f32 v51, s72, v49
    v_exp_f32 v50, v50 clamp
    v_exp_f32 v51, v51 clamp
    v_max_f32 v48, 0, v48
    v_max_f32 v49, 0, v49
    v_add_f32 v48, v48, v50
    v_add_f32 v49, v49, v51
    v_min_f32 v56, v48, v49
    v_cvt_pk_bf16_f32 v40, v48, v49
    v_cvt_pk_bf16_f32 v41, v82, v83
    v_lshlrev_b32 v48, 16, v41
    v_and_b32 v49, 0xffff0000, v41
    v_mul_f32 v50, s72, v48
    v_mul_f32 v51, s72, v49
    v_exp_f32 v50, v50 clamp
    v_exp_f32 v51, v51 clamp
    v_max_f32 v48, 0, v48
    v_max_f32 v49, 0, v49
    v_add_f32 v48, v48, v50
    v_add_f32 v49, v49, v51
    v_min3_f32 v56, v48, v49, v56
    v_cvt_pk_bf16_f32 v41, v48, v49
    v_cvt_pk_bf16_f32 v42, v84, v85
    v_lshlrev_b32 v48, 16, v42
    v_and_b32 v49, 0xffff0000, v42
    v_mul_f32 v50, s72, v48
    v_mul_f32 v51, s72, v49
    v_exp_f32 v50, v50 clamp
    v_exp_f32 v51, v51 clamp
    v_max_f32 v48, 0, v48
    v_max_f32 v49, 0, v49
    v_add_f32 v48, v48, v50
    v_add_f32 v49, v49, v51
    v_min3_f32 v56, v48, v49, v56
    v_cvt_pk_bf16_f32 v42, v48, v49
    v_cvt_pk_bf16_f32 v43, v86, v87
    v_lshlrev_b32 v48, 16, v43
    v_and_b32 v49, 0xffff0000, v43
    v_mul_f32 v50, s72, v48
    v_mul_f32 v51, s72, v49
    v_exp_f32 v50, v50 clamp
    v_exp_f32 v51, v51 clamp
    v_max_f32 v48, 0, v48
    v_max_f32 v49, 0, v49
    v_add_f32 v48, v48, v50
    v_add_f32 v49, v49, v51
    v_min3_f32 v56, v48, v49, v56
    v_cvt_pk_bf16_f32 v43, v48, v49
    v_cvt_pk_bf16_f32 v44, v88, v89
    v_lshlrev_b32 v48, 16, v44
    v_and_b32 v49, 0xffff0000, v44
    v_mul_f32 v50, s72, v48
    v_mul_f32 v51, s72, v49
    v_exp_f32 v50, v50 clamp
    v_exp_f32 v51, v51 clamp
    v_max_f32 v48, 0, v48
    v_max_f32 v49, 0, v49
    v_add_f32 v48, v48, v50
    v_add_f32 v49, v49, v51
    v_min3_f32 v56, v48, v49, v56
    v_cvt_pk_bf16_f32 v44, v48, v49
    v_cvt_pk_bf16_f32 v45, v90, v91
    v_lshlrev_b32 v48, 16, v45
    v_and_b32 v49, 0xffff0000, v45
    v_mul_f32 v50, s72, v48
    v_mul_f32 v51, s72, v49
    v_exp_f32 v50, v50 clamp
    v_exp_f32 v51, v51 clamp
    v_max_f32 v48, 0, v48
    v_max_f32 v49, 0, v49
    v_add_f32 v48, v48, v50
    v_add_f32 v49, v49, v51
    v_min3_f32 v56, v48, v49, v56
    v_cvt_pk_bf16_f32 v45, v48, v49
    v_cvt_pk_bf16_f32 v46, v92, v93
    v_lshlrev_b32 v48, 16, v46
    v_and_b32 v49, 0xffff0000, v46
    v_mul_f32 v50, s72, v48
    v_mul_f32 v51, s72, v49
    v_exp_f32 v50, v50 clamp
    v_exp_f32 v51, v51 clamp
    v_max_f32 v48, 0, v48
    v_max_f32 v49, 0, v49
    v_add_f32 v48, v48, v50
    v_add_f32 v49, v49, v51
    v_min3_f32 v56, v48, v49, v56
    v_cvt_pk_bf16_f32 v46, v48, v49
    v_cvt_pk_bf16_f32 v47, v94, v95
    v_lshlrev_b32 v48, 16, v47
    v_and_b32 v49, 0xffff0000, v47
    v_mul_f32 v50, s72, v48
    v_mul_f32 v51, s72, v49
    v_exp_f32 v50, v50 clamp
    v_exp_f32 v51, v51 clamp
    v_max_f32 v48, 0, v48
    v_max_f32 v49, 0, v49
    v_add_f32 v48, v48, v50
    v_add_f32 v49, v49, v51
    v_min3_f32 v56, v48, v49, v56
    v_cvt_pk_bf16_f32 v47, v48, v49
    v_cmp_gt_f32 vcc, 0x3a800000, v56
    s_cbranch_vccnz phi_18_fix
phi_18_done:
    s_waitcnt lgkmcnt(0)
    v_readfirstlane_b32 s75, v6
    s_waitcnt vmcnt(0)
    v_sub_f32 v248, 1.0, v228
    v_cvt_pk_bf16_f32 v248, v248, v248
    v_lshlrev_b32 v248, 16, v248
    v_lshlrev_b32 v232, 16, v220
    v_and_b32 v233, 0xffff0000, v220
    v_mul_f32 v232, v232, v248
    v_mul_f32 v233, v233, v248
    v_cvt_pk_bf16_f32 v3, v232, v233
    v_lshlrev_b32 v232, 16, v3
    v_and_b32 v233, 0xffff0000, v3
    v_lshlrev_b32 v234, 16, v221
    v_and_b32 v235, 0xffff0000, v221
    v_mul_f32 v234, v234, v248
    v_mul_f32 v235, v235, v248
    v_cvt_pk_bf16_f32 v3, v234, v235
    v_lshlrev_b32 v234, 16, v3
    v_and_b32 v235, 0xffff0000, v3
    v_lshlrev_b32 v236, 16, v222
    v_and_b32 v237, 0xffff0000, v222
    v_mul_f32 v236, v236, v248
    v_mul_f32 v237, v237, v248
    v_cvt_pk_bf16_f32 v3, v236, v237
    v_lshlrev_b32 v236, 16, v3
    v_and_b32 v237, 0xffff0000, v3
    v_lshlrev_b32 v238, 16, v223
    v_and_b32 v239, 0xffff0000, v223
    v_mul_f32 v238, v238, v248
    v_mul_f32 v239, v239, v248
    v_cvt_pk_bf16_f32 v3, v238, v239
    v_lshlrev_b32 v238, 16, v3
    v_and_b32 v239, 0xffff0000, v3
    v_lshlrev_b32 v240, 16, v224
    v_and_b32 v241, 0xffff0000, v224
    v_mul_f32 v240, v240, v248
    v_mul_f32 v241, v241, v248
    v_cvt_pk_bf16_f32 v3, v240, v241
    v_lshlrev_b32 v240, 16, v3
    v_and_b32 v241, 0xffff0000, v3
    v_lshlrev_b32 v242, 16, v225
    v_and_b32 v243, 0xffff0000, v225
    v_mul_f32 v242, v242, v248
    v_mul_f32 v243, v243, v248
    v_cvt_pk_bf16_f32 v3, v242, v243
    v_lshlrev_b32 v242, 16, v3
    v_and_b32 v243, 0xffff0000, v3
    v_lshlrev_b32 v244, 16, v226
    v_and_b32 v245, 0xffff0000, v226
    v_mul_f32 v244, v244, v248
    v_mul_f32 v245, v245, v248
    v_cvt_pk_bf16_f32 v3, v244, v245
    v_lshlrev_b32 v244, 16, v3
    v_and_b32 v245, 0xffff0000, v3
    v_lshlrev_b32 v246, 16, v227
    v_and_b32 v247, 0xffff0000, v227
    v_mul_f32 v246, v246, v248
    v_mul_f32 v247, v247, v248
    v_cvt_pk_bf16_f32 v3, v246, v247
    v_lshlrev_b32 v246, 16, v3
    v_and_b32 v247, 0xffff0000, v3
    s_cmp_lg_u32 s3, 0
    s_cbranch_scc1 C_nh
    s_lshr_b32 s64, s2, 2
    s_lshl_b32 s64, s64, 14
    s_add_u32 s64, s64, 5398528
    v_lshl_add_u32 v16, v2, 4, s64
    v_lshrrev_b32 v8, 4, v2
    s_mov_b32 s65, 0
H_hl:
    s_mov_b32 s64, 0
    buffer_load_dwordx4 v[64:67], v16, s[16:19], s64 offen offset:0 sc1
    s_mov_b32 s64, 0
    buffer_load_dwordx4 v[68:71], v16, s[16:19], s64 offen offset:1024 sc1
    s_mov_b32 s64, 0
    buffer_load_dwordx4 v[72:75], v16, s[16:19], s64 offen offset:2048 sc1
    s_mov_b32 s64, 0
    buffer_load_dwordx4 v[76:79], v16, s[16:19], s64 offen offset:3072 sc1
    s_mov_b32 s64, 4096
    buffer_load_dwordx4 v[80:83], v16, s[16:19], s64 offen offset:0 sc1
    s_mov_b32 s64, 4096
    buffer_load_dwordx4 v[84:87], v16, s[16:19], s64 offen offset:1024 sc1
    s_mov_b32 s64, 4096
    buffer_load_dwordx4 v[88:91], v16, s[16:19], s64 offen offset:2048 sc1
    s_mov_b32 s64, 4096
    buffer_load_dwordx4 v[92:95], v16, s[16:19], s64 offen offset:3072 sc1
    s_mov_b32 s64, 8192
    buffer_load_dwordx4 v[96:99], v16, s[16:19], s64 offen offset:0 sc1
    s_mov_b32 s64, 8192
    buffer_load_dwordx4 v[100:103], v16, s[16:19], s64 offen offset:1024 sc1
    s_mov_b32 s64, 8192
    buffer_load_dwordx4 v[104:107], v16, s[16:19], s64 offen offset:2048 sc1
    s_mov_b32 s64, 8192
    buffer_load_dwordx4 v[108:111], v16, s[16:19], s64 offen offset:3072 sc1
    s_mov_b32 s64, 12288
    buffer_load_dwordx4 v[112:115], v16, s[16:19], s64 offen offset:0 sc1
    s_mov_b32 s64, 12288
    buffer_load_dwordx4 v[116:119], v16, s[16:19], s64 offen offset:1024 sc1
    s_mov_b32 s64, 12288
    buffer_load_dwordx4 v[120:123], v16, s[16:19], s64 offen offset:2048 sc1
    s_mov_b32 s64, 12288
    buffer_load_dwordx4 v[124:127], v16, s[16:19], s64 offen offset:3072 sc1
    s_waitcnt vmcnt(0)
    v_max3_u32 v17, v64, v65, v66
    v_max3_u32 v17, v67, v68, v17
    v_max3_u32 v17, v69, v70, v17
    v_max3_u32 v17, v71, v72, v17
    v_max3_u32 v17, v73, v74, v17
    v_max3_u32 v17, v75, v76, v17
    v_max3_u32 v17, v77, v78, v17
    v_max3_u32 v17, v79, v80, v17
    v_max3_u32 v17, v81, v82, v17
    v_max3_u32 v17, v83, v84, v17
    v_max3_u32 v17, v85, v86, v17
    v_max3_u32 v17, v87, v88, v17
    v_max3_u32 v17, v89, v90, v17
    v_max3_u32 v17, v91, v92, v17
    v_max3_u32 v17, v93, v94, v17
    v_max3_u32 v17, v95, v96, v17
    v_max3_u32 v17, v97, v98, v17
    v_max3_u32 v17, v99, v100, v17
    v_max3_u32 v17, v101, v102, v17
    v_max3_u32 v17, v103, v104, v17
    v_max3_u32 v17, v105, v106, v17
    v_max3_u32 v17, v107, v108, v17
    v_max3_u32 v17, v109, v110, v17
    v_max3_u32 v17, v111, v112, v17
    v_max3_u32 v17, v113, v114, v17
    v_max3_u32 v17, v115, v116, v17
    v_max3_u32 v17, v117, v118, v17
    v_max3_u32 v17, v119, v120, v17
    v_max3_u32 v17, v121, v122, v17
    v_max3_u32 v17, v123, v124, v17
    v_max3_u32 v17, v125, v126, v17
    v_max_u32 v17, v127, v17
    s_mov_b32 exec_lo, 0x3fff3fff
    s_mov_b32 exec_hi, 0x3fff3fff
    v_cmp_eq_u32 vcc, -1, v17
    s_mov_b64 exec, -1
    s_cbranch_vccz H_hok
    s_add_u32 s65, s65, 1
    s_cmp_ge_u32 s65, 100000
    s_cbranch_scc1 H_hok
    s_sleep 8
    s_branch H_hl
H_hok:
    v_add_f32 v64, v64, v68
    v_add_f32 v65, v65, v69
    v_add_f32 v66, v66, v70
    v_add_f32 v67, v67, v71
    v_add_f32 v64, v64, v72
    v_add_f32 v65, v65, v73
    v_add_f32 v66, v66, v74
    v_add_f32 v67, v67, v75
    v_add_f32 v64, v64, v76
    v_add_f32 v65, v65, v77
    v_add_f32 v66, v66, v78
    v_add_f32 v67, v67, v79
    v_add_f32 v64, v64, v80
    v_add_f32 v65, v65, v81
    v_add_f32 v66, v66, v82
    v_add_f32 v67, v67, v83
    v_add_f32 v64, v64, v84
    v_add_f32 v65, v65, v85
    v_add_f32 v66, v66, v86
    v_add_f32 v67, v67, v87
    v_add_f32 v64, v64, v88
    v_add_f32 v65, v65, v89
    v_add_f32 v66, v66, v90
    v_add_f32 v67, v67, v91
    v_add_f32 v64, v64, v92
    v_add_f32 v65, v65, v93
    v_add_f32 v66, v66, v94
    v_add_f32 v67, v67, v95
    v_add_f32 v96, v96, v100
    v_add_f32 v97, v97, v101
    v_add_f32 v98, v98, v102
    v_add_f32 v99, v99, v103
    v_add_f32 v96, v96, v104
    v_add_f32 v97, v97, v105
    v_add_f32 v98, v98, v106
    v_add_f32 v99, v99, v107
    v_add_f32 v96, v96, v108
    v_add_f32 v97, v97, v109
    v_add_f32 v98, v98, v110
    v_add_f32 v99, v99, v111
    v_add_f32 v96, v96, v112
    v_add_f32 v97, v97, v113
    v_add_f32 v98, v98, v114
    v_add_f32 v99, v99, v115
    v_add_f32 v96, v96, v116
    v_add_f32 v97, v97, v117
    v_add_f32 v98, v98, v118
    v_add_f32 v99, v99, v119
    v_add_f32 v96, v96, v120
    v_add_f32 v97, v97, v121
    v_add_f32 v98, v98, v122
    v_add_f32 v99, v99, v123
    v_add_f32 v96, v96, v124
    v_add_f32 v97, v97, v125
    v_add_f32 v98, v98, v126
    v_add_f32 v99, v99, v127
    s_nop 1
    v_permlane16_swap_b32 v64, v96
    v_permlane16_swap_b32 v65, v97
    v_permlane16_swap_b32 v66, v98
    v_permlane16_swap_b32 v67, v99
    v_add_f32 v64, v64, v96
    v_add_f32 v65, v65, v97
    v_add_f32 v66, v66, v98
    v_add_f32 v67, v67, v99
    s_nop 1
    v_permlane32_swap_b32 v64, v66
    v_permlane32_swap_b32 v65, v67
    v_add_f32 v64, v64, v66
    v_add_f32 v65, v65, v67
    s_nop 1
    v_permlane16_swap_b32 v64, v65
    v_cvt_pk_bf16_f32 v66, v64, v65
    v_lshlrev_b32 v64, 16, v66
    v_and_b32 v65, 0xffff0000, v66
    v_mul_f32 v66, s72, v64
    v_exp_f32 v66, -v66
    v_and_b32 v16, 15, v2
    v_add_f32 v66, 1.0, v66
    v_rcp_f32 v66, v66
    v_lshl_add_u32 v16, v16, 2, v8
    v_mul_f32 v66, v66, v64
    v_cvt_pk_bf16_f32 v66, v66, v66
    v_lshlrev_b32 v66, 16, v66
    v_mul_f32 v66, v66, v65
    v_cvt_pk_bf16_f32 v66, v66, v66
    v_lshlrev_b32 v66, 16, v66
    v_lshlrev_b32 v16, 2, v16
    ds_write_b32 v16, v66 offset:4352
    s_waitcnt lgkmcnt(0)
C_nh:
    v_lshlrev_b32 v3, 4, v2
    s_barrier
    ds_read_b128 v[24:27], v5 offset:4096
    ds_read_b128 v[16:19], v4 offset:0
    ds_read_b128 v[20:23], v4 offset:1024
    s_waitcnt lgkmcnt(2)
    v_mfma_f32_16x16x32_bf16 v[96:99], v[24:27], v[32:35], 0
    v_mfma_f32_16x16x32_bf16 v[100:103], v[24:27], v[36:39], 0
    v_mfma_f32_16x16x32_bf16 v[104:107], v[24:27], v[40:43], 0
    v_mfma_f32_16x16x32_bf16 v[108:111], v[24:27], v[44:47], 0
    s_waitcnt lgkmcnt(0)
    v_mfma_f32_16x16x32_bf16 v[64:67], v[16:19], v[32:35], 0
    v_mfma_f32_16x16x32_bf16 v[68:71], v[20:23], v[32:35], 0
    v_mfma_f32_16x16x32_bf16 v[72:75], v[16:19], v[36:39], 0
    v_mfma_f32_16x16x32_bf16 v[76:79], v[20:23], v[36:39], 0
    v_mfma_f32_16x16x32_bf16 v[80:83], v[16:19], v[40:43], 0
    v_mfma_f32_16x16x32_bf16 v[84:87], v[20:23], v[40:43], 0
    v_mfma_f32_16x16x32_bf16 v[88:91], v[16:19], v[44:47], 0
    v_mfma_f32_16x16x32_bf16 v[92:95], v[20:23], v[44:47], 0
    v_cvt_pk_bf16_f32 v48, v96, v96
    v_cvt_pk_bf16_f32 v49, v100, v100
    v_cvt_pk_bf16_f32 v50, v104, v104
    v_cvt_pk_bf16_f32 v51, v108, v108
    v_lshlrev_b32 v48, 16, v48
    v_lshlrev_b32 v49, 16, v49
    v_lshlrev_b32 v50, 16, v50
    v_lshlrev_b32 v51, 16, v51
    v_add_f32 v48, s73, v48
    v_add_f32 v49, s73, v49
    v_add_f32 v50, s73, v50
    v_add_f32 v51, s73, v51
    v_cvt_pk_bf16_f32 v48, v48, v48
    v_cvt_pk_bf16_f32 v49, v49, v49
    v_cvt_pk_bf16_f32 v50, v50, v50
    v_cvt_pk_bf16_f32 v51, v51, v51
    v_lshlrev_b32 v48, 16, v48
    v_lshlrev_b32 v49, 16, v49
    v_lshlrev_b32 v50, 16, v50
    v_lshlrev_b32 v51, 16, v51
    v_rcp_f32 v48, v48
    v_rcp_f32 v49, v49
    v_rcp_f32 v50, v50
    v_rcp_f32 v51, v51
    s_nop 0
    v_mul_f32 v64, v64, v48
    v_mul_f32 v65, v65, v48
    v_cvt_pk_bf16_f32 v128, v64, v65
    v_mul_f32 v66, v66, v48
    v_mul_f32 v67, v67, v48
    v_cvt_pk_bf16_f32 v129, v66, v67
    v_mul_f32 v68, v68, v48
    v_mul_f32 v69, v69, v48
    v_cvt_pk_bf16_f32 v130, v68, v69
    v_mul_f32 v70, v70, v48
    v_mul_f32 v71, v71, v48
    v_cvt_pk_bf16_f32 v131, v70, v71
    buffer_store_dwordx4 v[128:131], v3, s[16:19], s42 offen offset:0 sc0 sc1
    v_mul_f32 v72, v72, v49
    v_mul_f32 v73, v73, v49
    v_cvt_pk_bf16_f32 v132, v72, v73
    v_mul_f32 v74, v74, v49
    v_mul_f32 v75, v75, v49
    v_cvt_pk_bf16_f32 v133, v74, v75
    v_mul_f32 v76, v76, v49
    v_mul_f32 v77, v77, v49
    v_cvt_pk_bf16_f32 v134, v76, v77
    v_mul_f32 v78, v78, v49
    v_mul_f32 v79, v79, v49
    v_cvt_pk_bf16_f32 v135, v78, v79
    buffer_store_dwordx4 v[132:135], v3, s[16:19], s42 offen offset:1024 sc0 sc1
    s_add_u32 s42, s42, 65536
    v_mul_f32 v80, v80, v50
    v_mul_f32 v81, v81, v50
    v_cvt_pk_bf16_f32 v136, v80, v81
    v_mul_f32 v82, v82, v50
    v_mul_f32 v83, v83, v50
    v_cvt_pk_bf16_f32 v137, v82, v83
    v_mul_f32 v84, v84, v50
    v_mul_f32 v85, v85, v50
    v_cvt_pk_bf16_f32 v138, v84, v85
    v_mul_f32 v86, v86, v50
    v_mul_f32 v87, v87, v50
    v_cvt_pk_bf16_f32 v139, v86, v87
    buffer_store_dwordx4 v[136:139], v3, s[16:19], s42 offen offset:0 sc0 sc1
    v_mul_f32 v88, v88, v51
    v_mul_f32 v89, v89, v51
    v_cvt_pk_bf16_f32 v140, v88, v89
    v_mul_f32 v90, v90, v51
    v_mul_f32 v91, v91, v51
    v_cvt_pk_bf16_f32 v141, v90, v91
    v_mul_f32 v92, v92, v51
    v_mul_f32 v93, v93, v51
    v_cvt_pk_bf16_f32 v142, v92, v93
    v_mul_f32 v94, v94, v51
    v_mul_f32 v95, v95, v51
    v_cvt_pk_bf16_f32 v143, v94, v95
    buffer_store_dwordx4 v[140:143], v3, s[16:19], s42 offen offset:1024 sc0 sc1
    s_lshl_b32 s64, s4, 3
    s_add_u32 s64, s64, s3
    s_lshl_b32 s64, s64, 7
    s_add_u32 s64, s64, 5382144
    v_mov_b32 v14, s64
    s_mov_b64 exec, 1
    v_mov_b32 v15, 0
    buffer_atomic_or v15, v14, s[16:19], 0 offen sc0
    s_mov_b64 exec, -1
    s_waitcnt vmcnt(1)
    s_mov_b64 exec, 3
    buffer_atomic_or v13, v12, s[16:19], 0 offen
    s_mov_b64 exec, -1
P2_start:
    s_and_b32 s6, s3, 3
    s_lshr_b32 s7, s3, 2
    s_mov_b32 s20, s58
    s_mov_b32 s21, s59
    s_mov_b32 s22, 0x400000
    s_mov_b32 s23, 0x00020000
    s_and_b32 s67, s75, 0x7ff
    s_sub_u32 s67, 2047, s67
    s_lshl_b32 s64, s4, 2
    s_add_u32 s64, s64, s6
    s_lshl_b32 s64, s64, 16
    s_lshl_b32 s65, s7, 15
    s_add_u32 s64, s64, s65
    s_lshl_b32 s65, s7, 10
    s_add_u32 s66, s64, s65
    s_sub_u32 s64, s64, s65
    v_lshl_add_u32 v4, v2, 4, s66
    v_lshl_add_u32 v12, v2, 4, s64
    v_lshrrev_b32 v10, 4, v2
    v_bfe_u32 v11, v2, 2, 2
    v_lshl_add_u32 v10, v10, 2, v11
    v_bfe_u32 v13, v10, 1, 2
    v_lshlrev_b32 v10, 7, v10
    v_lshl_add_u32 v10, v13, 5, v10
    v_and_b32 v13, 3, v2
    v_lshl_add_u32 v5, v13, 3, v10
    v_xor_b32 v6, 32, v5
    v_xor_b32 v1, 64, v5
    v_xor_b32 v3, 96, v5
    s_lshl_b32 s74, s74, 1
    s_cmp_eq_u32 s7, 0
    s_mov_b32 s64, 147456
    s_cselect_b32 s64, 131072, s64
    s_sub_u32 m0, 16, s74
    s_and_b32 m0, m0, 15
    v_writelane_b32 v7, s64, m0
    s_cmp_eq_u32 s7, 0
    s_mov_b32 s64, 155648
    s_cselect_b32 s64, 139264, s64
    s_sub_u32 m0, 18, s74
    s_and_b32 m0, m0, 15
    v_writelane_b32 v7, s64, m0
    s_cmp_eq_u32 s7, 0
    s_mov_b32 s64, 81920
    s_cselect_b32 s64, 73728, s64
    s_sub_u32 m0, 20, s74
    s_and_b32 m0, m0, 15
    v_writelane_b32 v7, s64, m0
    s_cmp_eq_u32 s7, 0
    s_mov_b32 s64, 122880
    s_cselect_b32 s64, 114688, s64
    s_sub_u32 m0, 22, s74
    s_and_b32 m0, m0, 15
    v_writelane_b32 v7, s64, m0
    s_cmp_eq_u32 s7, 0
    s_mov_b32 s64, 49152
    s_cselect_b32 s64, 40960, s64
    s_sub_u32 m0, 24, s74
    s_and_b32 m0, m0, 15
    v_writelane_b32 v7, s64, m0
    s_cmp_eq_u32 s7, 0
    s_mov_b32 s64, 57344
    s_cselect_b32 s64, 8192, s64
    s_sub_u32 m0, 26, s74
    s_and_b32 m0, m0, 15
    v_writelane_b32 v7, s64, m0
    s_cmp_eq_u32 s7, 0
    s_mov_b32 s64, 65536
    s_cselect_b32 s64, 16384, s64
    s_sub_u32 m0, 28, s74
    s_and_b32 m0, m0, 15
    v_writelane_b32 v7, s64, m0
    s_cmp_eq_u32 s7, 0
    s_mov_b32 s64, 90112
    s_cselect_b32 s64, 98304, s64
    s_sub_u32 m0, 30, s74
    s_and_b32 m0, m0, 15
    v_writelane_b32 v7, s64, m0
    s_cmp_eq_u32 s7, 0
    v_mov_b32 v16, 0
    v_mov_b32 v17, 0
    v_mov_b32 v18, 0
    v_mov_b32 v19, 0
    v_mov_b32 v20, 0
    v_mov_b32 v21, 0
    v_mov_b32 v22, 0
    v_mov_b32 v23, 0
    v_mov_b32 v24, 0
    v_mov_b32 v25, 0
    v_mov_b32 v26, 0
    v_mov_b32 v27, 0
    v_mov_b32 v28, 0
    v_mov_b32 v29, 0
    v_mov_b32 v30, 0
    v_mov_b32 v31, 0
    v_mov_b32 v32, 0
    v_mov_b32 v33, 0
    v_mov_b32 v34, 0
    v_mov_b32 v35, 0
    v_mov_b32 v36, 0
    v_mov_b32 v37, 0
    v_mov_b32 v38, 0
    v_mov_b32 v39, 0
    v_mov_b32 v40, 0
    v_mov_b32 v41, 0
    v_mov_b32 v42, 0
    v_mov_b32 v43, 0
    v_mov_b32 v44, 0
    v_mov_b32 v45, 0
    v_mov_b32 v46, 0
    v_mov_b32 v47, 0
    v_mov_b32 v209, 0
    v_mov_b32 v215, 0
    s_lshr_b32 s46, s67, 7
    s_xor_b32 s46, s46, s4
    s_or_b32 s46, s46, s3
    s_mov_b32 s47, 0
    s_cbranch_scc0 P2_ys
P2_ysd:
    s_mov_b32 s66, 0x5555
    s_mov_b32 s65, 0
    s_cmp_lt_u32 s3, 4
    s_cbranch_scc0 D_wait
    s_waitcnt vmcnt(1)
    s_branch D_got
D_wait:
    s_waitcnt vmcnt(0)
D_got:
    v_readfirstlane_b32 s68, v15
    s_mul_i32 s68, s68, 0x10001
    s_lshr_b32 s68, s68, s74
    s_lshr_b32 s64, s68, 1
    s_and_b32 s68, s68, s64
    s_and_b32 s68, s68, s66
    s_cbranch_scc1 D_go
    s_add_u32 s65, s65, 1
    s_cmp_ge_u32 s65, 40000
    s_cbranch_scc1 D_end
    s_sleep 1
    s_mov_b64 exec, 1
    v_mov_b32 v15, 0
    buffer_atomic_or v15, v14, s[16:19], 0 offen sc0
    s_mov_b64 exec, -1
    s_branch D_wait
D_go:
    s_andn2_b32 s66, s66, s68
    s_bcnt1_i32_b32 s70, s68
    s_or_b32 s64, s46, s66
    s_cbranch_scc0 P2_yl
P2_nyl:
    s_cmp_gt_u32 s70, 4
    s_cbranch_scc1 D_t58
    s_cmp_gt_u32 s70, 2
    s_cbranch_scc1 D_t34
    s_cmp_eq_u32 s70, 2
    s_cbranch_scc1 D_e2
D_e1:
    s_ff1_i32_b32 s64, s68
    s_bitset0_b32 s68, s64
    v_readlane_b32 s32, v7, s64
    s_add_u32 s69, s64, s74
    s_and_b32 s69, s69, 15
    s_lshl_b32 s69, s69, 11
    buffer_load_dwordx4 v[80:83], v4, s[16:19], s69 offen offset:0 sc1
    buffer_load_dwordx4 v[84:87], v12, s[16:19], s69 offen offset:1024 sc1
    buffer_load_dwordx4 v[88:91], v4, s[16:19], s69 offen offset:2048 sc1
    buffer_load_dwordx4 v[92:95], v12, s[16:19], s69 offen offset:3072 sc1
    s_mov_b64 exec, 1
    v_mov_b32 v15, 0
    buffer_atomic_or v15, v14, s[16:19], 0 offen sc0
    s_mov_b64 exec, -1
    v_add_u32 v8, s32, v5
    ds_read_b64_tr_b16 v[48:49], v8 offset:0
    ds_read_b64_tr_b16 v[50:51], v8 offset:2048
    v_add_u32 v9, s32, v6
    ds_read_b64_tr_b16 v[52:53], v9 offset:0
    ds_read_b64_tr_b16 v[54:55], v9 offset:2048
    v_add_u32 v10, s32, v1
    ds_read_b64_tr_b16 v[56:57], v10 offset:0
    ds_read_b64_tr_b16 v[58:59], v10 offset:2048
    v_add_u32 v11, s32, v3
    ds_read_b64_tr_b16 v[60:61], v11 offset:0
    ds_read_b64_tr_b16 v[62:63], v11 offset:2048
    s_branch D_p0
D_e2:
    s_ff1_i32_b32 s64, s68
    s_bitset0_b32 s68, s64
    v_readlane_b32 s33, v7, s64
    s_add_u32 s69, s64, s74
    s_and_b32 s69, s69, 15
    s_lshl_b32 s69, s69, 11
    buffer_load_dwordx4 v[96:99], v4, s[16:19], s69 offen offset:0 sc1
    buffer_load_dwordx4 v[100:103], v12, s[16:19], s69 offen offset:1024 sc1
    buffer_load_dwordx4 v[104:107], v4, s[16:19], s69 offen offset:2048 sc1
    buffer_load_dwordx4 v[108:111], v12, s[16:19], s69 offen offset:3072 sc1
    s_ff1_i32_b32 s64, s68
    s_bitset0_b32 s68, s64
    v_readlane_b32 s32, v7, s64
    s_add_u32 s69, s64, s74
    s_and_b32 s69, s69, 15
    s_lshl_b32 s69, s69, 11
    buffer_load_dwordx4 v[80:83], v4, s[16:19], s69 offen offset:0 sc1
    buffer_load_dwordx4 v[84:87], v12, s[16:19], s69 offen offset:1024 sc1
    buffer_load_dwordx4 v[88:91], v4, s[16:19], s69 offen offset:2048 sc1
    buffer_load_dwordx4 v[92:95], v12, s[16:19], s69 offen offset:3072 sc1
    s_mov_b64 exec, 1
    v_mov_b32 v15, 0
    buffer_atomic_or v15, v14, s[16:19], 0 offen sc0
    s_mov_b64 exec, -1
    v_add_u32 v8, s33, v5
    ds_read_b64_tr_b16 v[48:49], v8 offset:0
    ds_read_b64_tr_b16 v[50:51], v8 offset:2048
    v_add_u32 v9, s33, v6
    ds_read_b64_tr_b16 v[52:53], v9 offset:0
    ds_read_b64_tr_b16 v[54:55], v9 offset:2048
    v_add_u32 v10, s33, v1
    ds_read_b64_tr_b16 v[56:57], v10 offset:0
    ds_read_b64_tr_b16 v[58:59], v10 offset:2048
    v_add_u32 v11, s33, v3
    ds_read_b64_tr_b16 v[60:61], v11 offset:0
    ds_read_b64_tr_b16 v[62:63], v11 offset:2048
    s_branch D_p1
D_t34:
    s_cmp_eq_u32 s70, 4
    s_cbranch_scc1 D_e4
D_e3:
    s_ff1_i32_b32 s64, s68
    s_bitset0_b32 s68, s64
    v_readlane_b32 s34, v7, s64
    s_add_u32 s69, s64, s74
    s_and_b32 s69, s69, 15
    s_lshl_b32 s69, s69, 11
    buffer_load_dwordx4 v[112:115], v4, s[16:19], s69 offen offset:0 sc1
    buffer_load_dwordx4 v[116:119], v12, s[16:19], s69 offen offset:1024 sc1
    buffer_load_dwordx4 v[120:123], v4, s[16:19], s69 offen offset:2048 sc1
    buffer_load_dwordx4 v[124:127], v12, s[16:19], s69 offen offset:3072 sc1
    s_ff1_i32_b32 s64, s68
    s_bitset0_b32 s68, s64
    v_readlane_b32 s33, v7, s64
    s_add_u32 s69, s64, s74
    s_and_b32 s69, s69, 15
    s_lshl_b32 s69, s69, 11
    buffer_load_dwordx4 v[96:99], v4, s[16:19], s69 offen offset:0 sc1
    buffer_load_dwordx4 v[100:103], v12, s[16:19], s69 offen offset:1024 sc1
    buffer_load_dwordx4 v[104:107], v4, s[16:19], s69 offen offset:2048 sc1
    buffer_load_dwordx4 v[108:111], v12, s[16:19], s69 offen offset:3072 sc1
    v_add_u32 v8, s34, v5
    ds_read_b64_tr_b16 v[48:49], v8 offset:0
    ds_read_b64_tr_b16 v[50:51], v8 offset:2048
    v_add_u32 v9, s34, v6
    ds_read_b64_tr_b16 v[52:53], v9 offset:0
    ds_read_b64_tr_b16 v[54:55], v9 offset:2048
    v_add_u32 v10, s34, v1
    ds_read_b64_tr_b16 v[56:57], v10 offset:0
    ds_read_b64_tr_b16 v[58:59], v10 offset:2048
    v_add_u32 v11, s34, v3
    ds_read_b64_tr_b16 v[60:61], v11 offset:0
    ds_read_b64_tr_b16 v[62:63], v11 offset:2048
    s_branch D_p2
D_e4:
    s_ff1_i32_b32 s64, s68
    s_bitset0_b32 s68, s64
    v_readlane_b32 s35, v7, s64
    s_add_u32 s69, s64, s74
    s_and_b32 s69, s69, 15
    s_lshl_b32 s69, s69, 11
    buffer_load_dwordx4 v[128:131], v4, s[16:19], s69 offen offset:0 sc1
    buffer_load_dwordx4 v[132:135], v12, s[16:19], s69 offen offset:1024 sc1
    buffer_load_dwordx4 v[136:139], v4, s[16:19], s69 offen offset:2048 sc1
    buffer_load_dwordx4 v[140:143], v12, s[16:19], s69 offen offset:3072 sc1
    s_ff1_i32_b32 s64, s68
    s_bitset0_b32 s68, s64
    v_readlane_b32 s34, v7, s64
    s_add_u32 s69, s64, s74
    s_and_b32 s69, s69, 15
    s_lshl_b32 s69, s69, 11
    buffer_load_dwordx4 v[112:115], v4, s[16:19], s69 offen offset:0 sc1
    buffer_load_dwordx4 v[116:119], v12, s[16:19], s69 offen offset:1024 sc1
    buffer_load_dwordx4 v[120:123], v4, s[16:19], s69 offen offset:2048 sc1
    buffer_load_dwordx4 v[124:127], v12, s[16:19], s69 offen offset:3072 sc1
    v_add_u32 v8, s35, v5
    ds_read_b64_tr_b16 v[48:49], v8 offset:0
    ds_read_b64_tr_b16 v[50:51], v8 offset:2048
    v_add_u32 v9, s35, v6
    ds_read_b64_tr_b16 v[52:53], v9 offset:0
    ds_read_b64_tr_b16 v[54:55], v9 offset:2048
    v_add_u32 v10, s35, v1
    ds_read_b64_tr_b16 v[56:57], v10 offset:0
    ds_read_b64_tr_b16 v[58:59], v10 offset:2048
    v_add_u32 v11, s35, v3
    ds_read_b64_tr_b16 v[60:61], v11 offset:0
    ds_read_b64_tr_b16 v[62:63], v11 offset:2048
    s_branch D_p3
D_t58:
    s_cmp_gt_u32 s70, 6
    s_cbranch_scc1 D_t78
    s_cmp_eq_u32 s70, 6
    s_cbranch_scc1 D_e6
D_e5:
    s_ff1_i32_b32 s64, s68
    s_bitset0_b32 s68, s64
    v_readlane_b32 s36, v7, s64
    s_add_u32 s69, s64, s74
    s_and_b32 s69, s69, 15
    s_lshl_b32 s69, s69, 11
    buffer_load_dwordx4 v[144:147], v4, s[16:19], s69 offen offset:0 sc1
    buffer_load_dwordx4 v[148:151], v12, s[16:19], s69 offen offset:1024 sc1
    buffer_load_dwordx4 v[152:155], v4, s[16:19], s69 offen offset:2048 sc1
    buffer_load_dwordx4 v[156:159], v12, s[16:19], s69 offen offset:3072 sc1
    s_ff1_i32_b32 s64, s68
    s_bitset0_b32 s68, s64
    v_readlane_b32 s35, v7, s64
    s_add_u32 s69, s64, s74
    s_and_b32 s69, s69, 15
    s_lshl_b32 s69, s69, 11
    buffer_load_dwordx4 v[128:131], v4, s[16:19], s69 offen offset:0 sc1
    buffer_load_dwordx4 v[132:135], v12, s[16:19], s69 offen offset:1024 sc1
    buffer_load_dwordx4 v[136:139], v4, s[16:19], s69 offen offset:2048 sc1
    buffer_load_dwordx4 v[140:143], v12, s[16:19], s69 offen offset:3072 sc1
    v_add_u32 v8, s36, v5
    ds_read_b64_tr_b16 v[48:49], v8 offset:0
    ds_read_b64_tr_b16 v[50:51], v8 offset:2048
    v_add_u32 v9, s36, v6
    ds_read_b64_tr_b16 v[52:53], v9 offset:0
    ds_read_b64_tr_b16 v[54:55], v9 offset:2048
    v_add_u32 v10, s36, v1
    ds_read_b64_tr_b16 v[56:57], v10 offset:0
    ds_read_b64_tr_b16 v[58:59], v10 offset:2048
    v_add_u32 v11, s36, v3
    ds_read_b64_tr_b16 v[60:61], v11 offset:0
    ds_read_b64_tr_b16 v[62:63], v11 offset:2048
    s_branch D_p4
D_e6:
    s_ff1_i32_b32 s64, s68
    s_bitset0_b32 s68, s64
    v_readlane_b32 s37, v7, s64
    s_add_u32 s69, s64, s74
    s_and_b32 s69, s69, 15
    s_lshl_b32 s69, s69, 11
    buffer_load_dwordx4 v[160:163], v4, s[16:19], s69 offen offset:0 sc1
    buffer_load_dwordx4 v[164:167], v12, s[16:19], s69 offen offset:1024 sc1
    buffer_load_dwordx4 v[168:171], v4, s[16:19], s69 offen offset:2048 sc1
    buffer_load_dwordx4 v[172:175], v12, s[16:19], s69 offen offset:3072 sc1
    s_ff1_i32_b32 s64, s68
    s_bitset0_b32 s68, s64
    v_readlane_b32 s36, v7, s64
    s_add_u32 s69, s64, s74
    s_and_b32 s69, s69, 15
    s_lshl_b32 s69, s69, 11
    buffer_load_dwordx4 v[144:147], v4, s[16:19], s69 offen offset:0 sc1
    buffer_load_dwordx4 v[148:151], v12, s[16:19], s69 offen offset:1024 sc1
    buffer_load_dwordx4 v[152:155], v4, s[16:19], s69 offen offset:2048 sc1
    buffer_load_dwordx4 v[156:159], v12, s[16:19], s69 offen offset:3072 sc1
    v_add_u32 v8, s37, v5
    ds_read_b64_tr_b16 v[48:49], v8 offset:0
    ds_read_b64_tr_b16 v[50:51], v8 offset:2048
    v_add_u32 v9, s37, v6
    ds_read_b64_tr_b16 v[52:53], v9 offset:0
    ds_read_b64_tr_b16 v[54:55], v9 offset:2048
    v_add_u32 v10, s37, v1
    ds_read_b64_tr_b16 v[56:57], v10 offset:0
    ds_read_b64_tr_b16 v[58:59], v10 offset:2048
    v_add_u32 v11, s37, v3
    ds_read_b64_tr_b16 v[60:61], v11 offset:0
    ds_read_b64_tr_b16 v[62:63], v11 offset:2048
    s_branch D_p5
D_t78:
    s_cmp_eq_u32 s70, 8
    s_cbranch_scc1 D_e8
D_e7:
    s_ff1_i32_b32 s64, s68
    s_bitset0_b32 s68, s64
    v_readlane_b32 s38, v7, s64
    s_add_u32 s69, s64, s74
    s_and_b32 s69, s69, 15
    s_lshl_b32 s69, s69, 11
    buffer_load_dwordx4 v[176:179], v4, s[16:19], s69 offen offset:0 sc1
    buffer_load_dwordx4 v[180:183], v12, s[16:19], s69 offen offset:1024 sc1
    buffer_load_dwordx4 v[184:187], v4, s[16:19], s69 offen offset:2048 sc1
    buffer_load_dwordx4 v[188:191], v12, s[16:19], s69 offen offset:3072 sc1
    s_ff1_i32_b32 s64, s68
    s_bitset0_b32 s68, s64
    v_readlane_b32 s37, v7, s64
    s_add_u32 s69, s64, s74
    s_and_b32 s69, s69, 15
    s_lshl_b32 s69, s69, 11
    buffer_load_dwordx4 v[160:163], v4, s[16:19], s69 offen offset:0 sc1
    buffer_load_dwordx4 v[164:167], v12, s[16:19], s69 offen offset:1024 sc1
    buffer_load_dwordx4 v[168:171], v4, s[16:19], s69 offen offset:2048 sc1
    buffer_load_dwordx4 v[172:175], v12, s[16:19], s69 offen offset:3072 sc1
    v_add_u32 v8, s38, v5
    ds_read_b64_tr_b16 v[48:49], v8 offset:0
    ds_read_b64_tr_b16 v[50:51], v8 offset:2048
    v_add_u32 v9, s38, v6
    ds_read_b64_tr_b16 v[52:53], v9 offset:0
    ds_read_b64_tr_b16 v[54:55], v9 offset:2048
    v_add_u32 v10, s38, v1
    ds_read_b64_tr_b16 v[56:57], v10 offset:0
    ds_read_b64_tr_b16 v[58:59], v10 offset:2048
    v_add_u32 v11, s38, v3
    ds_read_b64_tr_b16 v[60:61], v11 offset:0
    ds_read_b64_tr_b16 v[62:63], v11 offset:2048
    s_branch D_p6
D_e8:
    s_ff1_i32_b32 s64, s68
    s_bitset0_b32 s68, s64
    v_readlane_b32 s39, v7, s64
    s_add_u32 s69, s64, s74
    s_and_b32 s69, s69, 15
    s_lshl_b32 s69, s69, 11
    buffer_load_dwordx4 v[192:195], v4, s[16:19], s69 offen offset:0 sc1
    buffer_load_dwordx4 v[196:199], v12, s[16:19], s69 offen offset:1024 sc1
    buffer_load_dwordx4 v[200:203], v4, s[16:19], s69 offen offset:2048 sc1
    buffer_load_dwordx4 v[204:207], v12, s[16:19], s69 offen offset:3072 sc1
    s_ff1_i32_b32 s64, s68
    s_bitset0_b32 s68, s64
    v_readlane_b32 s38, v7, s64
    s_add_u32 s69, s64, s74
    s_and_b32 s69, s69, 15
    s_lshl_b32 s69, s69, 11
    buffer_load_dwordx4 v[176:179], v4, s[16:19], s69 offen offset:0 sc1
    buffer_load_dwordx4 v[180:183], v12, s[16:19], s69 offen offset:1024 sc1
    buffer_load_dwordx4 v[184:187], v4, s[16:19], s69 offen offset:2048 sc1
    buffer_load_dwordx4 v[188:191], v12, s[16:19], s69 offen offset:3072 sc1
    v_add_u32 v8, s39, v5
    ds_read_b64_tr_b16 v[48:49], v8 offset:0
    ds_read_b64_tr_b16 v[50:51], v8 offset:2048
    v_add_u32 v9, s39, v6
    ds_read_b64_tr_b16 v[52:53], v9 offset:0
    ds_read_b64_tr_b16 v[54:55], v9 offset:2048
    v_add_u32 v10, s39, v1
    ds_read_b64_tr_b16 v[56:57], v10 offset:0
    ds_read_b64_tr_b16 v[58:59], v10 offset:2048
    v_add_u32 v11, s39, v3
    ds_read_b64_tr_b16 v[60:61], v11 offset:0
    ds_read_b64_tr_b16 v[62:63], v11 offset:2048
D_p7:
    s_waitcnt vmcnt(4) lgkmcnt(0)
    v_mfma_f32_16x16x32_bf16 v[16:19], v[48:51], v[192:195], v[16:19]
    ds_read_b64_tr_b16 v[64:65], v8 offset:4096
    ds_read_b64_tr_b16 v[66:67], v8 offset:6144
    v_mfma_f32_16x16x32_bf16 v[32:35], v[48:51], v[196:199], v[32:35]
    ds_read_b64_tr_b16 v[68:69], v9 offset:4096
    ds_read_b64_tr_b16 v[70:71], v9 offset:6144
    v_mfma_f32_16x16x32_bf16 v[20:23], v[52:55], v[192:195], v[20:23]
    ds_read_b64_tr_b16 v[72:73], v10 offset:4096
    ds_read_b64_tr_b16 v[74:75], v10 offset:6144
    v_mfma_f32_16x16x32_bf16 v[36:39], v[52:55], v[196:199], v[36:39]
    ds_read_b64_tr_b16 v[76:77], v11 offset:4096
    ds_read_b64_tr_b16 v[78:79], v11 offset:6144
    s_ff1_i32_b32 s64, s68
    s_bitset0_b32 s68, s64
    v_readlane_b32 s37, v7, s64
    s_add_u32 s69, s64, s74
    s_and_b32 s69, s69, 15
    s_lshl_b32 s69, s69, 11
    buffer_load_dwordx4 v[160:163], v4, s[16:19], s69 offen offset:0 sc1
    v_mfma_f32_16x16x32_bf16 v[24:27], v[56:59], v[192:195], v[24:27]
    v_mfma_f32_16x16x32_bf16 v[40:43], v[56:59], v[196:199], v[40:43]
    v_mfma_f32_16x16x32_bf16 v[28:31], v[60:63], v[192:195], v[28:31]
    buffer_load_dwordx4 v[164:167], v12, s[16:19], s69 offen offset:1024 sc1
    v_mfma_f32_16x16x32_bf16 v[44:47], v[60:63], v[196:199], v[44:47]
    s_waitcnt lgkmcnt(0)
    v_mfma_f32_16x16x32_bf16 v[16:19], v[64:67], v[200:203], v[16:19]
    v_add_u32 v8, s38, v5
    ds_read_b64_tr_b16 v[48:49], v8 offset:0
    v_mfma_f32_16x16x32_bf16 v[32:35], v[64:67], v[204:207], v[32:35]
    ds_read_b64_tr_b16 v[50:51], v8 offset:2048
    v_add_u32 v9, s38, v6
    v_mfma_f32_16x16x32_bf16 v[20:23], v[68:71], v[200:203], v[20:23]
    ds_read_b64_tr_b16 v[52:53], v9 offset:0
    ds_read_b64_tr_b16 v[54:55], v9 offset:2048
    v_mfma_f32_16x16x32_bf16 v[36:39], v[68:71], v[204:207], v[36:39]
    v_add_u32 v10, s38, v1
    ds_read_b64_tr_b16 v[56:57], v10 offset:0
    buffer_load_dwordx4 v[168:171], v4, s[16:19], s69 offen offset:2048 sc1
    v_mfma_f32_16x16x32_bf16 v[24:27], v[72:75], v[200:203], v[24:27]
    ds_read_b64_tr_b16 v[58:59], v10 offset:2048
    v_add_u32 v11, s38, v3
    v_mfma_f32_16x16x32_bf16 v[40:43], v[72:75], v[204:207], v[40:43]
    ds_read_b64_tr_b16 v[60:61], v11 offset:0
    ds_read_b64_tr_b16 v[62:63], v11 offset:2048
    v_mfma_f32_16x16x32_bf16 v[28:31], v[76:79], v[200:203], v[28:31]
    buffer_load_dwordx4 v[172:175], v12, s[16:19], s69 offen offset:3072 sc1
    v_mfma_f32_16x16x32_bf16 v[44:47], v[76:79], v[204:207], v[44:47]
D_p6:
    s_waitcnt vmcnt(4) lgkmcnt(0)
    v_mfma_f32_16x16x32_bf16 v[16:19], v[48:51], v[176:179], v[16:19]
    ds_read_b64_tr_b16 v[64:65], v8 offset:4096
    ds_read_b64_tr_b16 v[66:67], v8 offset:6144
    v_mfma_f32_16x16x32_bf16 v[32:35], v[48:51], v[180:183], v[32:35]
    ds_read_b64_tr_b16 v[68:69], v9 offset:4096
    ds_read_b64_tr_b16 v[70:71], v9 offset:6144
    v_mfma_f32_16x16x32_bf16 v[20:23], v[52:55], v[176:179], v[20:23]
    ds_read_b64_tr_b16 v[72:73], v10 offset:4096
    ds_read_b64_tr_b16 v[74:75], v10 offset:6144
    v_mfma_f32_16x16x32_bf16 v[36:39], v[52:55], v[180:183], v[36:39]
    ds_read_b64_tr_b16 v[76:77], v11 offset:4096
    ds_read_b64_tr_b16 v[78:79], v11 offset:6144
    s_ff1_i32_b32 s64, s68
    s_bitset0_b32 s68, s64
    v_readlane_b32 s36, v7, s64
    s_add_u32 s69, s64, s74
    s_and_b32 s69, s69, 15
    s_lshl_b32 s69, s69, 11
    buffer_load_dwordx4 v[144:147], v4, s[16:19], s69 offen offset:0 sc1
    v_mfma_f32_16x16x32_bf16 v[24:27], v[56:59], v[176:179], v[24:27]
    v_mfma_f32_16x16x32_bf16 v[40:43], v[56:59], v[180:183], v[40:43]
    v_mfma_f32_16x16x32_bf16 v[28:31], v[60:63], v[176:179], v[28:31]
    buffer_load_dwordx4 v[148:151], v12, s[16:19], s69 offen offset:1024 sc1
    v_mfma_f32_16x16x32_bf16 v[44:47], v[60:63], v[180:183], v[44:47]
    s_waitcnt lgkmcnt(0)
    v_mfma_f32_16x16x32_bf16 v[16:19], v[64:67], v[184:187], v[16:19]
    v_add_u32 v8, s37, v5
    ds_read_b64_tr_b16 v[48:49], v8 offset:0
    v_mfma_f32_16x16x32_bf16 v[32:35], v[64:67], v[188:191], v[32:35]
    ds_read_b64_tr_b16 v[50:51], v8 offset:2048
    v_add_u32 v9, s37, v6
    v_mfma_f32_16x16x32_bf16 v[20:23], v[68:71], v[184:187], v[20:23]
    ds_read_b64_tr_b16 v[52:53], v9 offset:0
    ds_read_b64_tr_b16 v[54:55], v9 offset:2048
    v_mfma_f32_16x16x32_bf16 v[36:39], v[68:71], v[188:191], v[36:39]
    v_add_u32 v10, s37, v1
    ds_read_b64_tr_b16 v[56:57], v10 offset:0
    buffer_load_dwordx4 v[152:155], v4, s[16:19], s69 offen offset:2048 sc1
    v_mfma_f32_16x16x32_bf16 v[24:27], v[72:75], v[184:187], v[24:27]
    ds_read_b64_tr_b16 v[58:59], v10 offset:2048
    v_add_u32 v11, s37, v3
    v_mfma_f32_16x16x32_bf16 v[40:43], v[72:75], v[188:191], v[40:43]
    ds_read_b64_tr_b16 v[60:61], v11 offset:0
    ds_read_b64_tr_b16 v[62:63], v11 offset:2048
    v_mfma_f32_16x16x32_bf16 v[28:31], v[76:79], v[184:187], v[28:31]
    buffer_load_dwordx4 v[156:159], v12, s[16:19], s69 offen offset:3072 sc1
    v_mfma_f32_16x16x32_bf16 v[44:47], v[76:79], v[188:191], v[44:47]
D_p5:
    s_waitcnt vmcnt(4) lgkmcnt(0)
    v_mfma_f32_16x16x32_bf16 v[16:19], v[48:51], v[160:163], v[16:19]
    ds_read_b64_tr_b16 v[64:65], v8 offset:4096
    ds_read_b64_tr_b16 v[66:67], v8 offset:6144
    v_mfma_f32_16x16x32_bf16 v[32:35], v[48:51], v[164:167], v[32:35]
    ds_read_b64_tr_b16 v[68:69], v9 offset:4096
    ds_read_b64_tr_b16 v[70:71], v9 offset:6144
    v_mfma_f32_16x16x32_bf16 v[20:23], v[52:55], v[160:163], v[20:23]
    ds_read_b64_tr_b16 v[72:73], v10 offset:4096
    ds_read_b64_tr_b16 v[74:75], v10 offset:6144
    v_mfma_f32_16x16x32_bf16 v[36:39], v[52:55], v[164:167], v[36:39]
    ds_read_b64_tr_b16 v[76:77], v11 offset:4096
    ds_read_b64_tr_b16 v[78:79], v11 offset:6144
    s_ff1_i32_b32 s64, s68
    s_bitset0_b32 s68, s64
    v_readlane_b32 s35, v7, s64
    s_add_u32 s69, s64, s74
    s_and_b32 s69, s69, 15
    s_lshl_b32 s69, s69, 11
    buffer_load_dwordx4 v[128:131], v4, s[16:19], s69 offen offset:0 sc1
    v_mfma_f32_16x16x32_bf16 v[24:27], v[56:59], v[160:163], v[24:27]
    v_mfma_f32_16x16x32_bf16 v[40:43], v[56:59], v[164:167], v[40:43]
    v_mfma_f32_16x16x32_bf16 v[28:31], v[60:63], v[160:163], v[28:31]
    buffer_load_dwordx4 v[132:135], v12, s[16:19], s69 offen offset:1024 sc1
    v_mfma_f32_16x16x32_bf16 v[44:47], v[60:63], v[164:167], v[44:47]
    s_waitcnt lgkmcnt(0)
    v_mfma_f32_16x16x32_bf16 v[16:19], v[64:67], v[168:171], v[16:19]
    v_add_u32 v8, s36, v5
    ds_read_b64_tr_b16 v[48:49], v8 offset:0
    v_mfma_f32_16x16x32_bf16 v[32:35], v[64:67], v[172:175], v[32:35]
    ds_read_b64_tr_b16 v[50:51], v8 offset:2048
    v_add_u32 v9, s36, v6
    v_mfma_f32_16x16x32_bf16 v[20:23], v[68:71], v[168:171], v[20:23]
    ds_read_b64_tr_b16 v[52:53], v9 offset:0
    ds_read_b64_tr_b16 v[54:55], v9 offset:2048
    v_mfma_f32_16x16x32_bf16 v[36:39], v[68:71], v[172:175], v[36:39]
    v_add_u32 v10, s36, v1
    ds_read_b64_tr_b16 v[56:57], v10 offset:0
    buffer_load_dwordx4 v[136:139], v4, s[16:19], s69 offen offset:2048 sc1
    v_mfma_f32_16x16x32_bf16 v[24:27], v[72:75], v[168:171], v[24:27]
    ds_read_b64_tr_b16 v[58:59], v10 offset:2048
    v_add_u32 v11, s36, v3
    v_mfma_f32_16x16x32_bf16 v[40:43], v[72:75], v[172:175], v[40:43]
    ds_read_b64_tr_b16 v[60:61], v11 offset:0
    ds_read_b64_tr_b16 v[62:63], v11 offset:2048
    v_mfma_f32_16x16x32_bf16 v[28:31], v[76:79], v[168:171], v[28:31]
    buffer_load_dwordx4 v[140:143], v12, s[16:19], s69 offen offset:3072 sc1
    v_mfma_f32_16x16x32_bf16 v[44:47], v[76:79], v[172:175], v[44:47]
D_p4:
    s_waitcnt vmcnt(4) lgkmcnt(0)
    v_mfma_f32_16x16x32_bf16 v[16:19], v[48:51], v[144:147], v[16:19]
    ds_read_b64_tr_b16 v[64:65], v8 offset:4096
    ds_read_b64_tr_b16 v[66:67], v8 offset:6144
    v_mfma_f32_16x16x32_bf16 v[32:35], v[48:51], v[148:151], v[32:35]
    ds_read_b64_tr_b16 v[68:69], v9 offset:4096
    ds_read_b64_tr_b16 v[70:71], v9 offset:6144
    v_mfma_f32_16x16x32_bf16 v[20:23], v[52:55], v[144:147], v[20:23]
    ds_read_b64_tr_b16 v[72:73], v10 offset:4096
    ds_read_b64_tr_b16 v[74:75], v10 offset:6144
    v_mfma_f32_16x16x32_bf16 v[36:39], v[52:55], v[148:151], v[36:39]
    ds_read_b64_tr_b16 v[76:77], v11 offset:4096
    ds_read_b64_tr_b16 v[78:79], v11 offset:6144
    s_ff1_i32_b32 s64, s68
    s_bitset0_b32 s68, s64
    v_readlane_b32 s34, v7, s64
    s_add_u32 s69, s64, s74
    s_and_b32 s69, s69, 15
    s_lshl_b32 s69, s69, 11
    buffer_load_dwordx4 v[112:115], v4, s[16:19], s69 offen offset:0 sc1
    v_mfma_f32_16x16x32_bf16 v[24:27], v[56:59], v[144:147], v[24:27]
    v_mfma_f32_16x16x32_bf16 v[40:43], v[56:59], v[148:151], v[40:43]
    v_mfma_f32_16x16x32_bf16 v[28:31], v[60:63], v[144:147], v[28:31]
    buffer_load_dwordx4 v[116:119], v12, s[16:19], s69 offen offset:1024 sc1
    v_mfma_f32_16x16x32_bf16 v[44:47], v[60:63], v[148:151], v[44:47]
    s_waitcnt lgkmcnt(0)
    v_mfma_f32_16x16x32_bf16 v[16:19], v[64:67], v[152:155], v[16:19]
    v_add_u32 v8, s35, v5
    ds_read_b64_tr_b16 v[48:49], v8 offset:0
    v_mfma_f32_16x16x32_bf16 v[32:35], v[64:67], v[156:159], v[32:35]
    ds_read_b64_tr_b16 v[50:51], v8 offset:2048
    v_add_u32 v9, s35, v6
    v_mfma_f32_16x16x32_bf16 v[20:23], v[68:71], v[152:155], v[20:23]
    ds_read_b64_tr_b16 v[52:53], v9 offset:0
    ds_read_b64_tr_b16 v[54:55], v9 offset:2048
    v_mfma_f32_16x16x32_bf16 v[36:39], v[68:71], v[156:159], v[36:39]
    v_add_u32 v10, s35, v1
    ds_read_b64_tr_b16 v[56:57], v10 offset:0
    buffer_load_dwordx4 v[120:123], v4, s[16:19], s69 offen offset:2048 sc1
    v_mfma_f32_16x16x32_bf16 v[24:27], v[72:75], v[152:155], v[24:27]
    ds_read_b64_tr_b16 v[58:59], v10 offset:2048
    v_add_u32 v11, s35, v3
    v_mfma_f32_16x16x32_bf16 v[40:43], v[72:75], v[156:159], v[40:43]
    ds_read_b64_tr_b16 v[60:61], v11 offset:0
    ds_read_b64_tr_b16 v[62:63], v11 offset:2048
    v_mfma_f32_16x16x32_bf16 v[28:31], v[76:79], v[152:155], v[28:31]
    buffer_load_dwordx4 v[124:127], v12, s[16:19], s69 offen offset:3072 sc1
    v_mfma_f32_16x16x32_bf16 v[44:47], v[76:79], v[156:159], v[44:47]
D_p3:
    s_waitcnt vmcnt(4) lgkmcnt(0)
    v_mfma_f32_16x16x32_bf16 v[16:19], v[48:51], v[128:131], v[16:19]
    ds_read_b64_tr_b16 v[64:65], v8 offset:4096
    ds_read_b64_tr_b16 v[66:67], v8 offset:6144
    v_mfma_f32_16x16x32_bf16 v[32:35], v[48:51], v[132:135], v[32:35]
    ds_read_b64_tr_b16 v[68:69], v9 offset:4096
    ds_read_b64_tr_b16 v[70:71], v9 offset:6144
    v_mfma_f32_16x16x32_bf16 v[20:23], v[52:55], v[128:131], v[20:23]
    ds_read_b64_tr_b16 v[72:73], v10 offset:4096
    ds_read_b64_tr_b16 v[74:75], v10 offset:6144
    v_mfma_f32_16x16x32_bf16 v[36:39], v[52:55], v[132:135], v[36:39]
    ds_read_b64_tr_b16 v[76:77], v11 offset:4096
    ds_read_b64_tr_b16 v[78:79], v11 offset:6144
    s_ff1_i32_b32 s64, s68
    s_bitset0_b32 s68, s64
    v_readlane_b32 s33, v7, s64
    s_add_u32 s69, s64, s74
    s_and_b32 s69, s69, 15
    s_lshl_b32 s69, s69, 11
    buffer_load_dwordx4 v[96:99], v4, s[16:19], s69 offen offset:0 sc1
    v_mfma_f32_16x16x32_bf16 v[24:27], v[56:59], v[128:131], v[24:27]
    v_mfma_f32_16x16x32_bf16 v[40:43], v[56:59], v[132:135], v[40:43]
    v_mfma_f32_16x16x32_bf16 v[28:31], v[60:63], v[128:131], v[28:31]
    buffer_load_dwordx4 v[100:103], v12, s[16:19], s69 offen offset:1024 sc1
    v_mfma_f32_16x16x32_bf16 v[44:47], v[60:63], v[132:135], v[44:47]
    s_waitcnt lgkmcnt(0)
    v_mfma_f32_16x16x32_bf16 v[16:19], v[64:67], v[136:139], v[16:19]
    v_add_u32 v8, s34, v5
    ds_read_b64_tr_b16 v[48:49], v8 offset:0
    v_mfma_f32_16x16x32_bf16 v[32:35], v[64:67], v[140:143], v[32:35]
    ds_read_b64_tr_b16 v[50:51], v8 offset:2048
    v_add_u32 v9, s34, v6
    v_mfma_f32_16x16x32_bf16 v[20:23], v[68:71], v[136:139], v[20:23]
    ds_read_b64_tr_b16 v[52:53], v9 offset:0
    ds_read_b64_tr_b16 v[54:55], v9 offset:2048
    v_mfma_f32_16x16x32_bf16 v[36:39], v[68:71], v[140:143], v[36:39]
    v_add_u32 v10, s34, v1
    ds_read_b64_tr_b16 v[56:57], v10 offset:0
    buffer_load_dwordx4 v[104:107], v4, s[16:19], s69 offen offset:2048 sc1
    v_mfma_f32_16x16x32_bf16 v[24:27], v[72:75], v[136:139], v[24:27]
    ds_read_b64_tr_b16 v[58:59], v10 offset:2048
    v_add_u32 v11, s34, v3
    v_mfma_f32_16x16x32_bf16 v[40:43], v[72:75], v[140:143], v[40:43]
    ds_read_b64_tr_b16 v[60:61], v11 offset:0
    ds_read_b64_tr_b16 v[62:63], v11 offset:2048
    v_mfma_f32_16x16x32_bf16 v[28:31], v[76:79], v[136:139], v[28:31]
    buffer_load_dwordx4 v[108:111], v12, s[16:19], s69 offen offset:3072 sc1
    v_mfma_f32_16x16x32_bf16 v[44:47], v[76:79], v[140:143], v[44:47]
D_p2:
    s_waitcnt vmcnt(4) lgkmcnt(0)
    v_mfma_f32_16x16x32_bf16 v[16:19], v[48:51], v[112:115], v[16:19]
    ds_read_b64_tr_b16 v[64:65], v8 offset:4096
    ds_read_b64_tr_b16 v[66:67], v8 offset:6144
    v_mfma_f32_16x16x32_bf16 v[32:35], v[48:51], v[116:119], v[32:35]
    ds_read_b64_tr_b16 v[68:69], v9 offset:4096
    ds_read_b64_tr_b16 v[70:71], v9 offset:6144
    v_mfma_f32_16x16x32_bf16 v[20:23], v[52:55], v[112:115], v[20:23]
    ds_read_b64_tr_b16 v[72:73], v10 offset:4096
    ds_read_b64_tr_b16 v[74:75], v10 offset:6144
    v_mfma_f32_16x16x32_bf16 v[36:39], v[52:55], v[116:119], v[36:39]
    ds_read_b64_tr_b16 v[76:77], v11 offset:4096
    ds_read_b64_tr_b16 v[78:79], v11 offset:6144
    s_ff1_i32_b32 s64, s68
    s_bitset0_b32 s68, s64
    v_readlane_b32 s32, v7, s64
    s_add_u32 s69, s64, s74
    s_and_b32 s69, s69, 15
    s_lshl_b32 s69, s69, 11
    buffer_load_dwordx4 v[80:83], v4, s[16:19], s69 offen offset:0 sc1
    v_mfma_f32_16x16x32_bf16 v[24:27], v[56:59], v[112:115], v[24:27]
    v_mfma_f32_16x16x32_bf16 v[40:43], v[56:59], v[116:119], v[40:43]
    v_mfma_f32_16x16x32_bf16 v[28:31], v[60:63], v[112:115], v[28:31]
    buffer_load_dwordx4 v[84:87], v12, s[16:19], s69 offen offset:1024 sc1
    v_mfma_f32_16x16x32_bf16 v[44:47], v[60:63], v[116:119], v[44:47]
    s_waitcnt lgkmcnt(0)
    v_mfma_f32_16x16x32_bf16 v[16:19], v[64:67], v[120:123], v[16:19]
    v_add_u32 v8, s33, v5
    ds_read_b64_tr_b16 v[48:49], v8 offset:0
    v_mfma_f32_16x16x32_bf16 v[32:35], v[64:67], v[124:127], v[32:35]
    ds_read_b64_tr_b16 v[50:51], v8 offset:2048
    v_add_u32 v9, s33, v6
    v_mfma_f32_16x16x32_bf16 v[20:23], v[68:71], v[120:123], v[20:23]
    ds_read_b64_tr_b16 v[52:53], v9 offset:0
    ds_read_b64_tr_b16 v[54:55], v9 offset:2048
    v_mfma_f32_16x16x32_bf16 v[36:39], v[68:71], v[124:127], v[36:39]
    v_add_u32 v10, s33, v1
    ds_read_b64_tr_b16 v[56:57], v10 offset:0
    buffer_load_dwordx4 v[88:91], v4, s[16:19], s69 offen offset:2048 sc1
    v_mfma_f32_16x16x32_bf16 v[24:27], v[72:75], v[120:123], v[24:27]
    ds_read_b64_tr_b16 v[58:59], v10 offset:2048
    v_add_u32 v11, s33, v3
    v_mfma_f32_16x16x32_bf16 v[40:43], v[72:75], v[124:127], v[40:43]
    ds_read_b64_tr_b16 v[60:61], v11 offset:0
    ds_read_b64_tr_b16 v[62:63], v11 offset:2048
    v_mfma_f32_16x16x32_bf16 v[28:31], v[76:79], v[120:123], v[28:31]
    buffer_load_dwordx4 v[92:95], v12, s[16:19], s69 offen offset:3072 sc1
    s_mov_b64 exec, 1
    v_mov_b32 v15, 0
    buffer_atomic_or v15, v14, s[16:19], 0 offen sc0
    s_mov_b64 exec, -1
    v_mfma_f32_16x16x32_bf16 v[44:47], v[76:79], v[124:127], v[44:47]
D_p1:
    s_waitcnt vmcnt(5) lgkmcnt(0)
    v_mfma_f32_16x16x32_bf16 v[16:19], v[48:51], v[96:99], v[16:19]
    ds_read_b64_tr_b16 v[64:65], v8 offset:4096
    ds_read_b64_tr_b16 v[66:67], v8 offset:6144
    v_mfma_f32_16x16x32_bf16 v[32:35], v[48:51], v[100:103], v[32:35]
    ds_read_b64_tr_b16 v[68:69], v9 offset:4096
    ds_read_b64_tr_b16 v[70:71], v9 offset:6144
    v_mfma_f32_16x16x32_bf16 v[20:23], v[52:55], v[96:99], v[20:23]
    ds_read_b64_tr_b16 v[72:73], v10 offset:4096
    ds_read_b64_tr_b16 v[74:75], v10 offset:6144
    v_mfma_f32_16x16x32_bf16 v[36:39], v[52:55], v[100:103], v[36:39]
    ds_read_b64_tr_b16 v[76:77], v11 offset:4096
    ds_read_b64_tr_b16 v[78:79], v11 offset:6144
    v_mfma_f32_16x16x32_bf16 v[24:27], v[56:59], v[96:99], v[24:27]
    v_mfma_f32_16x16x32_bf16 v[40:43], v[56:59], v[100:103], v[40:43]
    v_mfma_f32_16x16x32_bf16 v[28:31], v[60:63], v[96:99], v[28:31]
    v_mfma_f32_16x16x32_bf16 v[44:47], v[60:63], v[100:103], v[44:47]
    s_waitcnt lgkmcnt(0)
    v_mfma_f32_16x16x32_bf16 v[16:19], v[64:67], v[104:107], v[16:19]
    v_add_u32 v8, s32, v5
    ds_read_b64_tr_b16 v[48:49], v8 offset:0
    v_mfma_f32_16x16x32_bf16 v[32:35], v[64:67], v[108:111], v[32:35]
    ds_read_b64_tr_b16 v[50:51], v8 offset:2048
    v_add_u32 v9, s32, v6
    v_mfma_f32_16x16x32_bf16 v[20:23], v[68:71], v[104:107], v[20:23]
    ds_read_b64_tr_b16 v[52:53], v9 offset:0
    ds_read_b64_tr_b16 v[54:55], v9 offset:2048
    v_mfma_f32_16x16x32_bf16 v[36:39], v[68:71], v[108:111], v[36:39]
    v_add_u32 v10, s32, v1
    ds_read_b64_tr_b16 v[56:57], v10 offset:0
    v_mfma_f32_16x16x32_bf16 v[24:27], v[72:75], v[104:107], v[24:27]
    ds_read_b64_tr_b16 v[58:59], v10 offset:2048
    v_add_u32 v11, s32, v3
    v_mfma_f32_16x16x32_bf16 v[40:43], v[72:75], v[108:111], v[40:43]
    ds_read_b64_tr_b16 v[60:61], v11 offset:0
    ds_read_b64_tr_b16 v[62:63], v11 offset:2048
    v_mfma_f32_16x16x32_bf16 v[28:31], v[76:79], v[104:107], v[28:31]
    v_mfma_f32_16x16x32_bf16 v[44:47], v[76:79], v[108:111], v[44:47]
D_p0:
    s_waitcnt vmcnt(1) lgkmcnt(0)
    v_mfma_f32_16x16x32_bf16 v[16:19], v[48:51], v[80:83], v[16:19]
    ds_read_b64_tr_b16 v[64:65], v8 offset:4096
    ds_read_b64_tr_b16 v[66:67], v8 offset:6144
    v_mfma_f32_16x16x32_bf16 v[32:35], v[48:51], v[84:87], v[32:35]
    ds_read_b64_tr_b16 v[68:69], v9 offset:4096
    ds_read_b64_tr_b16 v[70:71], v9 offset:6144
    v_mfma_f32_16x16x32_bf16 v[20:23], v[52:55], v[80:83], v[20:23]
    ds_read_b64_tr_b16 v[72:73], v10 offset:4096
    ds_read_b64_tr_b16 v[74:75], v10 offset:6144
    v_mfma_f32_16x16x32_bf16 v[36:39], v[52:55], v[84:87], v[36:39]
    ds_read_b64_tr_b16 v[76:77], v11 offset:4096
    ds_read_b64_tr_b16 v[78:79], v11 offset:6144
    v_mfma_f32_16x16x32_bf16 v[24:27], v[56:59], v[80:83], v[24:27]
    v_mfma_f32_16x16x32_bf16 v[40:43], v[56:59], v[84:87], v[40:43]
    v_mfma_f32_16x16x32_bf16 v[28:31], v[60:63], v[80:83], v[28:31]
    v_mfma_f32_16x16x32_bf16 v[44:47], v[60:63], v[84:87], v[44:47]
    s_waitcnt lgkmcnt(0)
    v_mfma_f32_16x16x32_bf16 v[16:19], v[64:67], v[88:91], v[16:19]
    v_mfma_f32_16x16x32_bf16 v[32:35], v[64:67], v[92:95], v[32:35]
    v_mfma_f32_16x16x32_bf16 v[20:23], v[68:71], v[88:91], v[20:23]
    v_mfma_f32_16x16x32_bf16 v[36:39], v[68:71], v[92:95], v[36:39]
    v_mfma_f32_16x16x32_bf16 v[24:27], v[72:75], v[88:91], v[24:27]
    v_mfma_f32_16x16x32_bf16 v[40:43], v[72:75], v[92:95], v[40:43]
    v_mfma_f32_16x16x32_bf16 v[28:31], v[76:79], v[88:91], v[28:31]
    v_mfma_f32_16x16x32_bf16 v[44:47], v[76:79], v[92:95], v[44:47]
    s_cmp_lg_u32 s66, 0
    s_cbranch_scc1 D_wait
D_end:
    s_lshl_b32 s64, s3, 12
    s_add_u32 s64, s64, 8192
    v_lshl_add_u32 v8, v2, 4, s64
    s_xor_b32 s65, s3, 4
    s_lshl_b32 s65, s65, 12
    s_add_u32 s65, s65, 8192
    v_lshl_add_u32 v5, v2, 4, s65
    v_lshlrev_b32 v9, 1, v229
    v_cmp_eq_u32 s[70:71], s67, v230
    s_cmp_eq_u32 s46, 0
    s_cbranch_scc1 P2_y
P2_ny:
    s_barrier
    ds_write_b128 v8, v[32:35] offset:0
    ds_write_b128 v8, v[36:39] offset:1024
    ds_write_b128 v8, v[40:43] offset:2048
    ds_write_b128 v8, v[44:47] offset:3072
    s_cmp_lg_u64 s[70:71], 0
    s_cbranch_scc1 P2_fix
P2_nr:
    s_waitcnt lgkmcnt(0)
    s_barrier
    ds_read_b128 v[64:67], v5 offset:0
    ds_read_b128 v[68:71], v5 offset:1024
    ds_read_b128 v[72:75], v5 offset:2048
    ds_read_b128 v[76:79], v5 offset:3072
    s_waitcnt lgkmcnt(2)
    v_pk_add_f32 v[16:17], v[16:17], v[64:65]
    v_pk_add_f32 v[18:19], v[18:19], v[66:67]
    v_pk_add_f32 v[20:21], v[20:21], v[68:69]
    v_pk_add_f32 v[22:23], v[22:23], v[70:71]
    v_cvt_pk_bf16_f32 v48, v16, v17
    v_cvt_pk_bf16_f32 v49, v18, v19
    v_cvt_pk_bf16_f32 v50, v20, v21
    v_cvt_pk_bf16_f32 v51, v22, v23
    s_nop 0
    v_permlane16_swap_b32 v48, v50
    v_permlane16_swap_b32 v49, v51
    v_lshlrev_b32 v16, 16, v48
    v_and_b32 v17, 0xffff0000, v48
    v_lshlrev_b32 v18, 16, v49
    v_and_b32 v19, 0xffff0000, v49
    v_lshlrev_b32 v20, 16, v50
    v_and_b32 v21, 0xffff0000, v50
    v_lshlrev_b32 v22, 16, v51
    v_and_b32 v23, 0xffff0000, v51
    v_pk_mul_f32 v[16:17], v[16:17], v[228:229] op_sel_hi:[1,0]
    v_pk_mul_f32 v[18:19], v[18:19], v[228:229] op_sel_hi:[1,0]
    v_pk_mul_f32 v[20:21], v[20:21], v[228:229] op_sel_hi:[1,0]
    v_pk_mul_f32 v[22:23], v[22:23], v[228:229] op_sel_hi:[1,0]
    v_cvt_pk_bf16_f32 v48, v16, v17
    v_cvt_pk_bf16_f32 v49, v18, v19
    v_cvt_pk_bf16_f32 v50, v20, v21
    v_cvt_pk_bf16_f32 v51, v22, v23
    v_lshlrev_b32 v16, 16, v48
    v_and_b32 v17, 0xffff0000, v48
    v_lshlrev_b32 v18, 16, v49
    v_and_b32 v19, 0xffff0000, v49
    v_lshlrev_b32 v20, 16, v50
    v_and_b32 v21, 0xffff0000, v50
    v_lshlrev_b32 v22, 16, v51
    v_and_b32 v23, 0xffff0000, v51
    v_pk_add_f32 v[16:17], v[16:17], v[232:233]
    v_pk_add_f32 v[18:19], v[18:19], v[234:235]
    v_pk_add_f32 v[20:21], v[20:21], v[236:237]
    v_pk_add_f32 v[22:23], v[22:23], v[238:239]
    v_cvt_pk_bf16_f32 v120, v16, v17
    v_cvt_pk_bf16_f32 v121, v18, v19
    v_cvt_pk_bf16_f32 v122, v20, v21
    v_cvt_pk_bf16_f32 v123, v22, v23
    v_and_b32 v6, 1, v2
    v_mul_u32_u24 v6, 1984, v6
    v_sub_u32 v231, v231, v6
    s_mov_b32 vcc_lo, 0x55555555
    s_mov_b32 vcc_hi, 0x55555555
    s_waitcnt lgkmcnt(0)
    v_pk_add_f32 v[24:25], v[24:25], v[72:73]
    v_pk_add_f32 v[26:27], v[26:27], v[74:75]
    v_pk_add_f32 v[28:29], v[28:29], v[76:77]
    v_pk_add_f32 v[30:31], v[30:31], v[78:79]
    v_cvt_pk_bf16_f32 v52, v24, v25
    v_cvt_pk_bf16_f32 v53, v26, v27
    v_cvt_pk_bf16_f32 v54, v28, v29
    v_cvt_pk_bf16_f32 v55, v30, v31
    s_nop 0
    v_permlane16_swap_b32 v52, v54
    v_permlane16_swap_b32 v53, v55
    v_lshlrev_b32 v24, 16, v52
    v_and_b32 v25, 0xffff0000, v52
    v_lshlrev_b32 v26, 16, v53
    v_and_b32 v27, 0xffff0000, v53
    v_lshlrev_b32 v28, 16, v54
    v_and_b32 v29, 0xffff0000, v54
    v_lshlrev_b32 v30, 16, v55
    v_and_b32 v31, 0xffff0000, v55
    v_pk_mul_f32 v[24:25], v[24:25], v[228:229] op_sel_hi:[1,0]
    v_pk_mul_f32 v[26:27], v[26:27], v[228:229] op_sel_hi:[1,0]
    v_pk_mul_f32 v[28:29], v[28:29], v[228:229] op_sel_hi:[1,0]
    v_pk_mul_f32 v[30:31], v[30:31], v[228:229] op_sel_hi:[1,0]
    v_cvt_pk_bf16_f32 v52, v24, v25
    v_cvt_pk_bf16_f32 v53, v26, v27
    v_cvt_pk_bf16_f32 v54, v28, v29
    v_cvt_pk_bf16_f32 v55, v30, v31
    v_lshlrev_b32 v24, 16, v52
    v_and_b32 v25, 0xffff0000, v52
    v_lshlrev_b32 v26, 16, v53
    v_and_b32 v27, 0xffff0000, v53
    v_lshlrev_b32 v28, 16, v54
    v_and_b32 v29, 0xffff0000, v54
    v_lshlrev_b32 v30, 16, v55
    v_and_b32 v31, 0xffff0000, v55
    v_pk_add_f32 v[24:25], v[24:25], v[240:241]
    v_pk_add_f32 v[26:27], v[26:27], v[242:243]
    v_pk_add_f32 v[28:29], v[28:29], v[244:245]
    v_pk_add_f32 v[30:31], v[30:31], v[246:247]
    v_cvt_pk_bf16_f32 v124, v24, v25
    v_cvt_pk_bf16_f32 v125, v26, v27
    v_cvt_pk_bf16_f32 v126, v28, v29
    v_cvt_pk_bf16_f32 v127, v30, v31
    s_nop 1
    v_cndmask_b32_dpp v56, v124, v120, vcc quad_perm:[1,0,3,2] row_mask:0xf bank_mask:0xf
    v_cndmask_b32_dpp v57, v125, v121, vcc quad_perm:[1,0,3,2] row_mask:0xf bank_mask:0xf
    v_cndmask_b32_dpp v58, v126, v122, vcc quad_perm:[1,0,3,2] row_mask:0xf bank_mask:0xf
    v_cndmask_b32_dpp v59, v127, v123, vcc quad_perm:[1,0,3,2] row_mask:0xf bank_mask:0xf
    buffer_store_dwordx4 v[56:59], v231, s[20:23], 0 offen nt
    s_not_b64 vcc, vcc
    v_cndmask_b32_dpp v60, v120, v124, vcc quad_perm:[1,0,3,2] row_mask:0xf bank_mask:0xf
    v_cndmask_b32_dpp v61, v121, v125, vcc quad_perm:[1,0,3,2] row_mask:0xf bank_mask:0xf
    v_cndmask_b32_dpp v62, v122, v126, vcc quad_perm:[1,0,3,2] row_mask:0xf bank_mask:0xf
    v_cndmask_b32_dpp v63, v123, v127, vcc quad_perm:[1,0,3,2] row_mask:0xf bank_mask:0xf
    buffer_store_dwordx4 v[60:63], v231, s[20:23], 0 offen offset:2048 nt
K_end:
    s_endpgm
H_nre:
    s_add_u32 s65, s65, 1
    s_cmp_ge_u32 s65, 200000
    s_cbranch_scc1 H_nok
    s_sleep 4
    buffer_load_dword v78, v79, s[20:23], 0 offen sc1
    s_waitcnt vmcnt(0)
    s_branch H_nspin
H_retry:
    s_add_u32 s65, s65, 1
    s_cmp_ge_u32 s65, 200000
    s_cbranch_scc1 H_nq
    s_sleep 8
    s_mov_b32 s64, 6717440
    buffer_load_dwordx4 v[24:27], v6, s[16:19], s64 offen offset:0 sc1
    buffer_load_dwordx4 v[28:31], v6, s[16:19], s64 offen offset:1024 sc1
    s_waitcnt vmcnt(0)
    s_branch H_spin
G_f15:
    s_bitset1_b32 s66, s55
    s_branch G_q15
G_f14:
    s_bitset1_b32 s66, s54
    s_branch G_q14
G_f13:
    s_bitset1_b32 s66, s53
    s_branch G_q13
G_f12:
    s_bitset1_b32 s66, s52
    s_branch G_q12
G_f11:
    s_bitset1_b32 s66, s51
    s_branch G_q11
G_f10:
    s_bitset1_b32 s66, s50
    s_branch G_q10
G_f9:
    s_bitset1_b32 s66, s49
    s_branch G_q9
G_f8:
    s_bitset1_b32 s66, s48
    s_branch G_q8
G_f7:
    s_bitset1_b32 s66, s47
    s_branch G_q7
G_f6:
    s_bitset1_b32 s66, s46
    s_branch G_q6
G_f5:
    s_bitset1_b32 s66, s45
    s_branch G_q5
G_f4:
    s_bitset1_b32 s66, s44
    s_branch G_q4
G_f3:
    s_bitset1_b32 s66, s43
    s_branch G_q3
G_f2:
    s_bitset1_b32 s66, s42
    s_branch G_q2
G_f1:
    s_bitset1_b32 s66, s41
    s_branch G_q1
G_f0:
    s_bitset1_b32 s66, s40
    s_branch G_q0
phi_15_fix:
    v_lshlrev_b32 v48, 16, v16
    v_and_b32 v49, 0xffff0000, v16
    v_add_f32 v48, s73, v48
    v_add_f32 v49, s73, v49
    v_cvt_pk_bf16_f32 v16, v48, v49
    v_lshlrev_b32 v48, 16, v17
    v_and_b32 v49, 0xffff0000, v17
    v_add_f32 v48, s73, v48
    v_add_f32 v49, s73, v49
    v_cvt_pk_bf16_f32 v17, v48, v49
    v_lshlrev_b32 v48, 16, v18
    v_and_b32 v49, 0xffff0000, v18
    v_add_f32 v48, s73, v48
    v_add_f32 v49, s73, v49
    v_cvt_pk_bf16_f32 v18, v48, v49
    v_lshlrev_b32 v48, 16, v19
    v_and_b32 v49, 0xffff0000, v19
    v_add_f32 v48, s73, v48
    v_add_f32 v49, s73, v49
    v_cvt_pk_bf16_f32 v19, v48, v49
    v_lshlrev_b32 v48, 16, v20
    v_and_b32 v49, 0xffff0000, v20
    v_add_f32 v48, s73, v48
    v_add_f32 v49, s73, v49
    v_cvt_pk_bf16_f32 v20, v48, v49
    v_lshlrev_b32 v48, 16, v21
    v_and_b32 v49, 0xffff0000, v21
    v_add_f32 v48, s73, v48
    v_add_f32 v49, s73, v49
    v_cvt_pk_bf16_f32 v21, v48, v49
    v_lshlrev_b32 v48, 16, v22
    v_and_b32 v49, 0xffff0000, v22
    v_add_f32 v48, s73, v48
    v_add_f32 v49, s73, v49
    v_cvt_pk_bf16_f32 v22, v48, v49
    v_lshlrev_b32 v48, 16, v23
    v_and_b32 v49, 0xffff0000, v23
    v_add_f32 v48, s73, v48
    v_add_f32 v49, s73, v49
    v_cvt_pk_bf16_f32 v23, v48, v49
    s_branch phi_15_done
phi_16_fix:
    v_lshlrev_b32 v48, 16, v24
    v_and_b32 v49, 0xffff0000, v24
    v_add_f32 v48, s73, v48
    v_add_f32 v49, s73, v49
    v_cvt_pk_bf16_f32 v24, v48, v49
    v_lshlrev_b32 v48, 16, v25
    v_and_b32 v49, 0xffff0000, v25
    v_add_f32 v48, s73, v48
    v_add_f32 v49, s73, v49
    v_cvt_pk_bf16_f32 v25, v48, v49
    v_lshlrev_b32 v48, 16, v26
    v_and_b32 v49, 0xffff0000, v26
    v_add_f32 v48, s73, v48
    v_add_f32 v49, s73, v49
    v_cvt_pk_bf16_f32 v26, v48, v49
    v_lshlrev_b32 v48, 16, v27
    v_and_b32 v49, 0xffff0000, v27
    v_add_f32 v48, s73, v48
    v_add_f32 v49, s73, v49
    v_cvt_pk_bf16_f32 v27, v48, v49
    v_lshlrev_b32 v48, 16, v28
    v_and_b32 v49, 0xffff0000, v28
    v_add_f32 v48, s73, v48
    v_add_f32 v49, s73, v49
    v_cvt_pk_bf16_f32 v28, v48, v49
    v_lshlrev_b32 v48, 16, v29
    v_and_b32 v49, 0xffff0000, v29
    v_add_f32 v48, s73, v48
    v_add_f32 v49, s73, v49
    v_cvt_pk_bf16_f32 v29, v48, v49
    v_lshlrev_b32 v48, 16, v30
    v_and_b32 v49, 0xffff0000, v30
    v_add_f32 v48, s73, v48
    v_add_f32 v49, s73, v49
    v_cvt_pk_bf16_f32 v30, v48, v49
    v_lshlrev_b32 v48, 16, v31
    v_and_b32 v49, 0xffff0000, v31
    v_add_f32 v48, s73, v48
    v_add_f32 v49, s73, v49
    v_cvt_pk_bf16_f32 v31, v48, v49
    s_branch phi_16_done
C_ex1:
    ds_write_b32 v227, v52 offset:4608
    ds_write_b128 v224, v[240:243] offset:32768
    ds_write_b128 v224, v[244:247] offset:33792
    s_nop 4
    v_mov_b32 v52, v60
    v_mov_b32 v240, v248
    v_mov_b32 v241, v249
    v_mov_b32 v242, v250
    v_mov_b32 v243, v251
    v_mov_b32 v244, v252
    v_mov_b32 v245, v253
    v_mov_b32 v246, v254
    v_mov_b32 v247, v255
    s_branch C_ex2
phi_17_fix:
    v_lshlrev_b32 v48, 16, v32
    v_and_b32 v49, 0xffff0000, v32
    v_add_f32 v48, s73, v48
    v_add_f32 v49, s73, v49
    v_cvt_pk_bf16_f32 v32, v48, v49
    v_lshlrev_b32 v48, 16, v33
    v_and_b32 v49, 0xffff0000, v33
    v_add_f32 v48, s73, v48
    v_add_f32 v49, s73, v49
    v_cvt_pk_bf16_f32 v33, v48, v49
    v_lshlrev_b32 v48, 16, v34
    v_and_b32 v49, 0xffff0000, v34
    v_add_f32 v48, s73, v48
    v_add_f32 v49, s73, v49
    v_cvt_pk_bf16_f32 v34, v48, v49
    v_lshlrev_b32 v48, 16, v35
    v_and_b32 v49, 0xffff0000, v35
    v_add_f32 v48, s73, v48
    v_add_f32 v49, s73, v49
    v_cvt_pk_bf16_f32 v35, v48, v49
    v_lshlrev_b32 v48, 16, v36
    v_and_b32 v49, 0xffff0000, v36
    v_add_f32 v48, s73, v48
    v_add_f32 v49, s73, v49
    v_cvt_pk_bf16_f32 v36, v48, v49
    v_lshlrev_b32 v48, 16, v37
    v_and_b32 v49, 0xffff0000, v37
    v_add_f32 v48, s73, v48
    v_add_f32 v49, s73, v49
    v_cvt_pk_bf16_f32 v37, v48, v49
    v_lshlrev_b32 v48, 16, v38
    v_and_b32 v49, 0xffff0000, v38
    v_add_f32 v48, s73, v48
    v_add_f32 v49, s73, v49
    v_cvt_pk_bf16_f32 v38, v48, v49
    v_lshlrev_b32 v48, 16, v39
    v_and_b32 v49, 0xffff0000, v39
    v_add_f32 v48, s73, v48
    v_add_f32 v49, s73, v49
    v_cvt_pk_bf16_f32 v39, v48, v49
    s_branch phi_17_done
phi_18_fix:
    v_lshlrev_b32 v48, 16, v40
    v_and_b32 v49, 0xffff0000, v40
    v_add_f32 v48, s73, v48
    v_add_f32 v49, s73, v49
    v_cvt_pk_bf16_f32 v40, v48, v49
    v_lshlrev_b32 v48, 16, v41
    v_and_b32 v49, 0xffff0000, v41
    v_add_f32 v48, s73, v48
    v_add_f32 v49, s73, v49
    v_cvt_pk_bf16_f32 v41, v48, v49
    v_lshlrev_b32 v48, 16, v42
    v_and_b32 v49, 0xffff0000, v42
    v_add_f32 v48, s73, v48
    v_add_f32 v49, s73, v49
    v_cvt_pk_bf16_f32 v42, v48, v49
    v_lshlrev_b32 v48, 16, v43
    v_and_b32 v49, 0xffff0000, v43
    v_add_f32 v48, s73, v48
    v_add_f32 v49, s73, v49
    v_cvt_pk_bf16_f32 v43, v48, v49
    v_lshlrev_b32 v48, 16, v44
    v_and_b32 v49, 0xffff0000, v44
    v_add_f32 v48, s73, v48
    v_add_f32 v49, s73, v49
    v_cvt_pk_bf16_f32 v44, v48, v49
    v_lshlrev_b32 v48, 16, v45
    v_and_b32 v49, 0xffff0000, v45
    v_add_f32 v48, s73, v48
    v_add_f32 v49, s73, v49
    v_cvt_pk_bf16_f32 v45, v48, v49
    v_lshlrev_b32 v48, 16, v46
    v_and_b32 v49, 0xffff0000, v46
    v_add_f32 v48, s73, v48
    v_add_f32 v49, s73, v49
    v_cvt_pk_bf16_f32 v46, v48, v49
    v_lshlrev_b32 v48, 16, v47
    v_and_b32 v49, 0xffff0000, v47
    v_add_f32 v48, s73, v48
    v_add_f32 v49, s73, v49
    v_cvt_pk_bf16_f32 v47, v48, v49
    s_branch phi_18_done
P2_ys:
    v_lshrrev_b32 v13, 4, v2
    v_lshlrev_b32 v13, 12, v13
    v_and_b32 v208, 15, v2
    v_lshl_add_u32 v13, v208, 4, v13
    s_lshl_b32 s64, s5, 8
    v_add_u32 v13, s64, v13
    s_lshl_b32 s64, s67, 11
    s_lshl_b32 s65, s5, 7
    s_add_u32 s64, s64, s65
    v_lshl_add_u32 v209, v208, 3, s64
    s_lshl_b32 s64, s67, 2
    s_add_u32 s64, s64, 6709248
    v_mov_b32 v215, s64
    s_branch P2_ysd
P2_yl:
    s_cmp_gt_u32 s70, 4
    s_cbranch_scc1 P2_nyl
    buffer_load_dwordx2 v[210:211], v209, s[8:11], 0 offen
    buffer_load_dword v212, v215, s[16:19], 0 offen sc1
    s_mov_b32 s69, 6447104
    buffer_load_dwordx4 v[144:147], v13, s[16:19], s69 offen sc1
    s_mov_b32 s69, 6463488
    buffer_load_dwordx4 v[148:151], v13, s[16:19], s69 offen sc1
    s_mov_b32 s69, 6479872
    buffer_load_dwordx4 v[152:155], v13, s[16:19], s69 offen sc1
    s_mov_b32 s69, 6496256
    buffer_load_dwordx4 v[156:159], v13, s[16:19], s69 offen sc1
    s_mov_b32 s69, 6512640
    buffer_load_dwordx4 v[160:163], v13, s[16:19], s69 offen sc1
    s_mov_b32 s69, 6529024
    buffer_load_dwordx4 v[164:167], v13, s[16:19], s69 offen sc1
    s_mov_b32 s69, 6545408
    buffer_load_dwordx4 v[168:171], v13, s[16:19], s69 offen sc1
    s_mov_b32 s69, 6561792
    buffer_load_dwordx4 v[172:175], v13, s[16:19], s69 offen sc1
    s_mov_b32 s69, 6578176
    buffer_load_dwordx4 v[176:179], v13, s[16:19], s69 offen sc1
    s_mov_b32 s69, 6594560
    buffer_load_dwordx4 v[180:183], v13, s[16:19], s69 offen sc1
    s_mov_b32 s69, 6610944
    buffer_load_dwordx4 v[184:187], v13, s[16:19], s69 offen sc1
    s_mov_b32 s69, 6627328
    buffer_load_dwordx4 v[188:191], v13, s[16:19], s69 offen sc1
    s_mov_b32 s69, 6643712
    buffer_load_dwordx4 v[192:195], v13, s[16:19], s69 offen sc1
    s_mov_b32 s69, 6660096
    buffer_load_dwordx4 v[196:199], v13, s[16:19], s69 offen sc1
    s_mov_b32 s69, 6676480
    buffer_load_dwordx4 v[200:203], v13, s[16:19], s69 offen sc1
    s_mov_b32 s69, 6692864
    buffer_load_dwordx4 v[204:207], v13, s[16:19], s69 offen sc1
    s_mov_b32 s47, 1
    s_branch P2_nyl
P2_y:
    s_mov_b32 s66, 0
    s_cmp_lg_u32 s47, 0
    s_cbranch_scc1 P2_ychk
P2_yre:
    buffer_load_dwordx2 v[210:211], v209, s[8:11], 0 offen
    buffer_load_dword v212, v215, s[16:19], 0 offen sc1
    s_mov_b32 s69, 6447104
    buffer_load_dwordx4 v[144:147], v13, s[16:19], s69 offen sc1
    s_mov_b32 s69, 6463488
    buffer_load_dwordx4 v[148:151], v13, s[16:19], s69 offen sc1
    s_mov_b32 s69, 6479872
    buffer_load_dwordx4 v[152:155], v13, s[16:19], s69 offen sc1
    s_mov_b32 s69, 6496256
    buffer_load_dwordx4 v[156:159], v13, s[16:19], s69 offen sc1
    s_mov_b32 s69, 6512640
    buffer_load_dwordx4 v[160:163], v13, s[16:19], s69 offen sc1
    s_mov_b32 s69, 6529024
    buffer_load_dwordx4 v[164:167], v13, s[16:19], s69 offen sc1
    s_mov_b32 s69, 6545408
    buffer_load_dwordx4 v[168:171], v13, s[16:19], s69 offen sc1
    s_mov_b32 s69, 6561792
    buffer_load_dwordx4 v[172:175], v13, s[16:19], s69 offen sc1
    s_mov_b32 s69, 6578176
    buffer_load_dwordx4 v[176:179], v13, s[16:19], s69 offen sc1
    s_mov_b32 s69, 6594560
    buffer_load_dwordx4 v[180:183], v13, s[16:19], s69 offen sc1
    s_mov_b32 s69, 6610944
    buffer_load_dwordx4 v[184:187], v13, s[16:19], s69 offen sc1
    s_mov_b32 s69, 6627328
    buffer_load_dwordx4 v[188:191], v13, s[16:19], s69 offen sc1
    s_mov_b32 s69, 6643712
    buffer_load_dwordx4 v[192:195], v13, s[16:19], s69 offen sc1
    s_mov_b32 s69, 6660096
    buffer_load_dwordx4 v[196:199], v13, s[16:19], s69 offen sc1
    s_mov_b32 s69, 6676480
    buffer_load_dwordx4 v[200:203], v13, s[16:19], s69 offen sc1
    s_mov_b32 s69, 6692864
    buffer_load_dwordx4 v[204:207], v13, s[16:19], s69 offen sc1
P2_ychk:
    s_and_b32 s64, s75, 0xffff0000
    s_xor_b32 s65, s64, 0x80000000
    s_not_b32 s69, s64
    s_and_b32 s69, s69, 0xffff0000
    s_cmp_ge_u32 s64, 0x80000000
    s_cselect_b32 s64, s65, s69
    v_mov_b32 v213, s64
    v_mul_f32 v213, s72, v213
    v_exp_f32 v213, -v213
    s_nop 0
    v_add_f32 v213, 1.0, v213
    v_rcp_f32 v213, v213
    s_nop 0
    v_cvt_pk_bf16_f32 v213, v213, v213
    v_lshlrev_b32 v213, 16, v213
    s_waitcnt vmcnt(0)
    v_sub_f32 v214, 1.0, v212
    v_cvt_pk_bf16_f32 v214, v214, v214
    v_lshlrev_b32 v214, 16, v214
    v_max3_u32 v10, v144, v145, v146
    v_max3_u32 v10, v147, v148, v10
    v_max3_u32 v10, v149, v150, v10
    v_max3_u32 v10, v151, v152, v10
    v_max3_u32 v10, v153, v154, v10
    v_max3_u32 v10, v155, v156, v10
    v_max3_u32 v10, v157, v158, v10
    v_max3_u32 v10, v159, v160, v10
    v_max3_u32 v10, v161, v162, v10
    v_max3_u32 v10, v163, v164, v10
    v_max3_u32 v10, v165, v166, v10
    v_max3_u32 v10, v167, v168, v10
    v_max3_u32 v10, v169, v170, v10
    v_max3_u32 v10, v171, v172, v10
    v_max3_u32 v10, v173, v174, v10
    v_max3_u32 v10, v175, v176, v10
    v_max3_u32 v10, v177, v178, v10
    v_max3_u32 v10, v179, v180, v10
    v_max3_u32 v10, v181, v182, v10
    v_max3_u32 v10, v183, v184, v10
    v_max3_u32 v10, v185, v186, v10
    v_max3_u32 v10, v187, v188, v10
    v_max3_u32 v10, v189, v190, v10
    v_max3_u32 v10, v191, v192, v10
    v_max3_u32 v10, v193, v194, v10
    v_max3_u32 v10, v195, v196, v10
    v_max3_u32 v10, v197, v198, v10
    v_max3_u32 v10, v199, v200, v10
    v_max3_u32 v10, v201, v202, v10
    v_max3_u32 v10, v203, v204, v10
    v_max3_u32 v10, v205, v206, v10
    v_max_u32 v10, v207, v10
    v_cmp_eq_u32 vcc, -1, v10
    s_cbranch_vccz P2_yok
    s_add_u32 s66, s66, 1
    s_cmp_ge_u32 s66, 40000
    s_cbranch_scc1 P2_yok
    s_sleep 4
    s_branch P2_yre
P2_yok:
    v_pk_add_f32 v[144:145], v[144:145], v[176:177]
    v_pk_add_f32 v[146:147], v[146:147], v[178:179]
    v_pk_add_f32 v[148:149], v[148:149], v[180:181]
    v_pk_add_f32 v[150:151], v[150:151], v[182:183]
    v_pk_add_f32 v[152:153], v[152:153], v[184:185]
    v_pk_add_f32 v[154:155], v[154:155], v[186:187]
    v_pk_add_f32 v[156:157], v[156:157], v[188:189]
    v_pk_add_f32 v[158:159], v[158:159], v[190:191]
    v_pk_add_f32 v[160:161], v[160:161], v[192:193]
    v_pk_add_f32 v[162:163], v[162:163], v[194:195]
    v_pk_add_f32 v[164:165], v[164:165], v[196:197]
    v_pk_add_f32 v[166:167], v[166:167], v[198:199]
    v_pk_add_f32 v[168:169], v[168:169], v[200:201]
    v_pk_add_f32 v[170:171], v[170:171], v[202:203]
    v_pk_add_f32 v[172:173], v[172:173], v[204:205]
    v_pk_add_f32 v[174:175], v[174:175], v[206:207]
    v_pk_add_f32 v[144:145], v[144:145], v[160:161]
    v_pk_add_f32 v[146:147], v[146:147], v[162:163]
    v_pk_add_f32 v[148:149], v[148:149], v[164:165]
    v_pk_add_f32 v[150:151], v[150:151], v[166:167]
    v_pk_add_f32 v[152:153], v[152:153], v[168:169]
    v_pk_add_f32 v[154:155], v[154:155], v[170:171]
    v_pk_add_f32 v[156:157], v[156:157], v[172:173]
    v_pk_add_f32 v[158:159], v[158:159], v[174:175]
    v_pk_add_f32 v[144:145], v[144:145], v[152:153]
    v_pk_add_f32 v[146:147], v[146:147], v[154:155]
    v_pk_add_f32 v[148:149], v[148:149], v[156:157]
    v_pk_add_f32 v[150:151], v[150:151], v[158:159]
    v_pk_add_f32 v[144:145], v[144:145], v[148:149]
    v_pk_add_f32 v[146:147], v[146:147], v[150:151]
    v_mov_b32 v148, v144
    v_mov_b32 v149, v145
    v_mov_b32 v150, v146
    v_mov_b32 v151, v147
    s_nop 0
    v_permlane16_swap_b32 v144, v148
    v_permlane16_swap_b32 v145, v149
    v_permlane16_swap_b32 v146, v150
    v_permlane16_swap_b32 v147, v151
    v_add_f32 v144, v144, v148
    v_add_f32 v145, v145, v149
    v_add_f32 v146, v146, v150
    v_add_f32 v147, v147, v151
    v_mov_b32 v148, v144
    v_mov_b32 v149, v145
    v_mov_b32 v150, v146
    v_mov_b32 v151, v147
    s_nop 0
    v_permlane32_swap_b32 v144, v148
    v_permlane32_swap_b32 v145, v149
    v_permlane32_swap_b32 v146, v150
    v_permlane32_swap_b32 v147, v151
    v_add_f32 v144, v144, v148
    v_add_f32 v145, v145, v149
    v_add_f32 v146, v146, v150
    v_add_f32 v147, v147, v151
    v_cvt_pk_bf16_f32 v152, v144, v145
    v_lshlrev_b32 v144, 16, v152
    v_and_b32 v145, 0xffff0000, v152
    v_mul_f32 v144, v144, v213
    v_mul_f32 v145, v145, v213
    v_cvt_pk_bf16_f32 v152, v144, v145
    v_lshlrev_b32 v144, 16, v152
    v_and_b32 v145, 0xffff0000, v152
    v_lshlrev_b32 v148, 16, v210
    v_and_b32 v149, 0xffff0000, v210
    v_add_f32 v144, v148, v144
    v_add_f32 v145, v149, v145
    v_cvt_pk_bf16_f32 v152, v144, v145
    v_lshlrev_b32 v144, 16, v152
    v_and_b32 v145, 0xffff0000, v152
    v_mul_f32 v144, v144, v214
    v_mul_f32 v145, v145, v214
    v_cvt_pk_bf16_f32 v152, v144, v145
    v_lshlrev_b32 v144, 16, v152
    v_and_b32 v145, 0xffff0000, v152
    v_cvt_pk_bf16_f32 v152, v146, v147
    v_lshlrev_b32 v146, 16, v152
    v_and_b32 v147, 0xffff0000, v152
    v_mul_f32 v146, v146, v213
    v_mul_f32 v147, v147, v213
    v_cvt_pk_bf16_f32 v152, v146, v147
    v_lshlrev_b32 v146, 16, v152
    v_and_b32 v147, 0xffff0000, v152
    v_lshlrev_b32 v150, 16, v211
    v_and_b32 v151, 0xffff0000, v211
    v_add_f32 v146, v150, v146
    v_add_f32 v147, v151, v147
    v_cvt_pk_bf16_f32 v152, v146, v147
    v_lshlrev_b32 v146, 16, v152
    v_and_b32 v147, 0xffff0000, v152
    v_mul_f32 v146, v146, v214
    v_mul_f32 v147, v147, v214
    v_cvt_pk_bf16_f32 v152, v146, v147
    v_lshlrev_b32 v146, 16, v152
    v_and_b32 v147, 0xffff0000, v152
    v_lshlrev_b32 v208, 4, v208
    ds_write_b128 v208, v[144:147] offset:5632
    s_waitcnt lgkmcnt(0)
    s_branch P2_ny
P2_fix:
    s_mov_b64 exec, s[70:71]
    ds_read_b128 v[232:235], v9 offset:5632
    ds_read_b128 v[236:239], v9 offset:5648
    ds_read_b128 v[240:243], v9 offset:5760
    ds_read_b128 v[244:247], v9 offset:5776
    s_mov_b64 exec, -1
    s_branch P2_nr
CODE_END:
.section .rodata,"a"
.p2align 6
.amdhsa_kernel gated_mix__linear_attn_block__moe_arch_mod__prompt_kernel
  .amdhsa_next_free_vgpr 256
  .amdhsa_next_free_sgpr 102
  .amdhsa_accum_offset 256
  .amdhsa_group_segment_fixed_size 0
  .amdhsa_kernarg_size 96
  .amdhsa_user_sgpr_count 2
  .amdhsa_user_sgpr_kernarg_segment_ptr 1
  .amdhsa_system_sgpr_workgroup_id_x 1
.end_amdhsa_kernel
```

```asm
; @launch grid=(256,1,1) block=(512,1,1) lds=163840
.amdgcn_target "amdgcn-amd-amdhsa--gfx950"
.text
.globl gated_mix__linear_attn_block__moe_arch_mod__prompt_kernel
.p2align 8
.type gated_mix__linear_attn_block__moe_arch_mod__prompt_kernel,@function
gated_mix__linear_attn_block__moe_arch_mod__prompt_kernel:
    s_load_dwordx16 s[40:55], s[0:1], 0
    s_load_dwordx8 s[56:63], s[0:1], 64
    s_cmp_ge_u32 s2, 256
    s_cbranch_scc1 K_end
    v_lshrrev_b32 v1, 6, v0
    v_and_b32 v2, 63, v0
    s_and_b32 s6, s2, 7
    v_readfirstlane_b32 s3, v1
    s_lshr_b32 s7, s2, 3
    s_and_b32 s4, s6, 1
    s_lshl_b32 s4, s4, 3
    s_and_b32 s64, s7, 7
    s_add_u32 s4, s4, s64
    s_lshr_b32 s5, s6, 1
    s_lshl_b32 s5, s5, 2
    s_lshr_b32 s64, s7, 3
    s_add_u32 s5, s5, s64
    s_and_b32 s74, s4, 3
    s_lshl_b32 s74, s74, 2
    s_add_u32 s74, s74, s6
    v_lshrrev_b32 v6, 3, v2
    s_lshl_b32 s65, s3, 3
    v_add_u32 v6, s65, v6
    s_lshl_b32 s64, s4, 7
    v_add_u32 v7, s64, v6
    v_lshlrev_b32 v7, 11, v7
    v_lshrrev_b32 v8, 4, v2
    s_and_b32 s64, s3, 1
    s_lshl_b32 s64, s64, 2
    v_add_u32 v9, s64, v8
    v_and_b32 v10, 7, v2
    v_xor_b32 v9, v9, v10
    v_lshl_add_u32 v7, v9, 4, v7
    v_mul_u32_u24 v6, 6144, v6
    v_and_b32 v9, 1, v8
    s_lshr_b32 s64, s64, 1
    v_lshl_add_u32 v9, v9, 2, s64
    v_xor_b32 v9, v9, v10
    v_lshl_add_u32 v6, v9, 4, v6
    s_lshl_b32 s64, s5, 7
    v_add_u32 v6, s64, v6
    s_lshl_b32 s66, s3, 10
    s_mov_b32 s10, 4194304
    s_mov_b32 s11, 0x00020000
    s_mov_b32 s14, 6291456
    s_mov_b32 s15, 0x00020000
    s_add_u32 s65, s74, 0
    s_and_b32 s65, s65, 15
    s_lshl_b32 s67, s65, 7
    s_mul_i32 s65, s65, 393216
    s_waitcnt lgkmcnt(0)
    s_mov_b32 s8, s40
    s_mov_b32 s9, s41
    s_mov_b32 s12, s42
    s_mov_b32 s13, s43
    s_add_u32 m0, s66, 8192
    s_add_u32 s64, s67, 0
    buffer_load_dwordx4 v7, s[8:11], s64 offen lds
    s_add_u32 m0, s66, 16384
    s_add_u32 s64, s67, 131072
    buffer_load_dwordx4 v7, s[8:11], s64 offen lds
    s_add_u32 m0, s66, 24576
    s_add_u32 s64, s65, 0
    buffer_load_dwordx4 v6, s[12:15], s64 offen lds
    s_add_u32 m0, s66, 32768
    s_add_u32 s64, s65, 2048
    buffer_load_dwordx4 v6, s[12:15], s64 offen lds
    s_add_u32 m0, s66, 40960
    s_add_u32 s64, s65, 4096
    buffer_load_dwordx4 v6, s[12:15], s64 offen lds
    s_barrier
    s_mov_b32 s72, 0x3fb8aa3b
    s_mov_b32 s73, 0x358637bd
    s_mov_b32 s16, s62
    s_mov_b32 s17, s63
    s_mov_b32 s18, 0x10000000
    s_mov_b32 s19, 0x00020000
    s_cmp_lt_u32 s3, 4
    s_cbranch_scc1 C_start
    s_sub_u32 s6, s3, 4
    s_lshl_b32 s7, s6, 10
    v_lshrrev_b32 v6, 3, v2
    s_lshl_b32 s64, s4, 7
    s_lshl_b32 s65, s6, 3
    s_add_u32 s64, s64, s65
    v_add_u32 v7, s64, v6
    v_lshlrev_b32 v7, 11, v7
    s_and_b32 s64, s6, 1
    s_lshl_b32 s64, s64, 2
    v_add_u32 v9, s64, v8
    v_xor_b32 v9, v9, v10
    v_lshl_add_u32 v4, v9, 4, v7
    v_add_u32 v7, s65, v6
    v_mul_u32_u24 v7, 6144, v7
    v_and_b32 v9, 1, v8
    s_lshr_b32 s64, s64, 1
    v_lshl_add_u32 v9, v9, 2, s64
    v_xor_b32 v9, v9, v10
    v_lshl_add_u32 v7, v9, 4, v7
    s_lshl_b32 s64, s5, 7
    v_add_u32 v5, s64, v7
    v_lshlrev_b32 v6, 4, v2
    s_and_b32 s64, s2, 1
    s_lshl_b32 s68, s64, 10
    s_bfe_u32 s64, s2, 0x20001
    s_lshl_b32 s64, s64, 8
    s_add_u32 s68, s68, s64
    s_and_b32 s64, s2, 0xf8
    s_add_u32 s68, s68, s64
    s_lshl_b32 s64, s6, 1
    s_add_u32 s68, s68, s64
    s_lshl_b32 s64, s68, 11
    v_add_u32 v13, s64, v6
    s_add_u32 s41, s74, 1
    s_and_b32 s41, s41, 15
    s_lshl_b32 s42, s41, 7
    s_mul_i32 s41, s41, 393216
    s_add_u32 m0, s7, 49152
    s_add_u32 s40, s42, 0
    buffer_load_dwordx4 v4, s[8:11], s40 offen lds
    s_add_u32 m0, s7, 53248
    s_add_u32 s40, s42, 65536
    buffer_load_dwordx4 v4, s[8:11], s40 offen lds
    s_add_u32 m0, s7, 57344
    s_add_u32 s40, s42, 131072
    buffer_load_dwordx4 v4, s[8:11], s40 offen lds
    s_add_u32 m0, s7, 61440
    s_add_u32 s40, s42, 196608
    buffer_load_dwordx4 v4, s[8:11], s40 offen lds
    s_add_u32 m0, s7, 65536
    s_add_u32 s40, s41, 0
    buffer_load_dwordx4 v5, s[12:15], s40 offen lds
    s_add_u32 m0, s7, 69632
    s_add_u32 s40, s41, 196608
    buffer_load_dwordx4 v5, s[12:15], s40 offen lds
    s_add_u32 m0, s7, 73728
    s_add_u32 s40, s41, 2048
    buffer_load_dwordx4 v5, s[12:15], s40 offen lds
    s_add_u32 m0, s7, 77824
    s_add_u32 s40, s41, 198656
    buffer_load_dwordx4 v5, s[12:15], s40 offen lds
    s_add_u32 m0, s7, 81920
    s_add_u32 s40, s41, 4096
    buffer_load_dwordx4 v5, s[12:15], s40 offen lds
    s_add_u32 m0, s7, 86016
    s_add_u32 s40, s41, 200704
    buffer_load_dwordx4 v5, s[12:15], s40 offen lds
    s_mov_b32 s32, s50
    s_mov_b32 s33, s51
    s_mov_b32 s34, 0x700000
    s_mov_b32 s35, 0x00020000
    s_mov_b32 s36, s52
    s_mov_b32 s37, s53
    s_mov_b32 s38, 0x700000
    s_mov_b32 s39, 0x00020000
    s_or_b32 s64, s2, s6
    s_cmp_lg_u32 s64, 0
    s_cbranch_scc1 H_nn
    s_mov_b32 s64, 6717440
    s_load_dwordx2 s[66:67], s[62:63], s64
    s_mov_b32 s20, s60
    s_mov_b32 s21, s61
    s_mov_b32 s22, 0x100
    s_mov_b32 s23, 0x00020000
    s_waitcnt lgkmcnt(0)
    s_xor_b32 s64, s66, s67
    s_add_u32 s64, s64, 1
    s_max_u32 s64, s64, 1
    v_mov_b32 v72, s64
    v_mov_b32 v73, 0
    s_mov_b64 exec, 1
    buffer_store_dword v72, v73, s[20:23], 0 offen sc0 sc1
    s_mov_b64 exec, -1
H_nn:
    s_mov_b32 s20, s60
    s_mov_b32 s21, s61
    s_mov_b32 s22, 0x100
    s_mov_b32 s23, 0x00020000
    s_mov_b32 s24, s48
    s_mov_b32 s25, s49
    s_mov_b32 s26, 0x800
    s_mov_b32 s27, 0x00020000
    s_mov_b32 s28, s56
    s_mov_b32 s29, s57
    s_mov_b32 s30, 0x800
    s_mov_b32 s31, 0x00020000
    s_lshr_b32 s69, s2, 3
    s_and_b32 s64, s2, 7
    v_and_b32 v9, 15, v2
    v_min_u32 v9, 13, v9
    s_lshl_b32 s65, s69, 5
    v_lshl_add_u32 v7, v8, 3, s65
    v_mul_u32_u24 v7, 7168, v7
    s_mul_i32 s65, s64, 896
    s_mul_i32 s66, s6, 224
    s_add_u32 s65, s65, s66
    v_lshl_add_u32 v7, v9, 4, v7
    v_add_u32 v11, s65, v7
    v_cmp_le_u32 vcc, 7, v9
    v_mov_b32 v15, 16160
    s_nop 0
    v_cndmask_b32 v7, 0, v15, vcc
    v_lshl_add_u32 v7, v9, 5, v7
    v_lshrrev_b32 v15, 1, v8
    v_lshl_add_u32 v7, v15, 13, v7
    v_and_b32 v15, 1, v8
    v_lshl_add_u32 v7, v15, 4, v7
    s_lshl_b32 s64, s64, 17
    s_lshl_b32 s65, s6, 15
    s_add_u32 s64, s64, s65
    s_lshl_b32 s65, s69, 8
    s_add_u32 s64, s64, s65
    s_add_u32 s64, s64, 5398528
    v_add_u32 v12, s64, v7
    s_lshl_b32 s70, s5, 2
    s_add_u32 s70, s70, s6
    s_mul_i32 s70, s70, 18432
    s_add_u32 s70, s70, 4194304
    s_mul_i32 s64, s4, 1152
    s_add_u32 s64, s64, s70
    s_mov_b32 s67, s64
    v_lshl_add_u32 v15, v2, 2, s64
    v_add_u32 v15, 960, v15
    s_lshl_b32 s64, s5, 2
    s_add_u32 s64, s64, s6
    s_lshl_b32 s64, s64, 7
    s_add_u32 s64, s64, 5373952
    v_mov_b32 v23, s64
    s_lshl_b32 s65, s4, 10
    s_add_u32 s65, s65, 5382016
    v_lshl_add_u32 v20, v2, 7, s65
    v_cmp_gt_u32 vcc, 16, v2
    s_nop 1
    v_cndmask_b32 v15, v15, v20, vcc
    v_writelane_b32 v15, s64, 0
    s_cmp_eq_u32 s4, 0
    s_cselect_b32 s75, 1, 0
    s_or_b32 s64, s5, s6
    s_cmp_eq_u32 s64, 0
    s_cselect_b32 s64, 0x1fe, 0
    s_or_b32 s75, s75, s64
    s_or_b32 s75, s75, 0xffff0000
    v_add_u32 v22, s67, v6
    v_mov_b32 v16, -1
    v_mov_b32 v17, -1
    v_mov_b32 v18, -1
    v_mov_b32 v19, -1
    v_cndmask_b32 v20, -1, 0, vcc
    s_waitcnt vmcnt(10)
    s_barrier
    s_add_u32 s41, s74, 2
    s_and_b32 s41, s41, 15
    s_lshl_b32 s42, s41, 7
    s_mul_i32 s41, s41, 393216
    s_add_u32 m0, s7, 90112
    s_add_u32 s40, s42, 0
    buffer_load_dwordx4 v4, s[8:11], s40 offen lds
    s_add_u32 m0, s7, 94208
    s_add_u32 s40, s42, 65536
    buffer_load_dwordx4 v4, s[8:11], s40 offen lds
    s_add_u32 m0, s7, 98304
    s_add_u32 s40, s42, 131072
    buffer_load_dwordx4 v4, s[8:11], s40 offen lds
    s_add_u32 m0, s7, 102400
    s_add_u32 s40, s42, 196608
    buffer_load_dwordx4 v4, s[8:11], s40 offen lds
    s_add_u32 m0, s7, 106496
    s_add_u32 s40, s41, 0
    buffer_load_dwordx4 v5, s[12:15], s40 offen lds
    s_add_u32 m0, s7, 110592
    s_add_u32 s40, s41, 196608
    buffer_load_dwordx4 v5, s[12:15], s40 offen lds
    s_add_u32 m0, s7, 114688
    s_add_u32 s40, s41, 2048
    buffer_load_dwordx4 v5, s[12:15], s40 offen lds
    s_add_u32 m0, s7, 118784
    s_add_u32 s40, s41, 198656
    buffer_load_dwordx4 v5, s[12:15], s40 offen lds
    s_add_u32 m0, s7, 122880
    s_add_u32 s40, s41, 4096
    buffer_load_dwordx4 v5, s[12:15], s40 offen lds
    s_add_u32 m0, s7, 126976
    s_add_u32 s40, s41, 200704
    buffer_load_dwordx4 v5, s[12:15], s40 offen lds
    buffer_load_dwordx4 v[24:27], v13, s[8:11], 0 offen offset:0
    buffer_load_dwordx4 v[28:31], v13, s[8:11], 0 offen offset:1024
    buffer_load_dwordx4 v[32:35], v13, s[8:11], 0 offen offset:2048
    buffer_load_dwordx4 v[36:39], v13, s[8:11], 0 offen offset:3072
    s_cmp_lt_u32 s6, 2
    s_cselect_b32 s24, s48, s56
    s_cselect_b32 s25, s49, s57
    s_and_b32 s64, s7, 1024
    s_add_u32 m0, s7, 0
    s_nop 0
    buffer_load_dwordx4 v6, s[24:27], s64 offen lds
    s_waitcnt vmcnt(15)
    s_barrier
    s_add_u32 s41, s74, 3
    s_and_b32 s41, s41, 15
    s_lshl_b32 s42, s41, 7
    s_mul_i32 s41, s41, 393216
    s_add_u32 m0, s7, 8192
    s_add_u32 s40, s42, 0
    buffer_load_dwordx4 v4, s[8:11], s40 offen lds
    s_add_u32 m0, s7, 12288
    s_add_u32 s40, s42, 65536
    buffer_load_dwordx4 v4, s[8:11], s40 offen lds
    s_add_u32 m0, s7, 16384
    s_add_u32 s40, s42, 131072
    buffer_load_dwordx4 v4, s[8:11], s40 offen lds
    s_add_u32 m0, s7, 20480
    s_add_u32 s40, s42, 196608
    buffer_load_dwordx4 v4, s[8:11], s40 offen lds
    s_add_u32 m0, s7, 24576
    s_add_u32 s40, s41, 0
    buffer_load_dwordx4 v5, s[12:15], s40 offen lds
    s_add_u32 m0, s7, 28672
    s_add_u32 s40, s41, 196608
    buffer_load_dwordx4 v5, s[12:15], s40 offen lds
    s_add_u32 m0, s7, 32768
    s_add_u32 s40, s41, 2048
    buffer_load_dwordx4 v5, s[12:15], s40 offen lds
    s_add_u32 m0, s7, 36864
    s_add_u32 s40, s41, 198656
    buffer_load_dwordx4 v5, s[12:15], s40 offen lds
    s_add_u32 m0, s7, 40960
    s_add_u32 s40, s41, 4096
    buffer_load_dwordx4 v5, s[12:15], s40 offen lds
    s_add_u32 m0, s7, 45056
    s_add_u32 s40, s41, 200704
    buffer_load_dwordx4 v5, s[12:15], s40 offen lds
    buffer_store_dwordx4 v[16:19], v22, s[16:19], 0 offen sc0 sc1
    s_mov_b32 exec_lo, s75
    s_mov_b32 exec_hi, 0
    buffer_store_dword v20, v15, s[16:19], 0 offen sc0 sc1
    s_mov_b32 exec_lo, 0x3fff3fff
    s_mov_b32 exec_hi, 0x3fff3fff
    buffer_store_dwordx4 v[16:19], v12, s[16:19], 0 offen sc0 sc1
    s_mov_b64 exec, 0xffff
    s_lshl_b32 s64, s2, 10
    s_lshl_b32 s65, s6, 8
    s_add_u32 s64, s64, s65
    s_add_u32 s64, s64, 6447104
    buffer_store_dwordx4 v[16:19], v6, s[16:19], s64 offen sc0 sc1
    s_mov_b64 exec, -1
    s_waitcnt vmcnt(19)
    s_barrier
    v_mov_b32 v79, 0
    s_cmp_lg_u32 s6, 0
    s_cbranch_scc1 H_nc
    buffer_load_dword v78, v79, s[20:23], 0 offen sc1
H_nc:
    s_add_u32 s41, s74, 4
    s_and_b32 s41, s41, 15
    s_lshl_b32 s42, s41, 7
    s_mul_i32 s41, s41, 393216
    s_add_u32 m0, s7, 49152
    s_add_u32 s40, s42, 0
    buffer_load_dwordx4 v4, s[8:11], s40 offen lds
    s_add_u32 m0, s7, 53248
    s_add_u32 s40, s42, 65536
    buffer_load_dwordx4 v4, s[8:11], s40 offen lds
    s_add_u32 m0, s7, 57344
    s_add_u32 s40, s42, 131072
    buffer_load_dwordx4 v4, s[8:11], s40 offen lds
    s_add_u32 m0, s7, 61440
    s_add_u32 s40, s42, 196608
    buffer_load_dwordx4 v4, s[8:11], s40 offen lds
    s_add_u32 m0, s7, 65536
    s_add_u32 s40, s41, 0
    buffer_load_dwordx4 v5, s[12:15], s40 offen lds
    s_add_u32 m0, s7, 69632
    s_add_u32 s40, s41, 196608
    buffer_load_dwordx4 v5, s[12:15], s40 offen lds
    s_add_u32 m0, s7, 73728
    s_add_u32 s40, s41, 2048
    buffer_load_dwordx4 v5, s[12:15], s40 offen lds
    s_add_u32 m0, s7, 77824
    s_add_u32 s40, s41, 198656
    buffer_load_dwordx4 v5, s[12:15], s40 offen lds
    s_add_u32 m0, s7, 81920
    s_add_u32 s40, s41, 4096
    buffer_load_dwordx4 v5, s[12:15], s40 offen lds
    s_add_u32 m0, s7, 86016
    s_add_u32 s40, s41, 200704
    buffer_load_dwordx4 v5, s[12:15], s40 offen lds
    s_waitcnt vmcnt(14)
    s_barrier
    ds_read_b128 v[40:43], v6 offset:0
    ds_read_b128 v[44:47], v6 offset:1024
    ds_read_b128 v[48:51], v6 offset:2048
    ds_read_b128 v[52:55], v6 offset:3072
    s_add_u32 s41, s74, 5
    s_and_b32 s41, s41, 15
    s_lshl_b32 s42, s41, 7
    s_mul_i32 s41, s41, 393216
    s_add_u32 m0, s7, 90112
    s_add_u32 s40, s42, 0
    buffer_load_dwordx4 v4, s[8:11], s40 offen lds
    s_waitcnt lgkmcnt(0)
    s_add_u32 m0, s7, 94208
    s_add_u32 s40, s42, 65536
    buffer_load_dwordx4 v4, s[8:11], s40 offen lds
    v_dot2_f32_bf16 v72, v24, v48, 0
    v_dot2_f32_bf16 v73, v32, v48, 0
    v_dot2_f32_bf16 v74, v24, v40, 0
    v_dot2_f32_bf16 v75, v32, v40, 0
    s_add_u32 m0, s7, 98304
    s_add_u32 s40, s42, 131072
    buffer_load_dwordx4 v4, s[8:11], s40 offen lds
    v_dot2_f32_bf16 v72, v25, v49, v72
    v_dot2_f32_bf16 v73, v33, v49, v73
    v_dot2_f32_bf16 v74, v25, v41, v74
    v_dot2_f32_bf16 v75, v33, v41, v75
    s_add_u32 m0, s7, 102400
    s_add_u32 s40, s42, 196608
    buffer_load_dwordx4 v4, s[8:11], s40 offen lds
    v_dot2_f32_bf16 v72, v26, v50, v72
    v_dot2_f32_bf16 v73, v34, v50, v73
    v_dot2_f32_bf16 v74, v26, v42, v74
    v_dot2_f32_bf16 v75, v34, v42, v75
    s_add_u32 m0, s7, 106496
    s_add_u32 s40, s41, 0
    buffer_load_dwordx4 v5, s[12:15], s40 offen lds
    v_dot2_f32_bf16 v72, v27, v51, v72
    v_dot2_f32_bf16 v73, v35, v51, v73
    v_dot2_f32_bf16 v74, v27, v43, v74
    v_dot2_f32_bf16 v75, v35, v43, v75
    s_add_u32 m0, s7, 110592
    s_add_u32 s40, s41, 196608
    buffer_load_dwordx4 v5, s[12:15], s40 offen lds
    v_dot2_f32_bf16 v72, v28, v52, v72
    v_dot2_f32_bf16 v73, v36, v52, v73
    v_dot2_f32_bf16 v74, v28, v44, v74
    v_dot2_f32_bf16 v75, v36, v44, v75
    s_add_u32 m0, s7, 114688
    s_add_u32 s40, s41, 2048
    buffer_load_dwordx4 v5, s[12:15], s40 offen lds
    v_dot2_f32_bf16 v72, v29, v53, v72
    v_dot2_f32_bf16 v73, v37, v53, v73
    v_dot2_f32_bf16 v74, v29, v45, v74
    v_dot2_f32_bf16 v75, v37, v45, v75
    s_add_u32 m0, s7, 118784
    s_add_u32 s40, s41, 198656
    buffer_load_dwordx4 v5, s[12:15], s40 offen lds
    v_dot2_f32_bf16 v72, v30, v54, v72
    v_dot2_f32_bf16 v73, v38, v54, v73
    v_dot2_f32_bf16 v74, v30, v46, v74
    v_dot2_f32_bf16 v75, v38, v46, v75
    s_add_u32 m0, s7, 122880
    s_add_u32 s40, s41, 4096
    buffer_load_dwordx4 v5, s[12:15], s40 offen lds
    v_dot2_f32_bf16 v72, v31, v55, v72
    v_dot2_f32_bf16 v73, v39, v55, v73
    v_dot2_f32_bf16 v74, v31, v47, v74
    v_dot2_f32_bf16 v75, v39, v47, v75
    s_add_u32 m0, s7, 126976
    s_add_u32 s40, s41, 200704
    buffer_load_dwordx4 v5, s[12:15], s40 offen lds
    s_waitcnt vmcnt(10)
    s_barrier
    s_add_u32 s41, s74, 6
    s_and_b32 s41, s41, 15
    s_lshl_b32 s42, s41, 7
    s_mul_i32 s41, s41, 393216
    s_add_u32 m0, s7, 8192
    s_add_u32 s40, s42, 0
    buffer_load_dwordx4 v4, s[8:11], s40 offen lds
    v_permlane32_swap_b32 v72, v74
    v_permlane32_swap_b32 v73, v75
    v_add_f32 v72, v72, v74
    v_add_f32 v73, v73, v75
    s_add_u32 m0, s7, 12288
    s_add_u32 s40, s42, 65536
    buffer_load_dwordx4 v4, s[8:11], s40 offen lds
    s_lshl_b32 s64, s68, 2
    s_add_u32 s64, s64, 6709248
    v_permlane16_swap_b32 v72, v73
    v_add_f32 v72, v72, v73
    s_add_u32 m0, s7, 16384
    s_add_u32 s40, s42, 131072
    buffer_load_dwordx4 v4, s[8:11], s40 offen lds
    v_and_b32 v75, 1, v8
    v_lshl_add_u32 v76, v75, 2, s64
    v_add_f32_dpp v72, v72, v72 quad_perm:[1,0,3,2] row_mask:0xf bank_mask:0xf
    s_nop 1
    s_add_u32 m0, s7, 20480
    s_add_u32 s40, s42, 196608
    buffer_load_dwordx4 v4, s[8:11], s40 offen lds
    v_add_f32_dpp v72, v72, v72 quad_perm:[2,3,0,1] row_mask:0xf bank_mask:0xf
    s_nop 1
    v_add_f32_dpp v72, v72, v72 row_half_mirror row_mask:0xf bank_mask:0xf
    s_nop 1
    s_add_u32 m0, s7, 24576
    s_add_u32 s40, s41, 0
    buffer_load_dwordx4 v5, s[12:15], s40 offen lds
    v_add_f32_dpp v72, v72, v72 row_mirror row_mask:0xf bank_mask:0xf
    s_nop 1
    v_cvt_pk_bf16_f32 v72, v72, v72
    s_sub_u32 s64, 34815, s68
    s_add_u32 m0, s7, 28672
    s_add_u32 s40, s41, 196608
    buffer_load_dwordx4 v5, s[12:15], s40 offen lds
    v_lshlrev_b32 v72, 16, v72
    v_ashrrev_i32 v73, 31, v72
    v_sub_u32 v77, s64, v75
    v_or_b32 v73, 0x80000000, v73
    s_add_u32 m0, s7, 32768
    s_add_u32 s40, s41, 2048
    buffer_load_dwordx4 v5, s[12:15], s40 offen lds
    s_lshl_b32 s64, s6, 3
    v_xor_b32 v73, v72, v73
    v_lshl_add_u32 v75, v75, 2, s64
    v_and_b32 v73, 0xffff0000, v73
    s_add_u32 m0, s7, 36864
    s_add_u32 s40, s41, 198656
    buffer_load_dwordx4 v5, s[12:15], s40 offen lds
    v_or_b32 v73, v77, v73
    v_mul_f32 v72, s72, v72
    v_exp_f32 v72, -v72
    s_nop 0
    s_add_u32 m0, s7, 40960
    s_add_u32 s40, s41, 4096
    buffer_load_dwordx4 v5, s[12:15], s40 offen lds
    v_add_f32 v72, 1.0, v72
    v_rcp_f32 v72, v72
    s_nop 0
    v_cvt_pk_bf16_f32 v72, v72, v72
    s_add_u32 m0, s7, 45056
    s_add_u32 s40, s41, 200704
    buffer_load_dwordx4 v5, s[12:15], s40 offen lds
    v_lshlrev_b32 v72, 16, v72
    s_mov_b32 exec_lo, 0
    s_mov_b32 exec_hi, 0x10001
    ds_write_b32 v75, v73 offset:4224
    s_mov_b32 exec_lo, 0x10001
    s_mov_b32 exec_hi, 0
    buffer_store_dword v72, v76, s[16:19], 0 offen sc0 sc1
    s_mov_b64 exec, -1
    s_mov_b32 exec_lo, 0x3fff3fff
    s_mov_b32 exec_hi, 0x3fff3fff
    s_mov_b32 s64, 0
    buffer_load_dwordx4 v[96:99], v11, s[32:35], s64 offen nt
    s_mov_b32 s64, 0
    buffer_load_dwordx4 v[128:131], v11, s[36:39], s64 offen nt
    s_mov_b32 s64, 7168
    buffer_load_dwordx4 v[100:103], v11, s[32:35], s64 offen nt
    s_mov_b32 s64, 7168
    buffer_load_dwordx4 v[132:135], v11, s[36:39], s64 offen nt
    s_mov_b32 s64, 14336
    buffer_load_dwordx4 v[104:107], v11, s[32:35], s64 offen nt
    s_mov_b64 exec, -1
    s_waitcnt vmcnt(16)
    s_waitcnt lgkmcnt(0)
    s_barrier
    s_add_u32 s41, s74, 7
    s_and_b32 s41, s41, 15
    s_lshl_b32 s42, s41, 7
    s_mul_i32 s41, s41, 393216
    s_add_u32 m0, s7, 49152
    s_add_u32 s40, s42, 0
    buffer_load_dwordx4 v4, s[8:11], s40 offen lds
    s_add_u32 m0, s7, 53248
    s_add_u32 s40, s42, 65536
    buffer_load_dwordx4 v4, s[8:11], s40 offen lds
    s_add_u32 m0, s7, 57344
    s_add_u32 s40, s42, 131072
    buffer_load_dwordx4 v4, s[8:11], s40 offen lds
    s_add_u32 m0, s7, 61440
    s_add_u32 s40, s42, 196608
    buffer_load_dwordx4 v4, s[8:11], s40 offen lds
    s_add_u32 m0, s7, 65536
    s_add_u32 s40, s41, 0
    buffer_load_dwordx4 v5, s[12:15], s40 offen lds
    s_add_u32 m0, s7, 69632
    s_add_u32 s40, s41, 196608
    buffer_load_dwordx4 v5, s[12:15], s40 offen lds
    s_add_u32 m0, s7, 73728
    s_add_u32 s40, s41, 2048
    buffer_load_dwordx4 v5, s[12:15], s40 offen lds
    s_add_u32 m0, s7, 77824
    s_add_u32 s40, s41, 198656
    buffer_load_dwordx4 v5, s[12:15], s40 offen lds
    s_add_u32 m0, s7, 81920
    s_add_u32 s40, s41, 4096
    buffer_load_dwordx4 v5, s[12:15], s40 offen lds
    s_add_u32 m0, s7, 86016
    s_add_u32 s40, s41, 200704
    buffer_load_dwordx4 v5, s[12:15], s40 offen lds
    s_waitcnt vmcnt(16)
    s_barrier
    s_add_u32 s41, s74, 8
    s_and_b32 s41, s41, 15
    s_lshl_b32 s42, s41, 7
    s_mul_i32 s41, s41, 393216
    s_add_u32 m0, s7, 90112
    s_add_u32 s40, s42, 0
    buffer_load_dwordx4 v4, s[8:11], s40 offen lds
    s_add_u32 m0, s7, 94208
    s_add_u32 s40, s42, 65536
    buffer_load_dwordx4 v4, s[8:11], s40 offen lds
    s_add_u32 m0, s7, 98304
    s_add_u32 s40, s42, 131072
    buffer_load_dwordx4 v4, s[8:11], s40 offen lds
    s_add_u32 m0, s7, 102400
    s_add_u32 s40, s42, 196608
    buffer_load_dwordx4 v4, s[8:11], s40 offen lds
    s_add_u32 m0, s7, 106496
    s_add_u32 s40, s41, 0
    buffer_load_dwordx4 v5, s[12:15], s40 offen lds
    s_add_u32 m0, s7, 110592
    s_add_u32 s40, s41, 196608
    buffer_load_dwordx4 v5, s[12:15], s40 offen lds
    s_add_u32 m0, s7, 114688
    s_add_u32 s40, s41, 2048
    buffer_load_dwordx4 v5, s[12:15], s40 offen lds
    s_add_u32 m0, s7, 118784
    s_add_u32 s40, s41, 198656
    buffer_load_dwordx4 v5, s[12:15], s40 offen lds
    s_add_u32 m0, s7, 122880
    s_add_u32 s40, s41, 4096
    buffer_load_dwordx4 v5, s[12:15], s40 offen lds
    s_add_u32 m0, s7, 126976
    s_add_u32 s40, s41, 200704
    buffer_load_dwordx4 v5, s[12:15], s40 offen lds
    s_waitcnt vmcnt(10)
    s_barrier
    s_add_u32 s41, s74, 9
    s_and_b32 s41, s41, 15
    s_lshl_b32 s42, s41, 7
    s_mul_i32 s41, s41, 393216
    s_add_u32 m0, s7, 8192
    s_add_u32 s40, s42, 0
    buffer_load_dwordx4 v4, s[8:11], s40 offen lds
    s_add_u32 m0, s7, 12288
    s_add_u32 s40, s42, 65536
    buffer_load_dwordx4 v4, s[8:11], s40 offen lds
    s_add_u32 m0, s7, 16384
    s_add_u32 s40, s42, 131072
    buffer_load_dwordx4 v4, s[8:11], s40 offen lds
    s_add_u32 m0, s7, 20480
    s_add_u32 s40, s42, 196608
    buffer_load_dwordx4 v4, s[8:11], s40 offen lds
    s_add_u32 m0, s7, 24576
    s_add_u32 s40, s41, 0
    buffer_load_dwordx4 v5, s[12:15], s40 offen lds
    s_add_u32 m0, s7, 28672
    s_add_u32 s40, s41, 196608
    buffer_load_dwordx4 v5, s[12:15], s40 offen lds
    s_add_u32 m0, s7, 32768
    s_add_u32 s40, s41, 2048
    buffer_load_dwordx4 v5, s[12:15], s40 offen lds
    s_add_u32 m0, s7, 36864
    s_add_u32 s40, s41, 198656
    buffer_load_dwordx4 v5, s[12:15], s40 offen lds
    s_add_u32 m0, s7, 40960
    s_add_u32 s40, s41, 4096
    buffer_load_dwordx4 v5, s[12:15], s40 offen lds
    s_add_u32 m0, s7, 45056
    s_add_u32 s40, s41, 200704
    buffer_load_dwordx4 v5, s[12:15], s40 offen lds
    s_cmp_lg_u32 s6, 0
    s_cbranch_scc1 H_nk
    v_mov_b32 v3, 4224
    ds_read_b128 v[72:75], v3
    ds_read_b128 v[24:27], v3 offset:16
    s_mov_b32 s65, 0
H_nspin:
    v_readfirstlane_b32 s71, v78
    s_cmp_eq_u32 s71, 0
    s_cbranch_scc1 H_nre
H_nok:
    s_lshl_b32 s64, s2, 3
    s_add_u32 s64, s64, 6717440
    v_mov_b32 v3, s64
    s_waitcnt lgkmcnt(0)
    v_max3_u32 v72, v72, v73, v74
    v_max3_u32 v24, v24, v25, v26
    v_max3_u32 v72, v72, v75, v27
    v_max_u32 v72, v72, v24
    v_xor_b32 v73, s71, v72
    s_mov_b64 exec, 1
    buffer_store_dwordx2 v[72:73], v3, s[16:19], 0 offen sc0 sc1
    s_mov_b64 exec, -1
H_nk:
    s_mov_b32 exec_lo, 0x3fff3fff
    s_mov_b32 exec_hi, 0x3fff3fff
    s_mov_b32 s64, 14336
    buffer_load_dwordx4 v[136:139], v11, s[36:39], s64 offen nt
    s_mov_b32 s64, 21504
    buffer_load_dwordx4 v[108:111], v11, s[32:35], s64 offen nt
    s_mov_b32 s64, 21504
    buffer_load_dwordx4 v[140:143], v11, s[36:39], s64 offen nt
    s_mov_b32 s64, 28672
    buffer_load_dwordx4 v[112:115], v11, s[32:35], s64 offen nt
    s_mov_b32 s64, 28672
    buffer_load_dwordx4 v[144:147], v11, s[36:39], s64 offen nt
    s_mov_b64 exec, -1
    s_waitcnt vmcnt(15)
    s_barrier
    s_add_u32 s41, s74, 10
    s_and_b32 s41, s41, 15
    s_lshl_b32 s42, s41, 7
    s_mul_i32 s41, s41, 393216
    s_add_u32 m0, s7, 49152
    s_add_u32 s40, s42, 0
    buffer_load_dwordx4 v4, s[8:11], s40 offen lds
    s_add_u32 m0, s7, 53248
    s_add_u32 s40, s42, 65536
    buffer_load_dwordx4 v4, s[8:11], s40 offen lds
    s_add_u32 m0, s7, 57344
    s_add_u32 s40, s42, 131072
    buffer_load_dwordx4 v4, s[8:11], s40 offen lds
    s_add_u32 m0, s7, 61440
    s_add_u32 s40, s42, 196608
    buffer_load_dwordx4 v4, s[8:11], s40 offen lds
    s_add_u32 m0, s7, 65536
    s_add_u32 s40, s41, 0
    buffer_load_dwordx4 v5, s[12:15], s40 offen lds
    s_add_u32 m0, s7, 69632
    s_add_u32 s40, s41, 196608
    buffer_load_dwordx4 v5, s[12:15], s40 offen lds
    s_add_u32 m0, s7, 73728
    s_add_u32 s40, s41, 2048
    buffer_load_dwordx4 v5, s[12:15], s40 offen lds
    s_add_u32 m0, s7, 77824
    s_add_u32 s40, s41, 198656
    buffer_load_dwordx4 v5, s[12:15], s40 offen lds
    s_add_u32 m0, s7, 81920
    s_add_u32 s40, s41, 4096
    buffer_load_dwordx4 v5, s[12:15], s40 offen lds
    s_add_u32 m0, s7, 86016
    s_add_u32 s40, s41, 200704
    buffer_load_dwordx4 v5, s[12:15], s40 offen lds
    s_waitcnt vmcnt(15)
    s_barrier
    s_add_u32 s41, s74, 11
    s_and_b32 s41, s41, 15
    s_lshl_b32 s42, s41, 7
    s_mul_i32 s41, s41, 393216
    s_add_u32 m0, s7, 90112
    s_add_u32 s40, s42, 0
    buffer_load_dwordx4 v4, s[8:11], s40 offen lds
    s_add_u32 m0, s7, 94208
    s_add_u32 s40, s42, 65536
    buffer_load_dwordx4 v4, s[8:11], s40 offen lds
    s_add_u32 m0, s7, 98304
    s_add_u32 s40, s42, 131072
    buffer_load_dwordx4 v4, s[8:11], s40 offen lds
    s_add_u32 m0, s7, 102400
    s_add_u32 s40, s42, 196608
    buffer_load_dwordx4 v4, s[8:11], s40 offen lds
    s_add_u32 m0, s7, 106496
    s_add_u32 s40, s41, 0
    buffer_load_dwordx4 v5, s[12:15], s40 offen lds
    s_add_u32 m0, s7, 110592
    s_add_u32 s40, s41, 196608
    buffer_load_dwordx4 v5, s[12:15], s40 offen lds
    s_add_u32 m0, s7, 114688
    s_add_u32 s40, s41, 2048
    buffer_load_dwordx4 v5, s[12:15], s40 offen lds
    s_add_u32 m0, s7, 118784
    s_add_u32 s40, s41, 198656
    buffer_load_dwordx4 v5, s[12:15], s40 offen lds
    s_add_u32 m0, s7, 122880
    s_add_u32 s40, s41, 4096
    buffer_load_dwordx4 v5, s[12:15], s40 offen lds
    s_add_u32 m0, s7, 126976
    s_add_u32 s40, s41, 200704
    buffer_load_dwordx4 v5, s[12:15], s40 offen lds
    s_waitcnt vmcnt(10)
    s_barrier
    s_add_u32 s41, s74, 12
    s_and_b32 s41, s41, 15
    s_lshl_b32 s42, s41, 7
    s_mul_i32 s41, s41, 393216
    s_add_u32 m0, s7, 8192
    s_add_u32 s40, s42, 0
    buffer_load_dwordx4 v4, s[8:11], s40 offen lds
    s_add_u32 m0, s7, 12288
    s_add_u32 s40, s42, 65536
    buffer_load_dwordx4 v4, s[8:11], s40 offen lds
    s_add_u32 m0, s7, 16384
    s_add_u32 s40, s42, 131072
    buffer_load_dwordx4 v4, s[8:11], s40 offen lds
    s_add_u32 m0, s7, 20480
    s_add_u32 s40, s42, 196608
    buffer_load_dwordx4 v4, s[8:11], s40 offen lds
    s_add_u32 m0, s7, 24576
    s_add_u32 s40, s41, 0
    buffer_load_dwordx4 v5, s[12:15], s40 offen lds
    s_add_u32 m0, s7, 28672
    s_add_u32 s40, s41, 196608
    buffer_load_dwordx4 v5, s[12:15], s40 offen lds
    s_add_u32 m0, s7, 32768
    s_add_u32 s40, s41, 2048
    buffer_load_dwordx4 v5, s[12:15], s40 offen lds
    s_add_u32 m0, s7, 36864
    s_add_u32 s40, s41, 198656
    buffer_load_dwordx4 v5, s[12:15], s40 offen lds
    s_add_u32 m0, s7, 40960
    s_add_u32 s40, s41, 4096
    buffer_load_dwordx4 v5, s[12:15], s40 offen lds
    s_add_u32 m0, s7, 45056
    s_add_u32 s40, s41, 200704
    buffer_load_dwordx4 v5, s[12:15], s40 offen lds
    s_mov_b32 exec_lo, 0x3fff3fff
    s_mov_b32 exec_hi, 0x3fff3fff
    s_mov_b32 s64, 35840
    buffer_load_dwordx4 v[116:119], v11, s[32:35], s64 offen nt
    s_mov_b32 s64, 35840
    buffer_load_dwordx4 v[148:151], v11, s[36:39], s64 offen nt
    s_mov_b32 s64, 43008
    buffer_load_dwordx4 v[120:123], v11, s[32:35], s64 offen nt
    s_mov_b32 s64, 43008
    buffer_load_dwordx4 v[152:155], v11, s[36:39], s64 offen nt
    s_mov_b32 s64, 50176
    buffer_load_dwordx4 v[124:127], v11, s[32:35], s64 offen nt
    s_mov_b32 s64, 50176
    buffer_load_dwordx4 v[156:159], v11, s[36:39], s64 offen nt
    s_mov_b64 exec, -1
    s_waitcnt vmcnt(16)
    s_barrier
    s_cmp_lg_u32 s6, 0
    s_cbranch_scc1 H_np
    s_mov_b32 s64, 6717440
    buffer_load_dwordx4 v[24:27], v6, s[16:19], s64 offen offset:0 sc1
    buffer_load_dwordx4 v[28:31], v6, s[16:19], s64 offen offset:1024 sc1
H_np:
    s_add_u32 s41, s74, 13
    s_and_b32 s41, s41, 15
    s_lshl_b32 s42, s41, 7
    s_mul_i32 s41, s41, 393216
    s_add_u32 m0, s7, 49152
    s_add_u32 s40, s42, 0
    buffer_load_dwordx4 v4, s[8:11], s40 offen lds
    s_add_u32 m0, s7, 53248
    s_add_u32 s40, s42, 65536
    buffer_load_dwordx4 v4, s[8:11], s40 offen lds
    s_add_u32 m0, s7, 57344
    s_add_u32 s40, s42, 131072
    buffer_load_dwordx4 v4, s[8:11], s40 offen lds
    s_add_u32 m0, s7, 61440
    s_add_u32 s40, s42, 196608
    buffer_load_dwordx4 v4, s[8:11], s40 offen lds
    s_add_u32 m0, s7, 65536
    s_add_u32 s40, s41, 0
    buffer_load_dwordx4 v5, s[12:15], s40 offen lds
    s_add_u32 m0, s7, 69632
    s_add_u32 s40, s41, 196608
    buffer_load_dwordx4 v5, s[12:15], s40 offen lds
    s_add_u32 m0, s7, 73728
    s_add_u32 s40, s41, 2048
    buffer_load_dwordx4 v5, s[12:15], s40 offen lds
    s_add_u32 m0, s7, 77824
    s_add_u32 s40, s41, 198656
    buffer_load_dwordx4 v5, s[12:15], s40 offen lds
    s_add_u32 m0, s7, 81920
    s_add_u32 s40, s41, 4096
    buffer_load_dwordx4 v5, s[12:15], s40 offen lds
    s_add_u32 m0, s7, 86016
    s_add_u32 s40, s41, 200704
    buffer_load_dwordx4 v5, s[12:15], s40 offen lds
    s_waitcnt vmcnt(16)
    s_barrier
    s_cmp_lg_u32 s6, 0
    s_cbranch_scc1 H_nq
    s_waitcnt vmcnt(10)
    s_mov_b32 s65, 0
H_spin:
    v_xor_b32 v25, v24, v25
    v_xor_b32 v27, v26, v27
    v_xor_b32 v29, v28, v29
    v_xor_b32 v31, v30, v31
    v_xor_b32 v3, s71, v25
    v_xor_b32 v7, s71, v27
    v_xor_b32 v25, s71, v29
    v_xor_b32 v27, s71, v31
    v_or3_b32 v3, v3, v7, v25
    v_or_b32 v3, v3, v27
    v_cmp_ne_u32 vcc, 0, v3
    s_cbranch_vccnz H_retry
H_nq:
    s_add_u32 s41, s74, 14
    s_and_b32 s41, s41, 15
    s_lshl_b32 s42, s41, 7
    s_mul_i32 s41, s41, 393216
    s_add_u32 m0, s7, 90112
    s_add_u32 s40, s42, 0
    buffer_load_dwordx4 v4, s[8:11], s40 offen lds
    v_max_u32 v3, v24, v26
    v_max3_u32 v3, v3, v28, v30
    s_nop 1
    v_max_u32_dpp v3, v3, v3 quad_perm:[1,0,3,2] row_mask:0xf bank_mask:0xf
    s_add_u32 m0, s7, 94208
    s_add_u32 s40, s42, 65536
    buffer_load_dwordx4 v4, s[8:11], s40 offen lds
    s_nop 1
    v_max_u32_dpp v3, v3, v3 quad_perm:[2,3,0,1] row_mask:0xf bank_mask:0xf
    s_nop 1
    v_max_u32_dpp v3, v3, v3 row_half_mirror row_mask:0xf bank_mask:0xf
    s_add_u32 m0, s7, 98304
    s_add_u32 s40, s42, 131072
    buffer_load_dwordx4 v4, s[8:11], s40 offen lds
    s_nop 1
    v_max_u32_dpp v3, v3, v3 row_mirror row_mask:0xf bank_mask:0xf
    s_nop 1
    v_mov_b32 v7, v3
    s_add_u32 m0, s7, 102400
    s_add_u32 s40, s42, 196608
    buffer_load_dwordx4 v4, s[8:11], s40 offen lds
    s_nop 1
    v_permlane16_swap_b32 v3, v7
    v_max_u32 v3, v3, v7
    v_mov_b32 v7, v3
    s_add_u32 m0, s7, 106496
    s_add_u32 s40, s41, 0
    buffer_load_dwordx4 v5, s[12:15], s40 offen lds
    s_nop 1
    v_permlane32_swap_b32 v3, v7
    v_max_u32 v3, v3, v7
    v_mov_b32 v7, 4256
    s_add_u32 m0, s7, 110592
    s_add_u32 s40, s41, 196608
    buffer_load_dwordx4 v5, s[12:15], s40 offen lds
    s_add_u32 m0, s7, 114688
    s_add_u32 s40, s41, 2048
    buffer_load_dwordx4 v5, s[12:15], s40 offen lds
    s_add_u32 m0, s7, 118784
    s_add_u32 s40, s41, 198656
    buffer_load_dwordx4 v5, s[12:15], s40 offen lds
    s_add_u32 m0, s7, 122880
    s_add_u32 s40, s41, 4096
    buffer_load_dwordx4 v5, s[12:15], s40 offen lds
    s_add_u32 m0, s7, 126976
    s_add_u32 s40, s41, 200704
    buffer_load_dwordx4 v5, s[12:15], s40 offen lds
    s_cmp_lg_u32 s6, 0
    s_cbranch_scc1 H_nw
    ds_write_b32 v7, v3
H_nw:
    s_waitcnt vmcnt(10)
    s_waitcnt lgkmcnt(0)
    s_barrier
    v_mov_b32 v7, 4256
    ds_read_b32 v3, v7
    s_lshl_b32 s65, s69, 6
    v_lshl_add_u32 v7, v8, 4, s65
    s_waitcnt lgkmcnt(0)
    v_readfirstlane_b32 s75, v3
    s_nop 3
    s_and_b32 s64, s75, 0x7ff
    s_sub_u32 s64, 2047, s64
    s_lshl_b32 s64, s64, 11
    buffer_load_dwordx4 v[88:91], v7, s[8:11], s64 offen
    s_add_u32 s41, s74, 15
    s_and_b32 s41, s41, 15
    s_lshl_b32 s42, s41, 7
    s_mul_i32 s41, s41, 393216
    s_add_u32 m0, s7, 8192
    s_add_u32 s40, s42, 0
    buffer_load_dwordx4 v4, s[8:11], s40 offen lds
    s_add_u32 m0, s7, 12288
    s_add_u32 s40, s42, 65536
    buffer_load_dwordx4 v4, s[8:11], s40 offen lds
    s_add_u32 m0, s7, 16384
    s_add_u32 s40, s42, 131072
    buffer_load_dwordx4 v4, s[8:11], s40 offen lds
    s_add_u32 m0, s7, 20480
    s_add_u32 s40, s42, 196608
    buffer_load_dwordx4 v4, s[8:11], s40 offen lds
    s_add_u32 m0, s7, 24576
    s_add_u32 s40, s41, 0
    buffer_load_dwordx4 v5, s[12:15], s40 offen lds
    s_add_u32 m0, s7, 28672
    s_add_u32 s40, s41, 196608
    buffer_load_dwordx4 v5, s[12:15], s40 offen lds
    s_add_u32 m0, s7, 32768
    s_add_u32 s40, s41, 2048
    buffer_load_dwordx4 v5, s[12:15], s40 offen lds
    s_add_u32 m0, s7, 36864
    s_add_u32 s40, s41, 198656
    buffer_load_dwordx4 v5, s[12:15], s40 offen lds
    s_add_u32 m0, s7, 40960
    s_add_u32 s40, s41, 4096
    buffer_load_dwordx4 v5, s[12:15], s40 offen lds
    s_add_u32 m0, s7, 45056
    s_add_u32 s40, s41, 200704
    buffer_load_dwordx4 v5, s[12:15], s40 offen lds
    s_mov_b32 s24, s54
    s_mov_b32 s25, s55
    s_mov_b32 s26, 0x700000
    s_mov_b32 s27, 0x00020000
    s_lshr_b32 s64, s2, 2
    s_mul_i32 s64, s64, 114688
    s_and_b32 s65, s2, 3
    s_lshl_b32 s65, s65, 9
    s_add_u32 s64, s64, s65
    s_lshl_b32 s65, s6, 7
    s_add_u32 s64, s64, s65
    v_lshrrev_b32 v7, 3, v2
    v_lshlrev_b32 v7, 11, v7
    v_and_b32 v9, 7, v2
    v_lshl_add_u32 v7, v9, 4, v7
    v_add_u32 v21, s64, v7
    s_mov_b32 s64, 0
    buffer_load_dwordx4 v[192:195], v21, s[24:27], s64 offen nt
    s_mov_b32 s64, 16384
    buffer_load_dwordx4 v[196:199], v21, s[24:27], s64 offen nt
    s_mov_b32 s64, 32768
    buffer_load_dwordx4 v[200:203], v21, s[24:27], s64 offen nt
    s_mov_b32 s64, 49152
    buffer_load_dwordx4 v[204:207], v21, s[24:27], s64 offen nt
    s_mov_b32 s64, 65536
    buffer_load_dwordx4 v[208:211], v21, s[24:27], s64 offen nt
    s_mov_b32 s64, 81920
    buffer_load_dwordx4 v[212:215], v21, s[24:27], s64 offen nt
    s_mov_b32 s64, 98304
    buffer_load_dwordx4 v[216:219], v21, s[24:27], s64 offen nt
    s_waitcnt vmcnt(18)
    s_barrier
    s_waitcnt vmcnt(17)
    s_and_b32 s64, s2, 7
    s_lshr_b32 s65, s2, 3
    s_and_b32 s4, s64, 3
    s_lshl_b32 s4, s4, 2
    s_and_b32 s66, s65, 3
    s_add_u32 s4, s4, s66
    s_lshr_b32 s5, s64, 2
    s_lshl_b32 s5, s5, 3
    s_lshr_b32 s66, s65, 2
    s_add_u32 s5, s5, s66
    s_mov_b32 s28, s44
    s_mov_b32 s29, s45
    s_mov_b32 s30, 0x200000
    s_mov_b32 s31, 0x00020000
    v_lshrrev_b32 v7, 3, v2
    s_lshl_b32 s64, s6, 3
    v_add_u32 v7, s64, v7
    v_lshlrev_b32 v7, 11, v7
    v_lshrrev_b32 v9, 4, v2
    v_lshlrev_b32 v9, 1, v9
    v_and_b32 v10, 7, v2
    v_xor_b32 v9, v9, v10
    v_lshl_add_u32 v7, v9, 4, v7
    s_lshl_b32 s64, s5, 7
    v_add_u32 v10, s64, v7
    s_add_u32 m0, s7, 131072
    s_mov_b32 s40, 0
    buffer_load_dwordx4 v10, s[28:31], s40 offen lds
    v_and_b32 v48, 15, v2
    v_and_b32 v49, 1, v2
    v_lshlrev_b32 v49, 4, v49
    v_mov_b32 v50, 0xffff
    v_lshlrev_b32 v49, v49, v50
    v_lshrrev_b32 v48, 1, v48
    v_cmp_eq_u32 vcc, 0, v48
    s_nop 1
    v_cndmask_b32 v40, 0, v49, vcc
    v_cmp_eq_u32 vcc, 1, v48
    s_nop 1
    v_cndmask_b32 v41, 0, v49, vcc
    v_cmp_eq_u32 vcc, 2, v48
    s_nop 1
    v_cndmask_b32 v42, 0, v49, vcc
    v_cmp_eq_u32 vcc, 3, v48
    s_nop 1
    v_cndmask_b32 v43, 0, v49, vcc
    s_mov_b32 s64, 0x01000100
    s_mov_b32 s65, 0x03020302
    v_perm_b32 v48, v88, v88, s64
    v_and_b32 v44, v48, v40
    v_and_b32 v45, v48, v41
    v_and_b32 v46, v48, v42
    s_add_u32 m0, s7, 135168
    s_mov_b32 s40, 65536
    buffer_load_dwordx4 v10, s[28:31], s40 offen lds
    v_and_b32 v47, v48, v43
    s_nop 1
    v_mfma_f32_16x16x32_bf16 v[32:35], v[44:47], v[96:99], 0
    v_mfma_f32_16x16x32_bf16 v[36:39], v[44:47], v[128:131], 0
    v_perm_b32 v48, v88, v88, s65
    v_and_b32 v52, v48, v40
    v_and_b32 v53, v48, v41
    v_and_b32 v54, v48, v42
    v_and_b32 v55, v48, v43
    s_nop 1
    v_mfma_f32_16x16x32_bf16 v[32:35], v[52:55], v[100:103], v[32:35]
    v_mfma_f32_16x16x32_bf16 v[36:39], v[52:55], v[132:135], v[36:39]
    v_perm_b32 v48, v89, v89, s64
    v_and_b32 v44, v48, v40
    v_and_b32 v45, v48, v41
    v_and_b32 v46, v48, v42
    v_and_b32 v47, v48, v43
    s_nop 1
    v_mfma_f32_16x16x32_bf16 v[32:35], v[44:47], v[104:107], v[32:35]
    v_mfma_f32_16x16x32_bf16 v[36:39], v[44:47], v[136:139], v[36:39]
    v_perm_b32 v48, v89, v89, s65
    v_and_b32 v52, v48, v40
    v_and_b32 v53, v48, v41
    v_and_b32 v54, v48, v42
    s_add_u32 m0, s7, 147456
    s_mov_b32 s40, 1048576
    buffer_load_dwordx4 v10, s[28:31], s40 offen lds
    v_and_b32 v55, v48, v43
    s_nop 1
    v_mfma_f32_16x16x32_bf16 v[32:35], v[52:55], v[108:111], v[32:35]
    v_mfma_f32_16x16x32_bf16 v[36:39], v[52:55], v[140:143], v[36:39]
    v_perm_b32 v48, v90, v90, s64
    v_and_b32 v44, v48, v40
    v_and_b32 v45, v48, v41
    v_and_b32 v46, v48, v42
    v_and_b32 v47, v48, v43
    s_nop 1
    v_mfma_f32_16x16x32_bf16 v[32:35], v[44:47], v[112:115], v[32:35]
    v_mfma_f32_16x16x32_bf16 v[36:39], v[44:47], v[144:147], v[36:39]
    v_perm_b32 v48, v90, v90, s65
    v_and_b32 v52, v48, v40
    v_and_b32 v53, v48, v41
    v_and_b32 v54, v48, v42
    v_and_b32 v55, v48, v43
    s_nop 1
    v_mfma_f32_16x16x32_bf16 v[32:35], v[52:55], v[116:119], v[32:35]
    v_mfma_f32_16x16x32_bf16 v[36:39], v[52:55], v[148:151], v[36:39]
    v_perm_b32 v48, v91, v91, s64
    v_and_b32 v44, v48, v40
    v_and_b32 v45, v48, v41
    v_and_b32 v46, v48, v42
    s_add_u32 m0, s7, 151552
    s_mov_b32 s40, 1114112
    buffer_load_dwordx4 v10, s[28:31], s40 offen lds
    v_and_b32 v47, v48, v43
    s_nop 1
    v_mfma_f32_16x16x32_bf16 v[32:35], v[44:47], v[120:123], v[32:35]
    v_mfma_f32_16x16x32_bf16 v[36:39], v[44:47], v[152:155], v[36:39]
    v_perm_b32 v48, v91, v91, s65
    v_and_b32 v52, v48, v40
    v_and_b32 v53, v48, v41
    v_and_b32 v54, v48, v42
    v_and_b32 v55, v48, v43
    s_nop 1
    v_mfma_f32_16x16x32_bf16 v[32:35], v[52:55], v[124:127], v[32:35]
    v_mfma_f32_16x16x32_bf16 v[36:39], v[52:55], v[156:159], v[36:39]
    s_nop 7
    v_permlane32_swap_b32 v32, v36
    v_permlane32_swap_b32 v33, v37
    v_permlane32_swap_b32 v34, v38
    v_permlane32_swap_b32 v35, v39
    s_mov_b32 exec_lo, 0x3fff3fff
    s_mov_b32 exec_hi, 0x3fff3fff
    buffer_store_dwordx4 v[32:35], v12, s[16:19], 0 offen sc0 sc1
    s_mov_b64 exec, -1
    s_waitcnt vmcnt(12)
    s_barrier
    s_add_u32 m0, s7, 139264
    s_mov_b32 s40, 131072
    buffer_load_dwordx4 v10, s[28:31], s40 offen lds
    s_add_u32 m0, s7, 143360
    s_mov_b32 s40, 196608
    buffer_load_dwordx4 v10, s[28:31], s40 offen lds
    s_add_u32 m0, s7, 155648
    s_mov_b32 s40, 1179648
    buffer_load_dwordx4 v10, s[28:31], s40 offen lds
    s_add_u32 m0, s7, 159744
    s_mov_b32 s40, 1245184
    buffer_load_dwordx4 v10, s[28:31], s40 offen lds
    s_add_u32 m0, s7, 73728
    s_mov_b32 s40, 262144
    buffer_load_dwordx4 v10, s[28:31], s40 offen lds
    s_add_u32 m0, s7, 77824
    s_mov_b32 s40, 327680
    buffer_load_dwordx4 v10, s[28:31], s40 offen lds
    s_add_u32 m0, s7, 81920
    s_mov_b32 s40, 1310720
    buffer_load_dwordx4 v10, s[28:31], s40 offen lds
    s_add_u32 m0, s7, 86016
    s_mov_b32 s40, 1376256
    buffer_load_dwordx4 v10, s[28:31], s40 offen lds
    s_barrier
    s_and_b32 s64, s3, 3
    s_lshl_b32 s64, s64, 1
    s_lshr_b32 s65, s3, 2
    s_add_u32 s64, s64, s65
    s_lshl_b32 s64, s64, 4
    s_lshl_b32 s65, s4, 7
    s_add_u32 s64, s64, s65
    v_and_b32 v230, 15, v2
    v_add_u32 v230, s64, v230
    v_bfe_u32 v3, v2, 4, 1
    v_lshlrev_b32 v229, 5, v3
    v_lshrrev_b32 v3, 5, v2
    v_lshl_add_u32 v229, v3, 4, v229
    v_lshl_add_u32 v231, v230, 11, v229
    s_lshl_b32 s64, s5, 7
    v_add_u32 v231, s64, v231
    v_lshlrev_b32 v3, 2, v230
    v_add_u32 v3, 6709248, v3
    buffer_load_dwordx4 v[220:223], v231, s[8:11], 0 offen
    buffer_load_dwordx4 v[224:227], v231, s[8:11], 0 offen offset:64
    buffer_load_dword v228, v3, s[16:19], 0 offen sc1
    s_add_u32 m0, s7, 114688
    s_mov_b32 s40, 393216
    buffer_load_dwordx4 v10, s[28:31], s40 offen lds
    s_add_u32 m0, s7, 118784
    s_mov_b32 s40, 458752
    buffer_load_dwordx4 v10, s[28:31], s40 offen lds
    s_add_u32 m0, s7, 122880
    s_mov_b32 s40, 1441792
    buffer_load_dwordx4 v10, s[28:31], s40 offen lds
    s_add_u32 m0, s7, 126976
    s_mov_b32 s40, 1507328
    buffer_load_dwordx4 v10, s[28:31], s40 offen lds
    s_add_u32 m0, s7, 40960
    s_mov_b32 s40, 524288
    buffer_load_dwordx4 v10, s[28:31], s40 offen lds
    s_add_u32 m0, s7, 45056
    s_mov_b32 s40, 589824
    buffer_load_dwordx4 v10, s[28:31], s40 offen lds
    s_add_u32 m0, s7, 49152
    s_mov_b32 s40, 1572864
    buffer_load_dwordx4 v10, s[28:31], s40 offen lds
    s_add_u32 m0, s7, 53248
    s_mov_b32 s40, 1638400
    buffer_load_dwordx4 v10, s[28:31], s40 offen lds
    s_add_u32 m0, s7, 8192
    s_mov_b32 s40, 655360
    buffer_load_dwordx4 v10, s[28:31], s40 offen lds
    s_add_u32 m0, s7, 12288
    s_mov_b32 s40, 720896
    buffer_load_dwordx4 v10, s[28:31], s40 offen lds
    s_add_u32 m0, s7, 57344
    s_mov_b32 s40, 1703936
    buffer_load_dwordx4 v10, s[28:31], s40 offen lds
    s_add_u32 m0, s7, 61440
    s_mov_b32 s40, 1769472
    buffer_load_dwordx4 v10, s[28:31], s40 offen lds
    s_add_u32 m0, s7, 16384
    s_mov_b32 s40, 786432
    buffer_load_dwordx4 v10, s[28:31], s40 offen lds
    s_add_u32 m0, s7, 20480
    s_mov_b32 s40, 851968
    buffer_load_dwordx4 v10, s[28:31], s40 offen lds
    s_add_u32 m0, s7, 65536
    s_mov_b32 s40, 1835008
    buffer_load_dwordx4 v10, s[28:31], s40 offen lds
    s_add_u32 m0, s7, 69632
    s_mov_b32 s40, 1900544
    buffer_load_dwordx4 v10, s[28:31], s40 offen lds
    s_add_u32 m0, s7, 98304
    s_mov_b32 s40, 917504
    buffer_load_dwordx4 v10, s[28:31], s40 offen lds
    s_add_u32 m0, s7, 102400
    s_mov_b32 s40, 983040
    buffer_load_dwordx4 v10, s[28:31], s40 offen lds
    s_add_u32 m0, s7, 90112
    s_mov_b32 s40, 1966080
    buffer_load_dwordx4 v10, s[28:31], s40 offen lds
    s_add_u32 m0, s7, 94208
    s_mov_b32 s40, 2031616
    buffer_load_dwordx4 v10, s[28:31], s40 offen lds
    s_mov_b64 exec, 1
    v_mov_b32 v20, 0
    buffer_atomic_or v20, v23, s[16:19], 0 offen sc0
    s_mov_b64 exec, -1
    v_add_u32 v17, s70, v6
    v_lshrrev_b32 v18, 2, v2
    v_mul_u32_u24 v18, 1152, v18
    v_and_b32 v19, 3, v2
    v_lshl_add_u32 v18, v19, 4, v18
    s_add_u32 s64, s70, 1024
    v_add_u32 v18, s64, v18
    v_bfe_u32 v26, v2, 3, 1
    v_lshl_add_u32 v26, v26, 2, v19
    v_bfe_u32 v27, v2, 2, 1
    v_lshrrev_b32 v28, 5, v2
    v_cmp_eq_u32 vcc, v27, v28
    v_and_b32 v27, 16, v2
    v_cmp_eq_u32 s[64:65], 0, v27
    s_and_b64 vcc, vcc, s[64:65]
    v_and_b32 v27, 1, v26
    v_lshlrev_b32 v27, 4, v27
    v_mov_b32 v28, 0x3f80
    v_lshlrev_b32 v27, v27, v28
    v_cndmask_b32 v27, 0, v27, vcc
    v_lshrrev_b32 v26, 1, v26
    v_cmp_eq_u32 vcc, 0, v26
    s_nop 1
    v_cndmask_b32 v48, 0, v27, vcc
    v_cmp_eq_u32 vcc, 1, v26
    s_nop 1
    v_cndmask_b32 v49, 0, v27, vcc
    v_cmp_eq_u32 vcc, 2, v26
    s_nop 1
    v_cndmask_b32 v50, 0, v27, vcc
    v_cmp_eq_u32 vcc, 3, v26
    s_nop 1
    v_cndmask_b32 v51, 0, v27, vcc
    v_mov_b32 v128, 0
    v_mov_b32 v129, 0
    v_mov_b32 v130, 0
    v_mov_b32 v131, 0
    v_mov_b32 v132, 0
    v_mov_b32 v133, 0
    v_mov_b32 v134, 0
    v_mov_b32 v135, 0
    v_mov_b32 v136, 0
    v_mov_b32 v137, 0
    v_mov_b32 v138, 0
    v_mov_b32 v139, 0
    v_mov_b32 v140, 0
    v_mov_b32 v141, 0
    v_mov_b32 v142, 0
    v_mov_b32 v143, 0
    s_mov_b32 s66, 0xffff
    s_mov_b32 s65, 0
    s_waitcnt vmcnt(0)
G_loop:
    v_readfirstlane_b32 s68, v20
    s_and_b32 s68, s68, s66
    s_andn2_b32 s66, s66, s68
    s_bcnt1_i32_b32 s67, s68
    s_cmp_eq_u32 s67, 0
    s_cbranch_scc1 G_l0
    s_cmp_gt_u32 s67, 8
    s_cbranch_scc1 G_lt_1
    s_cmp_gt_u32 s67, 4
    s_cbranch_scc1 G_lt_2
    s_cmp_gt_u32 s67, 2
    s_cbranch_scc1 G_lt_3
    s_cmp_eq_u32 s67, 1
    s_cbranch_scc1 G_l1
    s_branch G_l2
G_lt_3:
    s_cmp_eq_u32 s67, 3
    s_cbranch_scc1 G_l3
    s_branch G_l4
G_lt_2:
    s_cmp_gt_u32 s67, 6
    s_cbranch_scc1 G_lt_4
    s_cmp_eq_u32 s67, 5
    s_cbranch_scc1 G_l5
    s_branch G_l6
G_lt_4:
    s_cmp_eq_u32 s67, 7
    s_cbranch_scc1 G_l7
    s_branch G_l8
G_lt_1:
    s_cmp_gt_u32 s67, 12
    s_cbranch_scc1 G_lt_5
    s_cmp_gt_u32 s67, 10
    s_cbranch_scc1 G_lt_6
    s_cmp_eq_u32 s67, 9
    s_cbranch_scc1 G_l9
    s_branch G_l10
G_lt_6:
    s_cmp_eq_u32 s67, 11
    s_cbranch_scc1 G_l11
    s_branch G_l12
G_lt_5:
    s_cmp_gt_u32 s67, 14
    s_cbranch_scc1 G_lt_7
    s_cmp_eq_u32 s67, 13
    s_cbranch_scc1 G_l13
    s_branch G_l14
G_lt_7:
    s_cmp_eq_u32 s67, 15
    s_cbranch_scc1 G_l15
G_l16:
    s_ff1_i32_b32 s55, s68
    s_bitset0_b32 s68, s55
    s_mul_i32 s64, s55, 1152
    buffer_load_dwordx4 v[124:127], v17, s[16:19], s64 offen sc1
G_l15:
    s_ff1_i32_b32 s54, s68
    s_bitset0_b32 s68, s54
    s_mul_i32 s64, s54, 1152
    buffer_load_dwordx4 v[120:123], v17, s[16:19], s64 offen sc1
G_l14:
    s_ff1_i32_b32 s53, s68
    s_bitset0_b32 s68, s53
    s_mul_i32 s64, s53, 1152
    buffer_load_dwordx4 v[116:119], v17, s[16:19], s64 offen sc1
G_l13:
    s_ff1_i32_b32 s52, s68
    s_bitset0_b32 s68, s52
    s_mul_i32 s64, s52, 1152
    buffer_load_dwordx4 v[112:115], v17, s[16:19], s64 offen sc1
G_l12:
    s_ff1_i32_b32 s51, s68
    s_bitset0_b32 s68, s51
    s_mul_i32 s64, s51, 1152
    buffer_load_dwordx4 v[108:111], v17, s[16:19], s64 offen sc1
G_l11:
    s_ff1_i32_b32 s50, s68
    s_bitset0_b32 s68, s50
    s_mul_i32 s64, s50, 1152
    buffer_load_dwordx4 v[104:107], v17, s[16:19], s64 offen sc1
G_l10:
    s_ff1_i32_b32 s49, s68
    s_bitset0_b32 s68, s49
    s_mul_i32 s64, s49, 1152
    buffer_load_dwordx4 v[100:103], v17, s[16:19], s64 offen sc1
G_l9:
    s_ff1_i32_b32 s48, s68
    s_bitset0_b32 s68, s48
    s_mul_i32 s64, s48, 1152
    buffer_load_dwordx4 v[96:99], v17, s[16:19], s64 offen sc1
G_l8:
    s_ff1_i32_b32 s47, s68
    s_bitset0_b32 s68, s47
    s_mul_i32 s64, s47, 1152
    buffer_load_dwordx4 v[92:95], v17, s[16:19], s64 offen sc1
G_l7:
    s_ff1_i32_b32 s46, s68
    s_bitset0_b32 s68, s46
    s_mul_i32 s64, s46, 1152
    buffer_load_dwordx4 v[88:91], v17, s[16:19], s64 offen sc1
G_l6:
    s_ff1_i32_b32 s45, s68
    s_bitset0_b32 s68, s45
    s_mul_i32 s64, s45, 1152
    buffer_load_dwordx4 v[84:87], v17, s[16:19], s64 offen sc1
G_l5:
    s_ff1_i32_b32 s44, s68
    s_bitset0_b32 s68, s44
    s_mul_i32 s64, s44, 1152
    buffer_load_dwordx4 v[80:83], v17, s[16:19], s64 offen sc1
G_l4:
    s_ff1_i32_b32 s43, s68
    s_bitset0_b32 s68, s43
    s_mul_i32 s64, s43, 1152
    buffer_load_dwordx4 v[76:79], v17, s[16:19], s64 offen sc1
G_l3:
    s_ff1_i32_b32 s42, s68
    s_bitset0_b32 s68, s42
    s_mul_i32 s64, s42, 1152
    buffer_load_dwordx4 v[72:75], v17, s[16:19], s64 offen sc1
G_l2:
    s_ff1_i32_b32 s41, s68
    s_bitset0_b32 s68, s41
    s_mul_i32 s64, s41, 1152
    buffer_load_dwordx4 v[68:71], v17, s[16:19], s64 offen sc1
G_l1:
    s_ff1_i32_b32 s40, s68
    s_bitset0_b32 s68, s40
    s_mul_i32 s64, s40, 1152
    buffer_load_dwordx4 v[64:67], v17, s[16:19], s64 offen sc1
G_l0:
    s_mov_b32 s68, s66
    s_cmp_eq_u32 s66, 0
    s_cbranch_scc1 G_z
    s_cmp_lg_u32 s67, 0
    s_cbranch_scc1 G_p
    s_sleep 2
G_p:
    s_mov_b64 exec, 1
    v_mov_b32 v20, 0
    buffer_atomic_or v20, v23, s[16:19], 0 offen sc0
    s_mov_b64 exec, -1
    s_branch G_proc
G_z:
    buffer_load_dwordx4 v[56:59], v18, s[16:19], 0 offen sc1
G_proc:
    s_cmp_eq_u32 s67, 0
    s_cbranch_scc1 G_q0
    s_cmp_gt_u32 s67, 8
    s_cbranch_scc1 G_qt_8
    s_cmp_gt_u32 s67, 4
    s_cbranch_scc1 G_qt_9
    s_cmp_gt_u32 s67, 2
    s_cbranch_scc1 G_qt_10
    s_cmp_eq_u32 s67, 1
    s_cbranch_scc1 G_q1
    s_branch G_q2
G_qt_10:
    s_cmp_eq_u32 s67, 3
    s_cbranch_scc1 G_q3
    s_branch G_q4
G_qt_9:
    s_cmp_gt_u32 s67, 6
    s_cbranch_scc1 G_qt_11
    s_cmp_eq_u32 s67, 5
    s_cbranch_scc1 G_q5
    s_branch G_q6
G_qt_11:
    s_cmp_eq_u32 s67, 7
    s_cbranch_scc1 G_q7
    s_branch G_q8
G_qt_8:
    s_cmp_gt_u32 s67, 12
    s_cbranch_scc1 G_qt_12
    s_cmp_gt_u32 s67, 10
    s_cbranch_scc1 G_qt_13
    s_cmp_eq_u32 s67, 9
    s_cbranch_scc1 G_q9
    s_branch G_q10
G_qt_13:
    s_cmp_eq_u32 s67, 11
    s_cbranch_scc1 G_q11
    s_branch G_q12
G_qt_12:
    s_cmp_gt_u32 s67, 14
    s_cbranch_scc1 G_qt_14
    s_cmp_eq_u32 s67, 13
    s_cbranch_scc1 G_q13
    s_branch G_q14
G_qt_14:
    s_cmp_eq_u32 s67, 15
    s_cbranch_scc1 G_q15
G_q16:
    s_waitcnt vmcnt(16)
    v_max3_u32 v21, v124, v125, v126
    v_max_u32 v21, v21, v127
    v_cmp_eq_u32 vcc, -1, v21
    s_cbranch_vccnz G_f15
    v_mfma_f32_32x32x16_bf16 v[128:143], v[48:51], v[124:127], v[128:143]
G_q15:
    s_waitcnt vmcnt(15)
    v_max3_u32 v21, v120, v121, v122
    v_max_u32 v21, v21, v123
    v_cmp_eq_u32 vcc, -1, v21
    s_cbranch_vccnz G_f14
    v_mfma_f32_32x32x16_bf16 v[128:143], v[48:51], v[120:123], v[128:143]
G_q14:
    s_waitcnt vmcnt(14)
    v_max3_u32 v21, v116, v117, v118
    v_max_u32 v21, v21, v119
    v_cmp_eq_u32 vcc, -1, v21
    s_cbranch_vccnz G_f13
    v_mfma_f32_32x32x16_bf16 v[128:143], v[48:51], v[116:119], v[128:143]
G_q13:
    s_waitcnt vmcnt(13)
    v_max3_u32 v21, v112, v113, v114
    v_max_u32 v21, v21, v115
    v_cmp_eq_u32 vcc, -1, v21
    s_cbranch_vccnz G_f12
    v_mfma_f32_32x32x16_bf16 v[128:143], v[48:51], v[112:115], v[128:143]
G_q12:
    s_waitcnt vmcnt(12)
    v_max3_u32 v21, v108, v109, v110
    v_max_u32 v21, v21, v111
    v_cmp_eq_u32 vcc, -1, v21
    s_cbranch_vccnz G_f11
    v_mfma_f32_32x32x16_bf16 v[128:143], v[48:51], v[108:111], v[128:143]
G_q11:
    s_waitcnt vmcnt(11)
    v_max3_u32 v21, v104, v105, v106
    v_max_u32 v21, v21, v107
    v_cmp_eq_u32 vcc, -1, v21
    s_cbranch_vccnz G_f10
    v_mfma_f32_32x32x16_bf16 v[128:143], v[48:51], v[104:107], v[128:143]
G_q10:
    s_waitcnt vmcnt(10)
    v_max3_u32 v21, v100, v101, v102
    v_max_u32 v21, v21, v103
    v_cmp_eq_u32 vcc, -1, v21
    s_cbranch_vccnz G_f9
    v_mfma_f32_32x32x16_bf16 v[128:143], v[48:51], v[100:103], v[128:143]
G_q9:
    s_waitcnt vmcnt(9)
    v_max3_u32 v21, v96, v97, v98
    v_max_u32 v21, v21, v99
    v_cmp_eq_u32 vcc, -1, v21
    s_cbranch_vccnz G_f8
    v_mfma_f32_32x32x16_bf16 v[128:143], v[48:51], v[96:99], v[128:143]
G_q8:
    s_waitcnt vmcnt(8)
    v_max3_u32 v21, v92, v93, v94
    v_max_u32 v21, v21, v95
    v_cmp_eq_u32 vcc, -1, v21
    s_cbranch_vccnz G_f7
    v_mfma_f32_32x32x16_bf16 v[128:143], v[48:51], v[92:95], v[128:143]
G_q7:
    s_waitcnt vmcnt(7)
    v_max3_u32 v21, v88, v89, v90
    v_max_u32 v21, v21, v91
    v_cmp_eq_u32 vcc, -1, v21
    s_cbranch_vccnz G_f6
    v_mfma_f32_32x32x16_bf16 v[128:143], v[48:51], v[88:91], v[128:143]
G_q6:
    s_waitcnt vmcnt(6)
    v_max3_u32 v21, v84, v85, v86
    v_max_u32 v21, v21, v87
    v_cmp_eq_u32 vcc, -1, v21
    s_cbranch_vccnz G_f5
    v_mfma_f32_32x32x16_bf16 v[128:143], v[48:51], v[84:87], v[128:143]
G_q5:
    s_waitcnt vmcnt(5)
    v_max3_u32 v21, v80, v81, v82
    v_max_u32 v21, v21, v83
    v_cmp_eq_u32 vcc, -1, v21
    s_cbranch_vccnz G_f4
    v_mfma_f32_32x32x16_bf16 v[128:143], v[48:51], v[80:83], v[128:143]
G_q4:
    s_waitcnt vmcnt(4)
    v_max3_u32 v21, v76, v77, v78
    v_max_u32 v21, v21, v79
    v_cmp_eq_u32 vcc, -1, v21
    s_cbranch_vccnz G_f3
    v_mfma_f32_32x32x16_bf16 v[128:143], v[48:51], v[76:79], v[128:143]
G_q3:
    s_waitcnt vmcnt(3)
    v_max3_u32 v21, v72, v73, v74
    v_max_u32 v21, v21, v75
    v_cmp_eq_u32 vcc, -1, v21
    s_cbranch_vccnz G_f2
    v_mfma_f32_32x32x16_bf16 v[128:143], v[48:51], v[72:75], v[128:143]
G_q2:
    s_waitcnt vmcnt(2)
    v_max3_u32 v21, v68, v69, v70
    v_max_u32 v21, v21, v71
    v_cmp_eq_u32 vcc, -1, v21
    s_cbranch_vccnz G_f1
    v_mfma_f32_32x32x16_bf16 v[128:143], v[48:51], v[68:71], v[128:143]
G_q1:
    s_waitcnt vmcnt(1)
    v_max3_u32 v21, v64, v65, v66
    v_max_u32 v21, v21, v67
    v_cmp_eq_u32 vcc, -1, v21
    s_cbranch_vccnz G_f0
    v_mfma_f32_32x32x16_bf16 v[128:143], v[48:51], v[64:67], v[128:143]
G_q0:
    s_waitcnt vmcnt(0)
    s_add_u32 s65, s65, 1
    s_cmp_ge_u32 s65, 40000
    s_cbranch_scc1 G_done
    s_cmp_lg_u32 s68, 0
    s_cbranch_scc1 G_loop
    v_mov_b32 v20, -1
    s_cmp_lg_u32 s66, 0
    s_cbranch_scc1 G_loop
    v_max3_u32 v21, v56, v57, v58
    v_max_u32 v21, v21, v59
    v_cmp_eq_u32 vcc, -1, v21
    s_cbranch_vccnz G_loop
G_done:
    v_add_u32 v16, s7, v6
    v_add_f32_dpp v56, v56, v56 row_ror:4 row_mask:0xf bank_mask:0xf
    v_add_f32_dpp v57, v57, v57 row_ror:4 row_mask:0xf bank_mask:0xf
    v_add_f32_dpp v58, v58, v58 row_ror:4 row_mask:0xf bank_mask:0xf
    v_add_f32_dpp v59, v59, v59 row_ror:4 row_mask:0xf bank_mask:0xf
    v_add_f32_dpp v56, v56, v56 row_ror:8 row_mask:0xf bank_mask:0xf
    v_add_f32_dpp v57, v57, v57 row_ror:8 row_mask:0xf bank_mask:0xf
    v_add_f32_dpp v58, v58, v58 row_ror:8 row_mask:0xf bank_mask:0xf
    v_add_f32_dpp v59, v59, v59 row_ror:8 row_mask:0xf bank_mask:0xf
    v_mov_b32 v64, v56
    v_mov_b32 v65, v57
    v_mov_b32 v66, v58
    v_mov_b32 v67, v59
    s_nop 0
    v_permlane16_swap_b32 v56, v64
    v_permlane16_swap_b32 v57, v65
    v_permlane16_swap_b32 v58, v66
    v_permlane16_swap_b32 v59, v67
    v_add_f32 v56, v56, v64
    v_add_f32 v57, v57, v65
    v_add_f32 v58, v58, v66
    v_add_f32 v59, v59, v67
    v_mov_b32 v64, v56
    v_mov_b32 v65, v57
    v_mov_b32 v66, v58
    v_mov_b32 v67, v59
    s_nop 0
    v_permlane32_swap_b32 v56, v64
    v_permlane32_swap_b32 v57, v65
    v_permlane32_swap_b32 v58, v66
    v_permlane32_swap_b32 v59, v67
    v_add_f32 v56, v56, v64
    v_add_f32 v57, v57, v65
    v_add_f32 v58, v58, v66
    v_add_f32 v59, v59, v67
    v_cvt_pk_bf16_f32 v60, v128, v129
    v_cvt_pk_bf16_f32 v61, v130, v131
    v_cvt_pk_bf16_f32 v62, v132, v133
    v_cvt_pk_bf16_f32 v63, v134, v135
    ds_write_b128 v16, v[60:63] offset:0
    v_cvt_pk_bf16_f32 v56, v56, v57
    v_cvt_pk_bf16_f32 v57, v58, v59
    s_lshr_b32 s64, s6, 1
    s_lshl_b32 s64, s64, 6
    s_and_b32 s65, s6, 1
    s_lshl_b32 s65, s65, 3
    s_add_u32 s64, s64, s65
    v_lshl_add_u32 v16, v2, 4, s64
    s_mov_b64 exec, 15
    ds_write_b64 v16, v[56:57] offset:4096
    s_mov_b64 exec, -1
    s_waitcnt lgkmcnt(0)
    s_barrier
    v_lshrrev_b32 v18, 3, v2
    v_lshlrev_b32 v18, 2, v18
    ds_read_b32 v24, v18 offset:4352
    ds_read_b32 v25, v18 offset:4384
    ds_read_b32 v26, v18 offset:4416
    ds_read_b32 v27, v18 offset:4448
    ds_read_b32 v28, v18 offset:4480
    ds_read_b32 v29, v18 offset:4512
    ds_read_b32 v30, v18 offset:4544
    s_waitcnt lgkmcnt(0)
    v_lshlrev_b32 v48, 16, v192
    v_and_b32 v49, 0xffff0000, v192
    v_mul_f32 v32, v48, v24
    v_mul_f32 v33, v49, v24
    v_lshlrev_b32 v48, 16, v193
    v_and_b32 v49, 0xffff0000, v193
    v_mul_f32 v34, v48, v24
    v_mul_f32 v35, v49, v24
    v_lshlrev_b32 v48, 16, v194
    v_and_b32 v49, 0xffff0000, v194
    v_mul_f32 v36, v48, v24
    v_mul_f32 v37, v49, v24
    v_lshlrev_b32 v48, 16, v195
    v_and_b32 v49, 0xffff0000, v195
    v_mul_f32 v38, v48, v24
    v_mul_f32 v39, v49, v24
    v_lshlrev_b32 v48, 16, v196
    v_and_b32 v49, 0xffff0000, v196
    v_fmac_f32 v32, v48, v25
    v_fmac_f32 v33, v49, v25
    v_lshlrev_b32 v48, 16, v197
    v_and_b32 v49, 0xffff0000, v197
    v_fmac_f32 v34, v48, v25
    v_fmac_f32 v35, v49, v25
    v_lshlrev_b32 v48, 16, v198
    v_and_b32 v49, 0xffff0000, v198
    v_fmac_f32 v36, v48, v25
    v_fmac_f32 v37, v49, v25
    v_lshlrev_b32 v48, 16, v199
    v_and_b32 v49, 0xffff0000, v199
    v_fmac_f32 v38, v48, v25
    v_fmac_f32 v39, v49, v25
    v_lshlrev_b32 v48, 16, v200
    v_and_b32 v49, 0xffff0000, v200
    v_fmac_f32 v32, v48, v26
    v_fmac_f32 v33, v49, v26
    v_lshlrev_b32 v48, 16, v201
    v_and_b32 v49, 0xffff0000, v201
    v_fmac_f32 v34, v48, v26
    v_fmac_f32 v35, v49, v26
    v_lshlrev_b32 v48, 16, v202
    v_and_b32 v49, 0xffff0000, v202
    v_fmac_f32 v36, v48, v26
    v_fmac_f32 v37, v49, v26
    v_lshlrev_b32 v48, 16, v203
    v_and_b32 v49, 0xffff0000, v203
    v_fmac_f32 v38, v48, v26
    v_fmac_f32 v39, v49, v26
    v_lshlrev_b32 v48, 16, v204
    v_and_b32 v49, 0xffff0000, v204
    v_fmac_f32 v32, v48, v27
    v_fmac_f32 v33, v49, v27
    v_lshlrev_b32 v48, 16, v205
    v_and_b32 v49, 0xffff0000, v205
    v_fmac_f32 v34, v48, v27
    v_fmac_f32 v35, v49, v27
    v_lshlrev_b32 v48, 16, v206
    v_and_b32 v49, 0xffff0000, v206
    v_fmac_f32 v36, v48, v27
    v_fmac_f32 v37, v49, v27
    v_lshlrev_b32 v48, 16, v207
    v_and_b32 v49, 0xffff0000, v207
    v_fmac_f32 v38, v48, v27
    v_fmac_f32 v39, v49, v27
    v_lshlrev_b32 v48, 16, v208
    v_and_b32 v49, 0xffff0000, v208
    v_fmac_f32 v32, v48, v28
    v_fmac_f32 v33, v49, v28
    v_lshlrev_b32 v48, 16, v209
    v_and_b32 v49, 0xffff0000, v209
    v_fmac_f32 v34, v48, v28
    v_fmac_f32 v35, v49, v28
    v_lshlrev_b32 v48, 16, v210
    v_and_b32 v49, 0xffff0000, v210
    v_fmac_f32 v36, v48, v28
    v_fmac_f32 v37, v49, v28
    v_lshlrev_b32 v48, 16, v211
    v_and_b32 v49, 0xffff0000, v211
    v_fmac_f32 v38, v48, v28
    v_fmac_f32 v39, v49, v28
    v_lshlrev_b32 v48, 16, v212
    v_and_b32 v49, 0xffff0000, v212
    v_fmac_f32 v32, v48, v29
    v_fmac_f32 v33, v49, v29
    v_lshlrev_b32 v48, 16, v213
    v_and_b32 v49, 0xffff0000, v213
    v_fmac_f32 v34, v48, v29
    v_fmac_f32 v35, v49, v29
    v_lshlrev_b32 v48, 16, v214
    v_and_b32 v49, 0xffff0000, v214
    v_fmac_f32 v36, v48, v29
    v_fmac_f32 v37, v49, v29
    v_lshlrev_b32 v48, 16, v215
    v_and_b32 v49, 0xffff0000, v215
    v_fmac_f32 v38, v48, v29
    v_fmac_f32 v39, v49, v29
    v_lshlrev_b32 v48, 16, v216
    v_and_b32 v49, 0xffff0000, v216
    v_fmac_f32 v32, v48, v30
    v_fmac_f32 v33, v49, v30
    v_lshlrev_b32 v48, 16, v217
    v_and_b32 v49, 0xffff0000, v217
    v_fmac_f32 v34, v48, v30
    v_fmac_f32 v35, v49, v30
    v_lshlrev_b32 v48, 16, v218
    v_and_b32 v49, 0xffff0000, v218
    v_fmac_f32 v36, v48, v30
    v_fmac_f32 v37, v49, v30
    v_lshlrev_b32 v48, 16, v219
    v_and_b32 v49, 0xffff0000, v219
    v_fmac_f32 v38, v48, v30
    v_fmac_f32 v39, v49, v30
    s_nop 1
    v_permlane32_swap_b32 v32, v36
    v_permlane32_swap_b32 v33, v37
    v_permlane32_swap_b32 v34, v38
    v_permlane32_swap_b32 v35, v39
    v_add_f32 v32, v32, v36
    v_add_f32 v33, v33, v37
    v_add_f32 v34, v34, v38
    v_add_f32 v35, v35, v39
    s_nop 1
    v_permlane16_swap_b32 v32, v34
    v_permlane16_swap_b32 v33, v35
    v_add_f32 v32, v32, v34
    v_add_f32 v33, v33, v35
    s_nop 1
    v_add_f32_dpp v32, v32, v32 row_ror:8 row_mask:0xf bank_mask:0xf
    v_add_f32_dpp v33, v33, v33 row_ror:8 row_mask:0xf bank_mask:0xf
    v_and_b32 v16, 7, v2
    v_lshlrev_b32 v16, 5, v16
    v_lshl_add_u32 v16, v8, 3, v16
    s_lshl_b32 s64, s2, 10
    s_lshl_b32 s65, s6, 8
    s_add_u32 s64, s64, s65
    s_add_u32 s64, s64, 6447104
    s_mov_b32 exec_lo, 0x00ff00ff
    s_mov_b32 exec_hi, 0x00ff00ff
    buffer_store_dwordx2 v[32:33], v16, s[16:19], s64 offen sc0 sc1
    s_mov_b64 exec, -1
    s_lshl_b32 s64, s4, 3
    s_add_u32 s64, s64, s3
    s_lshl_b32 s64, s64, 7
    s_add_u32 s64, s64, 5382144
    v_mov_b32 v14, s64
    s_mov_b64 exec, 1
    v_mov_b32 v15, 0
    buffer_atomic_or v15, v14, s[16:19], 0 offen sc0
    s_mov_b64 exec, -1
    v_sub_f32 v248, 1.0, v228
    v_cvt_pk_bf16_f32 v248, v248, v248
    v_lshlrev_b32 v248, 16, v248
    v_lshlrev_b32 v232, 16, v220
    v_and_b32 v233, 0xffff0000, v220
    v_mul_f32 v232, v232, v248
    v_mul_f32 v233, v233, v248
    v_cvt_pk_bf16_f32 v3, v232, v233
    v_lshlrev_b32 v232, 16, v3
    v_and_b32 v233, 0xffff0000, v3
    v_lshlrev_b32 v234, 16, v221
    v_and_b32 v235, 0xffff0000, v221
    v_mul_f32 v234, v234, v248
    v_mul_f32 v235, v235, v248
    v_cvt_pk_bf16_f32 v3, v234, v235
    v_lshlrev_b32 v234, 16, v3
    v_and_b32 v235, 0xffff0000, v3
    v_lshlrev_b32 v236, 16, v222
    v_and_b32 v237, 0xffff0000, v222
    v_mul_f32 v236, v236, v248
    v_mul_f32 v237, v237, v248
    v_cvt_pk_bf16_f32 v3, v236, v237
    v_lshlrev_b32 v236, 16, v3
    v_and_b32 v237, 0xffff0000, v3
    v_lshlrev_b32 v238, 16, v223
    v_and_b32 v239, 0xffff0000, v223
    v_mul_f32 v238, v238, v248
    v_mul_f32 v239, v239, v248
    v_cvt_pk_bf16_f32 v3, v238, v239
    v_lshlrev_b32 v238, 16, v3
    v_and_b32 v239, 0xffff0000, v3
    v_lshlrev_b32 v240, 16, v224
    v_and_b32 v241, 0xffff0000, v224
    v_mul_f32 v240, v240, v248
    v_mul_f32 v241, v241, v248
    v_cvt_pk_bf16_f32 v3, v240, v241
    v_lshlrev_b32 v240, 16, v3
    v_and_b32 v241, 0xffff0000, v3
    v_lshlrev_b32 v242, 16, v225
    v_and_b32 v243, 0xffff0000, v225
    v_mul_f32 v242, v242, v248
    v_mul_f32 v243, v243, v248
    v_cvt_pk_bf16_f32 v3, v242, v243
    v_lshlrev_b32 v242, 16, v3
    v_and_b32 v243, 0xffff0000, v3
    v_lshlrev_b32 v244, 16, v226
    v_and_b32 v245, 0xffff0000, v226
    v_mul_f32 v244, v244, v248
    v_mul_f32 v245, v245, v248
    v_cvt_pk_bf16_f32 v3, v244, v245
    v_lshlrev_b32 v244, 16, v3
    v_and_b32 v245, 0xffff0000, v3
    v_lshlrev_b32 v246, 16, v227
    v_and_b32 v247, 0xffff0000, v227
    v_mul_f32 v246, v246, v248
    v_mul_f32 v247, v247, v248
    v_cvt_pk_bf16_f32 v3, v246, v247
    v_lshlrev_b32 v246, 16, v3
    v_and_b32 v247, 0xffff0000, v3
    s_branch P2_start
C_start:
    s_getpc_b64 s[68:69]
C_pc:
    s_sub_u32 s68, s68, C_pc-gated_mix__linear_attn_block__moe_arch_mod__prompt_kernel
    s_subb_u32 s69, s69, 0
    s_lshr_b32 s64, s2, 3
    s_lshl_b32 s64, s64, 2
    s_add_u32 s64, s64, s3
    s_mul_i32 s64, s64, 256
    s_mov_b32 s65, CODE_END-gated_mix__linear_attn_block__moe_arch_mod__prompt_kernel-4
    s_min_u32 s66, s64, s65
    s_load_dword s75, s[68:69], s66
    s_add_u32 s64, s64, 64
    s_min_u32 s66, s64, s65
    s_load_dword s75, s[68:69], s66
    s_add_u32 s64, s64, 64
    s_min_u32 s66, s64, s65
    s_load_dword s75, s[68:69], s66
    s_add_u32 s64, s64, 64
    s_min_u32 s66, s64, s65
    s_load_dword s75, s[68:69], s66
    s_add_u32 s64, s64, 64
    s_and_b32 s6, s3, 1
    s_lshr_b32 s7, s3, 1
    v_and_b32 v3, 15, v2
    s_lshl_b32 s64, s6, 6
    v_add_u32 v3, s64, v3
    v_lshlrev_b32 v3, 7, v3
    v_add_u32 v3, 8192, v3
    v_bfe_u32 v56, v2, 1, 3
    v_lshrrev_b32 v57, 4, v2
    v_xor_b32 v56, v56, v57
    v_lshl_add_u32 v4, v56, 4, v3
    v_xor_b32 v5, 64, v4
    v_bfe_u32 v56, v2, 2, 2
    v_lshl_add_u32 v58, v57, 3, v56
    v_lshlrev_b32 v58, 7, v58
    v_lshrrev_b32 v56, 1, v56
    v_xor_b32 v56, s7, v56
    v_lshl_add_u32 v58, v56, 6, v58
    v_and_b32 v57, 1, v57
    v_lshl_add_u32 v58, v57, 5, v58
    v_and_b32 v56, 3, v2
    v_lshl_add_u32 v58, v56, 3, v58
    v_add_u32 v6, 24576, v58
    v_xor_b32 v7, 32, v6
    v_mov_b32 v8, v4
    v_mov_b32 v10, v6
    v_mov_b32 v9, v5
    v_mov_b32 v11, v7
    v_mov_b32 v64, 0
    v_mov_b32 v65, 0
    v_mov_b32 v66, 0
    v_mov_b32 v67, 0
    v_mov_b32 v68, 0
    v_mov_b32 v69, 0
    v_mov_b32 v70, 0
    v_mov_b32 v71, 0
    v_mov_b32 v72, 0
    v_mov_b32 v73, 0
    v_mov_b32 v74, 0
    v_mov_b32 v75, 0
    v_mov_b32 v76, 0
    v_mov_b32 v77, 0
    v_mov_b32 v78, 0
    v_mov_b32 v79, 0
    v_mov_b32 v80, 0
    v_mov_b32 v81, 0
    v_mov_b32 v82, 0
    v_mov_b32 v83, 0
    v_mov_b32 v84, 0
    v_mov_b32 v85, 0
    v_mov_b32 v86, 0
    v_mov_b32 v87, 0
    v_mov_b32 v88, 0
    v_mov_b32 v89, 0
    v_mov_b32 v90, 0
    v_mov_b32 v91, 0
    v_mov_b32 v92, 0
    v_mov_b32 v93, 0
    v_mov_b32 v94, 0
    v_mov_b32 v95, 0
    v_mov_b32 v96, 0
    v_mov_b32 v97, 0
    v_mov_b32 v98, 0
    v_mov_b32 v99, 0
    v_mov_b32 v100, 0
    v_mov_b32 v101, 0
    v_mov_b32 v102, 0
    v_mov_b32 v103, 0
    v_mov_b32 v104, 0
    v_mov_b32 v105, 0
    v_mov_b32 v106, 0
    v_mov_b32 v107, 0
    v_mov_b32 v108, 0
    v_mov_b32 v109, 0
    v_mov_b32 v110, 0
    v_mov_b32 v111, 0
    v_mov_b32 v112, 0
    v_mov_b32 v113, 0
    v_mov_b32 v114, 0
    v_mov_b32 v115, 0
    v_mov_b32 v116, 0
    v_mov_b32 v117, 0
    v_mov_b32 v118, 0
    v_mov_b32 v119, 0
    v_mov_b32 v120, 0
    v_mov_b32 v121, 0
    v_mov_b32 v122, 0
    v_mov_b32 v123, 0
    v_mov_b32 v124, 0
    v_mov_b32 v125, 0
    v_mov_b32 v126, 0
    v_mov_b32 v127, 0
    v_mov_b32 v128, 0
    v_mov_b32 v129, 0
    v_mov_b32 v130, 0
    v_mov_b32 v131, 0
    v_mov_b32 v132, 0
    v_mov_b32 v133, 0
    v_mov_b32 v134, 0
    v_mov_b32 v135, 0
    v_mov_b32 v136, 0
    v_mov_b32 v137, 0
    v_mov_b32 v138, 0
    v_mov_b32 v139, 0
    v_mov_b32 v140, 0
    v_mov_b32 v141, 0
    v_mov_b32 v142, 0
    v_mov_b32 v143, 0
    v_mov_b32 v144, 0
    v_mov_b32 v145, 0
    v_mov_b32 v146, 0
    v_mov_b32 v147, 0
    v_mov_b32 v148, 0
    v_mov_b32 v149, 0
    v_mov_b32 v150, 0
    v_mov_b32 v151, 0
    v_mov_b32 v152, 0
    v_mov_b32 v153, 0
    v_mov_b32 v154, 0
    v_mov_b32 v155, 0
    v_mov_b32 v156, 0
    v_mov_b32 v157, 0
    v_mov_b32 v158, 0
    v_mov_b32 v159, 0
    s_lshl_b32 s64, s3, 2
    v_mov_b32 v229, s64
    ds_write_b32 v229, v64 offset:4288
    v_lshlrev_b32 v3, 4, v2
    s_lshl_b32 s64, s3, 11
    v_add_u32 v224, s64, v3
    v_xor_b32 v225, 2048, v224
    s_lshl_b32 s64, s3, 8
    v_lshl_add_u32 v227, v2, 2, s64
    v_xor_b32 v228, 256, v227
    v_xor_b32 v230, 4, v229
    v_mov_b32 v231, 1
    v_lshlrev_b32 v232, 2, v2
    s_lshl_b32 s64, 1, s4
    v_mov_b32 v233, s64
    s_lshl_b32 s43, s5, 2
    s_add_u32 s43, s43, s3
    s_lshl_b32 s64, s43, 7
    s_add_u32 s64, s64, 5373952
    v_mov_b32 v234, s64
    s_lshl_b32 s43, s43, 4
    s_add_u32 s43, s43, s4
    s_mul_i32 s43, s43, 1152
    s_add_u32 s43, s43, 4194304
    s_lshl_b32 s42, s4, 2
    s_lshl_b32 s64, s6, 1
    s_add_u32 s42, s42, s64
    s_lshl_b32 s42, s42, 5
    s_lshl_b32 s64, s5, 1
    s_add_u32 s42, s42, s64
    s_add_u32 s42, s42, s7
    s_lshl_b32 s42, s42, 11
    s_and_b32 s64, s5, 7
    s_lshl_b32 s64, s64, 1
    s_add_u32 s64, s64, s7
    s_lshl_b32 s64, 1, s64
    v_mov_b32 v13, s64
    s_lshr_b32 s64, s5, 3
    s_lshl_b32 s64, s64, 1
    s_add_u32 s64, s64, s6
    s_lshl_b32 s64, s64, 8
    s_lshl_b32 s65, s4, 10
    s_add_u32 s64, s64, s65
    s_add_u32 s64, s64, 5382144
    v_lshl_add_u32 v12, v2, 7, s64
    s_and_b32 s64, s2, 7
    s_lshr_b32 s65, s2, 3
    s_and_b32 s4, s64, 3
    s_lshl_b32 s4, s4, 2
    s_and_b32 s66, s65, 3
    s_add_u32 s4, s4, s66
    s_lshr_b32 s5, s64, 2
    s_lshl_b32 s5, s5, 3
    s_lshr_b32 s66, s65, 2
    s_add_u32 s5, s5, s66
    s_mov_b32 s65, 0
    s_mov_b32 s66, 0
    v_mov_b32 v236, 0x3f803f80
    v_mov_b32 v237, 0x3f803f80
    v_mov_b32 v238, 0x3f803f80
    v_mov_b32 v239, 0x3f803f80
    s_waitcnt vmcnt(0) lgkmcnt(0)
    s_barrier
    ds_read_b64_tr_b16 v[16:17], v10 offset:0
    ds_read_b64_tr_b16 v[18:19], v10 offset:512
    ds_read_b128 v[192:195], v8 offset:0
    ds_read_b128 v[196:199], v8 offset:2048
    ds_read_b128 v[200:203], v8 offset:4096
    ds_read_b128 v[204:207], v8 offset:6144
    ds_read_b64_tr_b16 v[20:21], v11 offset:0
    ds_read_b64_tr_b16 v[22:23], v11 offset:512
    ds_read_b64_tr_b16 v[24:25], v10 offset:8192
    ds_read_b64_tr_b16 v[26:27], v10 offset:8704
    ds_read_b64_tr_b16 v[28:29], v11 offset:8192
    ds_read_b64_tr_b16 v[30:31], v11 offset:8704
    ds_read_b64_tr_b16 v[32:33], v10 offset:16384
    ds_read_b64_tr_b16 v[34:35], v10 offset:16896
    ds_read_b64_tr_b16 v[36:37], v11 offset:16384
    ds_read_b64_tr_b16 v[38:39], v11 offset:16896
.p2align 3
C_loop:
    s_waitcnt lgkmcnt(0)
    v_mfma_f32_16x16x32_bf16 v[64:67], v[16:19], v[192:195], v[64:67]
    ds_read_b64_tr_b16 v[40:41], v10 offset:4096
    v_mfma_f32_16x16x32_bf16 v[72:75], v[16:19], v[196:199], v[72:75]
    ds_read_b64_tr_b16 v[42:43], v10 offset:4608
    v_mfma_f32_16x16x32_bf16 v[80:83], v[16:19], v[200:203], v[80:83]
    ds_read_b128 v[208:211], v9 offset:0
    v_mfma_f32_16x16x32_bf16 v[88:91], v[16:19], v[204:207], v[88:91]
    ds_read_b128 v[212:215], v9 offset:2048
    v_mfma_f32_16x16x32_bf16 v[68:71], v[20:23], v[192:195], v[68:71]
    ds_read_b128 v[216:219], v9 offset:4096
    v_mfma_f32_16x16x32_bf16 v[76:79], v[20:23], v[196:199], v[76:79]
    ds_read_b128 v[220:223], v9 offset:6144
    v_mfma_f32_16x16x32_bf16 v[84:87], v[20:23], v[200:203], v[84:87]
    ds_read_b64_tr_b16 v[44:45], v11 offset:4096
    v_mfma_f32_16x16x32_bf16 v[92:95], v[20:23], v[204:207], v[92:95]
    ds_read_b64_tr_b16 v[46:47], v11 offset:4608
    v_mfma_f32_16x16x32_bf16 v[96:99], v[192:195], v[24:27], v[96:99]
    ds_read_b64_tr_b16 v[48:49], v10 offset:12288
    v_mfma_f32_16x16x32_bf16 v[100:103], v[196:199], v[24:27], v[100:103]
    ds_read_b64_tr_b16 v[50:51], v10 offset:12800
    v_mfma_f32_16x16x32_bf16 v[112:115], v[200:203], v[24:27], v[112:115]
    ds_read_b64_tr_b16 v[52:53], v11 offset:12288
    v_mfma_f32_16x16x32_bf16 v[116:119], v[204:207], v[24:27], v[116:119]
    ds_read_b64_tr_b16 v[54:55], v11 offset:12800
    v_mfma_f32_16x16x32_bf16 v[104:107], v[192:195], v[28:31], v[104:107]
    ds_read_b64_tr_b16 v[56:57], v10 offset:20480
    v_mfma_f32_16x16x32_bf16 v[108:111], v[196:199], v[28:31], v[108:111]
    ds_read_b64_tr_b16 v[58:59], v10 offset:20992
    v_mfma_f32_16x16x32_bf16 v[120:123], v[200:203], v[28:31], v[120:123]
    ds_read_b64_tr_b16 v[60:61], v11 offset:20480
    v_mfma_f32_16x16x32_bf16 v[124:127], v[204:207], v[28:31], v[124:127]
    ds_read_b64_tr_b16 v[62:63], v11 offset:20992
    v_mfma_f32_16x16x32_bf16 v[128:131], v[192:195], v[32:35], v[128:131]
    v_mfma_f32_16x16x32_bf16 v[132:135], v[196:199], v[32:35], v[132:135]
    v_mfma_f32_16x16x32_bf16 v[144:147], v[200:203], v[32:35], v[144:147]
    v_mfma_f32_16x16x32_bf16 v[148:151], v[204:207], v[32:35], v[148:151]
    v_mfma_f32_16x16x32_bf16 v[136:139], v[192:195], v[36:39], v[136:139]
    v_mfma_f32_16x16x32_bf16 v[140:143], v[196:199], v[36:39], v[140:143]
    v_mfma_f32_16x16x32_bf16 v[152:155], v[200:203], v[36:39], v[152:155]
    v_mfma_f32_16x16x32_bf16 v[156:159], v[204:207], v[36:39], v[156:159]
    s_waitcnt lgkmcnt(0)
    s_barrier
    s_add_u32 s65, s65, 40960
    s_cmp_eq_u32 s65, 122880
    s_cselect_b32 s65, 0, s65
    v_mfma_f32_16x16x32_bf16 v[64:67], v[40:43], v[208:211], v[64:67]
    v_add_u32 v10, s65, v6
    v_add_u32 v8, s65, v4
    v_mfma_f32_16x16x32_bf16 v[72:75], v[40:43], v[212:215], v[72:75]
    ds_read_b64_tr_b16 v[16:17], v10 offset:0
    v_mfma_f32_16x16x32_bf16 v[80:83], v[40:43], v[216:219], v[80:83]
    ds_read_b64_tr_b16 v[18:19], v10 offset:512
    v_mfma_f32_16x16x32_bf16 v[88:91], v[40:43], v[220:223], v[88:91]
    ds_read_b128 v[192:195], v8 offset:0
    v_mfma_f32_16x16x32_bf16 v[68:71], v[44:47], v[208:211], v[68:71]
    ds_read_b128 v[196:199], v8 offset:2048
    v_mfma_f32_16x16x32_bf16 v[76:79], v[44:47], v[212:215], v[76:79]
    ds_read_b128 v[200:203], v8 offset:4096
    v_mfma_f32_16x16x32_bf16 v[84:87], v[44:47], v[216:219], v[84:87]
    ds_read_b128 v[204:207], v8 offset:6144
    v_mfma_f32_16x16x32_bf16 v[92:95], v[44:47], v[220:223], v[92:95]
    v_add_u32 v11, s65, v7
    v_mfma_f32_16x16x32_bf16 v[96:99], v[208:211], v[48:51], v[96:99]
    ds_read_b64_tr_b16 v[20:21], v11 offset:0
    v_mfma_f32_16x16x32_bf16 v[100:103], v[212:215], v[48:51], v[100:103]
    ds_read_b64_tr_b16 v[22:23], v11 offset:512
    v_mfma_f32_16x16x32_bf16 v[112:115], v[216:219], v[48:51], v[112:115]
    ds_read_b64_tr_b16 v[24:25], v10 offset:8192
    v_mfma_f32_16x16x32_bf16 v[116:119], v[220:223], v[48:51], v[116:119]
    ds_read_b64_tr_b16 v[26:27], v10 offset:8704
    v_mfma_f32_16x16x32_bf16 v[104:107], v[208:211], v[52:55], v[104:107]
    ds_read_b64_tr_b16 v[28:29], v11 offset:8192
    v_mfma_f32_16x16x32_bf16 v[108:111], v[212:215], v[52:55], v[108:111]
    ds_read_b64_tr_b16 v[30:31], v11 offset:8704
    v_mfma_f32_16x16x32_bf16 v[120:123], v[216:219], v[52:55], v[120:123]
    ds_read_b64_tr_b16 v[32:33], v10 offset:16384
    v_mfma_f32_16x16x32_bf16 v[124:127], v[220:223], v[52:55], v[124:127]
    ds_read_b64_tr_b16 v[34:35], v10 offset:16896
    v_mfma_f32_16x16x32_bf16 v[128:131], v[208:211], v[56:59], v[128:131]
    ds_read_b64_tr_b16 v[36:37], v11 offset:16384
    v_mfma_f32_16x16x32_bf16 v[132:135], v[212:215], v[56:59], v[132:135]
    ds_read_b64_tr_b16 v[38:39], v11 offset:16896
    v_mfma_f32_16x16x32_bf16 v[144:147], v[216:219], v[56:59], v[144:147]
    v_add_u32 v9, s65, v5
    v_mfma_f32_16x16x32_bf16 v[148:151], v[220:223], v[56:59], v[148:151]
    v_mfma_f32_16x16x32_bf16 v[136:139], v[208:211], v[60:63], v[136:139]
    v_mfma_f32_16x16x32_bf16 v[140:143], v[212:215], v[60:63], v[140:143]
    v_mfma_f32_16x16x32_bf16 v[152:155], v[216:219], v[60:63], v[152:155]
    v_mfma_f32_16x16x32_bf16 v[156:159], v[220:223], v[60:63], v[156:159]
    s_add_u32 s66, s66, 1
    s_cmp_lt_u32 s66, 14
    s_cbranch_scc1 C_loop
    s_waitcnt lgkmcnt(0)
    v_mfma_f32_16x16x32_bf16 v[96:99], v[192:195], v[24:27], v[96:99]
    ds_read_b64_tr_b16 v[48:49], v10 offset:12288
    v_mfma_f32_16x16x32_bf16 v[100:103], v[196:199], v[24:27], v[100:103]
    ds_read_b64_tr_b16 v[50:51], v10 offset:12800
    v_mfma_f32_16x16x32_bf16 v[112:115], v[200:203], v[24:27], v[112:115]
    ds_read_b128 v[160:163], v9 offset:0
    v_mfma_f32_16x16x32_bf16 v[116:119], v[204:207], v[24:27], v[116:119]
    ds_read_b128 v[164:167], v9 offset:2048
    v_mfma_f32_16x16x32_bf16 v[104:107], v[192:195], v[28:31], v[104:107]
    ds_read_b128 v[168:171], v9 offset:4096
    v_mfma_f32_16x16x32_bf16 v[108:111], v[196:199], v[28:31], v[108:111]
    ds_read_b128 v[172:175], v9 offset:6144
    v_mfma_f32_16x16x32_bf16 v[120:123], v[200:203], v[28:31], v[120:123]
    ds_read_b64_tr_b16 v[52:53], v11 offset:12288
    v_mfma_f32_16x16x32_bf16 v[124:127], v[204:207], v[28:31], v[124:127]
    ds_read_b64_tr_b16 v[54:55], v11 offset:12800
    v_mfma_f32_16x16x32_bf16 v[128:131], v[192:195], v[32:35], v[128:131]
    ds_read_b64_tr_b16 v[56:57], v10 offset:20480
    v_mfma_f32_16x16x32_bf16 v[132:135], v[196:199], v[32:35], v[132:135]
    ds_read_b64_tr_b16 v[58:59], v10 offset:20992
    v_mfma_f32_16x16x32_bf16 v[144:147], v[200:203], v[32:35], v[144:147]
    ds_read_b64_tr_b16 v[60:61], v11 offset:20480
    v_mfma_f32_16x16x32_bf16 v[148:151], v[204:207], v[32:35], v[148:151]
    ds_read_b64_tr_b16 v[62:63], v11 offset:20992
    v_mfma_f32_16x16x32_bf16 v[136:139], v[192:195], v[36:39], v[136:139]
    v_mfma_f32_16x16x32_bf16 v[140:143], v[196:199], v[36:39], v[140:143]
    v_mfma_f32_16x16x32_bf16 v[152:155], v[200:203], v[36:39], v[152:155]
    v_mfma_f32_16x16x32_bf16 v[156:159], v[204:207], v[36:39], v[156:159]
    s_waitcnt lgkmcnt(0)
    s_barrier
    s_add_u32 s66, s66, 1
    v_mfma_f32_16x16x32_bf16 v[96:99], v[160:163], v[48:51], v[96:99]
    v_mov_b32 v10, v6
    v_mov_b32 v8, v4
    v_mfma_f32_16x16x32_bf16 v[100:103], v[164:167], v[48:51], v[100:103]
    ds_read_b64_tr_b16 v[24:25], v10 offset:8192
    v_mfma_f32_16x16x32_bf16 v[112:115], v[168:171], v[48:51], v[112:115]
    ds_read_b64_tr_b16 v[26:27], v10 offset:8704
    v_mfma_f32_16x16x32_bf16 v[116:119], v[172:175], v[48:51], v[116:119]
    v_mov_b32 v11, v7
    v_mov_b32 v9, v5
    v_mfma_f32_16x16x32_bf16 v[104:107], v[160:163], v[52:55], v[104:107]
    ds_read_b128 v[176:179], v8 offset:0
    v_mfma_f32_16x16x32_bf16 v[108:111], v[164:167], v[52:55], v[108:111]
    ds_read_b128 v[180:183], v8 offset:2048
    v_mfma_f32_16x16x32_bf16 v[120:123], v[168:171], v[52:55], v[120:123]
    ds_read_b128 v[184:187], v8 offset:4096
    v_mfma_f32_16x16x32_bf16 v[124:127], v[172:175], v[52:55], v[124:127]
    ds_read_b128 v[188:191], v8 offset:6144
    v_mfma_f32_16x16x32_bf16 v[128:131], v[160:163], v[56:59], v[128:131]
    ds_read_b64_tr_b16 v[28:29], v11 offset:8192
    v_mfma_f32_16x16x32_bf16 v[132:135], v[164:167], v[56:59], v[132:135]
    ds_read_b64_tr_b16 v[30:31], v11 offset:8704
    v_mfma_f32_16x16x32_bf16 v[144:147], v[168:171], v[56:59], v[144:147]
    ds_read_b64_tr_b16 v[32:33], v10 offset:16384
    v_mfma_f32_16x16x32_bf16 v[148:151], v[172:175], v[56:59], v[148:151]
    ds_read_b64_tr_b16 v[34:35], v10 offset:16896
    v_mfma_f32_16x16x32_bf16 v[136:139], v[160:163], v[60:63], v[136:139]
    ds_read_b64_tr_b16 v[36:37], v11 offset:16384
    v_mfma_f32_16x16x32_bf16 v[140:143], v[164:167], v[60:63], v[140:143]
    ds_read_b64_tr_b16 v[38:39], v11 offset:16896
    v_mfma_f32_16x16x32_bf16 v[152:155], v[168:171], v[60:63], v[152:155]
    v_mfma_f32_16x16x32_bf16 v[156:159], v[172:175], v[60:63], v[156:159]
    s_waitcnt lgkmcnt(0)
    v_mfma_f32_16x16x32_bf16 v[96:99], v[176:179], v[24:27], v[96:99]
    ds_read_b64_tr_b16 v[48:49], v10 offset:12288
    v_mfma_f32_16x16x32_bf16 v[100:103], v[180:183], v[24:27], v[100:103]
    ds_read_b64_tr_b16 v[50:51], v10 offset:12800
    v_mfma_f32_16x16x32_bf16 v[112:115], v[184:187], v[24:27], v[112:115]
    ds_read_b128 v[208:211], v9 offset:0
    v_mfma_f32_16x16x32_bf16 v[116:119], v[188:191], v[24:27], v[116:119]
    ds_read_b128 v[212:215], v9 offset:2048
    v_mfma_f32_16x16x32_bf16 v[104:107], v[176:179], v[28:31], v[104:107]
    ds_read_b128 v[216:219], v9 offset:4096
    v_mfma_f32_16x16x32_bf16 v[108:111], v[180:183], v[28:31], v[108:111]
    ds_read_b128 v[220:223], v9 offset:6144
    v_mfma_f32_16x16x32_bf16 v[120:123], v[184:187], v[28:31], v[120:123]
    ds_read_b64_tr_b16 v[52:53], v11 offset:12288
    v_mfma_f32_16x16x32_bf16 v[124:127], v[188:191], v[28:31], v[124:127]
    ds_read_b64_tr_b16 v[54:55], v11 offset:12800
    v_mfma_f32_16x16x32_bf16 v[128:131], v[176:179], v[32:35], v[128:131]
    ds_read_b64_tr_b16 v[56:57], v10 offset:20480
    v_mfma_f32_16x16x32_bf16 v[132:135], v[180:183], v[32:35], v[132:135]
    ds_read_b64_tr_b16 v[58:59], v10 offset:20992
    v_mfma_f32_16x16x32_bf16 v[144:147], v[184:187], v[32:35], v[144:147]
    ds_read_b64_tr_b16 v[60:61], v11 offset:20480
    v_mfma_f32_16x16x32_bf16 v[148:151], v[188:191], v[32:35], v[148:151]
    ds_read_b64_tr_b16 v[62:63], v11 offset:20992
    v_mfma_f32_16x16x32_bf16 v[136:139], v[176:179], v[36:39], v[136:139]
    v_mfma_f32_16x16x32_bf16 v[140:143], v[180:183], v[36:39], v[140:143]
    v_mfma_f32_16x16x32_bf16 v[152:155], v[184:187], v[36:39], v[152:155]
    v_mfma_f32_16x16x32_bf16 v[156:159], v[188:191], v[36:39], v[156:159]
    s_waitcnt lgkmcnt(0)
    s_barrier
    v_mfma_f32_16x16x32_bf16 v[96:99], v[208:211], v[48:51], v[96:99]
    v_mfma_f32_16x16x32_bf16 v[100:103], v[212:215], v[48:51], v[100:103]
    v_mfma_f32_16x16x32_bf16 v[112:115], v[216:219], v[48:51], v[112:115]
    v_mfma_f32_16x16x32_bf16 v[116:119], v[220:223], v[48:51], v[116:119]
    v_mfma_f32_16x16x32_bf16 v[104:107], v[208:211], v[52:55], v[104:107]
    v_mfma_f32_16x16x32_bf16 v[108:111], v[212:215], v[52:55], v[108:111]
    v_mfma_f32_16x16x32_bf16 v[120:123], v[216:219], v[52:55], v[120:123]
    v_mfma_f32_16x16x32_bf16 v[124:127], v[220:223], v[52:55], v[124:127]
    v_mfma_f32_16x16x32_bf16 v[128:131], v[208:211], v[56:59], v[128:131]
    v_mfma_f32_16x16x32_bf16 v[132:135], v[212:215], v[56:59], v[132:135]
    v_mfma_f32_16x16x32_bf16 v[144:147], v[216:219], v[56:59], v[144:147]
    v_mfma_f32_16x16x32_bf16 v[148:151], v[220:223], v[56:59], v[148:151]
    v_mfma_f32_16x16x32_bf16 v[136:139], v[208:211], v[60:63], v[136:139]
    v_mfma_f32_16x16x32_bf16 v[140:143], v[212:215], v[60:63], v[140:143]
    v_mfma_f32_16x16x32_bf16 v[152:155], v[216:219], v[60:63], v[152:155]
    v_mfma_f32_16x16x32_bf16 v[156:159], v[220:223], v[60:63], v[156:159]
    v_add_u32 v10, 81920, v6
    v_add_u32 v11, 81920, v7
    v_cvt_pk_bf16_f32 v16, v96, v97
    v_lshlrev_b32 v48, 16, v16
    v_and_b32 v49, 0xffff0000, v16
    v_mul_f32 v50, s72, v48
    v_mul_f32 v51, s72, v49
    v_exp_f32 v50, v50 clamp
    v_exp_f32 v51, v51 clamp
    v_max_f32 v48, 0, v48
    v_max_f32 v49, 0, v49
    v_add_f32 v48, v48, v50
    v_add_f32 v49, v49, v51
    v_min_f32 v56, v48, v49
    v_cvt_pk_bf16_f32 v16, v48, v49
    v_cvt_pk_bf16_f32 v17, v98, v99
    v_lshlrev_b32 v48, 16, v17
    v_and_b32 v49, 0xffff0000, v17
    v_mul_f32 v50, s72, v48
    v_mul_f32 v51, s72, v49
    v_exp_f32 v50, v50 clamp
    v_exp_f32 v51, v51 clamp
    v_max_f32 v48, 0, v48
    v_max_f32 v49, 0, v49
    v_add_f32 v48, v48, v50
    v_add_f32 v49, v49, v51
    v_min3_f32 v56, v48, v49, v56
    v_cvt_pk_bf16_f32 v17, v48, v49
    v_cvt_pk_bf16_f32 v18, v100, v101
    v_lshlrev_b32 v48, 16, v18
    v_and_b32 v49, 0xffff0000, v18
    v_mul_f32 v50, s72, v48
    v_mul_f32 v51, s72, v49
    v_exp_f32 v50, v50 clamp
    v_exp_f32 v51, v51 clamp
    v_max_f32 v48, 0, v48
    v_max_f32 v49, 0, v49
    v_add_f32 v48, v48, v50
    v_add_f32 v49, v49, v51
    v_min3_f32 v56, v48, v49, v56
    v_cvt_pk_bf16_f32 v18, v48, v49
    v_cvt_pk_bf16_f32 v19, v102, v103
    v_lshlrev_b32 v48, 16, v19
    v_and_b32 v49, 0xffff0000, v19
    v_mul_f32 v50, s72, v48
    v_mul_f32 v51, s72, v49
    v_exp_f32 v50, v50 clamp
    v_exp_f32 v51, v51 clamp
    v_max_f32 v48, 0, v48
    v_max_f32 v49, 0, v49
    v_add_f32 v48, v48, v50
    v_add_f32 v49, v49, v51
    v_min3_f32 v56, v48, v49, v56
    v_cvt_pk_bf16_f32 v19, v48, v49
    v_cvt_pk_bf16_f32 v20, v104, v105
    v_lshlrev_b32 v48, 16, v20
    v_and_b32 v49, 0xffff0000, v20
    v_mul_f32 v50, s72, v48
    v_mul_f32 v51, s72, v49
    v_exp_f32 v50, v50 clamp
    v_exp_f32 v51, v51 clamp
    v_max_f32 v48, 0, v48
    v_max_f32 v49, 0, v49
    v_add_f32 v48, v48, v50
    v_add_f32 v49, v49, v51
    v_min3_f32 v56, v48, v49, v56
    v_cvt_pk_bf16_f32 v20, v48, v49
    v_cvt_pk_bf16_f32 v21, v106, v107
    v_lshlrev_b32 v48, 16, v21
    v_and_b32 v49, 0xffff0000, v21
    v_mul_f32 v50, s72, v48
    v_mul_f32 v51, s72, v49
    v_exp_f32 v50, v50 clamp
    v_exp_f32 v51, v51 clamp
    v_max_f32 v48, 0, v48
    v_max_f32 v49, 0, v49
    v_add_f32 v48, v48, v50
    v_add_f32 v49, v49, v51
    v_min3_f32 v56, v48, v49, v56
    v_cvt_pk_bf16_f32 v21, v48, v49
    v_cvt_pk_bf16_f32 v22, v108, v109
    v_lshlrev_b32 v48, 16, v22
    v_and_b32 v49, 0xffff0000, v22
    v_mul_f32 v50, s72, v48
    v_mul_f32 v51, s72, v49
    v_exp_f32 v50, v50 clamp
    v_exp_f32 v51, v51 clamp
    v_max_f32 v48, 0, v48
    v_max_f32 v49, 0, v49
    v_add_f32 v48, v48, v50
    v_add_f32 v49, v49, v51
    v_min3_f32 v56, v48, v49, v56
    v_cvt_pk_bf16_f32 v22, v48, v49
    v_cvt_pk_bf16_f32 v23, v110, v111
    v_lshlrev_b32 v48, 16, v23
    v_and_b32 v49, 0xffff0000, v23
    v_mul_f32 v50, s72, v48
    v_mul_f32 v51, s72, v49
    v_exp_f32 v50, v50 clamp
    v_exp_f32 v51, v51 clamp
    v_max_f32 v48, 0, v48
    v_max_f32 v49, 0, v49
    v_add_f32 v48, v48, v50
    v_add_f32 v49, v49, v51
    v_min3_f32 v56, v48, v49, v56
    v_cvt_pk_bf16_f32 v23, v48, v49
    v_cmp_gt_f32 vcc, 0x3a800000, v56
    s_cbranch_vccnz phi_15_fix
phi_15_done:
    v_cvt_pk_bf16_f32 v32, v128, v129
    v_cvt_pk_bf16_f32 v33, v130, v131
    v_mfma_f32_16x16x32_bf16 v[96:99], v[236:239], v[16:19], 0
    v_cvt_pk_bf16_f32 v34, v132, v133
    v_mfma_f32_16x16x32_bf16 v[60:63], v[236:239], v[20:23], 0
    v_cvt_pk_bf16_f32 v35, v134, v135
    v_cvt_pk_bf16_f32 v36, v136, v137
    v_cvt_pk_bf16_f32 v37, v138, v139
    v_mfma_f32_16x16x32_bf16 v[240:243], v[16:19], v[32:35], 0
    v_cvt_pk_bf16_f32 v38, v140, v141
    v_mfma_f32_16x16x32_bf16 v[244:247], v[20:23], v[32:35], 0
    v_cvt_pk_bf16_f32 v39, v142, v143
    s_nop 1
    v_mfma_f32_16x16x32_bf16 v[248:251], v[16:19], v[36:39], 0
    v_mfma_f32_16x16x32_bf16 v[252:255], v[20:23], v[36:39], 0
    v_cvt_pk_bf16_f32 v24, v112, v113
    v_lshlrev_b32 v48, 16, v24
    v_and_b32 v49, 0xffff0000, v24
    v_mul_f32 v50, s72, v48
    v_mul_f32 v51, s72, v49
    v_exp_f32 v50, v50 clamp
    v_exp_f32 v51, v51 clamp
    v_max_f32 v48, 0, v48
    v_max_f32 v49, 0, v49
    v_add_f32 v48, v48, v50
    v_add_f32 v49, v49, v51
    v_min_f32 v56, v48, v49
    v_cvt_pk_bf16_f32 v24, v48, v49
    v_cvt_pk_bf16_f32 v25, v114, v115
    v_lshlrev_b32 v48, 16, v25
    v_and_b32 v49, 0xffff0000, v25
    v_mul_f32 v50, s72, v48
    v_mul_f32 v51, s72, v49
    v_exp_f32 v50, v50 clamp
    v_exp_f32 v51, v51 clamp
    v_max_f32 v48, 0, v48
    v_max_f32 v49, 0, v49
    v_add_f32 v48, v48, v50
    v_add_f32 v49, v49, v51
    v_min3_f32 v56, v48, v49, v56
    v_cvt_pk_bf16_f32 v25, v48, v49
    v_cvt_pk_bf16_f32 v26, v116, v117
    v_lshlrev_b32 v48, 16, v26
    v_and_b32 v49, 0xffff0000, v26
    v_mul_f32 v50, s72, v48
    v_mul_f32 v51, s72, v49
    v_exp_f32 v50, v50 clamp
    v_exp_f32 v51, v51 clamp
    v_max_f32 v48, 0, v48
    v_max_f32 v49, 0, v49
    v_add_f32 v48, v48, v50
    v_add_f32 v49, v49, v51
    v_min3_f32 v56, v48, v49, v56
    v_cvt_pk_bf16_f32 v26, v48, v49
    v_cvt_pk_bf16_f32 v27, v118, v119
    v_lshlrev_b32 v48, 16, v27
    v_and_b32 v49, 0xffff0000, v27
    v_mul_f32 v50, s72, v48
    v_mul_f32 v51, s72, v49
    v_exp_f32 v50, v50 clamp
    v_exp_f32 v51, v51 clamp
    v_max_f32 v48, 0, v48
    v_max_f32 v49, 0, v49
    v_add_f32 v48, v48, v50
    v_add_f32 v49, v49, v51
    v_min3_f32 v56, v48, v49, v56
    v_cvt_pk_bf16_f32 v27, v48, v49
    v_cvt_pk_bf16_f32 v28, v120, v121
    v_lshlrev_b32 v48, 16, v28
    v_and_b32 v49, 0xffff0000, v28
    v_mul_f32 v50, s72, v48
    v_mul_f32 v51, s72, v49
    v_exp_f32 v50, v50 clamp
    v_exp_f32 v51, v51 clamp
    v_max_f32 v48, 0, v48
    v_max_f32 v49, 0, v49
    v_add_f32 v48, v48, v50
    v_add_f32 v49, v49, v51
    v_min3_f32 v56, v48, v49, v56
    v_cvt_pk_bf16_f32 v28, v48, v49
    v_cvt_pk_bf16_f32 v29, v122, v123
    v_lshlrev_b32 v48, 16, v29
    v_and_b32 v49, 0xffff0000, v29
    v_mul_f32 v50, s72, v48
    v_mul_f32 v51, s72, v49
    v_exp_f32 v50, v50 clamp
    v_exp_f32 v51, v51 clamp
    v_max_f32 v48, 0, v48
    v_max_f32 v49, 0, v49
    v_add_f32 v48, v48, v50
    v_add_f32 v49, v49, v51
    v_min3_f32 v56, v48, v49, v56
    v_cvt_pk_bf16_f32 v29, v48, v49
    v_cvt_pk_bf16_f32 v30, v124, v125
    v_lshlrev_b32 v48, 16, v30
    v_and_b32 v49, 0xffff0000, v30
    v_mul_f32 v50, s72, v48
    v_mul_f32 v51, s72, v49
    v_exp_f32 v50, v50 clamp
    v_exp_f32 v51, v51 clamp
    v_max_f32 v48, 0, v48
    v_max_f32 v49, 0, v49
    v_add_f32 v48, v48, v50
    v_add_f32 v49, v49, v51
    v_min3_f32 v56, v48, v49, v56
    v_cvt_pk_bf16_f32 v30, v48, v49
    v_cvt_pk_bf16_f32 v31, v126, v127
    v_lshlrev_b32 v48, 16, v31
    v_and_b32 v49, 0xffff0000, v31
    v_mul_f32 v50, s72, v48
    v_mul_f32 v51, s72, v49
    v_exp_f32 v50, v50 clamp
    v_exp_f32 v51, v51 clamp
    v_max_f32 v48, 0, v48
    v_max_f32 v49, 0, v49
    v_add_f32 v48, v48, v50
    v_add_f32 v49, v49, v51
    v_min3_f32 v56, v48, v49, v56
    v_cvt_pk_bf16_f32 v31, v48, v49
    v_cmp_gt_f32 vcc, 0x3a800000, v56
    s_cbranch_vccnz phi_16_fix
phi_16_done:
    v_cvt_pk_bf16_f32 v40, v144, v145
    v_cvt_pk_bf16_f32 v41, v146, v147
    v_mfma_f32_16x16x32_bf16 v[96:99], v[236:239], v[24:27], v[96:99]
    v_cvt_pk_bf16_f32 v42, v148, v149
    v_mfma_f32_16x16x32_bf16 v[60:63], v[236:239], v[28:31], v[60:63]
    v_cvt_pk_bf16_f32 v43, v150, v151
    v_cvt_pk_bf16_f32 v44, v152, v153
    v_cvt_pk_bf16_f32 v45, v154, v155
    v_mfma_f32_16x16x32_bf16 v[240:243], v[24:27], v[40:43], v[240:243]
    v_cvt_pk_bf16_f32 v46, v156, v157
    v_mfma_f32_16x16x32_bf16 v[244:247], v[28:31], v[40:43], v[244:247]
    v_cvt_pk_bf16_f32 v47, v158, v159
    s_nop 1
    v_mfma_f32_16x16x32_bf16 v[248:251], v[24:27], v[44:47], v[248:251]
    v_mfma_f32_16x16x32_bf16 v[252:255], v[28:31], v[44:47], v[252:255]
    s_cmp_eq_u32 s6, 0
    s_cbranch_scc0 C_ex1
    ds_write_b32 v227, v60 offset:4608
    s_nop 5
    ds_write_b128 v224, v[248:251] offset:32768
    ds_write_b128 v224, v[252:255] offset:33792
C_ex2:
    ds_write_b32 v229, v231 offset:4288
C_ps:
    ds_read_b32 v25, v230 offset:4288
    ds_read_b128 v[16:19], v225 offset:32768
    ds_read_b128 v[20:23], v225 offset:33792
    ds_read_b32 v24, v228 offset:4608
    s_waitcnt lgkmcnt(0)
    v_cmp_eq_u32 vcc, 0, v25
    s_cbranch_vccnz C_ps
    v_add_f32 v16, v16, v240
    v_add_f32 v17, v17, v241
    v_add_f32 v18, v18, v242
    v_add_f32 v19, v19, v243
    v_add_f32 v20, v20, v244
    v_add_f32 v21, v21, v245
    v_add_f32 v22, v22, v246
    v_add_f32 v23, v23, v247
    v_add_f32 v24, v24, v96
    v_cvt_pk_bf16_f32 v28, v16, v17
    v_cvt_pk_bf16_f32 v29, v18, v19
    v_cvt_pk_bf16_f32 v30, v20, v21
    v_cvt_pk_bf16_f32 v31, v22, v23
    buffer_store_dwordx4 v[28:31], v3, s[16:19], s43 offen sc0 sc1
    s_mov_b64 exec, 0xffff
    buffer_store_dword v24, v232, s[16:19], s43 offen offset:1024 sc0 sc1
    s_mov_b64 exec, 1
    buffer_atomic_or v233, v234, s[16:19], 0 offen
    s_mov_b64 exec, -1
    ds_read_b64_tr_b16 v[96:97], v10 offset:0
    ds_read_b64_tr_b16 v[98:99], v10 offset:512
    ds_read_b64_tr_b16 v[100:101], v11 offset:0
    ds_read_b64_tr_b16 v[102:103], v11 offset:512
    ds_read_b64_tr_b16 v[104:105], v10 offset:4096
    ds_read_b64_tr_b16 v[106:107], v10 offset:4608
    ds_read_b64_tr_b16 v[108:109], v11 offset:4096
    ds_read_b64_tr_b16 v[110:111], v11 offset:4608
    ds_read_b64_tr_b16 v[112:113], v6 offset:0
    ds_read_b64_tr_b16 v[114:115], v6 offset:512
    ds_read_b64_tr_b16 v[116:117], v7 offset:0
    ds_read_b64_tr_b16 v[118:119], v7 offset:512
    ds_read_b64_tr_b16 v[120:121], v6 offset:4096
    ds_read_b64_tr_b16 v[122:123], v6 offset:4608
    ds_read_b64_tr_b16 v[124:125], v7 offset:4096
    ds_read_b64_tr_b16 v[126:127], v7 offset:4608
    s_waitcnt lgkmcnt(12)
    v_mfma_f32_16x16x32_bf16 v[64:67], v[96:99], v[192:195], v[64:67]
    v_mfma_f32_16x16x32_bf16 v[72:75], v[96:99], v[196:199], v[72:75]
    v_mfma_f32_16x16x32_bf16 v[80:83], v[96:99], v[200:203], v[80:83]
    v_mfma_f32_16x16x32_bf16 v[88:91], v[96:99], v[204:207], v[88:91]
    v_mfma_f32_16x16x32_bf16 v[68:71], v[100:103], v[192:195], v[68:71]
    v_mfma_f32_16x16x32_bf16 v[76:79], v[100:103], v[196:199], v[76:79]
    v_mfma_f32_16x16x32_bf16 v[84:87], v[100:103], v[200:203], v[84:87]
    v_mfma_f32_16x16x32_bf16 v[92:95], v[100:103], v[204:207], v[92:95]
    s_waitcnt lgkmcnt(8)
    v_mfma_f32_16x16x32_bf16 v[64:67], v[104:107], v[160:163], v[64:67]
    v_mfma_f32_16x16x32_bf16 v[72:75], v[104:107], v[164:167], v[72:75]
    v_mfma_f32_16x16x32_bf16 v[80:83], v[104:107], v[168:171], v[80:83]
    v_mfma_f32_16x16x32_bf16 v[88:91], v[104:107], v[172:175], v[88:91]
    v_mfma_f32_16x16x32_bf16 v[68:71], v[108:111], v[160:163], v[68:71]
    v_mfma_f32_16x16x32_bf16 v[76:79], v[108:111], v[164:167], v[76:79]
    v_mfma_f32_16x16x32_bf16 v[84:87], v[108:111], v[168:171], v[84:87]
    v_mfma_f32_16x16x32_bf16 v[92:95], v[108:111], v[172:175], v[92:95]
    s_waitcnt lgkmcnt(4)
    v_mfma_f32_16x16x32_bf16 v[64:67], v[112:115], v[176:179], v[64:67]
    v_mfma_f32_16x16x32_bf16 v[72:75], v[112:115], v[180:183], v[72:75]
    v_mfma_f32_16x16x32_bf16 v[80:83], v[112:115], v[184:187], v[80:83]
    v_mfma_f32_16x16x32_bf16 v[88:91], v[112:115], v[188:191], v[88:91]
    v_mfma_f32_16x16x32_bf16 v[68:71], v[116:119], v[176:179], v[68:71]
    v_mfma_f32_16x16x32_bf16 v[76:79], v[116:119], v[180:183], v[76:79]
    v_mfma_f32_16x16x32_bf16 v[84:87], v[116:119], v[184:187], v[84:87]
    v_mfma_f32_16x16x32_bf16 v[92:95], v[116:119], v[188:191], v[92:95]
    s_waitcnt lgkmcnt(0)
    v_mfma_f32_16x16x32_bf16 v[64:67], v[120:123], v[208:211], v[64:67]
    v_mfma_f32_16x16x32_bf16 v[72:75], v[120:123], v[212:215], v[72:75]
    v_mfma_f32_16x16x32_bf16 v[80:83], v[120:123], v[216:219], v[80:83]
    v_mfma_f32_16x16x32_bf16 v[88:91], v[120:123], v[220:223], v[88:91]
    v_mfma_f32_16x16x32_bf16 v[68:71], v[124:127], v[208:211], v[68:71]
    v_mfma_f32_16x16x32_bf16 v[76:79], v[124:127], v[212:215], v[76:79]
    v_mfma_f32_16x16x32_bf16 v[84:87], v[124:127], v[216:219], v[84:87]
    v_mfma_f32_16x16x32_bf16 v[92:95], v[124:127], v[220:223], v[92:95]
    s_and_b32 s64, s3, 3
    s_lshl_b32 s64, s64, 1
    s_lshr_b32 s65, s3, 2
    s_add_u32 s64, s64, s65
    s_lshl_b32 s64, s64, 4
    s_lshl_b32 s65, s4, 7
    s_add_u32 s64, s64, s65
    v_and_b32 v230, 15, v2
    v_add_u32 v230, s64, v230
    v_bfe_u32 v3, v2, 4, 1
    v_lshlrev_b32 v229, 5, v3
    v_lshrrev_b32 v3, 5, v2
    v_lshl_add_u32 v229, v3, 4, v229
    v_lshl_add_u32 v231, v230, 11, v229
    s_lshl_b32 s64, s5, 7
    v_add_u32 v231, s64, v231
    v_lshlrev_b32 v3, 2, v230
    v_add_u32 v3, 6709248, v3
    buffer_load_dwordx4 v[220:223], v231, s[8:11], 0 offen
    buffer_load_dwordx4 v[224:227], v231, s[8:11], 0 offen offset:64
    buffer_load_dword v228, v3, s[16:19], 0 offen sc1
    v_lshlrev_b32 v3, 4, v2
    s_lshl_b32 s64, s7, 11
    v_add_u32 v4, s64, v3
    v_lshrrev_b32 v5, 4, v2
    v_lshlrev_b32 v5, 4, v5
    s_lshl_b32 s64, s7, 6
    v_add_u32 v5, s64, v5
    v_mov_b32 v6, 4256
    ds_read_b32 v6, v6
    v_cvt_pk_bf16_f32 v32, v64, v65
    v_lshlrev_b32 v48, 16, v32
    v_and_b32 v49, 0xffff0000, v32
    v_mul_f32 v50, s72, v48
    v_mul_f32 v51, s72, v49
    v_exp_f32 v50, v50 clamp
    v_exp_f32 v51, v51 clamp
    v_max_f32 v48, 0, v48
    v_max_f32 v49, 0, v49
    v_add_f32 v48, v48, v50
    v_add_f32 v49, v49, v51
    v_min_f32 v56, v48, v49
    v_cvt_pk_bf16_f32 v32, v48, v49
    v_cvt_pk_bf16_f32 v33, v66, v67
    v_lshlrev_b32 v48, 16, v33
    v_and_b32 v49, 0xffff0000, v33
    v_mul_f32 v50, s72, v48
    v_mul_f32 v51, s72, v49
    v_exp_f32 v50, v50 clamp
    v_exp_f32 v51, v51 clamp
    v_max_f32 v48, 0, v48
    v_max_f32 v49, 0, v49
    v_add_f32 v48, v48, v50
    v_add_f32 v49, v49, v51
    v_min3_f32 v56, v48, v49, v56
    v_cvt_pk_bf16_f32 v33, v48, v49
    v_cvt_pk_bf16_f32 v34, v68, v69
    v_lshlrev_b32 v48, 16, v34
    v_and_b32 v49, 0xffff0000, v34
    v_mul_f32 v50, s72, v48
    v_mul_f32 v51, s72, v49
    v_exp_f32 v50, v50 clamp
    v_exp_f32 v51, v51 clamp
    v_max_f32 v48, 0, v48
    v_max_f32 v49, 0, v49
    v_add_f32 v48, v48, v50
    v_add_f32 v49, v49, v51
    v_min3_f32 v56, v48, v49, v56
    v_cvt_pk_bf16_f32 v34, v48, v49
    v_cvt_pk_bf16_f32 v35, v70, v71
    v_lshlrev_b32 v48, 16, v35
    v_and_b32 v49, 0xffff0000, v35
    v_mul_f32 v50, s72, v48
    v_mul_f32 v51, s72, v49
    v_exp_f32 v50, v50 clamp
    v_exp_f32 v51, v51 clamp
    v_max_f32 v48, 0, v48
    v_max_f32 v49, 0, v49
    v_add_f32 v48, v48, v50
    v_add_f32 v49, v49, v51
    v_min3_f32 v56, v48, v49, v56
    v_cvt_pk_bf16_f32 v35, v48, v49
    v_cvt_pk_bf16_f32 v36, v72, v73
    v_lshlrev_b32 v48, 16, v36
    v_and_b32 v49, 0xffff0000, v36
    v_mul_f32 v50, s72, v48
    v_mul_f32 v51, s72, v49
    v_exp_f32 v50, v50 clamp
    v_exp_f32 v51, v51 clamp
    v_max_f32 v48, 0, v48
    v_max_f32 v49, 0, v49
    v_add_f32 v48, v48, v50
    v_add_f32 v49, v49, v51
    v_min3_f32 v56, v48, v49, v56
    v_cvt_pk_bf16_f32 v36, v48, v49
    v_cvt_pk_bf16_f32 v37, v74, v75
    v_lshlrev_b32 v48, 16, v37
    v_and_b32 v49, 0xffff0000, v37
    v_mul_f32 v50, s72, v48
    v_mul_f32 v51, s72, v49
    v_exp_f32 v50, v50 clamp
    v_exp_f32 v51, v51 clamp
    v_max_f32 v48, 0, v48
    v_max_f32 v49, 0, v49
    v_add_f32 v48, v48, v50
    v_add_f32 v49, v49, v51
    v_min3_f32 v56, v48, v49, v56
    v_cvt_pk_bf16_f32 v37, v48, v49
    v_cvt_pk_bf16_f32 v38, v76, v77
    v_lshlrev_b32 v48, 16, v38
    v_and_b32 v49, 0xffff0000, v38
    v_mul_f32 v50, s72, v48
    v_mul_f32 v51, s72, v49
    v_exp_f32 v50, v50 clamp
    v_exp_f32 v51, v51 clamp
    v_max_f32 v48, 0, v48
    v_max_f32 v49, 0, v49
    v_add_f32 v48, v48, v50
    v_add_f32 v49, v49, v51
    v_min3_f32 v56, v48, v49, v56
    v_cvt_pk_bf16_f32 v38, v48, v49
    v_cvt_pk_bf16_f32 v39, v78, v79
    v_lshlrev_b32 v48, 16, v39
    v_and_b32 v49, 0xffff0000, v39
    v_mul_f32 v50, s72, v48
    v_mul_f32 v51, s72, v49
    v_exp_f32 v50, v50 clamp
    v_exp_f32 v51, v51 clamp
    v_max_f32 v48, 0, v48
    v_max_f32 v49, 0, v49
    v_add_f32 v48, v48, v50
    v_add_f32 v49, v49, v51
    v_min3_f32 v56, v48, v49, v56
    v_cvt_pk_bf16_f32 v39, v48, v49
    v_cmp_gt_f32 vcc, 0x3a800000, v56
    s_cbranch_vccnz phi_17_fix
phi_17_done:
    v_cvt_pk_bf16_f32 v40, v80, v81
    v_lshlrev_b32 v48, 16, v40
    v_and_b32 v49, 0xffff0000, v40
    v_mul_f32 v50, s72, v48
    v_mul_f32 v51, s72, v49
    v_exp_f32 v50, v50 clamp
    v_exp_f32 v51, v51 clamp
    v_max_f32 v48, 0, v48
    v_max_f32 v49, 0, v49
    v_add_f32 v48, v48, v50
    v_add_f32 v49, v49, v51
    v_min_f32 v56, v48, v49
    v_cvt_pk_bf16_f32 v40, v48, v49
    v_cvt_pk_bf16_f32 v41, v82, v83
    v_lshlrev_b32 v48, 16, v41
    v_and_b32 v49, 0xffff0000, v41
    v_mul_f32 v50, s72, v48
    v_mul_f32 v51, s72, v49
    v_exp_f32 v50, v50 clamp
    v_exp_f32 v51, v51 clamp
    v_max_f32 v48, 0, v48
    v_max_f32 v49, 0, v49
    v_add_f32 v48, v48, v50
    v_add_f32 v49, v49, v51
    v_min3_f32 v56, v48, v49, v56
    v_cvt_pk_bf16_f32 v41, v48, v49
    v_cvt_pk_bf16_f32 v42, v84, v85
    v_lshlrev_b32 v48, 16, v42
    v_and_b32 v49, 0xffff0000, v42
    v_mul_f32 v50, s72, v48
    v_mul_f32 v51, s72, v49
    v_exp_f32 v50, v50 clamp
    v_exp_f32 v51, v51 clamp
    v_max_f32 v48, 0, v48
    v_max_f32 v49, 0, v49
    v_add_f32 v48, v48, v50
    v_add_f32 v49, v49, v51
    v_min3_f32 v56, v48, v49, v56
    v_cvt_pk_bf16_f32 v42, v48, v49
    v_cvt_pk_bf16_f32 v43, v86, v87
    v_lshlrev_b32 v48, 16, v43
    v_and_b32 v49, 0xffff0000, v43
    v_mul_f32 v50, s72, v48
    v_mul_f32 v51, s72, v49
    v_exp_f32 v50, v50 clamp
    v_exp_f32 v51, v51 clamp
    v_max_f32 v48, 0, v48
    v_max_f32 v49, 0, v49
    v_add_f32 v48, v48, v50
    v_add_f32 v49, v49, v51
    v_min3_f32 v56, v48, v49, v56
    v_cvt_pk_bf16_f32 v43, v48, v49
    v_cvt_pk_bf16_f32 v44, v88, v89
    v_lshlrev_b32 v48, 16, v44
    v_and_b32 v49, 0xffff0000, v44
    v_mul_f32 v50, s72, v48
    v_mul_f32 v51, s72, v49
    v_exp_f32 v50, v50 clamp
    v_exp_f32 v51, v51 clamp
    v_max_f32 v48, 0, v48
    v_max_f32 v49, 0, v49
    v_add_f32 v48, v48, v50
    v_add_f32 v49, v49, v51
    v_min3_f32 v56, v48, v49, v56
    v_cvt_pk_bf16_f32 v44, v48, v49
    v_cvt_pk_bf16_f32 v45, v90, v91
    v_lshlrev_b32 v48, 16, v45
    v_and_b32 v49, 0xffff0000, v45
    v_mul_f32 v50, s72, v48
    v_mul_f32 v51, s72, v49
    v_exp_f32 v50, v50 clamp
    v_exp_f32 v51, v51 clamp
    v_max_f32 v48, 0, v48
    v_max_f32 v49, 0, v49
    v_add_f32 v48, v48, v50
    v_add_f32 v49, v49, v51
    v_min3_f32 v56, v48, v49, v56
    v_cvt_pk_bf16_f32 v45, v48, v49
    v_cvt_pk_bf16_f32 v46, v92, v93
    v_lshlrev_b32 v48, 16, v46
    v_and_b32 v49, 0xffff0000, v46
    v_mul_f32 v50, s72, v48
    v_mul_f32 v51, s72, v49
    v_exp_f32 v50, v50 clamp
    v_exp_f32 v51, v51 clamp
    v_max_f32 v48, 0, v48
    v_max_f32 v49, 0, v49
    v_add_f32 v48, v48, v50
    v_add_f32 v49, v49, v51
    v_min3_f32 v56, v48, v49, v56
    v_cvt_pk_bf16_f32 v46, v48, v49
    v_cvt_pk_bf16_f32 v47, v94, v95
    v_lshlrev_b32 v48, 16, v47
    v_and_b32 v49, 0xffff0000, v47
    v_mul_f32 v50, s72, v48
    v_mul_f32 v51, s72, v49
    v_exp_f32 v50, v50 clamp
    v_exp_f32 v51, v51 clamp
    v_max_f32 v48, 0, v48
    v_max_f32 v49, 0, v49
    v_add_f32 v48, v48, v50
    v_add_f32 v49, v49, v51
    v_min3_f32 v56, v48, v49, v56
    v_cvt_pk_bf16_f32 v47, v48, v49
    v_cmp_gt_f32 vcc, 0x3a800000, v56
    s_cbranch_vccnz phi_18_fix
phi_18_done:
    s_waitcnt lgkmcnt(0)
    v_readfirstlane_b32 s75, v6
    s_waitcnt vmcnt(0)
    v_sub_f32 v248, 1.0, v228
    v_cvt_pk_bf16_f32 v248, v248, v248
    v_lshlrev_b32 v248, 16, v248
    v_lshlrev_b32 v232, 16, v220
    v_and_b32 v233, 0xffff0000, v220
    v_mul_f32 v232, v232, v248
    v_mul_f32 v233, v233, v248
    v_cvt_pk_bf16_f32 v3, v232, v233
    v_lshlrev_b32 v232, 16, v3
    v_and_b32 v233, 0xffff0000, v3
    v_lshlrev_b32 v234, 16, v221
    v_and_b32 v235, 0xffff0000, v221
    v_mul_f32 v234, v234, v248
    v_mul_f32 v235, v235, v248
    v_cvt_pk_bf16_f32 v3, v234, v235
    v_lshlrev_b32 v234, 16, v3
    v_and_b32 v235, 0xffff0000, v3
    v_lshlrev_b32 v236, 16, v222
    v_and_b32 v237, 0xffff0000, v222
    v_mul_f32 v236, v236, v248
    v_mul_f32 v237, v237, v248
    v_cvt_pk_bf16_f32 v3, v236, v237
    v_lshlrev_b32 v236, 16, v3
    v_and_b32 v237, 0xffff0000, v3
    v_lshlrev_b32 v238, 16, v223
    v_and_b32 v239, 0xffff0000, v223
    v_mul_f32 v238, v238, v248
    v_mul_f32 v239, v239, v248
    v_cvt_pk_bf16_f32 v3, v238, v239
    v_lshlrev_b32 v238, 16, v3
    v_and_b32 v239, 0xffff0000, v3
    v_lshlrev_b32 v240, 16, v224
    v_and_b32 v241, 0xffff0000, v224
    v_mul_f32 v240, v240, v248
    v_mul_f32 v241, v241, v248
    v_cvt_pk_bf16_f32 v3, v240, v241
    v_lshlrev_b32 v240, 16, v3
    v_and_b32 v241, 0xffff0000, v3
    v_lshlrev_b32 v242, 16, v225
    v_and_b32 v243, 0xffff0000, v225
    v_mul_f32 v242, v242, v248
    v_mul_f32 v243, v243, v248
    v_cvt_pk_bf16_f32 v3, v242, v243
    v_lshlrev_b32 v242, 16, v3
    v_and_b32 v243, 0xffff0000, v3
    v_lshlrev_b32 v244, 16, v226
    v_and_b32 v245, 0xffff0000, v226
    v_mul_f32 v244, v244, v248
    v_mul_f32 v245, v245, v248
    v_cvt_pk_bf16_f32 v3, v244, v245
    v_lshlrev_b32 v244, 16, v3
    v_and_b32 v245, 0xffff0000, v3
    v_lshlrev_b32 v246, 16, v227
    v_and_b32 v247, 0xffff0000, v227
    v_mul_f32 v246, v246, v248
    v_mul_f32 v247, v247, v248
    v_cvt_pk_bf16_f32 v3, v246, v247
    v_lshlrev_b32 v246, 16, v3
    v_and_b32 v247, 0xffff0000, v3
    s_cmp_lg_u32 s3, 0
    s_cbranch_scc1 C_nh
    s_lshr_b32 s64, s2, 2
    s_lshl_b32 s64, s64, 14
    s_add_u32 s64, s64, 5398528
    v_lshl_add_u32 v16, v2, 4, s64
    v_lshrrev_b32 v8, 4, v2
    s_mov_b32 s65, 0
H_hl:
    s_mov_b32 s64, 0
    buffer_load_dwordx4 v[64:67], v16, s[16:19], s64 offen offset:0 sc1
    s_mov_b32 s64, 0
    buffer_load_dwordx4 v[68:71], v16, s[16:19], s64 offen offset:1024 sc1
    s_mov_b32 s64, 0
    buffer_load_dwordx4 v[72:75], v16, s[16:19], s64 offen offset:2048 sc1
    s_mov_b32 s64, 0
    buffer_load_dwordx4 v[76:79], v16, s[16:19], s64 offen offset:3072 sc1
    s_mov_b32 s64, 4096
    buffer_load_dwordx4 v[80:83], v16, s[16:19], s64 offen offset:0 sc1
    s_mov_b32 s64, 4096
    buffer_load_dwordx4 v[84:87], v16, s[16:19], s64 offen offset:1024 sc1
    s_mov_b32 s64, 4096
    buffer_load_dwordx4 v[88:91], v16, s[16:19], s64 offen offset:2048 sc1
    s_mov_b32 s64, 4096
    buffer_load_dwordx4 v[92:95], v16, s[16:19], s64 offen offset:3072 sc1
    s_mov_b32 s64, 8192
    buffer_load_dwordx4 v[96:99], v16, s[16:19], s64 offen offset:0 sc1
    s_mov_b32 s64, 8192
    buffer_load_dwordx4 v[100:103], v16, s[16:19], s64 offen offset:1024 sc1
    s_mov_b32 s64, 8192
    buffer_load_dwordx4 v[104:107], v16, s[16:19], s64 offen offset:2048 sc1
    s_mov_b32 s64, 8192
    buffer_load_dwordx4 v[108:111], v16, s[16:19], s64 offen offset:3072 sc1
    s_mov_b32 s64, 12288
    buffer_load_dwordx4 v[112:115], v16, s[16:19], s64 offen offset:0 sc1
    s_mov_b32 s64, 12288
    buffer_load_dwordx4 v[116:119], v16, s[16:19], s64 offen offset:1024 sc1
    s_mov_b32 s64, 12288
    buffer_load_dwordx4 v[120:123], v16, s[16:19], s64 offen offset:2048 sc1
    s_mov_b32 s64, 12288
    buffer_load_dwordx4 v[124:127], v16, s[16:19], s64 offen offset:3072 sc1
    s_waitcnt vmcnt(0)
    v_max3_u32 v17, v64, v65, v66
    v_max3_u32 v17, v67, v68, v17
    v_max3_u32 v17, v69, v70, v17
    v_max3_u32 v17, v71, v72, v17
    v_max3_u32 v17, v73, v74, v17
    v_max3_u32 v17, v75, v76, v17
    v_max3_u32 v17, v77, v78, v17
    v_max3_u32 v17, v79, v80, v17
    v_max3_u32 v17, v81, v82, v17
    v_max3_u32 v17, v83, v84, v17
    v_max3_u32 v17, v85, v86, v17
    v_max3_u32 v17, v87, v88, v17
    v_max3_u32 v17, v89, v90, v17
    v_max3_u32 v17, v91, v92, v17
    v_max3_u32 v17, v93, v94, v17
    v_max3_u32 v17, v95, v96, v17
    v_max3_u32 v17, v97, v98, v17
    v_max3_u32 v17, v99, v100, v17
    v_max3_u32 v17, v101, v102, v17
    v_max3_u32 v17, v103, v104, v17
    v_max3_u32 v17, v105, v106, v17
    v_max3_u32 v17, v107, v108, v17
    v_max3_u32 v17, v109, v110, v17
    v_max3_u32 v17, v111, v112, v17
    v_max3_u32 v17, v113, v114, v17
    v_max3_u32 v17, v115, v116, v17
    v_max3_u32 v17, v117, v118, v17
    v_max3_u32 v17, v119, v120, v17
    v_max3_u32 v17, v121, v122, v17
    v_max3_u32 v17, v123, v124, v17
    v_max3_u32 v17, v125, v126, v17
    v_max_u32 v17, v127, v17
    s_mov_b32 exec_lo, 0x3fff3fff
    s_mov_b32 exec_hi, 0x3fff3fff
    v_cmp_eq_u32 vcc, -1, v17
    s_mov_b64 exec, -1
    s_cbranch_vccz H_hok
    s_add_u32 s65, s65, 1
    s_cmp_ge_u32 s65, 100000
    s_cbranch_scc1 H_hok
    s_sleep 8
    s_branch H_hl
H_hok:
    v_add_f32 v64, v64, v68
    v_add_f32 v65, v65, v69
    v_add_f32 v66, v66, v70
    v_add_f32 v67, v67, v71
    v_add_f32 v64, v64, v72
    v_add_f32 v65, v65, v73
    v_add_f32 v66, v66, v74
    v_add_f32 v67, v67, v75
    v_add_f32 v64, v64, v76
    v_add_f32 v65, v65, v77
    v_add_f32 v66, v66, v78
    v_add_f32 v67, v67, v79
    v_add_f32 v64, v64, v80
    v_add_f32 v65, v65, v81
    v_add_f32 v66, v66, v82
    v_add_f32 v67, v67, v83
    v_add_f32 v64, v64, v84
    v_add_f32 v65, v65, v85
    v_add_f32 v66, v66, v86
    v_add_f32 v67, v67, v87
    v_add_f32 v64, v64, v88
    v_add_f32 v65, v65, v89
    v_add_f32 v66, v66, v90
    v_add_f32 v67, v67, v91
    v_add_f32 v64, v64, v92
    v_add_f32 v65, v65, v93
    v_add_f32 v66, v66, v94
    v_add_f32 v67, v67, v95
    v_add_f32 v96, v96, v100
    v_add_f32 v97, v97, v101
    v_add_f32 v98, v98, v102
    v_add_f32 v99, v99, v103
    v_add_f32 v96, v96, v104
    v_add_f32 v97, v97, v105
    v_add_f32 v98, v98, v106
    v_add_f32 v99, v99, v107
    v_add_f32 v96, v96, v108
    v_add_f32 v97, v97, v109
    v_add_f32 v98, v98, v110
    v_add_f32 v99, v99, v111
    v_add_f32 v96, v96, v112
    v_add_f32 v97, v97, v113
    v_add_f32 v98, v98, v114
    v_add_f32 v99, v99, v115
    v_add_f32 v96, v96, v116
    v_add_f32 v97, v97, v117
    v_add_f32 v98, v98, v118
    v_add_f32 v99, v99, v119
    v_add_f32 v96, v96, v120
    v_add_f32 v97, v97, v121
    v_add_f32 v98, v98, v122
    v_add_f32 v99, v99, v123
    v_add_f32 v96, v96, v124
    v_add_f32 v97, v97, v125
    v_add_f32 v98, v98, v126
    v_add_f32 v99, v99, v127
    s_nop 1
    v_permlane16_swap_b32 v64, v96
    v_permlane16_swap_b32 v65, v97
    v_permlane16_swap_b32 v66, v98
    v_permlane16_swap_b32 v67, v99
    v_add_f32 v64, v64, v96
    v_add_f32 v65, v65, v97
    v_add_f32 v66, v66, v98
    v_add_f32 v67, v67, v99
    s_nop 1
    v_permlane32_swap_b32 v64, v66
    v_permlane32_swap_b32 v65, v67
    v_add_f32 v64, v64, v66
    v_add_f32 v65, v65, v67
    s_nop 1
    v_permlane16_swap_b32 v64, v65
    v_cvt_pk_bf16_f32 v66, v64, v65
    v_lshlrev_b32 v64, 16, v66
    v_and_b32 v65, 0xffff0000, v66
    v_mul_f32 v66, s72, v64
    v_exp_f32 v66, -v66
    v_and_b32 v16, 15, v2
    v_add_f32 v66, 1.0, v66
    v_rcp_f32 v66, v66
    v_lshl_add_u32 v16, v16, 2, v8
    v_mul_f32 v66, v66, v64
    v_cvt_pk_bf16_f32 v66, v66, v66
    v_lshlrev_b32 v66, 16, v66
    v_mul_f32 v66, v66, v65
    v_cvt_pk_bf16_f32 v66, v66, v66
    v_lshlrev_b32 v66, 16, v66
    v_lshlrev_b32 v16, 2, v16
    ds_write_b32 v16, v66 offset:4352
    s_waitcnt lgkmcnt(0)
C_nh:
    v_lshlrev_b32 v3, 4, v2
    s_barrier
    ds_read_b128 v[24:27], v5 offset:4096
    ds_read_b128 v[16:19], v4 offset:0
    ds_read_b128 v[20:23], v4 offset:1024
    s_waitcnt lgkmcnt(2)
    v_mfma_f32_16x16x32_bf16 v[96:99], v[24:27], v[32:35], 0
    v_mfma_f32_16x16x32_bf16 v[100:103], v[24:27], v[36:39], 0
    v_mfma_f32_16x16x32_bf16 v[104:107], v[24:27], v[40:43], 0
    v_mfma_f32_16x16x32_bf16 v[108:111], v[24:27], v[44:47], 0
    s_waitcnt lgkmcnt(0)
    v_mfma_f32_16x16x32_bf16 v[64:67], v[16:19], v[32:35], 0
    v_mfma_f32_16x16x32_bf16 v[68:71], v[20:23], v[32:35], 0
    v_mfma_f32_16x16x32_bf16 v[72:75], v[16:19], v[36:39], 0
    v_mfma_f32_16x16x32_bf16 v[76:79], v[20:23], v[36:39], 0
    v_mfma_f32_16x16x32_bf16 v[80:83], v[16:19], v[40:43], 0
    v_mfma_f32_16x16x32_bf16 v[84:87], v[20:23], v[40:43], 0
    v_mfma_f32_16x16x32_bf16 v[88:91], v[16:19], v[44:47], 0
    v_mfma_f32_16x16x32_bf16 v[92:95], v[20:23], v[44:47], 0
    v_cvt_pk_bf16_f32 v48, v96, v96
    v_cvt_pk_bf16_f32 v49, v100, v100
    v_cvt_pk_bf16_f32 v50, v104, v104
    v_cvt_pk_bf16_f32 v51, v108, v108
    v_lshlrev_b32 v48, 16, v48
    v_lshlrev_b32 v49, 16, v49
    v_lshlrev_b32 v50, 16, v50
    v_lshlrev_b32 v51, 16, v51
    v_add_f32 v48, s73, v48
    v_add_f32 v49, s73, v49
    v_add_f32 v50, s73, v50
    v_add_f32 v51, s73, v51
    v_cvt_pk_bf16_f32 v48, v48, v48
    v_cvt_pk_bf16_f32 v49, v49, v49
    v_cvt_pk_bf16_f32 v50, v50, v50
    v_cvt_pk_bf16_f32 v51, v51, v51
    v_lshlrev_b32 v48, 16, v48
    v_lshlrev_b32 v49, 16, v49
    v_lshlrev_b32 v50, 16, v50
    v_lshlrev_b32 v51, 16, v51
    v_rcp_f32 v48, v48
    v_rcp_f32 v49, v49
    v_rcp_f32 v50, v50
    v_rcp_f32 v51, v51
    s_nop 0
    v_mul_f32 v64, v64, v48
    v_mul_f32 v65, v65, v48
    v_cvt_pk_bf16_f32 v128, v64, v65
    v_mul_f32 v66, v66, v48
    v_mul_f32 v67, v67, v48
    v_cvt_pk_bf16_f32 v129, v66, v67
    v_mul_f32 v68, v68, v48
    v_mul_f32 v69, v69, v48
    v_cvt_pk_bf16_f32 v130, v68, v69
    v_mul_f32 v70, v70, v48
    v_mul_f32 v71, v71, v48
    v_cvt_pk_bf16_f32 v131, v70, v71
    buffer_store_dwordx4 v[128:131], v3, s[16:19], s42 offen offset:0 sc0 sc1
    v_mul_f32 v72, v72, v49
    v_mul_f32 v73, v73, v49
    v_cvt_pk_bf16_f32 v132, v72, v73
    v_mul_f32 v74, v74, v49
    v_mul_f32 v75, v75, v49
    v_cvt_pk_bf16_f32 v133, v74, v75
    v_mul_f32 v76, v76, v49
    v_mul_f32 v77, v77, v49
    v_cvt_pk_bf16_f32 v134, v76, v77
    v_mul_f32 v78, v78, v49
    v_mul_f32 v79, v79, v49
    v_cvt_pk_bf16_f32 v135, v78, v79
    buffer_store_dwordx4 v[132:135], v3, s[16:19], s42 offen offset:1024 sc0 sc1
    s_add_u32 s42, s42, 65536
    v_mul_f32 v80, v80, v50
    v_mul_f32 v81, v81, v50
    v_cvt_pk_bf16_f32 v136, v80, v81
    v_mul_f32 v82, v82, v50
    v_mul_f32 v83, v83, v50
    v_cvt_pk_bf16_f32 v137, v82, v83
    v_mul_f32 v84, v84, v50
    v_mul_f32 v85, v85, v50
    v_cvt_pk_bf16_f32 v138, v84, v85
    v_mul_f32 v86, v86, v50
    v_mul_f32 v87, v87, v50
    v_cvt_pk_bf16_f32 v139, v86, v87
    buffer_store_dwordx4 v[136:139], v3, s[16:19], s42 offen offset:0 sc0 sc1
    v_mul_f32 v88, v88, v51
    v_mul_f32 v89, v89, v51
    v_cvt_pk_bf16_f32 v140, v88, v89
    v_mul_f32 v90, v90, v51
    v_mul_f32 v91, v91, v51
    v_cvt_pk_bf16_f32 v141, v90, v91
    v_mul_f32 v92, v92, v51
    v_mul_f32 v93, v93, v51
    v_cvt_pk_bf16_f32 v142, v92, v93
    v_mul_f32 v94, v94, v51
    v_mul_f32 v95, v95, v51
    v_cvt_pk_bf16_f32 v143, v94, v95
    buffer_store_dwordx4 v[140:143], v3, s[16:19], s42 offen offset:1024 sc0 sc1
    s_lshl_b32 s64, s4, 3
    s_add_u32 s64, s64, s3
    s_lshl_b32 s64, s64, 7
    s_add_u32 s64, s64, 5382144
    v_mov_b32 v14, s64
    s_mov_b64 exec, 1
    v_mov_b32 v15, 0
    buffer_atomic_or v15, v14, s[16:19], 0 offen sc0
    s_mov_b64 exec, -1
    s_waitcnt vmcnt(1)
    s_mov_b64 exec, 3
    buffer_atomic_or v13, v12, s[16:19], 0 offen
    s_mov_b64 exec, -1
P2_start:
    s_and_b32 s6, s3, 3
    s_lshr_b32 s7, s3, 2
    s_mov_b32 s20, s58
    s_mov_b32 s21, s59
    s_mov_b32 s22, 0x400000
    s_mov_b32 s23, 0x00020000
    s_and_b32 s67, s75, 0x7ff
    s_sub_u32 s67, 2047, s67
    s_lshl_b32 s64, s4, 2
    s_add_u32 s64, s64, s6
    s_lshl_b32 s64, s64, 16
    s_lshl_b32 s65, s7, 15
    s_add_u32 s64, s64, s65
    s_lshl_b32 s65, s7, 10
    s_add_u32 s66, s64, s65
    s_sub_u32 s64, s64, s65
    v_lshl_add_u32 v4, v2, 4, s66
    v_lshl_add_u32 v12, v2, 4, s64
    v_lshrrev_b32 v10, 4, v2
    v_bfe_u32 v11, v2, 2, 2
    v_lshl_add_u32 v10, v10, 2, v11
    v_bfe_u32 v13, v10, 1, 2
    v_lshlrev_b32 v10, 7, v10
    v_lshl_add_u32 v10, v13, 5, v10
    v_and_b32 v13, 3, v2
    v_lshl_add_u32 v5, v13, 3, v10
    v_xor_b32 v6, 32, v5
    v_xor_b32 v1, 64, v5
    v_xor_b32 v3, 96, v5
    s_and_b32 s74, s5, 7
    s_lshl_b32 s74, s74, 1
    s_cmp_eq_u32 s7, 0
    s_mov_b32 s64, 147456
    s_cselect_b32 s64, 131072, s64
    s_sub_u32 m0, 16, s74
    s_and_b32 m0, m0, 15
    v_writelane_b32 v7, s64, m0
    s_cmp_eq_u32 s7, 0
    s_mov_b32 s64, 155648
    s_cselect_b32 s64, 139264, s64
    s_sub_u32 m0, 18, s74
    s_and_b32 m0, m0, 15
    v_writelane_b32 v7, s64, m0
    s_cmp_eq_u32 s7, 0
    s_mov_b32 s64, 81920
    s_cselect_b32 s64, 73728, s64
    s_sub_u32 m0, 20, s74
    s_and_b32 m0, m0, 15
    v_writelane_b32 v7, s64, m0
    s_cmp_eq_u32 s7, 0
    s_mov_b32 s64, 122880
    s_cselect_b32 s64, 114688, s64
    s_sub_u32 m0, 22, s74
    s_and_b32 m0, m0, 15
    v_writelane_b32 v7, s64, m0
    s_cmp_eq_u32 s7, 0
    s_mov_b32 s64, 49152
    s_cselect_b32 s64, 40960, s64
    s_sub_u32 m0, 24, s74
    s_and_b32 m0, m0, 15
    v_writelane_b32 v7, s64, m0
    s_cmp_eq_u32 s7, 0
    s_mov_b32 s64, 57344
    s_cselect_b32 s64, 8192, s64
    s_sub_u32 m0, 26, s74
    s_and_b32 m0, m0, 15
    v_writelane_b32 v7, s64, m0
    s_cmp_eq_u32 s7, 0
    s_mov_b32 s64, 65536
    s_cselect_b32 s64, 16384, s64
    s_sub_u32 m0, 28, s74
    s_and_b32 m0, m0, 15
    v_writelane_b32 v7, s64, m0
    s_cmp_eq_u32 s7, 0
    s_mov_b32 s64, 90112
    s_cselect_b32 s64, 98304, s64
    s_sub_u32 m0, 30, s74
    s_and_b32 m0, m0, 15
    v_writelane_b32 v7, s64, m0
    s_cmp_eq_u32 s7, 0
    v_mov_b32 v16, 0
    v_mov_b32 v17, 0
    v_mov_b32 v18, 0
    v_mov_b32 v19, 0
    v_mov_b32 v20, 0
    v_mov_b32 v21, 0
    v_mov_b32 v22, 0
    v_mov_b32 v23, 0
    v_mov_b32 v24, 0
    v_mov_b32 v25, 0
    v_mov_b32 v26, 0
    v_mov_b32 v27, 0
    v_mov_b32 v28, 0
    v_mov_b32 v29, 0
    v_mov_b32 v30, 0
    v_mov_b32 v31, 0
    v_mov_b32 v32, 0
    v_mov_b32 v33, 0
    v_mov_b32 v34, 0
    v_mov_b32 v35, 0
    v_mov_b32 v36, 0
    v_mov_b32 v37, 0
    v_mov_b32 v38, 0
    v_mov_b32 v39, 0
    v_mov_b32 v40, 0
    v_mov_b32 v41, 0
    v_mov_b32 v42, 0
    v_mov_b32 v43, 0
    v_mov_b32 v44, 0
    v_mov_b32 v45, 0
    v_mov_b32 v46, 0
    v_mov_b32 v47, 0
    v_mov_b32 v209, 0
    v_mov_b32 v215, 0
    s_lshr_b32 s46, s67, 7
    s_xor_b32 s46, s46, s4
    s_or_b32 s46, s46, s3
    s_mov_b32 s47, 0
    s_cbranch_scc0 P2_ys
P2_ysd:
    s_mov_b32 s66, 0x5555
    s_mov_b32 s65, 0
    s_cmp_lt_u32 s3, 4
    s_cbranch_scc0 D_wait
    s_waitcnt vmcnt(1)
    s_branch D_got
D_wait:
    s_waitcnt vmcnt(0)
D_got:
    v_readfirstlane_b32 s68, v15
    s_mul_i32 s68, s68, 0x10001
    s_lshr_b32 s68, s68, s74
    s_lshr_b32 s64, s68, 1
    s_and_b32 s68, s68, s64
    s_and_b32 s68, s68, s66
    s_cbranch_scc1 D_go
    s_add_u32 s65, s65, 1
    s_cmp_ge_u32 s65, 40000
    s_cbranch_scc1 D_end
    s_sleep 1
    s_mov_b64 exec, 1
    v_mov_b32 v15, 0
    buffer_atomic_or v15, v14, s[16:19], 0 offen sc0
    s_mov_b64 exec, -1
    s_branch D_wait
D_go:
    s_andn2_b32 s66, s66, s68
    s_bcnt1_i32_b32 s70, s68
    s_or_b32 s64, s46, s66
    s_cbranch_scc0 P2_yl
P2_nyl:
    s_cmp_gt_u32 s70, 4
    s_cbranch_scc1 D_t58
    s_cmp_gt_u32 s70, 2
    s_cbranch_scc1 D_t34
    s_cmp_eq_u32 s70, 2
    s_cbranch_scc1 D_e2
D_e1:
    s_ff1_i32_b32 s64, s68
    s_bitset0_b32 s68, s64
    v_readlane_b32 s32, v7, s64
    s_add_u32 s69, s64, s74
    s_and_b32 s69, s69, 15
    s_lshl_b32 s69, s69, 11
    buffer_load_dwordx4 v[80:83], v4, s[16:19], s69 offen offset:0 sc1
    buffer_load_dwordx4 v[84:87], v12, s[16:19], s69 offen offset:1024 sc1
    buffer_load_dwordx4 v[88:91], v4, s[16:19], s69 offen offset:2048 sc1
    buffer_load_dwordx4 v[92:95], v12, s[16:19], s69 offen offset:3072 sc1
    s_mov_b64 exec, 1
    v_mov_b32 v15, 0
    buffer_atomic_or v15, v14, s[16:19], 0 offen sc0
    s_mov_b64 exec, -1
    v_add_u32 v8, s32, v5
    ds_read_b64_tr_b16 v[48:49], v8 offset:0
    ds_read_b64_tr_b16 v[50:51], v8 offset:2048
    v_add_u32 v9, s32, v6
    ds_read_b64_tr_b16 v[52:53], v9 offset:0
    ds_read_b64_tr_b16 v[54:55], v9 offset:2048
    v_add_u32 v10, s32, v1
    ds_read_b64_tr_b16 v[56:57], v10 offset:0
    ds_read_b64_tr_b16 v[58:59], v10 offset:2048
    v_add_u32 v11, s32, v3
    ds_read_b64_tr_b16 v[60:61], v11 offset:0
    ds_read_b64_tr_b16 v[62:63], v11 offset:2048
    s_branch D_p0
D_e2:
    s_ff1_i32_b32 s64, s68
    s_bitset0_b32 s68, s64
    v_readlane_b32 s33, v7, s64
    s_add_u32 s69, s64, s74
    s_and_b32 s69, s69, 15
    s_lshl_b32 s69, s69, 11
    buffer_load_dwordx4 v[96:99], v4, s[16:19], s69 offen offset:0 sc1
    buffer_load_dwordx4 v[100:103], v12, s[16:19], s69 offen offset:1024 sc1
    buffer_load_dwordx4 v[104:107], v4, s[16:19], s69 offen offset:2048 sc1
    buffer_load_dwordx4 v[108:111], v12, s[16:19], s69 offen offset:3072 sc1
    s_ff1_i32_b32 s64, s68
    s_bitset0_b32 s68, s64
    v_readlane_b32 s32, v7, s64
    s_add_u32 s69, s64, s74
    s_and_b32 s69, s69, 15
    s_lshl_b32 s69, s69, 11
    buffer_load_dwordx4 v[80:83], v4, s[16:19], s69 offen offset:0 sc1
    buffer_load_dwordx4 v[84:87], v12, s[16:19], s69 offen offset:1024 sc1
    buffer_load_dwordx4 v[88:91], v4, s[16:19], s69 offen offset:2048 sc1
    buffer_load_dwordx4 v[92:95], v12, s[16:19], s69 offen offset:3072 sc1
    s_mov_b64 exec, 1
    v_mov_b32 v15, 0
    buffer_atomic_or v15, v14, s[16:19], 0 offen sc0
    s_mov_b64 exec, -1
    v_add_u32 v8, s33, v5
    ds_read_b64_tr_b16 v[48:49], v8 offset:0
    ds_read_b64_tr_b16 v[50:51], v8 offset:2048
    v_add_u32 v9, s33, v6
    ds_read_b64_tr_b16 v[52:53], v9 offset:0
    ds_read_b64_tr_b16 v[54:55], v9 offset:2048
    v_add_u32 v10, s33, v1
    ds_read_b64_tr_b16 v[56:57], v10 offset:0
    ds_read_b64_tr_b16 v[58:59], v10 offset:2048
    v_add_u32 v11, s33, v3
    ds_read_b64_tr_b16 v[60:61], v11 offset:0
    ds_read_b64_tr_b16 v[62:63], v11 offset:2048
    s_branch D_p1
D_t34:
    s_cmp_eq_u32 s70, 4
    s_cbranch_scc1 D_e4
D_e3:
    s_ff1_i32_b32 s64, s68
    s_bitset0_b32 s68, s64
    v_readlane_b32 s34, v7, s64
    s_add_u32 s69, s64, s74
    s_and_b32 s69, s69, 15
    s_lshl_b32 s69, s69, 11
    buffer_load_dwordx4 v[112:115], v4, s[16:19], s69 offen offset:0 sc1
    buffer_load_dwordx4 v[116:119], v12, s[16:19], s69 offen offset:1024 sc1
    buffer_load_dwordx4 v[120:123], v4, s[16:19], s69 offen offset:2048 sc1
    buffer_load_dwordx4 v[124:127], v12, s[16:19], s69 offen offset:3072 sc1
    s_ff1_i32_b32 s64, s68
    s_bitset0_b32 s68, s64
    v_readlane_b32 s33, v7, s64
    s_add_u32 s69, s64, s74
    s_and_b32 s69, s69, 15
    s_lshl_b32 s69, s69, 11
    buffer_load_dwordx4 v[96:99], v4, s[16:19], s69 offen offset:0 sc1
    buffer_load_dwordx4 v[100:103], v12, s[16:19], s69 offen offset:1024 sc1
    buffer_load_dwordx4 v[104:107], v4, s[16:19], s69 offen offset:2048 sc1
    buffer_load_dwordx4 v[108:111], v12, s[16:19], s69 offen offset:3072 sc1
    v_add_u32 v8, s34, v5
    ds_read_b64_tr_b16 v[48:49], v8 offset:0
    ds_read_b64_tr_b16 v[50:51], v8 offset:2048
    v_add_u32 v9, s34, v6
    ds_read_b64_tr_b16 v[52:53], v9 offset:0
    ds_read_b64_tr_b16 v[54:55], v9 offset:2048
    v_add_u32 v10, s34, v1
    ds_read_b64_tr_b16 v[56:57], v10 offset:0
    ds_read_b64_tr_b16 v[58:59], v10 offset:2048
    v_add_u32 v11, s34, v3
    ds_read_b64_tr_b16 v[60:61], v11 offset:0
    ds_read_b64_tr_b16 v[62:63], v11 offset:2048
    s_branch D_p2
D_e4:
    s_ff1_i32_b32 s64, s68
    s_bitset0_b32 s68, s64
    v_readlane_b32 s35, v7, s64
    s_add_u32 s69, s64, s74
    s_and_b32 s69, s69, 15
    s_lshl_b32 s69, s69, 11
    buffer_load_dwordx4 v[128:131], v4, s[16:19], s69 offen offset:0 sc1
    buffer_load_dwordx4 v[132:135], v12, s[16:19], s69 offen offset:1024 sc1
    buffer_load_dwordx4 v[136:139], v4, s[16:19], s69 offen offset:2048 sc1
    buffer_load_dwordx4 v[140:143], v12, s[16:19], s69 offen offset:3072 sc1
    s_ff1_i32_b32 s64, s68
    s_bitset0_b32 s68, s64
    v_readlane_b32 s34, v7, s64
    s_add_u32 s69, s64, s74
    s_and_b32 s69, s69, 15
    s_lshl_b32 s69, s69, 11
    buffer_load_dwordx4 v[112:115], v4, s[16:19], s69 offen offset:0 sc1
    buffer_load_dwordx4 v[116:119], v12, s[16:19], s69 offen offset:1024 sc1
    buffer_load_dwordx4 v[120:123], v4, s[16:19], s69 offen offset:2048 sc1
    buffer_load_dwordx4 v[124:127], v12, s[16:19], s69 offen offset:3072 sc1
    v_add_u32 v8, s35, v5
    ds_read_b64_tr_b16 v[48:49], v8 offset:0
    ds_read_b64_tr_b16 v[50:51], v8 offset:2048
    v_add_u32 v9, s35, v6
    ds_read_b64_tr_b16 v[52:53], v9 offset:0
    ds_read_b64_tr_b16 v[54:55], v9 offset:2048
    v_add_u32 v10, s35, v1
    ds_read_b64_tr_b16 v[56:57], v10 offset:0
    ds_read_b64_tr_b16 v[58:59], v10 offset:2048
    v_add_u32 v11, s35, v3
    ds_read_b64_tr_b16 v[60:61], v11 offset:0
    ds_read_b64_tr_b16 v[62:63], v11 offset:2048
    s_branch D_p3
D_t58:
    s_cmp_gt_u32 s70, 6
    s_cbranch_scc1 D_t78
    s_cmp_eq_u32 s70, 6
    s_cbranch_scc1 D_e6
D_e5:
    s_ff1_i32_b32 s64, s68
    s_bitset0_b32 s68, s64
    v_readlane_b32 s36, v7, s64
    s_add_u32 s69, s64, s74
    s_and_b32 s69, s69, 15
    s_lshl_b32 s69, s69, 11
    buffer_load_dwordx4 v[144:147], v4, s[16:19], s69 offen offset:0 sc1
    buffer_load_dwordx4 v[148:151], v12, s[16:19], s69 offen offset:1024 sc1
    buffer_load_dwordx4 v[152:155], v4, s[16:19], s69 offen offset:2048 sc1
    buffer_load_dwordx4 v[156:159], v12, s[16:19], s69 offen offset:3072 sc1
    s_ff1_i32_b32 s64, s68
    s_bitset0_b32 s68, s64
    v_readlane_b32 s35, v7, s64
    s_add_u32 s69, s64, s74
    s_and_b32 s69, s69, 15
    s_lshl_b32 s69, s69, 11
    buffer_load_dwordx4 v[128:131], v4, s[16:19], s69 offen offset:0 sc1
    buffer_load_dwordx4 v[132:135], v12, s[16:19], s69 offen offset:1024 sc1
    buffer_load_dwordx4 v[136:139], v4, s[16:19], s69 offen offset:2048 sc1
    buffer_load_dwordx4 v[140:143], v12, s[16:19], s69 offen offset:3072 sc1
    v_add_u32 v8, s36, v5
    ds_read_b64_tr_b16 v[48:49], v8 offset:0
    ds_read_b64_tr_b16 v[50:51], v8 offset:2048
    v_add_u32 v9, s36, v6
    ds_read_b64_tr_b16 v[52:53], v9 offset:0
    ds_read_b64_tr_b16 v[54:55], v9 offset:2048
    v_add_u32 v10, s36, v1
    ds_read_b64_tr_b16 v[56:57], v10 offset:0
    ds_read_b64_tr_b16 v[58:59], v10 offset:2048
    v_add_u32 v11, s36, v3
    ds_read_b64_tr_b16 v[60:61], v11 offset:0
    ds_read_b64_tr_b16 v[62:63], v11 offset:2048
    s_branch D_p4
D_e6:
    s_ff1_i32_b32 s64, s68
    s_bitset0_b32 s68, s64
    v_readlane_b32 s37, v7, s64
    s_add_u32 s69, s64, s74
    s_and_b32 s69, s69, 15
    s_lshl_b32 s69, s69, 11
    buffer_load_dwordx4 v[160:163], v4, s[16:19], s69 offen offset:0 sc1
    buffer_load_dwordx4 v[164:167], v12, s[16:19], s69 offen offset:1024 sc1
    buffer_load_dwordx4 v[168:171], v4, s[16:19], s69 offen offset:2048 sc1
    buffer_load_dwordx4 v[172:175], v12, s[16:19], s69 offen offset:3072 sc1
    s_ff1_i32_b32 s64, s68
    s_bitset0_b32 s68, s64
    v_readlane_b32 s36, v7, s64
    s_add_u32 s69, s64, s74
    s_and_b32 s69, s69, 15
    s_lshl_b32 s69, s69, 11
    buffer_load_dwordx4 v[144:147], v4, s[16:19], s69 offen offset:0 sc1
    buffer_load_dwordx4 v[148:151], v12, s[16:19], s69 offen offset:1024 sc1
    buffer_load_dwordx4 v[152:155], v4, s[16:19], s69 offen offset:2048 sc1
    buffer_load_dwordx4 v[156:159], v12, s[16:19], s69 offen offset:3072 sc1
    v_add_u32 v8, s37, v5
    ds_read_b64_tr_b16 v[48:49], v8 offset:0
    ds_read_b64_tr_b16 v[50:51], v8 offset:2048
    v_add_u32 v9, s37, v6
    ds_read_b64_tr_b16 v[52:53], v9 offset:0
    ds_read_b64_tr_b16 v[54:55], v9 offset:2048
    v_add_u32 v10, s37, v1
    ds_read_b64_tr_b16 v[56:57], v10 offset:0
    ds_read_b64_tr_b16 v[58:59], v10 offset:2048
    v_add_u32 v11, s37, v3
    ds_read_b64_tr_b16 v[60:61], v11 offset:0
    ds_read_b64_tr_b16 v[62:63], v11 offset:2048
    s_branch D_p5
D_t78:
    s_cmp_eq_u32 s70, 8
    s_cbranch_scc1 D_e8
D_e7:
    s_ff1_i32_b32 s64, s68
    s_bitset0_b32 s68, s64
    v_readlane_b32 s38, v7, s64
    s_add_u32 s69, s64, s74
    s_and_b32 s69, s69, 15
    s_lshl_b32 s69, s69, 11
    buffer_load_dwordx4 v[176:179], v4, s[16:19], s69 offen offset:0 sc1
    buffer_load_dwordx4 v[180:183], v12, s[16:19], s69 offen offset:1024 sc1
    buffer_load_dwordx4 v[184:187], v4, s[16:19], s69 offen offset:2048 sc1
    buffer_load_dwordx4 v[188:191], v12, s[16:19], s69 offen offset:3072 sc1
    s_ff1_i32_b32 s64, s68
    s_bitset0_b32 s68, s64
    v_readlane_b32 s37, v7, s64
    s_add_u32 s69, s64, s74
    s_and_b32 s69, s69, 15
    s_lshl_b32 s69, s69, 11
    buffer_load_dwordx4 v[160:163], v4, s[16:19], s69 offen offset:0 sc1
    buffer_load_dwordx4 v[164:167], v12, s[16:19], s69 offen offset:1024 sc1
    buffer_load_dwordx4 v[168:171], v4, s[16:19], s69 offen offset:2048 sc1
    buffer_load_dwordx4 v[172:175], v12, s[16:19], s69 offen offset:3072 sc1
    v_add_u32 v8, s38, v5
    ds_read_b64_tr_b16 v[48:49], v8 offset:0
    ds_read_b64_tr_b16 v[50:51], v8 offset:2048
    v_add_u32 v9, s38, v6
    ds_read_b64_tr_b16 v[52:53], v9 offset:0
    ds_read_b64_tr_b16 v[54:55], v9 offset:2048
    v_add_u32 v10, s38, v1
    ds_read_b64_tr_b16 v[56:57], v10 offset:0
    ds_read_b64_tr_b16 v[58:59], v10 offset:2048
    v_add_u32 v11, s38, v3
    ds_read_b64_tr_b16 v[60:61], v11 offset:0
    ds_read_b64_tr_b16 v[62:63], v11 offset:2048
    s_branch D_p6
D_e8:
    s_ff1_i32_b32 s64, s68
    s_bitset0_b32 s68, s64
    v_readlane_b32 s39, v7, s64
    s_add_u32 s69, s64, s74
    s_and_b32 s69, s69, 15
    s_lshl_b32 s69, s69, 11
    buffer_load_dwordx4 v[192:195], v4, s[16:19], s69 offen offset:0 sc1
    buffer_load_dwordx4 v[196:199], v12, s[16:19], s69 offen offset:1024 sc1
    buffer_load_dwordx4 v[200:203], v4, s[16:19], s69 offen offset:2048 sc1
    buffer_load_dwordx4 v[204:207], v12, s[16:19], s69 offen offset:3072 sc1
    s_ff1_i32_b32 s64, s68
    s_bitset0_b32 s68, s64
    v_readlane_b32 s38, v7, s64
    s_add_u32 s69, s64, s74
    s_and_b32 s69, s69, 15
    s_lshl_b32 s69, s69, 11
    buffer_load_dwordx4 v[176:179], v4, s[16:19], s69 offen offset:0 sc1
    buffer_load_dwordx4 v[180:183], v12, s[16:19], s69 offen offset:1024 sc1
    buffer_load_dwordx4 v[184:187], v4, s[16:19], s69 offen offset:2048 sc1
    buffer_load_dwordx4 v[188:191], v12, s[16:19], s69 offen offset:3072 sc1
    v_add_u32 v8, s39, v5
    ds_read_b64_tr_b16 v[48:49], v8 offset:0
    ds_read_b64_tr_b16 v[50:51], v8 offset:2048
    v_add_u32 v9, s39, v6
    ds_read_b64_tr_b16 v[52:53], v9 offset:0
    ds_read_b64_tr_b16 v[54:55], v9 offset:2048
    v_add_u32 v10, s39, v1
    ds_read_b64_tr_b16 v[56:57], v10 offset:0
    ds_read_b64_tr_b16 v[58:59], v10 offset:2048
    v_add_u32 v11, s39, v3
    ds_read_b64_tr_b16 v[60:61], v11 offset:0
    ds_read_b64_tr_b16 v[62:63], v11 offset:2048
D_p7:
    s_waitcnt vmcnt(4) lgkmcnt(0)
    v_mfma_f32_16x16x32_bf16 v[16:19], v[48:51], v[192:195], v[16:19]
    ds_read_b64_tr_b16 v[64:65], v8 offset:4096
    ds_read_b64_tr_b16 v[66:67], v8 offset:6144
    v_mfma_f32_16x16x32_bf16 v[32:35], v[48:51], v[196:199], v[32:35]
    ds_read_b64_tr_b16 v[68:69], v9 offset:4096
    ds_read_b64_tr_b16 v[70:71], v9 offset:6144
    v_mfma_f32_16x16x32_bf16 v[20:23], v[52:55], v[192:195], v[20:23]
    ds_read_b64_tr_b16 v[72:73], v10 offset:4096
    ds_read_b64_tr_b16 v[74:75], v10 offset:6144
    v_mfma_f32_16x16x32_bf16 v[36:39], v[52:55], v[196:199], v[36:39]
    ds_read_b64_tr_b16 v[76:77], v11 offset:4096
    ds_read_b64_tr_b16 v[78:79], v11 offset:6144
    s_ff1_i32_b32 s64, s68
    s_bitset0_b32 s68, s64
    v_readlane_b32 s37, v7, s64
    s_add_u32 s69, s64, s74
    s_and_b32 s69, s69, 15
    s_lshl_b32 s69, s69, 11
    buffer_load_dwordx4 v[160:163], v4, s[16:19], s69 offen offset:0 sc1
    v_mfma_f32_16x16x32_bf16 v[24:27], v[56:59], v[192:195], v[24:27]
    v_mfma_f32_16x16x32_bf16 v[40:43], v[56:59], v[196:199], v[40:43]
    v_mfma_f32_16x16x32_bf16 v[28:31], v[60:63], v[192:195], v[28:31]
    buffer_load_dwordx4 v[164:167], v12, s[16:19], s69 offen offset:1024 sc1
    v_mfma_f32_16x16x32_bf16 v[44:47], v[60:63], v[196:199], v[44:47]
    s_waitcnt lgkmcnt(0)
    v_mfma_f32_16x16x32_bf16 v[16:19], v[64:67], v[200:203], v[16:19]
    v_add_u32 v8, s38, v5
    ds_read_b64_tr_b16 v[48:49], v8 offset:0
    v_mfma_f32_16x16x32_bf16 v[32:35], v[64:67], v[204:207], v[32:35]
    ds_read_b64_tr_b16 v[50:51], v8 offset:2048
    v_add_u32 v9, s38, v6
    v_mfma_f32_16x16x32_bf16 v[20:23], v[68:71], v[200:203], v[20:23]
    ds_read_b64_tr_b16 v[52:53], v9 offset:0
    ds_read_b64_tr_b16 v[54:55], v9 offset:2048
    v_mfma_f32_16x16x32_bf16 v[36:39], v[68:71], v[204:207], v[36:39]
    v_add_u32 v10, s38, v1
    ds_read_b64_tr_b16 v[56:57], v10 offset:0
    buffer_load_dwordx4 v[168:171], v4, s[16:19], s69 offen offset:2048 sc1
    v_mfma_f32_16x16x32_bf16 v[24:27], v[72:75], v[200:203], v[24:27]
    ds_read_b64_tr_b16 v[58:59], v10 offset:2048
    v_add_u32 v11, s38, v3
    v_mfma_f32_16x16x32_bf16 v[40:43], v[72:75], v[204:207], v[40:43]
    ds_read_b64_tr_b16 v[60:61], v11 offset:0
    ds_read_b64_tr_b16 v[62:63], v11 offset:2048
    v_mfma_f32_16x16x32_bf16 v[28:31], v[76:79], v[200:203], v[28:31]
    buffer_load_dwordx4 v[172:175], v12, s[16:19], s69 offen offset:3072 sc1
    v_mfma_f32_16x16x32_bf16 v[44:47], v[76:79], v[204:207], v[44:47]
D_p6:
    s_waitcnt vmcnt(4) lgkmcnt(0)
    v_mfma_f32_16x16x32_bf16 v[16:19], v[48:51], v[176:179], v[16:19]
    ds_read_b64_tr_b16 v[64:65], v8 offset:4096
    ds_read_b64_tr_b16 v[66:67], v8 offset:6144
    v_mfma_f32_16x16x32_bf16 v[32:35], v[48:51], v[180:183], v[32:35]
    ds_read_b64_tr_b16 v[68:69], v9 offset:4096
    ds_read_b64_tr_b16 v[70:71], v9 offset:6144
    v_mfma_f32_16x16x32_bf16 v[20:23], v[52:55], v[176:179], v[20:23]
    ds_read_b64_tr_b16 v[72:73], v10 offset:4096
    ds_read_b64_tr_b16 v[74:75], v10 offset:6144
    v_mfma_f32_16x16x32_bf16 v[36:39], v[52:55], v[180:183], v[36:39]
    ds_read_b64_tr_b16 v[76:77], v11 offset:4096
    ds_read_b64_tr_b16 v[78:79], v11 offset:6144
    s_ff1_i32_b32 s64, s68
    s_bitset0_b32 s68, s64
    v_readlane_b32 s36, v7, s64
    s_add_u32 s69, s64, s74
    s_and_b32 s69, s69, 15
    s_lshl_b32 s69, s69, 11
    buffer_load_dwordx4 v[144:147], v4, s[16:19], s69 offen offset:0 sc1
    v_mfma_f32_16x16x32_bf16 v[24:27], v[56:59], v[176:179], v[24:27]
    v_mfma_f32_16x16x32_bf16 v[40:43], v[56:59], v[180:183], v[40:43]
    v_mfma_f32_16x16x32_bf16 v[28:31], v[60:63], v[176:179], v[28:31]
    buffer_load_dwordx4 v[148:151], v12, s[16:19], s69 offen offset:1024 sc1
    v_mfma_f32_16x16x32_bf16 v[44:47], v[60:63], v[180:183], v[44:47]
    s_waitcnt lgkmcnt(0)
    v_mfma_f32_16x16x32_bf16 v[16:19], v[64:67], v[184:187], v[16:19]
    v_add_u32 v8, s37, v5
    ds_read_b64_tr_b16 v[48:49], v8 offset:0
    v_mfma_f32_16x16x32_bf16 v[32:35], v[64:67], v[188:191], v[32:35]
    ds_read_b64_tr_b16 v[50:51], v8 offset:2048
    v_add_u32 v9, s37, v6
    v_mfma_f32_16x16x32_bf16 v[20:23], v[68:71], v[184:187], v[20:23]
    ds_read_b64_tr_b16 v[52:53], v9 offset:0
    ds_read_b64_tr_b16 v[54:55], v9 offset:2048
    v_mfma_f32_16x16x32_bf16 v[36:39], v[68:71], v[188:191], v[36:39]
    v_add_u32 v10, s37, v1
    ds_read_b64_tr_b16 v[56:57], v10 offset:0
    buffer_load_dwordx4 v[152:155], v4, s[16:19], s69 offen offset:2048 sc1
    v_mfma_f32_16x16x32_bf16 v[24:27], v[72:75], v[184:187], v[24:27]
    ds_read_b64_tr_b16 v[58:59], v10 offset:2048
    v_add_u32 v11, s37, v3
    v_mfma_f32_16x16x32_bf16 v[40:43], v[72:75], v[188:191], v[40:43]
    ds_read_b64_tr_b16 v[60:61], v11 offset:0
    ds_read_b64_tr_b16 v[62:63], v11 offset:2048
    v_mfma_f32_16x16x32_bf16 v[28:31], v[76:79], v[184:187], v[28:31]
    buffer_load_dwordx4 v[156:159], v12, s[16:19], s69 offen offset:3072 sc1
    v_mfma_f32_16x16x32_bf16 v[44:47], v[76:79], v[188:191], v[44:47]
D_p5:
    s_waitcnt vmcnt(4) lgkmcnt(0)
    v_mfma_f32_16x16x32_bf16 v[16:19], v[48:51], v[160:163], v[16:19]
    ds_read_b64_tr_b16 v[64:65], v8 offset:4096
    ds_read_b64_tr_b16 v[66:67], v8 offset:6144
    v_mfma_f32_16x16x32_bf16 v[32:35], v[48:51], v[164:167], v[32:35]
    ds_read_b64_tr_b16 v[68:69], v9 offset:4096
    ds_read_b64_tr_b16 v[70:71], v9 offset:6144
    v_mfma_f32_16x16x32_bf16 v[20:23], v[52:55], v[160:163], v[20:23]
    ds_read_b64_tr_b16 v[72:73], v10 offset:4096
    ds_read_b64_tr_b16 v[74:75], v10 offset:6144
    v_mfma_f32_16x16x32_bf16 v[36:39], v[52:55], v[164:167], v[36:39]
    ds_read_b64_tr_b16 v[76:77], v11 offset:4096
    ds_read_b64_tr_b16 v[78:79], v11 offset:6144
    s_ff1_i32_b32 s64, s68
    s_bitset0_b32 s68, s64
    v_readlane_b32 s35, v7, s64
    s_add_u32 s69, s64, s74
    s_and_b32 s69, s69, 15
    s_lshl_b32 s69, s69, 11
    buffer_load_dwordx4 v[128:131], v4, s[16:19], s69 offen offset:0 sc1
    v_mfma_f32_16x16x32_bf16 v[24:27], v[56:59], v[160:163], v[24:27]
    v_mfma_f32_16x16x32_bf16 v[40:43], v[56:59], v[164:167], v[40:43]
    v_mfma_f32_16x16x32_bf16 v[28:31], v[60:63], v[160:163], v[28:31]
    buffer_load_dwordx4 v[132:135], v12, s[16:19], s69 offen offset:1024 sc1
    v_mfma_f32_16x16x32_bf16 v[44:47], v[60:63], v[164:167], v[44:47]
    s_waitcnt lgkmcnt(0)
    v_mfma_f32_16x16x32_bf16 v[16:19], v[64:67], v[168:171], v[16:19]
    v_add_u32 v8, s36, v5
    ds_read_b64_tr_b16 v[48:49], v8 offset:0
    v_mfma_f32_16x16x32_bf16 v[32:35], v[64:67], v[172:175], v[32:35]
    ds_read_b64_tr_b16 v[50:51], v8 offset:2048
    v_add_u32 v9, s36, v6
    v_mfma_f32_16x16x32_bf16 v[20:23], v[68:71], v[168:171], v[20:23]
    ds_read_b64_tr_b16 v[52:53], v9 offset:0
    ds_read_b64_tr_b16 v[54:55], v9 offset:2048
    v_mfma_f32_16x16x32_bf16 v[36:39], v[68:71], v[172:175], v[36:39]
    v_add_u32 v10, s36, v1
    ds_read_b64_tr_b16 v[56:57], v10 offset:0
    buffer_load_dwordx4 v[136:139], v4, s[16:19], s69 offen offset:2048 sc1
    v_mfma_f32_16x16x32_bf16 v[24:27], v[72:75], v[168:171], v[24:27]
    ds_read_b64_tr_b16 v[58:59], v10 offset:2048
    v_add_u32 v11, s36, v3
    v_mfma_f32_16x16x32_bf16 v[40:43], v[72:75], v[172:175], v[40:43]
    ds_read_b64_tr_b16 v[60:61], v11 offset:0
    ds_read_b64_tr_b16 v[62:63], v11 offset:2048
    v_mfma_f32_16x16x32_bf16 v[28:31], v[76:79], v[168:171], v[28:31]
    buffer_load_dwordx4 v[140:143], v12, s[16:19], s69 offen offset:3072 sc1
    v_mfma_f32_16x16x32_bf16 v[44:47], v[76:79], v[172:175], v[44:47]
D_p4:
    s_waitcnt vmcnt(4) lgkmcnt(0)
    v_mfma_f32_16x16x32_bf16 v[16:19], v[48:51], v[144:147], v[16:19]
    ds_read_b64_tr_b16 v[64:65], v8 offset:4096
    ds_read_b64_tr_b16 v[66:67], v8 offset:6144
    v_mfma_f32_16x16x32_bf16 v[32:35], v[48:51], v[148:151], v[32:35]
    ds_read_b64_tr_b16 v[68:69], v9 offset:4096
    ds_read_b64_tr_b16 v[70:71], v9 offset:6144
    v_mfma_f32_16x16x32_bf16 v[20:23], v[52:55], v[144:147], v[20:23]
    ds_read_b64_tr_b16 v[72:73], v10 offset:4096
    ds_read_b64_tr_b16 v[74:75], v10 offset:6144
    v_mfma_f32_16x16x32_bf16 v[36:39], v[52:55], v[148:151], v[36:39]
    ds_read_b64_tr_b16 v[76:77], v11 offset:4096
    ds_read_b64_tr_b16 v[78:79], v11 offset:6144
    s_ff1_i32_b32 s64, s68
    s_bitset0_b32 s68, s64
    v_readlane_b32 s34, v7, s64
    s_add_u32 s69, s64, s74
    s_and_b32 s69, s69, 15
    s_lshl_b32 s69, s69, 11
    buffer_load_dwordx4 v[112:115], v4, s[16:19], s69 offen offset:0 sc1
    v_mfma_f32_16x16x32_bf16 v[24:27], v[56:59], v[144:147], v[24:27]
    v_mfma_f32_16x16x32_bf16 v[40:43], v[56:59], v[148:151], v[40:43]
    v_mfma_f32_16x16x32_bf16 v[28:31], v[60:63], v[144:147], v[28:31]
    buffer_load_dwordx4 v[116:119], v12, s[16:19], s69 offen offset:1024 sc1
    v_mfma_f32_16x16x32_bf16 v[44:47], v[60:63], v[148:151], v[44:47]
    s_waitcnt lgkmcnt(0)
    v_mfma_f32_16x16x32_bf16 v[16:19], v[64:67], v[152:155], v[16:19]
    v_add_u32 v8, s35, v5
    ds_read_b64_tr_b16 v[48:49], v8 offset:0
    v_mfma_f32_16x16x32_bf16 v[32:35], v[64:67], v[156:159], v[32:35]
    ds_read_b64_tr_b16 v[50:51], v8 offset:2048
    v_add_u32 v9, s35, v6
    v_mfma_f32_16x16x32_bf16 v[20:23], v[68:71], v[152:155], v[20:23]
    ds_read_b64_tr_b16 v[52:53], v9 offset:0
    ds_read_b64_tr_b16 v[54:55], v9 offset:2048
    v_mfma_f32_16x16x32_bf16 v[36:39], v[68:71], v[156:159], v[36:39]
    v_add_u32 v10, s35, v1
    ds_read_b64_tr_b16 v[56:57], v10 offset:0
    buffer_load_dwordx4 v[120:123], v4, s[16:19], s69 offen offset:2048 sc1
    v_mfma_f32_16x16x32_bf16 v[24:27], v[72:75], v[152:155], v[24:27]
    ds_read_b64_tr_b16 v[58:59], v10 offset:2048
    v_add_u32 v11, s35, v3
    v_mfma_f32_16x16x32_bf16 v[40:43], v[72:75], v[156:159], v[40:43]
    ds_read_b64_tr_b16 v[60:61], v11 offset:0
    ds_read_b64_tr_b16 v[62:63], v11 offset:2048
    v_mfma_f32_16x16x32_bf16 v[28:31], v[76:79], v[152:155], v[28:31]
    buffer_load_dwordx4 v[124:127], v12, s[16:19], s69 offen offset:3072 sc1
    v_mfma_f32_16x16x32_bf16 v[44:47], v[76:79], v[156:159], v[44:47]
D_p3:
    s_waitcnt vmcnt(4) lgkmcnt(0)
    v_mfma_f32_16x16x32_bf16 v[16:19], v[48:51], v[128:131], v[16:19]
    ds_read_b64_tr_b16 v[64:65], v8 offset:4096
    ds_read_b64_tr_b16 v[66:67], v8 offset:6144
    v_mfma_f32_16x16x32_bf16 v[32:35], v[48:51], v[132:135], v[32:35]
    ds_read_b64_tr_b16 v[68:69], v9 offset:4096
    ds_read_b64_tr_b16 v[70:71], v9 offset:6144
    v_mfma_f32_16x16x32_bf16 v[20:23], v[52:55], v[128:131], v[20:23]
    ds_read_b64_tr_b16 v[72:73], v10 offset:4096
    ds_read_b64_tr_b16 v[74:75], v10 offset:6144
    v_mfma_f32_16x16x32_bf16 v[36:39], v[52:55], v[132:135], v[36:39]
    ds_read_b64_tr_b16 v[76:77], v11 offset:4096
    ds_read_b64_tr_b16 v[78:79], v11 offset:6144
    s_ff1_i32_b32 s64, s68
    s_bitset0_b32 s68, s64
    v_readlane_b32 s33, v7, s64
    s_add_u32 s69, s64, s74
    s_and_b32 s69, s69, 15
    s_lshl_b32 s69, s69, 11
    buffer_load_dwordx4 v[96:99], v4, s[16:19], s69 offen offset:0 sc1
    v_mfma_f32_16x16x32_bf16 v[24:27], v[56:59], v[128:131], v[24:27]
    v_mfma_f32_16x16x32_bf16 v[40:43], v[56:59], v[132:135], v[40:43]
    v_mfma_f32_16x16x32_bf16 v[28:31], v[60:63], v[128:131], v[28:31]
    buffer_load_dwordx4 v[100:103], v12, s[16:19], s69 offen offset:1024 sc1
    v_mfma_f32_16x16x32_bf16 v[44:47], v[60:63], v[132:135], v[44:47]
    s_waitcnt lgkmcnt(0)
    v_mfma_f32_16x16x32_bf16 v[16:19], v[64:67], v[136:139], v[16:19]
    v_add_u32 v8, s34, v5
    ds_read_b64_tr_b16 v[48:49], v8 offset:0
    v_mfma_f32_16x16x32_bf16 v[32:35], v[64:67], v[140:143], v[32:35]
    ds_read_b64_tr_b16 v[50:51], v8 offset:2048
    v_add_u32 v9, s34, v6
    v_mfma_f32_16x16x32_bf16 v[20:23], v[68:71], v[136:139], v[20:23]
    ds_read_b64_tr_b16 v[52:53], v9 offset:0
    ds_read_b64_tr_b16 v[54:55], v9 offset:2048
    v_mfma_f32_16x16x32_bf16 v[36:39], v[68:71], v[140:143], v[36:39]
    v_add_u32 v10, s34, v1
    ds_read_b64_tr_b16 v[56:57], v10 offset:0
    buffer_load_dwordx4 v[104:107], v4, s[16:19], s69 offen offset:2048 sc1
    v_mfma_f32_16x16x32_bf16 v[24:27], v[72:75], v[136:139], v[24:27]
    ds_read_b64_tr_b16 v[58:59], v10 offset:2048
    v_add_u32 v11, s34, v3
    v_mfma_f32_16x16x32_bf16 v[40:43], v[72:75], v[140:143], v[40:43]
    ds_read_b64_tr_b16 v[60:61], v11 offset:0
    ds_read_b64_tr_b16 v[62:63], v11 offset:2048
    v_mfma_f32_16x16x32_bf16 v[28:31], v[76:79], v[136:139], v[28:31]
    buffer_load_dwordx4 v[108:111], v12, s[16:19], s69 offen offset:3072 sc1
    v_mfma_f32_16x16x32_bf16 v[44:47], v[76:79], v[140:143], v[44:47]
D_p2:
    s_waitcnt vmcnt(4) lgkmcnt(0)
    v_mfma_f32_16x16x32_bf16 v[16:19], v[48:51], v[112:115], v[16:19]
    ds_read_b64_tr_b16 v[64:65], v8 offset:4096
    ds_read_b64_tr_b16 v[66:67], v8 offset:6144
    v_mfma_f32_16x16x32_bf16 v[32:35], v[48:51], v[116:119], v[32:35]
    ds_read_b64_tr_b16 v[68:69], v9 offset:4096
    ds_read_b64_tr_b16 v[70:71], v9 offset:6144
    v_mfma_f32_16x16x32_bf16 v[20:23], v[52:55], v[112:115], v[20:23]
    ds_read_b64_tr_b16 v[72:73], v10 offset:4096
    ds_read_b64_tr_b16 v[74:75], v10 offset:6144
    v_mfma_f32_16x16x32_bf16 v[36:39], v[52:55], v[116:119], v[36:39]
    ds_read_b64_tr_b16 v[76:77], v11 offset:4096
    ds_read_b64_tr_b16 v[78:79], v11 offset:6144
    s_ff1_i32_b32 s64, s68
    s_bitset0_b32 s68, s64
    v_readlane_b32 s32, v7, s64
    s_add_u32 s69, s64, s74
    s_and_b32 s69, s69, 15
    s_lshl_b32 s69, s69, 11
    buffer_load_dwordx4 v[80:83], v4, s[16:19], s69 offen offset:0 sc1
    v_mfma_f32_16x16x32_bf16 v[24:27], v[56:59], v[112:115], v[24:27]
    v_mfma_f32_16x16x32_bf16 v[40:43], v[56:59], v[116:119], v[40:43]
    v_mfma_f32_16x16x32_bf16 v[28:31], v[60:63], v[112:115], v[28:31]
    buffer_load_dwordx4 v[84:87], v12, s[16:19], s69 offen offset:1024 sc1
    v_mfma_f32_16x16x32_bf16 v[44:47], v[60:63], v[116:119], v[44:47]
    s_waitcnt lgkmcnt(0)
    v_mfma_f32_16x16x32_bf16 v[16:19], v[64:67], v[120:123], v[16:19]
    v_add_u32 v8, s33, v5
    ds_read_b64_tr_b16 v[48:49], v8 offset:0
    v_mfma_f32_16x16x32_bf16 v[32:35], v[64:67], v[124:127], v[32:35]
    ds_read_b64_tr_b16 v[50:51], v8 offset:2048
    v_add_u32 v9, s33, v6
    v_mfma_f32_16x16x32_bf16 v[20:23], v[68:71], v[120:123], v[20:23]
    ds_read_b64_tr_b16 v[52:53], v9 offset:0
    ds_read_b64_tr_b16 v[54:55], v9 offset:2048
    v_mfma_f32_16x16x32_bf16 v[36:39], v[68:71], v[124:127], v[36:39]
    v_add_u32 v10, s33, v1
    ds_read_b64_tr_b16 v[56:57], v10 offset:0
    buffer_load_dwordx4 v[88:91], v4, s[16:19], s69 offen offset:2048 sc1
    v_mfma_f32_16x16x32_bf16 v[24:27], v[72:75], v[120:123], v[24:27]
    ds_read_b64_tr_b16 v[58:59], v10 offset:2048
    v_add_u32 v11, s33, v3
    v_mfma_f32_16x16x32_bf16 v[40:43], v[72:75], v[124:127], v[40:43]
    ds_read_b64_tr_b16 v[60:61], v11 offset:0
    ds_read_b64_tr_b16 v[62:63], v11 offset:2048
    v_mfma_f32_16x16x32_bf16 v[28:31], v[76:79], v[120:123], v[28:31]
    buffer_load_dwordx4 v[92:95], v12, s[16:19], s69 offen offset:3072 sc1
    s_mov_b64 exec, 1
    v_mov_b32 v15, 0
    buffer_atomic_or v15, v14, s[16:19], 0 offen sc0
    s_mov_b64 exec, -1
    v_mfma_f32_16x16x32_bf16 v[44:47], v[76:79], v[124:127], v[44:47]
D_p1:
    s_waitcnt vmcnt(5) lgkmcnt(0)
    v_mfma_f32_16x16x32_bf16 v[16:19], v[48:51], v[96:99], v[16:19]
    ds_read_b64_tr_b16 v[64:65], v8 offset:4096
    ds_read_b64_tr_b16 v[66:67], v8 offset:6144
    v_mfma_f32_16x16x32_bf16 v[32:35], v[48:51], v[100:103], v[32:35]
    ds_read_b64_tr_b16 v[68:69], v9 offset:4096
    ds_read_b64_tr_b16 v[70:71], v9 offset:6144
    v_mfma_f32_16x16x32_bf16 v[20:23], v[52:55], v[96:99], v[20:23]
    ds_read_b64_tr_b16 v[72:73], v10 offset:4096
    ds_read_b64_tr_b16 v[74:75], v10 offset:6144
    v_mfma_f32_16x16x32_bf16 v[36:39], v[52:55], v[100:103], v[36:39]
    ds_read_b64_tr_b16 v[76:77], v11 offset:4096
    ds_read_b64_tr_b16 v[78:79], v11 offset:6144
    v_mfma_f32_16x16x32_bf16 v[24:27], v[56:59], v[96:99], v[24:27]
    v_mfma_f32_16x16x32_bf16 v[40:43], v[56:59], v[100:103], v[40:43]
    v_mfma_f32_16x16x32_bf16 v[28:31], v[60:63], v[96:99], v[28:31]
    v_mfma_f32_16x16x32_bf16 v[44:47], v[60:63], v[100:103], v[44:47]
    s_waitcnt lgkmcnt(0)
    v_mfma_f32_16x16x32_bf16 v[16:19], v[64:67], v[104:107], v[16:19]
    v_add_u32 v8, s32, v5
    ds_read_b64_tr_b16 v[48:49], v8 offset:0
    v_mfma_f32_16x16x32_bf16 v[32:35], v[64:67], v[108:111], v[32:35]
    ds_read_b64_tr_b16 v[50:51], v8 offset:2048
    v_add_u32 v9, s32, v6
    v_mfma_f32_16x16x32_bf16 v[20:23], v[68:71], v[104:107], v[20:23]
    ds_read_b64_tr_b16 v[52:53], v9 offset:0
    ds_read_b64_tr_b16 v[54:55], v9 offset:2048
    v_mfma_f32_16x16x32_bf16 v[36:39], v[68:71], v[108:111], v[36:39]
    v_add_u32 v10, s32, v1
    ds_read_b64_tr_b16 v[56:57], v10 offset:0
    v_mfma_f32_16x16x32_bf16 v[24:27], v[72:75], v[104:107], v[24:27]
    ds_read_b64_tr_b16 v[58:59], v10 offset:2048
    v_add_u32 v11, s32, v3
    v_mfma_f32_16x16x32_bf16 v[40:43], v[72:75], v[108:111], v[40:43]
    ds_read_b64_tr_b16 v[60:61], v11 offset:0
    ds_read_b64_tr_b16 v[62:63], v11 offset:2048
    v_mfma_f32_16x16x32_bf16 v[28:31], v[76:79], v[104:107], v[28:31]
    v_mfma_f32_16x16x32_bf16 v[44:47], v[76:79], v[108:111], v[44:47]
D_p0:
    s_waitcnt vmcnt(1) lgkmcnt(0)
    v_mfma_f32_16x16x32_bf16 v[16:19], v[48:51], v[80:83], v[16:19]
    ds_read_b64_tr_b16 v[64:65], v8 offset:4096
    ds_read_b64_tr_b16 v[66:67], v8 offset:6144
    v_mfma_f32_16x16x32_bf16 v[32:35], v[48:51], v[84:87], v[32:35]
    ds_read_b64_tr_b16 v[68:69], v9 offset:4096
    ds_read_b64_tr_b16 v[70:71], v9 offset:6144
    v_mfma_f32_16x16x32_bf16 v[20:23], v[52:55], v[80:83], v[20:23]
    ds_read_b64_tr_b16 v[72:73], v10 offset:4096
    ds_read_b64_tr_b16 v[74:75], v10 offset:6144
    v_mfma_f32_16x16x32_bf16 v[36:39], v[52:55], v[84:87], v[36:39]
    ds_read_b64_tr_b16 v[76:77], v11 offset:4096
    ds_read_b64_tr_b16 v[78:79], v11 offset:6144
    v_mfma_f32_16x16x32_bf16 v[24:27], v[56:59], v[80:83], v[24:27]
    v_mfma_f32_16x16x32_bf16 v[40:43], v[56:59], v[84:87], v[40:43]
    v_mfma_f32_16x16x32_bf16 v[28:31], v[60:63], v[80:83], v[28:31]
    v_mfma_f32_16x16x32_bf16 v[44:47], v[60:63], v[84:87], v[44:47]
    s_waitcnt lgkmcnt(0)
    v_mfma_f32_16x16x32_bf16 v[16:19], v[64:67], v[88:91], v[16:19]
    v_mfma_f32_16x16x32_bf16 v[32:35], v[64:67], v[92:95], v[32:35]
    v_mfma_f32_16x16x32_bf16 v[20:23], v[68:71], v[88:91], v[20:23]
    v_mfma_f32_16x16x32_bf16 v[36:39], v[68:71], v[92:95], v[36:39]
    v_mfma_f32_16x16x32_bf16 v[24:27], v[72:75], v[88:91], v[24:27]
    v_mfma_f32_16x16x32_bf16 v[40:43], v[72:75], v[92:95], v[40:43]
    v_mfma_f32_16x16x32_bf16 v[28:31], v[76:79], v[88:91], v[28:31]
    v_mfma_f32_16x16x32_bf16 v[44:47], v[76:79], v[92:95], v[44:47]
    s_cmp_lg_u32 s66, 0
    s_cbranch_scc1 D_wait
D_end:
    s_lshl_b32 s64, s3, 12
    s_add_u32 s64, s64, 8192
    v_lshl_add_u32 v8, v2, 4, s64
    s_xor_b32 s65, s3, 4
    s_lshl_b32 s65, s65, 12
    s_add_u32 s65, s65, 8192
    v_lshl_add_u32 v5, v2, 4, s65
    v_lshlrev_b32 v9, 1, v229
    v_cmp_eq_u32 s[70:71], s67, v230
    s_cmp_eq_u32 s46, 0
    s_cbranch_scc1 P2_y
P2_ny:
    s_barrier
    ds_write_b128 v8, v[32:35] offset:0
    ds_write_b128 v8, v[36:39] offset:1024
    ds_write_b128 v8, v[40:43] offset:2048
    ds_write_b128 v8, v[44:47] offset:3072
    s_cmp_lg_u64 s[70:71], 0
    s_cbranch_scc1 P2_fix
P2_nr:
    s_waitcnt lgkmcnt(0)
    s_barrier
    ds_read_b128 v[64:67], v5 offset:0
    ds_read_b128 v[68:71], v5 offset:1024
    ds_read_b128 v[72:75], v5 offset:2048
    ds_read_b128 v[76:79], v5 offset:3072
    s_waitcnt lgkmcnt(2)
    v_pk_add_f32 v[16:17], v[16:17], v[64:65]
    v_pk_add_f32 v[18:19], v[18:19], v[66:67]
    v_pk_add_f32 v[20:21], v[20:21], v[68:69]
    v_pk_add_f32 v[22:23], v[22:23], v[70:71]
    v_cvt_pk_bf16_f32 v48, v16, v17
    v_cvt_pk_bf16_f32 v49, v18, v19
    v_cvt_pk_bf16_f32 v50, v20, v21
    v_cvt_pk_bf16_f32 v51, v22, v23
    s_nop 0
    v_permlane16_swap_b32 v48, v50
    v_permlane16_swap_b32 v49, v51
    v_lshlrev_b32 v16, 16, v48
    v_and_b32 v17, 0xffff0000, v48
    v_lshlrev_b32 v18, 16, v49
    v_and_b32 v19, 0xffff0000, v49
    v_lshlrev_b32 v20, 16, v50
    v_and_b32 v21, 0xffff0000, v50
    v_lshlrev_b32 v22, 16, v51
    v_and_b32 v23, 0xffff0000, v51
    v_pk_mul_f32 v[16:17], v[16:17], v[228:229] op_sel_hi:[1,0]
    v_pk_mul_f32 v[18:19], v[18:19], v[228:229] op_sel_hi:[1,0]
    v_pk_mul_f32 v[20:21], v[20:21], v[228:229] op_sel_hi:[1,0]
    v_pk_mul_f32 v[22:23], v[22:23], v[228:229] op_sel_hi:[1,0]
    v_cvt_pk_bf16_f32 v48, v16, v17
    v_cvt_pk_bf16_f32 v49, v18, v19
    v_cvt_pk_bf16_f32 v50, v20, v21
    v_cvt_pk_bf16_f32 v51, v22, v23
    v_lshlrev_b32 v16, 16, v48
    v_and_b32 v17, 0xffff0000, v48
    v_lshlrev_b32 v18, 16, v49
    v_and_b32 v19, 0xffff0000, v49
    v_lshlrev_b32 v20, 16, v50
    v_and_b32 v21, 0xffff0000, v50
    v_lshlrev_b32 v22, 16, v51
    v_and_b32 v23, 0xffff0000, v51
    v_pk_add_f32 v[16:17], v[16:17], v[232:233]
    v_pk_add_f32 v[18:19], v[18:19], v[234:235]
    v_pk_add_f32 v[20:21], v[20:21], v[236:237]
    v_pk_add_f32 v[22:23], v[22:23], v[238:239]
    v_cvt_pk_bf16_f32 v120, v16, v17
    v_cvt_pk_bf16_f32 v121, v18, v19
    v_cvt_pk_bf16_f32 v122, v20, v21
    v_cvt_pk_bf16_f32 v123, v22, v23
    v_and_b32 v6, 1, v2
    v_mul_u32_u24 v6, 1984, v6
    v_sub_u32 v231, v231, v6
    s_mov_b32 vcc_lo, 0x55555555
    s_mov_b32 vcc_hi, 0x55555555
    s_waitcnt lgkmcnt(0)
    v_pk_add_f32 v[24:25], v[24:25], v[72:73]
    v_pk_add_f32 v[26:27], v[26:27], v[74:75]
    v_pk_add_f32 v[28:29], v[28:29], v[76:77]
    v_pk_add_f32 v[30:31], v[30:31], v[78:79]
    v_cvt_pk_bf16_f32 v52, v24, v25
    v_cvt_pk_bf16_f32 v53, v26, v27
    v_cvt_pk_bf16_f32 v54, v28, v29
    v_cvt_pk_bf16_f32 v55, v30, v31
    s_nop 0
    v_permlane16_swap_b32 v52, v54
    v_permlane16_swap_b32 v53, v55
    v_lshlrev_b32 v24, 16, v52
    v_and_b32 v25, 0xffff0000, v52
    v_lshlrev_b32 v26, 16, v53
    v_and_b32 v27, 0xffff0000, v53
    v_lshlrev_b32 v28, 16, v54
    v_and_b32 v29, 0xffff0000, v54
    v_lshlrev_b32 v30, 16, v55
    v_and_b32 v31, 0xffff0000, v55
    v_pk_mul_f32 v[24:25], v[24:25], v[228:229] op_sel_hi:[1,0]
    v_pk_mul_f32 v[26:27], v[26:27], v[228:229] op_sel_hi:[1,0]
    v_pk_mul_f32 v[28:29], v[28:29], v[228:229] op_sel_hi:[1,0]
    v_pk_mul_f32 v[30:31], v[30:31], v[228:229] op_sel_hi:[1,0]
    v_cvt_pk_bf16_f32 v52, v24, v25
    v_cvt_pk_bf16_f32 v53, v26, v27
    v_cvt_pk_bf16_f32 v54, v28, v29
    v_cvt_pk_bf16_f32 v55, v30, v31
    v_lshlrev_b32 v24, 16, v52
    v_and_b32 v25, 0xffff0000, v52
    v_lshlrev_b32 v26, 16, v53
    v_and_b32 v27, 0xffff0000, v53
    v_lshlrev_b32 v28, 16, v54
    v_and_b32 v29, 0xffff0000, v54
    v_lshlrev_b32 v30, 16, v55
    v_and_b32 v31, 0xffff0000, v55
    v_pk_add_f32 v[24:25], v[24:25], v[240:241]
    v_pk_add_f32 v[26:27], v[26:27], v[242:243]
    v_pk_add_f32 v[28:29], v[28:29], v[244:245]
    v_pk_add_f32 v[30:31], v[30:31], v[246:247]
    v_cvt_pk_bf16_f32 v124, v24, v25
    v_cvt_pk_bf16_f32 v125, v26, v27
    v_cvt_pk_bf16_f32 v126, v28, v29
    v_cvt_pk_bf16_f32 v127, v30, v31
    s_nop 1
    v_cndmask_b32_dpp v56, v124, v120, vcc quad_perm:[1,0,3,2] row_mask:0xf bank_mask:0xf
    v_cndmask_b32_dpp v57, v125, v121, vcc quad_perm:[1,0,3,2] row_mask:0xf bank_mask:0xf
    v_cndmask_b32_dpp v58, v126, v122, vcc quad_perm:[1,0,3,2] row_mask:0xf bank_mask:0xf
    v_cndmask_b32_dpp v59, v127, v123, vcc quad_perm:[1,0,3,2] row_mask:0xf bank_mask:0xf
    buffer_store_dwordx4 v[56:59], v231, s[20:23], 0 offen nt
    s_not_b64 vcc, vcc
    v_cndmask_b32_dpp v60, v120, v124, vcc quad_perm:[1,0,3,2] row_mask:0xf bank_mask:0xf
    v_cndmask_b32_dpp v61, v121, v125, vcc quad_perm:[1,0,3,2] row_mask:0xf bank_mask:0xf
    v_cndmask_b32_dpp v62, v122, v126, vcc quad_perm:[1,0,3,2] row_mask:0xf bank_mask:0xf
    v_cndmask_b32_dpp v63, v123, v127, vcc quad_perm:[1,0,3,2] row_mask:0xf bank_mask:0xf
    buffer_store_dwordx4 v[60:63], v231, s[20:23], 0 offen offset:2048 nt
K_end:
    s_endpgm
H_nre:
    s_add_u32 s65, s65, 1
    s_cmp_ge_u32 s65, 200000
    s_cbranch_scc1 H_nok
    s_sleep 4
    buffer_load_dword v78, v79, s[20:23], 0 offen sc1
    s_waitcnt vmcnt(0)
    s_branch H_nspin
H_retry:
    s_add_u32 s65, s65, 1
    s_cmp_ge_u32 s65, 200000
    s_cbranch_scc1 H_nq
    s_sleep 8
    s_mov_b32 s64, 6717440
    buffer_load_dwordx4 v[24:27], v6, s[16:19], s64 offen offset:0 sc1
    buffer_load_dwordx4 v[28:31], v6, s[16:19], s64 offen offset:1024 sc1
    s_waitcnt vmcnt(0)
    s_branch H_spin
G_f15:
    s_bitset1_b32 s66, s55
    s_branch G_q15
G_f14:
    s_bitset1_b32 s66, s54
    s_branch G_q14
G_f13:
    s_bitset1_b32 s66, s53
    s_branch G_q13
G_f12:
    s_bitset1_b32 s66, s52
    s_branch G_q12
G_f11:
    s_bitset1_b32 s66, s51
    s_branch G_q11
G_f10:
    s_bitset1_b32 s66, s50
    s_branch G_q10
G_f9:
    s_bitset1_b32 s66, s49
    s_branch G_q9
G_f8:
    s_bitset1_b32 s66, s48
    s_branch G_q8
G_f7:
    s_bitset1_b32 s66, s47
    s_branch G_q7
G_f6:
    s_bitset1_b32 s66, s46
    s_branch G_q6
G_f5:
    s_bitset1_b32 s66, s45
    s_branch G_q5
G_f4:
    s_bitset1_b32 s66, s44
    s_branch G_q4
G_f3:
    s_bitset1_b32 s66, s43
    s_branch G_q3
G_f2:
    s_bitset1_b32 s66, s42
    s_branch G_q2
G_f1:
    s_bitset1_b32 s66, s41
    s_branch G_q1
G_f0:
    s_bitset1_b32 s66, s40
    s_branch G_q0
phi_15_fix:
    v_lshlrev_b32 v48, 16, v16
    v_and_b32 v49, 0xffff0000, v16
    v_add_f32 v48, s73, v48
    v_add_f32 v49, s73, v49
    v_cvt_pk_bf16_f32 v16, v48, v49
    v_lshlrev_b32 v48, 16, v17
    v_and_b32 v49, 0xffff0000, v17
    v_add_f32 v48, s73, v48
    v_add_f32 v49, s73, v49
    v_cvt_pk_bf16_f32 v17, v48, v49
    v_lshlrev_b32 v48, 16, v18
    v_and_b32 v49, 0xffff0000, v18
    v_add_f32 v48, s73, v48
    v_add_f32 v49, s73, v49
    v_cvt_pk_bf16_f32 v18, v48, v49
    v_lshlrev_b32 v48, 16, v19
    v_and_b32 v49, 0xffff0000, v19
    v_add_f32 v48, s73, v48
    v_add_f32 v49, s73, v49
    v_cvt_pk_bf16_f32 v19, v48, v49
    v_lshlrev_b32 v48, 16, v20
    v_and_b32 v49, 0xffff0000, v20
    v_add_f32 v48, s73, v48
    v_add_f32 v49, s73, v49
    v_cvt_pk_bf16_f32 v20, v48, v49
    v_lshlrev_b32 v48, 16, v21
    v_and_b32 v49, 0xffff0000, v21
    v_add_f32 v48, s73, v48
    v_add_f32 v49, s73, v49
    v_cvt_pk_bf16_f32 v21, v48, v49
    v_lshlrev_b32 v48, 16, v22
    v_and_b32 v49, 0xffff0000, v22
    v_add_f32 v48, s73, v48
    v_add_f32 v49, s73, v49
    v_cvt_pk_bf16_f32 v22, v48, v49
    v_lshlrev_b32 v48, 16, v23
    v_and_b32 v49, 0xffff0000, v23
    v_add_f32 v48, s73, v48
    v_add_f32 v49, s73, v49
    v_cvt_pk_bf16_f32 v23, v48, v49
    s_branch phi_15_done
phi_16_fix:
    v_lshlrev_b32 v48, 16, v24
    v_and_b32 v49, 0xffff0000, v24
    v_add_f32 v48, s73, v48
    v_add_f32 v49, s73, v49
    v_cvt_pk_bf16_f32 v24, v48, v49
    v_lshlrev_b32 v48, 16, v25
    v_and_b32 v49, 0xffff0000, v25
    v_add_f32 v48, s73, v48
    v_add_f32 v49, s73, v49
    v_cvt_pk_bf16_f32 v25, v48, v49
    v_lshlrev_b32 v48, 16, v26
    v_and_b32 v49, 0xffff0000, v26
    v_add_f32 v48, s73, v48
    v_add_f32 v49, s73, v49
    v_cvt_pk_bf16_f32 v26, v48, v49
    v_lshlrev_b32 v48, 16, v27
    v_and_b32 v49, 0xffff0000, v27
    v_add_f32 v48, s73, v48
    v_add_f32 v49, s73, v49
    v_cvt_pk_bf16_f32 v27, v48, v49
    v_lshlrev_b32 v48, 16, v28
    v_and_b32 v49, 0xffff0000, v28
    v_add_f32 v48, s73, v48
    v_add_f32 v49, s73, v49
    v_cvt_pk_bf16_f32 v28, v48, v49
    v_lshlrev_b32 v48, 16, v29
    v_and_b32 v49, 0xffff0000, v29
    v_add_f32 v48, s73, v48
    v_add_f32 v49, s73, v49
    v_cvt_pk_bf16_f32 v29, v48, v49
    v_lshlrev_b32 v48, 16, v30
    v_and_b32 v49, 0xffff0000, v30
    v_add_f32 v48, s73, v48
    v_add_f32 v49, s73, v49
    v_cvt_pk_bf16_f32 v30, v48, v49
    v_lshlrev_b32 v48, 16, v31
    v_and_b32 v49, 0xffff0000, v31
    v_add_f32 v48, s73, v48
    v_add_f32 v49, s73, v49
    v_cvt_pk_bf16_f32 v31, v48, v49
    s_branch phi_16_done
C_ex1:
    ds_write_b32 v227, v96 offset:4608
    ds_write_b128 v224, v[240:243] offset:32768
    ds_write_b128 v224, v[244:247] offset:33792
    s_nop 4
    v_mov_b32 v96, v60
    v_mov_b32 v240, v248
    v_mov_b32 v241, v249
    v_mov_b32 v242, v250
    v_mov_b32 v243, v251
    v_mov_b32 v244, v252
    v_mov_b32 v245, v253
    v_mov_b32 v246, v254
    v_mov_b32 v247, v255
    s_branch C_ex2
phi_17_fix:
    v_lshlrev_b32 v48, 16, v32
    v_and_b32 v49, 0xffff0000, v32
    v_add_f32 v48, s73, v48
    v_add_f32 v49, s73, v49
    v_cvt_pk_bf16_f32 v32, v48, v49
    v_lshlrev_b32 v48, 16, v33
    v_and_b32 v49, 0xffff0000, v33
    v_add_f32 v48, s73, v48
    v_add_f32 v49, s73, v49
    v_cvt_pk_bf16_f32 v33, v48, v49
    v_lshlrev_b32 v48, 16, v34
    v_and_b32 v49, 0xffff0000, v34
    v_add_f32 v48, s73, v48
    v_add_f32 v49, s73, v49
    v_cvt_pk_bf16_f32 v34, v48, v49
    v_lshlrev_b32 v48, 16, v35
    v_and_b32 v49, 0xffff0000, v35
    v_add_f32 v48, s73, v48
    v_add_f32 v49, s73, v49
    v_cvt_pk_bf16_f32 v35, v48, v49
    v_lshlrev_b32 v48, 16, v36
    v_and_b32 v49, 0xffff0000, v36
    v_add_f32 v48, s73, v48
    v_add_f32 v49, s73, v49
    v_cvt_pk_bf16_f32 v36, v48, v49
    v_lshlrev_b32 v48, 16, v37
    v_and_b32 v49, 0xffff0000, v37
    v_add_f32 v48, s73, v48
    v_add_f32 v49, s73, v49
    v_cvt_pk_bf16_f32 v37, v48, v49
    v_lshlrev_b32 v48, 16, v38
    v_and_b32 v49, 0xffff0000, v38
    v_add_f32 v48, s73, v48
    v_add_f32 v49, s73, v49
    v_cvt_pk_bf16_f32 v38, v48, v49
    v_lshlrev_b32 v48, 16, v39
    v_and_b32 v49, 0xffff0000, v39
    v_add_f32 v48, s73, v48
    v_add_f32 v49, s73, v49
    v_cvt_pk_bf16_f32 v39, v48, v49
    s_branch phi_17_done
phi_18_fix:
    v_lshlrev_b32 v48, 16, v40
    v_and_b32 v49, 0xffff0000, v40
    v_add_f32 v48, s73, v48
    v_add_f32 v49, s73, v49
    v_cvt_pk_bf16_f32 v40, v48, v49
    v_lshlrev_b32 v48, 16, v41
    v_and_b32 v49, 0xffff0000, v41
    v_add_f32 v48, s73, v48
    v_add_f32 v49, s73, v49
    v_cvt_pk_bf16_f32 v41, v48, v49
    v_lshlrev_b32 v48, 16, v42
    v_and_b32 v49, 0xffff0000, v42
    v_add_f32 v48, s73, v48
    v_add_f32 v49, s73, v49
    v_cvt_pk_bf16_f32 v42, v48, v49
    v_lshlrev_b32 v48, 16, v43
    v_and_b32 v49, 0xffff0000, v43
    v_add_f32 v48, s73, v48
    v_add_f32 v49, s73, v49
    v_cvt_pk_bf16_f32 v43, v48, v49
    v_lshlrev_b32 v48, 16, v44
    v_and_b32 v49, 0xffff0000, v44
    v_add_f32 v48, s73, v48
    v_add_f32 v49, s73, v49
    v_cvt_pk_bf16_f32 v44, v48, v49
    v_lshlrev_b32 v48, 16, v45
    v_and_b32 v49, 0xffff0000, v45
    v_add_f32 v48, s73, v48
    v_add_f32 v49, s73, v49
    v_cvt_pk_bf16_f32 v45, v48, v49
    v_lshlrev_b32 v48, 16, v46
    v_and_b32 v49, 0xffff0000, v46
    v_add_f32 v48, s73, v48
    v_add_f32 v49, s73, v49
    v_cvt_pk_bf16_f32 v46, v48, v49
    v_lshlrev_b32 v48, 16, v47
    v_and_b32 v49, 0xffff0000, v47
    v_add_f32 v48, s73, v48
    v_add_f32 v49, s73, v49
    v_cvt_pk_bf16_f32 v47, v48, v49
    s_branch phi_18_done
P2_ys:
    v_lshrrev_b32 v13, 4, v2
    v_lshlrev_b32 v13, 12, v13
    v_and_b32 v208, 15, v2
    v_lshl_add_u32 v13, v208, 4, v13
    s_lshl_b32 s64, s5, 8
    v_add_u32 v13, s64, v13
    s_lshl_b32 s64, s67, 11
    s_lshl_b32 s65, s5, 7
    s_add_u32 s64, s64, s65
    v_lshl_add_u32 v209, v208, 3, s64
    s_lshl_b32 s64, s67, 2
    s_add_u32 s64, s64, 6709248
    v_mov_b32 v215, s64
    s_branch P2_ysd
P2_yl:
    s_cmp_gt_u32 s70, 4
    s_cbranch_scc1 P2_nyl
    buffer_load_dwordx2 v[210:211], v209, s[8:11], 0 offen
    buffer_load_dword v212, v215, s[16:19], 0 offen sc1
    s_mov_b32 s69, 6447104
    buffer_load_dwordx4 v[144:147], v13, s[16:19], s69 offen sc1
    s_mov_b32 s69, 6463488
    buffer_load_dwordx4 v[148:151], v13, s[16:19], s69 offen sc1
    s_mov_b32 s69, 6479872
    buffer_load_dwordx4 v[152:155], v13, s[16:19], s69 offen sc1
    s_mov_b32 s69, 6496256
    buffer_load_dwordx4 v[156:159], v13, s[16:19], s69 offen sc1
    s_mov_b32 s69, 6512640
    buffer_load_dwordx4 v[160:163], v13, s[16:19], s69 offen sc1
    s_mov_b32 s69, 6529024
    buffer_load_dwordx4 v[164:167], v13, s[16:19], s69 offen sc1
    s_mov_b32 s69, 6545408
    buffer_load_dwordx4 v[168:171], v13, s[16:19], s69 offen sc1
    s_mov_b32 s69, 6561792
    buffer_load_dwordx4 v[172:175], v13, s[16:19], s69 offen sc1
    s_mov_b32 s69, 6578176
    buffer_load_dwordx4 v[176:179], v13, s[16:19], s69 offen sc1
    s_mov_b32 s69, 6594560
    buffer_load_dwordx4 v[180:183], v13, s[16:19], s69 offen sc1
    s_mov_b32 s69, 6610944
    buffer_load_dwordx4 v[184:187], v13, s[16:19], s69 offen sc1
    s_mov_b32 s69, 6627328
    buffer_load_dwordx4 v[188:191], v13, s[16:19], s69 offen sc1
    s_mov_b32 s69, 6643712
    buffer_load_dwordx4 v[192:195], v13, s[16:19], s69 offen sc1
    s_mov_b32 s69, 6660096
    buffer_load_dwordx4 v[196:199], v13, s[16:19], s69 offen sc1
    s_mov_b32 s69, 6676480
    buffer_load_dwordx4 v[200:203], v13, s[16:19], s69 offen sc1
    s_mov_b32 s69, 6692864
    buffer_load_dwordx4 v[204:207], v13, s[16:19], s69 offen sc1
    s_mov_b32 s47, 1
    s_branch P2_nyl
P2_y:
    s_mov_b32 s66, 0
    s_cmp_lg_u32 s47, 0
    s_cbranch_scc1 P2_ychk
P2_yre:
    buffer_load_dwordx2 v[210:211], v209, s[8:11], 0 offen
    buffer_load_dword v212, v215, s[16:19], 0 offen sc1
    s_mov_b32 s69, 6447104
    buffer_load_dwordx4 v[144:147], v13, s[16:19], s69 offen sc1
    s_mov_b32 s69, 6463488
    buffer_load_dwordx4 v[148:151], v13, s[16:19], s69 offen sc1
    s_mov_b32 s69, 6479872
    buffer_load_dwordx4 v[152:155], v13, s[16:19], s69 offen sc1
    s_mov_b32 s69, 6496256
    buffer_load_dwordx4 v[156:159], v13, s[16:19], s69 offen sc1
    s_mov_b32 s69, 6512640
    buffer_load_dwordx4 v[160:163], v13, s[16:19], s69 offen sc1
    s_mov_b32 s69, 6529024
    buffer_load_dwordx4 v[164:167], v13, s[16:19], s69 offen sc1
    s_mov_b32 s69, 6545408
    buffer_load_dwordx4 v[168:171], v13, s[16:19], s69 offen sc1
    s_mov_b32 s69, 6561792
    buffer_load_dwordx4 v[172:175], v13, s[16:19], s69 offen sc1
    s_mov_b32 s69, 6578176
    buffer_load_dwordx4 v[176:179], v13, s[16:19], s69 offen sc1
    s_mov_b32 s69, 6594560
    buffer_load_dwordx4 v[180:183], v13, s[16:19], s69 offen sc1
    s_mov_b32 s69, 6610944
    buffer_load_dwordx4 v[184:187], v13, s[16:19], s69 offen sc1
    s_mov_b32 s69, 6627328
    buffer_load_dwordx4 v[188:191], v13, s[16:19], s69 offen sc1
    s_mov_b32 s69, 6643712
    buffer_load_dwordx4 v[192:195], v13, s[16:19], s69 offen sc1
    s_mov_b32 s69, 6660096
    buffer_load_dwordx4 v[196:199], v13, s[16:19], s69 offen sc1
    s_mov_b32 s69, 6676480
    buffer_load_dwordx4 v[200:203], v13, s[16:19], s69 offen sc1
    s_mov_b32 s69, 6692864
    buffer_load_dwordx4 v[204:207], v13, s[16:19], s69 offen sc1
P2_ychk:
    s_and_b32 s64, s75, 0xffff0000
    s_xor_b32 s65, s64, 0x80000000
    s_not_b32 s69, s64
    s_and_b32 s69, s69, 0xffff0000
    s_cmp_ge_u32 s64, 0x80000000
    s_cselect_b32 s64, s65, s69
    v_mov_b32 v213, s64
    v_mul_f32 v213, s72, v213
    v_exp_f32 v213, -v213
    s_nop 0
    v_add_f32 v213, 1.0, v213
    v_rcp_f32 v213, v213
    s_nop 0
    v_cvt_pk_bf16_f32 v213, v213, v213
    v_lshlrev_b32 v213, 16, v213
    s_waitcnt vmcnt(0)
    v_sub_f32 v214, 1.0, v212
    v_cvt_pk_bf16_f32 v214, v214, v214
    v_lshlrev_b32 v214, 16, v214
    v_max3_u32 v10, v144, v145, v146
    v_max3_u32 v10, v147, v148, v10
    v_max3_u32 v10, v149, v150, v10
    v_max3_u32 v10, v151, v152, v10
    v_max3_u32 v10, v153, v154, v10
    v_max3_u32 v10, v155, v156, v10
    v_max3_u32 v10, v157, v158, v10
    v_max3_u32 v10, v159, v160, v10
    v_max3_u32 v10, v161, v162, v10
    v_max3_u32 v10, v163, v164, v10
    v_max3_u32 v10, v165, v166, v10
    v_max3_u32 v10, v167, v168, v10
    v_max3_u32 v10, v169, v170, v10
    v_max3_u32 v10, v171, v172, v10
    v_max3_u32 v10, v173, v174, v10
    v_max3_u32 v10, v175, v176, v10
    v_max3_u32 v10, v177, v178, v10
    v_max3_u32 v10, v179, v180, v10
    v_max3_u32 v10, v181, v182, v10
    v_max3_u32 v10, v183, v184, v10
    v_max3_u32 v10, v185, v186, v10
    v_max3_u32 v10, v187, v188, v10
    v_max3_u32 v10, v189, v190, v10
    v_max3_u32 v10, v191, v192, v10
    v_max3_u32 v10, v193, v194, v10
    v_max3_u32 v10, v195, v196, v10
    v_max3_u32 v10, v197, v198, v10
    v_max3_u32 v10, v199, v200, v10
    v_max3_u32 v10, v201, v202, v10
    v_max3_u32 v10, v203, v204, v10
    v_max3_u32 v10, v205, v206, v10
    v_max_u32 v10, v207, v10
    v_cmp_eq_u32 vcc, -1, v10
    s_cbranch_vccz P2_yok
    s_add_u32 s66, s66, 1
    s_cmp_ge_u32 s66, 40000
    s_cbranch_scc1 P2_yok
    s_sleep 4
    s_branch P2_yre
P2_yok:
    v_pk_add_f32 v[144:145], v[144:145], v[176:177]
    v_pk_add_f32 v[146:147], v[146:147], v[178:179]
    v_pk_add_f32 v[148:149], v[148:149], v[180:181]
    v_pk_add_f32 v[150:151], v[150:151], v[182:183]
    v_pk_add_f32 v[152:153], v[152:153], v[184:185]
    v_pk_add_f32 v[154:155], v[154:155], v[186:187]
    v_pk_add_f32 v[156:157], v[156:157], v[188:189]
    v_pk_add_f32 v[158:159], v[158:159], v[190:191]
    v_pk_add_f32 v[160:161], v[160:161], v[192:193]
    v_pk_add_f32 v[162:163], v[162:163], v[194:195]
    v_pk_add_f32 v[164:165], v[164:165], v[196:197]
    v_pk_add_f32 v[166:167], v[166:167], v[198:199]
    v_pk_add_f32 v[168:169], v[168:169], v[200:201]
    v_pk_add_f32 v[170:171], v[170:171], v[202:203]
    v_pk_add_f32 v[172:173], v[172:173], v[204:205]
    v_pk_add_f32 v[174:175], v[174:175], v[206:207]
    v_pk_add_f32 v[144:145], v[144:145], v[160:161]
    v_pk_add_f32 v[146:147], v[146:147], v[162:163]
    v_pk_add_f32 v[148:149], v[148:149], v[164:165]
    v_pk_add_f32 v[150:151], v[150:151], v[166:167]
    v_pk_add_f32 v[152:153], v[152:153], v[168:169]
    v_pk_add_f32 v[154:155], v[154:155], v[170:171]
    v_pk_add_f32 v[156:157], v[156:157], v[172:173]
    v_pk_add_f32 v[158:159], v[158:159], v[174:175]
    v_pk_add_f32 v[144:145], v[144:145], v[152:153]
    v_pk_add_f32 v[146:147], v[146:147], v[154:155]
    v_pk_add_f32 v[148:149], v[148:149], v[156:157]
    v_pk_add_f32 v[150:151], v[150:151], v[158:159]
    v_pk_add_f32 v[144:145], v[144:145], v[148:149]
    v_pk_add_f32 v[146:147], v[146:147], v[150:151]
    v_mov_b32 v148, v144
    v_mov_b32 v149, v145
    v_mov_b32 v150, v146
    v_mov_b32 v151, v147
    s_nop 0
    v_permlane16_swap_b32 v144, v148
    v_permlane16_swap_b32 v145, v149
    v_permlane16_swap_b32 v146, v150
    v_permlane16_swap_b32 v147, v151
    v_add_f32 v144, v144, v148
    v_add_f32 v145, v145, v149
    v_add_f32 v146, v146, v150
    v_add_f32 v147, v147, v151
    v_mov_b32 v148, v144
    v_mov_b32 v149, v145
    v_mov_b32 v150, v146
    v_mov_b32 v151, v147
    s_nop 0
    v_permlane32_swap_b32 v144, v148
    v_permlane32_swap_b32 v145, v149
    v_permlane32_swap_b32 v146, v150
    v_permlane32_swap_b32 v147, v151
    v_add_f32 v144, v144, v148
    v_add_f32 v145, v145, v149
    v_add_f32 v146, v146, v150
    v_add_f32 v147, v147, v151
    v_cvt_pk_bf16_f32 v152, v144, v145
    v_lshlrev_b32 v144, 16, v152
    v_and_b32 v145, 0xffff0000, v152
    v_mul_f32 v144, v144, v213
    v_mul_f32 v145, v145, v213
    v_cvt_pk_bf16_f32 v152, v144, v145
    v_lshlrev_b32 v144, 16, v152
    v_and_b32 v145, 0xffff0000, v152
    v_lshlrev_b32 v148, 16, v210
    v_and_b32 v149, 0xffff0000, v210
    v_add_f32 v144, v148, v144
    v_add_f32 v145, v149, v145
    v_cvt_pk_bf16_f32 v152, v144, v145
    v_lshlrev_b32 v144, 16, v152
    v_and_b32 v145, 0xffff0000, v152
    v_mul_f32 v144, v144, v214
    v_mul_f32 v145, v145, v214
    v_cvt_pk_bf16_f32 v152, v144, v145
    v_lshlrev_b32 v144, 16, v152
    v_and_b32 v145, 0xffff0000, v152
    v_cvt_pk_bf16_f32 v152, v146, v147
    v_lshlrev_b32 v146, 16, v152
    v_and_b32 v147, 0xffff0000, v152
    v_mul_f32 v146, v146, v213
    v_mul_f32 v147, v147, v213
    v_cvt_pk_bf16_f32 v152, v146, v147
    v_lshlrev_b32 v146, 16, v152
    v_and_b32 v147, 0xffff0000, v152
    v_lshlrev_b32 v150, 16, v211
    v_and_b32 v151, 0xffff0000, v211
    v_add_f32 v146, v150, v146
    v_add_f32 v147, v151, v147
    v_cvt_pk_bf16_f32 v152, v146, v147
    v_lshlrev_b32 v146, 16, v152
    v_and_b32 v147, 0xffff0000, v152
    v_mul_f32 v146, v146, v214
    v_mul_f32 v147, v147, v214
    v_cvt_pk_bf16_f32 v152, v146, v147
    v_lshlrev_b32 v146, 16, v152
    v_and_b32 v147, 0xffff0000, v152
    v_lshlrev_b32 v208, 4, v208
    ds_write_b128 v208, v[144:147] offset:5632
    s_waitcnt lgkmcnt(0)
    s_branch P2_ny
P2_fix:
    s_mov_b64 exec, s[70:71]
    ds_read_b128 v[232:235], v9 offset:5632
    ds_read_b128 v[236:239], v9 offset:5648
    ds_read_b128 v[240:243], v9 offset:5760
    ds_read_b128 v[244:247], v9 offset:5776
    s_mov_b64 exec, -1
    s_branch P2_nr
CODE_END:
.section .rodata,"a"
.p2align 6
.amdhsa_kernel gated_mix__linear_attn_block__moe_arch_mod__prompt_kernel
  .amdhsa_next_free_vgpr 256
  .amdhsa_next_free_sgpr 102
  .amdhsa_accum_offset 256
  .amdhsa_group_segment_fixed_size 0
  .amdhsa_kernarg_size 96
  .amdhsa_user_sgpr_count 2
  .amdhsa_user_sgpr_kernarg_segment_ptr 1
  .amdhsa_system_sgpr_workgroup_id_x 1
.end_amdhsa_kernel
```

```asm
; @launch grid=(256,1,1) block=(512,1,1) lds=163840
.amdgcn_target "amdgcn-amd-amdhsa--gfx950"
.text
.globl gated_mix__linear_attn_block__moe_arch_mod__prompt_kernel
.p2align 8
.type gated_mix__linear_attn_block__moe_arch_mod__prompt_kernel,@function
gated_mix__linear_attn_block__moe_arch_mod__prompt_kernel:
    s_load_dwordx16 s[40:55], s[0:1], 0
    s_load_dwordx8 s[56:63], s[0:1], 64
    s_cmp_ge_u32 s2, 256
    s_cbranch_scc1 K_end
    v_lshrrev_b32 v1, 6, v0
    v_and_b32 v2, 63, v0
    s_and_b32 s6, s2, 7
    v_readfirstlane_b32 s3, v1
    s_lshr_b32 s7, s2, 3
    s_and_b32 s4, s6, 1
    s_lshl_b32 s4, s4, 3
    s_and_b32 s64, s7, 7
    s_add_u32 s4, s4, s64
    s_lshr_b32 s5, s6, 1
    s_lshl_b32 s5, s5, 2
    s_lshr_b32 s64, s7, 3
    s_add_u32 s5, s5, s64
    s_and_b32 s74, s4, 3
    s_lshl_b32 s74, s74, 2
    s_add_u32 s74, s74, s6
    v_lshrrev_b32 v6, 3, v2
    s_lshl_b32 s65, s3, 3
    v_add_u32 v6, s65, v6
    s_lshl_b32 s64, s4, 7
    v_add_u32 v7, s64, v6
    v_lshlrev_b32 v7, 11, v7
    v_lshrrev_b32 v8, 4, v2
    s_and_b32 s64, s3, 1
    s_lshl_b32 s64, s64, 2
    v_add_u32 v9, s64, v8
    v_and_b32 v10, 7, v2
    v_xor_b32 v9, v9, v10
    v_lshl_add_u32 v7, v9, 4, v7
    v_mul_u32_u24 v6, 6144, v6
    v_and_b32 v9, 1, v8
    s_lshr_b32 s64, s64, 1
    v_lshl_add_u32 v9, v9, 2, s64
    v_xor_b32 v9, v9, v10
    v_lshl_add_u32 v6, v9, 4, v6
    s_lshl_b32 s64, s5, 7
    v_add_u32 v6, s64, v6
    s_lshl_b32 s66, s3, 10
    s_mov_b32 s10, 4194304
    s_mov_b32 s11, 0x00020000
    s_mov_b32 s14, 6291456
    s_mov_b32 s15, 0x00020000
    s_add_u32 s65, s74, 0
    s_and_b32 s65, s65, 15
    s_lshl_b32 s67, s65, 7
    s_mul_i32 s65, s65, 393216
    s_waitcnt lgkmcnt(0)
    s_mov_b32 s8, s40
    s_mov_b32 s9, s41
    s_mov_b32 s12, s42
    s_mov_b32 s13, s43
    s_add_u32 m0, s66, 8192
    s_add_u32 s64, s67, 0
    buffer_load_dwordx4 v7, s[8:11], s64 offen lds
    s_add_u32 m0, s66, 16384
    s_add_u32 s64, s67, 131072
    buffer_load_dwordx4 v7, s[8:11], s64 offen lds
    s_add_u32 m0, s66, 24576
    s_add_u32 s64, s65, 0
    buffer_load_dwordx4 v6, s[12:15], s64 offen lds
    s_add_u32 m0, s66, 32768
    s_add_u32 s64, s65, 2048
    buffer_load_dwordx4 v6, s[12:15], s64 offen lds
    s_add_u32 m0, s66, 40960
    s_add_u32 s64, s65, 4096
    buffer_load_dwordx4 v6, s[12:15], s64 offen lds
    s_cmp_lt_u32 s3, 4
    s_cbranch_scc1 K_nt
    s_lshl_b32 s64, s2, 2
    s_add_u32 s64, s64, s3
    s_sub_u32 s64, s64, 4
    s_mul_i32 s64, s64, 6144
    s_add_u32 s46, s12, s64
    s_addc_u32 s47, s13, 0
    s_load_dword s43, s[46:47], 384
    s_load_dword s43, s[46:47], 448
    s_load_dword s43, s[46:47], 1408
    s_load_dword s43, s[46:47], 1472
    s_load_dword s43, s[46:47], 2432
    s_load_dword s43, s[46:47], 2496
    s_load_dword s43, s[46:47], 3456
    s_load_dword s43, s[46:47], 3520
    s_load_dword s43, s[46:47], 4480
    s_load_dword s43, s[46:47], 4544
    s_load_dword s43, s[46:47], 5504
    s_load_dword s43, s[46:47], 5568
K_nt:
    s_barrier
    s_mov_b32 s72, 0x3fb8aa3b
    s_mov_b32 s73, 0x358637bd
    s_mov_b32 s16, s62
    s_mov_b32 s17, s63
    s_mov_b32 s18, 0x10000000
    s_mov_b32 s19, 0x00020000
    s_cmp_lt_u32 s3, 4
    s_cbranch_scc1 C_start
    s_sub_u32 s6, s3, 4
    s_lshl_b32 s7, s6, 10
    v_lshrrev_b32 v6, 3, v2
    s_lshl_b32 s64, s4, 7
    s_lshl_b32 s65, s6, 3
    s_add_u32 s64, s64, s65
    v_add_u32 v7, s64, v6
    v_lshlrev_b32 v7, 11, v7
    s_and_b32 s64, s6, 1
    s_lshl_b32 s64, s64, 2
    v_add_u32 v9, s64, v8
    v_xor_b32 v9, v9, v10
    v_lshl_add_u32 v4, v9, 4, v7
    v_add_u32 v7, s65, v6
    v_mul_u32_u24 v7, 6144, v7
    v_and_b32 v9, 1, v8
    s_lshr_b32 s64, s64, 1
    v_lshl_add_u32 v9, v9, 2, s64
    v_xor_b32 v9, v9, v10
    v_lshl_add_u32 v7, v9, 4, v7
    s_lshl_b32 s64, s5, 7
    v_add_u32 v5, s64, v7
    v_lshlrev_b32 v6, 4, v2
    s_and_b32 s64, s2, 1
    s_lshl_b32 s68, s64, 10
    s_bfe_u32 s64, s2, 0x20001
    s_lshl_b32 s64, s64, 8
    s_add_u32 s68, s68, s64
    s_and_b32 s64, s2, 0xf8
    s_add_u32 s68, s68, s64
    s_lshl_b32 s64, s6, 1
    s_add_u32 s68, s68, s64
    s_lshl_b32 s64, s68, 11
    v_add_u32 v13, s64, v6
    s_add_u32 s41, s74, 1
    s_and_b32 s41, s41, 15
    s_lshl_b32 s42, s41, 7
    s_mul_i32 s41, s41, 393216
    s_add_u32 m0, s7, 49152
    s_add_u32 s40, s42, 0
    buffer_load_dwordx4 v4, s[8:11], s40 offen lds
    s_add_u32 m0, s7, 53248
    s_add_u32 s40, s42, 65536
    buffer_load_dwordx4 v4, s[8:11], s40 offen lds
    s_add_u32 m0, s7, 57344
    s_add_u32 s40, s42, 131072
    buffer_load_dwordx4 v4, s[8:11], s40 offen lds
    s_add_u32 m0, s7, 61440
    s_add_u32 s40, s42, 196608
    buffer_load_dwordx4 v4, s[8:11], s40 offen lds
    s_add_u32 m0, s7, 65536
    s_add_u32 s40, s41, 0
    buffer_load_dwordx4 v5, s[12:15], s40 offen lds
    s_add_u32 m0, s7, 69632
    s_add_u32 s40, s41, 196608
    buffer_load_dwordx4 v5, s[12:15], s40 offen lds
    s_add_u32 m0, s7, 73728
    s_add_u32 s40, s41, 2048
    buffer_load_dwordx4 v5, s[12:15], s40 offen lds
    s_add_u32 m0, s7, 77824
    s_add_u32 s40, s41, 198656
    buffer_load_dwordx4 v5, s[12:15], s40 offen lds
    s_add_u32 m0, s7, 81920
    s_add_u32 s40, s41, 4096
    buffer_load_dwordx4 v5, s[12:15], s40 offen lds
    s_add_u32 m0, s7, 86016
    s_add_u32 s40, s41, 200704
    buffer_load_dwordx4 v5, s[12:15], s40 offen lds
    s_mov_b32 s32, s50
    s_mov_b32 s33, s51
    s_mov_b32 s34, 0x700000
    s_mov_b32 s35, 0x00020000
    s_mov_b32 s36, s52
    s_mov_b32 s37, s53
    s_mov_b32 s38, 0x700000
    s_mov_b32 s39, 0x00020000
    s_or_b32 s64, s2, s6
    s_cmp_lg_u32 s64, 0
    s_cbranch_scc1 H_nn
    s_mov_b32 s64, 6717440
    s_load_dwordx2 s[66:67], s[62:63], s64
    s_mov_b32 s20, s60
    s_mov_b32 s21, s61
    s_mov_b32 s22, 0x100
    s_mov_b32 s23, 0x00020000
    s_waitcnt lgkmcnt(0)
    s_xor_b32 s64, s66, s67
    s_add_u32 s64, s64, 1
    s_max_u32 s64, s64, 1
    v_mov_b32 v72, s64
    v_mov_b32 v73, 0
    s_mov_b64 exec, 1
    buffer_store_dword v72, v73, s[20:23], 0 offen sc0 sc1
    s_mov_b64 exec, -1
H_nn:
    s_mov_b32 s20, s60
    s_mov_b32 s21, s61
    s_mov_b32 s22, 0x100
    s_mov_b32 s23, 0x00020000
    s_mov_b32 s24, s48
    s_mov_b32 s25, s49
    s_mov_b32 s26, 0x800
    s_mov_b32 s27, 0x00020000
    s_mov_b32 s28, s56
    s_mov_b32 s29, s57
    s_mov_b32 s30, 0x800
    s_mov_b32 s31, 0x00020000
    s_lshr_b32 s69, s2, 3
    s_and_b32 s64, s2, 7
    v_and_b32 v9, 15, v2
    v_min_u32 v9, 13, v9
    s_lshl_b32 s65, s69, 5
    v_lshl_add_u32 v7, v8, 3, s65
    v_mul_u32_u24 v7, 7168, v7
    s_mul_i32 s65, s64, 896
    s_mul_i32 s66, s6, 224
    s_add_u32 s65, s65, s66
    v_lshl_add_u32 v7, v9, 4, v7
    v_add_u32 v11, s65, v7
    v_cmp_le_u32 vcc, 7, v9
    v_mov_b32 v15, 16160
    s_nop 0
    v_cndmask_b32 v7, 0, v15, vcc
    v_lshl_add_u32 v7, v9, 5, v7
    v_lshrrev_b32 v15, 1, v8
    v_lshl_add_u32 v7, v15, 13, v7
    v_and_b32 v15, 1, v8
    v_lshl_add_u32 v7, v15, 4, v7
    s_lshl_b32 s64, s64, 17
    s_lshl_b32 s65, s6, 15
    s_add_u32 s64, s64, s65
    s_lshl_b32 s65, s69, 8
    s_add_u32 s64, s64, s65
    s_add_u32 s64, s64, 5398528
    v_add_u32 v12, s64, v7
    s_lshl_b32 s70, s5, 2
    s_add_u32 s70, s70, s6
    s_mul_i32 s70, s70, 18432
    s_add_u32 s70, s70, 4194304
    s_mul_i32 s64, s4, 1152
    s_add_u32 s64, s64, s70
    s_mov_b32 s67, s64
    v_lshl_add_u32 v15, v2, 2, s64
    v_add_u32 v15, 960, v15
    s_lshl_b32 s64, s5, 2
    s_add_u32 s64, s64, s6
    s_lshl_b32 s64, s64, 7
    s_add_u32 s64, s64, 5373952
    v_mov_b32 v23, s64
    s_lshl_b32 s65, s4, 10
    s_add_u32 s65, s65, 5382016
    v_lshl_add_u32 v20, v2, 7, s65
    v_cmp_gt_u32 vcc, 16, v2
    s_nop 1
    v_cndmask_b32 v15, v15, v20, vcc
    v_writelane_b32 v15, s64, 0
    s_cmp_eq_u32 s4, 0
    s_cselect_b32 s75, 1, 0
    s_or_b32 s64, s5, s6
    s_cmp_eq_u32 s64, 0
    s_cselect_b32 s64, 0x1fe, 0
    s_or_b32 s75, s75, s64
    s_or_b32 s75, s75, 0xffff0000
    v_add_u32 v22, s67, v6
    v_mov_b32 v16, -1
    v_mov_b32 v17, -1
    v_mov_b32 v18, -1
    v_mov_b32 v19, -1
    v_cndmask_b32 v20, -1, 0, vcc
    s_waitcnt vmcnt(10)
    s_barrier
    s_add_u32 s41, s74, 2
    s_and_b32 s41, s41, 15
    s_lshl_b32 s42, s41, 7
    s_mul_i32 s41, s41, 393216
    s_add_u32 m0, s7, 90112
    s_add_u32 s40, s42, 0
    buffer_load_dwordx4 v4, s[8:11], s40 offen lds
    s_add_u32 m0, s7, 94208
    s_add_u32 s40, s42, 65536
    buffer_load_dwordx4 v4, s[8:11], s40 offen lds
    s_add_u32 m0, s7, 98304
    s_add_u32 s40, s42, 131072
    buffer_load_dwordx4 v4, s[8:11], s40 offen lds
    s_add_u32 m0, s7, 102400
    s_add_u32 s40, s42, 196608
    buffer_load_dwordx4 v4, s[8:11], s40 offen lds
    s_add_u32 m0, s7, 106496
    s_add_u32 s40, s41, 0
    buffer_load_dwordx4 v5, s[12:15], s40 offen lds
    s_add_u32 m0, s7, 110592
    s_add_u32 s40, s41, 196608
    buffer_load_dwordx4 v5, s[12:15], s40 offen lds
    s_add_u32 m0, s7, 114688
    s_add_u32 s40, s41, 2048
    buffer_load_dwordx4 v5, s[12:15], s40 offen lds
    s_add_u32 m0, s7, 118784
    s_add_u32 s40, s41, 198656
    buffer_load_dwordx4 v5, s[12:15], s40 offen lds
    s_add_u32 m0, s7, 122880
    s_add_u32 s40, s41, 4096
    buffer_load_dwordx4 v5, s[12:15], s40 offen lds
    s_add_u32 m0, s7, 126976
    s_add_u32 s40, s41, 200704
    buffer_load_dwordx4 v5, s[12:15], s40 offen lds
    buffer_load_dwordx4 v[24:27], v13, s[8:11], 0 offen offset:0
    buffer_load_dwordx4 v[28:31], v13, s[8:11], 0 offen offset:1024
    buffer_load_dwordx4 v[32:35], v13, s[8:11], 0 offen offset:2048
    buffer_load_dwordx4 v[36:39], v13, s[8:11], 0 offen offset:3072
    s_cmp_lt_u32 s6, 2
    s_cselect_b32 s24, s48, s56
    s_cselect_b32 s25, s49, s57
    s_and_b32 s64, s7, 1024
    s_add_u32 m0, s7, 0
    s_nop 0
    buffer_load_dwordx4 v6, s[24:27], s64 offen lds
    s_waitcnt vmcnt(15)
    s_barrier
    s_add_u32 s41, s74, 3
    s_and_b32 s41, s41, 15
    s_lshl_b32 s42, s41, 7
    s_mul_i32 s41, s41, 393216
    s_add_u32 m0, s7, 8192
    s_add_u32 s40, s42, 0
    buffer_load_dwordx4 v4, s[8:11], s40 offen lds
    s_add_u32 m0, s7, 12288
    s_add_u32 s40, s42, 65536
    buffer_load_dwordx4 v4, s[8:11], s40 offen lds
    s_add_u32 m0, s7, 16384
    s_add_u32 s40, s42, 131072
    buffer_load_dwordx4 v4, s[8:11], s40 offen lds
    s_add_u32 m0, s7, 20480
    s_add_u32 s40, s42, 196608
    buffer_load_dwordx4 v4, s[8:11], s40 offen lds
    s_add_u32 m0, s7, 24576
    s_add_u32 s40, s41, 0
    buffer_load_dwordx4 v5, s[12:15], s40 offen lds
    s_add_u32 m0, s7, 28672
    s_add_u32 s40, s41, 196608
    buffer_load_dwordx4 v5, s[12:15], s40 offen lds
    s_add_u32 m0, s7, 32768
    s_add_u32 s40, s41, 2048
    buffer_load_dwordx4 v5, s[12:15], s40 offen lds
    s_add_u32 m0, s7, 36864
    s_add_u32 s40, s41, 198656
    buffer_load_dwordx4 v5, s[12:15], s40 offen lds
    s_add_u32 m0, s7, 40960
    s_add_u32 s40, s41, 4096
    buffer_load_dwordx4 v5, s[12:15], s40 offen lds
    s_add_u32 m0, s7, 45056
    s_add_u32 s40, s41, 200704
    buffer_load_dwordx4 v5, s[12:15], s40 offen lds
    buffer_store_dwordx4 v[16:19], v22, s[16:19], 0 offen sc0 sc1
    s_mov_b32 exec_lo, s75
    s_mov_b32 exec_hi, 0
    buffer_store_dword v20, v15, s[16:19], 0 offen sc0 sc1
    s_mov_b32 exec_lo, 0x3fff3fff
    s_mov_b32 exec_hi, 0x3fff3fff
    buffer_store_dwordx4 v[16:19], v12, s[16:19], 0 offen sc0 sc1
    s_mov_b64 exec, 0xffff
    s_lshl_b32 s64, s2, 10
    s_lshl_b32 s65, s6, 8
    s_add_u32 s64, s64, s65
    s_add_u32 s64, s64, 6447104
    buffer_store_dwordx4 v[16:19], v6, s[16:19], s64 offen sc0 sc1
    s_mov_b64 exec, -1
    s_waitcnt vmcnt(19)
    s_barrier
    v_mov_b32 v79, 0
    s_cmp_lg_u32 s6, 0
    s_cbranch_scc1 H_nc
    buffer_load_dword v78, v79, s[20:23], 0 offen sc1
H_nc:
    s_add_u32 s41, s74, 4
    s_and_b32 s41, s41, 15
    s_lshl_b32 s42, s41, 7
    s_mul_i32 s41, s41, 393216
    s_add_u32 m0, s7, 49152
    s_add_u32 s40, s42, 0
    buffer_load_dwordx4 v4, s[8:11], s40 offen lds
    s_add_u32 m0, s7, 53248
    s_add_u32 s40, s42, 65536
    buffer_load_dwordx4 v4, s[8:11], s40 offen lds
    s_add_u32 m0, s7, 57344
    s_add_u32 s40, s42, 131072
    buffer_load_dwordx4 v4, s[8:11], s40 offen lds
    s_add_u32 m0, s7, 61440
    s_add_u32 s40, s42, 196608
    buffer_load_dwordx4 v4, s[8:11], s40 offen lds
    s_add_u32 m0, s7, 65536
    s_add_u32 s40, s41, 0
    buffer_load_dwordx4 v5, s[12:15], s40 offen lds
    s_add_u32 m0, s7, 69632
    s_add_u32 s40, s41, 196608
    buffer_load_dwordx4 v5, s[12:15], s40 offen lds
    s_add_u32 m0, s7, 73728
    s_add_u32 s40, s41, 2048
    buffer_load_dwordx4 v5, s[12:15], s40 offen lds
    s_add_u32 m0, s7, 77824
    s_add_u32 s40, s41, 198656
    buffer_load_dwordx4 v5, s[12:15], s40 offen lds
    s_add_u32 m0, s7, 81920
    s_add_u32 s40, s41, 4096
    buffer_load_dwordx4 v5, s[12:15], s40 offen lds
    s_add_u32 m0, s7, 86016
    s_add_u32 s40, s41, 200704
    buffer_load_dwordx4 v5, s[12:15], s40 offen lds
    s_waitcnt vmcnt(14)
    s_barrier
    ds_read_b128 v[40:43], v6 offset:0
    ds_read_b128 v[44:47], v6 offset:1024
    ds_read_b128 v[48:51], v6 offset:2048
    ds_read_b128 v[52:55], v6 offset:3072
    s_add_u32 s41, s74, 5
    s_and_b32 s41, s41, 15
    s_lshl_b32 s42, s41, 7
    s_mul_i32 s41, s41, 393216
    s_add_u32 m0, s7, 90112
    s_add_u32 s40, s42, 0
    buffer_load_dwordx4 v4, s[8:11], s40 offen lds
    s_waitcnt lgkmcnt(0)
    s_add_u32 m0, s7, 94208
    s_add_u32 s40, s42, 65536
    buffer_load_dwordx4 v4, s[8:11], s40 offen lds
    v_dot2_f32_bf16 v72, v24, v48, 0
    v_dot2_f32_bf16 v73, v32, v48, 0
    v_dot2_f32_bf16 v74, v24, v40, 0
    v_dot2_f32_bf16 v75, v32, v40, 0
    s_add_u32 m0, s7, 98304
    s_add_u32 s40, s42, 131072
    buffer_load_dwordx4 v4, s[8:11], s40 offen lds
    v_dot2_f32_bf16 v72, v25, v49, v72
    v_dot2_f32_bf16 v73, v33, v49, v73
    v_dot2_f32_bf16 v74, v25, v41, v74
    v_dot2_f32_bf16 v75, v33, v41, v75
    s_add_u32 m0, s7, 102400
    s_add_u32 s40, s42, 196608
    buffer_load_dwordx4 v4, s[8:11], s40 offen lds
    v_dot2_f32_bf16 v72, v26, v50, v72
    v_dot2_f32_bf16 v73, v34, v50, v73
    v_dot2_f32_bf16 v74, v26, v42, v74
    v_dot2_f32_bf16 v75, v34, v42, v75
    s_add_u32 m0, s7, 106496
    s_add_u32 s40, s41, 0
    buffer_load_dwordx4 v5, s[12:15], s40 offen lds
    v_dot2_f32_bf16 v72, v27, v51, v72
    v_dot2_f32_bf16 v73, v35, v51, v73
    v_dot2_f32_bf16 v74, v27, v43, v74
    v_dot2_f32_bf16 v75, v35, v43, v75
    s_add_u32 m0, s7, 110592
    s_add_u32 s40, s41, 196608
    buffer_load_dwordx4 v5, s[12:15], s40 offen lds
    v_dot2_f32_bf16 v72, v28, v52, v72
    v_dot2_f32_bf16 v73, v36, v52, v73
    v_dot2_f32_bf16 v74, v28, v44, v74
    v_dot2_f32_bf16 v75, v36, v44, v75
    s_add_u32 m0, s7, 114688
    s_add_u32 s40, s41, 2048
    buffer_load_dwordx4 v5, s[12:15], s40 offen lds
    v_dot2_f32_bf16 v72, v29, v53, v72
    v_dot2_f32_bf16 v73, v37, v53, v73
    v_dot2_f32_bf16 v74, v29, v45, v74
    v_dot2_f32_bf16 v75, v37, v45, v75
    s_add_u32 m0, s7, 118784
    s_add_u32 s40, s41, 198656
    buffer_load_dwordx4 v5, s[12:15], s40 offen lds
    v_dot2_f32_bf16 v72, v30, v54, v72
    v_dot2_f32_bf16 v73, v38, v54, v73
    v_dot2_f32_bf16 v74, v30, v46, v74
    v_dot2_f32_bf16 v75, v38, v46, v75
    s_add_u32 m0, s7, 122880
    s_add_u32 s40, s41, 4096
    buffer_load_dwordx4 v5, s[12:15], s40 offen lds
    v_dot2_f32_bf16 v72, v31, v55, v72
    v_dot2_f32_bf16 v73, v39, v55, v73
    v_dot2_f32_bf16 v74, v31, v47, v74
    v_dot2_f32_bf16 v75, v39, v47, v75
    s_add_u32 m0, s7, 126976
    s_add_u32 s40, s41, 200704
    buffer_load_dwordx4 v5, s[12:15], s40 offen lds
    s_waitcnt vmcnt(10)
    s_barrier
    s_add_u32 s41, s74, 6
    s_and_b32 s41, s41, 15
    s_lshl_b32 s42, s41, 7
    s_mul_i32 s41, s41, 393216
    s_add_u32 m0, s7, 8192
    s_add_u32 s40, s42, 0
    buffer_load_dwordx4 v4, s[8:11], s40 offen lds
    v_permlane32_swap_b32 v72, v74
    v_permlane32_swap_b32 v73, v75
    v_add_f32 v72, v72, v74
    v_add_f32 v73, v73, v75
    s_add_u32 m0, s7, 12288
    s_add_u32 s40, s42, 65536
    buffer_load_dwordx4 v4, s[8:11], s40 offen lds
    s_lshl_b32 s64, s68, 2
    s_add_u32 s64, s64, 6709248
    v_permlane16_swap_b32 v72, v73
    v_add_f32 v72, v72, v73
    s_add_u32 m0, s7, 16384
    s_add_u32 s40, s42, 131072
    buffer_load_dwordx4 v4, s[8:11], s40 offen lds
    v_and_b32 v75, 1, v8
    v_lshl_add_u32 v76, v75, 2, s64
    v_add_f32_dpp v72, v72, v72 quad_perm:[1,0,3,2] row_mask:0xf bank_mask:0xf
    s_nop 1
    s_add_u32 m0, s7, 20480
    s_add_u32 s40, s42, 196608
    buffer_load_dwordx4 v4, s[8:11], s40 offen lds
    v_add_f32_dpp v72, v72, v72 quad_perm:[2,3,0,1] row_mask:0xf bank_mask:0xf
    s_nop 1
    v_add_f32_dpp v72, v72, v72 row_half_mirror row_mask:0xf bank_mask:0xf
    s_nop 1
    s_add_u32 m0, s7, 24576
    s_add_u32 s40, s41, 0
    buffer_load_dwordx4 v5, s[12:15], s40 offen lds
    v_add_f32_dpp v72, v72, v72 row_mirror row_mask:0xf bank_mask:0xf
    s_nop 1
    v_cvt_pk_bf16_f32 v72, v72, v72
    s_sub_u32 s64, 34815, s68
    s_add_u32 m0, s7, 28672
    s_add_u32 s40, s41, 196608
    buffer_load_dwordx4 v5, s[12:15], s40 offen lds
    v_lshlrev_b32 v72, 16, v72
    v_ashrrev_i32 v73, 31, v72
    v_sub_u32 v77, s64, v75
    v_or_b32 v73, 0x80000000, v73
    s_add_u32 m0, s7, 32768
    s_add_u32 s40, s41, 2048
    buffer_load_dwordx4 v5, s[12:15], s40 offen lds
    s_lshl_b32 s64, s6, 3
    v_xor_b32 v73, v72, v73
    v_lshl_add_u32 v75, v75, 2, s64
    v_and_b32 v73, 0xffff0000, v73
    s_add_u32 m0, s7, 36864
    s_add_u32 s40, s41, 198656
    buffer_load_dwordx4 v5, s[12:15], s40 offen lds
    v_or_b32 v73, v77, v73
    v_mul_f32 v72, s72, v72
    v_exp_f32 v72, -v72
    s_nop 0
    s_add_u32 m0, s7, 40960
    s_add_u32 s40, s41, 4096
    buffer_load_dwordx4 v5, s[12:15], s40 offen lds
    v_add_f32 v72, 1.0, v72
    v_rcp_f32 v72, v72
    s_nop 0
    v_cvt_pk_bf16_f32 v72, v72, v72
    s_add_u32 m0, s7, 45056
    s_add_u32 s40, s41, 200704
    buffer_load_dwordx4 v5, s[12:15], s40 offen lds
    v_lshlrev_b32 v72, 16, v72
    s_mov_b32 exec_lo, 0
    s_mov_b32 exec_hi, 0x10001
    ds_write_b32 v75, v73 offset:4224
    s_mov_b32 exec_lo, 0x10001
    s_mov_b32 exec_hi, 0
    buffer_store_dword v72, v76, s[16:19], 0 offen sc0 sc1
    s_mov_b64 exec, -1
    s_mov_b32 exec_lo, 0x3fff3fff
    s_mov_b32 exec_hi, 0x3fff3fff
    s_mov_b32 s64, 0
    buffer_load_dwordx4 v[96:99], v11, s[32:35], s64 offen nt
    s_mov_b32 s64, 0
    buffer_load_dwordx4 v[128:131], v11, s[36:39], s64 offen nt
    s_mov_b32 s64, 7168
    buffer_load_dwordx4 v[100:103], v11, s[32:35], s64 offen nt
    s_mov_b32 s64, 7168
    buffer_load_dwordx4 v[132:135], v11, s[36:39], s64 offen nt
    s_mov_b32 s64, 14336
    buffer_load_dwordx4 v[104:107], v11, s[32:35], s64 offen nt
    s_mov_b64 exec, -1
    s_waitcnt vmcnt(16)
    s_waitcnt lgkmcnt(0)
    s_barrier
    s_add_u32 s41, s74, 7
    s_and_b32 s41, s41, 15
    s_lshl_b32 s42, s41, 7
    s_mul_i32 s41, s41, 393216
    s_add_u32 m0, s7, 49152
    s_add_u32 s40, s42, 0
    buffer_load_dwordx4 v4, s[8:11], s40 offen lds
    s_add_u32 m0, s7, 53248
    s_add_u32 s40, s42, 65536
    buffer_load_dwordx4 v4, s[8:11], s40 offen lds
    s_add_u32 m0, s7, 57344
    s_add_u32 s40, s42, 131072
    buffer_load_dwordx4 v4, s[8:11], s40 offen lds
    s_add_u32 m0, s7, 61440
    s_add_u32 s40, s42, 196608
    buffer_load_dwordx4 v4, s[8:11], s40 offen lds
    s_add_u32 m0, s7, 65536
    s_add_u32 s40, s41, 0
    buffer_load_dwordx4 v5, s[12:15], s40 offen lds
    s_add_u32 m0, s7, 69632
    s_add_u32 s40, s41, 196608
    buffer_load_dwordx4 v5, s[12:15], s40 offen lds
    s_add_u32 m0, s7, 73728
    s_add_u32 s40, s41, 2048
    buffer_load_dwordx4 v5, s[12:15], s40 offen lds
    s_add_u32 m0, s7, 77824
    s_add_u32 s40, s41, 198656
    buffer_load_dwordx4 v5, s[12:15], s40 offen lds
    s_add_u32 m0, s7, 81920
    s_add_u32 s40, s41, 4096
    buffer_load_dwordx4 v5, s[12:15], s40 offen lds
    s_add_u32 m0, s7, 86016
    s_add_u32 s40, s41, 200704
    buffer_load_dwordx4 v5, s[12:15], s40 offen lds
    s_waitcnt vmcnt(16)
    s_barrier
    s_add_u32 s41, s74, 8
    s_and_b32 s41, s41, 15
    s_lshl_b32 s42, s41, 7
    s_mul_i32 s41, s41, 393216
    s_add_u32 m0, s7, 90112
    s_add_u32 s40, s42, 0
    buffer_load_dwordx4 v4, s[8:11], s40 offen lds
    s_add_u32 m0, s7, 94208
    s_add_u32 s40, s42, 65536
    buffer_load_dwordx4 v4, s[8:11], s40 offen lds
    s_add_u32 m0, s7, 98304
    s_add_u32 s40, s42, 131072
    buffer_load_dwordx4 v4, s[8:11], s40 offen lds
    s_add_u32 m0, s7, 102400
    s_add_u32 s40, s42, 196608
    buffer_load_dwordx4 v4, s[8:11], s40 offen lds
    s_add_u32 m0, s7, 106496
    s_add_u32 s40, s41, 0
    buffer_load_dwordx4 v5, s[12:15], s40 offen lds
    s_add_u32 m0, s7, 110592
    s_add_u32 s40, s41, 196608
    buffer_load_dwordx4 v5, s[12:15], s40 offen lds
    s_add_u32 m0, s7, 114688
    s_add_u32 s40, s41, 2048
    buffer_load_dwordx4 v5, s[12:15], s40 offen lds
    s_add_u32 m0, s7, 118784
    s_add_u32 s40, s41, 198656
    buffer_load_dwordx4 v5, s[12:15], s40 offen lds
    s_add_u32 m0, s7, 122880
    s_add_u32 s40, s41, 4096
    buffer_load_dwordx4 v5, s[12:15], s40 offen lds
    s_add_u32 m0, s7, 126976
    s_add_u32 s40, s41, 200704
    buffer_load_dwordx4 v5, s[12:15], s40 offen lds
    s_waitcnt vmcnt(10)
    s_barrier
    s_add_u32 s41, s74, 9
    s_and_b32 s41, s41, 15
    s_lshl_b32 s42, s41, 7
    s_mul_i32 s41, s41, 393216
    s_add_u32 m0, s7, 8192
    s_add_u32 s40, s42, 0
    buffer_load_dwordx4 v4, s[8:11], s40 offen lds
    s_add_u32 m0, s7, 12288
    s_add_u32 s40, s42, 65536
    buffer_load_dwordx4 v4, s[8:11], s40 offen lds
    s_add_u32 m0, s7, 16384
    s_add_u32 s40, s42, 131072
    buffer_load_dwordx4 v4, s[8:11], s40 offen lds
    s_add_u32 m0, s7, 20480
    s_add_u32 s40, s42, 196608
    buffer_load_dwordx4 v4, s[8:11], s40 offen lds
    s_add_u32 m0, s7, 24576
    s_add_u32 s40, s41, 0
    buffer_load_dwordx4 v5, s[12:15], s40 offen lds
    s_add_u32 m0, s7, 28672
    s_add_u32 s40, s41, 196608
    buffer_load_dwordx4 v5, s[12:15], s40 offen lds
    s_add_u32 m0, s7, 32768
    s_add_u32 s40, s41, 2048
    buffer_load_dwordx4 v5, s[12:15], s40 offen lds
    s_add_u32 m0, s7, 36864
    s_add_u32 s40, s41, 198656
    buffer_load_dwordx4 v5, s[12:15], s40 offen lds
    s_add_u32 m0, s7, 40960
    s_add_u32 s40, s41, 4096
    buffer_load_dwordx4 v5, s[12:15], s40 offen lds
    s_add_u32 m0, s7, 45056
    s_add_u32 s40, s41, 200704
    buffer_load_dwordx4 v5, s[12:15], s40 offen lds
    s_cmp_lg_u32 s6, 0
    s_cbranch_scc1 H_nk
    v_mov_b32 v3, 4224
    ds_read_b128 v[72:75], v3
    ds_read_b128 v[24:27], v3 offset:16
    s_mov_b32 s65, 0
H_nspin:
    v_readfirstlane_b32 s71, v78
    s_cmp_eq_u32 s71, 0
    s_cbranch_scc1 H_nre
H_nok:
    s_lshl_b32 s64, s2, 3
    s_add_u32 s64, s64, 6717440
    v_mov_b32 v3, s64
    s_waitcnt lgkmcnt(0)
    v_max3_u32 v72, v72, v73, v74
    v_max3_u32 v24, v24, v25, v26
    v_max3_u32 v72, v72, v75, v27
    v_max_u32 v72, v72, v24
    v_xor_b32 v73, s71, v72
    s_mov_b64 exec, 1
    buffer_store_dwordx2 v[72:73], v3, s[16:19], 0 offen sc0 sc1
    s_mov_b64 exec, -1
H_nk:
    s_mov_b32 exec_lo, 0x3fff3fff
    s_mov_b32 exec_hi, 0x3fff3fff
    s_mov_b32 s64, 14336
    buffer_load_dwordx4 v[136:139], v11, s[36:39], s64 offen nt
    s_mov_b32 s64, 21504
    buffer_load_dwordx4 v[108:111], v11, s[32:35], s64 offen nt
    s_mov_b32 s64, 21504
    buffer_load_dwordx4 v[140:143], v11, s[36:39], s64 offen nt
    s_mov_b32 s64, 28672
    buffer_load_dwordx4 v[112:115], v11, s[32:35], s64 offen nt
    s_mov_b32 s64, 28672
    buffer_load_dwordx4 v[144:147], v11, s[36:39], s64 offen nt
    s_mov_b64 exec, -1
    s_waitcnt vmcnt(15)
    s_barrier
    s_add_u32 s41, s74, 10
    s_and_b32 s41, s41, 15
    s_lshl_b32 s42, s41, 7
    s_mul_i32 s41, s41, 393216
    s_add_u32 m0, s7, 49152
    s_add_u32 s40, s42, 0
    buffer_load_dwordx4 v4, s[8:11], s40 offen lds
    s_add_u32 m0, s7, 53248
    s_add_u32 s40, s42, 65536
    buffer_load_dwordx4 v4, s[8:11], s40 offen lds
    s_add_u32 m0, s7, 57344
    s_add_u32 s40, s42, 131072
    buffer_load_dwordx4 v4, s[8:11], s40 offen lds
    s_add_u32 m0, s7, 61440
    s_add_u32 s40, s42, 196608
    buffer_load_dwordx4 v4, s[8:11], s40 offen lds
    s_add_u32 m0, s7, 65536
    s_add_u32 s40, s41, 0
    buffer_load_dwordx4 v5, s[12:15], s40 offen lds
    s_add_u32 m0, s7, 69632
    s_add_u32 s40, s41, 196608
    buffer_load_dwordx4 v5, s[12:15], s40 offen lds
    s_add_u32 m0, s7, 73728
    s_add_u32 s40, s41, 2048
    buffer_load_dwordx4 v5, s[12:15], s40 offen lds
    s_add_u32 m0, s7, 77824
    s_add_u32 s40, s41, 198656
    buffer_load_dwordx4 v5, s[12:15], s40 offen lds
    s_add_u32 m0, s7, 81920
    s_add_u32 s40, s41, 4096
    buffer_load_dwordx4 v5, s[12:15], s40 offen lds
    s_add_u32 m0, s7, 86016
    s_add_u32 s40, s41, 200704
    buffer_load_dwordx4 v5, s[12:15], s40 offen lds
    s_lshl_b32 s64, s2, 2
    s_add_u32 s64, s64, s6
    s_mul_i32 s64, s64, 2048
    s_add_u32 s46, s44, s64
    s_addc_u32 s47, s45, 0
    s_load_dword s43, s[46:47], 384
    s_load_dword s43, s[46:47], 448
    s_load_dword s43, s[46:47], 1408
    s_load_dword s43, s[46:47], 1472
    s_waitcnt vmcnt(15)
    s_barrier
    s_add_u32 s41, s74, 11
    s_and_b32 s41, s41, 15
    s_lshl_b32 s42, s41, 7
    s_mul_i32 s41, s41, 393216
    s_add_u32 m0, s7, 90112
    s_add_u32 s40, s42, 0
    buffer_load_dwordx4 v4, s[8:11], s40 offen lds
    s_add_u32 m0, s7, 94208
    s_add_u32 s40, s42, 65536
    buffer_load_dwordx4 v4, s[8:11], s40 offen lds
    s_add_u32 m0, s7, 98304
    s_add_u32 s40, s42, 131072
    buffer_load_dwordx4 v4, s[8:11], s40 offen lds
    s_add_u32 m0, s7, 102400
    s_add_u32 s40, s42, 196608
    buffer_load_dwordx4 v4, s[8:11], s40 offen lds
    s_add_u32 m0, s7, 106496
    s_add_u32 s40, s41, 0
    buffer_load_dwordx4 v5, s[12:15], s40 offen lds
    s_add_u32 m0, s7, 110592
    s_add_u32 s40, s41, 196608
    buffer_load_dwordx4 v5, s[12:15], s40 offen lds
    s_add_u32 m0, s7, 114688
    s_add_u32 s40, s41, 2048
    buffer_load_dwordx4 v5, s[12:15], s40 offen lds
    s_add_u32 m0, s7, 118784
    s_add_u32 s40, s41, 198656
    buffer_load_dwordx4 v5, s[12:15], s40 offen lds
    s_add_u32 m0, s7, 122880
    s_add_u32 s40, s41, 4096
    buffer_load_dwordx4 v5, s[12:15], s40 offen lds
    s_add_u32 m0, s7, 126976
    s_add_u32 s40, s41, 200704
    buffer_load_dwordx4 v5, s[12:15], s40 offen lds
    s_waitcnt vmcnt(10)
    s_barrier
    s_add_u32 s41, s74, 12
    s_and_b32 s41, s41, 15
    s_lshl_b32 s42, s41, 7
    s_mul_i32 s41, s41, 393216
    s_add_u32 m0, s7, 8192
    s_add_u32 s40, s42, 0
    buffer_load_dwordx4 v4, s[8:11], s40 offen lds
    s_add_u32 m0, s7, 12288
    s_add_u32 s40, s42, 65536
    buffer_load_dwordx4 v4, s[8:11], s40 offen lds
    s_add_u32 m0, s7, 16384
    s_add_u32 s40, s42, 131072
    buffer_load_dwordx4 v4, s[8:11], s40 offen lds
    s_add_u32 m0, s7, 20480
    s_add_u32 s40, s42, 196608
    buffer_load_dwordx4 v4, s[8:11], s40 offen lds
    s_add_u32 m0, s7, 24576
    s_add_u32 s40, s41, 0
    buffer_load_dwordx4 v5, s[12:15], s40 offen lds
    s_add_u32 m0, s7, 28672
    s_add_u32 s40, s41, 196608
    buffer_load_dwordx4 v5, s[12:15], s40 offen lds
    s_add_u32 m0, s7, 32768
    s_add_u32 s40, s41, 2048
    buffer_load_dwordx4 v5, s[12:15], s40 offen lds
    s_add_u32 m0, s7, 36864
    s_add_u32 s40, s41, 198656
    buffer_load_dwordx4 v5, s[12:15], s40 offen lds
    s_add_u32 m0, s7, 40960
    s_add_u32 s40, s41, 4096
    buffer_load_dwordx4 v5, s[12:15], s40 offen lds
    s_add_u32 m0, s7, 45056
    s_add_u32 s40, s41, 200704
    buffer_load_dwordx4 v5, s[12:15], s40 offen lds
    s_mov_b32 exec_lo, 0x3fff3fff
    s_mov_b32 exec_hi, 0x3fff3fff
    s_mov_b32 s64, 35840
    buffer_load_dwordx4 v[116:119], v11, s[32:35], s64 offen nt
    s_mov_b32 s64, 35840
    buffer_load_dwordx4 v[148:151], v11, s[36:39], s64 offen nt
    s_mov_b32 s64, 43008
    buffer_load_dwordx4 v[120:123], v11, s[32:35], s64 offen nt
    s_mov_b32 s64, 43008
    buffer_load_dwordx4 v[152:155], v11, s[36:39], s64 offen nt
    s_mov_b32 s64, 50176
    buffer_load_dwordx4 v[124:127], v11, s[32:35], s64 offen nt
    s_mov_b32 s64, 50176
    buffer_load_dwordx4 v[156:159], v11, s[36:39], s64 offen nt
    s_mov_b64 exec, -1
    s_waitcnt vmcnt(16)
    s_barrier
    s_cmp_lg_u32 s6, 0
    s_cbranch_scc1 H_np
    s_mov_b32 s64, 6717440
    buffer_load_dwordx4 v[24:27], v6, s[16:19], s64 offen offset:0 sc1
    buffer_load_dwordx4 v[28:31], v6, s[16:19], s64 offen offset:1024 sc1
H_np:
    s_add_u32 s41, s74, 13
    s_and_b32 s41, s41, 15
    s_lshl_b32 s42, s41, 7
    s_mul_i32 s41, s41, 393216
    s_add_u32 m0, s7, 49152
    s_add_u32 s40, s42, 0
    buffer_load_dwordx4 v4, s[8:11], s40 offen lds
    s_add_u32 m0, s7, 53248
    s_add_u32 s40, s42, 65536
    buffer_load_dwordx4 v4, s[8:11], s40 offen lds
    s_add_u32 m0, s7, 57344
    s_add_u32 s40, s42, 131072
    buffer_load_dwordx4 v4, s[8:11], s40 offen lds
    s_add_u32 m0, s7, 61440
    s_add_u32 s40, s42, 196608
    buffer_load_dwordx4 v4, s[8:11], s40 offen lds
    s_add_u32 m0, s7, 65536
    s_add_u32 s40, s41, 0
    buffer_load_dwordx4 v5, s[12:15], s40 offen lds
    s_add_u32 m0, s7, 69632
    s_add_u32 s40, s41, 196608
    buffer_load_dwordx4 v5, s[12:15], s40 offen lds
    s_add_u32 m0, s7, 73728
    s_add_u32 s40, s41, 2048
    buffer_load_dwordx4 v5, s[12:15], s40 offen lds
    s_add_u32 m0, s7, 77824
    s_add_u32 s40, s41, 198656
    buffer_load_dwordx4 v5, s[12:15], s40 offen lds
    s_add_u32 m0, s7, 81920
    s_add_u32 s40, s41, 4096
    buffer_load_dwordx4 v5, s[12:15], s40 offen lds
    s_add_u32 m0, s7, 86016
    s_add_u32 s40, s41, 200704
    buffer_load_dwordx4 v5, s[12:15], s40 offen lds
    s_waitcnt vmcnt(16)
    s_barrier
    s_cmp_lg_u32 s6, 0
    s_cbranch_scc1 H_nq
    s_waitcnt vmcnt(10)
    s_mov_b32 s65, 0
H_spin:
    v_xor_b32 v25, v24, v25
    v_xor_b32 v27, v26, v27
    v_xor_b32 v29, v28, v29
    v_xor_b32 v31, v30, v31
    v_xor_b32 v3, s71, v25
    v_xor_b32 v7, s71, v27
    v_xor_b32 v25, s71, v29
    v_xor_b32 v27, s71, v31
    v_or3_b32 v3, v3, v7, v25
    v_or_b32 v3, v3, v27
    v_cmp_ne_u32 vcc, 0, v3
    s_cbranch_vccnz H_retry
H_nq:
    s_add_u32 s41, s74, 14
    s_and_b32 s41, s41, 15
    s_lshl_b32 s42, s41, 7
    s_mul_i32 s41, s41, 393216
    s_add_u32 m0, s7, 90112
    s_add_u32 s40, s42, 0
    buffer_load_dwordx4 v4, s[8:11], s40 offen lds
    v_max_u32 v3, v24, v26
    v_max3_u32 v3, v3, v28, v30
    s_nop 1
    v_max_u32_dpp v3, v3, v3 quad_perm:[1,0,3,2] row_mask:0xf bank_mask:0xf
    s_add_u32 m0, s7, 94208
    s_add_u32 s40, s42, 65536
    buffer_load_dwordx4 v4, s[8:11], s40 offen lds
    s_nop 1
    v_max_u32_dpp v3, v3, v3 quad_perm:[2,3,0,1] row_mask:0xf bank_mask:0xf
    s_nop 1
    v_max_u32_dpp v3, v3, v3 row_half_mirror row_mask:0xf bank_mask:0xf
    s_add_u32 m0, s7, 98304
    s_add_u32 s40, s42, 131072
    buffer_load_dwordx4 v4, s[8:11], s40 offen lds
    s_nop 1
    v_max_u32_dpp v3, v3, v3 row_mirror row_mask:0xf bank_mask:0xf
    s_nop 1
    v_mov_b32 v7, v3
    s_add_u32 m0, s7, 102400
    s_add_u32 s40, s42, 196608
    buffer_load_dwordx4 v4, s[8:11], s40 offen lds
    s_nop 1
    v_permlane16_swap_b32 v3, v7
    v_max_u32 v3, v3, v7
    v_mov_b32 v7, v3
    s_add_u32 m0, s7, 106496
    s_add_u32 s40, s41, 0
    buffer_load_dwordx4 v5, s[12:15], s40 offen lds
    s_nop 1
    v_permlane32_swap_b32 v3, v7
    v_max_u32 v3, v3, v7
    v_mov_b32 v7, 4256
    s_add_u32 m0, s7, 110592
    s_add_u32 s40, s41, 196608
    buffer_load_dwordx4 v5, s[12:15], s40 offen lds
    s_add_u32 m0, s7, 114688
    s_add_u32 s40, s41, 2048
    buffer_load_dwordx4 v5, s[12:15], s40 offen lds
    s_add_u32 m0, s7, 118784
    s_add_u32 s40, s41, 198656
    buffer_load_dwordx4 v5, s[12:15], s40 offen lds
    s_add_u32 m0, s7, 122880
    s_add_u32 s40, s41, 4096
    buffer_load_dwordx4 v5, s[12:15], s40 offen lds
    s_add_u32 m0, s7, 126976
    s_add_u32 s40, s41, 200704
    buffer_load_dwordx4 v5, s[12:15], s40 offen lds
    s_cmp_lg_u32 s6, 0
    s_cbranch_scc1 H_nw
    ds_write_b32 v7, v3
H_nw:
    s_waitcnt vmcnt(10)
    s_waitcnt lgkmcnt(0)
    s_barrier
    v_mov_b32 v7, 4256
    ds_read_b32 v3, v7
    s_lshl_b32 s65, s69, 6
    v_lshl_add_u32 v7, v8, 4, s65
    s_waitcnt lgkmcnt(0)
    v_readfirstlane_b32 s75, v3
    s_nop 3
    s_and_b32 s64, s75, 0x7ff
    s_sub_u32 s64, 2047, s64
    s_lshl_b32 s64, s64, 11
    buffer_load_dwordx4 v[88:91], v7, s[8:11], s64 offen
    s_add_u32 s41, s74, 15
    s_and_b32 s41, s41, 15
    s_lshl_b32 s42, s41, 7
    s_mul_i32 s41, s41, 393216
    s_add_u32 m0, s7, 8192
    s_add_u32 s40, s42, 0
    buffer_load_dwordx4 v4, s[8:11], s40 offen lds
    s_add_u32 m0, s7, 12288
    s_add_u32 s40, s42, 65536
    buffer_load_dwordx4 v4, s[8:11], s40 offen lds
    s_add_u32 m0, s7, 16384
    s_add_u32 s40, s42, 131072
    buffer_load_dwordx4 v4, s[8:11], s40 offen lds
    s_add_u32 m0, s7, 20480
    s_add_u32 s40, s42, 196608
    buffer_load_dwordx4 v4, s[8:11], s40 offen lds
    s_add_u32 m0, s7, 24576
    s_add_u32 s40, s41, 0
    buffer_load_dwordx4 v5, s[12:15], s40 offen lds
    s_add_u32 m0, s7, 28672
    s_add_u32 s40, s41, 196608
    buffer_load_dwordx4 v5, s[12:15], s40 offen lds
    s_add_u32 m0, s7, 32768
    s_add_u32 s40, s41, 2048
    buffer_load_dwordx4 v5, s[12:15], s40 offen lds
    s_add_u32 m0, s7, 36864
    s_add_u32 s40, s41, 198656
    buffer_load_dwordx4 v5, s[12:15], s40 offen lds
    s_add_u32 m0, s7, 40960
    s_add_u32 s40, s41, 4096
    buffer_load_dwordx4 v5, s[12:15], s40 offen lds
    s_add_u32 m0, s7, 45056
    s_add_u32 s40, s41, 200704
    buffer_load_dwordx4 v5, s[12:15], s40 offen lds
    s_mov_b32 s24, s54
    s_mov_b32 s25, s55
    s_mov_b32 s26, 0x700000
    s_mov_b32 s27, 0x00020000
    s_lshr_b32 s64, s2, 2
    s_mul_i32 s64, s64, 114688
    s_and_b32 s65, s2, 3
    s_lshl_b32 s65, s65, 9
    s_add_u32 s64, s64, s65
    s_lshl_b32 s65, s6, 7
    s_add_u32 s64, s64, s65
    v_lshrrev_b32 v7, 3, v2
    v_lshlrev_b32 v7, 11, v7
    v_and_b32 v9, 7, v2
    v_lshl_add_u32 v7, v9, 4, v7
    v_add_u32 v21, s64, v7
    s_mov_b32 s64, 0
    buffer_load_dwordx4 v[192:195], v21, s[24:27], s64 offen nt
    s_mov_b32 s64, 16384
    buffer_load_dwordx4 v[196:199], v21, s[24:27], s64 offen nt
    s_mov_b32 s64, 32768
    buffer_load_dwordx4 v[200:203], v21, s[24:27], s64 offen nt
    s_mov_b32 s64, 49152
    buffer_load_dwordx4 v[204:207], v21, s[24:27], s64 offen nt
    s_mov_b32 s64, 65536
    buffer_load_dwordx4 v[208:211], v21, s[24:27], s64 offen nt
    s_mov_b32 s64, 81920
    buffer_load_dwordx4 v[212:215], v21, s[24:27], s64 offen nt
    s_mov_b32 s64, 98304
    buffer_load_dwordx4 v[216:219], v21, s[24:27], s64 offen nt
    s_waitcnt vmcnt(18)
    s_barrier
    s_waitcnt vmcnt(17)
    s_and_b32 s64, s2, 7
    s_lshr_b32 s65, s2, 3
    s_and_b32 s4, s64, 3
    s_lshl_b32 s4, s4, 2
    s_and_b32 s66, s65, 3
    s_add_u32 s4, s4, s66
    s_lshr_b32 s5, s64, 2
    s_lshl_b32 s5, s5, 3
    s_lshr_b32 s66, s65, 2
    s_add_u32 s5, s5, s66
    s_mov_b32 s28, s44
    s_mov_b32 s29, s45
    s_mov_b32 s30, 0x200000
    s_mov_b32 s31, 0x00020000
    v_lshrrev_b32 v7, 3, v2
    s_lshl_b32 s64, s6, 3
    v_add_u32 v7, s64, v7
    v_lshlrev_b32 v7, 11, v7
    v_lshrrev_b32 v9, 4, v2
    v_lshlrev_b32 v9, 1, v9
    v_and_b32 v10, 7, v2
    v_xor_b32 v9, v9, v10
    v_lshl_add_u32 v7, v9, 4, v7
    s_lshl_b32 s64, s5, 7
    v_add_u32 v10, s64, v7
    s_add_u32 m0, s7, 131072
    s_mov_b32 s40, 0
    buffer_load_dwordx4 v10, s[28:31], s40 offen lds
    v_and_b32 v48, 15, v2
    v_and_b32 v49, 1, v2
    v_lshlrev_b32 v49, 4, v49
    v_mov_b32 v50, 0xffff
    v_lshlrev_b32 v49, v49, v50
    v_lshrrev_b32 v48, 1, v48
    v_cmp_eq_u32 vcc, 0, v48
    s_nop 1
    v_cndmask_b32 v40, 0, v49, vcc
    v_cmp_eq_u32 vcc, 1, v48
    s_nop 1
    v_cndmask_b32 v41, 0, v49, vcc
    v_cmp_eq_u32 vcc, 2, v48
    s_nop 1
    v_cndmask_b32 v42, 0, v49, vcc
    v_cmp_eq_u32 vcc, 3, v48
    s_nop 1
    v_cndmask_b32 v43, 0, v49, vcc
    s_mov_b32 s64, 0x01000100
    s_mov_b32 s65, 0x03020302
    v_perm_b32 v48, v88, v88, s64
    v_and_b32 v44, v48, v40
    v_and_b32 v45, v48, v41
    v_and_b32 v46, v48, v42
    s_add_u32 m0, s7, 135168
    s_mov_b32 s40, 65536
    buffer_load_dwordx4 v10, s[28:31], s40 offen lds
    v_and_b32 v47, v48, v43
    s_nop 1
    v_mfma_f32_16x16x32_bf16 v[32:35], v[44:47], v[96:99], 0
    v_mfma_f32_16x16x32_bf16 v[36:39], v[44:47], v[128:131], 0
    v_perm_b32 v48, v88, v88, s65
    v_and_b32 v52, v48, v40
    v_and_b32 v53, v48, v41
    v_and_b32 v54, v48, v42
    v_and_b32 v55, v48, v43
    s_nop 1
    v_mfma_f32_16x16x32_bf16 v[32:35], v[52:55], v[100:103], v[32:35]
    v_mfma_f32_16x16x32_bf16 v[36:39], v[52:55], v[132:135], v[36:39]
    v_perm_b32 v48, v89, v89, s64
    v_and_b32 v44, v48, v40
    v_and_b32 v45, v48, v41
    v_and_b32 v46, v48, v42
    v_and_b32 v47, v48, v43
    s_nop 1
    v_mfma_f32_16x16x32_bf16 v[32:35], v[44:47], v[104:107], v[32:35]
    v_mfma_f32_16x16x32_bf16 v[36:39], v[44:47], v[136:139], v[36:39]
    v_perm_b32 v48, v89, v89, s65
    v_and_b32 v52, v48, v40
    v_and_b32 v53, v48, v41
    v_and_b32 v54, v48, v42
    s_add_u32 m0, s7, 147456
    s_mov_b32 s40, 1048576
    buffer_load_dwordx4 v10, s[28:31], s40 offen lds
    v_and_b32 v55, v48, v43
    s_nop 1
    v_mfma_f32_16x16x32_bf16 v[32:35], v[52:55], v[108:111], v[32:35]
    v_mfma_f32_16x16x32_bf16 v[36:39], v[52:55], v[140:143], v[36:39]
    v_perm_b32 v48, v90, v90, s64
    v_and_b32 v44, v48, v40
    v_and_b32 v45, v48, v41
    v_and_b32 v46, v48, v42
    v_and_b32 v47, v48, v43
    s_nop 1
    v_mfma_f32_16x16x32_bf16 v[32:35], v[44:47], v[112:115], v[32:35]
    v_mfma_f32_16x16x32_bf16 v[36:39], v[44:47], v[144:147], v[36:39]
    v_perm_b32 v48, v90, v90, s65
    v_and_b32 v52, v48, v40
    v_and_b32 v53, v48, v41
    v_and_b32 v54, v48, v42
    v_and_b32 v55, v48, v43
    s_nop 1
    v_mfma_f32_16x16x32_bf16 v[32:35], v[52:55], v[116:119], v[32:35]
    v_mfma_f32_16x16x32_bf16 v[36:39], v[52:55], v[148:151], v[36:39]
    v_perm_b32 v48, v91, v91, s64
    v_and_b32 v44, v48, v40
    v_and_b32 v45, v48, v41
    v_and_b32 v46, v48, v42
    s_add_u32 m0, s7, 151552
    s_mov_b32 s40, 1114112
    buffer_load_dwordx4 v10, s[28:31], s40 offen lds
    v_and_b32 v47, v48, v43
    s_nop 1
    v_mfma_f32_16x16x32_bf16 v[32:35], v[44:47], v[120:123], v[32:35]
    v_mfma_f32_16x16x32_bf16 v[36:39], v[44:47], v[152:155], v[36:39]
    v_perm_b32 v48, v91, v91, s65
    v_and_b32 v52, v48, v40
    v_and_b32 v53, v48, v41
    v_and_b32 v54, v48, v42
    v_and_b32 v55, v48, v43
    s_nop 1
    v_mfma_f32_16x16x32_bf16 v[32:35], v[52:55], v[124:127], v[32:35]
    v_mfma_f32_16x16x32_bf16 v[36:39], v[52:55], v[156:159], v[36:39]
    s_nop 7
    v_permlane32_swap_b32 v32, v36
    v_permlane32_swap_b32 v33, v37
    v_permlane32_swap_b32 v34, v38
    v_permlane32_swap_b32 v35, v39
    s_mov_b32 exec_lo, 0x3fff3fff
    s_mov_b32 exec_hi, 0x3fff3fff
    buffer_store_dwordx4 v[32:35], v12, s[16:19], 0 offen sc0 sc1
    s_mov_b64 exec, -1
    s_waitcnt vmcnt(12)
    s_barrier
    s_add_u32 m0, s7, 139264
    s_mov_b32 s40, 131072
    buffer_load_dwordx4 v10, s[28:31], s40 offen lds
    s_add_u32 m0, s7, 143360
    s_mov_b32 s40, 196608
    buffer_load_dwordx4 v10, s[28:31], s40 offen lds
    s_add_u32 m0, s7, 155648
    s_mov_b32 s40, 1179648
    buffer_load_dwordx4 v10, s[28:31], s40 offen lds
    s_add_u32 m0, s7, 159744
    s_mov_b32 s40, 1245184
    buffer_load_dwordx4 v10, s[28:31], s40 offen lds
    s_add_u32 m0, s7, 73728
    s_mov_b32 s40, 262144
    buffer_load_dwordx4 v10, s[28:31], s40 offen lds
    s_add_u32 m0, s7, 77824
    s_mov_b32 s40, 327680
    buffer_load_dwordx4 v10, s[28:31], s40 offen lds
    s_add_u32 m0, s7, 81920
    s_mov_b32 s40, 1310720
    buffer_load_dwordx4 v10, s[28:31], s40 offen lds
    s_add_u32 m0, s7, 86016
    s_mov_b32 s40, 1376256
    buffer_load_dwordx4 v10, s[28:31], s40 offen lds
    s_barrier
    s_and_b32 s64, s3, 3
    s_lshl_b32 s64, s64, 1
    s_lshr_b32 s65, s3, 2
    s_add_u32 s64, s64, s65
    s_lshl_b32 s64, s64, 4
    s_lshl_b32 s65, s4, 7
    s_add_u32 s64, s64, s65
    v_and_b32 v230, 15, v2
    v_add_u32 v230, s64, v230
    v_bfe_u32 v3, v2, 4, 1
    v_lshlrev_b32 v229, 5, v3
    v_lshrrev_b32 v3, 5, v2
    v_lshl_add_u32 v229, v3, 4, v229
    v_lshl_add_u32 v231, v230, 11, v229
    s_lshl_b32 s64, s5, 7
    v_add_u32 v231, s64, v231
    v_lshlrev_b32 v3, 2, v230
    v_add_u32 v3, 6709248, v3
    buffer_load_dwordx4 v[220:223], v231, s[8:11], 0 offen
    buffer_load_dwordx4 v[224:227], v231, s[8:11], 0 offen offset:64
    buffer_load_dword v228, v3, s[16:19], 0 offen sc1
    s_add_u32 m0, s7, 114688
    s_mov_b32 s40, 393216
    buffer_load_dwordx4 v10, s[28:31], s40 offen lds
    s_add_u32 m0, s7, 118784
    s_mov_b32 s40, 458752
    buffer_load_dwordx4 v10, s[28:31], s40 offen lds
    s_add_u32 m0, s7, 122880
    s_mov_b32 s40, 1441792
    buffer_load_dwordx4 v10, s[28:31], s40 offen lds
    s_add_u32 m0, s7, 126976
    s_mov_b32 s40, 1507328
    buffer_load_dwordx4 v10, s[28:31], s40 offen lds
    s_add_u32 m0, s7, 40960
    s_mov_b32 s40, 524288
    buffer_load_dwordx4 v10, s[28:31], s40 offen lds
    s_add_u32 m0, s7, 45056
    s_mov_b32 s40, 589824
    buffer_load_dwordx4 v10, s[28:31], s40 offen lds
    s_add_u32 m0, s7, 49152
    s_mov_b32 s40, 1572864
    buffer_load_dwordx4 v10, s[28:31], s40 offen lds
    s_add_u32 m0, s7, 53248
    s_mov_b32 s40, 1638400
    buffer_load_dwordx4 v10, s[28:31], s40 offen lds
    s_add_u32 m0, s7, 8192
    s_mov_b32 s40, 655360
    buffer_load_dwordx4 v10, s[28:31], s40 offen lds
    s_add_u32 m0, s7, 12288
    s_mov_b32 s40, 720896
    buffer_load_dwordx4 v10, s[28:31], s40 offen lds
    s_add_u32 m0, s7, 57344
    s_mov_b32 s40, 1703936
    buffer_load_dwordx4 v10, s[28:31], s40 offen lds
    s_add_u32 m0, s7, 61440
    s_mov_b32 s40, 1769472
    buffer_load_dwordx4 v10, s[28:31], s40 offen lds
    s_add_u32 m0, s7, 16384
    s_mov_b32 s40, 786432
    buffer_load_dwordx4 v10, s[28:31], s40 offen lds
    s_add_u32 m0, s7, 20480
    s_mov_b32 s40, 851968
    buffer_load_dwordx4 v10, s[28:31], s40 offen lds
    s_add_u32 m0, s7, 65536
    s_mov_b32 s40, 1835008
    buffer_load_dwordx4 v10, s[28:31], s40 offen lds
    s_add_u32 m0, s7, 69632
    s_mov_b32 s40, 1900544
    buffer_load_dwordx4 v10, s[28:31], s40 offen lds
    s_add_u32 m0, s7, 98304
    s_mov_b32 s40, 917504
    buffer_load_dwordx4 v10, s[28:31], s40 offen lds
    s_add_u32 m0, s7, 102400
    s_mov_b32 s40, 983040
    buffer_load_dwordx4 v10, s[28:31], s40 offen lds
    s_add_u32 m0, s7, 90112
    s_mov_b32 s40, 1966080
    buffer_load_dwordx4 v10, s[28:31], s40 offen lds
    s_add_u32 m0, s7, 94208
    s_mov_b32 s40, 2031616
    buffer_load_dwordx4 v10, s[28:31], s40 offen lds
    s_mov_b64 exec, 1
    v_mov_b32 v20, 0
    buffer_atomic_or v20, v23, s[16:19], 0 offen sc0
    s_mov_b64 exec, -1
    v_add_u32 v17, s70, v6
    v_lshrrev_b32 v18, 2, v2
    v_mul_u32_u24 v18, 1152, v18
    v_and_b32 v19, 3, v2
    v_lshl_add_u32 v18, v19, 4, v18
    s_add_u32 s64, s70, 1024
    v_add_u32 v18, s64, v18
    v_bfe_u32 v26, v2, 3, 1
    v_lshl_add_u32 v26, v26, 2, v19
    v_bfe_u32 v27, v2, 2, 1
    v_lshrrev_b32 v28, 5, v2
    v_cmp_eq_u32 vcc, v27, v28
    v_and_b32 v27, 16, v2
    v_cmp_eq_u32 s[64:65], 0, v27
    s_and_b64 vcc, vcc, s[64:65]
    v_and_b32 v27, 1, v26
    v_lshlrev_b32 v27, 4, v27
    v_mov_b32 v28, 0x3f80
    v_lshlrev_b32 v27, v27, v28
    v_cndmask_b32 v27, 0, v27, vcc
    v_lshrrev_b32 v26, 1, v26
    v_cmp_eq_u32 vcc, 0, v26
    s_nop 1
    v_cndmask_b32 v48, 0, v27, vcc
    v_cmp_eq_u32 vcc, 1, v26
    s_nop 1
    v_cndmask_b32 v49, 0, v27, vcc
    v_cmp_eq_u32 vcc, 2, v26
    s_nop 1
    v_cndmask_b32 v50, 0, v27, vcc
    v_cmp_eq_u32 vcc, 3, v26
    s_nop 1
    v_cndmask_b32 v51, 0, v27, vcc
    v_mov_b32 v128, 0
    v_mov_b32 v129, 0
    v_mov_b32 v130, 0
    v_mov_b32 v131, 0
    v_mov_b32 v132, 0
    v_mov_b32 v133, 0
    v_mov_b32 v134, 0
    v_mov_b32 v135, 0
    v_mov_b32 v136, 0
    v_mov_b32 v137, 0
    v_mov_b32 v138, 0
    v_mov_b32 v139, 0
    v_mov_b32 v140, 0
    v_mov_b32 v141, 0
    v_mov_b32 v142, 0
    v_mov_b32 v143, 0
    s_mov_b32 s66, 0xffff
    s_mov_b32 s65, 0
    s_waitcnt vmcnt(0)
G_loop:
    v_readfirstlane_b32 s68, v20
    s_and_b32 s68, s68, s66
    s_andn2_b32 s66, s66, s68
    s_bcnt1_i32_b32 s67, s68
    s_cmp_eq_u32 s67, 0
    s_cbranch_scc1 G_l0
    s_cmp_gt_u32 s67, 8
    s_cbranch_scc1 G_lt_1
    s_cmp_gt_u32 s67, 4
    s_cbranch_scc1 G_lt_2
    s_cmp_gt_u32 s67, 2
    s_cbranch_scc1 G_lt_3
    s_cmp_eq_u32 s67, 1
    s_cbranch_scc1 G_l1
    s_branch G_l2
G_lt_3:
    s_cmp_eq_u32 s67, 3
    s_cbranch_scc1 G_l3
    s_branch G_l4
G_lt_2:
    s_cmp_gt_u32 s67, 6
    s_cbranch_scc1 G_lt_4
    s_cmp_eq_u32 s67, 5
    s_cbranch_scc1 G_l5
    s_branch G_l6
G_lt_4:
    s_cmp_eq_u32 s67, 7
    s_cbranch_scc1 G_l7
    s_branch G_l8
G_lt_1:
    s_cmp_gt_u32 s67, 12
    s_cbranch_scc1 G_lt_5
    s_cmp_gt_u32 s67, 10
    s_cbranch_scc1 G_lt_6
    s_cmp_eq_u32 s67, 9
    s_cbranch_scc1 G_l9
    s_branch G_l10
G_lt_6:
    s_cmp_eq_u32 s67, 11
    s_cbranch_scc1 G_l11
    s_branch G_l12
G_lt_5:
    s_cmp_gt_u32 s67, 14
    s_cbranch_scc1 G_lt_7
    s_cmp_eq_u32 s67, 13
    s_cbranch_scc1 G_l13
    s_branch G_l14
G_lt_7:
    s_cmp_eq_u32 s67, 15
    s_cbranch_scc1 G_l15
G_l16:
    s_ff1_i32_b32 s55, s68
    s_bitset0_b32 s68, s55
    s_mul_i32 s64, s55, 1152
    buffer_load_dwordx4 v[124:127], v17, s[16:19], s64 offen sc1
G_l15:
    s_ff1_i32_b32 s54, s68
    s_bitset0_b32 s68, s54
    s_mul_i32 s64, s54, 1152
    buffer_load_dwordx4 v[120:123], v17, s[16:19], s64 offen sc1
G_l14:
    s_ff1_i32_b32 s53, s68
    s_bitset0_b32 s68, s53
    s_mul_i32 s64, s53, 1152
    buffer_load_dwordx4 v[116:119], v17, s[16:19], s64 offen sc1
G_l13:
    s_ff1_i32_b32 s52, s68
    s_bitset0_b32 s68, s52
    s_mul_i32 s64, s52, 1152
    buffer_load_dwordx4 v[112:115], v17, s[16:19], s64 offen sc1
G_l12:
    s_ff1_i32_b32 s51, s68
    s_bitset0_b32 s68, s51
    s_mul_i32 s64, s51, 1152
    buffer_load_dwordx4 v[108:111], v17, s[16:19], s64 offen sc1
G_l11:
    s_ff1_i32_b32 s50, s68
    s_bitset0_b32 s68, s50
    s_mul_i32 s64, s50, 1152
    buffer_load_dwordx4 v[104:107], v17, s[16:19], s64 offen sc1
G_l10:
    s_ff1_i32_b32 s49, s68
    s_bitset0_b32 s68, s49
    s_mul_i32 s64, s49, 1152
    buffer_load_dwordx4 v[100:103], v17, s[16:19], s64 offen sc1
G_l9:
    s_ff1_i32_b32 s48, s68
    s_bitset0_b32 s68, s48
    s_mul_i32 s64, s48, 1152
    buffer_load_dwordx4 v[96:99], v17, s[16:19], s64 offen sc1
G_l8:
    s_ff1_i32_b32 s47, s68
    s_bitset0_b32 s68, s47
    s_mul_i32 s64, s47, 1152
    buffer_load_dwordx4 v[92:95], v17, s[16:19], s64 offen sc1
G_l7:
    s_ff1_i32_b32 s46, s68
    s_bitset0_b32 s68, s46
    s_mul_i32 s64, s46, 1152
    buffer_load_dwordx4 v[88:91], v17, s[16:19], s64 offen sc1
G_l6:
    s_ff1_i32_b32 s45, s68
    s_bitset0_b32 s68, s45
    s_mul_i32 s64, s45, 1152
    buffer_load_dwordx4 v[84:87], v17, s[16:19], s64 offen sc1
G_l5:
    s_ff1_i32_b32 s44, s68
    s_bitset0_b32 s68, s44
    s_mul_i32 s64, s44, 1152
    buffer_load_dwordx4 v[80:83], v17, s[16:19], s64 offen sc1
G_l4:
    s_ff1_i32_b32 s43, s68
    s_bitset0_b32 s68, s43
    s_mul_i32 s64, s43, 1152
    buffer_load_dwordx4 v[76:79], v17, s[16:19], s64 offen sc1
G_l3:
    s_ff1_i32_b32 s42, s68
    s_bitset0_b32 s68, s42
    s_mul_i32 s64, s42, 1152
    buffer_load_dwordx4 v[72:75], v17, s[16:19], s64 offen sc1
G_l2:
    s_ff1_i32_b32 s41, s68
    s_bitset0_b32 s68, s41
    s_mul_i32 s64, s41, 1152
    buffer_load_dwordx4 v[68:71], v17, s[16:19], s64 offen sc1
G_l1:
    s_ff1_i32_b32 s40, s68
    s_bitset0_b32 s68, s40
    s_mul_i32 s64, s40, 1152
    buffer_load_dwordx4 v[64:67], v17, s[16:19], s64 offen sc1
G_l0:
    s_mov_b32 s68, s66
    s_cmp_eq_u32 s66, 0
    s_cbranch_scc1 G_z
    s_cmp_lg_u32 s67, 0
    s_cbranch_scc1 G_p
    s_sleep 2
G_p:
    s_mov_b64 exec, 1
    v_mov_b32 v20, 0
    buffer_atomic_or v20, v23, s[16:19], 0 offen sc0
    s_mov_b64 exec, -1
    s_branch G_proc
G_z:
    buffer_load_dwordx4 v[56:59], v18, s[16:19], 0 offen sc1
G_proc:
    s_cmp_eq_u32 s67, 0
    s_cbranch_scc1 G_q0
    s_cmp_gt_u32 s67, 8
    s_cbranch_scc1 G_qt_8
    s_cmp_gt_u32 s67, 4
    s_cbranch_scc1 G_qt_9
    s_cmp_gt_u32 s67, 2
    s_cbranch_scc1 G_qt_10
    s_cmp_eq_u32 s67, 1
    s_cbranch_scc1 G_q1
    s_branch G_q2
G_qt_10:
    s_cmp_eq_u32 s67, 3
    s_cbranch_scc1 G_q3
    s_branch G_q4
G_qt_9:
    s_cmp_gt_u32 s67, 6
    s_cbranch_scc1 G_qt_11
    s_cmp_eq_u32 s67, 5
    s_cbranch_scc1 G_q5
    s_branch G_q6
G_qt_11:
    s_cmp_eq_u32 s67, 7
    s_cbranch_scc1 G_q7
    s_branch G_q8
G_qt_8:
    s_cmp_gt_u32 s67, 12
    s_cbranch_scc1 G_qt_12
    s_cmp_gt_u32 s67, 10
    s_cbranch_scc1 G_qt_13
    s_cmp_eq_u32 s67, 9
    s_cbranch_scc1 G_q9
    s_branch G_q10
G_qt_13:
    s_cmp_eq_u32 s67, 11
    s_cbranch_scc1 G_q11
    s_branch G_q12
G_qt_12:
    s_cmp_gt_u32 s67, 14
    s_cbranch_scc1 G_qt_14
    s_cmp_eq_u32 s67, 13
    s_cbranch_scc1 G_q13
    s_branch G_q14
G_qt_14:
    s_cmp_eq_u32 s67, 15
    s_cbranch_scc1 G_q15
G_q16:
    s_waitcnt vmcnt(16)
    v_max3_u32 v21, v124, v125, v126
    v_max_u32 v21, v21, v127
    v_cmp_eq_u32 vcc, -1, v21
    s_cbranch_vccnz G_f15
    v_mfma_f32_32x32x16_bf16 v[128:143], v[48:51], v[124:127], v[128:143]
G_q15:
    s_waitcnt vmcnt(15)
    v_max3_u32 v21, v120, v121, v122
    v_max_u32 v21, v21, v123
    v_cmp_eq_u32 vcc, -1, v21
    s_cbranch_vccnz G_f14
    v_mfma_f32_32x32x16_bf16 v[128:143], v[48:51], v[120:123], v[128:143]
G_q14:
    s_waitcnt vmcnt(14)
    v_max3_u32 v21, v116, v117, v118
    v_max_u32 v21, v21, v119
    v_cmp_eq_u32 vcc, -1, v21
    s_cbranch_vccnz G_f13
    v_mfma_f32_32x32x16_bf16 v[128:143], v[48:51], v[116:119], v[128:143]
G_q13:
    s_waitcnt vmcnt(13)
    v_max3_u32 v21, v112, v113, v114
    v_max_u32 v21, v21, v115
    v_cmp_eq_u32 vcc, -1, v21
    s_cbranch_vccnz G_f12
    v_mfma_f32_32x32x16_bf16 v[128:143], v[48:51], v[112:115], v[128:143]
G_q12:
    s_waitcnt vmcnt(12)
    v_max3_u32 v21, v108, v109, v110
    v_max_u32 v21, v21, v111
    v_cmp_eq_u32 vcc, -1, v21
    s_cbranch_vccnz G_f11
    v_mfma_f32_32x32x16_bf16 v[128:143], v[48:51], v[108:111], v[128:143]
G_q11:
    s_waitcnt vmcnt(11)
    v_max3_u32 v21, v104, v105, v106
    v_max_u32 v21, v21, v107
    v_cmp_eq_u32 vcc, -1, v21
    s_cbranch_vccnz G_f10
    v_mfma_f32_32x32x16_bf16 v[128:143], v[48:51], v[104:107], v[128:143]
G_q10:
    s_waitcnt vmcnt(10)
    v_max3_u32 v21, v100, v101, v102
    v_max_u32 v21, v21, v103
    v_cmp_eq_u32 vcc, -1, v21
    s_cbranch_vccnz G_f9
    v_mfma_f32_32x32x16_bf16 v[128:143], v[48:51], v[100:103], v[128:143]
G_q9:
    s_waitcnt vmcnt(9)
    v_max3_u32 v21, v96, v97, v98
    v_max_u32 v21, v21, v99
    v_cmp_eq_u32 vcc, -1, v21
    s_cbranch_vccnz G_f8
    v_mfma_f32_32x32x16_bf16 v[128:143], v[48:51], v[96:99], v[128:143]
G_q8:
    s_waitcnt vmcnt(8)
    v_max3_u32 v21, v92, v93, v94
    v_max_u32 v21, v21, v95
    v_cmp_eq_u32 vcc, -1, v21
    s_cbranch_vccnz G_f7
    v_mfma_f32_32x32x16_bf16 v[128:143], v[48:51], v[92:95], v[128:143]
G_q7:
    s_waitcnt vmcnt(7)
    v_max3_u32 v21, v88, v89, v90
    v_max_u32 v21, v21, v91
    v_cmp_eq_u32 vcc, -1, v21
    s_cbranch_vccnz G_f6
    v_mfma_f32_32x32x16_bf16 v[128:143], v[48:51], v[88:91], v[128:143]
G_q6:
    s_waitcnt vmcnt(6)
    v_max3_u32 v21, v84, v85, v86
    v_max_u32 v21, v21, v87
    v_cmp_eq_u32 vcc, -1, v21
    s_cbranch_vccnz G_f5
    v_mfma_f32_32x32x16_bf16 v[128:143], v[48:51], v[84:87], v[128:143]
G_q5:
    s_waitcnt vmcnt(5)
    v_max3_u32 v21, v80, v81, v82
    v_max_u32 v21, v21, v83
    v_cmp_eq_u32 vcc, -1, v21
    s_cbranch_vccnz G_f4
    v_mfma_f32_32x32x16_bf16 v[128:143], v[48:51], v[80:83], v[128:143]
G_q4:
    s_waitcnt vmcnt(4)
    v_max3_u32 v21, v76, v77, v78
    v_max_u32 v21, v21, v79
    v_cmp_eq_u32 vcc, -1, v21
    s_cbranch_vccnz G_f3
    v_mfma_f32_32x32x16_bf16 v[128:143], v[48:51], v[76:79], v[128:143]
G_q3:
    s_waitcnt vmcnt(3)
    v_max3_u32 v21, v72, v73, v74
    v_max_u32 v21, v21, v75
    v_cmp_eq_u32 vcc, -1, v21
    s_cbranch_vccnz G_f2
    v_mfma_f32_32x32x16_bf16 v[128:143], v[48:51], v[72:75], v[128:143]
G_q2:
    s_waitcnt vmcnt(2)
    v_max3_u32 v21, v68, v69, v70
    v_max_u32 v21, v21, v71
    v_cmp_eq_u32 vcc, -1, v21
    s_cbranch_vccnz G_f1
    v_mfma_f32_32x32x16_bf16 v[128:143], v[48:51], v[68:71], v[128:143]
G_q1:
    s_waitcnt vmcnt(1)
    v_max3_u32 v21, v64, v65, v66
    v_max_u32 v21, v21, v67
    v_cmp_eq_u32 vcc, -1, v21
    s_cbranch_vccnz G_f0
    v_mfma_f32_32x32x16_bf16 v[128:143], v[48:51], v[64:67], v[128:143]
G_q0:
    s_waitcnt vmcnt(0)
    s_add_u32 s65, s65, 1
    s_cmp_ge_u32 s65, 40000
    s_cbranch_scc1 G_done
    s_cmp_lg_u32 s68, 0
    s_cbranch_scc1 G_loop
    v_mov_b32 v20, -1
    s_cmp_lg_u32 s66, 0
    s_cbranch_scc1 G_loop
    v_max3_u32 v21, v56, v57, v58
    v_max_u32 v21, v21, v59
    v_cmp_eq_u32 vcc, -1, v21
    s_cbranch_vccnz G_loop
G_done:
    v_add_u32 v16, s7, v6
    v_add_f32_dpp v56, v56, v56 row_ror:4 row_mask:0xf bank_mask:0xf
    v_add_f32_dpp v57, v57, v57 row_ror:4 row_mask:0xf bank_mask:0xf
    v_add_f32_dpp v58, v58, v58 row_ror:4 row_mask:0xf bank_mask:0xf
    v_add_f32_dpp v59, v59, v59 row_ror:4 row_mask:0xf bank_mask:0xf
    v_add_f32_dpp v56, v56, v56 row_ror:8 row_mask:0xf bank_mask:0xf
    v_add_f32_dpp v57, v57, v57 row_ror:8 row_mask:0xf bank_mask:0xf
    v_add_f32_dpp v58, v58, v58 row_ror:8 row_mask:0xf bank_mask:0xf
    v_add_f32_dpp v59, v59, v59 row_ror:8 row_mask:0xf bank_mask:0xf
    v_mov_b32 v64, v56
    v_mov_b32 v65, v57
    v_mov_b32 v66, v58
    v_mov_b32 v67, v59
    s_nop 0
    v_permlane16_swap_b32 v56, v64
    v_permlane16_swap_b32 v57, v65
    v_permlane16_swap_b32 v58, v66
    v_permlane16_swap_b32 v59, v67
    v_add_f32 v56, v56, v64
    v_add_f32 v57, v57, v65
    v_add_f32 v58, v58, v66
    v_add_f32 v59, v59, v67
    v_mov_b32 v64, v56
    v_mov_b32 v65, v57
    v_mov_b32 v66, v58
    v_mov_b32 v67, v59
    s_nop 0
    v_permlane32_swap_b32 v56, v64
    v_permlane32_swap_b32 v57, v65
    v_permlane32_swap_b32 v58, v66
    v_permlane32_swap_b32 v59, v67
    v_add_f32 v56, v56, v64
    v_add_f32 v57, v57, v65
    v_add_f32 v58, v58, v66
    v_add_f32 v59, v59, v67
    v_cvt_pk_bf16_f32 v60, v128, v129
    v_cvt_pk_bf16_f32 v61, v130, v131
    v_cvt_pk_bf16_f32 v62, v132, v133
    v_cvt_pk_bf16_f32 v63, v134, v135
    ds_write_b128 v16, v[60:63] offset:0
    v_cvt_pk_bf16_f32 v56, v56, v57
    v_cvt_pk_bf16_f32 v57, v58, v59
    s_lshr_b32 s64, s6, 1
    s_lshl_b32 s64, s64, 6
    s_and_b32 s65, s6, 1
    s_lshl_b32 s65, s65, 3
    s_add_u32 s64, s64, s65
    v_lshl_add_u32 v16, v2, 4, s64
    s_mov_b64 exec, 15
    ds_write_b64 v16, v[56:57] offset:4096
    s_mov_b64 exec, -1
    s_waitcnt lgkmcnt(0)
    s_barrier
    v_lshrrev_b32 v18, 3, v2
    v_lshlrev_b32 v18, 2, v18
    ds_read_b32 v24, v18 offset:4352
    ds_read_b32 v25, v18 offset:4384
    ds_read_b32 v26, v18 offset:4416
    ds_read_b32 v27, v18 offset:4448
    ds_read_b32 v28, v18 offset:4480
    ds_read_b32 v29, v18 offset:4512
    ds_read_b32 v30, v18 offset:4544
    s_waitcnt lgkmcnt(0)
    v_lshlrev_b32 v48, 16, v192
    v_and_b32 v49, 0xffff0000, v192
    v_mul_f32 v32, v48, v24
    v_mul_f32 v33, v49, v24
    v_lshlrev_b32 v48, 16, v193
    v_and_b32 v49, 0xffff0000, v193
    v_mul_f32 v34, v48, v24
    v_mul_f32 v35, v49, v24
    v_lshlrev_b32 v48, 16, v194
    v_and_b32 v49, 0xffff0000, v194
    v_mul_f32 v36, v48, v24
    v_mul_f32 v37, v49, v24
    v_lshlrev_b32 v48, 16, v195
    v_and_b32 v49, 0xffff0000, v195
    v_mul_f32 v38, v48, v24
    v_mul_f32 v39, v49, v24
    v_lshlrev_b32 v48, 16, v196
    v_and_b32 v49, 0xffff0000, v196
    v_fmac_f32 v32, v48, v25
    v_fmac_f32 v33, v49, v25
    v_lshlrev_b32 v48, 16, v197
    v_and_b32 v49, 0xffff0000, v197
    v_fmac_f32 v34, v48, v25
    v_fmac_f32 v35, v49, v25
    v_lshlrev_b32 v48, 16, v198
    v_and_b32 v49, 0xffff0000, v198
    v_fmac_f32 v36, v48, v25
    v_fmac_f32 v37, v49, v25
    v_lshlrev_b32 v48, 16, v199
    v_and_b32 v49, 0xffff0000, v199
    v_fmac_f32 v38, v48, v25
    v_fmac_f32 v39, v49, v25
    v_lshlrev_b32 v48, 16, v200
    v_and_b32 v49, 0xffff0000, v200
    v_fmac_f32 v32, v48, v26
    v_fmac_f32 v33, v49, v26
    v_lshlrev_b32 v48, 16, v201
    v_and_b32 v49, 0xffff0000, v201
    v_fmac_f32 v34, v48, v26
    v_fmac_f32 v35, v49, v26
    v_lshlrev_b32 v48, 16, v202
    v_and_b32 v49, 0xffff0000, v202
    v_fmac_f32 v36, v48, v26
    v_fmac_f32 v37, v49, v26
    v_lshlrev_b32 v48, 16, v203
    v_and_b32 v49, 0xffff0000, v203
    v_fmac_f32 v38, v48, v26
    v_fmac_f32 v39, v49, v26
    v_lshlrev_b32 v48, 16, v204
    v_and_b32 v49, 0xffff0000, v204
    v_fmac_f32 v32, v48, v27
    v_fmac_f32 v33, v49, v27
    v_lshlrev_b32 v48, 16, v205
    v_and_b32 v49, 0xffff0000, v205
    v_fmac_f32 v34, v48, v27
    v_fmac_f32 v35, v49, v27
    v_lshlrev_b32 v48, 16, v206
    v_and_b32 v49, 0xffff0000, v206
    v_fmac_f32 v36, v48, v27
    v_fmac_f32 v37, v49, v27
    v_lshlrev_b32 v48, 16, v207
    v_and_b32 v49, 0xffff0000, v207
    v_fmac_f32 v38, v48, v27
    v_fmac_f32 v39, v49, v27
    v_lshlrev_b32 v48, 16, v208
    v_and_b32 v49, 0xffff0000, v208
    v_fmac_f32 v32, v48, v28
    v_fmac_f32 v33, v49, v28
    v_lshlrev_b32 v48, 16, v209
    v_and_b32 v49, 0xffff0000, v209
    v_fmac_f32 v34, v48, v28
    v_fmac_f32 v35, v49, v28
    v_lshlrev_b32 v48, 16, v210
    v_and_b32 v49, 0xffff0000, v210
    v_fmac_f32 v36, v48, v28
    v_fmac_f32 v37, v49, v28
    v_lshlrev_b32 v48, 16, v211
    v_and_b32 v49, 0xffff0000, v211
    v_fmac_f32 v38, v48, v28
    v_fmac_f32 v39, v49, v28
    v_lshlrev_b32 v48, 16, v212
    v_and_b32 v49, 0xffff0000, v212
    v_fmac_f32 v32, v48, v29
    v_fmac_f32 v33, v49, v29
    v_lshlrev_b32 v48, 16, v213
    v_and_b32 v49, 0xffff0000, v213
    v_fmac_f32 v34, v48, v29
    v_fmac_f32 v35, v49, v29
    v_lshlrev_b32 v48, 16, v214
    v_and_b32 v49, 0xffff0000, v214
    v_fmac_f32 v36, v48, v29
    v_fmac_f32 v37, v49, v29
    v_lshlrev_b32 v48, 16, v215
    v_and_b32 v49, 0xffff0000, v215
    v_fmac_f32 v38, v48, v29
    v_fmac_f32 v39, v49, v29
    v_lshlrev_b32 v48, 16, v216
    v_and_b32 v49, 0xffff0000, v216
    v_fmac_f32 v32, v48, v30
    v_fmac_f32 v33, v49, v30
    v_lshlrev_b32 v48, 16, v217
    v_and_b32 v49, 0xffff0000, v217
    v_fmac_f32 v34, v48, v30
    v_fmac_f32 v35, v49, v30
    v_lshlrev_b32 v48, 16, v218
    v_and_b32 v49, 0xffff0000, v218
    v_fmac_f32 v36, v48, v30
    v_fmac_f32 v37, v49, v30
    v_lshlrev_b32 v48, 16, v219
    v_and_b32 v49, 0xffff0000, v219
    v_fmac_f32 v38, v48, v30
    v_fmac_f32 v39, v49, v30
    s_nop 1
    v_permlane32_swap_b32 v32, v36
    v_permlane32_swap_b32 v33, v37
    v_permlane32_swap_b32 v34, v38
    v_permlane32_swap_b32 v35, v39
    v_add_f32 v32, v32, v36
    v_add_f32 v33, v33, v37
    v_add_f32 v34, v34, v38
    v_add_f32 v35, v35, v39
    s_nop 1
    v_permlane16_swap_b32 v32, v34
    v_permlane16_swap_b32 v33, v35
    v_add_f32 v32, v32, v34
    v_add_f32 v33, v33, v35
    s_nop 1
    v_add_f32_dpp v32, v32, v32 row_ror:8 row_mask:0xf bank_mask:0xf
    v_add_f32_dpp v33, v33, v33 row_ror:8 row_mask:0xf bank_mask:0xf
    v_and_b32 v16, 7, v2
    v_lshlrev_b32 v16, 5, v16
    v_lshl_add_u32 v16, v8, 3, v16
    s_lshl_b32 s64, s2, 10
    s_lshl_b32 s65, s6, 8
    s_add_u32 s64, s64, s65
    s_add_u32 s64, s64, 6447104
    s_mov_b32 exec_lo, 0x00ff00ff
    s_mov_b32 exec_hi, 0x00ff00ff
    buffer_store_dwordx2 v[32:33], v16, s[16:19], s64 offen sc0 sc1
    s_mov_b64 exec, -1
    s_lshl_b32 s64, s4, 3
    s_add_u32 s64, s64, s3
    s_lshl_b32 s64, s64, 7
    s_add_u32 s64, s64, 5382144
    v_mov_b32 v14, s64
    s_mov_b64 exec, 1
    v_mov_b32 v15, 0
    buffer_atomic_or v15, v14, s[16:19], 0 offen sc0
    s_mov_b64 exec, -1
    v_sub_f32 v248, 1.0, v228
    v_cvt_pk_bf16_f32 v248, v248, v248
    v_lshlrev_b32 v248, 16, v248
    v_lshlrev_b32 v232, 16, v220
    v_and_b32 v233, 0xffff0000, v220
    v_mul_f32 v232, v232, v248
    v_mul_f32 v233, v233, v248
    v_cvt_pk_bf16_f32 v3, v232, v233
    v_lshlrev_b32 v232, 16, v3
    v_and_b32 v233, 0xffff0000, v3
    v_lshlrev_b32 v234, 16, v221
    v_and_b32 v235, 0xffff0000, v221
    v_mul_f32 v234, v234, v248
    v_mul_f32 v235, v235, v248
    v_cvt_pk_bf16_f32 v3, v234, v235
    v_lshlrev_b32 v234, 16, v3
    v_and_b32 v235, 0xffff0000, v3
    v_lshlrev_b32 v236, 16, v222
    v_and_b32 v237, 0xffff0000, v222
    v_mul_f32 v236, v236, v248
    v_mul_f32 v237, v237, v248
    v_cvt_pk_bf16_f32 v3, v236, v237
    v_lshlrev_b32 v236, 16, v3
    v_and_b32 v237, 0xffff0000, v3
    v_lshlrev_b32 v238, 16, v223
    v_and_b32 v239, 0xffff0000, v223
    v_mul_f32 v238, v238, v248
    v_mul_f32 v239, v239, v248
    v_cvt_pk_bf16_f32 v3, v238, v239
    v_lshlrev_b32 v238, 16, v3
    v_and_b32 v239, 0xffff0000, v3
    v_lshlrev_b32 v240, 16, v224
    v_and_b32 v241, 0xffff0000, v224
    v_mul_f32 v240, v240, v248
    v_mul_f32 v241, v241, v248
    v_cvt_pk_bf16_f32 v3, v240, v241
    v_lshlrev_b32 v240, 16, v3
    v_and_b32 v241, 0xffff0000, v3
    v_lshlrev_b32 v242, 16, v225
    v_and_b32 v243, 0xffff0000, v225
    v_mul_f32 v242, v242, v248
    v_mul_f32 v243, v243, v248
    v_cvt_pk_bf16_f32 v3, v242, v243
    v_lshlrev_b32 v242, 16, v3
    v_and_b32 v243, 0xffff0000, v3
    v_lshlrev_b32 v244, 16, v226
    v_and_b32 v245, 0xffff0000, v226
    v_mul_f32 v244, v244, v248
    v_mul_f32 v245, v245, v248
    v_cvt_pk_bf16_f32 v3, v244, v245
    v_lshlrev_b32 v244, 16, v3
    v_and_b32 v245, 0xffff0000, v3
    v_lshlrev_b32 v246, 16, v227
    v_and_b32 v247, 0xffff0000, v227
    v_mul_f32 v246, v246, v248
    v_mul_f32 v247, v247, v248
    v_cvt_pk_bf16_f32 v3, v246, v247
    v_lshlrev_b32 v246, 16, v3
    v_and_b32 v247, 0xffff0000, v3
    s_branch P2_start
C_start:
    s_getpc_b64 s[68:69]
C_pc:
    s_sub_u32 s68, s68, C_pc-gated_mix__linear_attn_block__moe_arch_mod__prompt_kernel
    s_subb_u32 s69, s69, 0
    s_lshr_b32 s64, s2, 3
    s_lshl_b32 s64, s64, 2
    s_add_u32 s64, s64, s3
    s_mul_i32 s64, s64, 256
    s_mov_b32 s65, CODE_END-gated_mix__linear_attn_block__moe_arch_mod__prompt_kernel-4
    s_min_u32 s66, s64, s65
    s_load_dword s75, s[68:69], s66
    s_add_u32 s64, s64, 64
    s_min_u32 s66, s64, s65
    s_load_dword s75, s[68:69], s66
    s_add_u32 s64, s64, 64
    s_min_u32 s66, s64, s65
    s_load_dword s75, s[68:69], s66
    s_add_u32 s64, s64, 64
    s_min_u32 s66, s64, s65
    s_load_dword s75, s[68:69], s66
    s_add_u32 s64, s64, 64
    s_and_b32 s6, s3, 1
    s_lshr_b32 s7, s3, 1
    v_and_b32 v3, 15, v2
    s_lshl_b32 s64, s6, 6
    v_add_u32 v3, s64, v3
    v_lshlrev_b32 v3, 7, v3
    v_add_u32 v3, 8192, v3
    v_bfe_u32 v56, v2, 1, 3
    v_lshrrev_b32 v57, 4, v2
    v_xor_b32 v56, v56, v57
    v_lshl_add_u32 v4, v56, 4, v3
    v_xor_b32 v5, 64, v4
    v_bfe_u32 v56, v2, 2, 2
    v_lshl_add_u32 v58, v57, 3, v56
    v_lshlrev_b32 v58, 7, v58
    v_lshrrev_b32 v56, 1, v56
    v_xor_b32 v56, s7, v56
    v_lshl_add_u32 v58, v56, 6, v58
    v_and_b32 v57, 1, v57
    v_lshl_add_u32 v58, v57, 5, v58
    v_and_b32 v56, 3, v2
    v_lshl_add_u32 v58, v56, 3, v58
    v_add_u32 v6, 24576, v58
    v_xor_b32 v7, 32, v6
    v_mov_b32 v8, v4
    v_mov_b32 v10, v6
    v_mov_b32 v9, v5
    v_mov_b32 v11, v7
    v_mov_b32 v64, 0
    v_mov_b32 v65, 0
    v_mov_b32 v66, 0
    v_mov_b32 v67, 0
    v_mov_b32 v68, 0
    v_mov_b32 v69, 0
    v_mov_b32 v70, 0
    v_mov_b32 v71, 0
    v_mov_b32 v72, 0
    v_mov_b32 v73, 0
    v_mov_b32 v74, 0
    v_mov_b32 v75, 0
    v_mov_b32 v76, 0
    v_mov_b32 v77, 0
    v_mov_b32 v78, 0
    v_mov_b32 v79, 0
    v_mov_b32 v80, 0
    v_mov_b32 v81, 0
    v_mov_b32 v82, 0
    v_mov_b32 v83, 0
    v_mov_b32 v84, 0
    v_mov_b32 v85, 0
    v_mov_b32 v86, 0
    v_mov_b32 v87, 0
    v_mov_b32 v88, 0
    v_mov_b32 v89, 0
    v_mov_b32 v90, 0
    v_mov_b32 v91, 0
    v_mov_b32 v92, 0
    v_mov_b32 v93, 0
    v_mov_b32 v94, 0
    v_mov_b32 v95, 0
    v_mov_b32 v96, 0
    v_mov_b32 v97, 0
    v_mov_b32 v98, 0
    v_mov_b32 v99, 0
    v_mov_b32 v100, 0
    v_mov_b32 v101, 0
    v_mov_b32 v102, 0
    v_mov_b32 v103, 0
    v_mov_b32 v104, 0
    v_mov_b32 v105, 0
    v_mov_b32 v106, 0
    v_mov_b32 v107, 0
    v_mov_b32 v108, 0
    v_mov_b32 v109, 0
    v_mov_b32 v110, 0
    v_mov_b32 v111, 0
    v_mov_b32 v112, 0
    v_mov_b32 v113, 0
    v_mov_b32 v114, 0
    v_mov_b32 v115, 0
    v_mov_b32 v116, 0
    v_mov_b32 v117, 0
    v_mov_b32 v118, 0
    v_mov_b32 v119, 0
    v_mov_b32 v120, 0
    v_mov_b32 v121, 0
    v_mov_b32 v122, 0
    v_mov_b32 v123, 0
    v_mov_b32 v124, 0
    v_mov_b32 v125, 0
    v_mov_b32 v126, 0
    v_mov_b32 v127, 0
    v_mov_b32 v128, 0
    v_mov_b32 v129, 0
    v_mov_b32 v130, 0
    v_mov_b32 v131, 0
    v_mov_b32 v132, 0
    v_mov_b32 v133, 0
    v_mov_b32 v134, 0
    v_mov_b32 v135, 0
    v_mov_b32 v136, 0
    v_mov_b32 v137, 0
    v_mov_b32 v138, 0
    v_mov_b32 v139, 0
    v_mov_b32 v140, 0
    v_mov_b32 v141, 0
    v_mov_b32 v142, 0
    v_mov_b32 v143, 0
    v_mov_b32 v144, 0
    v_mov_b32 v145, 0
    v_mov_b32 v146, 0
    v_mov_b32 v147, 0
    v_mov_b32 v148, 0
    v_mov_b32 v149, 0
    v_mov_b32 v150, 0
    v_mov_b32 v151, 0
    v_mov_b32 v152, 0
    v_mov_b32 v153, 0
    v_mov_b32 v154, 0
    v_mov_b32 v155, 0
    v_mov_b32 v156, 0
    v_mov_b32 v157, 0
    v_mov_b32 v158, 0
    v_mov_b32 v159, 0
    s_lshl_b32 s64, s3, 2
    v_mov_b32 v229, s64
    ds_write_b32 v229, v64 offset:4288
    v_lshlrev_b32 v3, 4, v2
    s_lshl_b32 s64, s3, 11
    v_add_u32 v224, s64, v3
    v_xor_b32 v225, 2048, v224
    s_lshl_b32 s64, s3, 8
    v_lshl_add_u32 v227, v2, 2, s64
    v_xor_b32 v228, 256, v227
    v_xor_b32 v230, 4, v229
    v_mov_b32 v231, 1
    v_lshlrev_b32 v232, 2, v2
    s_lshl_b32 s64, 1, s4
    v_mov_b32 v233, s64
    s_lshl_b32 s43, s5, 2
    s_add_u32 s43, s43, s3
    s_lshl_b32 s64, s43, 7
    s_add_u32 s64, s64, 5373952
    v_mov_b32 v234, s64
    s_lshl_b32 s43, s43, 4
    s_add_u32 s43, s43, s4
    s_mul_i32 s43, s43, 1152
    s_add_u32 s43, s43, 4194304
    s_lshl_b32 s42, s4, 2
    s_lshl_b32 s64, s6, 1
    s_add_u32 s42, s42, s64
    s_lshl_b32 s42, s42, 5
    s_lshl_b32 s64, s5, 1
    s_add_u32 s42, s42, s64
    s_add_u32 s42, s42, s7
    s_lshl_b32 s42, s42, 11
    s_and_b32 s64, s5, 7
    s_lshl_b32 s64, s64, 1
    s_add_u32 s64, s64, s7
    s_lshl_b32 s64, 1, s64
    v_mov_b32 v13, s64
    s_lshr_b32 s64, s5, 3
    s_lshl_b32 s64, s64, 1
    s_add_u32 s64, s64, s6
    s_lshl_b32 s64, s64, 8
    s_lshl_b32 s65, s4, 10
    s_add_u32 s64, s64, s65
    s_add_u32 s64, s64, 5382144
    v_lshl_add_u32 v12, v2, 7, s64
    s_and_b32 s64, s2, 7
    s_lshr_b32 s65, s2, 3
    s_and_b32 s4, s64, 3
    s_lshl_b32 s4, s4, 2
    s_and_b32 s66, s65, 3
    s_add_u32 s4, s4, s66
    s_lshr_b32 s5, s64, 2
    s_lshl_b32 s5, s5, 3
    s_lshr_b32 s66, s65, 2
    s_add_u32 s5, s5, s66
    s_mov_b32 s65, 0
    s_mov_b32 s66, 0
    v_mov_b32 v236, 0x3f803f80
    v_mov_b32 v237, 0x3f803f80
    v_mov_b32 v238, 0x3f803f80
    v_mov_b32 v239, 0x3f803f80
    s_waitcnt vmcnt(0) lgkmcnt(0)
    s_barrier
    ds_read_b64_tr_b16 v[16:17], v10 offset:0
    ds_read_b64_tr_b16 v[18:19], v10 offset:512
    ds_read_b128 v[192:195], v8 offset:0
    ds_read_b128 v[196:199], v8 offset:2048
    ds_read_b128 v[200:203], v8 offset:4096
    ds_read_b128 v[204:207], v8 offset:6144
    ds_read_b64_tr_b16 v[20:21], v11 offset:0
    ds_read_b64_tr_b16 v[22:23], v11 offset:512
    ds_read_b64_tr_b16 v[24:25], v10 offset:8192
    ds_read_b64_tr_b16 v[26:27], v10 offset:8704
    ds_read_b64_tr_b16 v[28:29], v11 offset:8192
    ds_read_b64_tr_b16 v[30:31], v11 offset:8704
    ds_read_b64_tr_b16 v[32:33], v10 offset:16384
    ds_read_b64_tr_b16 v[34:35], v10 offset:16896
    ds_read_b64_tr_b16 v[36:37], v11 offset:16384
    ds_read_b64_tr_b16 v[38:39], v11 offset:16896
.p2align 3
C_loop:
    s_waitcnt lgkmcnt(0)
    v_mfma_f32_16x16x32_bf16 v[64:67], v[16:19], v[192:195], v[64:67]
    ds_read_b64_tr_b16 v[40:41], v10 offset:4096
    v_mfma_f32_16x16x32_bf16 v[72:75], v[16:19], v[196:199], v[72:75]
    ds_read_b64_tr_b16 v[42:43], v10 offset:4608
    v_mfma_f32_16x16x32_bf16 v[80:83], v[16:19], v[200:203], v[80:83]
    ds_read_b128 v[208:211], v9 offset:0
    v_mfma_f32_16x16x32_bf16 v[88:91], v[16:19], v[204:207], v[88:91]
    ds_read_b128 v[212:215], v9 offset:2048
    v_mfma_f32_16x16x32_bf16 v[68:71], v[20:23], v[192:195], v[68:71]
    ds_read_b128 v[216:219], v9 offset:4096
    v_mfma_f32_16x16x32_bf16 v[76:79], v[20:23], v[196:199], v[76:79]
    ds_read_b128 v[220:223], v9 offset:6144
    v_mfma_f32_16x16x32_bf16 v[84:87], v[20:23], v[200:203], v[84:87]
    ds_read_b64_tr_b16 v[44:45], v11 offset:4096
    v_mfma_f32_16x16x32_bf16 v[92:95], v[20:23], v[204:207], v[92:95]
    ds_read_b64_tr_b16 v[46:47], v11 offset:4608
    v_mfma_f32_16x16x32_bf16 v[96:99], v[192:195], v[24:27], v[96:99]
    ds_read_b64_tr_b16 v[48:49], v10 offset:12288
    v_mfma_f32_16x16x32_bf16 v[100:103], v[196:199], v[24:27], v[100:103]
    ds_read_b64_tr_b16 v[50:51], v10 offset:12800
    v_mfma_f32_16x16x32_bf16 v[112:115], v[200:203], v[24:27], v[112:115]
    ds_read_b64_tr_b16 v[52:53], v11 offset:12288
    v_mfma_f32_16x16x32_bf16 v[116:119], v[204:207], v[24:27], v[116:119]
    ds_read_b64_tr_b16 v[54:55], v11 offset:12800
    v_mfma_f32_16x16x32_bf16 v[104:107], v[192:195], v[28:31], v[104:107]
    ds_read_b64_tr_b16 v[56:57], v10 offset:20480
    v_mfma_f32_16x16x32_bf16 v[108:111], v[196:199], v[28:31], v[108:111]
    ds_read_b64_tr_b16 v[58:59], v10 offset:20992
    v_mfma_f32_16x16x32_bf16 v[120:123], v[200:203], v[28:31], v[120:123]
    ds_read_b64_tr_b16 v[60:61], v11 offset:20480
    v_mfma_f32_16x16x32_bf16 v[124:127], v[204:207], v[28:31], v[124:127]
    ds_read_b64_tr_b16 v[62:63], v11 offset:20992
    v_mfma_f32_16x16x32_bf16 v[128:131], v[192:195], v[32:35], v[128:131]
    v_mfma_f32_16x16x32_bf16 v[132:135], v[196:199], v[32:35], v[132:135]
    v_mfma_f32_16x16x32_bf16 v[144:147], v[200:203], v[32:35], v[144:147]
    v_mfma_f32_16x16x32_bf16 v[148:151], v[204:207], v[32:35], v[148:151]
    v_mfma_f32_16x16x32_bf16 v[136:139], v[192:195], v[36:39], v[136:139]
    v_mfma_f32_16x16x32_bf16 v[140:143], v[196:199], v[36:39], v[140:143]
    v_mfma_f32_16x16x32_bf16 v[152:155], v[200:203], v[36:39], v[152:155]
    v_mfma_f32_16x16x32_bf16 v[156:159], v[204:207], v[36:39], v[156:159]
    s_waitcnt lgkmcnt(0)
    s_barrier
    s_add_u32 s65, s65, 40960
    s_cmp_eq_u32 s65, 122880
    s_cselect_b32 s65, 0, s65
    v_mfma_f32_16x16x32_bf16 v[64:67], v[40:43], v[208:211], v[64:67]
    v_add_u32 v10, s65, v6
    v_add_u32 v8, s65, v4
    v_mfma_f32_16x16x32_bf16 v[72:75], v[40:43], v[212:215], v[72:75]
    ds_read_b64_tr_b16 v[16:17], v10 offset:0
    v_mfma_f32_16x16x32_bf16 v[80:83], v[40:43], v[216:219], v[80:83]
    ds_read_b64_tr_b16 v[18:19], v10 offset:512
    v_mfma_f32_16x16x32_bf16 v[88:91], v[40:43], v[220:223], v[88:91]
    ds_read_b128 v[192:195], v8 offset:0
    v_mfma_f32_16x16x32_bf16 v[68:71], v[44:47], v[208:211], v[68:71]
    ds_read_b128 v[196:199], v8 offset:2048
    v_mfma_f32_16x16x32_bf16 v[76:79], v[44:47], v[212:215], v[76:79]
    ds_read_b128 v[200:203], v8 offset:4096
    v_mfma_f32_16x16x32_bf16 v[84:87], v[44:47], v[216:219], v[84:87]
    ds_read_b128 v[204:207], v8 offset:6144
    v_mfma_f32_16x16x32_bf16 v[92:95], v[44:47], v[220:223], v[92:95]
    v_add_u32 v11, s65, v7
    v_mfma_f32_16x16x32_bf16 v[96:99], v[208:211], v[48:51], v[96:99]
    ds_read_b64_tr_b16 v[20:21], v11 offset:0
    v_mfma_f32_16x16x32_bf16 v[100:103], v[212:215], v[48:51], v[100:103]
    ds_read_b64_tr_b16 v[22:23], v11 offset:512
    v_mfma_f32_16x16x32_bf16 v[112:115], v[216:219], v[48:51], v[112:115]
    ds_read_b64_tr_b16 v[24:25], v10 offset:8192
    v_mfma_f32_16x16x32_bf16 v[116:119], v[220:223], v[48:51], v[116:119]
    ds_read_b64_tr_b16 v[26:27], v10 offset:8704
    v_mfma_f32_16x16x32_bf16 v[104:107], v[208:211], v[52:55], v[104:107]
    ds_read_b64_tr_b16 v[28:29], v11 offset:8192
    v_mfma_f32_16x16x32_bf16 v[108:111], v[212:215], v[52:55], v[108:111]
    ds_read_b64_tr_b16 v[30:31], v11 offset:8704
    v_mfma_f32_16x16x32_bf16 v[120:123], v[216:219], v[52:55], v[120:123]
    ds_read_b64_tr_b16 v[32:33], v10 offset:16384
    v_mfma_f32_16x16x32_bf16 v[124:127], v[220:223], v[52:55], v[124:127]
    ds_read_b64_tr_b16 v[34:35], v10 offset:16896
    v_mfma_f32_16x16x32_bf16 v[128:131], v[208:211], v[56:59], v[128:131]
    ds_read_b64_tr_b16 v[36:37], v11 offset:16384
    v_mfma_f32_16x16x32_bf16 v[132:135], v[212:215], v[56:59], v[132:135]
    ds_read_b64_tr_b16 v[38:39], v11 offset:16896
    v_mfma_f32_16x16x32_bf16 v[144:147], v[216:219], v[56:59], v[144:147]
    v_add_u32 v9, s65, v5
    v_mfma_f32_16x16x32_bf16 v[148:151], v[220:223], v[56:59], v[148:151]
    v_mfma_f32_16x16x32_bf16 v[136:139], v[208:211], v[60:63], v[136:139]
    v_mfma_f32_16x16x32_bf16 v[140:143], v[212:215], v[60:63], v[140:143]
    v_mfma_f32_16x16x32_bf16 v[152:155], v[216:219], v[60:63], v[152:155]
    v_mfma_f32_16x16x32_bf16 v[156:159], v[220:223], v[60:63], v[156:159]
    s_add_u32 s66, s66, 1
    s_cmp_lt_u32 s66, 14
    s_cbranch_scc1 C_loop
    s_waitcnt lgkmcnt(0)
    v_mfma_f32_16x16x32_bf16 v[96:99], v[192:195], v[24:27], v[96:99]
    ds_read_b64_tr_b16 v[48:49], v10 offset:12288
    v_mfma_f32_16x16x32_bf16 v[100:103], v[196:199], v[24:27], v[100:103]
    ds_read_b64_tr_b16 v[50:51], v10 offset:12800
    v_mfma_f32_16x16x32_bf16 v[112:115], v[200:203], v[24:27], v[112:115]
    ds_read_b128 v[160:163], v9 offset:0
    v_mfma_f32_16x16x32_bf16 v[116:119], v[204:207], v[24:27], v[116:119]
    ds_read_b128 v[164:167], v9 offset:2048
    v_mfma_f32_16x16x32_bf16 v[104:107], v[192:195], v[28:31], v[104:107]
    ds_read_b128 v[168:171], v9 offset:4096
    v_mfma_f32_16x16x32_bf16 v[108:111], v[196:199], v[28:31], v[108:111]
    ds_read_b128 v[172:175], v9 offset:6144
    v_mfma_f32_16x16x32_bf16 v[120:123], v[200:203], v[28:31], v[120:123]
    ds_read_b64_tr_b16 v[52:53], v11 offset:12288
    v_mfma_f32_16x16x32_bf16 v[124:127], v[204:207], v[28:31], v[124:127]
    ds_read_b64_tr_b16 v[54:55], v11 offset:12800
    v_mfma_f32_16x16x32_bf16 v[128:131], v[192:195], v[32:35], v[128:131]
    ds_read_b64_tr_b16 v[56:57], v10 offset:20480
    v_mfma_f32_16x16x32_bf16 v[132:135], v[196:199], v[32:35], v[132:135]
    ds_read_b64_tr_b16 v[58:59], v10 offset:20992
    v_mfma_f32_16x16x32_bf16 v[144:147], v[200:203], v[32:35], v[144:147]
    ds_read_b64_tr_b16 v[60:61], v11 offset:20480
    v_mfma_f32_16x16x32_bf16 v[148:151], v[204:207], v[32:35], v[148:151]
    ds_read_b64_tr_b16 v[62:63], v11 offset:20992
    v_mfma_f32_16x16x32_bf16 v[136:139], v[192:195], v[36:39], v[136:139]
    v_mfma_f32_16x16x32_bf16 v[140:143], v[196:199], v[36:39], v[140:143]
    v_mfma_f32_16x16x32_bf16 v[152:155], v[200:203], v[36:39], v[152:155]
    v_mfma_f32_16x16x32_bf16 v[156:159], v[204:207], v[36:39], v[156:159]
    s_waitcnt lgkmcnt(0)
    s_barrier
    s_add_u32 s66, s66, 1
    v_mfma_f32_16x16x32_bf16 v[96:99], v[160:163], v[48:51], v[96:99]
    v_mov_b32 v10, v6
    v_mov_b32 v8, v4
    v_mfma_f32_16x16x32_bf16 v[100:103], v[164:167], v[48:51], v[100:103]
    ds_read_b64_tr_b16 v[24:25], v10 offset:8192
    v_mfma_f32_16x16x32_bf16 v[112:115], v[168:171], v[48:51], v[112:115]
    ds_read_b64_tr_b16 v[26:27], v10 offset:8704
    v_mfma_f32_16x16x32_bf16 v[116:119], v[172:175], v[48:51], v[116:119]
    v_mov_b32 v11, v7
    v_mov_b32 v9, v5
    v_mfma_f32_16x16x32_bf16 v[104:107], v[160:163], v[52:55], v[104:107]
    ds_read_b128 v[176:179], v8 offset:0
    v_mfma_f32_16x16x32_bf16 v[108:111], v[164:167], v[52:55], v[108:111]
    ds_read_b128 v[180:183], v8 offset:2048
    v_mfma_f32_16x16x32_bf16 v[120:123], v[168:171], v[52:55], v[120:123]
    ds_read_b128 v[184:187], v8 offset:4096
    v_mfma_f32_16x16x32_bf16 v[124:127], v[172:175], v[52:55], v[124:127]
    ds_read_b128 v[188:191], v8 offset:6144
    v_mfma_f32_16x16x32_bf16 v[128:131], v[160:163], v[56:59], v[128:131]
    ds_read_b64_tr_b16 v[28:29], v11 offset:8192
    v_mfma_f32_16x16x32_bf16 v[132:135], v[164:167], v[56:59], v[132:135]
    ds_read_b64_tr_b16 v[30:31], v11 offset:8704
    v_mfma_f32_16x16x32_bf16 v[144:147], v[168:171], v[56:59], v[144:147]
    ds_read_b64_tr_b16 v[32:33], v10 offset:16384
    v_mfma_f32_16x16x32_bf16 v[148:151], v[172:175], v[56:59], v[148:151]
    ds_read_b64_tr_b16 v[34:35], v10 offset:16896
    v_mfma_f32_16x16x32_bf16 v[136:139], v[160:163], v[60:63], v[136:139]
    ds_read_b64_tr_b16 v[36:37], v11 offset:16384
    v_mfma_f32_16x16x32_bf16 v[140:143], v[164:167], v[60:63], v[140:143]
    ds_read_b64_tr_b16 v[38:39], v11 offset:16896
    v_mfma_f32_16x16x32_bf16 v[152:155], v[168:171], v[60:63], v[152:155]
    v_mfma_f32_16x16x32_bf16 v[156:159], v[172:175], v[60:63], v[156:159]
    s_waitcnt lgkmcnt(0)
    v_mfma_f32_16x16x32_bf16 v[96:99], v[176:179], v[24:27], v[96:99]
    ds_read_b64_tr_b16 v[48:49], v10 offset:12288
    v_mfma_f32_16x16x32_bf16 v[100:103], v[180:183], v[24:27], v[100:103]
    ds_read_b64_tr_b16 v[50:51], v10 offset:12800
    v_mfma_f32_16x16x32_bf16 v[112:115], v[184:187], v[24:27], v[112:115]
    ds_read_b128 v[208:211], v9 offset:0
    v_mfma_f32_16x16x32_bf16 v[116:119], v[188:191], v[24:27], v[116:119]
    ds_read_b128 v[212:215], v9 offset:2048
    v_mfma_f32_16x16x32_bf16 v[104:107], v[176:179], v[28:31], v[104:107]
    ds_read_b128 v[216:219], v9 offset:4096
    v_mfma_f32_16x16x32_bf16 v[108:111], v[180:183], v[28:31], v[108:111]
    ds_read_b128 v[220:223], v9 offset:6144
    v_mfma_f32_16x16x32_bf16 v[120:123], v[184:187], v[28:31], v[120:123]
    ds_read_b64_tr_b16 v[52:53], v11 offset:12288
    v_mfma_f32_16x16x32_bf16 v[124:127], v[188:191], v[28:31], v[124:127]
    ds_read_b64_tr_b16 v[54:55], v11 offset:12800
    v_mfma_f32_16x16x32_bf16 v[128:131], v[176:179], v[32:35], v[128:131]
    ds_read_b64_tr_b16 v[56:57], v10 offset:20480
    v_mfma_f32_16x16x32_bf16 v[132:135], v[180:183], v[32:35], v[132:135]
    ds_read_b64_tr_b16 v[58:59], v10 offset:20992
    v_mfma_f32_16x16x32_bf16 v[144:147], v[184:187], v[32:35], v[144:147]
    ds_read_b64_tr_b16 v[60:61], v11 offset:20480
    v_mfma_f32_16x16x32_bf16 v[148:151], v[188:191], v[32:35], v[148:151]
    ds_read_b64_tr_b16 v[62:63], v11 offset:20992
    v_mfma_f32_16x16x32_bf16 v[136:139], v[176:179], v[36:39], v[136:139]
    v_mfma_f32_16x16x32_bf16 v[140:143], v[180:183], v[36:39], v[140:143]
    v_mfma_f32_16x16x32_bf16 v[152:155], v[184:187], v[36:39], v[152:155]
    v_mfma_f32_16x16x32_bf16 v[156:159], v[188:191], v[36:39], v[156:159]
    s_waitcnt lgkmcnt(0)
    s_barrier
    v_mfma_f32_16x16x32_bf16 v[96:99], v[208:211], v[48:51], v[96:99]
    v_mfma_f32_16x16x32_bf16 v[100:103], v[212:215], v[48:51], v[100:103]
    v_mfma_f32_16x16x32_bf16 v[112:115], v[216:219], v[48:51], v[112:115]
    v_mfma_f32_16x16x32_bf16 v[116:119], v[220:223], v[48:51], v[116:119]
    v_mfma_f32_16x16x32_bf16 v[104:107], v[208:211], v[52:55], v[104:107]
    v_mfma_f32_16x16x32_bf16 v[108:111], v[212:215], v[52:55], v[108:111]
    v_mfma_f32_16x16x32_bf16 v[120:123], v[216:219], v[52:55], v[120:123]
    v_mfma_f32_16x16x32_bf16 v[124:127], v[220:223], v[52:55], v[124:127]
    v_mfma_f32_16x16x32_bf16 v[128:131], v[208:211], v[56:59], v[128:131]
    v_mfma_f32_16x16x32_bf16 v[132:135], v[212:215], v[56:59], v[132:135]
    v_mfma_f32_16x16x32_bf16 v[144:147], v[216:219], v[56:59], v[144:147]
    v_mfma_f32_16x16x32_bf16 v[148:151], v[220:223], v[56:59], v[148:151]
    v_mfma_f32_16x16x32_bf16 v[136:139], v[208:211], v[60:63], v[136:139]
    v_mfma_f32_16x16x32_bf16 v[140:143], v[212:215], v[60:63], v[140:143]
    v_mfma_f32_16x16x32_bf16 v[152:155], v[216:219], v[60:63], v[152:155]
    v_mfma_f32_16x16x32_bf16 v[156:159], v[220:223], v[60:63], v[156:159]
    v_add_u32 v10, 81920, v6
    v_add_u32 v11, 81920, v7
    v_cvt_pk_bf16_f32 v16, v96, v97
    v_lshlrev_b32 v48, 16, v16
    v_and_b32 v49, 0xffff0000, v16
    v_mul_f32 v50, s72, v48
    v_mul_f32 v51, s72, v49
    v_exp_f32 v50, v50 clamp
    v_exp_f32 v51, v51 clamp
    v_max_f32 v48, 0, v48
    v_max_f32 v49, 0, v49
    v_add_f32 v48, v48, v50
    v_add_f32 v49, v49, v51
    v_min_f32 v56, v48, v49
    v_cvt_pk_bf16_f32 v16, v48, v49
    v_cvt_pk_bf16_f32 v17, v98, v99
    v_lshlrev_b32 v48, 16, v17
    v_and_b32 v49, 0xffff0000, v17
    v_mul_f32 v50, s72, v48
    v_mul_f32 v51, s72, v49
    v_exp_f32 v50, v50 clamp
    v_exp_f32 v51, v51 clamp
    v_max_f32 v48, 0, v48
    v_max_f32 v49, 0, v49
    v_add_f32 v48, v48, v50
    v_add_f32 v49, v49, v51
    v_min3_f32 v56, v48, v49, v56
    v_cvt_pk_bf16_f32 v17, v48, v49
    v_cvt_pk_bf16_f32 v18, v100, v101
    v_lshlrev_b32 v48, 16, v18
    v_and_b32 v49, 0xffff0000, v18
    v_mul_f32 v50, s72, v48
    v_mul_f32 v51, s72, v49
    v_exp_f32 v50, v50 clamp
    v_exp_f32 v51, v51 clamp
    v_max_f32 v48, 0, v48
    v_max_f32 v49, 0, v49
    v_add_f32 v48, v48, v50
    v_add_f32 v49, v49, v51
    v_min3_f32 v56, v48, v49, v56
    v_cvt_pk_bf16_f32 v18, v48, v49
    v_cvt_pk_bf16_f32 v19, v102, v103
    v_lshlrev_b32 v48, 16, v19
    v_and_b32 v49, 0xffff0000, v19
    v_mul_f32 v50, s72, v48
    v_mul_f32 v51, s72, v49
    v_exp_f32 v50, v50 clamp
    v_exp_f32 v51, v51 clamp
    v_max_f32 v48, 0, v48
    v_max_f32 v49, 0, v49
    v_add_f32 v48, v48, v50
    v_add_f32 v49, v49, v51
    v_min3_f32 v56, v48, v49, v56
    v_cvt_pk_bf16_f32 v19, v48, v49
    v_cvt_pk_bf16_f32 v20, v104, v105
    v_lshlrev_b32 v48, 16, v20
    v_and_b32 v49, 0xffff0000, v20
    v_mul_f32 v50, s72, v48
    v_mul_f32 v51, s72, v49
    v_exp_f32 v50, v50 clamp
    v_exp_f32 v51, v51 clamp
    v_max_f32 v48, 0, v48
    v_max_f32 v49, 0, v49
    v_add_f32 v48, v48, v50
    v_add_f32 v49, v49, v51
    v_min3_f32 v56, v48, v49, v56
    v_cvt_pk_bf16_f32 v20, v48, v49
    v_cvt_pk_bf16_f32 v21, v106, v107
    v_lshlrev_b32 v48, 16, v21
    v_and_b32 v49, 0xffff0000, v21
    v_mul_f32 v50, s72, v48
    v_mul_f32 v51, s72, v49
    v_exp_f32 v50, v50 clamp
    v_exp_f32 v51, v51 clamp
    v_max_f32 v48, 0, v48
    v_max_f32 v49, 0, v49
    v_add_f32 v48, v48, v50
    v_add_f32 v49, v49, v51
    v_min3_f32 v56, v48, v49, v56
    v_cvt_pk_bf16_f32 v21, v48, v49
    v_cvt_pk_bf16_f32 v22, v108, v109
    v_lshlrev_b32 v48, 16, v22
    v_and_b32 v49, 0xffff0000, v22
    v_mul_f32 v50, s72, v48
    v_mul_f32 v51, s72, v49
    v_exp_f32 v50, v50 clamp
    v_exp_f32 v51, v51 clamp
    v_max_f32 v48, 0, v48
    v_max_f32 v49, 0, v49
    v_add_f32 v48, v48, v50
    v_add_f32 v49, v49, v51
    v_min3_f32 v56, v48, v49, v56
    v_cvt_pk_bf16_f32 v22, v48, v49
    v_cvt_pk_bf16_f32 v23, v110, v111
    v_lshlrev_b32 v48, 16, v23
    v_and_b32 v49, 0xffff0000, v23
    v_mul_f32 v50, s72, v48
    v_mul_f32 v51, s72, v49
    v_exp_f32 v50, v50 clamp
    v_exp_f32 v51, v51 clamp
    v_max_f32 v48, 0, v48
    v_max_f32 v49, 0, v49
    v_add_f32 v48, v48, v50
    v_add_f32 v49, v49, v51
    v_min3_f32 v56, v48, v49, v56
    v_cvt_pk_bf16_f32 v23, v48, v49
    v_cmp_gt_f32 vcc, 0x3a800000, v56
    s_cbranch_vccnz phi_15_fix
phi_15_done:
    v_cvt_pk_bf16_f32 v32, v128, v129
    v_cvt_pk_bf16_f32 v33, v130, v131
    v_mfma_f32_16x16x32_bf16 v[96:99], v[236:239], v[16:19], 0
    v_cvt_pk_bf16_f32 v34, v132, v133
    v_mfma_f32_16x16x32_bf16 v[60:63], v[236:239], v[20:23], 0
    v_cvt_pk_bf16_f32 v35, v134, v135
    v_cvt_pk_bf16_f32 v36, v136, v137
    v_cvt_pk_bf16_f32 v37, v138, v139
    v_mfma_f32_16x16x32_bf16 v[240:243], v[16:19], v[32:35], 0
    v_cvt_pk_bf16_f32 v38, v140, v141
    v_mfma_f32_16x16x32_bf16 v[244:247], v[20:23], v[32:35], 0
    v_cvt_pk_bf16_f32 v39, v142, v143
    s_nop 1
    v_mfma_f32_16x16x32_bf16 v[248:251], v[16:19], v[36:39], 0
    v_mfma_f32_16x16x32_bf16 v[252:255], v[20:23], v[36:39], 0
    v_cvt_pk_bf16_f32 v24, v112, v113
    v_lshlrev_b32 v48, 16, v24
    v_and_b32 v49, 0xffff0000, v24
    v_mul_f32 v50, s72, v48
    v_mul_f32 v51, s72, v49
    v_exp_f32 v50, v50 clamp
    v_exp_f32 v51, v51 clamp
    v_max_f32 v48, 0, v48
    v_max_f32 v49, 0, v49
    v_add_f32 v48, v48, v50
    v_add_f32 v49, v49, v51
    v_min_f32 v56, v48, v49
    v_cvt_pk_bf16_f32 v24, v48, v49
    v_cvt_pk_bf16_f32 v25, v114, v115
    v_lshlrev_b32 v48, 16, v25
    v_and_b32 v49, 0xffff0000, v25
    v_mul_f32 v50, s72, v48
    v_mul_f32 v51, s72, v49
    v_exp_f32 v50, v50 clamp
    v_exp_f32 v51, v51 clamp
    v_max_f32 v48, 0, v48
    v_max_f32 v49, 0, v49
    v_add_f32 v48, v48, v50
    v_add_f32 v49, v49, v51
    v_min3_f32 v56, v48, v49, v56
    v_cvt_pk_bf16_f32 v25, v48, v49
    v_cvt_pk_bf16_f32 v26, v116, v117
    v_lshlrev_b32 v48, 16, v26
    v_and_b32 v49, 0xffff0000, v26
    v_mul_f32 v50, s72, v48
    v_mul_f32 v51, s72, v49
    v_exp_f32 v50, v50 clamp
    v_exp_f32 v51, v51 clamp
    v_max_f32 v48, 0, v48
    v_max_f32 v49, 0, v49
    v_add_f32 v48, v48, v50
    v_add_f32 v49, v49, v51
    v_min3_f32 v56, v48, v49, v56
    v_cvt_pk_bf16_f32 v26, v48, v49
    v_cvt_pk_bf16_f32 v27, v118, v119
    v_lshlrev_b32 v48, 16, v27
    v_and_b32 v49, 0xffff0000, v27
    v_mul_f32 v50, s72, v48
    v_mul_f32 v51, s72, v49
    v_exp_f32 v50, v50 clamp
    v_exp_f32 v51, v51 clamp
    v_max_f32 v48, 0, v48
    v_max_f32 v49, 0, v49
    v_add_f32 v48, v48, v50
    v_add_f32 v49, v49, v51
    v_min3_f32 v56, v48, v49, v56
    v_cvt_pk_bf16_f32 v27, v48, v49
    v_cvt_pk_bf16_f32 v28, v120, v121
    v_lshlrev_b32 v48, 16, v28
    v_and_b32 v49, 0xffff0000, v28
    v_mul_f32 v50, s72, v48
    v_mul_f32 v51, s72, v49
    v_exp_f32 v50, v50 clamp
    v_exp_f32 v51, v51 clamp
    v_max_f32 v48, 0, v48
    v_max_f32 v49, 0, v49
    v_add_f32 v48, v48, v50
    v_add_f32 v49, v49, v51
    v_min3_f32 v56, v48, v49, v56
    v_cvt_pk_bf16_f32 v28, v48, v49
    v_cvt_pk_bf16_f32 v29, v122, v123
    v_lshlrev_b32 v48, 16, v29
    v_and_b32 v49, 0xffff0000, v29
    v_mul_f32 v50, s72, v48
    v_mul_f32 v51, s72, v49
    v_exp_f32 v50, v50 clamp
    v_exp_f32 v51, v51 clamp
    v_max_f32 v48, 0, v48
    v_max_f32 v49, 0, v49
    v_add_f32 v48, v48, v50
    v_add_f32 v49, v49, v51
    v_min3_f32 v56, v48, v49, v56
    v_cvt_pk_bf16_f32 v29, v48, v49
    v_cvt_pk_bf16_f32 v30, v124, v125
    v_lshlrev_b32 v48, 16, v30
    v_and_b32 v49, 0xffff0000, v30
    v_mul_f32 v50, s72, v48
    v_mul_f32 v51, s72, v49
    v_exp_f32 v50, v50 clamp
    v_exp_f32 v51, v51 clamp
    v_max_f32 v48, 0, v48
    v_max_f32 v49, 0, v49
    v_add_f32 v48, v48, v50
    v_add_f32 v49, v49, v51
    v_min3_f32 v56, v48, v49, v56
    v_cvt_pk_bf16_f32 v30, v48, v49
    v_cvt_pk_bf16_f32 v31, v126, v127
    v_lshlrev_b32 v48, 16, v31
    v_and_b32 v49, 0xffff0000, v31
    v_mul_f32 v50, s72, v48
    v_mul_f32 v51, s72, v49
    v_exp_f32 v50, v50 clamp
    v_exp_f32 v51, v51 clamp
    v_max_f32 v48, 0, v48
    v_max_f32 v49, 0, v49
    v_add_f32 v48, v48, v50
    v_add_f32 v49, v49, v51
    v_min3_f32 v56, v48, v49, v56
    v_cvt_pk_bf16_f32 v31, v48, v49
    v_cmp_gt_f32 vcc, 0x3a800000, v56
    s_cbranch_vccnz phi_16_fix
phi_16_done:
    v_cvt_pk_bf16_f32 v40, v144, v145
    v_cvt_pk_bf16_f32 v41, v146, v147
    v_mfma_f32_16x16x32_bf16 v[96:99], v[236:239], v[24:27], v[96:99]
    v_cvt_pk_bf16_f32 v42, v148, v149
    v_mfma_f32_16x16x32_bf16 v[60:63], v[236:239], v[28:31], v[60:63]
    v_cvt_pk_bf16_f32 v43, v150, v151
    v_cvt_pk_bf16_f32 v44, v152, v153
    v_cvt_pk_bf16_f32 v45, v154, v155
    v_mfma_f32_16x16x32_bf16 v[240:243], v[24:27], v[40:43], v[240:243]
    v_cvt_pk_bf16_f32 v46, v156, v157
    v_mfma_f32_16x16x32_bf16 v[244:247], v[28:31], v[40:43], v[244:247]
    v_cvt_pk_bf16_f32 v47, v158, v159
    s_nop 1
    v_mfma_f32_16x16x32_bf16 v[248:251], v[24:27], v[44:47], v[248:251]
    v_mfma_f32_16x16x32_bf16 v[252:255], v[28:31], v[44:47], v[252:255]
    s_cmp_eq_u32 s6, 0
    s_cbranch_scc0 C_ex1
    ds_write_b32 v227, v60 offset:4608
    s_nop 5
    ds_write_b128 v224, v[248:251] offset:32768
    ds_write_b128 v224, v[252:255] offset:33792
C_ex2:
    ds_write_b32 v229, v231 offset:4288
C_ps:
    ds_read_b32 v25, v230 offset:4288
    ds_read_b128 v[16:19], v225 offset:32768
    ds_read_b128 v[20:23], v225 offset:33792
    ds_read_b32 v24, v228 offset:4608
    s_waitcnt lgkmcnt(0)
    v_cmp_eq_u32 vcc, 0, v25
    s_cbranch_vccnz C_ps
    v_add_f32 v16, v16, v240
    v_add_f32 v17, v17, v241
    v_add_f32 v18, v18, v242
    v_add_f32 v19, v19, v243
    v_add_f32 v20, v20, v244
    v_add_f32 v21, v21, v245
    v_add_f32 v22, v22, v246
    v_add_f32 v23, v23, v247
    v_add_f32 v24, v24, v96
    v_cvt_pk_bf16_f32 v28, v16, v17
    v_cvt_pk_bf16_f32 v29, v18, v19
    v_cvt_pk_bf16_f32 v30, v20, v21
    v_cvt_pk_bf16_f32 v31, v22, v23
    buffer_store_dwordx4 v[28:31], v3, s[16:19], s43 offen sc0 sc1
    s_mov_b64 exec, 0xffff
    buffer_store_dword v24, v232, s[16:19], s43 offen offset:1024 sc0 sc1
    s_mov_b64 exec, 1
    buffer_atomic_or v233, v234, s[16:19], 0 offen
    s_mov_b64 exec, -1
    ds_read_b64_tr_b16 v[96:97], v10 offset:0
    ds_read_b64_tr_b16 v[98:99], v10 offset:512
    ds_read_b64_tr_b16 v[100:101], v11 offset:0
    ds_read_b64_tr_b16 v[102:103], v11 offset:512
    ds_read_b64_tr_b16 v[104:105], v10 offset:4096
    ds_read_b64_tr_b16 v[106:107], v10 offset:4608
    ds_read_b64_tr_b16 v[108:109], v11 offset:4096
    ds_read_b64_tr_b16 v[110:111], v11 offset:4608
    ds_read_b64_tr_b16 v[112:113], v6 offset:0
    ds_read_b64_tr_b16 v[114:115], v6 offset:512
    ds_read_b64_tr_b16 v[116:117], v7 offset:0
    ds_read_b64_tr_b16 v[118:119], v7 offset:512
    ds_read_b64_tr_b16 v[120:121], v6 offset:4096
    ds_read_b64_tr_b16 v[122:123], v6 offset:4608
    ds_read_b64_tr_b16 v[124:125], v7 offset:4096
    ds_read_b64_tr_b16 v[126:127], v7 offset:4608
    s_waitcnt lgkmcnt(12)
    v_mfma_f32_16x16x32_bf16 v[64:67], v[96:99], v[192:195], v[64:67]
    v_mfma_f32_16x16x32_bf16 v[72:75], v[96:99], v[196:199], v[72:75]
    v_mfma_f32_16x16x32_bf16 v[80:83], v[96:99], v[200:203], v[80:83]
    v_mfma_f32_16x16x32_bf16 v[88:91], v[96:99], v[204:207], v[88:91]
    v_mfma_f32_16x16x32_bf16 v[68:71], v[100:103], v[192:195], v[68:71]
    v_mfma_f32_16x16x32_bf16 v[76:79], v[100:103], v[196:199], v[76:79]
    v_mfma_f32_16x16x32_bf16 v[84:87], v[100:103], v[200:203], v[84:87]
    v_mfma_f32_16x16x32_bf16 v[92:95], v[100:103], v[204:207], v[92:95]
    s_waitcnt lgkmcnt(8)
    v_mfma_f32_16x16x32_bf16 v[64:67], v[104:107], v[160:163], v[64:67]
    v_mfma_f32_16x16x32_bf16 v[72:75], v[104:107], v[164:167], v[72:75]
    v_mfma_f32_16x16x32_bf16 v[80:83], v[104:107], v[168:171], v[80:83]
    v_mfma_f32_16x16x32_bf16 v[88:91], v[104:107], v[172:175], v[88:91]
    v_mfma_f32_16x16x32_bf16 v[68:71], v[108:111], v[160:163], v[68:71]
    v_mfma_f32_16x16x32_bf16 v[76:79], v[108:111], v[164:167], v[76:79]
    v_mfma_f32_16x16x32_bf16 v[84:87], v[108:111], v[168:171], v[84:87]
    v_mfma_f32_16x16x32_bf16 v[92:95], v[108:111], v[172:175], v[92:95]
    s_waitcnt lgkmcnt(4)
    v_mfma_f32_16x16x32_bf16 v[64:67], v[112:115], v[176:179], v[64:67]
    v_mfma_f32_16x16x32_bf16 v[72:75], v[112:115], v[180:183], v[72:75]
    v_mfma_f32_16x16x32_bf16 v[80:83], v[112:115], v[184:187], v[80:83]
    v_mfma_f32_16x16x32_bf16 v[88:91], v[112:115], v[188:191], v[88:91]
    v_mfma_f32_16x16x32_bf16 v[68:71], v[116:119], v[176:179], v[68:71]
    v_mfma_f32_16x16x32_bf16 v[76:79], v[116:119], v[180:183], v[76:79]
    v_mfma_f32_16x16x32_bf16 v[84:87], v[116:119], v[184:187], v[84:87]
    v_mfma_f32_16x16x32_bf16 v[92:95], v[116:119], v[188:191], v[92:95]
    s_waitcnt lgkmcnt(0)
    v_mfma_f32_16x16x32_bf16 v[64:67], v[120:123], v[208:211], v[64:67]
    v_mfma_f32_16x16x32_bf16 v[72:75], v[120:123], v[212:215], v[72:75]
    v_mfma_f32_16x16x32_bf16 v[80:83], v[120:123], v[216:219], v[80:83]
    v_mfma_f32_16x16x32_bf16 v[88:91], v[120:123], v[220:223], v[88:91]
    v_mfma_f32_16x16x32_bf16 v[68:71], v[124:127], v[208:211], v[68:71]
    v_mfma_f32_16x16x32_bf16 v[76:79], v[124:127], v[212:215], v[76:79]
    v_mfma_f32_16x16x32_bf16 v[84:87], v[124:127], v[216:219], v[84:87]
    v_mfma_f32_16x16x32_bf16 v[92:95], v[124:127], v[220:223], v[92:95]
    s_and_b32 s64, s3, 3
    s_lshl_b32 s64, s64, 1
    s_lshr_b32 s65, s3, 2
    s_add_u32 s64, s64, s65
    s_lshl_b32 s64, s64, 4
    s_lshl_b32 s65, s4, 7
    s_add_u32 s64, s64, s65
    v_and_b32 v230, 15, v2
    v_add_u32 v230, s64, v230
    v_bfe_u32 v3, v2, 4, 1
    v_lshlrev_b32 v229, 5, v3
    v_lshrrev_b32 v3, 5, v2
    v_lshl_add_u32 v229, v3, 4, v229
    v_lshl_add_u32 v231, v230, 11, v229
    s_lshl_b32 s64, s5, 7
    v_add_u32 v231, s64, v231
    v_lshlrev_b32 v3, 2, v230
    v_add_u32 v3, 6709248, v3
    buffer_load_dwordx4 v[220:223], v231, s[8:11], 0 offen
    buffer_load_dwordx4 v[224:227], v231, s[8:11], 0 offen offset:64
    buffer_load_dword v228, v3, s[16:19], 0 offen sc1
    v_lshlrev_b32 v3, 4, v2
    s_lshl_b32 s64, s7, 11
    v_add_u32 v4, s64, v3
    v_lshrrev_b32 v5, 4, v2
    v_lshlrev_b32 v5, 4, v5
    s_lshl_b32 s64, s7, 6
    v_add_u32 v5, s64, v5
    v_mov_b32 v6, 4256
    ds_read_b32 v6, v6
    v_cvt_pk_bf16_f32 v32, v64, v65
    v_lshlrev_b32 v48, 16, v32
    v_and_b32 v49, 0xffff0000, v32
    v_mul_f32 v50, s72, v48
    v_mul_f32 v51, s72, v49
    v_exp_f32 v50, v50 clamp
    v_exp_f32 v51, v51 clamp
    v_max_f32 v48, 0, v48
    v_max_f32 v49, 0, v49
    v_add_f32 v48, v48, v50
    v_add_f32 v49, v49, v51
    v_min_f32 v56, v48, v49
    v_cvt_pk_bf16_f32 v32, v48, v49
    v_cvt_pk_bf16_f32 v33, v66, v67
    v_lshlrev_b32 v48, 16, v33
    v_and_b32 v49, 0xffff0000, v33
    v_mul_f32 v50, s72, v48
    v_mul_f32 v51, s72, v49
    v_exp_f32 v50, v50 clamp
    v_exp_f32 v51, v51 clamp
    v_max_f32 v48, 0, v48
    v_max_f32 v49, 0, v49
    v_add_f32 v48, v48, v50
    v_add_f32 v49, v49, v51
    v_min3_f32 v56, v48, v49, v56
    v_cvt_pk_bf16_f32 v33, v48, v49
    v_cvt_pk_bf16_f32 v34, v68, v69
    v_lshlrev_b32 v48, 16, v34
    v_and_b32 v49, 0xffff0000, v34
    v_mul_f32 v50, s72, v48
    v_mul_f32 v51, s72, v49
    v_exp_f32 v50, v50 clamp
    v_exp_f32 v51, v51 clamp
    v_max_f32 v48, 0, v48
    v_max_f32 v49, 0, v49
    v_add_f32 v48, v48, v50
    v_add_f32 v49, v49, v51
    v_min3_f32 v56, v48, v49, v56
    v_cvt_pk_bf16_f32 v34, v48, v49
    v_cvt_pk_bf16_f32 v35, v70, v71
    v_lshlrev_b32 v48, 16, v35
    v_and_b32 v49, 0xffff0000, v35
    v_mul_f32 v50, s72, v48
    v_mul_f32 v51, s72, v49
    v_exp_f32 v50, v50 clamp
    v_exp_f32 v51, v51 clamp
    v_max_f32 v48, 0, v48
    v_max_f32 v49, 0, v49
    v_add_f32 v48, v48, v50
    v_add_f32 v49, v49, v51
    v_min3_f32 v56, v48, v49, v56
    v_cvt_pk_bf16_f32 v35, v48, v49
    v_cvt_pk_bf16_f32 v36, v72, v73
    v_lshlrev_b32 v48, 16, v36
    v_and_b32 v49, 0xffff0000, v36
    v_mul_f32 v50, s72, v48
    v_mul_f32 v51, s72, v49
    v_exp_f32 v50, v50 clamp
    v_exp_f32 v51, v51 clamp
    v_max_f32 v48, 0, v48
    v_max_f32 v49, 0, v49
    v_add_f32 v48, v48, v50
    v_add_f32 v49, v49, v51
    v_min3_f32 v56, v48, v49, v56
    v_cvt_pk_bf16_f32 v36, v48, v49
    v_cvt_pk_bf16_f32 v37, v74, v75
    v_lshlrev_b32 v48, 16, v37
    v_and_b32 v49, 0xffff0000, v37
    v_mul_f32 v50, s72, v48
    v_mul_f32 v51, s72, v49
    v_exp_f32 v50, v50 clamp
    v_exp_f32 v51, v51 clamp
    v_max_f32 v48, 0, v48
    v_max_f32 v49, 0, v49
    v_add_f32 v48, v48, v50
    v_add_f32 v49, v49, v51
    v_min3_f32 v56, v48, v49, v56
    v_cvt_pk_bf16_f32 v37, v48, v49
    v_cvt_pk_bf16_f32 v38, v76, v77
    v_lshlrev_b32 v48, 16, v38
    v_and_b32 v49, 0xffff0000, v38
    v_mul_f32 v50, s72, v48
    v_mul_f32 v51, s72, v49
    v_exp_f32 v50, v50 clamp
    v_exp_f32 v51, v51 clamp
    v_max_f32 v48, 0, v48
    v_max_f32 v49, 0, v49
    v_add_f32 v48, v48, v50
    v_add_f32 v49, v49, v51
    v_min3_f32 v56, v48, v49, v56
    v_cvt_pk_bf16_f32 v38, v48, v49
    v_cvt_pk_bf16_f32 v39, v78, v79
    v_lshlrev_b32 v48, 16, v39
    v_and_b32 v49, 0xffff0000, v39
    v_mul_f32 v50, s72, v48
    v_mul_f32 v51, s72, v49
    v_exp_f32 v50, v50 clamp
    v_exp_f32 v51, v51 clamp
    v_max_f32 v48, 0, v48
    v_max_f32 v49, 0, v49
    v_add_f32 v48, v48, v50
    v_add_f32 v49, v49, v51
    v_min3_f32 v56, v48, v49, v56
    v_cvt_pk_bf16_f32 v39, v48, v49
    v_cmp_gt_f32 vcc, 0x3a800000, v56
    s_cbranch_vccnz phi_17_fix
phi_17_done:
    v_cvt_pk_bf16_f32 v40, v80, v81
    v_lshlrev_b32 v48, 16, v40
    v_and_b32 v49, 0xffff0000, v40
    v_mul_f32 v50, s72, v48
    v_mul_f32 v51, s72, v49
    v_exp_f32 v50, v50 clamp
    v_exp_f32 v51, v51 clamp
    v_max_f32 v48, 0, v48
    v_max_f32 v49, 0, v49
    v_add_f32 v48, v48, v50
    v_add_f32 v49, v49, v51
    v_min_f32 v56, v48, v49
    v_cvt_pk_bf16_f32 v40, v48, v49
    v_cvt_pk_bf16_f32 v41, v82, v83
    v_lshlrev_b32 v48, 16, v41
    v_and_b32 v49, 0xffff0000, v41
    v_mul_f32 v50, s72, v48
    v_mul_f32 v51, s72, v49
    v_exp_f32 v50, v50 clamp
    v_exp_f32 v51, v51 clamp
    v_max_f32 v48, 0, v48
    v_max_f32 v49, 0, v49
    v_add_f32 v48, v48, v50
    v_add_f32 v49, v49, v51
    v_min3_f32 v56, v48, v49, v56
    v_cvt_pk_bf16_f32 v41, v48, v49
    v_cvt_pk_bf16_f32 v42, v84, v85
    v_lshlrev_b32 v48, 16, v42
    v_and_b32 v49, 0xffff0000, v42
    v_mul_f32 v50, s72, v48
    v_mul_f32 v51, s72, v49
    v_exp_f32 v50, v50 clamp
    v_exp_f32 v51, v51 clamp
    v_max_f32 v48, 0, v48
    v_max_f32 v49, 0, v49
    v_add_f32 v48, v48, v50
    v_add_f32 v49, v49, v51
    v_min3_f32 v56, v48, v49, v56
    v_cvt_pk_bf16_f32 v42, v48, v49
    v_cvt_pk_bf16_f32 v43, v86, v87
    v_lshlrev_b32 v48, 16, v43
    v_and_b32 v49, 0xffff0000, v43
    v_mul_f32 v50, s72, v48
    v_mul_f32 v51, s72, v49
    v_exp_f32 v50, v50 clamp
    v_exp_f32 v51, v51 clamp
    v_max_f32 v48, 0, v48
    v_max_f32 v49, 0, v49
    v_add_f32 v48, v48, v50
    v_add_f32 v49, v49, v51
    v_min3_f32 v56, v48, v49, v56
    v_cvt_pk_bf16_f32 v43, v48, v49
    v_cvt_pk_bf16_f32 v44, v88, v89
    v_lshlrev_b32 v48, 16, v44
    v_and_b32 v49, 0xffff0000, v44
    v_mul_f32 v50, s72, v48
    v_mul_f32 v51, s72, v49
    v_exp_f32 v50, v50 clamp
    v_exp_f32 v51, v51 clamp
    v_max_f32 v48, 0, v48
    v_max_f32 v49, 0, v49
    v_add_f32 v48, v48, v50
    v_add_f32 v49, v49, v51
    v_min3_f32 v56, v48, v49, v56
    v_cvt_pk_bf16_f32 v44, v48, v49
    v_cvt_pk_bf16_f32 v45, v90, v91
    v_lshlrev_b32 v48, 16, v45
    v_and_b32 v49, 0xffff0000, v45
    v_mul_f32 v50, s72, v48
    v_mul_f32 v51, s72, v49
    v_exp_f32 v50, v50 clamp
    v_exp_f32 v51, v51 clamp
    v_max_f32 v48, 0, v48
    v_max_f32 v49, 0, v49
    v_add_f32 v48, v48, v50
    v_add_f32 v49, v49, v51
    v_min3_f32 v56, v48, v49, v56
    v_cvt_pk_bf16_f32 v45, v48, v49
    v_cvt_pk_bf16_f32 v46, v92, v93
    v_lshlrev_b32 v48, 16, v46
    v_and_b32 v49, 0xffff0000, v46
    v_mul_f32 v50, s72, v48
    v_mul_f32 v51, s72, v49
    v_exp_f32 v50, v50 clamp
    v_exp_f32 v51, v51 clamp
    v_max_f32 v48, 0, v48
    v_max_f32 v49, 0, v49
    v_add_f32 v48, v48, v50
    v_add_f32 v49, v49, v51
    v_min3_f32 v56, v48, v49, v56
    v_cvt_pk_bf16_f32 v46, v48, v49
    v_cvt_pk_bf16_f32 v47, v94, v95
    v_lshlrev_b32 v48, 16, v47
    v_and_b32 v49, 0xffff0000, v47
    v_mul_f32 v50, s72, v48
    v_mul_f32 v51, s72, v49
    v_exp_f32 v50, v50 clamp
    v_exp_f32 v51, v51 clamp
    v_max_f32 v48, 0, v48
    v_max_f32 v49, 0, v49
    v_add_f32 v48, v48, v50
    v_add_f32 v49, v49, v51
    v_min3_f32 v56, v48, v49, v56
    v_cvt_pk_bf16_f32 v47, v48, v49
    v_cmp_gt_f32 vcc, 0x3a800000, v56
    s_cbranch_vccnz phi_18_fix
phi_18_done:
    s_waitcnt lgkmcnt(0)
    v_readfirstlane_b32 s75, v6
    s_waitcnt vmcnt(0)
    v_sub_f32 v248, 1.0, v228
    v_cvt_pk_bf16_f32 v248, v248, v248
    v_lshlrev_b32 v248, 16, v248
    v_lshlrev_b32 v232, 16, v220
    v_and_b32 v233, 0xffff0000, v220
    v_mul_f32 v232, v232, v248
    v_mul_f32 v233, v233, v248
    v_cvt_pk_bf16_f32 v3, v232, v233
    v_lshlrev_b32 v232, 16, v3
    v_and_b32 v233, 0xffff0000, v3
    v_lshlrev_b32 v234, 16, v221
    v_and_b32 v235, 0xffff0000, v221
    v_mul_f32 v234, v234, v248
    v_mul_f32 v235, v235, v248
    v_cvt_pk_bf16_f32 v3, v234, v235
    v_lshlrev_b32 v234, 16, v3
    v_and_b32 v235, 0xffff0000, v3
    v_lshlrev_b32 v236, 16, v222
    v_and_b32 v237, 0xffff0000, v222
    v_mul_f32 v236, v236, v248
    v_mul_f32 v237, v237, v248
    v_cvt_pk_bf16_f32 v3, v236, v237
    v_lshlrev_b32 v236, 16, v3
    v_and_b32 v237, 0xffff0000, v3
    v_lshlrev_b32 v238, 16, v223
    v_and_b32 v239, 0xffff0000, v223
    v_mul_f32 v238, v238, v248
    v_mul_f32 v239, v239, v248
    v_cvt_pk_bf16_f32 v3, v238, v239
    v_lshlrev_b32 v238, 16, v3
    v_and_b32 v239, 0xffff0000, v3
    v_lshlrev_b32 v240, 16, v224
    v_and_b32 v241, 0xffff0000, v224
    v_mul_f32 v240, v240, v248
    v_mul_f32 v241, v241, v248
    v_cvt_pk_bf16_f32 v3, v240, v241
    v_lshlrev_b32 v240, 16, v3
    v_and_b32 v241, 0xffff0000, v3
    v_lshlrev_b32 v242, 16, v225
    v_and_b32 v243, 0xffff0000, v225
    v_mul_f32 v242, v242, v248
    v_mul_f32 v243, v243, v248
    v_cvt_pk_bf16_f32 v3, v242, v243
    v_lshlrev_b32 v242, 16, v3
    v_and_b32 v243, 0xffff0000, v3
    v_lshlrev_b32 v244, 16, v226
    v_and_b32 v245, 0xffff0000, v226
    v_mul_f32 v244, v244, v248
    v_mul_f32 v245, v245, v248
    v_cvt_pk_bf16_f32 v3, v244, v245
    v_lshlrev_b32 v244, 16, v3
    v_and_b32 v245, 0xffff0000, v3
    v_lshlrev_b32 v246, 16, v227
    v_and_b32 v247, 0xffff0000, v227
    v_mul_f32 v246, v246, v248
    v_mul_f32 v247, v247, v248
    v_cvt_pk_bf16_f32 v3, v246, v247
    v_lshlrev_b32 v246, 16, v3
    v_and_b32 v247, 0xffff0000, v3
    s_cmp_lg_u32 s3, 0
    s_cbranch_scc1 C_nh
    s_lshr_b32 s64, s2, 2
    s_lshl_b32 s64, s64, 14
    s_add_u32 s64, s64, 5398528
    v_lshl_add_u32 v16, v2, 4, s64
    v_lshrrev_b32 v8, 4, v2
    s_mov_b32 s65, 0
H_hl:
    s_mov_b32 s64, 0
    buffer_load_dwordx4 v[64:67], v16, s[16:19], s64 offen offset:0 sc1
    s_mov_b32 s64, 0
    buffer_load_dwordx4 v[68:71], v16, s[16:19], s64 offen offset:1024 sc1
    s_mov_b32 s64, 0
    buffer_load_dwordx4 v[72:75], v16, s[16:19], s64 offen offset:2048 sc1
    s_mov_b32 s64, 0
    buffer_load_dwordx4 v[76:79], v16, s[16:19], s64 offen offset:3072 sc1
    s_mov_b32 s64, 4096
    buffer_load_dwordx4 v[80:83], v16, s[16:19], s64 offen offset:0 sc1
    s_mov_b32 s64, 4096
    buffer_load_dwordx4 v[84:87], v16, s[16:19], s64 offen offset:1024 sc1
    s_mov_b32 s64, 4096
    buffer_load_dwordx4 v[88:91], v16, s[16:19], s64 offen offset:2048 sc1
    s_mov_b32 s64, 4096
    buffer_load_dwordx4 v[92:95], v16, s[16:19], s64 offen offset:3072 sc1
    s_mov_b32 s64, 8192
    buffer_load_dwordx4 v[96:99], v16, s[16:19], s64 offen offset:0 sc1
    s_mov_b32 s64, 8192
    buffer_load_dwordx4 v[100:103], v16, s[16:19], s64 offen offset:1024 sc1
    s_mov_b32 s64, 8192
    buffer_load_dwordx4 v[104:107], v16, s[16:19], s64 offen offset:2048 sc1
    s_mov_b32 s64, 8192
    buffer_load_dwordx4 v[108:111], v16, s[16:19], s64 offen offset:3072 sc1
    s_mov_b32 s64, 12288
    buffer_load_dwordx4 v[112:115], v16, s[16:19], s64 offen offset:0 sc1
    s_mov_b32 s64, 12288
    buffer_load_dwordx4 v[116:119], v16, s[16:19], s64 offen offset:1024 sc1
    s_mov_b32 s64, 12288
    buffer_load_dwordx4 v[120:123], v16, s[16:19], s64 offen offset:2048 sc1
    s_mov_b32 s64, 12288
    buffer_load_dwordx4 v[124:127], v16, s[16:19], s64 offen offset:3072 sc1
    s_waitcnt vmcnt(0)
    v_max3_u32 v17, v64, v65, v66
    v_max3_u32 v17, v67, v68, v17
    v_max3_u32 v17, v69, v70, v17
    v_max3_u32 v17, v71, v72, v17
    v_max3_u32 v17, v73, v74, v17
    v_max3_u32 v17, v75, v76, v17
    v_max3_u32 v17, v77, v78, v17
    v_max3_u32 v17, v79, v80, v17
    v_max3_u32 v17, v81, v82, v17
    v_max3_u32 v17, v83, v84, v17
    v_max3_u32 v17, v85, v86, v17
    v_max3_u32 v17, v87, v88, v17
    v_max3_u32 v17, v89, v90, v17
    v_max3_u32 v17, v91, v92, v17
    v_max3_u32 v17, v93, v94, v17
    v_max3_u32 v17, v95, v96, v17
    v_max3_u32 v17, v97, v98, v17
    v_max3_u32 v17, v99, v100, v17
    v_max3_u32 v17, v101, v102, v17
    v_max3_u32 v17, v103, v104, v17
    v_max3_u32 v17, v105, v106, v17
    v_max3_u32 v17, v107, v108, v17
    v_max3_u32 v17, v109, v110, v17
    v_max3_u32 v17, v111, v112, v17
    v_max3_u32 v17, v113, v114, v17
    v_max3_u32 v17, v115, v116, v17
    v_max3_u32 v17, v117, v118, v17
    v_max3_u32 v17, v119, v120, v17
    v_max3_u32 v17, v121, v122, v17
    v_max3_u32 v17, v123, v124, v17
    v_max3_u32 v17, v125, v126, v17
    v_max_u32 v17, v127, v17
    s_mov_b32 exec_lo, 0x3fff3fff
    s_mov_b32 exec_hi, 0x3fff3fff
    v_cmp_eq_u32 vcc, -1, v17
    s_mov_b64 exec, -1
    s_cbranch_vccz H_hok
    s_add_u32 s65, s65, 1
    s_cmp_ge_u32 s65, 100000
    s_cbranch_scc1 H_hok
    s_sleep 8
    s_branch H_hl
H_hok:
    v_add_f32 v64, v64, v68
    v_add_f32 v65, v65, v69
    v_add_f32 v66, v66, v70
    v_add_f32 v67, v67, v71
    v_add_f32 v64, v64, v72
    v_add_f32 v65, v65, v73
    v_add_f32 v66, v66, v74
    v_add_f32 v67, v67, v75
    v_add_f32 v64, v64, v76
    v_add_f32 v65, v65, v77
    v_add_f32 v66, v66, v78
    v_add_f32 v67, v67, v79
    v_add_f32 v64, v64, v80
    v_add_f32 v65, v65, v81
    v_add_f32 v66, v66, v82
    v_add_f32 v67, v67, v83
    v_add_f32 v64, v64, v84
    v_add_f32 v65, v65, v85
    v_add_f32 v66, v66, v86
    v_add_f32 v67, v67, v87
    v_add_f32 v64, v64, v88
    v_add_f32 v65, v65, v89
    v_add_f32 v66, v66, v90
    v_add_f32 v67, v67, v91
    v_add_f32 v64, v64, v92
    v_add_f32 v65, v65, v93
    v_add_f32 v66, v66, v94
    v_add_f32 v67, v67, v95
    v_add_f32 v96, v96, v100
    v_add_f32 v97, v97, v101
    v_add_f32 v98, v98, v102
    v_add_f32 v99, v99, v103
    v_add_f32 v96, v96, v104
    v_add_f32 v97, v97, v105
    v_add_f32 v98, v98, v106
    v_add_f32 v99, v99, v107
    v_add_f32 v96, v96, v108
    v_add_f32 v97, v97, v109
    v_add_f32 v98, v98, v110
    v_add_f32 v99, v99, v111
    v_add_f32 v96, v96, v112
    v_add_f32 v97, v97, v113
    v_add_f32 v98, v98, v114
    v_add_f32 v99, v99, v115
    v_add_f32 v96, v96, v116
    v_add_f32 v97, v97, v117
    v_add_f32 v98, v98, v118
    v_add_f32 v99, v99, v119
    v_add_f32 v96, v96, v120
    v_add_f32 v97, v97, v121
    v_add_f32 v98, v98, v122
    v_add_f32 v99, v99, v123
    v_add_f32 v96, v96, v124
    v_add_f32 v97, v97, v125
    v_add_f32 v98, v98, v126
    v_add_f32 v99, v99, v127
    s_nop 1
    v_permlane16_swap_b32 v64, v96
    v_permlane16_swap_b32 v65, v97
    v_permlane16_swap_b32 v66, v98
    v_permlane16_swap_b32 v67, v99
    v_add_f32 v64, v64, v96
    v_add_f32 v65, v65, v97
    v_add_f32 v66, v66, v98
    v_add_f32 v67, v67, v99
    s_nop 1
    v_permlane32_swap_b32 v64, v66
    v_permlane32_swap_b32 v65, v67
    v_add_f32 v64, v64, v66
    v_add_f32 v65, v65, v67
    s_nop 1
    v_permlane16_swap_b32 v64, v65
    v_cvt_pk_bf16_f32 v66, v64, v65
    v_lshlrev_b32 v64, 16, v66
    v_and_b32 v65, 0xffff0000, v66
    v_mul_f32 v66, s72, v64
    v_exp_f32 v66, -v66
    v_and_b32 v16, 15, v2
    v_add_f32 v66, 1.0, v66
    v_rcp_f32 v66, v66
    v_lshl_add_u32 v16, v16, 2, v8
    v_mul_f32 v66, v66, v64
    v_cvt_pk_bf16_f32 v66, v66, v66
    v_lshlrev_b32 v66, 16, v66
    v_mul_f32 v66, v66, v65
    v_cvt_pk_bf16_f32 v66, v66, v66
    v_lshlrev_b32 v66, 16, v66
    v_lshlrev_b32 v16, 2, v16
    ds_write_b32 v16, v66 offset:4352
    s_waitcnt lgkmcnt(0)
C_nh:
    v_lshlrev_b32 v3, 4, v2
    s_barrier
    ds_read_b128 v[24:27], v5 offset:4096
    ds_read_b128 v[16:19], v4 offset:0
    ds_read_b128 v[20:23], v4 offset:1024
    s_waitcnt lgkmcnt(2)
    v_mfma_f32_16x16x32_bf16 v[96:99], v[24:27], v[32:35], 0
    v_mfma_f32_16x16x32_bf16 v[100:103], v[24:27], v[36:39], 0
    v_mfma_f32_16x16x32_bf16 v[104:107], v[24:27], v[40:43], 0
    v_mfma_f32_16x16x32_bf16 v[108:111], v[24:27], v[44:47], 0
    s_waitcnt lgkmcnt(0)
    v_mfma_f32_16x16x32_bf16 v[64:67], v[16:19], v[32:35], 0
    v_mfma_f32_16x16x32_bf16 v[68:71], v[20:23], v[32:35], 0
    v_mfma_f32_16x16x32_bf16 v[72:75], v[16:19], v[36:39], 0
    v_mfma_f32_16x16x32_bf16 v[76:79], v[20:23], v[36:39], 0
    v_mfma_f32_16x16x32_bf16 v[80:83], v[16:19], v[40:43], 0
    v_mfma_f32_16x16x32_bf16 v[84:87], v[20:23], v[40:43], 0
    v_mfma_f32_16x16x32_bf16 v[88:91], v[16:19], v[44:47], 0
    v_mfma_f32_16x16x32_bf16 v[92:95], v[20:23], v[44:47], 0
    v_cvt_pk_bf16_f32 v48, v96, v96
    v_cvt_pk_bf16_f32 v49, v100, v100
    v_cvt_pk_bf16_f32 v50, v104, v104
    v_cvt_pk_bf16_f32 v51, v108, v108
    v_lshlrev_b32 v48, 16, v48
    v_lshlrev_b32 v49, 16, v49
    v_lshlrev_b32 v50, 16, v50
    v_lshlrev_b32 v51, 16, v51
    v_add_f32 v48, s73, v48
    v_add_f32 v49, s73, v49
    v_add_f32 v50, s73, v50
    v_add_f32 v51, s73, v51
    v_cvt_pk_bf16_f32 v48, v48, v48
    v_cvt_pk_bf16_f32 v49, v49, v49
    v_cvt_pk_bf16_f32 v50, v50, v50
    v_cvt_pk_bf16_f32 v51, v51, v51
    v_lshlrev_b32 v48, 16, v48
    v_lshlrev_b32 v49, 16, v49
    v_lshlrev_b32 v50, 16, v50
    v_lshlrev_b32 v51, 16, v51
    v_rcp_f32 v48, v48
    v_rcp_f32 v49, v49
    v_rcp_f32 v50, v50
    v_rcp_f32 v51, v51
    s_nop 0
    v_mul_f32 v64, v64, v48
    v_mul_f32 v65, v65, v48
    v_cvt_pk_bf16_f32 v128, v64, v65
    v_mul_f32 v66, v66, v48
    v_mul_f32 v67, v67, v48
    v_cvt_pk_bf16_f32 v129, v66, v67
    v_mul_f32 v68, v68, v48
    v_mul_f32 v69, v69, v48
    v_cvt_pk_bf16_f32 v130, v68, v69
    v_mul_f32 v70, v70, v48
    v_mul_f32 v71, v71, v48
    v_cvt_pk_bf16_f32 v131, v70, v71
    buffer_store_dwordx4 v[128:131], v3, s[16:19], s42 offen offset:0 sc0 sc1
    v_mul_f32 v72, v72, v49
    v_mul_f32 v73, v73, v49
    v_cvt_pk_bf16_f32 v132, v72, v73
    v_mul_f32 v74, v74, v49
    v_mul_f32 v75, v75, v49
    v_cvt_pk_bf16_f32 v133, v74, v75
    v_mul_f32 v76, v76, v49
    v_mul_f32 v77, v77, v49
    v_cvt_pk_bf16_f32 v134, v76, v77
    v_mul_f32 v78, v78, v49
    v_mul_f32 v79, v79, v49
    v_cvt_pk_bf16_f32 v135, v78, v79
    buffer_store_dwordx4 v[132:135], v3, s[16:19], s42 offen offset:1024 sc0 sc1
    s_add_u32 s42, s42, 65536
    v_mul_f32 v80, v80, v50
    v_mul_f32 v81, v81, v50
    v_cvt_pk_bf16_f32 v136, v80, v81
    v_mul_f32 v82, v82, v50
    v_mul_f32 v83, v83, v50
    v_cvt_pk_bf16_f32 v137, v82, v83
    v_mul_f32 v84, v84, v50
    v_mul_f32 v85, v85, v50
    v_cvt_pk_bf16_f32 v138, v84, v85
    v_mul_f32 v86, v86, v50
    v_mul_f32 v87, v87, v50
    v_cvt_pk_bf16_f32 v139, v86, v87
    buffer_store_dwordx4 v[136:139], v3, s[16:19], s42 offen offset:0 sc0 sc1
    v_mul_f32 v88, v88, v51
    v_mul_f32 v89, v89, v51
    v_cvt_pk_bf16_f32 v140, v88, v89
    v_mul_f32 v90, v90, v51
    v_mul_f32 v91, v91, v51
    v_cvt_pk_bf16_f32 v141, v90, v91
    v_mul_f32 v92, v92, v51
    v_mul_f32 v93, v93, v51
    v_cvt_pk_bf16_f32 v142, v92, v93
    v_mul_f32 v94, v94, v51
    v_mul_f32 v95, v95, v51
    v_cvt_pk_bf16_f32 v143, v94, v95
    buffer_store_dwordx4 v[140:143], v3, s[16:19], s42 offen offset:1024 sc0 sc1
    s_lshl_b32 s64, s4, 3
    s_add_u32 s64, s64, s3
    s_lshl_b32 s64, s64, 7
    s_add_u32 s64, s64, 5382144
    v_mov_b32 v14, s64
    s_mov_b64 exec, 1
    v_mov_b32 v15, 0
    buffer_atomic_or v15, v14, s[16:19], 0 offen sc0
    s_mov_b64 exec, -1
    s_waitcnt vmcnt(1)
    s_mov_b64 exec, 3
    buffer_atomic_or v13, v12, s[16:19], 0 offen
    s_mov_b64 exec, -1
P2_start:
    s_and_b32 s6, s3, 3
    s_lshr_b32 s7, s3, 2
    s_mov_b32 s20, s58
    s_mov_b32 s21, s59
    s_mov_b32 s22, 0x400000
    s_mov_b32 s23, 0x00020000
    s_and_b32 s67, s75, 0x7ff
    s_sub_u32 s67, 2047, s67
    s_lshl_b32 s64, s4, 2
    s_add_u32 s64, s64, s6
    s_lshl_b32 s64, s64, 16
    s_lshl_b32 s65, s7, 15
    s_add_u32 s64, s64, s65
    s_lshl_b32 s65, s7, 10
    s_add_u32 s66, s64, s65
    s_sub_u32 s64, s64, s65
    v_lshl_add_u32 v4, v2, 4, s66
    v_lshl_add_u32 v12, v2, 4, s64
    v_lshrrev_b32 v10, 4, v2
    v_bfe_u32 v11, v2, 2, 2
    v_lshl_add_u32 v10, v10, 2, v11
    v_bfe_u32 v13, v10, 1, 2
    v_lshlrev_b32 v10, 7, v10
    v_lshl_add_u32 v10, v13, 5, v10
    v_and_b32 v13, 3, v2
    v_lshl_add_u32 v5, v13, 3, v10
    v_xor_b32 v6, 32, v5
    v_xor_b32 v1, 64, v5
    v_xor_b32 v3, 96, v5
    s_and_b32 s74, s5, 7
    s_lshl_b32 s74, s74, 1
    s_cmp_eq_u32 s7, 0
    s_mov_b32 s64, 147456
    s_cselect_b32 s64, 131072, s64
    s_sub_u32 m0, 16, s74
    s_and_b32 m0, m0, 15
    v_writelane_b32 v7, s64, m0
    s_cmp_eq_u32 s7, 0
    s_mov_b32 s64, 155648
    s_cselect_b32 s64, 139264, s64
    s_sub_u32 m0, 18, s74
    s_and_b32 m0, m0, 15
    v_writelane_b32 v7, s64, m0
    s_cmp_eq_u32 s7, 0
    s_mov_b32 s64, 81920
    s_cselect_b32 s64, 73728, s64
    s_sub_u32 m0, 20, s74
    s_and_b32 m0, m0, 15
    v_writelane_b32 v7, s64, m0
    s_cmp_eq_u32 s7, 0
    s_mov_b32 s64, 122880
    s_cselect_b32 s64, 114688, s64
    s_sub_u32 m0, 22, s74
    s_and_b32 m0, m0, 15
    v_writelane_b32 v7, s64, m0
    s_cmp_eq_u32 s7, 0
    s_mov_b32 s64, 49152
    s_cselect_b32 s64, 40960, s64
    s_sub_u32 m0, 24, s74
    s_and_b32 m0, m0, 15
    v_writelane_b32 v7, s64, m0
    s_cmp_eq_u32 s7, 0
    s_mov_b32 s64, 57344
    s_cselect_b32 s64, 8192, s64
    s_sub_u32 m0, 26, s74
    s_and_b32 m0, m0, 15
    v_writelane_b32 v7, s64, m0
    s_cmp_eq_u32 s7, 0
    s_mov_b32 s64, 65536
    s_cselect_b32 s64, 16384, s64
    s_sub_u32 m0, 28, s74
    s_and_b32 m0, m0, 15
    v_writelane_b32 v7, s64, m0
    s_cmp_eq_u32 s7, 0
    s_mov_b32 s64, 90112
    s_cselect_b32 s64, 98304, s64
    s_sub_u32 m0, 30, s74
    s_and_b32 m0, m0, 15
    v_writelane_b32 v7, s64, m0
    s_cmp_eq_u32 s7, 0
    v_mov_b32 v16, 0
    v_mov_b32 v17, 0
    v_mov_b32 v18, 0
    v_mov_b32 v19, 0
    v_mov_b32 v20, 0
    v_mov_b32 v21, 0
    v_mov_b32 v22, 0
    v_mov_b32 v23, 0
    v_mov_b32 v24, 0
    v_mov_b32 v25, 0
    v_mov_b32 v26, 0
    v_mov_b32 v27, 0
    v_mov_b32 v28, 0
    v_mov_b32 v29, 0
    v_mov_b32 v30, 0
    v_mov_b32 v31, 0
    v_mov_b32 v32, 0
    v_mov_b32 v33, 0
    v_mov_b32 v34, 0
    v_mov_b32 v35, 0
    v_mov_b32 v36, 0
    v_mov_b32 v37, 0
    v_mov_b32 v38, 0
    v_mov_b32 v39, 0
    v_mov_b32 v40, 0
    v_mov_b32 v41, 0
    v_mov_b32 v42, 0
    v_mov_b32 v43, 0
    v_mov_b32 v44, 0
    v_mov_b32 v45, 0
    v_mov_b32 v46, 0
    v_mov_b32 v47, 0
    v_mov_b32 v209, 0
    v_mov_b32 v215, 0
    s_lshr_b32 s46, s67, 7
    s_xor_b32 s46, s46, s4
    s_or_b32 s46, s46, s3
    s_mov_b32 s47, 0
    s_cbranch_scc0 P2_ys
P2_ysd:
    s_mov_b32 s66, 0x5555
    s_mov_b32 s65, 0
    s_cmp_lt_u32 s3, 4
    s_cbranch_scc0 D_wait
    s_waitcnt vmcnt(1)
    s_branch D_got
D_wait:
    s_waitcnt vmcnt(0)
D_got:
    v_readfirstlane_b32 s68, v15
    s_mul_i32 s68, s68, 0x10001
    s_lshr_b32 s68, s68, s74
    s_lshr_b32 s64, s68, 1
    s_and_b32 s68, s68, s64
    s_and_b32 s68, s68, s66
    s_cbranch_scc1 D_go
    s_add_u32 s65, s65, 1
    s_cmp_ge_u32 s65, 40000
    s_cbranch_scc1 D_end
    s_sleep 1
    s_mov_b64 exec, 1
    v_mov_b32 v15, 0
    buffer_atomic_or v15, v14, s[16:19], 0 offen sc0
    s_mov_b64 exec, -1
    s_branch D_wait
D_go:
    s_andn2_b32 s66, s66, s68
    s_bcnt1_i32_b32 s70, s68
    s_or_b32 s64, s46, s66
    s_cbranch_scc0 P2_yl
P2_nyl:
    s_cmp_gt_u32 s70, 4
    s_cbranch_scc1 D_t58
    s_cmp_gt_u32 s70, 2
    s_cbranch_scc1 D_t34
    s_cmp_eq_u32 s70, 2
    s_cbranch_scc1 D_e2
D_e1:
    s_ff1_i32_b32 s64, s68
    s_bitset0_b32 s68, s64
    v_readlane_b32 s32, v7, s64
    s_add_u32 s69, s64, s74
    s_and_b32 s69, s69, 15
    s_lshl_b32 s69, s69, 11
    buffer_load_dwordx4 v[80:83], v4, s[16:19], s69 offen offset:0 sc1
    buffer_load_dwordx4 v[84:87], v12, s[16:19], s69 offen offset:1024 sc1
    buffer_load_dwordx4 v[88:91], v4, s[16:19], s69 offen offset:2048 sc1
    buffer_load_dwordx4 v[92:95], v12, s[16:19], s69 offen offset:3072 sc1
    s_mov_b64 exec, 1
    v_mov_b32 v15, 0
    buffer_atomic_or v15, v14, s[16:19], 0 offen sc0
    s_mov_b64 exec, -1
    v_add_u32 v8, s32, v5
    ds_read_b64_tr_b16 v[48:49], v8 offset:0
    ds_read_b64_tr_b16 v[50:51], v8 offset:2048
    v_add_u32 v9, s32, v6
    ds_read_b64_tr_b16 v[52:53], v9 offset:0
    ds_read_b64_tr_b16 v[54:55], v9 offset:2048
    v_add_u32 v10, s32, v1
    ds_read_b64_tr_b16 v[56:57], v10 offset:0
    ds_read_b64_tr_b16 v[58:59], v10 offset:2048
    v_add_u32 v11, s32, v3
    ds_read_b64_tr_b16 v[60:61], v11 offset:0
    ds_read_b64_tr_b16 v[62:63], v11 offset:2048
    s_branch D_p0
D_e2:
    s_ff1_i32_b32 s64, s68
    s_bitset0_b32 s68, s64
    v_readlane_b32 s33, v7, s64
    s_add_u32 s69, s64, s74
    s_and_b32 s69, s69, 15
    s_lshl_b32 s69, s69, 11
    buffer_load_dwordx4 v[96:99], v4, s[16:19], s69 offen offset:0 sc1
    buffer_load_dwordx4 v[100:103], v12, s[16:19], s69 offen offset:1024 sc1
    buffer_load_dwordx4 v[104:107], v4, s[16:19], s69 offen offset:2048 sc1
    buffer_load_dwordx4 v[108:111], v12, s[16:19], s69 offen offset:3072 sc1
    s_ff1_i32_b32 s64, s68
    s_bitset0_b32 s68, s64
    v_readlane_b32 s32, v7, s64
    s_add_u32 s69, s64, s74
    s_and_b32 s69, s69, 15
    s_lshl_b32 s69, s69, 11
    buffer_load_dwordx4 v[80:83], v4, s[16:19], s69 offen offset:0 sc1
    buffer_load_dwordx4 v[84:87], v12, s[16:19], s69 offen offset:1024 sc1
    buffer_load_dwordx4 v[88:91], v4, s[16:19], s69 offen offset:2048 sc1
    buffer_load_dwordx4 v[92:95], v12, s[16:19], s69 offen offset:3072 sc1
    s_mov_b64 exec, 1
    v_mov_b32 v15, 0
    buffer_atomic_or v15, v14, s[16:19], 0 offen sc0
    s_mov_b64 exec, -1
    v_add_u32 v8, s33, v5
    ds_read_b64_tr_b16 v[48:49], v8 offset:0
    ds_read_b64_tr_b16 v[50:51], v8 offset:2048
    v_add_u32 v9, s33, v6
    ds_read_b64_tr_b16 v[52:53], v9 offset:0
    ds_read_b64_tr_b16 v[54:55], v9 offset:2048
    v_add_u32 v10, s33, v1
    ds_read_b64_tr_b16 v[56:57], v10 offset:0
    ds_read_b64_tr_b16 v[58:59], v10 offset:2048
    v_add_u32 v11, s33, v3
    ds_read_b64_tr_b16 v[60:61], v11 offset:0
    ds_read_b64_tr_b16 v[62:63], v11 offset:2048
    s_branch D_p1
D_t34:
    s_cmp_eq_u32 s70, 4
    s_cbranch_scc1 D_e4
D_e3:
    s_ff1_i32_b32 s64, s68
    s_bitset0_b32 s68, s64
    v_readlane_b32 s34, v7, s64
    s_add_u32 s69, s64, s74
    s_and_b32 s69, s69, 15
    s_lshl_b32 s69, s69, 11
    buffer_load_dwordx4 v[112:115], v4, s[16:19], s69 offen offset:0 sc1
    buffer_load_dwordx4 v[116:119], v12, s[16:19], s69 offen offset:1024 sc1
    buffer_load_dwordx4 v[120:123], v4, s[16:19], s69 offen offset:2048 sc1
    buffer_load_dwordx4 v[124:127], v12, s[16:19], s69 offen offset:3072 sc1
    s_ff1_i32_b32 s64, s68
    s_bitset0_b32 s68, s64
    v_readlane_b32 s33, v7, s64
    s_add_u32 s69, s64, s74
    s_and_b32 s69, s69, 15
    s_lshl_b32 s69, s69, 11
    buffer_load_dwordx4 v[96:99], v4, s[16:19], s69 offen offset:0 sc1
    buffer_load_dwordx4 v[100:103], v12, s[16:19], s69 offen offset:1024 sc1
    buffer_load_dwordx4 v[104:107], v4, s[16:19], s69 offen offset:2048 sc1
    buffer_load_dwordx4 v[108:111], v12, s[16:19], s69 offen offset:3072 sc1
    v_add_u32 v8, s34, v5
    ds_read_b64_tr_b16 v[48:49], v8 offset:0
    ds_read_b64_tr_b16 v[50:51], v8 offset:2048
    v_add_u32 v9, s34, v6
    ds_read_b64_tr_b16 v[52:53], v9 offset:0
    ds_read_b64_tr_b16 v[54:55], v9 offset:2048
    v_add_u32 v10, s34, v1
    ds_read_b64_tr_b16 v[56:57], v10 offset:0
    ds_read_b64_tr_b16 v[58:59], v10 offset:2048
    v_add_u32 v11, s34, v3
    ds_read_b64_tr_b16 v[60:61], v11 offset:0
    ds_read_b64_tr_b16 v[62:63], v11 offset:2048
    s_branch D_p2
D_e4:
    s_ff1_i32_b32 s64, s68
    s_bitset0_b32 s68, s64
    v_readlane_b32 s35, v7, s64
    s_add_u32 s69, s64, s74
    s_and_b32 s69, s69, 15
    s_lshl_b32 s69, s69, 11
    buffer_load_dwordx4 v[128:131], v4, s[16:19], s69 offen offset:0 sc1
    buffer_load_dwordx4 v[132:135], v12, s[16:19], s69 offen offset:1024 sc1
    buffer_load_dwordx4 v[136:139], v4, s[16:19], s69 offen offset:2048 sc1
    buffer_load_dwordx4 v[140:143], v12, s[16:19], s69 offen offset:3072 sc1
    s_ff1_i32_b32 s64, s68
    s_bitset0_b32 s68, s64
    v_readlane_b32 s34, v7, s64
    s_add_u32 s69, s64, s74
    s_and_b32 s69, s69, 15
    s_lshl_b32 s69, s69, 11
    buffer_load_dwordx4 v[112:115], v4, s[16:19], s69 offen offset:0 sc1
    buffer_load_dwordx4 v[116:119], v12, s[16:19], s69 offen offset:1024 sc1
    buffer_load_dwordx4 v[120:123], v4, s[16:19], s69 offen offset:2048 sc1
    buffer_load_dwordx4 v[124:127], v12, s[16:19], s69 offen offset:3072 sc1
    v_add_u32 v8, s35, v5
    ds_read_b64_tr_b16 v[48:49], v8 offset:0
    ds_read_b64_tr_b16 v[50:51], v8 offset:2048
    v_add_u32 v9, s35, v6
    ds_read_b64_tr_b16 v[52:53], v9 offset:0
    ds_read_b64_tr_b16 v[54:55], v9 offset:2048
    v_add_u32 v10, s35, v1
    ds_read_b64_tr_b16 v[56:57], v10 offset:0
    ds_read_b64_tr_b16 v[58:59], v10 offset:2048
    v_add_u32 v11, s35, v3
    ds_read_b64_tr_b16 v[60:61], v11 offset:0
    ds_read_b64_tr_b16 v[62:63], v11 offset:2048
    s_branch D_p3
D_t58:
    s_cmp_gt_u32 s70, 6
    s_cbranch_scc1 D_t78
    s_cmp_eq_u32 s70, 6
    s_cbranch_scc1 D_e6
D_e5:
    s_ff1_i32_b32 s64, s68
    s_bitset0_b32 s68, s64
    v_readlane_b32 s36, v7, s64
    s_add_u32 s69, s64, s74
    s_and_b32 s69, s69, 15
    s_lshl_b32 s69, s69, 11
    buffer_load_dwordx4 v[144:147], v4, s[16:19], s69 offen offset:0 sc1
    buffer_load_dwordx4 v[148:151], v12, s[16:19], s69 offen offset:1024 sc1
    buffer_load_dwordx4 v[152:155], v4, s[16:19], s69 offen offset:2048 sc1
    buffer_load_dwordx4 v[156:159], v12, s[16:19], s69 offen offset:3072 sc1
    s_ff1_i32_b32 s64, s68
    s_bitset0_b32 s68, s64
    v_readlane_b32 s35, v7, s64
    s_add_u32 s69, s64, s74
    s_and_b32 s69, s69, 15
    s_lshl_b32 s69, s69, 11
    buffer_load_dwordx4 v[128:131], v4, s[16:19], s69 offen offset:0 sc1
    buffer_load_dwordx4 v[132:135], v12, s[16:19], s69 offen offset:1024 sc1
    buffer_load_dwordx4 v[136:139], v4, s[16:19], s69 offen offset:2048 sc1
    buffer_load_dwordx4 v[140:143], v12, s[16:19], s69 offen offset:3072 sc1
    v_add_u32 v8, s36, v5
    ds_read_b64_tr_b16 v[48:49], v8 offset:0
    ds_read_b64_tr_b16 v[50:51], v8 offset:2048
    v_add_u32 v9, s36, v6
    ds_read_b64_tr_b16 v[52:53], v9 offset:0
    ds_read_b64_tr_b16 v[54:55], v9 offset:2048
    v_add_u32 v10, s36, v1
    ds_read_b64_tr_b16 v[56:57], v10 offset:0
    ds_read_b64_tr_b16 v[58:59], v10 offset:2048
    v_add_u32 v11, s36, v3
    ds_read_b64_tr_b16 v[60:61], v11 offset:0
    ds_read_b64_tr_b16 v[62:63], v11 offset:2048
    s_branch D_p4
D_e6:
    s_ff1_i32_b32 s64, s68
    s_bitset0_b32 s68, s64
    v_readlane_b32 s37, v7, s64
    s_add_u32 s69, s64, s74
    s_and_b32 s69, s69, 15
    s_lshl_b32 s69, s69, 11
    buffer_load_dwordx4 v[160:163], v4, s[16:19], s69 offen offset:0 sc1
    buffer_load_dwordx4 v[164:167], v12, s[16:19], s69 offen offset:1024 sc1
    buffer_load_dwordx4 v[168:171], v4, s[16:19], s69 offen offset:2048 sc1
    buffer_load_dwordx4 v[172:175], v12, s[16:19], s69 offen offset:3072 sc1
    s_ff1_i32_b32 s64, s68
    s_bitset0_b32 s68, s64
    v_readlane_b32 s36, v7, s64
    s_add_u32 s69, s64, s74
    s_and_b32 s69, s69, 15
    s_lshl_b32 s69, s69, 11
    buffer_load_dwordx4 v[144:147], v4, s[16:19], s69 offen offset:0 sc1
    buffer_load_dwordx4 v[148:151], v12, s[16:19], s69 offen offset:1024 sc1
    buffer_load_dwordx4 v[152:155], v4, s[16:19], s69 offen offset:2048 sc1
    buffer_load_dwordx4 v[156:159], v12, s[16:19], s69 offen offset:3072 sc1
    v_add_u32 v8, s37, v5
    ds_read_b64_tr_b16 v[48:49], v8 offset:0
    ds_read_b64_tr_b16 v[50:51], v8 offset:2048
    v_add_u32 v9, s37, v6
    ds_read_b64_tr_b16 v[52:53], v9 offset:0
    ds_read_b64_tr_b16 v[54:55], v9 offset:2048
    v_add_u32 v10, s37, v1
    ds_read_b64_tr_b16 v[56:57], v10 offset:0
    ds_read_b64_tr_b16 v[58:59], v10 offset:2048
    v_add_u32 v11, s37, v3
    ds_read_b64_tr_b16 v[60:61], v11 offset:0
    ds_read_b64_tr_b16 v[62:63], v11 offset:2048
    s_branch D_p5
D_t78:
    s_cmp_eq_u32 s70, 8
    s_cbranch_scc1 D_e8
D_e7:
    s_ff1_i32_b32 s64, s68
    s_bitset0_b32 s68, s64
    v_readlane_b32 s38, v7, s64
    s_add_u32 s69, s64, s74
    s_and_b32 s69, s69, 15
    s_lshl_b32 s69, s69, 11
    buffer_load_dwordx4 v[176:179], v4, s[16:19], s69 offen offset:0 sc1
    buffer_load_dwordx4 v[180:183], v12, s[16:19], s69 offen offset:1024 sc1
    buffer_load_dwordx4 v[184:187], v4, s[16:19], s69 offen offset:2048 sc1
    buffer_load_dwordx4 v[188:191], v12, s[16:19], s69 offen offset:3072 sc1
    s_ff1_i32_b32 s64, s68
    s_bitset0_b32 s68, s64
    v_readlane_b32 s37, v7, s64
    s_add_u32 s69, s64, s74
    s_and_b32 s69, s69, 15
    s_lshl_b32 s69, s69, 11
    buffer_load_dwordx4 v[160:163], v4, s[16:19], s69 offen offset:0 sc1
    buffer_load_dwordx4 v[164:167], v12, s[16:19], s69 offen offset:1024 sc1
    buffer_load_dwordx4 v[168:171], v4, s[16:19], s69 offen offset:2048 sc1
    buffer_load_dwordx4 v[172:175], v12, s[16:19], s69 offen offset:3072 sc1
    v_add_u32 v8, s38, v5
    ds_read_b64_tr_b16 v[48:49], v8 offset:0
    ds_read_b64_tr_b16 v[50:51], v8 offset:2048
    v_add_u32 v9, s38, v6
    ds_read_b64_tr_b16 v[52:53], v9 offset:0
    ds_read_b64_tr_b16 v[54:55], v9 offset:2048
    v_add_u32 v10, s38, v1
    ds_read_b64_tr_b16 v[56:57], v10 offset:0
    ds_read_b64_tr_b16 v[58:59], v10 offset:2048
    v_add_u32 v11, s38, v3
    ds_read_b64_tr_b16 v[60:61], v11 offset:0
    ds_read_b64_tr_b16 v[62:63], v11 offset:2048
    s_branch D_p6
D_e8:
    s_ff1_i32_b32 s64, s68
    s_bitset0_b32 s68, s64
    v_readlane_b32 s39, v7, s64
    s_add_u32 s69, s64, s74
    s_and_b32 s69, s69, 15
    s_lshl_b32 s69, s69, 11
    buffer_load_dwordx4 v[192:195], v4, s[16:19], s69 offen offset:0 sc1
    buffer_load_dwordx4 v[196:199], v12, s[16:19], s69 offen offset:1024 sc1
    buffer_load_dwordx4 v[200:203], v4, s[16:19], s69 offen offset:2048 sc1
    buffer_load_dwordx4 v[204:207], v12, s[16:19], s69 offen offset:3072 sc1
    s_ff1_i32_b32 s64, s68
    s_bitset0_b32 s68, s64
    v_readlane_b32 s38, v7, s64
    s_add_u32 s69, s64, s74
    s_and_b32 s69, s69, 15
    s_lshl_b32 s69, s69, 11
    buffer_load_dwordx4 v[176:179], v4, s[16:19], s69 offen offset:0 sc1
    buffer_load_dwordx4 v[180:183], v12, s[16:19], s69 offen offset:1024 sc1
    buffer_load_dwordx4 v[184:187], v4, s[16:19], s69 offen offset:2048 sc1
    buffer_load_dwordx4 v[188:191], v12, s[16:19], s69 offen offset:3072 sc1
    v_add_u32 v8, s39, v5
    ds_read_b64_tr_b16 v[48:49], v8 offset:0
    ds_read_b64_tr_b16 v[50:51], v8 offset:2048
    v_add_u32 v9, s39, v6
    ds_read_b64_tr_b16 v[52:53], v9 offset:0
    ds_read_b64_tr_b16 v[54:55], v9 offset:2048
    v_add_u32 v10, s39, v1
    ds_read_b64_tr_b16 v[56:57], v10 offset:0
    ds_read_b64_tr_b16 v[58:59], v10 offset:2048
    v_add_u32 v11, s39, v3
    ds_read_b64_tr_b16 v[60:61], v11 offset:0
    ds_read_b64_tr_b16 v[62:63], v11 offset:2048
D_p7:
    s_waitcnt vmcnt(4) lgkmcnt(0)
    v_mfma_f32_16x16x32_bf16 v[16:19], v[48:51], v[192:195], v[16:19]
    ds_read_b64_tr_b16 v[64:65], v8 offset:4096
    ds_read_b64_tr_b16 v[66:67], v8 offset:6144
    v_mfma_f32_16x16x32_bf16 v[32:35], v[48:51], v[196:199], v[32:35]
    ds_read_b64_tr_b16 v[68:69], v9 offset:4096
    ds_read_b64_tr_b16 v[70:71], v9 offset:6144
    v_mfma_f32_16x16x32_bf16 v[20:23], v[52:55], v[192:195], v[20:23]
    ds_read_b64_tr_b16 v[72:73], v10 offset:4096
    ds_read_b64_tr_b16 v[74:75], v10 offset:6144
    v_mfma_f32_16x16x32_bf16 v[36:39], v[52:55], v[196:199], v[36:39]
    ds_read_b64_tr_b16 v[76:77], v11 offset:4096
    ds_read_b64_tr_b16 v[78:79], v11 offset:6144
    s_ff1_i32_b32 s64, s68
    s_bitset0_b32 s68, s64
    v_readlane_b32 s37, v7, s64
    s_add_u32 s69, s64, s74
    s_and_b32 s69, s69, 15
    s_lshl_b32 s69, s69, 11
    buffer_load_dwordx4 v[160:163], v4, s[16:19], s69 offen offset:0 sc1
    v_mfma_f32_16x16x32_bf16 v[24:27], v[56:59], v[192:195], v[24:27]
    v_mfma_f32_16x16x32_bf16 v[40:43], v[56:59], v[196:199], v[40:43]
    v_mfma_f32_16x16x32_bf16 v[28:31], v[60:63], v[192:195], v[28:31]
    buffer_load_dwordx4 v[164:167], v12, s[16:19], s69 offen offset:1024 sc1
    v_mfma_f32_16x16x32_bf16 v[44:47], v[60:63], v[196:199], v[44:47]
    s_waitcnt lgkmcnt(0)
    v_mfma_f32_16x16x32_bf16 v[16:19], v[64:67], v[200:203], v[16:19]
    v_add_u32 v8, s38, v5
    ds_read_b64_tr_b16 v[48:49], v8 offset:0
    v_mfma_f32_16x16x32_bf16 v[32:35], v[64:67], v[204:207], v[32:35]
    ds_read_b64_tr_b16 v[50:51], v8 offset:2048
    v_add_u32 v9, s38, v6
    v_mfma_f32_16x16x32_bf16 v[20:23], v[68:71], v[200:203], v[20:23]
    ds_read_b64_tr_b16 v[52:53], v9 offset:0
    ds_read_b64_tr_b16 v[54:55], v9 offset:2048
    v_mfma_f32_16x16x32_bf16 v[36:39], v[68:71], v[204:207], v[36:39]
    v_add_u32 v10, s38, v1
    ds_read_b64_tr_b16 v[56:57], v10 offset:0
    buffer_load_dwordx4 v[168:171], v4, s[16:19], s69 offen offset:2048 sc1
    v_mfma_f32_16x16x32_bf16 v[24:27], v[72:75], v[200:203], v[24:27]
    ds_read_b64_tr_b16 v[58:59], v10 offset:2048
    v_add_u32 v11, s38, v3
    v_mfma_f32_16x16x32_bf16 v[40:43], v[72:75], v[204:207], v[40:43]
    ds_read_b64_tr_b16 v[60:61], v11 offset:0
    ds_read_b64_tr_b16 v[62:63], v11 offset:2048
    v_mfma_f32_16x16x32_bf16 v[28:31], v[76:79], v[200:203], v[28:31]
    buffer_load_dwordx4 v[172:175], v12, s[16:19], s69 offen offset:3072 sc1
    v_mfma_f32_16x16x32_bf16 v[44:47], v[76:79], v[204:207], v[44:47]
D_p6:
    s_waitcnt vmcnt(4) lgkmcnt(0)
    v_mfma_f32_16x16x32_bf16 v[16:19], v[48:51], v[176:179], v[16:19]
    ds_read_b64_tr_b16 v[64:65], v8 offset:4096
    ds_read_b64_tr_b16 v[66:67], v8 offset:6144
    v_mfma_f32_16x16x32_bf16 v[32:35], v[48:51], v[180:183], v[32:35]
    ds_read_b64_tr_b16 v[68:69], v9 offset:4096
    ds_read_b64_tr_b16 v[70:71], v9 offset:6144
    v_mfma_f32_16x16x32_bf16 v[20:23], v[52:55], v[176:179], v[20:23]
    ds_read_b64_tr_b16 v[72:73], v10 offset:4096
    ds_read_b64_tr_b16 v[74:75], v10 offset:6144
    v_mfma_f32_16x16x32_bf16 v[36:39], v[52:55], v[180:183], v[36:39]
    ds_read_b64_tr_b16 v[76:77], v11 offset:4096
    ds_read_b64_tr_b16 v[78:79], v11 offset:6144
    s_ff1_i32_b32 s64, s68
    s_bitset0_b32 s68, s64
    v_readlane_b32 s36, v7, s64
    s_add_u32 s69, s64, s74
    s_and_b32 s69, s69, 15
    s_lshl_b32 s69, s69, 11
    buffer_load_dwordx4 v[144:147], v4, s[16:19], s69 offen offset:0 sc1
    v_mfma_f32_16x16x32_bf16 v[24:27], v[56:59], v[176:179], v[24:27]
    v_mfma_f32_16x16x32_bf16 v[40:43], v[56:59], v[180:183], v[40:43]
    v_mfma_f32_16x16x32_bf16 v[28:31], v[60:63], v[176:179], v[28:31]
    buffer_load_dwordx4 v[148:151], v12, s[16:19], s69 offen offset:1024 sc1
    v_mfma_f32_16x16x32_bf16 v[44:47], v[60:63], v[180:183], v[44:47]
    s_waitcnt lgkmcnt(0)
    v_mfma_f32_16x16x32_bf16 v[16:19], v[64:67], v[184:187], v[16:19]
    v_add_u32 v8, s37, v5
    ds_read_b64_tr_b16 v[48:49], v8 offset:0
    v_mfma_f32_16x16x32_bf16 v[32:35], v[64:67], v[188:191], v[32:35]
    ds_read_b64_tr_b16 v[50:51], v8 offset:2048
    v_add_u32 v9, s37, v6
    v_mfma_f32_16x16x32_bf16 v[20:23], v[68:71], v[184:187], v[20:23]
    ds_read_b64_tr_b16 v[52:53], v9 offset:0
    ds_read_b64_tr_b16 v[54:55], v9 offset:2048
    v_mfma_f32_16x16x32_bf16 v[36:39], v[68:71], v[188:191], v[36:39]
    v_add_u32 v10, s37, v1
    ds_read_b64_tr_b16 v[56:57], v10 offset:0
    buffer_load_dwordx4 v[152:155], v4, s[16:19], s69 offen offset:2048 sc1
    v_mfma_f32_16x16x32_bf16 v[24:27], v[72:75], v[184:187], v[24:27]
    ds_read_b64_tr_b16 v[58:59], v10 offset:2048
    v_add_u32 v11, s37, v3
    v_mfma_f32_16x16x32_bf16 v[40:43], v[72:75], v[188:191], v[40:43]
    ds_read_b64_tr_b16 v[60:61], v11 offset:0
    ds_read_b64_tr_b16 v[62:63], v11 offset:2048
    v_mfma_f32_16x16x32_bf16 v[28:31], v[76:79], v[184:187], v[28:31]
    buffer_load_dwordx4 v[156:159], v12, s[16:19], s69 offen offset:3072 sc1
    v_mfma_f32_16x16x32_bf16 v[44:47], v[76:79], v[188:191], v[44:47]
D_p5:
    s_waitcnt vmcnt(4) lgkmcnt(0)
    v_mfma_f32_16x16x32_bf16 v[16:19], v[48:51], v[160:163], v[16:19]
    ds_read_b64_tr_b16 v[64:65], v8 offset:4096
    ds_read_b64_tr_b16 v[66:67], v8 offset:6144
    v_mfma_f32_16x16x32_bf16 v[32:35], v[48:51], v[164:167], v[32:35]
    ds_read_b64_tr_b16 v[68:69], v9 offset:4096
    ds_read_b64_tr_b16 v[70:71], v9 offset:6144
    v_mfma_f32_16x16x32_bf16 v[20:23], v[52:55], v[160:163], v[20:23]
    ds_read_b64_tr_b16 v[72:73], v10 offset:4096
    ds_read_b64_tr_b16 v[74:75], v10 offset:6144
    v_mfma_f32_16x16x32_bf16 v[36:39], v[52:55], v[164:167], v[36:39]
    ds_read_b64_tr_b16 v[76:77], v11 offset:4096
    ds_read_b64_tr_b16 v[78:79], v11 offset:6144
    s_ff1_i32_b32 s64, s68
    s_bitset0_b32 s68, s64
    v_readlane_b32 s35, v7, s64
    s_add_u32 s69, s64, s74
    s_and_b32 s69, s69, 15
    s_lshl_b32 s69, s69, 11
    buffer_load_dwordx4 v[128:131], v4, s[16:19], s69 offen offset:0 sc1
    v_mfma_f32_16x16x32_bf16 v[24:27], v[56:59], v[160:163], v[24:27]
    v_mfma_f32_16x16x32_bf16 v[40:43], v[56:59], v[164:167], v[40:43]
    v_mfma_f32_16x16x32_bf16 v[28:31], v[60:63], v[160:163], v[28:31]
    buffer_load_dwordx4 v[132:135], v12, s[16:19], s69 offen offset:1024 sc1
    v_mfma_f32_16x16x32_bf16 v[44:47], v[60:63], v[164:167], v[44:47]
    s_waitcnt lgkmcnt(0)
    v_mfma_f32_16x16x32_bf16 v[16:19], v[64:67], v[168:171], v[16:19]
    v_add_u32 v8, s36, v5
    ds_read_b64_tr_b16 v[48:49], v8 offset:0
    v_mfma_f32_16x16x32_bf16 v[32:35], v[64:67], v[172:175], v[32:35]
    ds_read_b64_tr_b16 v[50:51], v8 offset:2048
    v_add_u32 v9, s36, v6
    v_mfma_f32_16x16x32_bf16 v[20:23], v[68:71], v[168:171], v[20:23]
    ds_read_b64_tr_b16 v[52:53], v9 offset:0
    ds_read_b64_tr_b16 v[54:55], v9 offset:2048
    v_mfma_f32_16x16x32_bf16 v[36:39], v[68:71], v[172:175], v[36:39]
    v_add_u32 v10, s36, v1
    ds_read_b64_tr_b16 v[56:57], v10 offset:0
    buffer_load_dwordx4 v[136:139], v4, s[16:19], s69 offen offset:2048 sc1
    v_mfma_f32_16x16x32_bf16 v[24:27], v[72:75], v[168:171], v[24:27]
    ds_read_b64_tr_b16 v[58:59], v10 offset:2048
    v_add_u32 v11, s36, v3
    v_mfma_f32_16x16x32_bf16 v[40:43], v[72:75], v[172:175], v[40:43]
    ds_read_b64_tr_b16 v[60:61], v11 offset:0
    ds_read_b64_tr_b16 v[62:63], v11 offset:2048
    v_mfma_f32_16x16x32_bf16 v[28:31], v[76:79], v[168:171], v[28:31]
    buffer_load_dwordx4 v[140:143], v12, s[16:19], s69 offen offset:3072 sc1
    v_mfma_f32_16x16x32_bf16 v[44:47], v[76:79], v[172:175], v[44:47]
D_p4:
    s_waitcnt vmcnt(4) lgkmcnt(0)
    v_mfma_f32_16x16x32_bf16 v[16:19], v[48:51], v[144:147], v[16:19]
    ds_read_b64_tr_b16 v[64:65], v8 offset:4096
    ds_read_b64_tr_b16 v[66:67], v8 offset:6144
    v_mfma_f32_16x16x32_bf16 v[32:35], v[48:51], v[148:151], v[32:35]
    ds_read_b64_tr_b16 v[68:69], v9 offset:4096
    ds_read_b64_tr_b16 v[70:71], v9 offset:6144
    v_mfma_f32_16x16x32_bf16 v[20:23], v[52:55], v[144:147], v[20:23]
    ds_read_b64_tr_b16 v[72:73], v10 offset:4096
    ds_read_b64_tr_b16 v[74:75], v10 offset:6144
    v_mfma_f32_16x16x32_bf16 v[36:39], v[52:55], v[148:151], v[36:39]
    ds_read_b64_tr_b16 v[76:77], v11 offset:4096
    ds_read_b64_tr_b16 v[78:79], v11 offset:6144
    s_ff1_i32_b32 s64, s68
    s_bitset0_b32 s68, s64
    v_readlane_b32 s34, v7, s64
    s_add_u32 s69, s64, s74
    s_and_b32 s69, s69, 15
    s_lshl_b32 s69, s69, 11
    buffer_load_dwordx4 v[112:115], v4, s[16:19], s69 offen offset:0 sc1
    v_mfma_f32_16x16x32_bf16 v[24:27], v[56:59], v[144:147], v[24:27]
    v_mfma_f32_16x16x32_bf16 v[40:43], v[56:59], v[148:151], v[40:43]
    v_mfma_f32_16x16x32_bf16 v[28:31], v[60:63], v[144:147], v[28:31]
    buffer_load_dwordx4 v[116:119], v12, s[16:19], s69 offen offset:1024 sc1
    v_mfma_f32_16x16x32_bf16 v[44:47], v[60:63], v[148:151], v[44:47]
    s_waitcnt lgkmcnt(0)
    v_mfma_f32_16x16x32_bf16 v[16:19], v[64:67], v[152:155], v[16:19]
    v_add_u32 v8, s35, v5
    ds_read_b64_tr_b16 v[48:49], v8 offset:0
    v_mfma_f32_16x16x32_bf16 v[32:35], v[64:67], v[156:159], v[32:35]
    ds_read_b64_tr_b16 v[50:51], v8 offset:2048
    v_add_u32 v9, s35, v6
    v_mfma_f32_16x16x32_bf16 v[20:23], v[68:71], v[152:155], v[20:23]
    ds_read_b64_tr_b16 v[52:53], v9 offset:0
    ds_read_b64_tr_b16 v[54:55], v9 offset:2048
    v_mfma_f32_16x16x32_bf16 v[36:39], v[68:71], v[156:159], v[36:39]
    v_add_u32 v10, s35, v1
    ds_read_b64_tr_b16 v[56:57], v10 offset:0
    buffer_load_dwordx4 v[120:123], v4, s[16:19], s69 offen offset:2048 sc1
    v_mfma_f32_16x16x32_bf16 v[24:27], v[72:75], v[152:155], v[24:27]
    ds_read_b64_tr_b16 v[58:59], v10 offset:2048
    v_add_u32 v11, s35, v3
    v_mfma_f32_16x16x32_bf16 v[40:43], v[72:75], v[156:159], v[40:43]
    ds_read_b64_tr_b16 v[60:61], v11 offset:0
    ds_read_b64_tr_b16 v[62:63], v11 offset:2048
    v_mfma_f32_16x16x32_bf16 v[28:31], v[76:79], v[152:155], v[28:31]
    buffer_load_dwordx4 v[124:127], v12, s[16:19], s69 offen offset:3072 sc1
    v_mfma_f32_16x16x32_bf16 v[44:47], v[76:79], v[156:159], v[44:47]
D_p3:
    s_waitcnt vmcnt(4) lgkmcnt(0)
    v_mfma_f32_16x16x32_bf16 v[16:19], v[48:51], v[128:131], v[16:19]
    ds_read_b64_tr_b16 v[64:65], v8 offset:4096
    ds_read_b64_tr_b16 v[66:67], v8 offset:6144
    v_mfma_f32_16x16x32_bf16 v[32:35], v[48:51], v[132:135], v[32:35]
    ds_read_b64_tr_b16 v[68:69], v9 offset:4096
    ds_read_b64_tr_b16 v[70:71], v9 offset:6144
    v_mfma_f32_16x16x32_bf16 v[20:23], v[52:55], v[128:131], v[20:23]
    ds_read_b64_tr_b16 v[72:73], v10 offset:4096
    ds_read_b64_tr_b16 v[74:75], v10 offset:6144
    v_mfma_f32_16x16x32_bf16 v[36:39], v[52:55], v[132:135], v[36:39]
    ds_read_b64_tr_b16 v[76:77], v11 offset:4096
    ds_read_b64_tr_b16 v[78:79], v11 offset:6144
    s_ff1_i32_b32 s64, s68
    s_bitset0_b32 s68, s64
    v_readlane_b32 s33, v7, s64
    s_add_u32 s69, s64, s74
    s_and_b32 s69, s69, 15
    s_lshl_b32 s69, s69, 11
    buffer_load_dwordx4 v[96:99], v4, s[16:19], s69 offen offset:0 sc1
    v_mfma_f32_16x16x32_bf16 v[24:27], v[56:59], v[128:131], v[24:27]
    v_mfma_f32_16x16x32_bf16 v[40:43], v[56:59], v[132:135], v[40:43]
    v_mfma_f32_16x16x32_bf16 v[28:31], v[60:63], v[128:131], v[28:31]
    buffer_load_dwordx4 v[100:103], v12, s[16:19], s69 offen offset:1024 sc1
    v_mfma_f32_16x16x32_bf16 v[44:47], v[60:63], v[132:135], v[44:47]
    s_waitcnt lgkmcnt(0)
    v_mfma_f32_16x16x32_bf16 v[16:19], v[64:67], v[136:139], v[16:19]
    v_add_u32 v8, s34, v5
    ds_read_b64_tr_b16 v[48:49], v8 offset:0
    v_mfma_f32_16x16x32_bf16 v[32:35], v[64:67], v[140:143], v[32:35]
    ds_read_b64_tr_b16 v[50:51], v8 offset:2048
    v_add_u32 v9, s34, v6
    v_mfma_f32_16x16x32_bf16 v[20:23], v[68:71], v[136:139], v[20:23]
    ds_read_b64_tr_b16 v[52:53], v9 offset:0
    ds_read_b64_tr_b16 v[54:55], v9 offset:2048
    v_mfma_f32_16x16x32_bf16 v[36:39], v[68:71], v[140:143], v[36:39]
    v_add_u32 v10, s34, v1
    ds_read_b64_tr_b16 v[56:57], v10 offset:0
    buffer_load_dwordx4 v[104:107], v4, s[16:19], s69 offen offset:2048 sc1
    v_mfma_f32_16x16x32_bf16 v[24:27], v[72:75], v[136:139], v[24:27]
    ds_read_b64_tr_b16 v[58:59], v10 offset:2048
    v_add_u32 v11, s34, v3
    v_mfma_f32_16x16x32_bf16 v[40:43], v[72:75], v[140:143], v[40:43]
    ds_read_b64_tr_b16 v[60:61], v11 offset:0
    ds_read_b64_tr_b16 v[62:63], v11 offset:2048
    v_mfma_f32_16x16x32_bf16 v[28:31], v[76:79], v[136:139], v[28:31]
    buffer_load_dwordx4 v[108:111], v12, s[16:19], s69 offen offset:3072 sc1
    v_mfma_f32_16x16x32_bf16 v[44:47], v[76:79], v[140:143], v[44:47]
D_p2:
    s_waitcnt vmcnt(4) lgkmcnt(0)
    v_mfma_f32_16x16x32_bf16 v[16:19], v[48:51], v[112:115], v[16:19]
    ds_read_b64_tr_b16 v[64:65], v8 offset:4096
    ds_read_b64_tr_b16 v[66:67], v8 offset:6144
    v_mfma_f32_16x16x32_bf16 v[32:35], v[48:51], v[116:119], v[32:35]
    ds_read_b64_tr_b16 v[68:69], v9 offset:4096
    ds_read_b64_tr_b16 v[70:71], v9 offset:6144
    v_mfma_f32_16x16x32_bf16 v[20:23], v[52:55], v[112:115], v[20:23]
    ds_read_b64_tr_b16 v[72:73], v10 offset:4096
    ds_read_b64_tr_b16 v[74:75], v10 offset:6144
    v_mfma_f32_16x16x32_bf16 v[36:39], v[52:55], v[116:119], v[36:39]
    ds_read_b64_tr_b16 v[76:77], v11 offset:4096
    ds_read_b64_tr_b16 v[78:79], v11 offset:6144
    s_ff1_i32_b32 s64, s68
    s_bitset0_b32 s68, s64
    v_readlane_b32 s32, v7, s64
    s_add_u32 s69, s64, s74
    s_and_b32 s69, s69, 15
    s_lshl_b32 s69, s69, 11
    buffer_load_dwordx4 v[80:83], v4, s[16:19], s69 offen offset:0 sc1
    v_mfma_f32_16x16x32_bf16 v[24:27], v[56:59], v[112:115], v[24:27]
    v_mfma_f32_16x16x32_bf16 v[40:43], v[56:59], v[116:119], v[40:43]
    v_mfma_f32_16x16x32_bf16 v[28:31], v[60:63], v[112:115], v[28:31]
    buffer_load_dwordx4 v[84:87], v12, s[16:19], s69 offen offset:1024 sc1
    v_mfma_f32_16x16x32_bf16 v[44:47], v[60:63], v[116:119], v[44:47]
    s_waitcnt lgkmcnt(0)
    v_mfma_f32_16x16x32_bf16 v[16:19], v[64:67], v[120:123], v[16:19]
    v_add_u32 v8, s33, v5
    ds_read_b64_tr_b16 v[48:49], v8 offset:0
    v_mfma_f32_16x16x32_bf16 v[32:35], v[64:67], v[124:127], v[32:35]
    ds_read_b64_tr_b16 v[50:51], v8 offset:2048
    v_add_u32 v9, s33, v6
    v_mfma_f32_16x16x32_bf16 v[20:23], v[68:71], v[120:123], v[20:23]
    ds_read_b64_tr_b16 v[52:53], v9 offset:0
    ds_read_b64_tr_b16 v[54:55], v9 offset:2048
    v_mfma_f32_16x16x32_bf16 v[36:39], v[68:71], v[124:127], v[36:39]
    v_add_u32 v10, s33, v1
    ds_read_b64_tr_b16 v[56:57], v10 offset:0
    buffer_load_dwordx4 v[88:91], v4, s[16:19], s69 offen offset:2048 sc1
    v_mfma_f32_16x16x32_bf16 v[24:27], v[72:75], v[120:123], v[24:27]
    ds_read_b64_tr_b16 v[58:59], v10 offset:2048
    v_add_u32 v11, s33, v3
    v_mfma_f32_16x16x32_bf16 v[40:43], v[72:75], v[124:127], v[40:43]
    ds_read_b64_tr_b16 v[60:61], v11 offset:0
    ds_read_b64_tr_b16 v[62:63], v11 offset:2048
    v_mfma_f32_16x16x32_bf16 v[28:31], v[76:79], v[120:123], v[28:31]
    buffer_load_dwordx4 v[92:95], v12, s[16:19], s69 offen offset:3072 sc1
    s_mov_b64 exec, 1
    v_mov_b32 v15, 0
    buffer_atomic_or v15, v14, s[16:19], 0 offen sc0
    s_mov_b64 exec, -1
    v_mfma_f32_16x16x32_bf16 v[44:47], v[76:79], v[124:127], v[44:47]
D_p1:
    s_waitcnt vmcnt(5) lgkmcnt(0)
    v_mfma_f32_16x16x32_bf16 v[16:19], v[48:51], v[96:99], v[16:19]
    ds_read_b64_tr_b16 v[64:65], v8 offset:4096
    ds_read_b64_tr_b16 v[66:67], v8 offset:6144
    v_mfma_f32_16x16x32_bf16 v[32:35], v[48:51], v[100:103], v[32:35]
    ds_read_b64_tr_b16 v[68:69], v9 offset:4096
    ds_read_b64_tr_b16 v[70:71], v9 offset:6144
    v_mfma_f32_16x16x32_bf16 v[20:23], v[52:55], v[96:99], v[20:23]
    ds_read_b64_tr_b16 v[72:73], v10 offset:4096
    ds_read_b64_tr_b16 v[74:75], v10 offset:6144
    v_mfma_f32_16x16x32_bf16 v[36:39], v[52:55], v[100:103], v[36:39]
    ds_read_b64_tr_b16 v[76:77], v11 offset:4096
    ds_read_b64_tr_b16 v[78:79], v11 offset:6144
    v_mfma_f32_16x16x32_bf16 v[24:27], v[56:59], v[96:99], v[24:27]
    v_mfma_f32_16x16x32_bf16 v[40:43], v[56:59], v[100:103], v[40:43]
    v_mfma_f32_16x16x32_bf16 v[28:31], v[60:63], v[96:99], v[28:31]
    v_mfma_f32_16x16x32_bf16 v[44:47], v[60:63], v[100:103], v[44:47]
    s_waitcnt lgkmcnt(0)
    v_mfma_f32_16x16x32_bf16 v[16:19], v[64:67], v[104:107], v[16:19]
    v_add_u32 v8, s32, v5
    ds_read_b64_tr_b16 v[48:49], v8 offset:0
    v_mfma_f32_16x16x32_bf16 v[32:35], v[64:67], v[108:111], v[32:35]
    ds_read_b64_tr_b16 v[50:51], v8 offset:2048
    v_add_u32 v9, s32, v6
    v_mfma_f32_16x16x32_bf16 v[20:23], v[68:71], v[104:107], v[20:23]
    ds_read_b64_tr_b16 v[52:53], v9 offset:0
    ds_read_b64_tr_b16 v[54:55], v9 offset:2048
    v_mfma_f32_16x16x32_bf16 v[36:39], v[68:71], v[108:111], v[36:39]
    v_add_u32 v10, s32, v1
    ds_read_b64_tr_b16 v[56:57], v10 offset:0
    v_mfma_f32_16x16x32_bf16 v[24:27], v[72:75], v[104:107], v[24:27]
    ds_read_b64_tr_b16 v[58:59], v10 offset:2048
    v_add_u32 v11, s32, v3
    v_mfma_f32_16x16x32_bf16 v[40:43], v[72:75], v[108:111], v[40:43]
    ds_read_b64_tr_b16 v[60:61], v11 offset:0
    ds_read_b64_tr_b16 v[62:63], v11 offset:2048
    v_mfma_f32_16x16x32_bf16 v[28:31], v[76:79], v[104:107], v[28:31]
    v_mfma_f32_16x16x32_bf16 v[44:47], v[76:79], v[108:111], v[44:47]
D_p0:
    s_waitcnt vmcnt(1) lgkmcnt(0)
    v_mfma_f32_16x16x32_bf16 v[16:19], v[48:51], v[80:83], v[16:19]
    ds_read_b64_tr_b16 v[64:65], v8 offset:4096
    ds_read_b64_tr_b16 v[66:67], v8 offset:6144
    v_mfma_f32_16x16x32_bf16 v[32:35], v[48:51], v[84:87], v[32:35]
    ds_read_b64_tr_b16 v[68:69], v9 offset:4096
    ds_read_b64_tr_b16 v[70:71], v9 offset:6144
    v_mfma_f32_16x16x32_bf16 v[20:23], v[52:55], v[80:83], v[20:23]
    ds_read_b64_tr_b16 v[72:73], v10 offset:4096
    ds_read_b64_tr_b16 v[74:75], v10 offset:6144
    v_mfma_f32_16x16x32_bf16 v[36:39], v[52:55], v[84:87], v[36:39]
    ds_read_b64_tr_b16 v[76:77], v11 offset:4096
    ds_read_b64_tr_b16 v[78:79], v11 offset:6144
    v_mfma_f32_16x16x32_bf16 v[24:27], v[56:59], v[80:83], v[24:27]
    v_mfma_f32_16x16x32_bf16 v[40:43], v[56:59], v[84:87], v[40:43]
    v_mfma_f32_16x16x32_bf16 v[28:31], v[60:63], v[80:83], v[28:31]
    v_mfma_f32_16x16x32_bf16 v[44:47], v[60:63], v[84:87], v[44:47]
    s_waitcnt lgkmcnt(0)
    v_mfma_f32_16x16x32_bf16 v[16:19], v[64:67], v[88:91], v[16:19]
    v_mfma_f32_16x16x32_bf16 v[32:35], v[64:67], v[92:95], v[32:35]
    v_mfma_f32_16x16x32_bf16 v[20:23], v[68:71], v[88:91], v[20:23]
    v_mfma_f32_16x16x32_bf16 v[36:39], v[68:71], v[92:95], v[36:39]
    v_mfma_f32_16x16x32_bf16 v[24:27], v[72:75], v[88:91], v[24:27]
    v_mfma_f32_16x16x32_bf16 v[40:43], v[72:75], v[92:95], v[40:43]
    v_mfma_f32_16x16x32_bf16 v[28:31], v[76:79], v[88:91], v[28:31]
    v_mfma_f32_16x16x32_bf16 v[44:47], v[76:79], v[92:95], v[44:47]
    s_cmp_lg_u32 s66, 0
    s_cbranch_scc1 D_wait
D_end:
    s_lshl_b32 s64, s3, 12
    s_add_u32 s64, s64, 8192
    v_lshl_add_u32 v8, v2, 4, s64
    s_xor_b32 s65, s3, 4
    s_lshl_b32 s65, s65, 12
    s_add_u32 s65, s65, 8192
    v_lshl_add_u32 v5, v2, 4, s65
    v_lshlrev_b32 v9, 1, v229
    v_cmp_eq_u32 s[70:71], s67, v230
    s_cmp_eq_u32 s46, 0
    s_cbranch_scc1 P2_y
P2_ny:
    s_barrier
    ds_write_b128 v8, v[32:35] offset:0
    ds_write_b128 v8, v[36:39] offset:1024
    ds_write_b128 v8, v[40:43] offset:2048
    ds_write_b128 v8, v[44:47] offset:3072
    s_cmp_lg_u64 s[70:71], 0
    s_cbranch_scc1 P2_fix
P2_nr:
    s_waitcnt lgkmcnt(0)
    s_barrier
    ds_read_b128 v[64:67], v5 offset:0
    ds_read_b128 v[68:71], v5 offset:1024
    ds_read_b128 v[72:75], v5 offset:2048
    ds_read_b128 v[76:79], v5 offset:3072
    s_waitcnt lgkmcnt(2)
    v_pk_add_f32 v[16:17], v[16:17], v[64:65]
    v_pk_add_f32 v[18:19], v[18:19], v[66:67]
    v_pk_add_f32 v[20:21], v[20:21], v[68:69]
    v_pk_add_f32 v[22:23], v[22:23], v[70:71]
    v_cvt_pk_bf16_f32 v48, v16, v17
    v_cvt_pk_bf16_f32 v49, v18, v19
    v_cvt_pk_bf16_f32 v50, v20, v21
    v_cvt_pk_bf16_f32 v51, v22, v23
    s_nop 0
    v_permlane16_swap_b32 v48, v50
    v_permlane16_swap_b32 v49, v51
    v_lshlrev_b32 v16, 16, v48
    v_and_b32 v17, 0xffff0000, v48
    v_lshlrev_b32 v18, 16, v49
    v_and_b32 v19, 0xffff0000, v49
    v_lshlrev_b32 v20, 16, v50
    v_and_b32 v21, 0xffff0000, v50
    v_lshlrev_b32 v22, 16, v51
    v_and_b32 v23, 0xffff0000, v51
    v_pk_mul_f32 v[16:17], v[16:17], v[228:229] op_sel_hi:[1,0]
    v_pk_mul_f32 v[18:19], v[18:19], v[228:229] op_sel_hi:[1,0]
    v_pk_mul_f32 v[20:21], v[20:21], v[228:229] op_sel_hi:[1,0]
    v_pk_mul_f32 v[22:23], v[22:23], v[228:229] op_sel_hi:[1,0]
    v_cvt_pk_bf16_f32 v48, v16, v17
    v_cvt_pk_bf16_f32 v49, v18, v19
    v_cvt_pk_bf16_f32 v50, v20, v21
    v_cvt_pk_bf16_f32 v51, v22, v23
    v_lshlrev_b32 v16, 16, v48
    v_and_b32 v17, 0xffff0000, v48
    v_lshlrev_b32 v18, 16, v49
    v_and_b32 v19, 0xffff0000, v49
    v_lshlrev_b32 v20, 16, v50
    v_and_b32 v21, 0xffff0000, v50
    v_lshlrev_b32 v22, 16, v51
    v_and_b32 v23, 0xffff0000, v51
    v_pk_add_f32 v[16:17], v[16:17], v[232:233]
    v_pk_add_f32 v[18:19], v[18:19], v[234:235]
    v_pk_add_f32 v[20:21], v[20:21], v[236:237]
    v_pk_add_f32 v[22:23], v[22:23], v[238:239]
    v_cvt_pk_bf16_f32 v120, v16, v17
    v_cvt_pk_bf16_f32 v121, v18, v19
    v_cvt_pk_bf16_f32 v122, v20, v21
    v_cvt_pk_bf16_f32 v123, v22, v23
    v_and_b32 v6, 1, v2
    v_mul_u32_u24 v6, 1984, v6
    v_sub_u32 v231, v231, v6
    s_mov_b32 vcc_lo, 0x55555555
    s_mov_b32 vcc_hi, 0x55555555
    s_waitcnt lgkmcnt(0)
    v_pk_add_f32 v[24:25], v[24:25], v[72:73]
    v_pk_add_f32 v[26:27], v[26:27], v[74:75]
    v_pk_add_f32 v[28:29], v[28:29], v[76:77]
    v_pk_add_f32 v[30:31], v[30:31], v[78:79]
    v_cvt_pk_bf16_f32 v52, v24, v25
    v_cvt_pk_bf16_f32 v53, v26, v27
    v_cvt_pk_bf16_f32 v54, v28, v29
    v_cvt_pk_bf16_f32 v55, v30, v31
    s_nop 0
    v_permlane16_swap_b32 v52, v54
    v_permlane16_swap_b32 v53, v55
    v_lshlrev_b32 v24, 16, v52
    v_and_b32 v25, 0xffff0000, v52
    v_lshlrev_b32 v26, 16, v53
    v_and_b32 v27, 0xffff0000, v53
    v_lshlrev_b32 v28, 16, v54
    v_and_b32 v29, 0xffff0000, v54
    v_lshlrev_b32 v30, 16, v55
    v_and_b32 v31, 0xffff0000, v55
    v_pk_mul_f32 v[24:25], v[24:25], v[228:229] op_sel_hi:[1,0]
    v_pk_mul_f32 v[26:27], v[26:27], v[228:229] op_sel_hi:[1,0]
    v_pk_mul_f32 v[28:29], v[28:29], v[228:229] op_sel_hi:[1,0]
    v_pk_mul_f32 v[30:31], v[30:31], v[228:229] op_sel_hi:[1,0]
    v_cvt_pk_bf16_f32 v52, v24, v25
    v_cvt_pk_bf16_f32 v53, v26, v27
    v_cvt_pk_bf16_f32 v54, v28, v29
    v_cvt_pk_bf16_f32 v55, v30, v31
    v_lshlrev_b32 v24, 16, v52
    v_and_b32 v25, 0xffff0000, v52
    v_lshlrev_b32 v26, 16, v53
    v_and_b32 v27, 0xffff0000, v53
    v_lshlrev_b32 v28, 16, v54
    v_and_b32 v29, 0xffff0000, v54
    v_lshlrev_b32 v30, 16, v55
    v_and_b32 v31, 0xffff0000, v55
    v_pk_add_f32 v[24:25], v[24:25], v[240:241]
    v_pk_add_f32 v[26:27], v[26:27], v[242:243]
    v_pk_add_f32 v[28:29], v[28:29], v[244:245]
    v_pk_add_f32 v[30:31], v[30:31], v[246:247]
    v_cvt_pk_bf16_f32 v124, v24, v25
    v_cvt_pk_bf16_f32 v125, v26, v27
    v_cvt_pk_bf16_f32 v126, v28, v29
    v_cvt_pk_bf16_f32 v127, v30, v31
    s_nop 1
    v_cndmask_b32_dpp v56, v124, v120, vcc quad_perm:[1,0,3,2] row_mask:0xf bank_mask:0xf
    v_cndmask_b32_dpp v57, v125, v121, vcc quad_perm:[1,0,3,2] row_mask:0xf bank_mask:0xf
    v_cndmask_b32_dpp v58, v126, v122, vcc quad_perm:[1,0,3,2] row_mask:0xf bank_mask:0xf
    v_cndmask_b32_dpp v59, v127, v123, vcc quad_perm:[1,0,3,2] row_mask:0xf bank_mask:0xf
    buffer_store_dwordx4 v[56:59], v231, s[20:23], 0 offen nt
    s_not_b64 vcc, vcc
    v_cndmask_b32_dpp v60, v120, v124, vcc quad_perm:[1,0,3,2] row_mask:0xf bank_mask:0xf
    v_cndmask_b32_dpp v61, v121, v125, vcc quad_perm:[1,0,3,2] row_mask:0xf bank_mask:0xf
    v_cndmask_b32_dpp v62, v122, v126, vcc quad_perm:[1,0,3,2] row_mask:0xf bank_mask:0xf
    v_cndmask_b32_dpp v63, v123, v127, vcc quad_perm:[1,0,3,2] row_mask:0xf bank_mask:0xf
    buffer_store_dwordx4 v[60:63], v231, s[20:23], 0 offen offset:2048 nt
K_end:
    s_endpgm
H_nre:
    s_add_u32 s65, s65, 1
    s_cmp_ge_u32 s65, 200000
    s_cbranch_scc1 H_nok
    s_sleep 4
    buffer_load_dword v78, v79, s[20:23], 0 offen sc1
    s_waitcnt vmcnt(0)
    s_branch H_nspin
H_retry:
    s_add_u32 s65, s65, 1
    s_cmp_ge_u32 s65, 200000
    s_cbranch_scc1 H_nq
    s_sleep 8
    s_mov_b32 s64, 6717440
    buffer_load_dwordx4 v[24:27], v6, s[16:19], s64 offen offset:0 sc1
    buffer_load_dwordx4 v[28:31], v6, s[16:19], s64 offen offset:1024 sc1
    s_waitcnt vmcnt(0)
    s_branch H_spin
G_f15:
    s_bitset1_b32 s66, s55
    s_branch G_q15
G_f14:
    s_bitset1_b32 s66, s54
    s_branch G_q14
G_f13:
    s_bitset1_b32 s66, s53
    s_branch G_q13
G_f12:
    s_bitset1_b32 s66, s52
    s_branch G_q12
G_f11:
    s_bitset1_b32 s66, s51
    s_branch G_q11
G_f10:
    s_bitset1_b32 s66, s50
    s_branch G_q10
G_f9:
    s_bitset1_b32 s66, s49
    s_branch G_q9
G_f8:
    s_bitset1_b32 s66, s48
    s_branch G_q8
G_f7:
    s_bitset1_b32 s66, s47
    s_branch G_q7
G_f6:
    s_bitset1_b32 s66, s46
    s_branch G_q6
G_f5:
    s_bitset1_b32 s66, s45
    s_branch G_q5
G_f4:
    s_bitset1_b32 s66, s44
    s_branch G_q4
G_f3:
    s_bitset1_b32 s66, s43
    s_branch G_q3
G_f2:
    s_bitset1_b32 s66, s42
    s_branch G_q2
G_f1:
    s_bitset1_b32 s66, s41
    s_branch G_q1
G_f0:
    s_bitset1_b32 s66, s40
    s_branch G_q0
phi_15_fix:
    v_lshlrev_b32 v48, 16, v16
    v_and_b32 v49, 0xffff0000, v16
    v_add_f32 v48, s73, v48
    v_add_f32 v49, s73, v49
    v_cvt_pk_bf16_f32 v16, v48, v49
    v_lshlrev_b32 v48, 16, v17
    v_and_b32 v49, 0xffff0000, v17
    v_add_f32 v48, s73, v48
    v_add_f32 v49, s73, v49
    v_cvt_pk_bf16_f32 v17, v48, v49
    v_lshlrev_b32 v48, 16, v18
    v_and_b32 v49, 0xffff0000, v18
    v_add_f32 v48, s73, v48
    v_add_f32 v49, s73, v49
    v_cvt_pk_bf16_f32 v18, v48, v49
    v_lshlrev_b32 v48, 16, v19
    v_and_b32 v49, 0xffff0000, v19
    v_add_f32 v48, s73, v48
    v_add_f32 v49, s73, v49
    v_cvt_pk_bf16_f32 v19, v48, v49
    v_lshlrev_b32 v48, 16, v20
    v_and_b32 v49, 0xffff0000, v20
    v_add_f32 v48, s73, v48
    v_add_f32 v49, s73, v49
    v_cvt_pk_bf16_f32 v20, v48, v49
    v_lshlrev_b32 v48, 16, v21
    v_and_b32 v49, 0xffff0000, v21
    v_add_f32 v48, s73, v48
    v_add_f32 v49, s73, v49
    v_cvt_pk_bf16_f32 v21, v48, v49
    v_lshlrev_b32 v48, 16, v22
    v_and_b32 v49, 0xffff0000, v22
    v_add_f32 v48, s73, v48
    v_add_f32 v49, s73, v49
    v_cvt_pk_bf16_f32 v22, v48, v49
    v_lshlrev_b32 v48, 16, v23
    v_and_b32 v49, 0xffff0000, v23
    v_add_f32 v48, s73, v48
    v_add_f32 v49, s73, v49
    v_cvt_pk_bf16_f32 v23, v48, v49
    s_branch phi_15_done
phi_16_fix:
    v_lshlrev_b32 v48, 16, v24
    v_and_b32 v49, 0xffff0000, v24
    v_add_f32 v48, s73, v48
    v_add_f32 v49, s73, v49
    v_cvt_pk_bf16_f32 v24, v48, v49
    v_lshlrev_b32 v48, 16, v25
    v_and_b32 v49, 0xffff0000, v25
    v_add_f32 v48, s73, v48
    v_add_f32 v49, s73, v49
    v_cvt_pk_bf16_f32 v25, v48, v49
    v_lshlrev_b32 v48, 16, v26
    v_and_b32 v49, 0xffff0000, v26
    v_add_f32 v48, s73, v48
    v_add_f32 v49, s73, v49
    v_cvt_pk_bf16_f32 v26, v48, v49
    v_lshlrev_b32 v48, 16, v27
    v_and_b32 v49, 0xffff0000, v27
    v_add_f32 v48, s73, v48
    v_add_f32 v49, s73, v49
    v_cvt_pk_bf16_f32 v27, v48, v49
    v_lshlrev_b32 v48, 16, v28
    v_and_b32 v49, 0xffff0000, v28
    v_add_f32 v48, s73, v48
    v_add_f32 v49, s73, v49
    v_cvt_pk_bf16_f32 v28, v48, v49
    v_lshlrev_b32 v48, 16, v29
    v_and_b32 v49, 0xffff0000, v29
    v_add_f32 v48, s73, v48
    v_add_f32 v49, s73, v49
    v_cvt_pk_bf16_f32 v29, v48, v49
    v_lshlrev_b32 v48, 16, v30
    v_and_b32 v49, 0xffff0000, v30
    v_add_f32 v48, s73, v48
    v_add_f32 v49, s73, v49
    v_cvt_pk_bf16_f32 v30, v48, v49
    v_lshlrev_b32 v48, 16, v31
    v_and_b32 v49, 0xffff0000, v31
    v_add_f32 v48, s73, v48
    v_add_f32 v49, s73, v49
    v_cvt_pk_bf16_f32 v31, v48, v49
    s_branch phi_16_done
C_ex1:
    ds_write_b32 v227, v96 offset:4608
    ds_write_b128 v224, v[240:243] offset:32768
    ds_write_b128 v224, v[244:247] offset:33792
    s_nop 4
    v_mov_b32 v96, v60
    v_mov_b32 v240, v248
    v_mov_b32 v241, v249
    v_mov_b32 v242, v250
    v_mov_b32 v243, v251
    v_mov_b32 v244, v252
    v_mov_b32 v245, v253
    v_mov_b32 v246, v254
    v_mov_b32 v247, v255
    s_branch C_ex2
phi_17_fix:
    v_lshlrev_b32 v48, 16, v32
    v_and_b32 v49, 0xffff0000, v32
    v_add_f32 v48, s73, v48
    v_add_f32 v49, s73, v49
    v_cvt_pk_bf16_f32 v32, v48, v49
    v_lshlrev_b32 v48, 16, v33
    v_and_b32 v49, 0xffff0000, v33
    v_add_f32 v48, s73, v48
    v_add_f32 v49, s73, v49
    v_cvt_pk_bf16_f32 v33, v48, v49
    v_lshlrev_b32 v48, 16, v34
    v_and_b32 v49, 0xffff0000, v34
    v_add_f32 v48, s73, v48
    v_add_f32 v49, s73, v49
    v_cvt_pk_bf16_f32 v34, v48, v49
    v_lshlrev_b32 v48, 16, v35
    v_and_b32 v49, 0xffff0000, v35
    v_add_f32 v48, s73, v48
    v_add_f32 v49, s73, v49
    v_cvt_pk_bf16_f32 v35, v48, v49
    v_lshlrev_b32 v48, 16, v36
    v_and_b32 v49, 0xffff0000, v36
    v_add_f32 v48, s73, v48
    v_add_f32 v49, s73, v49
    v_cvt_pk_bf16_f32 v36, v48, v49
    v_lshlrev_b32 v48, 16, v37
    v_and_b32 v49, 0xffff0000, v37
    v_add_f32 v48, s73, v48
    v_add_f32 v49, s73, v49
    v_cvt_pk_bf16_f32 v37, v48, v49
    v_lshlrev_b32 v48, 16, v38
    v_and_b32 v49, 0xffff0000, v38
    v_add_f32 v48, s73, v48
    v_add_f32 v49, s73, v49
    v_cvt_pk_bf16_f32 v38, v48, v49
    v_lshlrev_b32 v48, 16, v39
    v_and_b32 v49, 0xffff0000, v39
    v_add_f32 v48, s73, v48
    v_add_f32 v49, s73, v49
    v_cvt_pk_bf16_f32 v39, v48, v49
    s_branch phi_17_done
phi_18_fix:
    v_lshlrev_b32 v48, 16, v40
    v_and_b32 v49, 0xffff0000, v40
    v_add_f32 v48, s73, v48
    v_add_f32 v49, s73, v49
    v_cvt_pk_bf16_f32 v40, v48, v49
    v_lshlrev_b32 v48, 16, v41
    v_and_b32 v49, 0xffff0000, v41
    v_add_f32 v48, s73, v48
    v_add_f32 v49, s73, v49
    v_cvt_pk_bf16_f32 v41, v48, v49
    v_lshlrev_b32 v48, 16, v42
    v_and_b32 v49, 0xffff0000, v42
    v_add_f32 v48, s73, v48
    v_add_f32 v49, s73, v49
    v_cvt_pk_bf16_f32 v42, v48, v49
    v_lshlrev_b32 v48, 16, v43
    v_and_b32 v49, 0xffff0000, v43
    v_add_f32 v48, s73, v48
    v_add_f32 v49, s73, v49
    v_cvt_pk_bf16_f32 v43, v48, v49
    v_lshlrev_b32 v48, 16, v44
    v_and_b32 v49, 0xffff0000, v44
    v_add_f32 v48, s73, v48
    v_add_f32 v49, s73, v49
    v_cvt_pk_bf16_f32 v44, v48, v49
    v_lshlrev_b32 v48, 16, v45
    v_and_b32 v49, 0xffff0000, v45
    v_add_f32 v48, s73, v48
    v_add_f32 v49, s73, v49
    v_cvt_pk_bf16_f32 v45, v48, v49
    v_lshlrev_b32 v48, 16, v46
    v_and_b32 v49, 0xffff0000, v46
    v_add_f32 v48, s73, v48
    v_add_f32 v49, s73, v49
    v_cvt_pk_bf16_f32 v46, v48, v49
    v_lshlrev_b32 v48, 16, v47
    v_and_b32 v49, 0xffff0000, v47
    v_add_f32 v48, s73, v48
    v_add_f32 v49, s73, v49
    v_cvt_pk_bf16_f32 v47, v48, v49
    s_branch phi_18_done
P2_ys:
    v_lshrrev_b32 v13, 4, v2
    v_lshlrev_b32 v13, 12, v13
    v_and_b32 v208, 15, v2
    v_lshl_add_u32 v13, v208, 4, v13
    s_lshl_b32 s64, s5, 8
    v_add_u32 v13, s64, v13
    s_lshl_b32 s64, s67, 11
    s_lshl_b32 s65, s5, 7
    s_add_u32 s64, s64, s65
    v_lshl_add_u32 v209, v208, 3, s64
    s_lshl_b32 s64, s67, 2
    s_add_u32 s64, s64, 6709248
    v_mov_b32 v215, s64
    s_branch P2_ysd
P2_yl:
    s_cmp_gt_u32 s70, 4
    s_cbranch_scc1 P2_nyl
    buffer_load_dwordx2 v[210:211], v209, s[8:11], 0 offen
    buffer_load_dword v212, v215, s[16:19], 0 offen sc1
    s_mov_b32 s69, 6447104
    buffer_load_dwordx4 v[144:147], v13, s[16:19], s69 offen sc1
    s_mov_b32 s69, 6463488
    buffer_load_dwordx4 v[148:151], v13, s[16:19], s69 offen sc1
    s_mov_b32 s69, 6479872
    buffer_load_dwordx4 v[152:155], v13, s[16:19], s69 offen sc1
    s_mov_b32 s69, 6496256
    buffer_load_dwordx4 v[156:159], v13, s[16:19], s69 offen sc1
    s_mov_b32 s69, 6512640
    buffer_load_dwordx4 v[160:163], v13, s[16:19], s69 offen sc1
    s_mov_b32 s69, 6529024
    buffer_load_dwordx4 v[164:167], v13, s[16:19], s69 offen sc1
    s_mov_b32 s69, 6545408
    buffer_load_dwordx4 v[168:171], v13, s[16:19], s69 offen sc1
    s_mov_b32 s69, 6561792
    buffer_load_dwordx4 v[172:175], v13, s[16:19], s69 offen sc1
    s_mov_b32 s69, 6578176
    buffer_load_dwordx4 v[176:179], v13, s[16:19], s69 offen sc1
    s_mov_b32 s69, 6594560
    buffer_load_dwordx4 v[180:183], v13, s[16:19], s69 offen sc1
    s_mov_b32 s69, 6610944
    buffer_load_dwordx4 v[184:187], v13, s[16:19], s69 offen sc1
    s_mov_b32 s69, 6627328
    buffer_load_dwordx4 v[188:191], v13, s[16:19], s69 offen sc1
    s_mov_b32 s69, 6643712
    buffer_load_dwordx4 v[192:195], v13, s[16:19], s69 offen sc1
    s_mov_b32 s69, 6660096
    buffer_load_dwordx4 v[196:199], v13, s[16:19], s69 offen sc1
    s_mov_b32 s69, 6676480
    buffer_load_dwordx4 v[200:203], v13, s[16:19], s69 offen sc1
    s_mov_b32 s69, 6692864
    buffer_load_dwordx4 v[204:207], v13, s[16:19], s69 offen sc1
    s_mov_b32 s47, 1
    s_branch P2_nyl
P2_y:
    s_mov_b32 s66, 0
    s_cmp_lg_u32 s47, 0
    s_cbranch_scc1 P2_ychk
P2_yre:
    buffer_load_dwordx2 v[210:211], v209, s[8:11], 0 offen
    buffer_load_dword v212, v215, s[16:19], 0 offen sc1
    s_mov_b32 s69, 6447104
    buffer_load_dwordx4 v[144:147], v13, s[16:19], s69 offen sc1
    s_mov_b32 s69, 6463488
    buffer_load_dwordx4 v[148:151], v13, s[16:19], s69 offen sc1
    s_mov_b32 s69, 6479872
    buffer_load_dwordx4 v[152:155], v13, s[16:19], s69 offen sc1
    s_mov_b32 s69, 6496256
    buffer_load_dwordx4 v[156:159], v13, s[16:19], s69 offen sc1
    s_mov_b32 s69, 6512640
    buffer_load_dwordx4 v[160:163], v13, s[16:19], s69 offen sc1
    s_mov_b32 s69, 6529024
    buffer_load_dwordx4 v[164:167], v13, s[16:19], s69 offen sc1
    s_mov_b32 s69, 6545408
    buffer_load_dwordx4 v[168:171], v13, s[16:19], s69 offen sc1
    s_mov_b32 s69, 6561792
    buffer_load_dwordx4 v[172:175], v13, s[16:19], s69 offen sc1
    s_mov_b32 s69, 6578176
    buffer_load_dwordx4 v[176:179], v13, s[16:19], s69 offen sc1
    s_mov_b32 s69, 6594560
    buffer_load_dwordx4 v[180:183], v13, s[16:19], s69 offen sc1
    s_mov_b32 s69, 6610944
    buffer_load_dwordx4 v[184:187], v13, s[16:19], s69 offen sc1
    s_mov_b32 s69, 6627328
    buffer_load_dwordx4 v[188:191], v13, s[16:19], s69 offen sc1
    s_mov_b32 s69, 6643712
    buffer_load_dwordx4 v[192:195], v13, s[16:19], s69 offen sc1
    s_mov_b32 s69, 6660096
    buffer_load_dwordx4 v[196:199], v13, s[16:19], s69 offen sc1
    s_mov_b32 s69, 6676480
    buffer_load_dwordx4 v[200:203], v13, s[16:19], s69 offen sc1
    s_mov_b32 s69, 6692864
    buffer_load_dwordx4 v[204:207], v13, s[16:19], s69 offen sc1
P2_ychk:
    s_and_b32 s64, s75, 0xffff0000
    s_xor_b32 s65, s64, 0x80000000
    s_not_b32 s69, s64
    s_and_b32 s69, s69, 0xffff0000
    s_cmp_ge_u32 s64, 0x80000000
    s_cselect_b32 s64, s65, s69
    v_mov_b32 v213, s64
    v_mul_f32 v213, s72, v213
    v_exp_f32 v213, -v213
    s_nop 0
    v_add_f32 v213, 1.0, v213
    v_rcp_f32 v213, v213
    s_nop 0
    v_cvt_pk_bf16_f32 v213, v213, v213
    v_lshlrev_b32 v213, 16, v213
    s_waitcnt vmcnt(0)
    v_sub_f32 v214, 1.0, v212
    v_cvt_pk_bf16_f32 v214, v214, v214
    v_lshlrev_b32 v214, 16, v214
    v_max3_u32 v10, v144, v145, v146
    v_max3_u32 v10, v147, v148, v10
    v_max3_u32 v10, v149, v150, v10
    v_max3_u32 v10, v151, v152, v10
    v_max3_u32 v10, v153, v154, v10
    v_max3_u32 v10, v155, v156, v10
    v_max3_u32 v10, v157, v158, v10
    v_max3_u32 v10, v159, v160, v10
    v_max3_u32 v10, v161, v162, v10
    v_max3_u32 v10, v163, v164, v10
    v_max3_u32 v10, v165, v166, v10
    v_max3_u32 v10, v167, v168, v10
    v_max3_u32 v10, v169, v170, v10
    v_max3_u32 v10, v171, v172, v10
    v_max3_u32 v10, v173, v174, v10
    v_max3_u32 v10, v175, v176, v10
    v_max3_u32 v10, v177, v178, v10
    v_max3_u32 v10, v179, v180, v10
    v_max3_u32 v10, v181, v182, v10
    v_max3_u32 v10, v183, v184, v10
    v_max3_u32 v10, v185, v186, v10
    v_max3_u32 v10, v187, v188, v10
    v_max3_u32 v10, v189, v190, v10
    v_max3_u32 v10, v191, v192, v10
    v_max3_u32 v10, v193, v194, v10
    v_max3_u32 v10, v195, v196, v10
    v_max3_u32 v10, v197, v198, v10
    v_max3_u32 v10, v199, v200, v10
    v_max3_u32 v10, v201, v202, v10
    v_max3_u32 v10, v203, v204, v10
    v_max3_u32 v10, v205, v206, v10
    v_max_u32 v10, v207, v10
    v_cmp_eq_u32 vcc, -1, v10
    s_cbranch_vccz P2_yok
    s_add_u32 s66, s66, 1
    s_cmp_ge_u32 s66, 40000
    s_cbranch_scc1 P2_yok
    s_sleep 4
    s_branch P2_yre
P2_yok:
    v_pk_add_f32 v[144:145], v[144:145], v[176:177]
    v_pk_add_f32 v[146:147], v[146:147], v[178:179]
    v_pk_add_f32 v[148:149], v[148:149], v[180:181]
    v_pk_add_f32 v[150:151], v[150:151], v[182:183]
    v_pk_add_f32 v[152:153], v[152:153], v[184:185]
    v_pk_add_f32 v[154:155], v[154:155], v[186:187]
    v_pk_add_f32 v[156:157], v[156:157], v[188:189]
    v_pk_add_f32 v[158:159], v[158:159], v[190:191]
    v_pk_add_f32 v[160:161], v[160:161], v[192:193]
    v_pk_add_f32 v[162:163], v[162:163], v[194:195]
    v_pk_add_f32 v[164:165], v[164:165], v[196:197]
    v_pk_add_f32 v[166:167], v[166:167], v[198:199]
    v_pk_add_f32 v[168:169], v[168:169], v[200:201]
    v_pk_add_f32 v[170:171], v[170:171], v[202:203]
    v_pk_add_f32 v[172:173], v[172:173], v[204:205]
    v_pk_add_f32 v[174:175], v[174:175], v[206:207]
    v_pk_add_f32 v[144:145], v[144:145], v[160:161]
    v_pk_add_f32 v[146:147], v[146:147], v[162:163]
    v_pk_add_f32 v[148:149], v[148:149], v[164:165]
    v_pk_add_f32 v[150:151], v[150:151], v[166:167]
    v_pk_add_f32 v[152:153], v[152:153], v[168:169]
    v_pk_add_f32 v[154:155], v[154:155], v[170:171]
    v_pk_add_f32 v[156:157], v[156:157], v[172:173]
    v_pk_add_f32 v[158:159], v[158:159], v[174:175]
    v_pk_add_f32 v[144:145], v[144:145], v[152:153]
    v_pk_add_f32 v[146:147], v[146:147], v[154:155]
    v_pk_add_f32 v[148:149], v[148:149], v[156:157]
    v_pk_add_f32 v[150:151], v[150:151], v[158:159]
    v_pk_add_f32 v[144:145], v[144:145], v[148:149]
    v_pk_add_f32 v[146:147], v[146:147], v[150:151]
    v_mov_b32 v148, v144
    v_mov_b32 v149, v145
    v_mov_b32 v150, v146
    v_mov_b32 v151, v147
    s_nop 0
    v_permlane16_swap_b32 v144, v148
    v_permlane16_swap_b32 v145, v149
    v_permlane16_swap_b32 v146, v150
    v_permlane16_swap_b32 v147, v151
    v_add_f32 v144, v144, v148
    v_add_f32 v145, v145, v149
    v_add_f32 v146, v146, v150
    v_add_f32 v147, v147, v151
    v_mov_b32 v148, v144
    v_mov_b32 v149, v145
    v_mov_b32 v150, v146
    v_mov_b32 v151, v147
    s_nop 0
    v_permlane32_swap_b32 v144, v148
    v_permlane32_swap_b32 v145, v149
    v_permlane32_swap_b32 v146, v150
    v_permlane32_swap_b32 v147, v151
    v_add_f32 v144, v144, v148
    v_add_f32 v145, v145, v149
    v_add_f32 v146, v146, v150
    v_add_f32 v147, v147, v151
    v_cvt_pk_bf16_f32 v152, v144, v145
    v_lshlrev_b32 v144, 16, v152
    v_and_b32 v145, 0xffff0000, v152
    v_mul_f32 v144, v144, v213
    v_mul_f32 v145, v145, v213
    v_cvt_pk_bf16_f32 v152, v144, v145
    v_lshlrev_b32 v144, 16, v152
    v_and_b32 v145, 0xffff0000, v152
    v_lshlrev_b32 v148, 16, v210
    v_and_b32 v149, 0xffff0000, v210
    v_add_f32 v144, v148, v144
    v_add_f32 v145, v149, v145
    v_cvt_pk_bf16_f32 v152, v144, v145
    v_lshlrev_b32 v144, 16, v152
    v_and_b32 v145, 0xffff0000, v152
    v_mul_f32 v144, v144, v214
    v_mul_f32 v145, v145, v214
    v_cvt_pk_bf16_f32 v152, v144, v145
    v_lshlrev_b32 v144, 16, v152
    v_and_b32 v145, 0xffff0000, v152
    v_cvt_pk_bf16_f32 v152, v146, v147
    v_lshlrev_b32 v146, 16, v152
    v_and_b32 v147, 0xffff0000, v152
    v_mul_f32 v146, v146, v213
    v_mul_f32 v147, v147, v213
    v_cvt_pk_bf16_f32 v152, v146, v147
    v_lshlrev_b32 v146, 16, v152
    v_and_b32 v147, 0xffff0000, v152
    v_lshlrev_b32 v150, 16, v211
    v_and_b32 v151, 0xffff0000, v211
    v_add_f32 v146, v150, v146
    v_add_f32 v147, v151, v147
    v_cvt_pk_bf16_f32 v152, v146, v147
    v_lshlrev_b32 v146, 16, v152
    v_and_b32 v147, 0xffff0000, v152
    v_mul_f32 v146, v146, v214
    v_mul_f32 v147, v147, v214
    v_cvt_pk_bf16_f32 v152, v146, v147
    v_lshlrev_b32 v146, 16, v152
    v_and_b32 v147, 0xffff0000, v152
    v_lshlrev_b32 v208, 4, v208
    ds_write_b128 v208, v[144:147] offset:5632
    s_waitcnt lgkmcnt(0)
    s_branch P2_ny
P2_fix:
    s_mov_b64 exec, s[70:71]
    ds_read_b128 v[232:235], v9 offset:5632
    ds_read_b128 v[236:239], v9 offset:5648
    ds_read_b128 v[240:243], v9 offset:5760
    ds_read_b128 v[244:247], v9 offset:5776
    s_mov_b64 exec, -1
    s_branch P2_nr
CODE_END:
.section .rodata,"a"
.p2align 6
.amdhsa_kernel gated_mix__linear_attn_block__moe_arch_mod__prompt_kernel
  .amdhsa_next_free_vgpr 256
  .amdhsa_next_free_sgpr 102
  .amdhsa_accum_offset 256
  .amdhsa_group_segment_fixed_size 0
  .amdhsa_kernarg_size 96
  .amdhsa_user_sgpr_count 2
  .amdhsa_user_sgpr_kernarg_segment_ptr 1
  .amdhsa_system_sgpr_workgroup_id_x 1
.end_amdhsa_kernel
```

```asm
; @launch grid=(256,1,1) block=(512,1,1) lds=163840
.amdgcn_target "amdgcn-amd-amdhsa--gfx950"
.text
.globl gated_mix__linear_attn_block__moe_arch_mod__prompt_kernel
.p2align 8
.type gated_mix__linear_attn_block__moe_arch_mod__prompt_kernel,@function
gated_mix__linear_attn_block__moe_arch_mod__prompt_kernel:
    s_load_dwordx16 s[40:55], s[0:1], 0
    s_load_dwordx8 s[56:63], s[0:1], 64
    s_cmp_ge_u32 s2, 256
    s_cbranch_scc1 K_end
    v_lshrrev_b32 v1, 6, v0
    v_and_b32 v2, 63, v0
    s_and_b32 s6, s2, 7
    v_readfirstlane_b32 s3, v1
    s_lshr_b32 s7, s2, 3
    s_and_b32 s4, s6, 1
    s_lshl_b32 s4, s4, 3
    s_and_b32 s64, s7, 7
    s_add_u32 s4, s4, s64
    s_lshr_b32 s5, s6, 1
    s_lshl_b32 s5, s5, 2
    s_lshr_b32 s64, s7, 3
    s_add_u32 s5, s5, s64
    s_and_b32 s74, s4, 3
    s_lshl_b32 s74, s74, 2
    s_add_u32 s74, s74, s6
    v_lshrrev_b32 v6, 3, v2
    s_lshl_b32 s65, s3, 3
    v_add_u32 v6, s65, v6
    s_lshl_b32 s64, s4, 7
    v_add_u32 v7, s64, v6
    v_lshlrev_b32 v7, 11, v7
    v_lshrrev_b32 v8, 4, v2
    s_and_b32 s64, s3, 1
    s_lshl_b32 s64, s64, 2
    v_add_u32 v9, s64, v8
    v_and_b32 v10, 7, v2
    v_xor_b32 v9, v9, v10
    v_lshl_add_u32 v7, v9, 4, v7
    v_mul_u32_u24 v6, 6144, v6
    v_and_b32 v9, 1, v8
    s_lshr_b32 s64, s64, 1
    v_lshl_add_u32 v9, v9, 2, s64
    v_xor_b32 v9, v9, v10
    v_lshl_add_u32 v6, v9, 4, v6
    s_lshl_b32 s64, s5, 7
    v_add_u32 v6, s64, v6
    s_lshl_b32 s66, s3, 10
    s_mov_b32 s10, 4194304
    s_mov_b32 s11, 0x00020000
    s_mov_b32 s14, 6291456
    s_mov_b32 s15, 0x00020000
    s_add_u32 s65, s74, 0
    s_and_b32 s65, s65, 15
    s_lshl_b32 s67, s65, 7
    s_mul_i32 s65, s65, 393216
    s_waitcnt lgkmcnt(0)
    s_mov_b32 s8, s40
    s_mov_b32 s9, s41
    s_mov_b32 s12, s42
    s_mov_b32 s13, s43
    s_add_u32 m0, s66, 8192
    s_add_u32 s64, s67, 0
    buffer_load_dwordx4 v7, s[8:11], s64 offen lds
    s_add_u32 m0, s66, 16384
    s_add_u32 s64, s67, 131072
    buffer_load_dwordx4 v7, s[8:11], s64 offen lds
    s_add_u32 m0, s66, 24576
    s_add_u32 s64, s65, 0
    buffer_load_dwordx4 v6, s[12:15], s64 offen lds
    s_add_u32 m0, s66, 32768
    s_add_u32 s64, s65, 2048
    buffer_load_dwordx4 v6, s[12:15], s64 offen lds
    s_add_u32 m0, s66, 40960
    s_add_u32 s64, s65, 4096
    buffer_load_dwordx4 v6, s[12:15], s64 offen lds
    s_cmp_lt_u32 s3, 4
    s_cbranch_scc1 K_nt
    s_lshl_b32 s64, s2, 2
    s_add_u32 s64, s64, s3
    s_sub_u32 s64, s64, 4
    s_mul_i32 s64, s64, 6144
    s_add_u32 s46, s12, s64
    s_addc_u32 s47, s13, 0
    s_load_dword s43, s[46:47], 384
    s_load_dword s43, s[46:47], 448
    s_load_dword s43, s[46:47], 1408
    s_load_dword s43, s[46:47], 1472
    s_load_dword s43, s[46:47], 2432
    s_load_dword s43, s[46:47], 2496
    s_load_dword s43, s[46:47], 3456
    s_load_dword s43, s[46:47], 3520
    s_load_dword s43, s[46:47], 4480
    s_load_dword s43, s[46:47], 4544
    s_load_dword s43, s[46:47], 5504
    s_load_dword s43, s[46:47], 5568
K_nt:
    s_barrier
    s_mov_b32 s72, 0x3fb8aa3b
    s_mov_b32 s73, 0x358637bd
    s_mov_b32 s16, s62
    s_mov_b32 s17, s63
    s_mov_b32 s18, 0x10000000
    s_mov_b32 s19, 0x00020000
    s_cmp_lt_u32 s3, 4
    s_cbranch_scc1 C_start
    s_sub_u32 s6, s3, 4
    s_lshl_b32 s7, s6, 10
    v_lshrrev_b32 v6, 3, v2
    s_lshl_b32 s64, s4, 7
    s_lshl_b32 s65, s6, 3
    s_add_u32 s64, s64, s65
    v_add_u32 v7, s64, v6
    v_lshlrev_b32 v7, 11, v7
    s_and_b32 s64, s6, 1
    s_lshl_b32 s64, s64, 2
    v_add_u32 v9, s64, v8
    v_xor_b32 v9, v9, v10
    v_lshl_add_u32 v4, v9, 4, v7
    v_add_u32 v7, s65, v6
    v_mul_u32_u24 v7, 6144, v7
    v_and_b32 v9, 1, v8
    s_lshr_b32 s64, s64, 1
    v_lshl_add_u32 v9, v9, 2, s64
    v_xor_b32 v9, v9, v10
    v_lshl_add_u32 v7, v9, 4, v7
    s_lshl_b32 s64, s5, 7
    v_add_u32 v5, s64, v7
    v_lshlrev_b32 v6, 4, v2
    s_and_b32 s64, s2, 1
    s_lshl_b32 s68, s64, 10
    s_bfe_u32 s64, s2, 0x20001
    s_lshl_b32 s64, s64, 8
    s_add_u32 s68, s68, s64
    s_and_b32 s64, s2, 0xf8
    s_add_u32 s68, s68, s64
    s_lshl_b32 s64, s6, 1
    s_add_u32 s68, s68, s64
    s_lshl_b32 s64, s68, 11
    v_add_u32 v13, s64, v6
    s_add_u32 s41, s74, 1
    s_and_b32 s41, s41, 15
    s_lshl_b32 s42, s41, 7
    s_mul_i32 s41, s41, 393216
    s_add_u32 m0, s7, 49152
    s_add_u32 s40, s42, 0
    buffer_load_dwordx4 v4, s[8:11], s40 offen lds
    s_add_u32 m0, s7, 53248
    s_add_u32 s40, s42, 65536
    buffer_load_dwordx4 v4, s[8:11], s40 offen lds
    s_add_u32 m0, s7, 57344
    s_add_u32 s40, s42, 131072
    buffer_load_dwordx4 v4, s[8:11], s40 offen lds
    s_add_u32 m0, s7, 61440
    s_add_u32 s40, s42, 196608
    buffer_load_dwordx4 v4, s[8:11], s40 offen lds
    s_add_u32 m0, s7, 65536
    s_add_u32 s40, s41, 0
    buffer_load_dwordx4 v5, s[12:15], s40 offen lds
    s_add_u32 m0, s7, 69632
    s_add_u32 s40, s41, 196608
    buffer_load_dwordx4 v5, s[12:15], s40 offen lds
    s_add_u32 m0, s7, 73728
    s_add_u32 s40, s41, 2048
    buffer_load_dwordx4 v5, s[12:15], s40 offen lds
    s_add_u32 m0, s7, 77824
    s_add_u32 s40, s41, 198656
    buffer_load_dwordx4 v5, s[12:15], s40 offen lds
    s_add_u32 m0, s7, 81920
    s_add_u32 s40, s41, 4096
    buffer_load_dwordx4 v5, s[12:15], s40 offen lds
    s_add_u32 m0, s7, 86016
    s_add_u32 s40, s41, 200704
    buffer_load_dwordx4 v5, s[12:15], s40 offen lds
    s_mov_b32 s32, s50
    s_mov_b32 s33, s51
    s_mov_b32 s34, 0x700000
    s_mov_b32 s35, 0x00020000
    s_mov_b32 s36, s52
    s_mov_b32 s37, s53
    s_mov_b32 s38, 0x700000
    s_mov_b32 s39, 0x00020000
    s_or_b32 s64, s2, s6
    s_cmp_lg_u32 s64, 0
    s_cbranch_scc1 H_nn
    s_mov_b32 s64, 6717440
    s_load_dwordx2 s[66:67], s[62:63], s64
    s_mov_b32 s20, s60
    s_mov_b32 s21, s61
    s_mov_b32 s22, 0x100
    s_mov_b32 s23, 0x00020000
    s_waitcnt lgkmcnt(0)
    s_xor_b32 s64, s66, s67
    s_add_u32 s64, s64, 1
    s_max_u32 s64, s64, 1
    v_mov_b32 v72, s64
    v_mov_b32 v73, 0
    s_mov_b64 exec, 1
    buffer_store_dword v72, v73, s[20:23], 0 offen sc0 sc1
    s_mov_b64 exec, -1
H_nn:
    s_mov_b32 s20, s60
    s_mov_b32 s21, s61
    s_mov_b32 s22, 0x100
    s_mov_b32 s23, 0x00020000
    s_mov_b32 s24, s48
    s_mov_b32 s25, s49
    s_mov_b32 s26, 0x800
    s_mov_b32 s27, 0x00020000
    s_mov_b32 s28, s56
    s_mov_b32 s29, s57
    s_mov_b32 s30, 0x800
    s_mov_b32 s31, 0x00020000
    s_lshr_b32 s69, s2, 3
    s_and_b32 s64, s2, 7
    v_and_b32 v9, 15, v2
    v_min_u32 v9, 13, v9
    s_lshl_b32 s65, s69, 5
    v_lshl_add_u32 v7, v8, 3, s65
    v_mul_u32_u24 v7, 7168, v7
    s_mul_i32 s65, s64, 896
    s_mul_i32 s66, s6, 224
    s_add_u32 s65, s65, s66
    v_lshl_add_u32 v7, v9, 4, v7
    v_add_u32 v11, s65, v7
    v_cmp_le_u32 vcc, 7, v9
    v_mov_b32 v15, 16160
    s_nop 0
    v_cndmask_b32 v7, 0, v15, vcc
    v_lshl_add_u32 v7, v9, 5, v7
    v_lshrrev_b32 v15, 1, v8
    v_lshl_add_u32 v7, v15, 13, v7
    v_and_b32 v15, 1, v8
    v_lshl_add_u32 v7, v15, 4, v7
    s_lshl_b32 s64, s64, 17
    s_lshl_b32 s65, s6, 15
    s_add_u32 s64, s64, s65
    s_lshl_b32 s65, s69, 8
    s_add_u32 s64, s64, s65
    s_add_u32 s64, s64, 5398528
    v_add_u32 v12, s64, v7
    s_lshl_b32 s70, s5, 2
    s_add_u32 s70, s70, s6
    s_mul_i32 s70, s70, 18432
    s_add_u32 s70, s70, 4194304
    s_mul_i32 s64, s4, 1152
    s_add_u32 s64, s64, s70
    s_mov_b32 s67, s64
    v_lshl_add_u32 v15, v2, 2, s64
    v_add_u32 v15, 960, v15
    s_lshl_b32 s64, s5, 2
    s_add_u32 s64, s64, s6
    s_lshl_b32 s64, s64, 7
    s_add_u32 s64, s64, 5373952
    v_mov_b32 v23, s64
    s_lshl_b32 s65, s4, 10
    s_add_u32 s65, s65, 5382016
    v_lshl_add_u32 v20, v2, 7, s65
    v_cmp_gt_u32 vcc, 16, v2
    s_nop 1
    v_cndmask_b32 v15, v15, v20, vcc
    v_writelane_b32 v15, s64, 0
    s_cmp_eq_u32 s4, 0
    s_cselect_b32 s75, 1, 0
    s_or_b32 s64, s5, s6
    s_cmp_eq_u32 s64, 0
    s_cselect_b32 s64, 0x1fe, 0
    s_or_b32 s75, s75, s64
    s_or_b32 s75, s75, 0xffff0000
    v_lshlrev_b32 v22, 4, v2
    v_add_u32 v22, s67, v22
    v_mov_b32 v16, -1
    v_mov_b32 v17, -1
    v_mov_b32 v18, -1
    v_mov_b32 v19, -1
    v_cndmask_b32 v20, -1, 0, vcc
    s_waitcnt vmcnt(10)
    s_barrier
    s_add_u32 s41, s74, 2
    s_and_b32 s41, s41, 15
    s_lshl_b32 s42, s41, 7
    s_mul_i32 s41, s41, 393216
    s_add_u32 m0, s7, 90112
    s_add_u32 s40, s42, 0
    buffer_load_dwordx4 v4, s[8:11], s40 offen lds
    s_add_u32 m0, s7, 94208
    s_add_u32 s40, s42, 65536
    buffer_load_dwordx4 v4, s[8:11], s40 offen lds
    s_add_u32 m0, s7, 98304
    s_add_u32 s40, s42, 131072
    buffer_load_dwordx4 v4, s[8:11], s40 offen lds
    s_add_u32 m0, s7, 102400
    s_add_u32 s40, s42, 196608
    buffer_load_dwordx4 v4, s[8:11], s40 offen lds
    s_add_u32 m0, s7, 106496
    s_add_u32 s40, s41, 0
    buffer_load_dwordx4 v5, s[12:15], s40 offen lds
    s_add_u32 m0, s7, 110592
    s_add_u32 s40, s41, 196608
    buffer_load_dwordx4 v5, s[12:15], s40 offen lds
    s_add_u32 m0, s7, 114688
    s_add_u32 s40, s41, 2048
    buffer_load_dwordx4 v5, s[12:15], s40 offen lds
    s_add_u32 m0, s7, 118784
    s_add_u32 s40, s41, 198656
    buffer_load_dwordx4 v5, s[12:15], s40 offen lds
    s_add_u32 m0, s7, 122880
    s_add_u32 s40, s41, 4096
    buffer_load_dwordx4 v5, s[12:15], s40 offen lds
    s_add_u32 m0, s7, 126976
    s_add_u32 s40, s41, 200704
    buffer_load_dwordx4 v5, s[12:15], s40 offen lds
    s_getpc_b64 s[66:67]
pc_1:
    s_sub_u32 s66, s66, pc_1-gated_mix__linear_attn_block__moe_arch_mod__prompt_kernel
    s_subb_u32 s67, s67, 0
    s_lshr_b32 s64, s2, 3
    s_lshl_b32 s64, s64, 2
    s_add_u32 s64, s64, s6
    s_mul_i32 s64, s64, 256
    s_min_u32 s65, s64, CODE_END-gated_mix__linear_attn_block__moe_arch_mod__prompt_kernel-4
    s_load_dword s43, s[66:67], s65
    s_add_u32 s64, s64, 64
    s_min_u32 s65, s64, CODE_END-gated_mix__linear_attn_block__moe_arch_mod__prompt_kernel-4
    s_load_dword s43, s[66:67], s65
    s_add_u32 s64, s64, 64
    s_min_u32 s65, s64, CODE_END-gated_mix__linear_attn_block__moe_arch_mod__prompt_kernel-4
    s_load_dword s43, s[66:67], s65
    s_add_u32 s64, s64, 64
    s_min_u32 s65, s64, CODE_END-gated_mix__linear_attn_block__moe_arch_mod__prompt_kernel-4
    s_load_dword s43, s[66:67], s65
    s_add_u32 s64, s64, 64
    buffer_load_dwordx4 v[24:27], v13, s[8:11], 0 offen offset:0
    buffer_load_dwordx4 v[28:31], v13, s[8:11], 0 offen offset:1024
    buffer_load_dwordx4 v[32:35], v13, s[8:11], 0 offen offset:2048
    buffer_load_dwordx4 v[36:39], v13, s[8:11], 0 offen offset:3072
    s_cmp_lt_u32 s6, 2
    s_cselect_b32 s24, s48, s56
    s_cselect_b32 s25, s49, s57
    s_and_b32 s64, s7, 1024
    s_add_u32 m0, s7, 0
    s_nop 0
    buffer_load_dwordx4 v6, s[24:27], s64 offen lds
    s_waitcnt vmcnt(15)
    s_barrier
    s_add_u32 s41, s74, 3
    s_and_b32 s41, s41, 15
    s_lshl_b32 s42, s41, 7
    s_mul_i32 s41, s41, 393216
    s_add_u32 m0, s7, 8192
    s_add_u32 s40, s42, 0
    buffer_load_dwordx4 v4, s[8:11], s40 offen lds
    s_add_u32 m0, s7, 12288
    s_add_u32 s40, s42, 65536
    buffer_load_dwordx4 v4, s[8:11], s40 offen lds
    s_add_u32 m0, s7, 16384
    s_add_u32 s40, s42, 131072
    buffer_load_dwordx4 v4, s[8:11], s40 offen lds
    s_add_u32 m0, s7, 20480
    s_add_u32 s40, s42, 196608
    buffer_load_dwordx4 v4, s[8:11], s40 offen lds
    s_add_u32 m0, s7, 24576
    s_add_u32 s40, s41, 0
    buffer_load_dwordx4 v5, s[12:15], s40 offen lds
    s_add_u32 m0, s7, 28672
    s_add_u32 s40, s41, 196608
    buffer_load_dwordx4 v5, s[12:15], s40 offen lds
    s_add_u32 m0, s7, 32768
    s_add_u32 s40, s41, 2048
    buffer_load_dwordx4 v5, s[12:15], s40 offen lds
    s_add_u32 m0, s7, 36864
    s_add_u32 s40, s41, 198656
    buffer_load_dwordx4 v5, s[12:15], s40 offen lds
    s_add_u32 m0, s7, 40960
    s_add_u32 s40, s41, 4096
    buffer_load_dwordx4 v5, s[12:15], s40 offen lds
    s_add_u32 m0, s7, 45056
    s_add_u32 s40, s41, 200704
    buffer_load_dwordx4 v5, s[12:15], s40 offen lds
    buffer_store_dwordx4 v[16:19], v22, s[16:19], 0 offen sc0 sc1
    s_mov_b32 exec_lo, s75
    s_mov_b32 exec_hi, 0
    buffer_store_dword v20, v15, s[16:19], 0 offen sc0 sc1
    s_mov_b32 exec_lo, 0x3fff3fff
    s_mov_b32 exec_hi, 0x3fff3fff
    buffer_store_dwordx4 v[16:19], v12, s[16:19], 0 offen sc0 sc1
    s_mov_b64 exec, 0xffff
    s_lshl_b32 s64, s2, 10
    s_lshl_b32 s65, s6, 8
    s_add_u32 s64, s64, s65
    s_add_u32 s64, s64, 6447104
    buffer_store_dwordx4 v[16:19], v6, s[16:19], s64 offen sc0 sc1
    s_mov_b64 exec, -1
    s_waitcnt vmcnt(19)
    s_barrier
    v_mov_b32 v79, 0
    s_cmp_lg_u32 s6, 0
    s_cbranch_scc1 H_nc
    buffer_load_dword v78, v79, s[20:23], 0 offen sc1
H_nc:
    s_add_u32 s41, s74, 4
    s_and_b32 s41, s41, 15
    s_lshl_b32 s42, s41, 7
    s_mul_i32 s41, s41, 393216
    s_add_u32 m0, s7, 49152
    s_add_u32 s40, s42, 0
    buffer_load_dwordx4 v4, s[8:11], s40 offen lds
    s_add_u32 m0, s7, 53248
    s_add_u32 s40, s42, 65536
    buffer_load_dwordx4 v4, s[8:11], s40 offen lds
    s_add_u32 m0, s7, 57344
    s_add_u32 s40, s42, 131072
    buffer_load_dwordx4 v4, s[8:11], s40 offen lds
    s_add_u32 m0, s7, 61440
    s_add_u32 s40, s42, 196608
    buffer_load_dwordx4 v4, s[8:11], s40 offen lds
    s_add_u32 m0, s7, 65536
    s_add_u32 s40, s41, 0
    buffer_load_dwordx4 v5, s[12:15], s40 offen lds
    s_add_u32 m0, s7, 69632
    s_add_u32 s40, s41, 196608
    buffer_load_dwordx4 v5, s[12:15], s40 offen lds
    s_add_u32 m0, s7, 73728
    s_add_u32 s40, s41, 2048
    buffer_load_dwordx4 v5, s[12:15], s40 offen lds
    s_add_u32 m0, s7, 77824
    s_add_u32 s40, s41, 198656
    buffer_load_dwordx4 v5, s[12:15], s40 offen lds
    s_add_u32 m0, s7, 81920
    s_add_u32 s40, s41, 4096
    buffer_load_dwordx4 v5, s[12:15], s40 offen lds
    s_add_u32 m0, s7, 86016
    s_add_u32 s40, s41, 200704
    buffer_load_dwordx4 v5, s[12:15], s40 offen lds
    s_waitcnt vmcnt(14)
    s_barrier
    ds_read_b128 v[40:43], v6 offset:0
    ds_read_b128 v[44:47], v6 offset:1024
    ds_read_b128 v[48:51], v6 offset:2048
    ds_read_b128 v[52:55], v6 offset:3072
    s_add_u32 s41, s74, 5
    s_and_b32 s41, s41, 15
    s_lshl_b32 s42, s41, 7
    s_mul_i32 s41, s41, 393216
    s_add_u32 m0, s7, 90112
    s_add_u32 s40, s42, 0
    buffer_load_dwordx4 v4, s[8:11], s40 offen lds
    s_waitcnt lgkmcnt(0)
    s_add_u32 m0, s7, 94208
    s_add_u32 s40, s42, 65536
    buffer_load_dwordx4 v4, s[8:11], s40 offen lds
    v_dot2_f32_bf16 v72, v24, v48, 0
    v_dot2_f32_bf16 v73, v32, v48, 0
    v_dot2_f32_bf16 v74, v24, v40, 0
    v_dot2_f32_bf16 v75, v32, v40, 0
    s_add_u32 m0, s7, 98304
    s_add_u32 s40, s42, 131072
    buffer_load_dwordx4 v4, s[8:11], s40 offen lds
    v_dot2_f32_bf16 v72, v25, v49, v72
    v_dot2_f32_bf16 v73, v33, v49, v73
    v_dot2_f32_bf16 v74, v25, v41, v74
    v_dot2_f32_bf16 v75, v33, v41, v75
    s_add_u32 m0, s7, 102400
    s_add_u32 s40, s42, 196608
    buffer_load_dwordx4 v4, s[8:11], s40 offen lds
    v_dot2_f32_bf16 v72, v26, v50, v72
    v_dot2_f32_bf16 v73, v34, v50, v73
    v_dot2_f32_bf16 v74, v26, v42, v74
    v_dot2_f32_bf16 v75, v34, v42, v75
    s_add_u32 m0, s7, 106496
    s_add_u32 s40, s41, 0
    buffer_load_dwordx4 v5, s[12:15], s40 offen lds
    v_dot2_f32_bf16 v72, v27, v51, v72
    v_dot2_f32_bf16 v73, v35, v51, v73
    v_dot2_f32_bf16 v74, v27, v43, v74
    v_dot2_f32_bf16 v75, v35, v43, v75
    s_add_u32 m0, s7, 110592
    s_add_u32 s40, s41, 196608
    buffer_load_dwordx4 v5, s[12:15], s40 offen lds
    v_dot2_f32_bf16 v72, v28, v52, v72
    v_dot2_f32_bf16 v73, v36, v52, v73
    v_dot2_f32_bf16 v74, v28, v44, v74
    v_dot2_f32_bf16 v75, v36, v44, v75
    s_add_u32 m0, s7, 114688
    s_add_u32 s40, s41, 2048
    buffer_load_dwordx4 v5, s[12:15], s40 offen lds
    v_dot2_f32_bf16 v72, v29, v53, v72
    v_dot2_f32_bf16 v73, v37, v53, v73
    v_dot2_f32_bf16 v74, v29, v45, v74
    v_dot2_f32_bf16 v75, v37, v45, v75
    s_add_u32 m0, s7, 118784
    s_add_u32 s40, s41, 198656
    buffer_load_dwordx4 v5, s[12:15], s40 offen lds
    v_dot2_f32_bf16 v72, v30, v54, v72
    v_dot2_f32_bf16 v73, v38, v54, v73
    v_dot2_f32_bf16 v74, v30, v46, v74
    v_dot2_f32_bf16 v75, v38, v46, v75
    s_add_u32 m0, s7, 122880
    s_add_u32 s40, s41, 4096
    buffer_load_dwordx4 v5, s[12:15], s40 offen lds
    v_dot2_f32_bf16 v72, v31, v55, v72
    v_dot2_f32_bf16 v73, v39, v55, v73
    v_dot2_f32_bf16 v74, v31, v47, v74
    v_dot2_f32_bf16 v75, v39, v47, v75
    s_add_u32 m0, s7, 126976
    s_add_u32 s40, s41, 200704
    buffer_load_dwordx4 v5, s[12:15], s40 offen lds
    s_waitcnt vmcnt(10)
    s_barrier
    s_add_u32 s41, s74, 6
    s_and_b32 s41, s41, 15
    s_lshl_b32 s42, s41, 7
    s_mul_i32 s41, s41, 393216
    s_add_u32 m0, s7, 8192
    s_add_u32 s40, s42, 0
    buffer_load_dwordx4 v4, s[8:11], s40 offen lds
    v_permlane32_swap_b32 v72, v74
    v_permlane32_swap_b32 v73, v75
    v_add_f32 v72, v72, v74
    v_add_f32 v73, v73, v75
    s_add_u32 m0, s7, 12288
    s_add_u32 s40, s42, 65536
    buffer_load_dwordx4 v4, s[8:11], s40 offen lds
    s_lshl_b32 s64, s68, 2
    s_add_u32 s64, s64, 6709248
    v_permlane16_swap_b32 v72, v73
    v_add_f32 v72, v72, v73
    s_add_u32 m0, s7, 16384
    s_add_u32 s40, s42, 131072
    buffer_load_dwordx4 v4, s[8:11], s40 offen lds
    v_and_b32 v75, 1, v8
    v_lshl_add_u32 v76, v75, 2, s64
    v_add_f32_dpp v72, v72, v72 quad_perm:[1,0,3,2] row_mask:0xf bank_mask:0xf
    s_nop 1
    s_add_u32 m0, s7, 20480
    s_add_u32 s40, s42, 196608
    buffer_load_dwordx4 v4, s[8:11], s40 offen lds
    v_add_f32_dpp v72, v72, v72 quad_perm:[2,3,0,1] row_mask:0xf bank_mask:0xf
    s_nop 1
    v_add_f32_dpp v72, v72, v72 row_half_mirror row_mask:0xf bank_mask:0xf
    s_nop 1
    s_add_u32 m0, s7, 24576
    s_add_u32 s40, s41, 0
    buffer_load_dwordx4 v5, s[12:15], s40 offen lds
    v_add_f32_dpp v72, v72, v72 row_mirror row_mask:0xf bank_mask:0xf
    s_nop 1
    v_cvt_pk_bf16_f32 v72, v72, v72
    s_sub_u32 s64, 34815, s68
    s_add_u32 m0, s7, 28672
    s_add_u32 s40, s41, 196608
    buffer_load_dwordx4 v5, s[12:15], s40 offen lds
    v_lshlrev_b32 v72, 16, v72
    v_ashrrev_i32 v73, 31, v72
    v_sub_u32 v77, s64, v75
    v_or_b32 v73, 0x80000000, v73
    s_add_u32 m0, s7, 32768
    s_add_u32 s40, s41, 2048
    buffer_load_dwordx4 v5, s[12:15], s40 offen lds
    s_lshl_b32 s64, s6, 3
    v_xor_b32 v73, v72, v73
    v_lshl_add_u32 v75, v75, 2, s64
    v_and_b32 v73, 0xffff0000, v73
    s_add_u32 m0, s7, 36864
    s_add_u32 s40, s41, 198656
    buffer_load_dwordx4 v5, s[12:15], s40 offen lds
    v_or_b32 v73, v77, v73
    v_mul_f32 v72, s72, v72
    v_exp_f32 v72, -v72
    s_nop 0
    s_add_u32 m0, s7, 40960
    s_add_u32 s40, s41, 4096
    buffer_load_dwordx4 v5, s[12:15], s40 offen lds
    v_add_f32 v72, 1.0, v72
    v_rcp_f32 v72, v72
    s_nop 0
    v_cvt_pk_bf16_f32 v72, v72, v72
    s_add_u32 m0, s7, 45056
    s_add_u32 s40, s41, 200704
    buffer_load_dwordx4 v5, s[12:15], s40 offen lds
    v_lshlrev_b32 v72, 16, v72
    s_mov_b32 exec_lo, 0
    s_mov_b32 exec_hi, 0x10001
    ds_write_b32 v75, v73 offset:4224
    s_mov_b32 exec_lo, 0x10001
    s_mov_b32 exec_hi, 0
    buffer_store_dword v72, v76, s[16:19], 0 offen sc0 sc1
    s_mov_b64 exec, -1
    s_mov_b32 exec_lo, 0x3fff3fff
    s_mov_b32 exec_hi, 0x3fff3fff
    s_mov_b32 s64, 0
    buffer_load_dwordx4 v[96:99], v11, s[32:35], s64 offen nt
    s_mov_b32 s64, 0
    buffer_load_dwordx4 v[128:131], v11, s[36:39], s64 offen nt
    s_mov_b32 s64, 7168
    buffer_load_dwordx4 v[100:103], v11, s[32:35], s64 offen nt
    s_mov_b32 s64, 7168
    buffer_load_dwordx4 v[132:135], v11, s[36:39], s64 offen nt
    s_mov_b32 s64, 14336
    buffer_load_dwordx4 v[104:107], v11, s[32:35], s64 offen nt
    s_mov_b64 exec, -1
    s_waitcnt vmcnt(16)
    s_waitcnt lgkmcnt(0)
    s_barrier
    s_add_u32 s41, s74, 7
    s_and_b32 s41, s41, 15
    s_lshl_b32 s42, s41, 7
    s_mul_i32 s41, s41, 393216
    s_add_u32 m0, s7, 49152
    s_add_u32 s40, s42, 0
    buffer_load_dwordx4 v4, s[8:11], s40 offen lds
    s_add_u32 m0, s7, 53248
    s_add_u32 s40, s42, 65536
    buffer_load_dwordx4 v4, s[8:11], s40 offen lds
    s_add_u32 m0, s7, 57344
    s_add_u32 s40, s42, 131072
    buffer_load_dwordx4 v4, s[8:11], s40 offen lds
    s_add_u32 m0, s7, 61440
    s_add_u32 s40, s42, 196608
    buffer_load_dwordx4 v4, s[8:11], s40 offen lds
    s_add_u32 m0, s7, 65536
    s_add_u32 s40, s41, 0
    buffer_load_dwordx4 v5, s[12:15], s40 offen lds
    s_add_u32 m0, s7, 69632
    s_add_u32 s40, s41, 196608
    buffer_load_dwordx4 v5, s[12:15], s40 offen lds
    s_add_u32 m0, s7, 73728
    s_add_u32 s40, s41, 2048
    buffer_load_dwordx4 v5, s[12:15], s40 offen lds
    s_add_u32 m0, s7, 77824
    s_add_u32 s40, s41, 198656
    buffer_load_dwordx4 v5, s[12:15], s40 offen lds
    s_add_u32 m0, s7, 81920
    s_add_u32 s40, s41, 4096
    buffer_load_dwordx4 v5, s[12:15], s40 offen lds
    s_add_u32 m0, s7, 86016
    s_add_u32 s40, s41, 200704
    buffer_load_dwordx4 v5, s[12:15], s40 offen lds
    s_waitcnt vmcnt(16)
    s_barrier
    s_add_u32 s41, s74, 8
    s_and_b32 s41, s41, 15
    s_lshl_b32 s42, s41, 7
    s_mul_i32 s41, s41, 393216
    s_add_u32 m0, s7, 90112
    s_add_u32 s40, s42, 0
    buffer_load_dwordx4 v4, s[8:11], s40 offen lds
    s_add_u32 m0, s7, 94208
    s_add_u32 s40, s42, 65536
    buffer_load_dwordx4 v4, s[8:11], s40 offen lds
    s_add_u32 m0, s7, 98304
    s_add_u32 s40, s42, 131072
    buffer_load_dwordx4 v4, s[8:11], s40 offen lds
    s_add_u32 m0, s7, 102400
    s_add_u32 s40, s42, 196608
    buffer_load_dwordx4 v4, s[8:11], s40 offen lds
    s_add_u32 m0, s7, 106496
    s_add_u32 s40, s41, 0
    buffer_load_dwordx4 v5, s[12:15], s40 offen lds
    s_add_u32 m0, s7, 110592
    s_add_u32 s40, s41, 196608
    buffer_load_dwordx4 v5, s[12:15], s40 offen lds
    s_add_u32 m0, s7, 114688
    s_add_u32 s40, s41, 2048
    buffer_load_dwordx4 v5, s[12:15], s40 offen lds
    s_add_u32 m0, s7, 118784
    s_add_u32 s40, s41, 198656
    buffer_load_dwordx4 v5, s[12:15], s40 offen lds
    s_add_u32 m0, s7, 122880
    s_add_u32 s40, s41, 4096
    buffer_load_dwordx4 v5, s[12:15], s40 offen lds
    s_add_u32 m0, s7, 126976
    s_add_u32 s40, s41, 200704
    buffer_load_dwordx4 v5, s[12:15], s40 offen lds
    s_waitcnt vmcnt(10)
    s_barrier
    s_add_u32 s41, s74, 9
    s_and_b32 s41, s41, 15
    s_lshl_b32 s42, s41, 7
    s_mul_i32 s41, s41, 393216
    s_add_u32 m0, s7, 8192
    s_add_u32 s40, s42, 0
    buffer_load_dwordx4 v4, s[8:11], s40 offen lds
    s_add_u32 m0, s7, 12288
    s_add_u32 s40, s42, 65536
    buffer_load_dwordx4 v4, s[8:11], s40 offen lds
    s_add_u32 m0, s7, 16384
    s_add_u32 s40, s42, 131072
    buffer_load_dwordx4 v4, s[8:11], s40 offen lds
    s_add_u32 m0, s7, 20480
    s_add_u32 s40, s42, 196608
    buffer_load_dwordx4 v4, s[8:11], s40 offen lds
    s_add_u32 m0, s7, 24576
    s_add_u32 s40, s41, 0
    buffer_load_dwordx4 v5, s[12:15], s40 offen lds
    s_add_u32 m0, s7, 28672
    s_add_u32 s40, s41, 196608
    buffer_load_dwordx4 v5, s[12:15], s40 offen lds
    s_add_u32 m0, s7, 32768
    s_add_u32 s40, s41, 2048
    buffer_load_dwordx4 v5, s[12:15], s40 offen lds
    s_add_u32 m0, s7, 36864
    s_add_u32 s40, s41, 198656
    buffer_load_dwordx4 v5, s[12:15], s40 offen lds
    s_add_u32 m0, s7, 40960
    s_add_u32 s40, s41, 4096
    buffer_load_dwordx4 v5, s[12:15], s40 offen lds
    s_add_u32 m0, s7, 45056
    s_add_u32 s40, s41, 200704
    buffer_load_dwordx4 v5, s[12:15], s40 offen lds
    s_cmp_lg_u32 s6, 0
    s_cbranch_scc1 H_nk
    v_mov_b32 v3, 4224
    ds_read_b128 v[72:75], v3
    ds_read_b128 v[24:27], v3 offset:16
    s_mov_b32 s65, 0
H_nspin:
    v_readfirstlane_b32 s71, v78
    s_cmp_eq_u32 s71, 0
    s_cbranch_scc1 H_nre
H_nok:
    s_lshl_b32 s64, s2, 3
    s_add_u32 s64, s64, 6717440
    v_mov_b32 v3, s64
    s_waitcnt lgkmcnt(0)
    v_max3_u32 v72, v72, v73, v74
    v_max3_u32 v24, v24, v25, v26
    v_max3_u32 v72, v72, v75, v27
    v_max_u32 v72, v72, v24
    v_xor_b32 v73, s71, v72
    s_mov_b64 exec, 1
    buffer_store_dwordx2 v[72:73], v3, s[16:19], 0 offen sc0 sc1
    s_mov_b64 exec, -1
H_nk:
    s_mov_b32 exec_lo, 0x3fff3fff
    s_mov_b32 exec_hi, 0x3fff3fff
    s_mov_b32 s64, 14336
    buffer_load_dwordx4 v[136:139], v11, s[36:39], s64 offen nt
    s_mov_b32 s64, 21504
    buffer_load_dwordx4 v[108:111], v11, s[32:35], s64 offen nt
    s_mov_b32 s64, 21504
    buffer_load_dwordx4 v[140:143], v11, s[36:39], s64 offen nt
    s_mov_b32 s64, 28672
    buffer_load_dwordx4 v[112:115], v11, s[32:35], s64 offen nt
    s_mov_b32 s64, 28672
    buffer_load_dwordx4 v[144:147], v11, s[36:39], s64 offen nt
    s_mov_b64 exec, -1
    s_waitcnt vmcnt(15)
    s_barrier
    s_add_u32 s41, s74, 10
    s_and_b32 s41, s41, 15
    s_lshl_b32 s42, s41, 7
    s_mul_i32 s41, s41, 393216
    s_add_u32 m0, s7, 49152
    s_add_u32 s40, s42, 0
    buffer_load_dwordx4 v4, s[8:11], s40 offen lds
    s_add_u32 m0, s7, 53248
    s_add_u32 s40, s42, 65536
    buffer_load_dwordx4 v4, s[8:11], s40 offen lds
    s_add_u32 m0, s7, 57344
    s_add_u32 s40, s42, 131072
    buffer_load_dwordx4 v4, s[8:11], s40 offen lds
    s_add_u32 m0, s7, 61440
    s_add_u32 s40, s42, 196608
    buffer_load_dwordx4 v4, s[8:11], s40 offen lds
    s_add_u32 m0, s7, 65536
    s_add_u32 s40, s41, 0
    buffer_load_dwordx4 v5, s[12:15], s40 offen lds
    s_add_u32 m0, s7, 69632
    s_add_u32 s40, s41, 196608
    buffer_load_dwordx4 v5, s[12:15], s40 offen lds
    s_add_u32 m0, s7, 73728
    s_add_u32 s40, s41, 2048
    buffer_load_dwordx4 v5, s[12:15], s40 offen lds
    s_add_u32 m0, s7, 77824
    s_add_u32 s40, s41, 198656
    buffer_load_dwordx4 v5, s[12:15], s40 offen lds
    s_add_u32 m0, s7, 81920
    s_add_u32 s40, s41, 4096
    buffer_load_dwordx4 v5, s[12:15], s40 offen lds
    s_add_u32 m0, s7, 86016
    s_add_u32 s40, s41, 200704
    buffer_load_dwordx4 v5, s[12:15], s40 offen lds
    s_lshl_b32 s64, s2, 2
    s_add_u32 s64, s64, s6
    s_mul_i32 s64, s64, 2048
    s_add_u32 s46, s44, s64
    s_addc_u32 s47, s45, 0
    s_load_dword s43, s[46:47], 384
    s_load_dword s43, s[46:47], 448
    s_load_dword s43, s[46:47], 1408
    s_load_dword s43, s[46:47], 1472
    s_waitcnt vmcnt(15)
    s_barrier
    s_add_u32 s41, s74, 11
    s_and_b32 s41, s41, 15
    s_lshl_b32 s42, s41, 7
    s_mul_i32 s41, s41, 393216
    s_add_u32 m0, s7, 90112
    s_add_u32 s40, s42, 0
    buffer_load_dwordx4 v4, s[8:11], s40 offen lds
    s_add_u32 m0, s7, 94208
    s_add_u32 s40, s42, 65536
    buffer_load_dwordx4 v4, s[8:11], s40 offen lds
    s_add_u32 m0, s7, 98304
    s_add_u32 s40, s42, 131072
    buffer_load_dwordx4 v4, s[8:11], s40 offen lds
    s_add_u32 m0, s7, 102400
    s_add_u32 s40, s42, 196608
    buffer_load_dwordx4 v4, s[8:11], s40 offen lds
    s_add_u32 m0, s7, 106496
    s_add_u32 s40, s41, 0
    buffer_load_dwordx4 v5, s[12:15], s40 offen lds
    s_add_u32 m0, s7, 110592
    s_add_u32 s40, s41, 196608
    buffer_load_dwordx4 v5, s[12:15], s40 offen lds
    s_add_u32 m0, s7, 114688
    s_add_u32 s40, s41, 2048
    buffer_load_dwordx4 v5, s[12:15], s40 offen lds
    s_add_u32 m0, s7, 118784
    s_add_u32 s40, s41, 198656
    buffer_load_dwordx4 v5, s[12:15], s40 offen lds
    s_add_u32 m0, s7, 122880
    s_add_u32 s40, s41, 4096
    buffer_load_dwordx4 v5, s[12:15], s40 offen lds
    s_add_u32 m0, s7, 126976
    s_add_u32 s40, s41, 200704
    buffer_load_dwordx4 v5, s[12:15], s40 offen lds
    s_waitcnt vmcnt(10)
    s_barrier
    s_add_u32 s41, s74, 12
    s_and_b32 s41, s41, 15
    s_lshl_b32 s42, s41, 7
    s_mul_i32 s41, s41, 393216
    s_add_u32 m0, s7, 8192
    s_add_u32 s40, s42, 0
    buffer_load_dwordx4 v4, s[8:11], s40 offen lds
    s_add_u32 m0, s7, 12288
    s_add_u32 s40, s42, 65536
    buffer_load_dwordx4 v4, s[8:11], s40 offen lds
    s_add_u32 m0, s7, 16384
    s_add_u32 s40, s42, 131072
    buffer_load_dwordx4 v4, s[8:11], s40 offen lds
    s_add_u32 m0, s7, 20480
    s_add_u32 s40, s42, 196608
    buffer_load_dwordx4 v4, s[8:11], s40 offen lds
    s_add_u32 m0, s7, 24576
    s_add_u32 s40, s41, 0
    buffer_load_dwordx4 v5, s[12:15], s40 offen lds
    s_add_u32 m0, s7, 28672
    s_add_u32 s40, s41, 196608
    buffer_load_dwordx4 v5, s[12:15], s40 offen lds
    s_add_u32 m0, s7, 32768
    s_add_u32 s40, s41, 2048
    buffer_load_dwordx4 v5, s[12:15], s40 offen lds
    s_add_u32 m0, s7, 36864
    s_add_u32 s40, s41, 198656
    buffer_load_dwordx4 v5, s[12:15], s40 offen lds
    s_add_u32 m0, s7, 40960
    s_add_u32 s40, s41, 4096
    buffer_load_dwordx4 v5, s[12:15], s40 offen lds
    s_add_u32 m0, s7, 45056
    s_add_u32 s40, s41, 200704
    buffer_load_dwordx4 v5, s[12:15], s40 offen lds
    s_mov_b32 exec_lo, 0x3fff3fff
    s_mov_b32 exec_hi, 0x3fff3fff
    s_mov_b32 s64, 35840
    buffer_load_dwordx4 v[116:119], v11, s[32:35], s64 offen nt
    s_mov_b32 s64, 35840
    buffer_load_dwordx4 v[148:151], v11, s[36:39], s64 offen nt
    s_mov_b32 s64, 43008
    buffer_load_dwordx4 v[120:123], v11, s[32:35], s64 offen nt
    s_mov_b32 s64, 43008
    buffer_load_dwordx4 v[152:155], v11, s[36:39], s64 offen nt
    s_mov_b32 s64, 50176
    buffer_load_dwordx4 v[124:127], v11, s[32:35], s64 offen nt
    s_mov_b32 s64, 50176
    buffer_load_dwordx4 v[156:159], v11, s[36:39], s64 offen nt
    s_mov_b64 exec, -1
    s_waitcnt vmcnt(16)
    s_barrier
    s_cmp_lg_u32 s6, 0
    s_cbranch_scc1 H_np
    s_mov_b32 s64, 6717440
    buffer_load_dwordx4 v[24:27], v6, s[16:19], s64 offen offset:0 sc1
    buffer_load_dwordx4 v[28:31], v6, s[16:19], s64 offen offset:1024 sc1
H_np:
    s_add_u32 s41, s74, 13
    s_and_b32 s41, s41, 15
    s_lshl_b32 s42, s41, 7
    s_mul_i32 s41, s41, 393216
    s_add_u32 m0, s7, 49152
    s_add_u32 s40, s42, 0
    buffer_load_dwordx4 v4, s[8:11], s40 offen lds
    s_add_u32 m0, s7, 53248
    s_add_u32 s40, s42, 65536
    buffer_load_dwordx4 v4, s[8:11], s40 offen lds
    s_add_u32 m0, s7, 57344
    s_add_u32 s40, s42, 131072
    buffer_load_dwordx4 v4, s[8:11], s40 offen lds
    s_add_u32 m0, s7, 61440
    s_add_u32 s40, s42, 196608
    buffer_load_dwordx4 v4, s[8:11], s40 offen lds
    s_add_u32 m0, s7, 65536
    s_add_u32 s40, s41, 0
    buffer_load_dwordx4 v5, s[12:15], s40 offen lds
    s_add_u32 m0, s7, 69632
    s_add_u32 s40, s41, 196608
    buffer_load_dwordx4 v5, s[12:15], s40 offen lds
    s_add_u32 m0, s7, 73728
    s_add_u32 s40, s41, 2048
    buffer_load_dwordx4 v5, s[12:15], s40 offen lds
    s_add_u32 m0, s7, 77824
    s_add_u32 s40, s41, 198656
    buffer_load_dwordx4 v5, s[12:15], s40 offen lds
    s_add_u32 m0, s7, 81920
    s_add_u32 s40, s41, 4096
    buffer_load_dwordx4 v5, s[12:15], s40 offen lds
    s_add_u32 m0, s7, 86016
    s_add_u32 s40, s41, 200704
    buffer_load_dwordx4 v5, s[12:15], s40 offen lds
    s_waitcnt vmcnt(16)
    s_barrier
    s_cmp_lg_u32 s6, 0
    s_cbranch_scc1 H_nq
    s_waitcnt vmcnt(10)
    s_mov_b32 s65, 0
H_spin:
    v_xor_b32 v25, v24, v25
    v_xor_b32 v27, v26, v27
    v_xor_b32 v29, v28, v29
    v_xor_b32 v31, v30, v31
    v_xor_b32 v3, s71, v25
    v_xor_b32 v7, s71, v27
    v_xor_b32 v25, s71, v29
    v_xor_b32 v27, s71, v31
    v_or3_b32 v3, v3, v7, v25
    v_or_b32 v3, v3, v27
    v_cmp_ne_u32 vcc, 0, v3
    s_cbranch_vccnz H_retry
H_nq:
    s_add_u32 s41, s74, 14
    s_and_b32 s41, s41, 15
    s_lshl_b32 s42, s41, 7
    s_mul_i32 s41, s41, 393216
    s_add_u32 m0, s7, 90112
    s_add_u32 s40, s42, 0
    buffer_load_dwordx4 v4, s[8:11], s40 offen lds
    v_max_u32 v3, v24, v26
    v_max3_u32 v3, v3, v28, v30
    s_nop 1
    v_max_u32_dpp v3, v3, v3 quad_perm:[1,0,3,2] row_mask:0xf bank_mask:0xf
    s_add_u32 m0, s7, 94208
    s_add_u32 s40, s42, 65536
    buffer_load_dwordx4 v4, s[8:11], s40 offen lds
    s_nop 1
    v_max_u32_dpp v3, v3, v3 quad_perm:[2,3,0,1] row_mask:0xf bank_mask:0xf
    s_nop 1
    v_max_u32_dpp v3, v3, v3 row_half_mirror row_mask:0xf bank_mask:0xf
    s_add_u32 m0, s7, 98304
    s_add_u32 s40, s42, 131072
    buffer_load_dwordx4 v4, s[8:11], s40 offen lds
    s_nop 1
    v_max_u32_dpp v3, v3, v3 row_mirror row_mask:0xf bank_mask:0xf
    s_nop 1
    v_mov_b32 v7, v3
    s_add_u32 m0, s7, 102400
    s_add_u32 s40, s42, 196608
    buffer_load_dwordx4 v4, s[8:11], s40 offen lds
    s_nop 1
    v_permlane16_swap_b32 v3, v7
    v_max_u32 v3, v3, v7
    v_mov_b32 v7, v3
    s_add_u32 m0, s7, 106496
    s_add_u32 s40, s41, 0
    buffer_load_dwordx4 v5, s[12:15], s40 offen lds
    s_nop 1
    v_permlane32_swap_b32 v3, v7
    v_max_u32 v3, v3, v7
    v_mov_b32 v7, 4256
    s_add_u32 m0, s7, 110592
    s_add_u32 s40, s41, 196608
    buffer_load_dwordx4 v5, s[12:15], s40 offen lds
    s_add_u32 m0, s7, 114688
    s_add_u32 s40, s41, 2048
    buffer_load_dwordx4 v5, s[12:15], s40 offen lds
    s_add_u32 m0, s7, 118784
    s_add_u32 s40, s41, 198656
    buffer_load_dwordx4 v5, s[12:15], s40 offen lds
    s_add_u32 m0, s7, 122880
    s_add_u32 s40, s41, 4096
    buffer_load_dwordx4 v5, s[12:15], s40 offen lds
    s_add_u32 m0, s7, 126976
    s_add_u32 s40, s41, 200704
    buffer_load_dwordx4 v5, s[12:15], s40 offen lds
    s_cmp_lg_u32 s6, 0
    s_cbranch_scc1 H_nw
    ds_write_b32 v7, v3
H_nw:
    s_waitcnt vmcnt(10)
    s_waitcnt lgkmcnt(0)
    s_barrier
    v_mov_b32 v7, 4256
    ds_read_b32 v3, v7
    s_lshl_b32 s65, s69, 6
    v_lshl_add_u32 v7, v8, 4, s65
    s_waitcnt lgkmcnt(0)
    v_readfirstlane_b32 s75, v3
    s_nop 3
    s_and_b32 s64, s75, 0x7ff
    s_sub_u32 s64, 2047, s64
    s_lshl_b32 s64, s64, 11
    buffer_load_dwordx4 v[88:91], v7, s[8:11], s64 offen
    s_add_u32 s41, s74, 15
    s_and_b32 s41, s41, 15
    s_lshl_b32 s42, s41, 7
    s_mul_i32 s41, s41, 393216
    s_add_u32 m0, s7, 8192
    s_add_u32 s40, s42, 0
    buffer_load_dwordx4 v4, s[8:11], s40 offen lds
    s_add_u32 m0, s7, 12288
    s_add_u32 s40, s42, 65536
    buffer_load_dwordx4 v4, s[8:11], s40 offen lds
    s_add_u32 m0, s7, 16384
    s_add_u32 s40, s42, 131072
    buffer_load_dwordx4 v4, s[8:11], s40 offen lds
    s_add_u32 m0, s7, 20480
    s_add_u32 s40, s42, 196608
    buffer_load_dwordx4 v4, s[8:11], s40 offen lds
    s_add_u32 m0, s7, 24576
    s_add_u32 s40, s41, 0
    buffer_load_dwordx4 v5, s[12:15], s40 offen lds
    s_add_u32 m0, s7, 28672
    s_add_u32 s40, s41, 196608
    buffer_load_dwordx4 v5, s[12:15], s40 offen lds
    s_add_u32 m0, s7, 32768
    s_add_u32 s40, s41, 2048
    buffer_load_dwordx4 v5, s[12:15], s40 offen lds
    s_add_u32 m0, s7, 36864
    s_add_u32 s40, s41, 198656
    buffer_load_dwordx4 v5, s[12:15], s40 offen lds
    s_add_u32 m0, s7, 40960
    s_add_u32 s40, s41, 4096
    buffer_load_dwordx4 v5, s[12:15], s40 offen lds
    s_add_u32 m0, s7, 45056
    s_add_u32 s40, s41, 200704
    buffer_load_dwordx4 v5, s[12:15], s40 offen lds
    s_mov_b32 s24, s54
    s_mov_b32 s25, s55
    s_mov_b32 s26, 0x700000
    s_mov_b32 s27, 0x00020000
    s_lshr_b32 s64, s2, 2
    s_mul_i32 s64, s64, 114688
    s_and_b32 s65, s2, 3
    s_lshl_b32 s65, s65, 9
    s_add_u32 s64, s64, s65
    s_lshl_b32 s65, s6, 7
    s_add_u32 s64, s64, s65
    v_lshrrev_b32 v7, 3, v2
    v_lshlrev_b32 v7, 11, v7
    v_and_b32 v9, 7, v2
    v_lshl_add_u32 v7, v9, 4, v7
    v_add_u32 v21, s64, v7
    s_mov_b32 s64, 0
    buffer_load_dwordx4 v[192:195], v21, s[24:27], s64 offen nt
    s_mov_b32 s64, 16384
    buffer_load_dwordx4 v[196:199], v21, s[24:27], s64 offen nt
    s_mov_b32 s64, 32768
    buffer_load_dwordx4 v[200:203], v21, s[24:27], s64 offen nt
    s_mov_b32 s64, 49152
    buffer_load_dwordx4 v[204:207], v21, s[24:27], s64 offen nt
    s_mov_b32 s64, 65536
    buffer_load_dwordx4 v[208:211], v21, s[24:27], s64 offen nt
    s_mov_b32 s64, 81920
    buffer_load_dwordx4 v[212:215], v21, s[24:27], s64 offen nt
    s_mov_b32 s64, 98304
    buffer_load_dwordx4 v[216:219], v21, s[24:27], s64 offen nt
    s_waitcnt vmcnt(18)
    s_barrier
    s_waitcnt vmcnt(17)
    s_and_b32 s64, s2, 7
    s_lshr_b32 s65, s2, 3
    s_and_b32 s4, s64, 3
    s_lshl_b32 s4, s4, 2
    s_and_b32 s66, s65, 3
    s_add_u32 s4, s4, s66
    s_lshr_b32 s5, s64, 2
    s_lshl_b32 s5, s5, 3
    s_lshr_b32 s66, s65, 2
    s_add_u32 s5, s5, s66
    s_mov_b32 s28, s44
    s_mov_b32 s29, s45
    s_mov_b32 s30, 0x200000
    s_mov_b32 s31, 0x00020000
    v_lshrrev_b32 v7, 3, v2
    s_lshl_b32 s64, s6, 3
    v_add_u32 v7, s64, v7
    v_lshlrev_b32 v7, 11, v7
    v_lshrrev_b32 v9, 4, v2
    v_lshlrev_b32 v9, 1, v9
    v_and_b32 v10, 7, v2
    v_xor_b32 v9, v9, v10
    v_lshl_add_u32 v7, v9, 4, v7
    s_lshl_b32 s64, s5, 7
    v_add_u32 v10, s64, v7
    s_add_u32 m0, s7, 131072
    s_mov_b32 s40, 0
    buffer_load_dwordx4 v10, s[28:31], s40 offen lds
    v_and_b32 v48, 15, v2
    v_and_b32 v49, 1, v2
    v_lshlrev_b32 v49, 4, v49
    v_mov_b32 v50, 0xffff
    v_lshlrev_b32 v49, v49, v50
    v_lshrrev_b32 v48, 1, v48
    v_cmp_eq_u32 vcc, 0, v48
    s_nop 1
    v_cndmask_b32 v40, 0, v49, vcc
    v_cmp_eq_u32 vcc, 1, v48
    s_nop 1
    v_cndmask_b32 v41, 0, v49, vcc
    v_cmp_eq_u32 vcc, 2, v48
    s_nop 1
    v_cndmask_b32 v42, 0, v49, vcc
    v_cmp_eq_u32 vcc, 3, v48
    s_nop 1
    v_cndmask_b32 v43, 0, v49, vcc
    s_mov_b32 s64, 0x01000100
    s_mov_b32 s65, 0x03020302
    v_perm_b32 v48, v88, v88, s64
    v_and_b32 v44, v48, v40
    v_and_b32 v45, v48, v41
    v_and_b32 v46, v48, v42
    s_add_u32 m0, s7, 135168
    s_mov_b32 s40, 65536
    buffer_load_dwordx4 v10, s[28:31], s40 offen lds
    v_and_b32 v47, v48, v43
    s_nop 1
    v_mfma_f32_16x16x32_bf16 v[32:35], v[44:47], v[96:99], 0
    v_mfma_f32_16x16x32_bf16 v[36:39], v[44:47], v[128:131], 0
    v_perm_b32 v48, v88, v88, s65
    v_and_b32 v52, v48, v40
    v_and_b32 v53, v48, v41
    v_and_b32 v54, v48, v42
    v_and_b32 v55, v48, v43
    s_nop 1
    v_mfma_f32_16x16x32_bf16 v[32:35], v[52:55], v[100:103], v[32:35]
    v_mfma_f32_16x16x32_bf16 v[36:39], v[52:55], v[132:135], v[36:39]
    v_perm_b32 v48, v89, v89, s64
    v_and_b32 v44, v48, v40
    v_and_b32 v45, v48, v41
    v_and_b32 v46, v48, v42
    v_and_b32 v47, v48, v43
    s_nop 1
    v_mfma_f32_16x16x32_bf16 v[32:35], v[44:47], v[104:107], v[32:35]
    v_mfma_f32_16x16x32_bf16 v[36:39], v[44:47], v[136:139], v[36:39]
    v_perm_b32 v48, v89, v89, s65
    v_and_b32 v52, v48, v40
    v_and_b32 v53, v48, v41
    v_and_b32 v54, v48, v42
    s_add_u32 m0, s7, 147456
    s_mov_b32 s40, 1048576
    buffer_load_dwordx4 v10, s[28:31], s40 offen lds
    v_and_b32 v55, v48, v43
    s_nop 1
    v_mfma_f32_16x16x32_bf16 v[32:35], v[52:55], v[108:111], v[32:35]
    v_mfma_f32_16x16x32_bf16 v[36:39], v[52:55], v[140:143], v[36:39]
    v_perm_b32 v48, v90, v90, s64
    v_and_b32 v44, v48, v40
    v_and_b32 v45, v48, v41
    v_and_b32 v46, v48, v42
    v_and_b32 v47, v48, v43
    s_nop 1
    v_mfma_f32_16x16x32_bf16 v[32:35], v[44:47], v[112:115], v[32:35]
    v_mfma_f32_16x16x32_bf16 v[36:39], v[44:47], v[144:147], v[36:39]
    v_perm_b32 v48, v90, v90, s65
    v_and_b32 v52, v48, v40
    v_and_b32 v53, v48, v41
    v_and_b32 v54, v48, v42
    v_and_b32 v55, v48, v43
    s_nop 1
    v_mfma_f32_16x16x32_bf16 v[32:35], v[52:55], v[116:119], v[32:35]
    v_mfma_f32_16x16x32_bf16 v[36:39], v[52:55], v[148:151], v[36:39]
    v_perm_b32 v48, v91, v91, s64
    v_and_b32 v44, v48, v40
    v_and_b32 v45, v48, v41
    v_and_b32 v46, v48, v42
    s_add_u32 m0, s7, 151552
    s_mov_b32 s40, 1114112
    buffer_load_dwordx4 v10, s[28:31], s40 offen lds
    v_and_b32 v47, v48, v43
    s_nop 1
    v_mfma_f32_16x16x32_bf16 v[32:35], v[44:47], v[120:123], v[32:35]
    v_mfma_f32_16x16x32_bf16 v[36:39], v[44:47], v[152:155], v[36:39]
    v_perm_b32 v48, v91, v91, s65
    v_and_b32 v52, v48, v40
    v_and_b32 v53, v48, v41
    v_and_b32 v54, v48, v42
    v_and_b32 v55, v48, v43
    s_nop 1
    v_mfma_f32_16x16x32_bf16 v[32:35], v[52:55], v[124:127], v[32:35]
    v_mfma_f32_16x16x32_bf16 v[36:39], v[52:55], v[156:159], v[36:39]
    s_nop 7
    v_permlane32_swap_b32 v32, v36
    v_permlane32_swap_b32 v33, v37
    v_permlane32_swap_b32 v34, v38
    v_permlane32_swap_b32 v35, v39
    s_mov_b32 exec_lo, 0x3fff3fff
    s_mov_b32 exec_hi, 0x3fff3fff
    buffer_store_dwordx4 v[32:35], v12, s[16:19], 0 offen sc0 sc1
    s_mov_b64 exec, -1
    s_waitcnt vmcnt(12)
    s_barrier
    s_add_u32 m0, s7, 139264
    s_mov_b32 s40, 131072
    buffer_load_dwordx4 v10, s[28:31], s40 offen lds
    s_add_u32 m0, s7, 143360
    s_mov_b32 s40, 196608
    buffer_load_dwordx4 v10, s[28:31], s40 offen lds
    s_add_u32 m0, s7, 155648
    s_mov_b32 s40, 1179648
    buffer_load_dwordx4 v10, s[28:31], s40 offen lds
    s_add_u32 m0, s7, 159744
    s_mov_b32 s40, 1245184
    buffer_load_dwordx4 v10, s[28:31], s40 offen lds
    s_add_u32 m0, s7, 73728
    s_mov_b32 s40, 262144
    buffer_load_dwordx4 v10, s[28:31], s40 offen lds
    s_add_u32 m0, s7, 77824
    s_mov_b32 s40, 327680
    buffer_load_dwordx4 v10, s[28:31], s40 offen lds
    s_add_u32 m0, s7, 81920
    s_mov_b32 s40, 1310720
    buffer_load_dwordx4 v10, s[28:31], s40 offen lds
    s_add_u32 m0, s7, 86016
    s_mov_b32 s40, 1376256
    buffer_load_dwordx4 v10, s[28:31], s40 offen lds
    s_barrier
    s_and_b32 s64, s3, 3
    s_lshl_b32 s64, s64, 1
    s_lshr_b32 s65, s3, 2
    s_add_u32 s64, s64, s65
    s_lshl_b32 s64, s64, 4
    s_lshl_b32 s65, s4, 7
    s_add_u32 s64, s64, s65
    v_and_b32 v230, 15, v2
    v_add_u32 v230, s64, v230
    v_bfe_u32 v3, v2, 4, 1
    v_lshlrev_b32 v229, 5, v3
    v_lshrrev_b32 v3, 5, v2
    v_lshl_add_u32 v229, v3, 4, v229
    v_lshl_add_u32 v231, v230, 11, v229
    s_lshl_b32 s64, s5, 7
    v_add_u32 v231, s64, v231
    v_lshlrev_b32 v3, 2, v230
    v_add_u32 v3, 6709248, v3
    buffer_load_dwordx4 v[220:223], v231, s[8:11], 0 offen
    buffer_load_dwordx4 v[224:227], v231, s[8:11], 0 offen offset:64
    buffer_load_dword v228, v3, s[16:19], 0 offen sc1
    s_add_u32 m0, s7, 114688
    s_mov_b32 s40, 393216
    buffer_load_dwordx4 v10, s[28:31], s40 offen lds
    s_add_u32 m0, s7, 118784
    s_mov_b32 s40, 458752
    buffer_load_dwordx4 v10, s[28:31], s40 offen lds
    s_add_u32 m0, s7, 122880
    s_mov_b32 s40, 1441792
    buffer_load_dwordx4 v10, s[28:31], s40 offen lds
    s_add_u32 m0, s7, 126976
    s_mov_b32 s40, 1507328
    buffer_load_dwordx4 v10, s[28:31], s40 offen lds
    s_add_u32 m0, s7, 40960
    s_mov_b32 s40, 524288
    buffer_load_dwordx4 v10, s[28:31], s40 offen lds
    s_add_u32 m0, s7, 45056
    s_mov_b32 s40, 589824
    buffer_load_dwordx4 v10, s[28:31], s40 offen lds
    s_add_u32 m0, s7, 49152
    s_mov_b32 s40, 1572864
    buffer_load_dwordx4 v10, s[28:31], s40 offen lds
    s_add_u32 m0, s7, 53248
    s_mov_b32 s40, 1638400
    buffer_load_dwordx4 v10, s[28:31], s40 offen lds
    s_add_u32 m0, s7, 8192
    s_mov_b32 s40, 655360
    buffer_load_dwordx4 v10, s[28:31], s40 offen lds
    s_add_u32 m0, s7, 12288
    s_mov_b32 s40, 720896
    buffer_load_dwordx4 v10, s[28:31], s40 offen lds
    s_add_u32 m0, s7, 57344
    s_mov_b32 s40, 1703936
    buffer_load_dwordx4 v10, s[28:31], s40 offen lds
    s_add_u32 m0, s7, 61440
    s_mov_b32 s40, 1769472
    buffer_load_dwordx4 v10, s[28:31], s40 offen lds
    s_add_u32 m0, s7, 16384
    s_mov_b32 s40, 786432
    buffer_load_dwordx4 v10, s[28:31], s40 offen lds
    s_add_u32 m0, s7, 20480
    s_mov_b32 s40, 851968
    buffer_load_dwordx4 v10, s[28:31], s40 offen lds
    s_add_u32 m0, s7, 65536
    s_mov_b32 s40, 1835008
    buffer_load_dwordx4 v10, s[28:31], s40 offen lds
    s_add_u32 m0, s7, 69632
    s_mov_b32 s40, 1900544
    buffer_load_dwordx4 v10, s[28:31], s40 offen lds
    s_add_u32 m0, s7, 98304
    s_mov_b32 s40, 917504
    buffer_load_dwordx4 v10, s[28:31], s40 offen lds
    s_add_u32 m0, s7, 102400
    s_mov_b32 s40, 983040
    buffer_load_dwordx4 v10, s[28:31], s40 offen lds
    s_add_u32 m0, s7, 90112
    s_mov_b32 s40, 1966080
    buffer_load_dwordx4 v10, s[28:31], s40 offen lds
    s_add_u32 m0, s7, 94208
    s_mov_b32 s40, 2031616
    buffer_load_dwordx4 v10, s[28:31], s40 offen lds
    s_mov_b64 exec, 1
    v_mov_b32 v20, 0
    buffer_atomic_or v20, v23, s[16:19], 0 offen sc0
    s_mov_b64 exec, -1
    v_lshlrev_b32 v17, 4, v2
    v_add_u32 v17, s70, v17
    v_lshrrev_b32 v18, 2, v2
    v_mul_u32_u24 v18, 1152, v18
    v_and_b32 v19, 3, v2
    v_lshl_add_u32 v18, v19, 4, v18
    s_add_u32 s64, s70, 1024
    v_add_u32 v18, s64, v18
    v_bfe_u32 v26, v2, 3, 1
    v_lshl_add_u32 v26, v26, 2, v19
    v_bfe_u32 v27, v2, 2, 1
    v_lshrrev_b32 v28, 5, v2
    v_cmp_eq_u32 vcc, v27, v28
    v_and_b32 v27, 16, v2
    v_cmp_eq_u32 s[64:65], 0, v27
    s_and_b64 vcc, vcc, s[64:65]
    v_and_b32 v27, 1, v26
    v_lshlrev_b32 v27, 4, v27
    v_mov_b32 v28, 0x3f80
    v_lshlrev_b32 v27, v27, v28
    v_cndmask_b32 v27, 0, v27, vcc
    v_lshrrev_b32 v26, 1, v26
    v_cmp_eq_u32 vcc, 0, v26
    s_nop 1
    v_cndmask_b32 v48, 0, v27, vcc
    v_cmp_eq_u32 vcc, 1, v26
    s_nop 1
    v_cndmask_b32 v49, 0, v27, vcc
    v_cmp_eq_u32 vcc, 2, v26
    s_nop 1
    v_cndmask_b32 v50, 0, v27, vcc
    v_cmp_eq_u32 vcc, 3, v26
    s_nop 1
    v_cndmask_b32 v51, 0, v27, vcc
    v_mov_b32 v128, 0
    v_mov_b32 v129, 0
    v_mov_b32 v130, 0
    v_mov_b32 v131, 0
    v_mov_b32 v132, 0
    v_mov_b32 v133, 0
    v_mov_b32 v134, 0
    v_mov_b32 v135, 0
    v_mov_b32 v136, 0
    v_mov_b32 v137, 0
    v_mov_b32 v138, 0
    v_mov_b32 v139, 0
    v_mov_b32 v140, 0
    v_mov_b32 v141, 0
    v_mov_b32 v142, 0
    v_mov_b32 v143, 0
    s_mov_b32 s66, 0xffff
    s_mov_b32 s65, 0
    s_waitcnt vmcnt(0)
G_loop:
    v_readfirstlane_b32 s68, v20
    s_and_b32 s68, s68, s66
    s_andn2_b32 s66, s66, s68
    s_bcnt1_i32_b32 s67, s68
    s_cmp_eq_u32 s67, 0
    s_cbranch_scc1 G_l0
    s_cmp_gt_u32 s67, 8
    s_cbranch_scc1 G_lt_2
    s_cmp_gt_u32 s67, 4
    s_cbranch_scc1 G_lt_3
    s_cmp_gt_u32 s67, 2
    s_cbranch_scc1 G_lt_4
    s_cmp_eq_u32 s67, 1
    s_cbranch_scc1 G_l1
    s_branch G_l2
G_lt_4:
    s_cmp_eq_u32 s67, 3
    s_cbranch_scc1 G_l3
    s_branch G_l4
G_lt_3:
    s_cmp_gt_u32 s67, 6
    s_cbranch_scc1 G_lt_5
    s_cmp_eq_u32 s67, 5
    s_cbranch_scc1 G_l5
    s_branch G_l6
G_lt_5:
    s_cmp_eq_u32 s67, 7
    s_cbranch_scc1 G_l7
    s_branch G_l8
G_lt_2:
    s_cmp_gt_u32 s67, 12
    s_cbranch_scc1 G_lt_6
    s_cmp_gt_u32 s67, 10
    s_cbranch_scc1 G_lt_7
    s_cmp_eq_u32 s67, 9
    s_cbranch_scc1 G_l9
    s_branch G_l10
G_lt_7:
    s_cmp_eq_u32 s67, 11
    s_cbranch_scc1 G_l11
    s_branch G_l12
G_lt_6:
    s_cmp_gt_u32 s67, 14
    s_cbranch_scc1 G_lt_8
    s_cmp_eq_u32 s67, 13
    s_cbranch_scc1 G_l13
    s_branch G_l14
G_lt_8:
    s_cmp_eq_u32 s67, 15
    s_cbranch_scc1 G_l15
G_l16:
    s_ff1_i32_b32 s55, s68
    s_bitset0_b32 s68, s55
    s_mul_i32 s64, s55, 1152
    buffer_load_dwordx4 v[124:127], v17, s[16:19], s64 offen sc1
G_l15:
    s_ff1_i32_b32 s54, s68
    s_bitset0_b32 s68, s54
    s_mul_i32 s64, s54, 1152
    buffer_load_dwordx4 v[120:123], v17, s[16:19], s64 offen sc1
G_l14:
    s_ff1_i32_b32 s53, s68
    s_bitset0_b32 s68, s53
    s_mul_i32 s64, s53, 1152
    buffer_load_dwordx4 v[116:119], v17, s[16:19], s64 offen sc1
G_l13:
    s_ff1_i32_b32 s52, s68
    s_bitset0_b32 s68, s52
    s_mul_i32 s64, s52, 1152
    buffer_load_dwordx4 v[112:115], v17, s[16:19], s64 offen sc1
G_l12:
    s_ff1_i32_b32 s51, s68
    s_bitset0_b32 s68, s51
    s_mul_i32 s64, s51, 1152
    buffer_load_dwordx4 v[108:111], v17, s[16:19], s64 offen sc1
G_l11:
    s_ff1_i32_b32 s50, s68
    s_bitset0_b32 s68, s50
    s_mul_i32 s64, s50, 1152
    buffer_load_dwordx4 v[104:107], v17, s[16:19], s64 offen sc1
G_l10:
    s_ff1_i32_b32 s49, s68
    s_bitset0_b32 s68, s49
    s_mul_i32 s64, s49, 1152
    buffer_load_dwordx4 v[100:103], v17, s[16:19], s64 offen sc1
G_l9:
    s_ff1_i32_b32 s48, s68
    s_bitset0_b32 s68, s48
    s_mul_i32 s64, s48, 1152
    buffer_load_dwordx4 v[96:99], v17, s[16:19], s64 offen sc1
G_l8:
    s_ff1_i32_b32 s47, s68
    s_bitset0_b32 s68, s47
    s_mul_i32 s64, s47, 1152
    buffer_load_dwordx4 v[92:95], v17, s[16:19], s64 offen sc1
G_l7:
    s_ff1_i32_b32 s46, s68
    s_bitset0_b32 s68, s46
    s_mul_i32 s64, s46, 1152
    buffer_load_dwordx4 v[88:91], v17, s[16:19], s64 offen sc1
G_l6:
    s_ff1_i32_b32 s45, s68
    s_bitset0_b32 s68, s45
    s_mul_i32 s64, s45, 1152
    buffer_load_dwordx4 v[84:87], v17, s[16:19], s64 offen sc1
G_l5:
    s_ff1_i32_b32 s44, s68
    s_bitset0_b32 s68, s44
    s_mul_i32 s64, s44, 1152
    buffer_load_dwordx4 v[80:83], v17, s[16:19], s64 offen sc1
G_l4:
    s_ff1_i32_b32 s43, s68
    s_bitset0_b32 s68, s43
    s_mul_i32 s64, s43, 1152
    buffer_load_dwordx4 v[76:79], v17, s[16:19], s64 offen sc1
G_l3:
    s_ff1_i32_b32 s42, s68
    s_bitset0_b32 s68, s42
    s_mul_i32 s64, s42, 1152
    buffer_load_dwordx4 v[72:75], v17, s[16:19], s64 offen sc1
G_l2:
    s_ff1_i32_b32 s41, s68
    s_bitset0_b32 s68, s41
    s_mul_i32 s64, s41, 1152
    buffer_load_dwordx4 v[68:71], v17, s[16:19], s64 offen sc1
G_l1:
    s_ff1_i32_b32 s40, s68
    s_bitset0_b32 s68, s40
    s_mul_i32 s64, s40, 1152
    buffer_load_dwordx4 v[64:67], v17, s[16:19], s64 offen sc1
G_l0:
    s_mov_b32 s68, s66
    s_cmp_eq_u32 s66, 0
    s_cbranch_scc1 G_z
    s_cmp_lg_u32 s67, 0
    s_cbranch_scc1 G_p
    s_sleep 2
G_p:
    s_mov_b64 exec, 1
    v_mov_b32 v20, 0
    buffer_atomic_or v20, v23, s[16:19], 0 offen sc0
    s_mov_b64 exec, -1
    s_branch G_proc
G_z:
    buffer_load_dwordx4 v[56:59], v18, s[16:19], 0 offen sc1
G_proc:
    s_cmp_eq_u32 s67, 0
    s_cbranch_scc1 G_q0
    s_cmp_gt_u32 s67, 8
    s_cbranch_scc1 G_qt_9
    s_cmp_gt_u32 s67, 4
    s_cbranch_scc1 G_qt_10
    s_cmp_gt_u32 s67, 2
    s_cbranch_scc1 G_qt_11
    s_cmp_eq_u32 s67, 1
    s_cbranch_scc1 G_q1
    s_branch G_q2
G_qt_11:
    s_cmp_eq_u32 s67, 3
    s_cbranch_scc1 G_q3
    s_branch G_q4
G_qt_10:
    s_cmp_gt_u32 s67, 6
    s_cbranch_scc1 G_qt_12
    s_cmp_eq_u32 s67, 5
    s_cbranch_scc1 G_q5
    s_branch G_q6
G_qt_12:
    s_cmp_eq_u32 s67, 7
    s_cbranch_scc1 G_q7
    s_branch G_q8
G_qt_9:
    s_cmp_gt_u32 s67, 12
    s_cbranch_scc1 G_qt_13
    s_cmp_gt_u32 s67, 10
    s_cbranch_scc1 G_qt_14
    s_cmp_eq_u32 s67, 9
    s_cbranch_scc1 G_q9
    s_branch G_q10
G_qt_14:
    s_cmp_eq_u32 s67, 11
    s_cbranch_scc1 G_q11
    s_branch G_q12
G_qt_13:
    s_cmp_gt_u32 s67, 14
    s_cbranch_scc1 G_qt_15
    s_cmp_eq_u32 s67, 13
    s_cbranch_scc1 G_q13
    s_branch G_q14
G_qt_15:
    s_cmp_eq_u32 s67, 15
    s_cbranch_scc1 G_q15
G_q16:
    s_waitcnt vmcnt(16)
    v_max3_u32 v21, v124, v125, v126
    v_max_u32 v21, v21, v127
    v_cmp_eq_u32 vcc, -1, v21
    s_cbranch_vccnz G_f15
    v_mfma_f32_32x32x16_bf16 v[128:143], v[48:51], v[124:127], v[128:143]
G_q15:
    s_waitcnt vmcnt(15)
    v_max3_u32 v21, v120, v121, v122
    v_max_u32 v21, v21, v123
    v_cmp_eq_u32 vcc, -1, v21
    s_cbranch_vccnz G_f14
    v_mfma_f32_32x32x16_bf16 v[128:143], v[48:51], v[120:123], v[128:143]
G_q14:
    s_waitcnt vmcnt(14)
    v_max3_u32 v21, v116, v117, v118
    v_max_u32 v21, v21, v119
    v_cmp_eq_u32 vcc, -1, v21
    s_cbranch_vccnz G_f13
    v_mfma_f32_32x32x16_bf16 v[128:143], v[48:51], v[116:119], v[128:143]
G_q13:
    s_waitcnt vmcnt(13)
    v_max3_u32 v21, v112, v113, v114
    v_max_u32 v21, v21, v115
    v_cmp_eq_u32 vcc, -1, v21
    s_cbranch_vccnz G_f12
    v_mfma_f32_32x32x16_bf16 v[128:143], v[48:51], v[112:115], v[128:143]
G_q12:
    s_waitcnt vmcnt(12)
    v_max3_u32 v21, v108, v109, v110
    v_max_u32 v21, v21, v111
    v_cmp_eq_u32 vcc, -1, v21
    s_cbranch_vccnz G_f11
    v_mfma_f32_32x32x16_bf16 v[128:143], v[48:51], v[108:111], v[128:143]
G_q11:
    s_waitcnt vmcnt(11)
    v_max3_u32 v21, v104, v105, v106
    v_max_u32 v21, v21, v107
    v_cmp_eq_u32 vcc, -1, v21
    s_cbranch_vccnz G_f10
    v_mfma_f32_32x32x16_bf16 v[128:143], v[48:51], v[104:107], v[128:143]
G_q10:
    s_waitcnt vmcnt(10)
    v_max3_u32 v21, v100, v101, v102
    v_max_u32 v21, v21, v103
    v_cmp_eq_u32 vcc, -1, v21
    s_cbranch_vccnz G_f9
    v_mfma_f32_32x32x16_bf16 v[128:143], v[48:51], v[100:103], v[128:143]
G_q9:
    s_waitcnt vmcnt(9)
    v_max3_u32 v21, v96, v97, v98
    v_max_u32 v21, v21, v99
    v_cmp_eq_u32 vcc, -1, v21
    s_cbranch_vccnz G_f8
    v_mfma_f32_32x32x16_bf16 v[128:143], v[48:51], v[96:99], v[128:143]
G_q8:
    s_waitcnt vmcnt(8)
    v_max3_u32 v21, v92, v93, v94
    v_max_u32 v21, v21, v95
    v_cmp_eq_u32 vcc, -1, v21
    s_cbranch_vccnz G_f7
    v_mfma_f32_32x32x16_bf16 v[128:143], v[48:51], v[92:95], v[128:143]
G_q7:
    s_waitcnt vmcnt(7)
    v_max3_u32 v21, v88, v89, v90
    v_max_u32 v21, v21, v91
    v_cmp_eq_u32 vcc, -1, v21
    s_cbranch_vccnz G_f6
    v_mfma_f32_32x32x16_bf16 v[128:143], v[48:51], v[88:91], v[128:143]
G_q6:
    s_waitcnt vmcnt(6)
    v_max3_u32 v21, v84, v85, v86
    v_max_u32 v21, v21, v87
    v_cmp_eq_u32 vcc, -1, v21
    s_cbranch_vccnz G_f5
    v_mfma_f32_32x32x16_bf16 v[128:143], v[48:51], v[84:87], v[128:143]
G_q5:
    s_waitcnt vmcnt(5)
    v_max3_u32 v21, v80, v81, v82
    v_max_u32 v21, v21, v83
    v_cmp_eq_u32 vcc, -1, v21
    s_cbranch_vccnz G_f4
    v_mfma_f32_32x32x16_bf16 v[128:143], v[48:51], v[80:83], v[128:143]
G_q4:
    s_waitcnt vmcnt(4)
    v_max3_u32 v21, v76, v77, v78
    v_max_u32 v21, v21, v79
    v_cmp_eq_u32 vcc, -1, v21
    s_cbranch_vccnz G_f3
    v_mfma_f32_32x32x16_bf16 v[128:143], v[48:51], v[76:79], v[128:143]
G_q3:
    s_waitcnt vmcnt(3)
    v_max3_u32 v21, v72, v73, v74
    v_max_u32 v21, v21, v75
    v_cmp_eq_u32 vcc, -1, v21
    s_cbranch_vccnz G_f2
    v_mfma_f32_32x32x16_bf16 v[128:143], v[48:51], v[72:75], v[128:143]
G_q2:
    s_waitcnt vmcnt(2)
    v_max3_u32 v21, v68, v69, v70
    v_max_u32 v21, v21, v71
    v_cmp_eq_u32 vcc, -1, v21
    s_cbranch_vccnz G_f1
    v_mfma_f32_32x32x16_bf16 v[128:143], v[48:51], v[68:71], v[128:143]
G_q1:
    s_waitcnt vmcnt(1)
    v_max3_u32 v21, v64, v65, v66
    v_max_u32 v21, v21, v67
    v_cmp_eq_u32 vcc, -1, v21
    s_cbranch_vccnz G_f0
    v_mfma_f32_32x32x16_bf16 v[128:143], v[48:51], v[64:67], v[128:143]
G_q0:
    s_waitcnt vmcnt(0)
    s_add_u32 s65, s65, 1
    s_cmp_ge_u32 s65, 40000
    s_cbranch_scc1 G_done
    s_cmp_lg_u32 s68, 0
    s_cbranch_scc1 G_loop
    v_mov_b32 v20, -1
    s_cmp_lg_u32 s66, 0
    s_cbranch_scc1 G_loop
    v_max3_u32 v21, v56, v57, v58
    v_max_u32 v21, v21, v59
    v_cmp_eq_u32 vcc, -1, v21
    s_cbranch_vccnz G_loop
G_done:
    v_add_u32 v16, s7, v6
    v_add_f32_dpp v56, v56, v56 row_ror:4 row_mask:0xf bank_mask:0xf
    v_add_f32_dpp v57, v57, v57 row_ror:4 row_mask:0xf bank_mask:0xf
    v_add_f32_dpp v58, v58, v58 row_ror:4 row_mask:0xf bank_mask:0xf
    v_add_f32_dpp v59, v59, v59 row_ror:4 row_mask:0xf bank_mask:0xf
    v_add_f32_dpp v56, v56, v56 row_ror:8 row_mask:0xf bank_mask:0xf
    v_add_f32_dpp v57, v57, v57 row_ror:8 row_mask:0xf bank_mask:0xf
    v_add_f32_dpp v58, v58, v58 row_ror:8 row_mask:0xf bank_mask:0xf
    v_add_f32_dpp v59, v59, v59 row_ror:8 row_mask:0xf bank_mask:0xf
    v_mov_b32 v64, v56
    v_mov_b32 v65, v57
    v_mov_b32 v66, v58
    v_mov_b32 v67, v59
    s_nop 0
    v_permlane16_swap_b32 v56, v64
    v_permlane16_swap_b32 v57, v65
    v_permlane16_swap_b32 v58, v66
    v_permlane16_swap_b32 v59, v67
    v_add_f32 v56, v56, v64
    v_add_f32 v57, v57, v65
    v_add_f32 v58, v58, v66
    v_add_f32 v59, v59, v67
    v_mov_b32 v64, v56
    v_mov_b32 v65, v57
    v_mov_b32 v66, v58
    v_mov_b32 v67, v59
    s_nop 0
    v_permlane32_swap_b32 v56, v64
    v_permlane32_swap_b32 v57, v65
    v_permlane32_swap_b32 v58, v66
    v_permlane32_swap_b32 v59, v67
    v_add_f32 v56, v56, v64
    v_add_f32 v57, v57, v65
    v_add_f32 v58, v58, v66
    v_add_f32 v59, v59, v67
    v_cvt_pk_bf16_f32 v60, v128, v129
    v_cvt_pk_bf16_f32 v61, v130, v131
    v_cvt_pk_bf16_f32 v62, v132, v133
    v_cvt_pk_bf16_f32 v63, v134, v135
    ds_write_b128 v16, v[60:63] offset:0
    v_cvt_pk_bf16_f32 v56, v56, v57
    v_cvt_pk_bf16_f32 v57, v58, v59
    s_lshr_b32 s64, s6, 1
    s_lshl_b32 s64, s64, 6
    s_and_b32 s65, s6, 1
    s_lshl_b32 s65, s65, 3
    s_add_u32 s64, s64, s65
    v_lshl_add_u32 v16, v2, 4, s64
    s_mov_b64 exec, 15
    ds_write_b64 v16, v[56:57] offset:4096
    s_mov_b64 exec, -1
    s_waitcnt lgkmcnt(0)
    s_barrier
    v_lshrrev_b32 v18, 3, v2
    v_lshlrev_b32 v18, 2, v18
    ds_read_b32 v24, v18 offset:4352
    ds_read_b32 v25, v18 offset:4384
    ds_read_b32 v26, v18 offset:4416
    ds_read_b32 v27, v18 offset:4448
    ds_read_b32 v28, v18 offset:4480
    ds_read_b32 v29, v18 offset:4512
    ds_read_b32 v30, v18 offset:4544
    s_waitcnt lgkmcnt(0)
    v_lshlrev_b32 v48, 16, v192
    v_and_b32 v49, 0xffff0000, v192
    v_mul_f32 v32, v48, v24
    v_mul_f32 v33, v49, v24
    v_lshlrev_b32 v48, 16, v193
    v_and_b32 v49, 0xffff0000, v193
    v_mul_f32 v34, v48, v24
    v_mul_f32 v35, v49, v24
    v_lshlrev_b32 v48, 16, v194
    v_and_b32 v49, 0xffff0000, v194
    v_mul_f32 v36, v48, v24
    v_mul_f32 v37, v49, v24
    v_lshlrev_b32 v48, 16, v195
    v_and_b32 v49, 0xffff0000, v195
    v_mul_f32 v38, v48, v24
    v_mul_f32 v39, v49, v24
    v_lshlrev_b32 v48, 16, v196
    v_and_b32 v49, 0xffff0000, v196
    v_fmac_f32 v32, v48, v25
    v_fmac_f32 v33, v49, v25
    v_lshlrev_b32 v48, 16, v197
    v_and_b32 v49, 0xffff0000, v197
    v_fmac_f32 v34, v48, v25
    v_fmac_f32 v35, v49, v25
    v_lshlrev_b32 v48, 16, v198
    v_and_b32 v49, 0xffff0000, v198
    v_fmac_f32 v36, v48, v25
    v_fmac_f32 v37, v49, v25
    v_lshlrev_b32 v48, 16, v199
    v_and_b32 v49, 0xffff0000, v199
    v_fmac_f32 v38, v48, v25
    v_fmac_f32 v39, v49, v25
    v_lshlrev_b32 v48, 16, v200
    v_and_b32 v49, 0xffff0000, v200
    v_fmac_f32 v32, v48, v26
    v_fmac_f32 v33, v49, v26
    v_lshlrev_b32 v48, 16, v201
    v_and_b32 v49, 0xffff0000, v201
    v_fmac_f32 v34, v48, v26
    v_fmac_f32 v35, v49, v26
    v_lshlrev_b32 v48, 16, v202
    v_and_b32 v49, 0xffff0000, v202
    v_fmac_f32 v36, v48, v26
    v_fmac_f32 v37, v49, v26
    v_lshlrev_b32 v48, 16, v203
    v_and_b32 v49, 0xffff0000, v203
    v_fmac_f32 v38, v48, v26
    v_fmac_f32 v39, v49, v26
    v_lshlrev_b32 v48, 16, v204
    v_and_b32 v49, 0xffff0000, v204
    v_fmac_f32 v32, v48, v27
    v_fmac_f32 v33, v49, v27
    v_lshlrev_b32 v48, 16, v205
    v_and_b32 v49, 0xffff0000, v205
    v_fmac_f32 v34, v48, v27
    v_fmac_f32 v35, v49, v27
    v_lshlrev_b32 v48, 16, v206
    v_and_b32 v49, 0xffff0000, v206
    v_fmac_f32 v36, v48, v27
    v_fmac_f32 v37, v49, v27
    v_lshlrev_b32 v48, 16, v207
    v_and_b32 v49, 0xffff0000, v207
    v_fmac_f32 v38, v48, v27
    v_fmac_f32 v39, v49, v27
    v_lshlrev_b32 v48, 16, v208
    v_and_b32 v49, 0xffff0000, v208
    v_fmac_f32 v32, v48, v28
    v_fmac_f32 v33, v49, v28
    v_lshlrev_b32 v48, 16, v209
    v_and_b32 v49, 0xffff0000, v209
    v_fmac_f32 v34, v48, v28
    v_fmac_f32 v35, v49, v28
    v_lshlrev_b32 v48, 16, v210
    v_and_b32 v49, 0xffff0000, v210
    v_fmac_f32 v36, v48, v28
    v_fmac_f32 v37, v49, v28
    v_lshlrev_b32 v48, 16, v211
    v_and_b32 v49, 0xffff0000, v211
    v_fmac_f32 v38, v48, v28
    v_fmac_f32 v39, v49, v28
    v_lshlrev_b32 v48, 16, v212
    v_and_b32 v49, 0xffff0000, v212
    v_fmac_f32 v32, v48, v29
    v_fmac_f32 v33, v49, v29
    v_lshlrev_b32 v48, 16, v213
    v_and_b32 v49, 0xffff0000, v213
    v_fmac_f32 v34, v48, v29
    v_fmac_f32 v35, v49, v29
    v_lshlrev_b32 v48, 16, v214
    v_and_b32 v49, 0xffff0000, v214
    v_fmac_f32 v36, v48, v29
    v_fmac_f32 v37, v49, v29
    v_lshlrev_b32 v48, 16, v215
    v_and_b32 v49, 0xffff0000, v215
    v_fmac_f32 v38, v48, v29
    v_fmac_f32 v39, v49, v29
    v_lshlrev_b32 v48, 16, v216
    v_and_b32 v49, 0xffff0000, v216
    v_fmac_f32 v32, v48, v30
    v_fmac_f32 v33, v49, v30
    v_lshlrev_b32 v48, 16, v217
    v_and_b32 v49, 0xffff0000, v217
    v_fmac_f32 v34, v48, v30
    v_fmac_f32 v35, v49, v30
    v_lshlrev_b32 v48, 16, v218
    v_and_b32 v49, 0xffff0000, v218
    v_fmac_f32 v36, v48, v30
    v_fmac_f32 v37, v49, v30
    v_lshlrev_b32 v48, 16, v219
    v_and_b32 v49, 0xffff0000, v219
    v_fmac_f32 v38, v48, v30
    v_fmac_f32 v39, v49, v30
    s_nop 1
    v_permlane32_swap_b32 v32, v36
    v_permlane32_swap_b32 v33, v37
    v_permlane32_swap_b32 v34, v38
    v_permlane32_swap_b32 v35, v39
    v_add_f32 v32, v32, v36
    v_add_f32 v33, v33, v37
    v_add_f32 v34, v34, v38
    v_add_f32 v35, v35, v39
    s_nop 1
    v_permlane16_swap_b32 v32, v34
    v_permlane16_swap_b32 v33, v35
    v_add_f32 v32, v32, v34
    v_add_f32 v33, v33, v35
    s_nop 1
    v_add_f32_dpp v32, v32, v32 row_ror:8 row_mask:0xf bank_mask:0xf
    v_add_f32_dpp v33, v33, v33 row_ror:8 row_mask:0xf bank_mask:0xf
    v_and_b32 v16, 7, v2
    v_lshlrev_b32 v16, 5, v16
    v_lshl_add_u32 v16, v8, 3, v16
    s_lshl_b32 s64, s2, 10
    s_lshl_b32 s65, s6, 8
    s_add_u32 s64, s64, s65
    s_add_u32 s64, s64, 6447104
    s_mov_b32 exec_lo, 0x00ff00ff
    s_mov_b32 exec_hi, 0x00ff00ff
    buffer_store_dwordx2 v[32:33], v16, s[16:19], s64 offen sc0 sc1
    s_mov_b64 exec, -1
    s_lshl_b32 s64, s4, 3
    s_add_u32 s64, s64, s3
    s_lshl_b32 s64, s64, 7
    s_add_u32 s64, s64, 5382144
    v_mov_b32 v14, s64
    s_mov_b64 exec, 1
    v_mov_b32 v15, 0
    buffer_atomic_or v15, v14, s[16:19], 0 offen sc0
    s_mov_b64 exec, -1
    v_sub_f32 v248, 1.0, v228
    v_cvt_pk_bf16_f32 v248, v248, v248
    v_lshlrev_b32 v248, 16, v248
    v_lshlrev_b32 v232, 16, v220
    v_and_b32 v233, 0xffff0000, v220
    v_mul_f32 v232, v232, v248
    v_mul_f32 v233, v233, v248
    v_cvt_pk_bf16_f32 v3, v232, v233
    v_lshlrev_b32 v232, 16, v3
    v_and_b32 v233, 0xffff0000, v3
    v_lshlrev_b32 v234, 16, v221
    v_and_b32 v235, 0xffff0000, v221
    v_mul_f32 v234, v234, v248
    v_mul_f32 v235, v235, v248
    v_cvt_pk_bf16_f32 v3, v234, v235
    v_lshlrev_b32 v234, 16, v3
    v_and_b32 v235, 0xffff0000, v3
    v_lshlrev_b32 v236, 16, v222
    v_and_b32 v237, 0xffff0000, v222
    v_mul_f32 v236, v236, v248
    v_mul_f32 v237, v237, v248
    v_cvt_pk_bf16_f32 v3, v236, v237
    v_lshlrev_b32 v236, 16, v3
    v_and_b32 v237, 0xffff0000, v3
    v_lshlrev_b32 v238, 16, v223
    v_and_b32 v239, 0xffff0000, v223
    v_mul_f32 v238, v238, v248
    v_mul_f32 v239, v239, v248
    v_cvt_pk_bf16_f32 v3, v238, v239
    v_lshlrev_b32 v238, 16, v3
    v_and_b32 v239, 0xffff0000, v3
    v_lshlrev_b32 v240, 16, v224
    v_and_b32 v241, 0xffff0000, v224
    v_mul_f32 v240, v240, v248
    v_mul_f32 v241, v241, v248
    v_cvt_pk_bf16_f32 v3, v240, v241
    v_lshlrev_b32 v240, 16, v3
    v_and_b32 v241, 0xffff0000, v3
    v_lshlrev_b32 v242, 16, v225
    v_and_b32 v243, 0xffff0000, v225
    v_mul_f32 v242, v242, v248
    v_mul_f32 v243, v243, v248
    v_cvt_pk_bf16_f32 v3, v242, v243
    v_lshlrev_b32 v242, 16, v3
    v_and_b32 v243, 0xffff0000, v3
    v_lshlrev_b32 v244, 16, v226
    v_and_b32 v245, 0xffff0000, v226
    v_mul_f32 v244, v244, v248
    v_mul_f32 v245, v245, v248
    v_cvt_pk_bf16_f32 v3, v244, v245
    v_lshlrev_b32 v244, 16, v3
    v_and_b32 v245, 0xffff0000, v3
    v_lshlrev_b32 v246, 16, v227
    v_and_b32 v247, 0xffff0000, v227
    v_mul_f32 v246, v246, v248
    v_mul_f32 v247, v247, v248
    v_cvt_pk_bf16_f32 v3, v246, v247
    v_lshlrev_b32 v246, 16, v3
    v_and_b32 v247, 0xffff0000, v3
    s_branch P2_start
C_start:
    s_and_b32 s6, s3, 1
    s_lshr_b32 s7, s3, 1
    v_and_b32 v3, 15, v2
    s_lshl_b32 s64, s6, 6
    v_add_u32 v3, s64, v3
    v_lshlrev_b32 v3, 7, v3
    v_add_u32 v3, 8192, v3
    v_bfe_u32 v56, v2, 1, 3
    v_lshrrev_b32 v57, 4, v2
    v_xor_b32 v56, v56, v57
    v_lshl_add_u32 v4, v56, 4, v3
    v_xor_b32 v5, 64, v4
    v_bfe_u32 v56, v2, 2, 2
    v_lshl_add_u32 v58, v57, 3, v56
    v_lshlrev_b32 v58, 7, v58
    v_lshrrev_b32 v56, 1, v56
    v_xor_b32 v56, s7, v56
    v_lshl_add_u32 v58, v56, 6, v58
    v_and_b32 v57, 1, v57
    v_lshl_add_u32 v58, v57, 5, v58
    v_and_b32 v56, 3, v2
    v_lshl_add_u32 v58, v56, 3, v58
    v_add_u32 v6, 24576, v58
    v_xor_b32 v7, 32, v6
    v_mov_b32 v8, v4
    v_mov_b32 v10, v6
    v_mov_b32 v9, v5
    v_mov_b32 v11, v7
    v_mov_b32 v64, 0
    v_mov_b32 v65, 0
    v_mov_b32 v66, 0
    v_mov_b32 v67, 0
    v_mov_b32 v68, 0
    v_mov_b32 v69, 0
    v_mov_b32 v70, 0
    v_mov_b32 v71, 0
    v_mov_b32 v72, 0
    v_mov_b32 v73, 0
    v_mov_b32 v74, 0
    v_mov_b32 v75, 0
    v_mov_b32 v76, 0
    v_mov_b32 v77, 0
    v_mov_b32 v78, 0
    v_mov_b32 v79, 0
    v_mov_b32 v80, 0
    v_mov_b32 v81, 0
    v_mov_b32 v82, 0
    v_mov_b32 v83, 0
    v_mov_b32 v84, 0
    v_mov_b32 v85, 0
    v_mov_b32 v86, 0
    v_mov_b32 v87, 0
    v_mov_b32 v88, 0
    v_mov_b32 v89, 0
    v_mov_b32 v90, 0
    v_mov_b32 v91, 0
    v_mov_b32 v92, 0
    v_mov_b32 v93, 0
    v_mov_b32 v94, 0
    v_mov_b32 v95, 0
    v_mov_b32 v96, 0
    v_mov_b32 v97, 0
    v_mov_b32 v98, 0
    v_mov_b32 v99, 0
    v_mov_b32 v100, 0
    v_mov_b32 v101, 0
    v_mov_b32 v102, 0
    v_mov_b32 v103, 0
    v_mov_b32 v104, 0
    v_mov_b32 v105, 0
    v_mov_b32 v106, 0
    v_mov_b32 v107, 0
    v_mov_b32 v108, 0
    v_mov_b32 v109, 0
    v_mov_b32 v110, 0
    v_mov_b32 v111, 0
    v_mov_b32 v112, 0
    v_mov_b32 v113, 0
    v_mov_b32 v114, 0
    v_mov_b32 v115, 0
    v_mov_b32 v116, 0
    v_mov_b32 v117, 0
    v_mov_b32 v118, 0
    v_mov_b32 v119, 0
    v_mov_b32 v120, 0
    v_mov_b32 v121, 0
    v_mov_b32 v122, 0
    v_mov_b32 v123, 0
    v_mov_b32 v124, 0
    v_mov_b32 v125, 0
    v_mov_b32 v126, 0
    v_mov_b32 v127, 0
    v_mov_b32 v128, 0
    v_mov_b32 v129, 0
    v_mov_b32 v130, 0
    v_mov_b32 v131, 0
    v_mov_b32 v132, 0
    v_mov_b32 v133, 0
    v_mov_b32 v134, 0
    v_mov_b32 v135, 0
    v_mov_b32 v136, 0
    v_mov_b32 v137, 0
    v_mov_b32 v138, 0
    v_mov_b32 v139, 0
    v_mov_b32 v140, 0
    v_mov_b32 v141, 0
    v_mov_b32 v142, 0
    v_mov_b32 v143, 0
    v_mov_b32 v144, 0
    v_mov_b32 v145, 0
    v_mov_b32 v146, 0
    v_mov_b32 v147, 0
    v_mov_b32 v148, 0
    v_mov_b32 v149, 0
    v_mov_b32 v150, 0
    v_mov_b32 v151, 0
    v_mov_b32 v152, 0
    v_mov_b32 v153, 0
    v_mov_b32 v154, 0
    v_mov_b32 v155, 0
    v_mov_b32 v156, 0
    v_mov_b32 v157, 0
    v_mov_b32 v158, 0
    v_mov_b32 v159, 0
    s_lshl_b32 s64, s3, 2
    v_mov_b32 v229, s64
    ds_write_b32 v229, v64 offset:4288
    ds_write_b32 v229, v64 offset:4304
    v_lshlrev_b32 v3, 4, v2
    s_lshl_b32 s64, s3, 11
    v_add_u32 v224, s64, v3
    v_xor_b32 v225, 2048, v224
    s_lshl_b32 s64, s3, 8
    v_lshl_add_u32 v227, v2, 2, s64
    v_xor_b32 v228, 256, v227
    v_xor_b32 v230, 4, v229
    v_mov_b32 v231, 1
    v_lshlrev_b32 v232, 2, v2
    s_lshl_b32 s64, 1, s4
    v_mov_b32 v233, s64
    s_lshl_b32 s43, s5, 2
    s_add_u32 s43, s43, s3
    s_lshl_b32 s64, s43, 7
    s_add_u32 s64, s64, 5373952
    v_mov_b32 v234, s64
    s_lshl_b32 s43, s43, 4
    s_add_u32 s43, s43, s4
    s_mul_i32 s43, s43, 1152
    s_add_u32 s43, s43, 4194304
    s_lshl_b32 s42, s4, 2
    s_lshl_b32 s64, s6, 1
    s_add_u32 s42, s42, s64
    s_lshl_b32 s42, s42, 5
    s_lshl_b32 s64, s5, 1
    s_add_u32 s42, s42, s64
    s_add_u32 s42, s42, s7
    s_lshl_b32 s42, s42, 11
    s_and_b32 s64, s5, 7
    s_lshl_b32 s64, s64, 1
    s_add_u32 s64, s64, s7
    s_lshl_b32 s64, 1, s64
    v_mov_b32 v13, s64
    s_lshr_b32 s64, s5, 3
    s_lshl_b32 s64, s64, 1
    s_add_u32 s64, s64, s6
    s_lshl_b32 s64, s64, 8
    s_lshl_b32 s65, s4, 10
    s_add_u32 s64, s64, s65
    s_add_u32 s64, s64, 5382144
    v_lshl_add_u32 v12, v2, 7, s64
    v_lshlrev_b32 v1, 4, v2
    s_and_b32 s64, s2, 7
    s_lshr_b32 s65, s2, 3
    s_and_b32 s4, s64, 3
    s_lshl_b32 s4, s4, 2
    s_and_b32 s66, s65, 3
    s_add_u32 s4, s4, s66
    s_lshr_b32 s5, s64, 2
    s_lshl_b32 s5, s5, 3
    s_lshr_b32 s66, s65, 2
    s_add_u32 s5, s5, s66
    s_mov_b32 s65, 0
    s_mov_b32 s66, 0
    v_mov_b32 v236, 0x3f803f80
    v_mov_b32 v237, 0x3f803f80
    v_mov_b32 v238, 0x3f803f80
    v_mov_b32 v239, 0x3f803f80
    s_waitcnt vmcnt(0) lgkmcnt(0)
    s_barrier
    ds_read_b64_tr_b16 v[16:17], v10 offset:0
    ds_read_b64_tr_b16 v[18:19], v10 offset:512
    ds_read_b128 v[192:195], v8 offset:0
    ds_read_b128 v[196:199], v8 offset:2048
    ds_read_b128 v[200:203], v8 offset:4096
    ds_read_b128 v[204:207], v8 offset:6144
    ds_read_b64_tr_b16 v[20:21], v11 offset:0
    ds_read_b64_tr_b16 v[22:23], v11 offset:512
    ds_read_b64_tr_b16 v[24:25], v10 offset:8192
    ds_read_b64_tr_b16 v[26:27], v10 offset:8704
    ds_read_b64_tr_b16 v[28:29], v11 offset:8192
    ds_read_b64_tr_b16 v[30:31], v11 offset:8704
    ds_read_b64_tr_b16 v[32:33], v10 offset:16384
    ds_read_b64_tr_b16 v[34:35], v10 offset:16896
    ds_read_b64_tr_b16 v[36:37], v11 offset:16384
    ds_read_b64_tr_b16 v[38:39], v11 offset:16896
.p2align 3
C_loop:
    s_waitcnt lgkmcnt(0)
    v_mfma_f32_16x16x32_bf16 v[64:67], v[16:19], v[192:195], v[64:67]
    ds_read_b64_tr_b16 v[40:41], v10 offset:4096
    v_mfma_f32_16x16x32_bf16 v[72:75], v[16:19], v[196:199], v[72:75]
    ds_read_b64_tr_b16 v[42:43], v10 offset:4608
    v_mfma_f32_16x16x32_bf16 v[80:83], v[16:19], v[200:203], v[80:83]
    ds_read_b128 v[208:211], v9 offset:0
    v_mfma_f32_16x16x32_bf16 v[88:91], v[16:19], v[204:207], v[88:91]
    ds_read_b128 v[212:215], v9 offset:2048
    v_mfma_f32_16x16x32_bf16 v[68:71], v[20:23], v[192:195], v[68:71]
    ds_read_b128 v[216:219], v9 offset:4096
    v_mfma_f32_16x16x32_bf16 v[76:79], v[20:23], v[196:199], v[76:79]
    ds_read_b128 v[220:223], v9 offset:6144
    v_mfma_f32_16x16x32_bf16 v[84:87], v[20:23], v[200:203], v[84:87]
    ds_read_b64_tr_b16 v[44:45], v11 offset:4096
    v_mfma_f32_16x16x32_bf16 v[92:95], v[20:23], v[204:207], v[92:95]
    ds_read_b64_tr_b16 v[46:47], v11 offset:4608
    v_mfma_f32_16x16x32_bf16 v[96:99], v[192:195], v[24:27], v[96:99]
    ds_read_b64_tr_b16 v[48:49], v10 offset:12288
    v_mfma_f32_16x16x32_bf16 v[100:103], v[196:199], v[24:27], v[100:103]
    ds_read_b64_tr_b16 v[50:51], v10 offset:12800
    v_mfma_f32_16x16x32_bf16 v[112:115], v[200:203], v[24:27], v[112:115]
    ds_read_b64_tr_b16 v[52:53], v11 offset:12288
    v_mfma_f32_16x16x32_bf16 v[116:119], v[204:207], v[24:27], v[116:119]
    ds_read_b64_tr_b16 v[54:55], v11 offset:12800
    v_mfma_f32_16x16x32_bf16 v[104:107], v[192:195], v[28:31], v[104:107]
    ds_read_b64_tr_b16 v[56:57], v10 offset:20480
    v_mfma_f32_16x16x32_bf16 v[108:111], v[196:199], v[28:31], v[108:111]
    ds_read_b64_tr_b16 v[58:59], v10 offset:20992
    v_mfma_f32_16x16x32_bf16 v[120:123], v[200:203], v[28:31], v[120:123]
    ds_read_b64_tr_b16 v[60:61], v11 offset:20480
    v_mfma_f32_16x16x32_bf16 v[124:127], v[204:207], v[28:31], v[124:127]
    ds_read_b64_tr_b16 v[62:63], v11 offset:20992
    v_mfma_f32_16x16x32_bf16 v[128:131], v[192:195], v[32:35], v[128:131]
    v_mfma_f32_16x16x32_bf16 v[132:135], v[196:199], v[32:35], v[132:135]
    v_mfma_f32_16x16x32_bf16 v[144:147], v[200:203], v[32:35], v[144:147]
    v_mfma_f32_16x16x32_bf16 v[148:151], v[204:207], v[32:35], v[148:151]
    v_mfma_f32_16x16x32_bf16 v[136:139], v[192:195], v[36:39], v[136:139]
    v_mfma_f32_16x16x32_bf16 v[140:143], v[196:199], v[36:39], v[140:143]
    v_mfma_f32_16x16x32_bf16 v[152:155], v[200:203], v[36:39], v[152:155]
    v_mfma_f32_16x16x32_bf16 v[156:159], v[204:207], v[36:39], v[156:159]
    s_waitcnt lgkmcnt(0)
    s_barrier
    s_add_u32 s65, s65, 40960
    s_cmp_eq_u32 s65, 122880
    s_cselect_b32 s65, 0, s65
    v_mfma_f32_16x16x32_bf16 v[64:67], v[40:43], v[208:211], v[64:67]
    v_add_u32 v10, s65, v6
    v_add_u32 v8, s65, v4
    v_mfma_f32_16x16x32_bf16 v[72:75], v[40:43], v[212:215], v[72:75]
    ds_read_b64_tr_b16 v[16:17], v10 offset:0
    v_mfma_f32_16x16x32_bf16 v[80:83], v[40:43], v[216:219], v[80:83]
    ds_read_b64_tr_b16 v[18:19], v10 offset:512
    v_mfma_f32_16x16x32_bf16 v[88:91], v[40:43], v[220:223], v[88:91]
    ds_read_b128 v[192:195], v8 offset:0
    v_mfma_f32_16x16x32_bf16 v[68:71], v[44:47], v[208:211], v[68:71]
    ds_read_b128 v[196:199], v8 offset:2048
    v_mfma_f32_16x16x32_bf16 v[76:79], v[44:47], v[212:215], v[76:79]
    ds_read_b128 v[200:203], v8 offset:4096
    v_mfma_f32_16x16x32_bf16 v[84:87], v[44:47], v[216:219], v[84:87]
    ds_read_b128 v[204:207], v8 offset:6144
    v_mfma_f32_16x16x32_bf16 v[92:95], v[44:47], v[220:223], v[92:95]
    v_add_u32 v11, s65, v7
    v_mfma_f32_16x16x32_bf16 v[96:99], v[208:211], v[48:51], v[96:99]
    ds_read_b64_tr_b16 v[20:21], v11 offset:0
    v_mfma_f32_16x16x32_bf16 v[100:103], v[212:215], v[48:51], v[100:103]
    ds_read_b64_tr_b16 v[22:23], v11 offset:512
    v_mfma_f32_16x16x32_bf16 v[112:115], v[216:219], v[48:51], v[112:115]
    ds_read_b64_tr_b16 v[24:25], v10 offset:8192
    v_mfma_f32_16x16x32_bf16 v[116:119], v[220:223], v[48:51], v[116:119]
    ds_read_b64_tr_b16 v[26:27], v10 offset:8704
    v_mfma_f32_16x16x32_bf16 v[104:107], v[208:211], v[52:55], v[104:107]
    ds_read_b64_tr_b16 v[28:29], v11 offset:8192
    v_mfma_f32_16x16x32_bf16 v[108:111], v[212:215], v[52:55], v[108:111]
    ds_read_b64_tr_b16 v[30:31], v11 offset:8704
    v_mfma_f32_16x16x32_bf16 v[120:123], v[216:219], v[52:55], v[120:123]
    ds_read_b64_tr_b16 v[32:33], v10 offset:16384
    v_mfma_f32_16x16x32_bf16 v[124:127], v[220:223], v[52:55], v[124:127]
    ds_read_b64_tr_b16 v[34:35], v10 offset:16896
    v_mfma_f32_16x16x32_bf16 v[128:131], v[208:211], v[56:59], v[128:131]
    ds_read_b64_tr_b16 v[36:37], v11 offset:16384
    v_mfma_f32_16x16x32_bf16 v[132:135], v[212:215], v[56:59], v[132:135]
    ds_read_b64_tr_b16 v[38:39], v11 offset:16896
    v_mfma_f32_16x16x32_bf16 v[144:147], v[216:219], v[56:59], v[144:147]
    v_add_u32 v9, s65, v5
    v_mfma_f32_16x16x32_bf16 v[148:151], v[220:223], v[56:59], v[148:151]
    v_mfma_f32_16x16x32_bf16 v[136:139], v[208:211], v[60:63], v[136:139]
    v_mfma_f32_16x16x32_bf16 v[140:143], v[212:215], v[60:63], v[140:143]
    v_mfma_f32_16x16x32_bf16 v[152:155], v[216:219], v[60:63], v[152:155]
    v_mfma_f32_16x16x32_bf16 v[156:159], v[220:223], v[60:63], v[156:159]
    s_add_u32 s66, s66, 1
    s_cmp_lt_u32 s66, 14
    s_cbranch_scc1 C_loop
    s_waitcnt lgkmcnt(0)
    v_mfma_f32_16x16x32_bf16 v[96:99], v[192:195], v[24:27], v[96:99]
    ds_read_b64_tr_b16 v[48:49], v10 offset:12288
    v_mfma_f32_16x16x32_bf16 v[100:103], v[196:199], v[24:27], v[100:103]
    ds_read_b64_tr_b16 v[50:51], v10 offset:12800
    v_mfma_f32_16x16x32_bf16 v[112:115], v[200:203], v[24:27], v[112:115]
    ds_read_b128 v[160:163], v9 offset:0
    v_mfma_f32_16x16x32_bf16 v[116:119], v[204:207], v[24:27], v[116:119]
    ds_read_b128 v[164:167], v9 offset:2048
    v_mfma_f32_16x16x32_bf16 v[104:107], v[192:195], v[28:31], v[104:107]
    ds_read_b128 v[168:171], v9 offset:4096
    v_mfma_f32_16x16x32_bf16 v[108:111], v[196:199], v[28:31], v[108:111]
    ds_read_b128 v[172:175], v9 offset:6144
    v_mfma_f32_16x16x32_bf16 v[120:123], v[200:203], v[28:31], v[120:123]
    ds_read_b64_tr_b16 v[52:53], v11 offset:12288
    v_mfma_f32_16x16x32_bf16 v[124:127], v[204:207], v[28:31], v[124:127]
    ds_read_b64_tr_b16 v[54:55], v11 offset:12800
    v_mfma_f32_16x16x32_bf16 v[128:131], v[192:195], v[32:35], v[128:131]
    ds_read_b64_tr_b16 v[56:57], v10 offset:20480
    v_mfma_f32_16x16x32_bf16 v[132:135], v[196:199], v[32:35], v[132:135]
    ds_read_b64_tr_b16 v[58:59], v10 offset:20992
    v_mfma_f32_16x16x32_bf16 v[144:147], v[200:203], v[32:35], v[144:147]
    ds_read_b64_tr_b16 v[60:61], v11 offset:20480
    v_mfma_f32_16x16x32_bf16 v[148:151], v[204:207], v[32:35], v[148:151]
    ds_read_b64_tr_b16 v[62:63], v11 offset:20992
    v_mfma_f32_16x16x32_bf16 v[136:139], v[192:195], v[36:39], v[136:139]
    v_mfma_f32_16x16x32_bf16 v[140:143], v[196:199], v[36:39], v[140:143]
    v_mfma_f32_16x16x32_bf16 v[152:155], v[200:203], v[36:39], v[152:155]
    v_mfma_f32_16x16x32_bf16 v[156:159], v[204:207], v[36:39], v[156:159]
    s_waitcnt lgkmcnt(0)
    s_barrier
    s_add_u32 s66, s66, 1
    v_mfma_f32_16x16x32_bf16 v[96:99], v[160:163], v[48:51], v[96:99]
    v_mov_b32 v10, v6
    v_mov_b32 v8, v4
    v_mfma_f32_16x16x32_bf16 v[100:103], v[164:167], v[48:51], v[100:103]
    ds_read_b64_tr_b16 v[24:25], v10 offset:8192
    v_mfma_f32_16x16x32_bf16 v[112:115], v[168:171], v[48:51], v[112:115]
    ds_read_b64_tr_b16 v[26:27], v10 offset:8704
    v_mfma_f32_16x16x32_bf16 v[116:119], v[172:175], v[48:51], v[116:119]
    v_mov_b32 v11, v7
    v_mov_b32 v9, v5
    v_mfma_f32_16x16x32_bf16 v[104:107], v[160:163], v[52:55], v[104:107]
    ds_read_b128 v[176:179], v8 offset:0
    v_mfma_f32_16x16x32_bf16 v[108:111], v[164:167], v[52:55], v[108:111]
    ds_read_b128 v[180:183], v8 offset:2048
    v_mfma_f32_16x16x32_bf16 v[120:123], v[168:171], v[52:55], v[120:123]
    ds_read_b128 v[184:187], v8 offset:4096
    v_mfma_f32_16x16x32_bf16 v[124:127], v[172:175], v[52:55], v[124:127]
    ds_read_b128 v[188:191], v8 offset:6144
    v_mfma_f32_16x16x32_bf16 v[128:131], v[160:163], v[56:59], v[128:131]
    ds_read_b64_tr_b16 v[28:29], v11 offset:8192
    v_mfma_f32_16x16x32_bf16 v[132:135], v[164:167], v[56:59], v[132:135]
    ds_read_b64_tr_b16 v[30:31], v11 offset:8704
    v_mfma_f32_16x16x32_bf16 v[144:147], v[168:171], v[56:59], v[144:147]
    ds_read_b64_tr_b16 v[32:33], v10 offset:16384
    v_mfma_f32_16x16x32_bf16 v[148:151], v[172:175], v[56:59], v[148:151]
    ds_read_b64_tr_b16 v[34:35], v10 offset:16896
    v_mfma_f32_16x16x32_bf16 v[136:139], v[160:163], v[60:63], v[136:139]
    ds_read_b64_tr_b16 v[36:37], v11 offset:16384
    v_mfma_f32_16x16x32_bf16 v[140:143], v[164:167], v[60:63], v[140:143]
    ds_read_b64_tr_b16 v[38:39], v11 offset:16896
    v_mfma_f32_16x16x32_bf16 v[152:155], v[168:171], v[60:63], v[152:155]
    v_mfma_f32_16x16x32_bf16 v[156:159], v[172:175], v[60:63], v[156:159]
    s_waitcnt lgkmcnt(0)
    v_mfma_f32_16x16x32_bf16 v[96:99], v[176:179], v[24:27], v[96:99]
    ds_read_b64_tr_b16 v[48:49], v10 offset:12288
    v_mfma_f32_16x16x32_bf16 v[100:103], v[180:183], v[24:27], v[100:103]
    ds_read_b64_tr_b16 v[50:51], v10 offset:12800
    v_mfma_f32_16x16x32_bf16 v[112:115], v[184:187], v[24:27], v[112:115]
    ds_read_b128 v[208:211], v9 offset:0
    v_mfma_f32_16x16x32_bf16 v[116:119], v[188:191], v[24:27], v[116:119]
    ds_read_b128 v[212:215], v9 offset:2048
    v_mfma_f32_16x16x32_bf16 v[104:107], v[176:179], v[28:31], v[104:107]
    ds_read_b128 v[216:219], v9 offset:4096
    v_mfma_f32_16x16x32_bf16 v[108:111], v[180:183], v[28:31], v[108:111]
    ds_read_b128 v[220:223], v9 offset:6144
    v_mfma_f32_16x16x32_bf16 v[120:123], v[184:187], v[28:31], v[120:123]
    ds_read_b64_tr_b16 v[52:53], v11 offset:12288
    v_mfma_f32_16x16x32_bf16 v[124:127], v[188:191], v[28:31], v[124:127]
    ds_read_b64_tr_b16 v[54:55], v11 offset:12800
    v_mfma_f32_16x16x32_bf16 v[128:131], v[176:179], v[32:35], v[128:131]
    ds_read_b64_tr_b16 v[56:57], v10 offset:20480
    v_mfma_f32_16x16x32_bf16 v[132:135], v[180:183], v[32:35], v[132:135]
    ds_read_b64_tr_b16 v[58:59], v10 offset:20992
    v_mfma_f32_16x16x32_bf16 v[144:147], v[184:187], v[32:35], v[144:147]
    ds_read_b64_tr_b16 v[60:61], v11 offset:20480
    v_mfma_f32_16x16x32_bf16 v[148:151], v[188:191], v[32:35], v[148:151]
    ds_read_b64_tr_b16 v[62:63], v11 offset:20992
    v_mfma_f32_16x16x32_bf16 v[136:139], v[176:179], v[36:39], v[136:139]
    v_mfma_f32_16x16x32_bf16 v[140:143], v[180:183], v[36:39], v[140:143]
    v_mfma_f32_16x16x32_bf16 v[152:155], v[184:187], v[36:39], v[152:155]
    v_mfma_f32_16x16x32_bf16 v[156:159], v[188:191], v[36:39], v[156:159]
    s_waitcnt lgkmcnt(0)
    s_barrier
    v_mfma_f32_16x16x32_bf16 v[96:99], v[208:211], v[48:51], v[96:99]
    v_mfma_f32_16x16x32_bf16 v[100:103], v[212:215], v[48:51], v[100:103]
    v_mfma_f32_16x16x32_bf16 v[112:115], v[216:219], v[48:51], v[112:115]
    v_mfma_f32_16x16x32_bf16 v[116:119], v[220:223], v[48:51], v[116:119]
    v_mfma_f32_16x16x32_bf16 v[104:107], v[208:211], v[52:55], v[104:107]
    v_mfma_f32_16x16x32_bf16 v[108:111], v[212:215], v[52:55], v[108:111]
    v_mfma_f32_16x16x32_bf16 v[120:123], v[216:219], v[52:55], v[120:123]
    v_mfma_f32_16x16x32_bf16 v[124:127], v[220:223], v[52:55], v[124:127]
    v_mfma_f32_16x16x32_bf16 v[128:131], v[208:211], v[56:59], v[128:131]
    v_mfma_f32_16x16x32_bf16 v[132:135], v[212:215], v[56:59], v[132:135]
    v_mfma_f32_16x16x32_bf16 v[144:147], v[216:219], v[56:59], v[144:147]
    v_mfma_f32_16x16x32_bf16 v[148:151], v[220:223], v[56:59], v[148:151]
    v_mfma_f32_16x16x32_bf16 v[136:139], v[208:211], v[60:63], v[136:139]
    v_mfma_f32_16x16x32_bf16 v[140:143], v[212:215], v[60:63], v[140:143]
    v_mfma_f32_16x16x32_bf16 v[152:155], v[216:219], v[60:63], v[152:155]
    v_mfma_f32_16x16x32_bf16 v[156:159], v[220:223], v[60:63], v[156:159]
    v_add_u32 v10, 81920, v6
    v_add_u32 v11, 81920, v7
    v_cvt_pk_bf16_f32 v16, v96, v97
    v_lshlrev_b32 v48, 16, v16
    v_and_b32 v49, 0xffff0000, v16
    v_mul_f32 v50, s72, v48
    v_mul_f32 v51, s72, v49
    v_exp_f32 v50, v50 clamp
    v_exp_f32 v51, v51 clamp
    v_max_f32 v48, 0, v48
    v_max_f32 v49, 0, v49
    v_add_f32 v48, v48, v50
    v_add_f32 v49, v49, v51
    v_min_f32 v56, v48, v49
    v_cvt_pk_bf16_f32 v16, v48, v49
    v_cvt_pk_bf16_f32 v17, v98, v99
    v_lshlrev_b32 v48, 16, v17
    v_and_b32 v49, 0xffff0000, v17
    v_mul_f32 v50, s72, v48
    v_mul_f32 v51, s72, v49
    v_exp_f32 v50, v50 clamp
    v_exp_f32 v51, v51 clamp
    v_max_f32 v48, 0, v48
    v_max_f32 v49, 0, v49
    v_add_f32 v48, v48, v50
    v_add_f32 v49, v49, v51
    v_min3_f32 v56, v48, v49, v56
    v_cvt_pk_bf16_f32 v17, v48, v49
    v_cvt_pk_bf16_f32 v18, v100, v101
    v_lshlrev_b32 v48, 16, v18
    v_and_b32 v49, 0xffff0000, v18
    v_mul_f32 v50, s72, v48
    v_mul_f32 v51, s72, v49
    v_exp_f32 v50, v50 clamp
    v_exp_f32 v51, v51 clamp
    v_max_f32 v48, 0, v48
    v_max_f32 v49, 0, v49
    v_add_f32 v48, v48, v50
    v_add_f32 v49, v49, v51
    v_min3_f32 v56, v48, v49, v56
    v_cvt_pk_bf16_f32 v18, v48, v49
    v_cvt_pk_bf16_f32 v19, v102, v103
    v_lshlrev_b32 v48, 16, v19
    v_and_b32 v49, 0xffff0000, v19
    v_mul_f32 v50, s72, v48
    v_mul_f32 v51, s72, v49
    v_exp_f32 v50, v50 clamp
    v_exp_f32 v51, v51 clamp
    v_max_f32 v48, 0, v48
    v_max_f32 v49, 0, v49
    v_add_f32 v48, v48, v50
    v_add_f32 v49, v49, v51
    v_min3_f32 v56, v48, v49, v56
    v_cvt_pk_bf16_f32 v19, v48, v49
    v_cvt_pk_bf16_f32 v20, v104, v105
    v_lshlrev_b32 v48, 16, v20
    v_and_b32 v49, 0xffff0000, v20
    v_mul_f32 v50, s72, v48
    v_mul_f32 v51, s72, v49
    v_exp_f32 v50, v50 clamp
    v_exp_f32 v51, v51 clamp
    v_max_f32 v48, 0, v48
    v_max_f32 v49, 0, v49
    v_add_f32 v48, v48, v50
    v_add_f32 v49, v49, v51
    v_min3_f32 v56, v48, v49, v56
    v_cvt_pk_bf16_f32 v20, v48, v49
    v_cvt_pk_bf16_f32 v21, v106, v107
    v_lshlrev_b32 v48, 16, v21
    v_and_b32 v49, 0xffff0000, v21
    v_mul_f32 v50, s72, v48
    v_mul_f32 v51, s72, v49
    v_exp_f32 v50, v50 clamp
    v_exp_f32 v51, v51 clamp
    v_max_f32 v48, 0, v48
    v_max_f32 v49, 0, v49
    v_add_f32 v48, v48, v50
    v_add_f32 v49, v49, v51
    v_min3_f32 v56, v48, v49, v56
    v_cvt_pk_bf16_f32 v21, v48, v49
    v_cvt_pk_bf16_f32 v22, v108, v109
    v_lshlrev_b32 v48, 16, v22
    v_and_b32 v49, 0xffff0000, v22
    v_mul_f32 v50, s72, v48
    v_mul_f32 v51, s72, v49
    v_exp_f32 v50, v50 clamp
    v_exp_f32 v51, v51 clamp
    v_max_f32 v48, 0, v48
    v_max_f32 v49, 0, v49
    v_add_f32 v48, v48, v50
    v_add_f32 v49, v49, v51
    v_min3_f32 v56, v48, v49, v56
    v_cvt_pk_bf16_f32 v22, v48, v49
    v_cvt_pk_bf16_f32 v23, v110, v111
    v_lshlrev_b32 v48, 16, v23
    v_and_b32 v49, 0xffff0000, v23
    v_mul_f32 v50, s72, v48
    v_mul_f32 v51, s72, v49
    v_exp_f32 v50, v50 clamp
    v_exp_f32 v51, v51 clamp
    v_max_f32 v48, 0, v48
    v_max_f32 v49, 0, v49
    v_add_f32 v48, v48, v50
    v_add_f32 v49, v49, v51
    v_min3_f32 v56, v48, v49, v56
    v_cvt_pk_bf16_f32 v23, v48, v49
    v_cmp_gt_f32 vcc, 0x3a800000, v56
    s_cbranch_vccnz phi_16_fix
phi_16_done:
    v_cvt_pk_bf16_f32 v32, v128, v129
    v_cvt_pk_bf16_f32 v33, v130, v131
    v_mfma_f32_16x16x32_bf16 v[96:99], v[236:239], v[16:19], 0
    v_cvt_pk_bf16_f32 v34, v132, v133
    v_mfma_f32_16x16x32_bf16 v[60:63], v[236:239], v[20:23], 0
    v_cvt_pk_bf16_f32 v35, v134, v135
    v_cvt_pk_bf16_f32 v36, v136, v137
    v_cvt_pk_bf16_f32 v37, v138, v139
    v_mfma_f32_16x16x32_bf16 v[240:243], v[16:19], v[32:35], 0
    v_cvt_pk_bf16_f32 v38, v140, v141
    v_mfma_f32_16x16x32_bf16 v[244:247], v[20:23], v[32:35], 0
    v_cvt_pk_bf16_f32 v39, v142, v143
    s_nop 1
    v_mfma_f32_16x16x32_bf16 v[248:251], v[16:19], v[36:39], 0
    v_mfma_f32_16x16x32_bf16 v[252:255], v[20:23], v[36:39], 0
    v_cvt_pk_bf16_f32 v24, v112, v113
    v_lshlrev_b32 v48, 16, v24
    v_and_b32 v49, 0xffff0000, v24
    v_mul_f32 v50, s72, v48
    v_mul_f32 v51, s72, v49
    v_exp_f32 v50, v50 clamp
    v_exp_f32 v51, v51 clamp
    v_max_f32 v48, 0, v48
    v_max_f32 v49, 0, v49
    v_add_f32 v48, v48, v50
    v_add_f32 v49, v49, v51
    v_min_f32 v56, v48, v49
    v_cvt_pk_bf16_f32 v24, v48, v49
    v_cvt_pk_bf16_f32 v25, v114, v115
    v_lshlrev_b32 v48, 16, v25
    v_and_b32 v49, 0xffff0000, v25
    v_mul_f32 v50, s72, v48
    v_mul_f32 v51, s72, v49
    v_exp_f32 v50, v50 clamp
    v_exp_f32 v51, v51 clamp
    v_max_f32 v48, 0, v48
    v_max_f32 v49, 0, v49
    v_add_f32 v48, v48, v50
    v_add_f32 v49, v49, v51
    v_min3_f32 v56, v48, v49, v56
    v_cvt_pk_bf16_f32 v25, v48, v49
    v_cvt_pk_bf16_f32 v26, v116, v117
    v_lshlrev_b32 v48, 16, v26
    v_and_b32 v49, 0xffff0000, v26
    v_mul_f32 v50, s72, v48
    v_mul_f32 v51, s72, v49
    v_exp_f32 v50, v50 clamp
    v_exp_f32 v51, v51 clamp
    v_max_f32 v48, 0, v48
    v_max_f32 v49, 0, v49
    v_add_f32 v48, v48, v50
    v_add_f32 v49, v49, v51
    v_min3_f32 v56, v48, v49, v56
    v_cvt_pk_bf16_f32 v26, v48, v49
    v_cvt_pk_bf16_f32 v27, v118, v119
    v_lshlrev_b32 v48, 16, v27
    v_and_b32 v49, 0xffff0000, v27
    v_mul_f32 v50, s72, v48
    v_mul_f32 v51, s72, v49
    v_exp_f32 v50, v50 clamp
    v_exp_f32 v51, v51 clamp
    v_max_f32 v48, 0, v48
    v_max_f32 v49, 0, v49
    v_add_f32 v48, v48, v50
    v_add_f32 v49, v49, v51
    v_min3_f32 v56, v48, v49, v56
    v_cvt_pk_bf16_f32 v27, v48, v49
    v_cvt_pk_bf16_f32 v28, v120, v121
    v_lshlrev_b32 v48, 16, v28
    v_and_b32 v49, 0xffff0000, v28
    v_mul_f32 v50, s72, v48
    v_mul_f32 v51, s72, v49
    v_exp_f32 v50, v50 clamp
    v_exp_f32 v51, v51 clamp
    v_max_f32 v48, 0, v48
    v_max_f32 v49, 0, v49
    v_add_f32 v48, v48, v50
    v_add_f32 v49, v49, v51
    v_min3_f32 v56, v48, v49, v56
    v_cvt_pk_bf16_f32 v28, v48, v49
    v_cvt_pk_bf16_f32 v29, v122, v123
    v_lshlrev_b32 v48, 16, v29
    v_and_b32 v49, 0xffff0000, v29
    v_mul_f32 v50, s72, v48
    v_mul_f32 v51, s72, v49
    v_exp_f32 v50, v50 clamp
    v_exp_f32 v51, v51 clamp
    v_max_f32 v48, 0, v48
    v_max_f32 v49, 0, v49
    v_add_f32 v48, v48, v50
    v_add_f32 v49, v49, v51
    v_min3_f32 v56, v48, v49, v56
    v_cvt_pk_bf16_f32 v29, v48, v49
    v_cvt_pk_bf16_f32 v30, v124, v125
    v_lshlrev_b32 v48, 16, v30
    v_and_b32 v49, 0xffff0000, v30
    v_mul_f32 v50, s72, v48
    v_mul_f32 v51, s72, v49
    v_exp_f32 v50, v50 clamp
    v_exp_f32 v51, v51 clamp
    v_max_f32 v48, 0, v48
    v_max_f32 v49, 0, v49
    v_add_f32 v48, v48, v50
    v_add_f32 v49, v49, v51
    v_min3_f32 v56, v48, v49, v56
    v_cvt_pk_bf16_f32 v30, v48, v49
    v_cvt_pk_bf16_f32 v31, v126, v127
    v_lshlrev_b32 v48, 16, v31
    v_and_b32 v49, 0xffff0000, v31
    v_mul_f32 v50, s72, v48
    v_mul_f32 v51, s72, v49
    v_exp_f32 v50, v50 clamp
    v_exp_f32 v51, v51 clamp
    v_max_f32 v48, 0, v48
    v_max_f32 v49, 0, v49
    v_add_f32 v48, v48, v50
    v_add_f32 v49, v49, v51
    v_min3_f32 v56, v48, v49, v56
    v_cvt_pk_bf16_f32 v31, v48, v49
    v_cmp_gt_f32 vcc, 0x3a800000, v56
    s_cbranch_vccnz phi_17_fix
phi_17_done:
    v_cvt_pk_bf16_f32 v40, v144, v145
    v_cvt_pk_bf16_f32 v41, v146, v147
    v_mfma_f32_16x16x32_bf16 v[96:99], v[236:239], v[24:27], v[96:99]
    v_cvt_pk_bf16_f32 v42, v148, v149
    v_mfma_f32_16x16x32_bf16 v[60:63], v[236:239], v[28:31], v[60:63]
    v_cvt_pk_bf16_f32 v43, v150, v151
    v_cvt_pk_bf16_f32 v44, v152, v153
    v_cvt_pk_bf16_f32 v45, v154, v155
    v_mfma_f32_16x16x32_bf16 v[240:243], v[24:27], v[40:43], v[240:243]
    v_cvt_pk_bf16_f32 v46, v156, v157
    v_mfma_f32_16x16x32_bf16 v[244:247], v[28:31], v[40:43], v[244:247]
    v_cvt_pk_bf16_f32 v47, v158, v159
    s_nop 1
    v_mfma_f32_16x16x32_bf16 v[248:251], v[24:27], v[44:47], v[248:251]
    v_mfma_f32_16x16x32_bf16 v[252:255], v[28:31], v[44:47], v[252:255]
    s_cmp_eq_u32 s6, 0
    s_cbranch_scc0 C_ex1
    ds_write_b32 v227, v60 offset:4608
    s_nop 5
    ds_write_b128 v224, v[248:251] offset:32768
    ds_write_b128 v224, v[252:255] offset:33792
C_ex2:
    ds_write_b32 v229, v231 offset:4288
C_ps:
    ds_read_b32 v25, v230 offset:4288
    ds_read_b128 v[16:19], v225 offset:32768
    ds_read_b128 v[20:23], v225 offset:33792
    ds_read_b32 v24, v228 offset:4608
    s_waitcnt lgkmcnt(0)
    v_cmp_eq_u32 vcc, 0, v25
    s_cbranch_vccnz C_ps
    v_add_f32 v16, v16, v240
    v_add_f32 v17, v17, v241
    v_add_f32 v18, v18, v242
    v_add_f32 v19, v19, v243
    v_add_f32 v20, v20, v244
    v_add_f32 v21, v21, v245
    v_add_f32 v22, v22, v246
    v_add_f32 v23, v23, v247
    v_add_f32 v24, v24, v96
    v_cvt_pk_bf16_f32 v28, v16, v17
    v_cvt_pk_bf16_f32 v29, v18, v19
    v_cvt_pk_bf16_f32 v30, v20, v21
    v_cvt_pk_bf16_f32 v31, v22, v23
    buffer_store_dwordx4 v[28:31], v1, s[16:19], s43 offen sc0 sc1
    s_mov_b64 exec, 0xffff
    buffer_store_dword v24, v232, s[16:19], s43 offen offset:1024 sc0 sc1
    s_mov_b64 exec, 1
    buffer_atomic_or v233, v234, s[16:19], 0 offen
    s_mov_b64 exec, -1
    ds_read_b64_tr_b16 v[96:97], v10 offset:0
    ds_read_b64_tr_b16 v[98:99], v10 offset:512
    ds_read_b64_tr_b16 v[100:101], v11 offset:0
    ds_read_b64_tr_b16 v[102:103], v11 offset:512
    ds_read_b64_tr_b16 v[104:105], v10 offset:4096
    ds_read_b64_tr_b16 v[106:107], v10 offset:4608
    ds_read_b64_tr_b16 v[108:109], v11 offset:4096
    ds_read_b64_tr_b16 v[110:111], v11 offset:4608
    ds_read_b64_tr_b16 v[112:113], v6 offset:0
    ds_read_b64_tr_b16 v[114:115], v6 offset:512
    ds_read_b64_tr_b16 v[116:117], v7 offset:0
    ds_read_b64_tr_b16 v[118:119], v7 offset:512
    ds_read_b64_tr_b16 v[120:121], v6 offset:4096
    ds_read_b64_tr_b16 v[122:123], v6 offset:4608
    ds_read_b64_tr_b16 v[124:125], v7 offset:4096
    ds_read_b64_tr_b16 v[126:127], v7 offset:4608
    s_waitcnt lgkmcnt(12)
    v_mfma_f32_16x16x32_bf16 v[64:67], v[96:99], v[192:195], v[64:67]
    v_mfma_f32_16x16x32_bf16 v[72:75], v[96:99], v[196:199], v[72:75]
    v_mfma_f32_16x16x32_bf16 v[80:83], v[96:99], v[200:203], v[80:83]
    v_mfma_f32_16x16x32_bf16 v[88:91], v[96:99], v[204:207], v[88:91]
    v_mfma_f32_16x16x32_bf16 v[68:71], v[100:103], v[192:195], v[68:71]
    v_mfma_f32_16x16x32_bf16 v[76:79], v[100:103], v[196:199], v[76:79]
    v_mfma_f32_16x16x32_bf16 v[84:87], v[100:103], v[200:203], v[84:87]
    v_mfma_f32_16x16x32_bf16 v[92:95], v[100:103], v[204:207], v[92:95]
    s_waitcnt lgkmcnt(8)
    v_mfma_f32_16x16x32_bf16 v[64:67], v[104:107], v[160:163], v[64:67]
    v_mfma_f32_16x16x32_bf16 v[72:75], v[104:107], v[164:167], v[72:75]
    v_mfma_f32_16x16x32_bf16 v[80:83], v[104:107], v[168:171], v[80:83]
    v_mfma_f32_16x16x32_bf16 v[88:91], v[104:107], v[172:175], v[88:91]
    v_mfma_f32_16x16x32_bf16 v[68:71], v[108:111], v[160:163], v[68:71]
    v_mfma_f32_16x16x32_bf16 v[76:79], v[108:111], v[164:167], v[76:79]
    v_mfma_f32_16x16x32_bf16 v[84:87], v[108:111], v[168:171], v[84:87]
    v_mfma_f32_16x16x32_bf16 v[92:95], v[108:111], v[172:175], v[92:95]
    s_waitcnt lgkmcnt(4)
    v_mfma_f32_16x16x32_bf16 v[64:67], v[112:115], v[176:179], v[64:67]
    v_mfma_f32_16x16x32_bf16 v[72:75], v[112:115], v[180:183], v[72:75]
    v_mfma_f32_16x16x32_bf16 v[80:83], v[112:115], v[184:187], v[80:83]
    v_mfma_f32_16x16x32_bf16 v[88:91], v[112:115], v[188:191], v[88:91]
    v_mfma_f32_16x16x32_bf16 v[68:71], v[116:119], v[176:179], v[68:71]
    v_mfma_f32_16x16x32_bf16 v[76:79], v[116:119], v[180:183], v[76:79]
    v_mfma_f32_16x16x32_bf16 v[84:87], v[116:119], v[184:187], v[84:87]
    v_mfma_f32_16x16x32_bf16 v[92:95], v[116:119], v[188:191], v[92:95]
    s_waitcnt lgkmcnt(0)
    v_mfma_f32_16x16x32_bf16 v[64:67], v[120:123], v[208:211], v[64:67]
    v_mfma_f32_16x16x32_bf16 v[72:75], v[120:123], v[212:215], v[72:75]
    v_mfma_f32_16x16x32_bf16 v[80:83], v[120:123], v[216:219], v[80:83]
    v_mfma_f32_16x16x32_bf16 v[88:91], v[120:123], v[220:223], v[88:91]
    v_mfma_f32_16x16x32_bf16 v[68:71], v[124:127], v[208:211], v[68:71]
    v_mfma_f32_16x16x32_bf16 v[76:79], v[124:127], v[212:215], v[76:79]
    v_mfma_f32_16x16x32_bf16 v[84:87], v[124:127], v[216:219], v[84:87]
    v_mfma_f32_16x16x32_bf16 v[92:95], v[124:127], v[220:223], v[92:95]
    s_and_b32 s64, s3, 3
    s_lshl_b32 s64, s64, 1
    s_lshr_b32 s65, s3, 2
    s_add_u32 s64, s64, s65
    s_lshl_b32 s64, s64, 4
    s_lshl_b32 s65, s4, 7
    s_add_u32 s64, s64, s65
    v_and_b32 v230, 15, v2
    v_add_u32 v230, s64, v230
    v_bfe_u32 v3, v2, 4, 1
    v_lshlrev_b32 v229, 5, v3
    v_lshrrev_b32 v3, 5, v2
    v_lshl_add_u32 v229, v3, 4, v229
    v_lshl_add_u32 v231, v230, 11, v229
    s_lshl_b32 s64, s5, 7
    v_add_u32 v231, s64, v231
    v_lshlrev_b32 v3, 2, v230
    v_add_u32 v3, 6709248, v3
    buffer_load_dwordx4 v[220:223], v231, s[8:11], 0 offen
    buffer_load_dwordx4 v[224:227], v231, s[8:11], 0 offen offset:64
    buffer_load_dword v228, v3, s[16:19], 0 offen sc1
    v_lshlrev_b32 v3, 4, v2
    s_lshl_b32 s64, s7, 11
    v_add_u32 v4, s64, v3
    v_lshrrev_b32 v5, 4, v2
    v_lshlrev_b32 v5, 4, v5
    s_lshl_b32 s64, s7, 6
    v_add_u32 v5, s64, v5
    v_mov_b32 v6, 4256
    ds_read_b32 v6, v6
    v_cvt_pk_bf16_f32 v32, v64, v65
    v_lshlrev_b32 v48, 16, v32
    v_and_b32 v49, 0xffff0000, v32
    v_mul_f32 v50, s72, v48
    v_mul_f32 v51, s72, v49
    v_exp_f32 v50, v50 clamp
    v_exp_f32 v51, v51 clamp
    v_max_f32 v48, 0, v48
    v_max_f32 v49, 0, v49
    v_add_f32 v48, v48, v50
    v_add_f32 v49, v49, v51
    v_min_f32 v56, v48, v49
    v_cvt_pk_bf16_f32 v32, v48, v49
    v_cvt_pk_bf16_f32 v33, v66, v67
    v_lshlrev_b32 v48, 16, v33
    v_and_b32 v49, 0xffff0000, v33
    v_mul_f32 v50, s72, v48
    v_mul_f32 v51, s72, v49
    v_exp_f32 v50, v50 clamp
    v_exp_f32 v51, v51 clamp
    v_max_f32 v48, 0, v48
    v_max_f32 v49, 0, v49
    v_add_f32 v48, v48, v50
    v_add_f32 v49, v49, v51
    v_min3_f32 v56, v48, v49, v56
    v_cvt_pk_bf16_f32 v33, v48, v49
    v_cvt_pk_bf16_f32 v34, v68, v69
    v_lshlrev_b32 v48, 16, v34
    v_and_b32 v49, 0xffff0000, v34
    v_mul_f32 v50, s72, v48
    v_mul_f32 v51, s72, v49
    v_exp_f32 v50, v50 clamp
    v_exp_f32 v51, v51 clamp
    v_max_f32 v48, 0, v48
    v_max_f32 v49, 0, v49
    v_add_f32 v48, v48, v50
    v_add_f32 v49, v49, v51
    v_min3_f32 v56, v48, v49, v56
    v_cvt_pk_bf16_f32 v34, v48, v49
    v_cvt_pk_bf16_f32 v35, v70, v71
    v_lshlrev_b32 v48, 16, v35
    v_and_b32 v49, 0xffff0000, v35
    v_mul_f32 v50, s72, v48
    v_mul_f32 v51, s72, v49
    v_exp_f32 v50, v50 clamp
    v_exp_f32 v51, v51 clamp
    v_max_f32 v48, 0, v48
    v_max_f32 v49, 0, v49
    v_add_f32 v48, v48, v50
    v_add_f32 v49, v49, v51
    v_min3_f32 v56, v48, v49, v56
    v_cvt_pk_bf16_f32 v35, v48, v49
    v_cvt_pk_bf16_f32 v36, v72, v73
    v_lshlrev_b32 v48, 16, v36
    v_and_b32 v49, 0xffff0000, v36
    v_mul_f32 v50, s72, v48
    v_mul_f32 v51, s72, v49
    v_exp_f32 v50, v50 clamp
    v_exp_f32 v51, v51 clamp
    v_max_f32 v48, 0, v48
    v_max_f32 v49, 0, v49
    v_add_f32 v48, v48, v50
    v_add_f32 v49, v49, v51
    v_min3_f32 v56, v48, v49, v56
    v_cvt_pk_bf16_f32 v36, v48, v49
    v_cvt_pk_bf16_f32 v37, v74, v75
    v_lshlrev_b32 v48, 16, v37
    v_and_b32 v49, 0xffff0000, v37
    v_mul_f32 v50, s72, v48
    v_mul_f32 v51, s72, v49
    v_exp_f32 v50, v50 clamp
    v_exp_f32 v51, v51 clamp
    v_max_f32 v48, 0, v48
    v_max_f32 v49, 0, v49
    v_add_f32 v48, v48, v50
    v_add_f32 v49, v49, v51
    v_min3_f32 v56, v48, v49, v56
    v_cvt_pk_bf16_f32 v37, v48, v49
    v_cvt_pk_bf16_f32 v38, v76, v77
    v_lshlrev_b32 v48, 16, v38
    v_and_b32 v49, 0xffff0000, v38
    v_mul_f32 v50, s72, v48
    v_mul_f32 v51, s72, v49
    v_exp_f32 v50, v50 clamp
    v_exp_f32 v51, v51 clamp
    v_max_f32 v48, 0, v48
    v_max_f32 v49, 0, v49
    v_add_f32 v48, v48, v50
    v_add_f32 v49, v49, v51
    v_min3_f32 v56, v48, v49, v56
    v_cvt_pk_bf16_f32 v38, v48, v49
    v_cvt_pk_bf16_f32 v39, v78, v79
    v_lshlrev_b32 v48, 16, v39
    v_and_b32 v49, 0xffff0000, v39
    v_mul_f32 v50, s72, v48
    v_mul_f32 v51, s72, v49
    v_exp_f32 v50, v50 clamp
    v_exp_f32 v51, v51 clamp
    v_max_f32 v48, 0, v48
    v_max_f32 v49, 0, v49
    v_add_f32 v48, v48, v50
    v_add_f32 v49, v49, v51
    v_min3_f32 v56, v48, v49, v56
    v_cvt_pk_bf16_f32 v39, v48, v49
    v_cmp_gt_f32 vcc, 0x3a800000, v56
    s_cbranch_vccnz phi_18_fix
phi_18_done:
    v_cvt_pk_bf16_f32 v40, v80, v81
    v_lshlrev_b32 v48, 16, v40
    v_and_b32 v49, 0xffff0000, v40
    v_mul_f32 v50, s72, v48
    v_mul_f32 v51, s72, v49
    v_exp_f32 v50, v50 clamp
    v_exp_f32 v51, v51 clamp
    v_max_f32 v48, 0, v48
    v_max_f32 v49, 0, v49
    v_add_f32 v48, v48, v50
    v_add_f32 v49, v49, v51
    v_min_f32 v56, v48, v49
    v_cvt_pk_bf16_f32 v40, v48, v49
    v_cvt_pk_bf16_f32 v41, v82, v83
    v_lshlrev_b32 v48, 16, v41
    v_and_b32 v49, 0xffff0000, v41
    v_mul_f32 v50, s72, v48
    v_mul_f32 v51, s72, v49
    v_exp_f32 v50, v50 clamp
    v_exp_f32 v51, v51 clamp
    v_max_f32 v48, 0, v48
    v_max_f32 v49, 0, v49
    v_add_f32 v48, v48, v50
    v_add_f32 v49, v49, v51
    v_min3_f32 v56, v48, v49, v56
    v_cvt_pk_bf16_f32 v41, v48, v49
    v_cvt_pk_bf16_f32 v42, v84, v85
    v_lshlrev_b32 v48, 16, v42
    v_and_b32 v49, 0xffff0000, v42
    v_mul_f32 v50, s72, v48
    v_mul_f32 v51, s72, v49
    v_exp_f32 v50, v50 clamp
    v_exp_f32 v51, v51 clamp
    v_max_f32 v48, 0, v48
    v_max_f32 v49, 0, v49
    v_add_f32 v48, v48, v50
    v_add_f32 v49, v49, v51
    v_min3_f32 v56, v48, v49, v56
    v_cvt_pk_bf16_f32 v42, v48, v49
    v_cvt_pk_bf16_f32 v43, v86, v87
    v_lshlrev_b32 v48, 16, v43
    v_and_b32 v49, 0xffff0000, v43
    v_mul_f32 v50, s72, v48
    v_mul_f32 v51, s72, v49
    v_exp_f32 v50, v50 clamp
    v_exp_f32 v51, v51 clamp
    v_max_f32 v48, 0, v48
    v_max_f32 v49, 0, v49
    v_add_f32 v48, v48, v50
    v_add_f32 v49, v49, v51
    v_min3_f32 v56, v48, v49, v56
    v_cvt_pk_bf16_f32 v43, v48, v49
    v_cvt_pk_bf16_f32 v44, v88, v89
    v_lshlrev_b32 v48, 16, v44
    v_and_b32 v49, 0xffff0000, v44
    v_mul_f32 v50, s72, v48
    v_mul_f32 v51, s72, v49
    v_exp_f32 v50, v50 clamp
    v_exp_f32 v51, v51 clamp
    v_max_f32 v48, 0, v48
    v_max_f32 v49, 0, v49
    v_add_f32 v48, v48, v50
    v_add_f32 v49, v49, v51
    v_min3_f32 v56, v48, v49, v56
    v_cvt_pk_bf16_f32 v44, v48, v49
    v_cvt_pk_bf16_f32 v45, v90, v91
    v_lshlrev_b32 v48, 16, v45
    v_and_b32 v49, 0xffff0000, v45
    v_mul_f32 v50, s72, v48
    v_mul_f32 v51, s72, v49
    v_exp_f32 v50, v50 clamp
    v_exp_f32 v51, v51 clamp
    v_max_f32 v48, 0, v48
    v_max_f32 v49, 0, v49
    v_add_f32 v48, v48, v50
    v_add_f32 v49, v49, v51
    v_min3_f32 v56, v48, v49, v56
    v_cvt_pk_bf16_f32 v45, v48, v49
    v_cvt_pk_bf16_f32 v46, v92, v93
    v_lshlrev_b32 v48, 16, v46
    v_and_b32 v49, 0xffff0000, v46
    v_mul_f32 v50, s72, v48
    v_mul_f32 v51, s72, v49
    v_exp_f32 v50, v50 clamp
    v_exp_f32 v51, v51 clamp
    v_max_f32 v48, 0, v48
    v_max_f32 v49, 0, v49
    v_add_f32 v48, v48, v50
    v_add_f32 v49, v49, v51
    v_min3_f32 v56, v48, v49, v56
    v_cvt_pk_bf16_f32 v46, v48, v49
    v_cvt_pk_bf16_f32 v47, v94, v95
    v_lshlrev_b32 v48, 16, v47
    v_and_b32 v49, 0xffff0000, v47
    v_mul_f32 v50, s72, v48
    v_mul_f32 v51, s72, v49
    v_exp_f32 v50, v50 clamp
    v_exp_f32 v51, v51 clamp
    v_max_f32 v48, 0, v48
    v_max_f32 v49, 0, v49
    v_add_f32 v48, v48, v50
    v_add_f32 v49, v49, v51
    v_min3_f32 v56, v48, v49, v56
    v_cvt_pk_bf16_f32 v47, v48, v49
    v_cmp_gt_f32 vcc, 0x3a800000, v56
    s_cbranch_vccnz phi_19_fix
phi_19_done:
    s_waitcnt lgkmcnt(0)
    v_readfirstlane_b32 s75, v6
    s_waitcnt vmcnt(0)
    v_sub_f32 v248, 1.0, v228
    v_cvt_pk_bf16_f32 v248, v248, v248
    v_lshlrev_b32 v248, 16, v248
    v_lshlrev_b32 v232, 16, v220
    v_and_b32 v233, 0xffff0000, v220
    v_mul_f32 v232, v232, v248
    v_mul_f32 v233, v233, v248
    v_cvt_pk_bf16_f32 v3, v232, v233
    v_lshlrev_b32 v232, 16, v3
    v_and_b32 v233, 0xffff0000, v3
    v_lshlrev_b32 v234, 16, v221
    v_and_b32 v235, 0xffff0000, v221
    v_mul_f32 v234, v234, v248
    v_mul_f32 v235, v235, v248
    v_cvt_pk_bf16_f32 v3, v234, v235
    v_lshlrev_b32 v234, 16, v3
    v_and_b32 v235, 0xffff0000, v3
    v_lshlrev_b32 v236, 16, v222
    v_and_b32 v237, 0xffff0000, v222
    v_mul_f32 v236, v236, v248
    v_mul_f32 v237, v237, v248
    v_cvt_pk_bf16_f32 v3, v236, v237
    v_lshlrev_b32 v236, 16, v3
    v_and_b32 v237, 0xffff0000, v3
    v_lshlrev_b32 v238, 16, v223
    v_and_b32 v239, 0xffff0000, v223
    v_mul_f32 v238, v238, v248
    v_mul_f32 v239, v239, v248
    v_cvt_pk_bf16_f32 v3, v238, v239
    v_lshlrev_b32 v238, 16, v3
    v_and_b32 v239, 0xffff0000, v3
    v_lshlrev_b32 v240, 16, v224
    v_and_b32 v241, 0xffff0000, v224
    v_mul_f32 v240, v240, v248
    v_mul_f32 v241, v241, v248
    v_cvt_pk_bf16_f32 v3, v240, v241
    v_lshlrev_b32 v240, 16, v3
    v_and_b32 v241, 0xffff0000, v3
    v_lshlrev_b32 v242, 16, v225
    v_and_b32 v243, 0xffff0000, v225
    v_mul_f32 v242, v242, v248
    v_mul_f32 v243, v243, v248
    v_cvt_pk_bf16_f32 v3, v242, v243
    v_lshlrev_b32 v242, 16, v3
    v_and_b32 v243, 0xffff0000, v3
    v_lshlrev_b32 v244, 16, v226
    v_and_b32 v245, 0xffff0000, v226
    v_mul_f32 v244, v244, v248
    v_mul_f32 v245, v245, v248
    v_cvt_pk_bf16_f32 v3, v244, v245
    v_lshlrev_b32 v244, 16, v3
    v_and_b32 v245, 0xffff0000, v3
    v_lshlrev_b32 v246, 16, v227
    v_and_b32 v247, 0xffff0000, v227
    v_mul_f32 v246, v246, v248
    v_mul_f32 v247, v247, v248
    v_cvt_pk_bf16_f32 v3, v246, v247
    v_lshlrev_b32 v246, 16, v3
    v_and_b32 v247, 0xffff0000, v3
    s_cmp_lg_u32 s3, 0
    s_cbranch_scc1 C_nh
    s_lshr_b32 s64, s2, 2
    s_lshl_b32 s64, s64, 14
    s_add_u32 s64, s64, 5398528
    v_lshl_add_u32 v16, v2, 4, s64
    v_lshrrev_b32 v8, 4, v2
    s_mov_b32 s65, 0
H_hl:
    s_mov_b32 s64, 0
    buffer_load_dwordx4 v[64:67], v16, s[16:19], s64 offen offset:0 sc1
    s_mov_b32 s64, 0
    buffer_load_dwordx4 v[68:71], v16, s[16:19], s64 offen offset:1024 sc1
    s_mov_b32 s64, 0
    buffer_load_dwordx4 v[72:75], v16, s[16:19], s64 offen offset:2048 sc1
    s_mov_b32 s64, 0
    buffer_load_dwordx4 v[76:79], v16, s[16:19], s64 offen offset:3072 sc1
    s_mov_b32 s64, 4096
    buffer_load_dwordx4 v[80:83], v16, s[16:19], s64 offen offset:0 sc1
    s_mov_b32 s64, 4096
    buffer_load_dwordx4 v[84:87], v16, s[16:19], s64 offen offset:1024 sc1
    s_mov_b32 s64, 4096
    buffer_load_dwordx4 v[88:91], v16, s[16:19], s64 offen offset:2048 sc1
    s_mov_b32 s64, 4096
    buffer_load_dwordx4 v[92:95], v16, s[16:19], s64 offen offset:3072 sc1
    s_mov_b32 s64, 8192
    buffer_load_dwordx4 v[96:99], v16, s[16:19], s64 offen offset:0 sc1
    s_mov_b32 s64, 8192
    buffer_load_dwordx4 v[100:103], v16, s[16:19], s64 offen offset:1024 sc1
    s_mov_b32 s64, 8192
    buffer_load_dwordx4 v[104:107], v16, s[16:19], s64 offen offset:2048 sc1
    s_mov_b32 s64, 8192
    buffer_load_dwordx4 v[108:111], v16, s[16:19], s64 offen offset:3072 sc1
    s_mov_b32 s64, 12288
    buffer_load_dwordx4 v[112:115], v16, s[16:19], s64 offen offset:0 sc1
    s_mov_b32 s64, 12288
    buffer_load_dwordx4 v[116:119], v16, s[16:19], s64 offen offset:1024 sc1
    s_mov_b32 s64, 12288
    buffer_load_dwordx4 v[120:123], v16, s[16:19], s64 offen offset:2048 sc1
    s_mov_b32 s64, 12288
    buffer_load_dwordx4 v[124:127], v16, s[16:19], s64 offen offset:3072 sc1
    s_waitcnt vmcnt(0)
    v_max3_u32 v17, v64, v65, v66
    v_max3_u32 v17, v67, v68, v17
    v_max3_u32 v17, v69, v70, v17
    v_max3_u32 v17, v71, v72, v17
    v_max3_u32 v17, v73, v74, v17
    v_max3_u32 v17, v75, v76, v17
    v_max3_u32 v17, v77, v78, v17
    v_max3_u32 v17, v79, v80, v17
    v_max3_u32 v17, v81, v82, v17
    v_max3_u32 v17, v83, v84, v17
    v_max3_u32 v17, v85, v86, v17
    v_max3_u32 v17, v87, v88, v17
    v_max3_u32 v17, v89, v90, v17
    v_max3_u32 v17, v91, v92, v17
    v_max3_u32 v17, v93, v94, v17
    v_max3_u32 v17, v95, v96, v17
    v_max3_u32 v17, v97, v98, v17
    v_max3_u32 v17, v99, v100, v17
    v_max3_u32 v17, v101, v102, v17
    v_max3_u32 v17, v103, v104, v17
    v_max3_u32 v17, v105, v106, v17
    v_max3_u32 v17, v107, v108, v17
    v_max3_u32 v17, v109, v110, v17
    v_max3_u32 v17, v111, v112, v17
    v_max3_u32 v17, v113, v114, v17
    v_max3_u32 v17, v115, v116, v17
    v_max3_u32 v17, v117, v118, v17
    v_max3_u32 v17, v119, v120, v17
    v_max3_u32 v17, v121, v122, v17
    v_max3_u32 v17, v123, v124, v17
    v_max3_u32 v17, v125, v126, v17
    v_max_u32 v17, v127, v17
    s_mov_b32 exec_lo, 0x3fff3fff
    s_mov_b32 exec_hi, 0x3fff3fff
    v_cmp_eq_u32 vcc, -1, v17
    s_mov_b64 exec, -1
    s_cbranch_vccz H_hok
    s_add_u32 s65, s65, 1
    s_cmp_ge_u32 s65, 100000
    s_cbranch_scc1 H_hok
    s_sleep 8
    s_branch H_hl
H_hok:
    v_add_f32 v64, v64, v68
    v_add_f32 v65, v65, v69
    v_add_f32 v66, v66, v70
    v_add_f32 v67, v67, v71
    v_add_f32 v64, v64, v72
    v_add_f32 v65, v65, v73
    v_add_f32 v66, v66, v74
    v_add_f32 v67, v67, v75
    v_add_f32 v64, v64, v76
    v_add_f32 v65, v65, v77
    v_add_f32 v66, v66, v78
    v_add_f32 v67, v67, v79
    v_add_f32 v64, v64, v80
    v_add_f32 v65, v65, v81
    v_add_f32 v66, v66, v82
    v_add_f32 v67, v67, v83
    v_add_f32 v64, v64, v84
    v_add_f32 v65, v65, v85
    v_add_f32 v66, v66, v86
    v_add_f32 v67, v67, v87
    v_add_f32 v64, v64, v88
    v_add_f32 v65, v65, v89
    v_add_f32 v66, v66, v90
    v_add_f32 v67, v67, v91
    v_add_f32 v64, v64, v92
    v_add_f32 v65, v65, v93
    v_add_f32 v66, v66, v94
    v_add_f32 v67, v67, v95
    v_add_f32 v96, v96, v100
    v_add_f32 v97, v97, v101
    v_add_f32 v98, v98, v102
    v_add_f32 v99, v99, v103
    v_add_f32 v96, v96, v104
    v_add_f32 v97, v97, v105
    v_add_f32 v98, v98, v106
    v_add_f32 v99, v99, v107
    v_add_f32 v96, v96, v108
    v_add_f32 v97, v97, v109
    v_add_f32 v98, v98, v110
    v_add_f32 v99, v99, v111
    v_add_f32 v96, v96, v112
    v_add_f32 v97, v97, v113
    v_add_f32 v98, v98, v114
    v_add_f32 v99, v99, v115
    v_add_f32 v96, v96, v116
    v_add_f32 v97, v97, v117
    v_add_f32 v98, v98, v118
    v_add_f32 v99, v99, v119
    v_add_f32 v96, v96, v120
    v_add_f32 v97, v97, v121
    v_add_f32 v98, v98, v122
    v_add_f32 v99, v99, v123
    v_add_f32 v96, v96, v124
    v_add_f32 v97, v97, v125
    v_add_f32 v98, v98, v126
    v_add_f32 v99, v99, v127
    s_nop 1
    v_permlane16_swap_b32 v64, v96
    v_permlane16_swap_b32 v65, v97
    v_permlane16_swap_b32 v66, v98
    v_permlane16_swap_b32 v67, v99
    v_add_f32 v64, v64, v96
    v_add_f32 v65, v65, v97
    v_add_f32 v66, v66, v98
    v_add_f32 v67, v67, v99
    s_nop 1
    v_permlane32_swap_b32 v64, v66
    v_permlane32_swap_b32 v65, v67
    v_add_f32 v64, v64, v66
    v_add_f32 v65, v65, v67
    s_nop 1
    v_permlane16_swap_b32 v64, v65
    v_cvt_pk_bf16_f32 v66, v64, v65
    v_lshlrev_b32 v64, 16, v66
    v_and_b32 v65, 0xffff0000, v66
    v_mul_f32 v66, s72, v64
    v_exp_f32 v66, -v66
    v_and_b32 v16, 15, v2
    v_add_f32 v66, 1.0, v66
    v_rcp_f32 v66, v66
    v_lshl_add_u32 v16, v16, 2, v8
    v_mul_f32 v66, v66, v64
    v_cvt_pk_bf16_f32 v66, v66, v66
    v_lshlrev_b32 v66, 16, v66
    v_mul_f32 v66, v66, v65
    v_cvt_pk_bf16_f32 v66, v66, v66
    v_lshlrev_b32 v66, 16, v66
    v_lshlrev_b32 v16, 2, v16
    ds_write_b32 v16, v66 offset:4352
    s_waitcnt lgkmcnt(0)
C_nh:
    v_lshlrev_b32 v3, 4, v2
    s_barrier
    ds_read_b128 v[24:27], v5 offset:4096
    ds_read_b128 v[16:19], v4 offset:0
    ds_read_b128 v[20:23], v4 offset:1024
    s_waitcnt lgkmcnt(2)
    v_mfma_f32_16x16x32_bf16 v[96:99], v[24:27], v[32:35], 0
    v_mfma_f32_16x16x32_bf16 v[100:103], v[24:27], v[36:39], 0
    v_mfma_f32_16x16x32_bf16 v[104:107], v[24:27], v[40:43], 0
    v_mfma_f32_16x16x32_bf16 v[108:111], v[24:27], v[44:47], 0
    s_waitcnt lgkmcnt(0)
    v_mfma_f32_16x16x32_bf16 v[64:67], v[16:19], v[32:35], 0
    v_mfma_f32_16x16x32_bf16 v[68:71], v[20:23], v[32:35], 0
    v_mfma_f32_16x16x32_bf16 v[72:75], v[16:19], v[36:39], 0
    v_mfma_f32_16x16x32_bf16 v[76:79], v[20:23], v[36:39], 0
    v_mfma_f32_16x16x32_bf16 v[80:83], v[16:19], v[40:43], 0
    v_mfma_f32_16x16x32_bf16 v[84:87], v[20:23], v[40:43], 0
    v_mfma_f32_16x16x32_bf16 v[88:91], v[16:19], v[44:47], 0
    v_mfma_f32_16x16x32_bf16 v[92:95], v[20:23], v[44:47], 0
    v_cvt_pk_bf16_f32 v48, v96, v96
    v_cvt_pk_bf16_f32 v49, v100, v100
    v_cvt_pk_bf16_f32 v50, v104, v104
    v_cvt_pk_bf16_f32 v51, v108, v108
    v_lshlrev_b32 v48, 16, v48
    v_lshlrev_b32 v49, 16, v49
    v_lshlrev_b32 v50, 16, v50
    v_lshlrev_b32 v51, 16, v51
    v_add_f32 v48, s73, v48
    v_add_f32 v49, s73, v49
    v_add_f32 v50, s73, v50
    v_add_f32 v51, s73, v51
    v_cvt_pk_bf16_f32 v48, v48, v48
    v_cvt_pk_bf16_f32 v49, v49, v49
    v_cvt_pk_bf16_f32 v50, v50, v50
    v_cvt_pk_bf16_f32 v51, v51, v51
    v_lshlrev_b32 v48, 16, v48
    v_lshlrev_b32 v49, 16, v49
    v_lshlrev_b32 v50, 16, v50
    v_lshlrev_b32 v51, 16, v51
    v_rcp_f32 v48, v48
    v_rcp_f32 v49, v49
    v_rcp_f32 v50, v50
    v_rcp_f32 v51, v51
    s_nop 0
    v_mul_f32 v64, v64, v48
    v_mul_f32 v65, v65, v48
    v_cvt_pk_bf16_f32 v128, v64, v65
    v_mul_f32 v66, v66, v48
    v_mul_f32 v67, v67, v48
    v_cvt_pk_bf16_f32 v129, v66, v67
    v_mul_f32 v68, v68, v48
    v_mul_f32 v69, v69, v48
    v_cvt_pk_bf16_f32 v130, v68, v69
    v_mul_f32 v70, v70, v48
    v_mul_f32 v71, v71, v48
    v_cvt_pk_bf16_f32 v131, v70, v71
    buffer_store_dwordx4 v[128:131], v1, s[16:19], s42 offen offset:0 sc0 sc1
    v_mul_f32 v72, v72, v49
    v_mul_f32 v73, v73, v49
    v_cvt_pk_bf16_f32 v132, v72, v73
    v_mul_f32 v74, v74, v49
    v_mul_f32 v75, v75, v49
    v_cvt_pk_bf16_f32 v133, v74, v75
    v_mul_f32 v76, v76, v49
    v_mul_f32 v77, v77, v49
    v_cvt_pk_bf16_f32 v134, v76, v77
    v_mul_f32 v78, v78, v49
    v_mul_f32 v79, v79, v49
    v_cvt_pk_bf16_f32 v135, v78, v79
    buffer_store_dwordx4 v[132:135], v1, s[16:19], s42 offen offset:1024 sc0 sc1
    s_add_u32 s42, s42, 65536
    v_mul_f32 v80, v80, v50
    v_mul_f32 v81, v81, v50
    v_cvt_pk_bf16_f32 v136, v80, v81
    v_mul_f32 v82, v82, v50
    v_mul_f32 v83, v83, v50
    v_cvt_pk_bf16_f32 v137, v82, v83
    v_mul_f32 v84, v84, v50
    v_mul_f32 v85, v85, v50
    v_cvt_pk_bf16_f32 v138, v84, v85
    v_mul_f32 v86, v86, v50
    v_mul_f32 v87, v87, v50
    v_cvt_pk_bf16_f32 v139, v86, v87
    buffer_store_dwordx4 v[136:139], v1, s[16:19], s42 offen offset:0 sc0 sc1
    v_mul_f32 v88, v88, v51
    v_mul_f32 v89, v89, v51
    v_cvt_pk_bf16_f32 v140, v88, v89
    v_mul_f32 v90, v90, v51
    v_mul_f32 v91, v91, v51
    v_cvt_pk_bf16_f32 v141, v90, v91
    v_mul_f32 v92, v92, v51
    v_mul_f32 v93, v93, v51
    v_cvt_pk_bf16_f32 v142, v92, v93
    v_mul_f32 v94, v94, v51
    v_mul_f32 v95, v95, v51
    v_cvt_pk_bf16_f32 v143, v94, v95
    buffer_store_dwordx4 v[140:143], v1, s[16:19], s42 offen offset:1024 sc0 sc1
    s_lshl_b32 s64, s4, 3
    s_add_u32 s64, s64, s3
    s_lshl_b32 s64, s64, 7
    s_add_u32 s64, s64, 5382144
    v_mov_b32 v14, s64
    s_mov_b64 exec, 1
    v_mov_b32 v15, 0
    buffer_atomic_or v15, v14, s[16:19], 0 offen sc0
    s_mov_b64 exec, -1
    s_waitcnt vmcnt(1)
    s_mov_b64 exec, 3
    buffer_atomic_or v13, v12, s[16:19], 0 offen
    s_mov_b64 exec, -1
P2_start:
    s_and_b32 s6, s3, 3
    s_lshr_b32 s7, s3, 2
    s_mov_b32 s20, s58
    s_mov_b32 s21, s59
    s_mov_b32 s22, 0x400000
    s_mov_b32 s23, 0x00020000
    s_and_b32 s67, s75, 0x7ff
    s_sub_u32 s67, 2047, s67
    s_lshl_b32 s64, s4, 2
    s_add_u32 s64, s64, s6
    s_lshl_b32 s64, s64, 16
    s_lshl_b32 s65, s7, 15
    s_add_u32 s64, s64, s65
    s_lshl_b32 s65, s7, 10
    s_add_u32 s66, s64, s65
    s_xor_b32 s64, s66, 1024
    v_lshlrev_b32 v12, 4, v2
    v_add_u32 v4, s66, v12
    v_add_u32 v12, s64, v12
    v_lshrrev_b32 v10, 4, v2
    v_bfe_u32 v11, v2, 2, 2
    v_lshl_add_u32 v10, v10, 2, v11
    v_bfe_u32 v13, v10, 1, 2
    v_lshlrev_b32 v10, 7, v10
    v_lshl_add_u32 v10, v13, 5, v10
    v_and_b32 v13, 3, v2
    v_lshl_add_u32 v5, v13, 3, v10
    v_xor_b32 v6, 32, v5
    v_xor_b32 v1, 64, v5
    v_xor_b32 v3, 96, v5
    s_and_b32 s74, s5, 7
    s_lshl_b32 s74, s74, 1
    s_cmp_eq_u32 s7, 0
    s_mov_b32 s64, 147456
    s_cselect_b32 s64, 131072, s64
    s_sub_u32 m0, 16, s74
    s_and_b32 m0, m0, 15
    v_writelane_b32 v7, s64, m0
    s_cmp_eq_u32 s7, 0
    s_mov_b32 s64, 155648
    s_cselect_b32 s64, 139264, s64
    s_sub_u32 m0, 18, s74
    s_and_b32 m0, m0, 15
    v_writelane_b32 v7, s64, m0
    s_cmp_eq_u32 s7, 0
    s_mov_b32 s64, 81920
    s_cselect_b32 s64, 73728, s64
    s_sub_u32 m0, 20, s74
    s_and_b32 m0, m0, 15
    v_writelane_b32 v7, s64, m0
    s_cmp_eq_u32 s7, 0
    s_mov_b32 s64, 122880
    s_cselect_b32 s64, 114688, s64
    s_sub_u32 m0, 22, s74
    s_and_b32 m0, m0, 15
    v_writelane_b32 v7, s64, m0
    s_cmp_eq_u32 s7, 0
    s_mov_b32 s64, 49152
    s_cselect_b32 s64, 40960, s64
    s_sub_u32 m0, 24, s74
    s_and_b32 m0, m0, 15
    v_writelane_b32 v7, s64, m0
    s_cmp_eq_u32 s7, 0
    s_mov_b32 s64, 57344
    s_cselect_b32 s64, 8192, s64
    s_sub_u32 m0, 26, s74
    s_and_b32 m0, m0, 15
    v_writelane_b32 v7, s64, m0
    s_cmp_eq_u32 s7, 0
    s_mov_b32 s64, 65536
    s_cselect_b32 s64, 16384, s64
    s_sub_u32 m0, 28, s74
    s_and_b32 m0, m0, 15
    v_writelane_b32 v7, s64, m0
    s_cmp_eq_u32 s7, 0
    s_mov_b32 s64, 90112
    s_cselect_b32 s64, 98304, s64
    s_sub_u32 m0, 30, s74
    s_and_b32 m0, m0, 15
    v_writelane_b32 v7, s64, m0
    s_cmp_eq_u32 s7, 0
    v_mov_b32 v16, 0
    v_mov_b32 v17, 0
    v_mov_b32 v18, 0
    v_mov_b32 v19, 0
    v_mov_b32 v20, 0
    v_mov_b32 v21, 0
    v_mov_b32 v22, 0
    v_mov_b32 v23, 0
    v_mov_b32 v24, 0
    v_mov_b32 v25, 0
    v_mov_b32 v26, 0
    v_mov_b32 v27, 0
    v_mov_b32 v28, 0
    v_mov_b32 v29, 0
    v_mov_b32 v30, 0
    v_mov_b32 v31, 0
    v_mov_b32 v32, 0
    v_mov_b32 v33, 0
    v_mov_b32 v34, 0
    v_mov_b32 v35, 0
    v_mov_b32 v36, 0
    v_mov_b32 v37, 0
    v_mov_b32 v38, 0
    v_mov_b32 v39, 0
    v_mov_b32 v40, 0
    v_mov_b32 v41, 0
    v_mov_b32 v42, 0
    v_mov_b32 v43, 0
    v_mov_b32 v44, 0
    v_mov_b32 v45, 0
    v_mov_b32 v46, 0
    v_mov_b32 v47, 0
    v_mov_b32 v209, 0
    v_mov_b32 v215, 0
    s_lshr_b32 s46, s67, 7
    s_xor_b32 s46, s46, s4
    s_or_b32 s46, s46, s7
    s_mov_b32 s47, 0
    s_cbranch_scc0 P2_ys
P2_ysd:
    s_mov_b32 s66, 0x5555
    s_mov_b32 s65, 0
    s_cmp_lt_u32 s3, 4
    s_cbranch_scc0 D_wait
    s_waitcnt vmcnt(1)
    s_branch D_got
D_wait:
    s_waitcnt vmcnt(0)
D_got:
    v_readfirstlane_b32 s68, v15
    s_mul_i32 s68, s68, 0x10001
    s_lshr_b32 s68, s68, s74
    s_lshr_b32 s64, s68, 1
    s_and_b32 s68, s68, s64
    s_and_b32 s68, s68, s66
    s_cbranch_scc1 D_go
    s_add_u32 s65, s65, 1
    s_cmp_ge_u32 s65, 40000
    s_cbranch_scc1 D_end
    s_sleep 1
    s_mov_b64 exec, 1
    v_mov_b32 v15, 0
    buffer_atomic_or v15, v14, s[16:19], 0 offen sc0
    s_mov_b64 exec, -1
    s_branch D_wait
D_go:
    s_andn2_b32 s66, s66, s68
    s_bcnt1_i32_b32 s70, s68
    s_or_b32 s64, s46, s66
    s_cbranch_scc0 P2_yl
P2_nyl:
    s_cmp_gt_u32 s70, 4
    s_cbranch_scc1 D_t58
    s_cmp_gt_u32 s70, 2
    s_cbranch_scc1 D_t34
    s_cmp_eq_u32 s70, 2
    s_cbranch_scc1 D_e2
D_e1:
    s_ff1_i32_b32 s64, s68
    s_bitset0_b32 s68, s64
    v_readlane_b32 s32, v7, s64
    s_add_u32 s69, s64, s74
    s_and_b32 s69, s69, 15
    s_lshl_b32 s69, s69, 11
    buffer_load_dwordx4 v[80:83], v4, s[16:19], s69 offen sc1
    buffer_load_dwordx4 v[84:87], v12, s[16:19], s69 offen sc1
    s_add_u32 s69, s69, 2048
    buffer_load_dwordx4 v[88:91], v4, s[16:19], s69 offen sc1
    buffer_load_dwordx4 v[92:95], v12, s[16:19], s69 offen sc1
    s_mov_b64 exec, 1
    v_mov_b32 v15, 0
    buffer_atomic_or v15, v14, s[16:19], 0 offen sc0
    s_mov_b64 exec, -1
    v_add_u32 v8, s32, v5
    ds_read_b64_tr_b16 v[48:49], v8 offset:0
    ds_read_b64_tr_b16 v[50:51], v8 offset:2048
    v_add_u32 v9, s32, v6
    ds_read_b64_tr_b16 v[52:53], v9 offset:0
    ds_read_b64_tr_b16 v[54:55], v9 offset:2048
    v_add_u32 v10, s32, v1
    ds_read_b64_tr_b16 v[56:57], v10 offset:0
    ds_read_b64_tr_b16 v[58:59], v10 offset:2048
    v_add_u32 v11, s32, v3
    ds_read_b64_tr_b16 v[60:61], v11 offset:0
    ds_read_b64_tr_b16 v[62:63], v11 offset:2048
    s_branch D_p0
D_e2:
    s_ff1_i32_b32 s64, s68
    s_bitset0_b32 s68, s64
    v_readlane_b32 s33, v7, s64
    s_add_u32 s69, s64, s74
    s_and_b32 s69, s69, 15
    s_lshl_b32 s69, s69, 11
    buffer_load_dwordx4 v[96:99], v4, s[16:19], s69 offen sc1
    buffer_load_dwordx4 v[100:103], v12, s[16:19], s69 offen sc1
    s_add_u32 s69, s69, 2048
    buffer_load_dwordx4 v[104:107], v4, s[16:19], s69 offen sc1
    buffer_load_dwordx4 v[108:111], v12, s[16:19], s69 offen sc1
    s_ff1_i32_b32 s64, s68
    s_bitset0_b32 s68, s64
    v_readlane_b32 s32, v7, s64
    s_add_u32 s69, s64, s74
    s_and_b32 s69, s69, 15
    s_lshl_b32 s69, s69, 11
    buffer_load_dwordx4 v[80:83], v4, s[16:19], s69 offen sc1
    buffer_load_dwordx4 v[84:87], v12, s[16:19], s69 offen sc1
    s_add_u32 s69, s69, 2048
    buffer_load_dwordx4 v[88:91], v4, s[16:19], s69 offen sc1
    buffer_load_dwordx4 v[92:95], v12, s[16:19], s69 offen sc1
    s_mov_b64 exec, 1
    v_mov_b32 v15, 0
    buffer_atomic_or v15, v14, s[16:19], 0 offen sc0
    s_mov_b64 exec, -1
    v_add_u32 v8, s33, v5
    ds_read_b64_tr_b16 v[48:49], v8 offset:0
    ds_read_b64_tr_b16 v[50:51], v8 offset:2048
    v_add_u32 v9, s33, v6
    ds_read_b64_tr_b16 v[52:53], v9 offset:0
    ds_read_b64_tr_b16 v[54:55], v9 offset:2048
    v_add_u32 v10, s33, v1
    ds_read_b64_tr_b16 v[56:57], v10 offset:0
    ds_read_b64_tr_b16 v[58:59], v10 offset:2048
    v_add_u32 v11, s33, v3
    ds_read_b64_tr_b16 v[60:61], v11 offset:0
    ds_read_b64_tr_b16 v[62:63], v11 offset:2048
    s_branch D_p1
D_t34:
    s_cmp_eq_u32 s70, 4
    s_cbranch_scc1 D_e4
D_e3:
    s_ff1_i32_b32 s64, s68
    s_bitset0_b32 s68, s64
    v_readlane_b32 s34, v7, s64
    s_add_u32 s69, s64, s74
    s_and_b32 s69, s69, 15
    s_lshl_b32 s69, s69, 11
    buffer_load_dwordx4 v[112:115], v4, s[16:19], s69 offen sc1
    buffer_load_dwordx4 v[116:119], v12, s[16:19], s69 offen sc1
    s_add_u32 s69, s69, 2048
    buffer_load_dwordx4 v[120:123], v4, s[16:19], s69 offen sc1
    buffer_load_dwordx4 v[124:127], v12, s[16:19], s69 offen sc1
    s_ff1_i32_b32 s64, s68
    s_bitset0_b32 s68, s64
    v_readlane_b32 s33, v7, s64
    s_add_u32 s69, s64, s74
    s_and_b32 s69, s69, 15
    s_lshl_b32 s69, s69, 11
    buffer_load_dwordx4 v[96:99], v4, s[16:19], s69 offen sc1
    buffer_load_dwordx4 v[100:103], v12, s[16:19], s69 offen sc1
    s_add_u32 s69, s69, 2048
    buffer_load_dwordx4 v[104:107], v4, s[16:19], s69 offen sc1
    buffer_load_dwordx4 v[108:111], v12, s[16:19], s69 offen sc1
    v_add_u32 v8, s34, v5
    ds_read_b64_tr_b16 v[48:49], v8 offset:0
    ds_read_b64_tr_b16 v[50:51], v8 offset:2048
    v_add_u32 v9, s34, v6
    ds_read_b64_tr_b16 v[52:53], v9 offset:0
    ds_read_b64_tr_b16 v[54:55], v9 offset:2048
    v_add_u32 v10, s34, v1
    ds_read_b64_tr_b16 v[56:57], v10 offset:0
    ds_read_b64_tr_b16 v[58:59], v10 offset:2048
    v_add_u32 v11, s34, v3
    ds_read_b64_tr_b16 v[60:61], v11 offset:0
    ds_read_b64_tr_b16 v[62:63], v11 offset:2048
    s_branch D_p2
D_e4:
    s_ff1_i32_b32 s64, s68
    s_bitset0_b32 s68, s64
    v_readlane_b32 s35, v7, s64
    s_add_u32 s69, s64, s74
    s_and_b32 s69, s69, 15
    s_lshl_b32 s69, s69, 11
    buffer_load_dwordx4 v[128:131], v4, s[16:19], s69 offen sc1
    buffer_load_dwordx4 v[132:135], v12, s[16:19], s69 offen sc1
    s_add_u32 s69, s69, 2048
    buffer_load_dwordx4 v[136:139], v4, s[16:19], s69 offen sc1
    buffer_load_dwordx4 v[140:143], v12, s[16:19], s69 offen sc1
    s_ff1_i32_b32 s64, s68
    s_bitset0_b32 s68, s64
    v_readlane_b32 s34, v7, s64
    s_add_u32 s69, s64, s74
    s_and_b32 s69, s69, 15
    s_lshl_b32 s69, s69, 11
    buffer_load_dwordx4 v[112:115], v4, s[16:19], s69 offen sc1
    buffer_load_dwordx4 v[116:119], v12, s[16:19], s69 offen sc1
    s_add_u32 s69, s69, 2048
    buffer_load_dwordx4 v[120:123], v4, s[16:19], s69 offen sc1
    buffer_load_dwordx4 v[124:127], v12, s[16:19], s69 offen sc1
    v_add_u32 v8, s35, v5
    ds_read_b64_tr_b16 v[48:49], v8 offset:0
    ds_read_b64_tr_b16 v[50:51], v8 offset:2048
    v_add_u32 v9, s35, v6
    ds_read_b64_tr_b16 v[52:53], v9 offset:0
    ds_read_b64_tr_b16 v[54:55], v9 offset:2048
    v_add_u32 v10, s35, v1
    ds_read_b64_tr_b16 v[56:57], v10 offset:0
    ds_read_b64_tr_b16 v[58:59], v10 offset:2048
    v_add_u32 v11, s35, v3
    ds_read_b64_tr_b16 v[60:61], v11 offset:0
    ds_read_b64_tr_b16 v[62:63], v11 offset:2048
    s_branch D_p3
D_t58:
    s_cmp_gt_u32 s70, 6
    s_cbranch_scc1 D_t78
    s_cmp_eq_u32 s70, 6
    s_cbranch_scc1 D_e6
D_e5:
    s_ff1_i32_b32 s64, s68
    s_bitset0_b32 s68, s64
    v_readlane_b32 s36, v7, s64
    s_add_u32 s69, s64, s74
    s_and_b32 s69, s69, 15
    s_lshl_b32 s69, s69, 11
    buffer_load_dwordx4 v[144:147], v4, s[16:19], s69 offen sc1
    buffer_load_dwordx4 v[148:151], v12, s[16:19], s69 offen sc1
    s_add_u32 s69, s69, 2048
    buffer_load_dwordx4 v[152:155], v4, s[16:19], s69 offen sc1
    buffer_load_dwordx4 v[156:159], v12, s[16:19], s69 offen sc1
    s_ff1_i32_b32 s64, s68
    s_bitset0_b32 s68, s64
    v_readlane_b32 s35, v7, s64
    s_add_u32 s69, s64, s74
    s_and_b32 s69, s69, 15
    s_lshl_b32 s69, s69, 11
    buffer_load_dwordx4 v[128:131], v4, s[16:19], s69 offen sc1
    buffer_load_dwordx4 v[132:135], v12, s[16:19], s69 offen sc1
    s_add_u32 s69, s69, 2048
    buffer_load_dwordx4 v[136:139], v4, s[16:19], s69 offen sc1
    buffer_load_dwordx4 v[140:143], v12, s[16:19], s69 offen sc1
    v_add_u32 v8, s36, v5
    ds_read_b64_tr_b16 v[48:49], v8 offset:0
    ds_read_b64_tr_b16 v[50:51], v8 offset:2048
    v_add_u32 v9, s36, v6
    ds_read_b64_tr_b16 v[52:53], v9 offset:0
    ds_read_b64_tr_b16 v[54:55], v9 offset:2048
    v_add_u32 v10, s36, v1
    ds_read_b64_tr_b16 v[56:57], v10 offset:0
    ds_read_b64_tr_b16 v[58:59], v10 offset:2048
    v_add_u32 v11, s36, v3
    ds_read_b64_tr_b16 v[60:61], v11 offset:0
    ds_read_b64_tr_b16 v[62:63], v11 offset:2048
    s_branch D_p4
D_e6:
    s_ff1_i32_b32 s64, s68
    s_bitset0_b32 s68, s64
    v_readlane_b32 s37, v7, s64
    s_add_u32 s69, s64, s74
    s_and_b32 s69, s69, 15
    s_lshl_b32 s69, s69, 11
    buffer_load_dwordx4 v[160:163], v4, s[16:19], s69 offen sc1
    buffer_load_dwordx4 v[164:167], v12, s[16:19], s69 offen sc1
    s_add_u32 s69, s69, 2048
    buffer_load_dwordx4 v[168:171], v4, s[16:19], s69 offen sc1
    buffer_load_dwordx4 v[172:175], v12, s[16:19], s69 offen sc1
    s_ff1_i32_b32 s64, s68
    s_bitset0_b32 s68, s64
    v_readlane_b32 s36, v7, s64
    s_add_u32 s69, s64, s74
    s_and_b32 s69, s69, 15
    s_lshl_b32 s69, s69, 11
    buffer_load_dwordx4 v[144:147], v4, s[16:19], s69 offen sc1
    buffer_load_dwordx4 v[148:151], v12, s[16:19], s69 offen sc1
    s_add_u32 s69, s69, 2048
    buffer_load_dwordx4 v[152:155], v4, s[16:19], s69 offen sc1
    buffer_load_dwordx4 v[156:159], v12, s[16:19], s69 offen sc1
    v_add_u32 v8, s37, v5
    ds_read_b64_tr_b16 v[48:49], v8 offset:0
    ds_read_b64_tr_b16 v[50:51], v8 offset:2048
    v_add_u32 v9, s37, v6
    ds_read_b64_tr_b16 v[52:53], v9 offset:0
    ds_read_b64_tr_b16 v[54:55], v9 offset:2048
    v_add_u32 v10, s37, v1
    ds_read_b64_tr_b16 v[56:57], v10 offset:0
    ds_read_b64_tr_b16 v[58:59], v10 offset:2048
    v_add_u32 v11, s37, v3
    ds_read_b64_tr_b16 v[60:61], v11 offset:0
    ds_read_b64_tr_b16 v[62:63], v11 offset:2048
    s_branch D_p5
D_t78:
    s_cmp_eq_u32 s70, 8
    s_cbranch_scc1 D_e8
D_e7:
    s_ff1_i32_b32 s64, s68
    s_bitset0_b32 s68, s64
    v_readlane_b32 s38, v7, s64
    s_add_u32 s69, s64, s74
    s_and_b32 s69, s69, 15
    s_lshl_b32 s69, s69, 11
    buffer_load_dwordx4 v[176:179], v4, s[16:19], s69 offen sc1
    buffer_load_dwordx4 v[180:183], v12, s[16:19], s69 offen sc1
    s_add_u32 s69, s69, 2048
    buffer_load_dwordx4 v[184:187], v4, s[16:19], s69 offen sc1
    buffer_load_dwordx4 v[188:191], v12, s[16:19], s69 offen sc1
    s_ff1_i32_b32 s64, s68
    s_bitset0_b32 s68, s64
    v_readlane_b32 s37, v7, s64
    s_add_u32 s69, s64, s74
    s_and_b32 s69, s69, 15
    s_lshl_b32 s69, s69, 11
    buffer_load_dwordx4 v[160:163], v4, s[16:19], s69 offen sc1
    buffer_load_dwordx4 v[164:167], v12, s[16:19], s69 offen sc1
    s_add_u32 s69, s69, 2048
    buffer_load_dwordx4 v[168:171], v4, s[16:19], s69 offen sc1
    buffer_load_dwordx4 v[172:175], v12, s[16:19], s69 offen sc1
    v_add_u32 v8, s38, v5
    ds_read_b64_tr_b16 v[48:49], v8 offset:0
    ds_read_b64_tr_b16 v[50:51], v8 offset:2048
    v_add_u32 v9, s38, v6
    ds_read_b64_tr_b16 v[52:53], v9 offset:0
    ds_read_b64_tr_b16 v[54:55], v9 offset:2048
    v_add_u32 v10, s38, v1
    ds_read_b64_tr_b16 v[56:57], v10 offset:0
    ds_read_b64_tr_b16 v[58:59], v10 offset:2048
    v_add_u32 v11, s38, v3
    ds_read_b64_tr_b16 v[60:61], v11 offset:0
    ds_read_b64_tr_b16 v[62:63], v11 offset:2048
    s_branch D_p6
D_e8:
    s_ff1_i32_b32 s64, s68
    s_bitset0_b32 s68, s64
    v_readlane_b32 s39, v7, s64
    s_add_u32 s69, s64, s74
    s_and_b32 s69, s69, 15
    s_lshl_b32 s69, s69, 11
    buffer_load_dwordx4 v[192:195], v4, s[16:19], s69 offen sc1
    buffer_load_dwordx4 v[196:199], v12, s[16:19], s69 offen sc1
    s_add_u32 s69, s69, 2048
    buffer_load_dwordx4 v[200:203], v4, s[16:19], s69 offen sc1
    buffer_load_dwordx4 v[204:207], v12, s[16:19], s69 offen sc1
    s_ff1_i32_b32 s64, s68
    s_bitset0_b32 s68, s64
    v_readlane_b32 s38, v7, s64
    s_add_u32 s69, s64, s74
    s_and_b32 s69, s69, 15
    s_lshl_b32 s69, s69, 11
    buffer_load_dwordx4 v[176:179], v4, s[16:19], s69 offen sc1
    buffer_load_dwordx4 v[180:183], v12, s[16:19], s69 offen sc1
    s_add_u32 s69, s69, 2048
    buffer_load_dwordx4 v[184:187], v4, s[16:19], s69 offen sc1
    buffer_load_dwordx4 v[188:191], v12, s[16:19], s69 offen sc1
    v_add_u32 v8, s39, v5
    ds_read_b64_tr_b16 v[48:49], v8 offset:0
    ds_read_b64_tr_b16 v[50:51], v8 offset:2048
    v_add_u32 v9, s39, v6
    ds_read_b64_tr_b16 v[52:53], v9 offset:0
    ds_read_b64_tr_b16 v[54:55], v9 offset:2048
    v_add_u32 v10, s39, v1
    ds_read_b64_tr_b16 v[56:57], v10 offset:0
    ds_read_b64_tr_b16 v[58:59], v10 offset:2048
    v_add_u32 v11, s39, v3
    ds_read_b64_tr_b16 v[60:61], v11 offset:0
    ds_read_b64_tr_b16 v[62:63], v11 offset:2048
D_p7:
    s_waitcnt vmcnt(4) lgkmcnt(0)
    v_mfma_f32_16x16x32_bf16 v[16:19], v[48:51], v[192:195], v[16:19]
    ds_read_b64_tr_b16 v[64:65], v8 offset:4096
    ds_read_b64_tr_b16 v[66:67], v8 offset:6144
    v_mfma_f32_16x16x32_bf16 v[32:35], v[48:51], v[196:199], v[32:35]
    ds_read_b64_tr_b16 v[68:69], v9 offset:4096
    ds_read_b64_tr_b16 v[70:71], v9 offset:6144
    v_mfma_f32_16x16x32_bf16 v[20:23], v[52:55], v[192:195], v[20:23]
    ds_read_b64_tr_b16 v[72:73], v10 offset:4096
    ds_read_b64_tr_b16 v[74:75], v10 offset:6144
    v_mfma_f32_16x16x32_bf16 v[36:39], v[52:55], v[196:199], v[36:39]
    ds_read_b64_tr_b16 v[76:77], v11 offset:4096
    ds_read_b64_tr_b16 v[78:79], v11 offset:6144
    s_ff1_i32_b32 s64, s68
    s_bitset0_b32 s68, s64
    v_readlane_b32 s37, v7, s64
    s_add_u32 s69, s64, s74
    s_and_b32 s69, s69, 15
    s_lshl_b32 s69, s69, 11
    buffer_load_dwordx4 v[160:163], v4, s[16:19], s69 offen sc1
    v_mfma_f32_16x16x32_bf16 v[24:27], v[56:59], v[192:195], v[24:27]
    v_mfma_f32_16x16x32_bf16 v[40:43], v[56:59], v[196:199], v[40:43]
    v_mfma_f32_16x16x32_bf16 v[28:31], v[60:63], v[192:195], v[28:31]
    buffer_load_dwordx4 v[164:167], v12, s[16:19], s69 offen sc1
    v_mfma_f32_16x16x32_bf16 v[44:47], v[60:63], v[196:199], v[44:47]
    s_waitcnt lgkmcnt(0)
    v_mfma_f32_16x16x32_bf16 v[16:19], v[64:67], v[200:203], v[16:19]
    v_add_u32 v8, s38, v5
    ds_read_b64_tr_b16 v[48:49], v8 offset:0
    v_mfma_f32_16x16x32_bf16 v[32:35], v[64:67], v[204:207], v[32:35]
    ds_read_b64_tr_b16 v[50:51], v8 offset:2048
    v_add_u32 v9, s38, v6
    v_mfma_f32_16x16x32_bf16 v[20:23], v[68:71], v[200:203], v[20:23]
    ds_read_b64_tr_b16 v[52:53], v9 offset:0
    ds_read_b64_tr_b16 v[54:55], v9 offset:2048
    v_mfma_f32_16x16x32_bf16 v[36:39], v[68:71], v[204:207], v[36:39]
    v_add_u32 v10, s38, v1
    ds_read_b64_tr_b16 v[56:57], v10 offset:0
    s_add_u32 s69, s69, 2048
    buffer_load_dwordx4 v[168:171], v4, s[16:19], s69 offen sc1
    v_mfma_f32_16x16x32_bf16 v[24:27], v[72:75], v[200:203], v[24:27]
    ds_read_b64_tr_b16 v[58:59], v10 offset:2048
    v_add_u32 v11, s38, v3
    v_mfma_f32_16x16x32_bf16 v[40:43], v[72:75], v[204:207], v[40:43]
    ds_read_b64_tr_b16 v[60:61], v11 offset:0
    ds_read_b64_tr_b16 v[62:63], v11 offset:2048
    v_mfma_f32_16x16x32_bf16 v[28:31], v[76:79], v[200:203], v[28:31]
    buffer_load_dwordx4 v[172:175], v12, s[16:19], s69 offen sc1
    v_mfma_f32_16x16x32_bf16 v[44:47], v[76:79], v[204:207], v[44:47]
D_p6:
    s_waitcnt vmcnt(4) lgkmcnt(0)
    v_mfma_f32_16x16x32_bf16 v[16:19], v[48:51], v[176:179], v[16:19]
    ds_read_b64_tr_b16 v[64:65], v8 offset:4096
    ds_read_b64_tr_b16 v[66:67], v8 offset:6144
    v_mfma_f32_16x16x32_bf16 v[32:35], v[48:51], v[180:183], v[32:35]
    ds_read_b64_tr_b16 v[68:69], v9 offset:4096
    ds_read_b64_tr_b16 v[70:71], v9 offset:6144
    v_mfma_f32_16x16x32_bf16 v[20:23], v[52:55], v[176:179], v[20:23]
    ds_read_b64_tr_b16 v[72:73], v10 offset:4096
    ds_read_b64_tr_b16 v[74:75], v10 offset:6144
    v_mfma_f32_16x16x32_bf16 v[36:39], v[52:55], v[180:183], v[36:39]
    ds_read_b64_tr_b16 v[76:77], v11 offset:4096
    ds_read_b64_tr_b16 v[78:79], v11 offset:6144
    s_ff1_i32_b32 s64, s68
    s_bitset0_b32 s68, s64
    v_readlane_b32 s36, v7, s64
    s_add_u32 s69, s64, s74
    s_and_b32 s69, s69, 15
    s_lshl_b32 s69, s69, 11
    buffer_load_dwordx4 v[144:147], v4, s[16:19], s69 offen sc1
    v_mfma_f32_16x16x32_bf16 v[24:27], v[56:59], v[176:179], v[24:27]
    v_mfma_f32_16x16x32_bf16 v[40:43], v[56:59], v[180:183], v[40:43]
    v_mfma_f32_16x16x32_bf16 v[28:31], v[60:63], v[176:179], v[28:31]
    buffer_load_dwordx4 v[148:151], v12, s[16:19], s69 offen sc1
    v_mfma_f32_16x16x32_bf16 v[44:47], v[60:63], v[180:183], v[44:47]
    s_waitcnt lgkmcnt(0)
    v_mfma_f32_16x16x32_bf16 v[16:19], v[64:67], v[184:187], v[16:19]
    v_add_u32 v8, s37, v5
    ds_read_b64_tr_b16 v[48:49], v8 offset:0
    v_mfma_f32_16x16x32_bf16 v[32:35], v[64:67], v[188:191], v[32:35]
    ds_read_b64_tr_b16 v[50:51], v8 offset:2048
    v_add_u32 v9, s37, v6
    v_mfma_f32_16x16x32_bf16 v[20:23], v[68:71], v[184:187], v[20:23]
    ds_read_b64_tr_b16 v[52:53], v9 offset:0
    ds_read_b64_tr_b16 v[54:55], v9 offset:2048
    v_mfma_f32_16x16x32_bf16 v[36:39], v[68:71], v[188:191], v[36:39]
    v_add_u32 v10, s37, v1
    ds_read_b64_tr_b16 v[56:57], v10 offset:0
    s_add_u32 s69, s69, 2048
    buffer_load_dwordx4 v[152:155], v4, s[16:19], s69 offen sc1
    v_mfma_f32_16x16x32_bf16 v[24:27], v[72:75], v[184:187], v[24:27]
    ds_read_b64_tr_b16 v[58:59], v10 offset:2048
    v_add_u32 v11, s37, v3
    v_mfma_f32_16x16x32_bf16 v[40:43], v[72:75], v[188:191], v[40:43]
    ds_read_b64_tr_b16 v[60:61], v11 offset:0
    ds_read_b64_tr_b16 v[62:63], v11 offset:2048
    v_mfma_f32_16x16x32_bf16 v[28:31], v[76:79], v[184:187], v[28:31]
    buffer_load_dwordx4 v[156:159], v12, s[16:19], s69 offen sc1
    v_mfma_f32_16x16x32_bf16 v[44:47], v[76:79], v[188:191], v[44:47]
D_p5:
    s_waitcnt vmcnt(4) lgkmcnt(0)
    v_mfma_f32_16x16x32_bf16 v[16:19], v[48:51], v[160:163], v[16:19]
    ds_read_b64_tr_b16 v[64:65], v8 offset:4096
    ds_read_b64_tr_b16 v[66:67], v8 offset:6144
    v_mfma_f32_16x16x32_bf16 v[32:35], v[48:51], v[164:167], v[32:35]
    ds_read_b64_tr_b16 v[68:69], v9 offset:4096
    ds_read_b64_tr_b16 v[70:71], v9 offset:6144
    v_mfma_f32_16x16x32_bf16 v[20:23], v[52:55], v[160:163], v[20:23]
    ds_read_b64_tr_b16 v[72:73], v10 offset:4096
    ds_read_b64_tr_b16 v[74:75], v10 offset:6144
    v_mfma_f32_16x16x32_bf16 v[36:39], v[52:55], v[164:167], v[36:39]
    ds_read_b64_tr_b16 v[76:77], v11 offset:4096
    ds_read_b64_tr_b16 v[78:79], v11 offset:6144
    s_ff1_i32_b32 s64, s68
    s_bitset0_b32 s68, s64
    v_readlane_b32 s35, v7, s64
    s_add_u32 s69, s64, s74
    s_and_b32 s69, s69, 15
    s_lshl_b32 s69, s69, 11
    buffer_load_dwordx4 v[128:131], v4, s[16:19], s69 offen sc1
    v_mfma_f32_16x16x32_bf16 v[24:27], v[56:59], v[160:163], v[24:27]
    v_mfma_f32_16x16x32_bf16 v[40:43], v[56:59], v[164:167], v[40:43]
    v_mfma_f32_16x16x32_bf16 v[28:31], v[60:63], v[160:163], v[28:31]
    buffer_load_dwordx4 v[132:135], v12, s[16:19], s69 offen sc1
    v_mfma_f32_16x16x32_bf16 v[44:47], v[60:63], v[164:167], v[44:47]
    s_waitcnt lgkmcnt(0)
    v_mfma_f32_16x16x32_bf16 v[16:19], v[64:67], v[168:171], v[16:19]
    v_add_u32 v8, s36, v5
    ds_read_b64_tr_b16 v[48:49], v8 offset:0
    v_mfma_f32_16x16x32_bf16 v[32:35], v[64:67], v[172:175], v[32:35]
    ds_read_b64_tr_b16 v[50:51], v8 offset:2048
    v_add_u32 v9, s36, v6
    v_mfma_f32_16x16x32_bf16 v[20:23], v[68:71], v[168:171], v[20:23]
    ds_read_b64_tr_b16 v[52:53], v9 offset:0
    ds_read_b64_tr_b16 v[54:55], v9 offset:2048
    v_mfma_f32_16x16x32_bf16 v[36:39], v[68:71], v[172:175], v[36:39]
    v_add_u32 v10, s36, v1
    ds_read_b64_tr_b16 v[56:57], v10 offset:0
    s_add_u32 s69, s69, 2048
    buffer_load_dwordx4 v[136:139], v4, s[16:19], s69 offen sc1
    v_mfma_f32_16x16x32_bf16 v[24:27], v[72:75], v[168:171], v[24:27]
    ds_read_b64_tr_b16 v[58:59], v10 offset:2048
    v_add_u32 v11, s36, v3
    v_mfma_f32_16x16x32_bf16 v[40:43], v[72:75], v[172:175], v[40:43]
    ds_read_b64_tr_b16 v[60:61], v11 offset:0
    ds_read_b64_tr_b16 v[62:63], v11 offset:2048
    v_mfma_f32_16x16x32_bf16 v[28:31], v[76:79], v[168:171], v[28:31]
    buffer_load_dwordx4 v[140:143], v12, s[16:19], s69 offen sc1
    v_mfma_f32_16x16x32_bf16 v[44:47], v[76:79], v[172:175], v[44:47]
D_p4:
    s_waitcnt vmcnt(4) lgkmcnt(0)
    v_mfma_f32_16x16x32_bf16 v[16:19], v[48:51], v[144:147], v[16:19]
    ds_read_b64_tr_b16 v[64:65], v8 offset:4096
    ds_read_b64_tr_b16 v[66:67], v8 offset:6144
    v_mfma_f32_16x16x32_bf16 v[32:35], v[48:51], v[148:151], v[32:35]
    ds_read_b64_tr_b16 v[68:69], v9 offset:4096
    ds_read_b64_tr_b16 v[70:71], v9 offset:6144
    v_mfma_f32_16x16x32_bf16 v[20:23], v[52:55], v[144:147], v[20:23]
    ds_read_b64_tr_b16 v[72:73], v10 offset:4096
    ds_read_b64_tr_b16 v[74:75], v10 offset:6144
    v_mfma_f32_16x16x32_bf16 v[36:39], v[52:55], v[148:151], v[36:39]
    ds_read_b64_tr_b16 v[76:77], v11 offset:4096
    ds_read_b64_tr_b16 v[78:79], v11 offset:6144
    s_ff1_i32_b32 s64, s68
    s_bitset0_b32 s68, s64
    v_readlane_b32 s34, v7, s64
    s_add_u32 s69, s64, s74
    s_and_b32 s69, s69, 15
    s_lshl_b32 s69, s69, 11
    buffer_load_dwordx4 v[112:115], v4, s[16:19], s69 offen sc1
    v_mfma_f32_16x16x32_bf16 v[24:27], v[56:59], v[144:147], v[24:27]
    v_mfma_f32_16x16x32_bf16 v[40:43], v[56:59], v[148:151], v[40:43]
    v_mfma_f32_16x16x32_bf16 v[28:31], v[60:63], v[144:147], v[28:31]
    buffer_load_dwordx4 v[116:119], v12, s[16:19], s69 offen sc1
    v_mfma_f32_16x16x32_bf16 v[44:47], v[60:63], v[148:151], v[44:47]
    s_waitcnt lgkmcnt(0)
    v_mfma_f32_16x16x32_bf16 v[16:19], v[64:67], v[152:155], v[16:19]
    v_add_u32 v8, s35, v5
    ds_read_b64_tr_b16 v[48:49], v8 offset:0
    v_mfma_f32_16x16x32_bf16 v[32:35], v[64:67], v[156:159], v[32:35]
    ds_read_b64_tr_b16 v[50:51], v8 offset:2048
    v_add_u32 v9, s35, v6
    v_mfma_f32_16x16x32_bf16 v[20:23], v[68:71], v[152:155], v[20:23]
    ds_read_b64_tr_b16 v[52:53], v9 offset:0
    ds_read_b64_tr_b16 v[54:55], v9 offset:2048
    v_mfma_f32_16x16x32_bf16 v[36:39], v[68:71], v[156:159], v[36:39]
    v_add_u32 v10, s35, v1
    ds_read_b64_tr_b16 v[56:57], v10 offset:0
    s_add_u32 s69, s69, 2048
    buffer_load_dwordx4 v[120:123], v4, s[16:19], s69 offen sc1
    v_mfma_f32_16x16x32_bf16 v[24:27], v[72:75], v[152:155], v[24:27]
    ds_read_b64_tr_b16 v[58:59], v10 offset:2048
    v_add_u32 v11, s35, v3
    v_mfma_f32_16x16x32_bf16 v[40:43], v[72:75], v[156:159], v[40:43]
    ds_read_b64_tr_b16 v[60:61], v11 offset:0
    ds_read_b64_tr_b16 v[62:63], v11 offset:2048
    v_mfma_f32_16x16x32_bf16 v[28:31], v[76:79], v[152:155], v[28:31]
    buffer_load_dwordx4 v[124:127], v12, s[16:19], s69 offen sc1
    v_mfma_f32_16x16x32_bf16 v[44:47], v[76:79], v[156:159], v[44:47]
D_p3:
    s_waitcnt vmcnt(4) lgkmcnt(0)
    v_mfma_f32_16x16x32_bf16 v[16:19], v[48:51], v[128:131], v[16:19]
    ds_read_b64_tr_b16 v[64:65], v8 offset:4096
    ds_read_b64_tr_b16 v[66:67], v8 offset:6144
    v_mfma_f32_16x16x32_bf16 v[32:35], v[48:51], v[132:135], v[32:35]
    ds_read_b64_tr_b16 v[68:69], v9 offset:4096
    ds_read_b64_tr_b16 v[70:71], v9 offset:6144
    v_mfma_f32_16x16x32_bf16 v[20:23], v[52:55], v[128:131], v[20:23]
    ds_read_b64_tr_b16 v[72:73], v10 offset:4096
    ds_read_b64_tr_b16 v[74:75], v10 offset:6144
    v_mfma_f32_16x16x32_bf16 v[36:39], v[52:55], v[132:135], v[36:39]
    ds_read_b64_tr_b16 v[76:77], v11 offset:4096
    ds_read_b64_tr_b16 v[78:79], v11 offset:6144
    s_ff1_i32_b32 s64, s68
    s_bitset0_b32 s68, s64
    v_readlane_b32 s33, v7, s64
    s_add_u32 s69, s64, s74
    s_and_b32 s69, s69, 15
    s_lshl_b32 s69, s69, 11
    buffer_load_dwordx4 v[96:99], v4, s[16:19], s69 offen sc1
    v_mfma_f32_16x16x32_bf16 v[24:27], v[56:59], v[128:131], v[24:27]
    v_mfma_f32_16x16x32_bf16 v[40:43], v[56:59], v[132:135], v[40:43]
    v_mfma_f32_16x16x32_bf16 v[28:31], v[60:63], v[128:131], v[28:31]
    buffer_load_dwordx4 v[100:103], v12, s[16:19], s69 offen sc1
    v_mfma_f32_16x16x32_bf16 v[44:47], v[60:63], v[132:135], v[44:47]
    s_waitcnt lgkmcnt(0)
    v_mfma_f32_16x16x32_bf16 v[16:19], v[64:67], v[136:139], v[16:19]
    v_add_u32 v8, s34, v5
    ds_read_b64_tr_b16 v[48:49], v8 offset:0
    v_mfma_f32_16x16x32_bf16 v[32:35], v[64:67], v[140:143], v[32:35]
    ds_read_b64_tr_b16 v[50:51], v8 offset:2048
    v_add_u32 v9, s34, v6
    v_mfma_f32_16x16x32_bf16 v[20:23], v[68:71], v[136:139], v[20:23]
    ds_read_b64_tr_b16 v[52:53], v9 offset:0
    ds_read_b64_tr_b16 v[54:55], v9 offset:2048
    v_mfma_f32_16x16x32_bf16 v[36:39], v[68:71], v[140:143], v[36:39]
    v_add_u32 v10, s34, v1
    ds_read_b64_tr_b16 v[56:57], v10 offset:0
    s_add_u32 s69, s69, 2048
    buffer_load_dwordx4 v[104:107], v4, s[16:19], s69 offen sc1
    v_mfma_f32_16x16x32_bf16 v[24:27], v[72:75], v[136:139], v[24:27]
    ds_read_b64_tr_b16 v[58:59], v10 offset:2048
    v_add_u32 v11, s34, v3
    v_mfma_f32_16x16x32_bf16 v[40:43], v[72:75], v[140:143], v[40:43]
    ds_read_b64_tr_b16 v[60:61], v11 offset:0
    ds_read_b64_tr_b16 v[62:63], v11 offset:2048
    v_mfma_f32_16x16x32_bf16 v[28:31], v[76:79], v[136:139], v[28:31]
    buffer_load_dwordx4 v[108:111], v12, s[16:19], s69 offen sc1
    v_mfma_f32_16x16x32_bf16 v[44:47], v[76:79], v[140:143], v[44:47]
D_p2:
    s_waitcnt vmcnt(4) lgkmcnt(0)
    v_mfma_f32_16x16x32_bf16 v[16:19], v[48:51], v[112:115], v[16:19]
    ds_read_b64_tr_b16 v[64:65], v8 offset:4096
    ds_read_b64_tr_b16 v[66:67], v8 offset:6144
    v_mfma_f32_16x16x32_bf16 v[32:35], v[48:51], v[116:119], v[32:35]
    ds_read_b64_tr_b16 v[68:69], v9 offset:4096
    ds_read_b64_tr_b16 v[70:71], v9 offset:6144
    v_mfma_f32_16x16x32_bf16 v[20:23], v[52:55], v[112:115], v[20:23]
    ds_read_b64_tr_b16 v[72:73], v10 offset:4096
    ds_read_b64_tr_b16 v[74:75], v10 offset:6144
    v_mfma_f32_16x16x32_bf16 v[36:39], v[52:55], v[116:119], v[36:39]
    ds_read_b64_tr_b16 v[76:77], v11 offset:4096
    ds_read_b64_tr_b16 v[78:79], v11 offset:6144
    s_ff1_i32_b32 s64, s68
    s_bitset0_b32 s68, s64
    v_readlane_b32 s32, v7, s64
    s_add_u32 s69, s64, s74
    s_and_b32 s69, s69, 15
    s_lshl_b32 s69, s69, 11
    buffer_load_dwordx4 v[80:83], v4, s[16:19], s69 offen sc1
    v_mfma_f32_16x16x32_bf16 v[24:27], v[56:59], v[112:115], v[24:27]
    v_mfma_f32_16x16x32_bf16 v[40:43], v[56:59], v[116:119], v[40:43]
    v_mfma_f32_16x16x32_bf16 v[28:31], v[60:63], v[112:115], v[28:31]
    buffer_load_dwordx4 v[84:87], v12, s[16:19], s69 offen sc1
    v_mfma_f32_16x16x32_bf16 v[44:47], v[60:63], v[116:119], v[44:47]
    s_waitcnt lgkmcnt(0)
    v_mfma_f32_16x16x32_bf16 v[16:19], v[64:67], v[120:123], v[16:19]
    v_add_u32 v8, s33, v5
    ds_read_b64_tr_b16 v[48:49], v8 offset:0
    v_mfma_f32_16x16x32_bf16 v[32:35], v[64:67], v[124:127], v[32:35]
    ds_read_b64_tr_b16 v[50:51], v8 offset:2048
    v_add_u32 v9, s33, v6
    v_mfma_f32_16x16x32_bf16 v[20:23], v[68:71], v[120:123], v[20:23]
    ds_read_b64_tr_b16 v[52:53], v9 offset:0
    ds_read_b64_tr_b16 v[54:55], v9 offset:2048
    v_mfma_f32_16x16x32_bf16 v[36:39], v[68:71], v[124:127], v[36:39]
    v_add_u32 v10, s33, v1
    ds_read_b64_tr_b16 v[56:57], v10 offset:0
    s_add_u32 s69, s69, 2048
    buffer_load_dwordx4 v[88:91], v4, s[16:19], s69 offen sc1
    v_mfma_f32_16x16x32_bf16 v[24:27], v[72:75], v[120:123], v[24:27]
    ds_read_b64_tr_b16 v[58:59], v10 offset:2048
    v_add_u32 v11, s33, v3
    v_mfma_f32_16x16x32_bf16 v[40:43], v[72:75], v[124:127], v[40:43]
    ds_read_b64_tr_b16 v[60:61], v11 offset:0
    ds_read_b64_tr_b16 v[62:63], v11 offset:2048
    v_mfma_f32_16x16x32_bf16 v[28:31], v[76:79], v[120:123], v[28:31]
    buffer_load_dwordx4 v[92:95], v12, s[16:19], s69 offen sc1
    s_mov_b64 exec, 1
    v_mov_b32 v15, 0
    buffer_atomic_or v15, v14, s[16:19], 0 offen sc0
    s_mov_b64 exec, -1
    v_mfma_f32_16x16x32_bf16 v[44:47], v[76:79], v[124:127], v[44:47]
D_p1:
    s_waitcnt vmcnt(5) lgkmcnt(0)
    v_mfma_f32_16x16x32_bf16 v[16:19], v[48:51], v[96:99], v[16:19]
    ds_read_b64_tr_b16 v[64:65], v8 offset:4096
    ds_read_b64_tr_b16 v[66:67], v8 offset:6144
    v_mfma_f32_16x16x32_bf16 v[32:35], v[48:51], v[100:103], v[32:35]
    ds_read_b64_tr_b16 v[68:69], v9 offset:4096
    ds_read_b64_tr_b16 v[70:71], v9 offset:6144
    v_mfma_f32_16x16x32_bf16 v[20:23], v[52:55], v[96:99], v[20:23]
    ds_read_b64_tr_b16 v[72:73], v10 offset:4096
    ds_read_b64_tr_b16 v[74:75], v10 offset:6144
    v_mfma_f32_16x16x32_bf16 v[36:39], v[52:55], v[100:103], v[36:39]
    ds_read_b64_tr_b16 v[76:77], v11 offset:4096
    ds_read_b64_tr_b16 v[78:79], v11 offset:6144
    v_mfma_f32_16x16x32_bf16 v[24:27], v[56:59], v[96:99], v[24:27]
    v_mfma_f32_16x16x32_bf16 v[40:43], v[56:59], v[100:103], v[40:43]
    v_mfma_f32_16x16x32_bf16 v[28:31], v[60:63], v[96:99], v[28:31]
    v_mfma_f32_16x16x32_bf16 v[44:47], v[60:63], v[100:103], v[44:47]
    s_waitcnt lgkmcnt(0)
    v_mfma_f32_16x16x32_bf16 v[16:19], v[64:67], v[104:107], v[16:19]
    v_add_u32 v8, s32, v5
    ds_read_b64_tr_b16 v[48:49], v8 offset:0
    v_mfma_f32_16x16x32_bf16 v[32:35], v[64:67], v[108:111], v[32:35]
    ds_read_b64_tr_b16 v[50:51], v8 offset:2048
    v_add_u32 v9, s32, v6
    v_mfma_f32_16x16x32_bf16 v[20:23], v[68:71], v[104:107], v[20:23]
    ds_read_b64_tr_b16 v[52:53], v9 offset:0
    ds_read_b64_tr_b16 v[54:55], v9 offset:2048
    v_mfma_f32_16x16x32_bf16 v[36:39], v[68:71], v[108:111], v[36:39]
    v_add_u32 v10, s32, v1
    ds_read_b64_tr_b16 v[56:57], v10 offset:0
    v_mfma_f32_16x16x32_bf16 v[24:27], v[72:75], v[104:107], v[24:27]
    ds_read_b64_tr_b16 v[58:59], v10 offset:2048
    v_add_u32 v11, s32, v3
    v_mfma_f32_16x16x32_bf16 v[40:43], v[72:75], v[108:111], v[40:43]
    ds_read_b64_tr_b16 v[60:61], v11 offset:0
    ds_read_b64_tr_b16 v[62:63], v11 offset:2048
    v_mfma_f32_16x16x32_bf16 v[28:31], v[76:79], v[104:107], v[28:31]
    v_mfma_f32_16x16x32_bf16 v[44:47], v[76:79], v[108:111], v[44:47]
D_p0:
    s_waitcnt vmcnt(1) lgkmcnt(0)
    v_mfma_f32_16x16x32_bf16 v[16:19], v[48:51], v[80:83], v[16:19]
    ds_read_b64_tr_b16 v[64:65], v8 offset:4096
    ds_read_b64_tr_b16 v[66:67], v8 offset:6144
    v_mfma_f32_16x16x32_bf16 v[32:35], v[48:51], v[84:87], v[32:35]
    ds_read_b64_tr_b16 v[68:69], v9 offset:4096
    ds_read_b64_tr_b16 v[70:71], v9 offset:6144
    v_mfma_f32_16x16x32_bf16 v[20:23], v[52:55], v[80:83], v[20:23]
    ds_read_b64_tr_b16 v[72:73], v10 offset:4096
    ds_read_b64_tr_b16 v[74:75], v10 offset:6144
    v_mfma_f32_16x16x32_bf16 v[36:39], v[52:55], v[84:87], v[36:39]
    ds_read_b64_tr_b16 v[76:77], v11 offset:4096
    ds_read_b64_tr_b16 v[78:79], v11 offset:6144
    v_mfma_f32_16x16x32_bf16 v[24:27], v[56:59], v[80:83], v[24:27]
    v_mfma_f32_16x16x32_bf16 v[40:43], v[56:59], v[84:87], v[40:43]
    v_mfma_f32_16x16x32_bf16 v[28:31], v[60:63], v[80:83], v[28:31]
    v_mfma_f32_16x16x32_bf16 v[44:47], v[60:63], v[84:87], v[44:47]
    s_waitcnt lgkmcnt(0)
    v_mfma_f32_16x16x32_bf16 v[16:19], v[64:67], v[88:91], v[16:19]
    v_mfma_f32_16x16x32_bf16 v[32:35], v[64:67], v[92:95], v[32:35]
    v_mfma_f32_16x16x32_bf16 v[20:23], v[68:71], v[88:91], v[20:23]
    v_mfma_f32_16x16x32_bf16 v[36:39], v[68:71], v[92:95], v[36:39]
    v_mfma_f32_16x16x32_bf16 v[24:27], v[72:75], v[88:91], v[24:27]
    v_mfma_f32_16x16x32_bf16 v[40:43], v[72:75], v[92:95], v[40:43]
    v_mfma_f32_16x16x32_bf16 v[28:31], v[76:79], v[88:91], v[28:31]
    v_mfma_f32_16x16x32_bf16 v[44:47], v[76:79], v[92:95], v[44:47]
    s_cmp_lg_u32 s66, 0
    s_cbranch_scc1 D_wait
D_end:
    s_lshl_b32 s64, s3, 12
    s_add_u32 s64, s64, 8192
    v_lshl_add_u32 v8, v2, 4, s64
    s_xor_b32 s65, s3, 4
    s_lshl_b32 s65, s65, 12
    s_add_u32 s65, s65, 8192
    v_lshl_add_u32 v5, v2, 4, s65
    v_lshlrev_b32 v9, 1, v229
    v_cmp_eq_u32 s[70:71], s67, v230
    s_cmp_eq_u32 s46, 0
    s_cbranch_scc1 P2_y
P2_ny:
    s_barrier
    ds_write_b128 v8, v[32:35] offset:0
    ds_write_b128 v8, v[36:39] offset:1024
    ds_write_b128 v8, v[40:43] offset:2048
    ds_write_b128 v8, v[44:47] offset:3072
    s_cmp_lg_u64 s[70:71], 0
    s_cbranch_scc1 P2_fix
P2_nr:
    s_waitcnt lgkmcnt(0)
    s_barrier
    ds_read_b128 v[64:67], v5 offset:0
    ds_read_b128 v[68:71], v5 offset:1024
    ds_read_b128 v[72:75], v5 offset:2048
    ds_read_b128 v[76:79], v5 offset:3072
    s_waitcnt lgkmcnt(2)
    v_pk_add_f32 v[16:17], v[16:17], v[64:65]
    v_pk_add_f32 v[18:19], v[18:19], v[66:67]
    v_pk_add_f32 v[20:21], v[20:21], v[68:69]
    v_pk_add_f32 v[22:23], v[22:23], v[70:71]
    v_cvt_pk_bf16_f32 v48, v16, v17
    v_cvt_pk_bf16_f32 v49, v18, v19
    v_cvt_pk_bf16_f32 v50, v20, v21
    v_cvt_pk_bf16_f32 v51, v22, v23
    s_nop 0
    v_permlane16_swap_b32 v48, v50
    v_permlane16_swap_b32 v49, v51
    v_lshlrev_b32 v16, 16, v48
    v_and_b32 v17, 0xffff0000, v48
    v_lshlrev_b32 v18, 16, v49
    v_and_b32 v19, 0xffff0000, v49
    v_lshlrev_b32 v20, 16, v50
    v_and_b32 v21, 0xffff0000, v50
    v_lshlrev_b32 v22, 16, v51
    v_and_b32 v23, 0xffff0000, v51
    v_pk_mul_f32 v[16:17], v[16:17], v[228:229] op_sel_hi:[1,0]
    v_pk_mul_f32 v[18:19], v[18:19], v[228:229] op_sel_hi:[1,0]
    v_pk_mul_f32 v[20:21], v[20:21], v[228:229] op_sel_hi:[1,0]
    v_pk_mul_f32 v[22:23], v[22:23], v[228:229] op_sel_hi:[1,0]
    v_cvt_pk_bf16_f32 v48, v16, v17
    v_cvt_pk_bf16_f32 v49, v18, v19
    v_cvt_pk_bf16_f32 v50, v20, v21
    v_cvt_pk_bf16_f32 v51, v22, v23
    v_lshlrev_b32 v16, 16, v48
    v_and_b32 v17, 0xffff0000, v48
    v_lshlrev_b32 v18, 16, v49
    v_and_b32 v19, 0xffff0000, v49
    v_lshlrev_b32 v20, 16, v50
    v_and_b32 v21, 0xffff0000, v50
    v_lshlrev_b32 v22, 16, v51
    v_and_b32 v23, 0xffff0000, v51
    v_pk_add_f32 v[16:17], v[16:17], v[232:233]
    v_pk_add_f32 v[18:19], v[18:19], v[234:235]
    v_pk_add_f32 v[20:21], v[20:21], v[236:237]
    v_pk_add_f32 v[22:23], v[22:23], v[238:239]
    v_cvt_pk_bf16_f32 v120, v16, v17
    v_cvt_pk_bf16_f32 v121, v18, v19
    v_cvt_pk_bf16_f32 v122, v20, v21
    v_cvt_pk_bf16_f32 v123, v22, v23
    v_and_b32 v6, 1, v2
    v_mul_u32_u24 v6, 1984, v6
    v_sub_u32 v231, v231, v6
    s_mov_b32 vcc_lo, 0x55555555
    s_mov_b32 vcc_hi, 0x55555555
    s_waitcnt lgkmcnt(0)
    v_pk_add_f32 v[24:25], v[24:25], v[72:73]
    v_pk_add_f32 v[26:27], v[26:27], v[74:75]
    v_pk_add_f32 v[28:29], v[28:29], v[76:77]
    v_pk_add_f32 v[30:31], v[30:31], v[78:79]
    v_cvt_pk_bf16_f32 v52, v24, v25
    v_cvt_pk_bf16_f32 v53, v26, v27
    v_cvt_pk_bf16_f32 v54, v28, v29
    v_cvt_pk_bf16_f32 v55, v30, v31
    s_nop 0
    v_permlane16_swap_b32 v52, v54
    v_permlane16_swap_b32 v53, v55
    v_lshlrev_b32 v24, 16, v52
    v_and_b32 v25, 0xffff0000, v52
    v_lshlrev_b32 v26, 16, v53
    v_and_b32 v27, 0xffff0000, v53
    v_lshlrev_b32 v28, 16, v54
    v_and_b32 v29, 0xffff0000, v54
    v_lshlrev_b32 v30, 16, v55
    v_and_b32 v31, 0xffff0000, v55
    v_pk_mul_f32 v[24:25], v[24:25], v[228:229] op_sel_hi:[1,0]
    v_pk_mul_f32 v[26:27], v[26:27], v[228:229] op_sel_hi:[1,0]
    v_pk_mul_f32 v[28:29], v[28:29], v[228:229] op_sel_hi:[1,0]
    v_pk_mul_f32 v[30:31], v[30:31], v[228:229] op_sel_hi:[1,0]
    v_cvt_pk_bf16_f32 v52, v24, v25
    v_cvt_pk_bf16_f32 v53, v26, v27
    v_cvt_pk_bf16_f32 v54, v28, v29
    v_cvt_pk_bf16_f32 v55, v30, v31
    v_lshlrev_b32 v24, 16, v52
    v_and_b32 v25, 0xffff0000, v52
    v_lshlrev_b32 v26, 16, v53
    v_and_b32 v27, 0xffff0000, v53
    v_lshlrev_b32 v28, 16, v54
    v_and_b32 v29, 0xffff0000, v54
    v_lshlrev_b32 v30, 16, v55
    v_and_b32 v31, 0xffff0000, v55
    v_pk_add_f32 v[24:25], v[24:25], v[240:241]
    v_pk_add_f32 v[26:27], v[26:27], v[242:243]
    v_pk_add_f32 v[28:29], v[28:29], v[244:245]
    v_pk_add_f32 v[30:31], v[30:31], v[246:247]
    v_cvt_pk_bf16_f32 v124, v24, v25
    v_cvt_pk_bf16_f32 v125, v26, v27
    v_cvt_pk_bf16_f32 v126, v28, v29
    v_cvt_pk_bf16_f32 v127, v30, v31
    s_nop 1
    v_cndmask_b32_dpp v56, v124, v120, vcc quad_perm:[1,0,3,2] row_mask:0xf bank_mask:0xf
    v_cndmask_b32_dpp v57, v125, v121, vcc quad_perm:[1,0,3,2] row_mask:0xf bank_mask:0xf
    v_cndmask_b32_dpp v58, v126, v122, vcc quad_perm:[1,0,3,2] row_mask:0xf bank_mask:0xf
    v_cndmask_b32_dpp v59, v127, v123, vcc quad_perm:[1,0,3,2] row_mask:0xf bank_mask:0xf
    buffer_store_dwordx4 v[56:59], v231, s[20:23], 0 offen nt
    s_not_b64 vcc, vcc
    v_cndmask_b32_dpp v60, v120, v124, vcc quad_perm:[1,0,3,2] row_mask:0xf bank_mask:0xf
    v_cndmask_b32_dpp v61, v121, v125, vcc quad_perm:[1,0,3,2] row_mask:0xf bank_mask:0xf
    v_cndmask_b32_dpp v62, v122, v126, vcc quad_perm:[1,0,3,2] row_mask:0xf bank_mask:0xf
    v_cndmask_b32_dpp v63, v123, v127, vcc quad_perm:[1,0,3,2] row_mask:0xf bank_mask:0xf
    buffer_store_dwordx4 v[60:63], v231, s[20:23], 0 offen offset:2048 nt
K_end:
    s_endpgm
H_nre:
    s_add_u32 s65, s65, 1
    s_cmp_ge_u32 s65, 200000
    s_cbranch_scc1 H_nok
    s_sleep 4
    buffer_load_dword v78, v79, s[20:23], 0 offen sc1
    s_waitcnt vmcnt(0)
    s_branch H_nspin
H_retry:
    s_add_u32 s65, s65, 1
    s_cmp_ge_u32 s65, 200000
    s_cbranch_scc1 H_nq
    s_sleep 8
    s_mov_b32 s64, 6717440
    buffer_load_dwordx4 v[24:27], v6, s[16:19], s64 offen offset:0 sc1
    buffer_load_dwordx4 v[28:31], v6, s[16:19], s64 offen offset:1024 sc1
    s_waitcnt vmcnt(0)
    s_branch H_spin
G_f15:
    s_bitset1_b32 s66, s55
    s_branch G_q15
G_f14:
    s_bitset1_b32 s66, s54
    s_branch G_q14
G_f13:
    s_bitset1_b32 s66, s53
    s_branch G_q13
G_f12:
    s_bitset1_b32 s66, s52
    s_branch G_q12
G_f11:
    s_bitset1_b32 s66, s51
    s_branch G_q11
G_f10:
    s_bitset1_b32 s66, s50
    s_branch G_q10
G_f9:
    s_bitset1_b32 s66, s49
    s_branch G_q9
G_f8:
    s_bitset1_b32 s66, s48
    s_branch G_q8
G_f7:
    s_bitset1_b32 s66, s47
    s_branch G_q7
G_f6:
    s_bitset1_b32 s66, s46
    s_branch G_q6
G_f5:
    s_bitset1_b32 s66, s45
    s_branch G_q5
G_f4:
    s_bitset1_b32 s66, s44
    s_branch G_q4
G_f3:
    s_bitset1_b32 s66, s43
    s_branch G_q3
G_f2:
    s_bitset1_b32 s66, s42
    s_branch G_q2
G_f1:
    s_bitset1_b32 s66, s41
    s_branch G_q1
G_f0:
    s_bitset1_b32 s66, s40
    s_branch G_q0
phi_16_fix:
    v_lshlrev_b32 v48, 16, v16
    v_and_b32 v49, 0xffff0000, v16
    v_add_f32 v48, s73, v48
    v_add_f32 v49, s73, v49
    v_cvt_pk_bf16_f32 v16, v48, v49
    v_lshlrev_b32 v48, 16, v17
    v_and_b32 v49, 0xffff0000, v17
    v_add_f32 v48, s73, v48
    v_add_f32 v49, s73, v49
    v_cvt_pk_bf16_f32 v17, v48, v49
    v_lshlrev_b32 v48, 16, v18
    v_and_b32 v49, 0xffff0000, v18
    v_add_f32 v48, s73, v48
    v_add_f32 v49, s73, v49
    v_cvt_pk_bf16_f32 v18, v48, v49
    v_lshlrev_b32 v48, 16, v19
    v_and_b32 v49, 0xffff0000, v19
    v_add_f32 v48, s73, v48
    v_add_f32 v49, s73, v49
    v_cvt_pk_bf16_f32 v19, v48, v49
    v_lshlrev_b32 v48, 16, v20
    v_and_b32 v49, 0xffff0000, v20
    v_add_f32 v48, s73, v48
    v_add_f32 v49, s73, v49
    v_cvt_pk_bf16_f32 v20, v48, v49
    v_lshlrev_b32 v48, 16, v21
    v_and_b32 v49, 0xffff0000, v21
    v_add_f32 v48, s73, v48
    v_add_f32 v49, s73, v49
    v_cvt_pk_bf16_f32 v21, v48, v49
    v_lshlrev_b32 v48, 16, v22
    v_and_b32 v49, 0xffff0000, v22
    v_add_f32 v48, s73, v48
    v_add_f32 v49, s73, v49
    v_cvt_pk_bf16_f32 v22, v48, v49
    v_lshlrev_b32 v48, 16, v23
    v_and_b32 v49, 0xffff0000, v23
    v_add_f32 v48, s73, v48
    v_add_f32 v49, s73, v49
    v_cvt_pk_bf16_f32 v23, v48, v49
    s_branch phi_16_done
phi_17_fix:
    v_lshlrev_b32 v48, 16, v24
    v_and_b32 v49, 0xffff0000, v24
    v_add_f32 v48, s73, v48
    v_add_f32 v49, s73, v49
    v_cvt_pk_bf16_f32 v24, v48, v49
    v_lshlrev_b32 v48, 16, v25
    v_and_b32 v49, 0xffff0000, v25
    v_add_f32 v48, s73, v48
    v_add_f32 v49, s73, v49
    v_cvt_pk_bf16_f32 v25, v48, v49
    v_lshlrev_b32 v48, 16, v26
    v_and_b32 v49, 0xffff0000, v26
    v_add_f32 v48, s73, v48
    v_add_f32 v49, s73, v49
    v_cvt_pk_bf16_f32 v26, v48, v49
    v_lshlrev_b32 v48, 16, v27
    v_and_b32 v49, 0xffff0000, v27
    v_add_f32 v48, s73, v48
    v_add_f32 v49, s73, v49
    v_cvt_pk_bf16_f32 v27, v48, v49
    v_lshlrev_b32 v48, 16, v28
    v_and_b32 v49, 0xffff0000, v28
    v_add_f32 v48, s73, v48
    v_add_f32 v49, s73, v49
    v_cvt_pk_bf16_f32 v28, v48, v49
    v_lshlrev_b32 v48, 16, v29
    v_and_b32 v49, 0xffff0000, v29
    v_add_f32 v48, s73, v48
    v_add_f32 v49, s73, v49
    v_cvt_pk_bf16_f32 v29, v48, v49
    v_lshlrev_b32 v48, 16, v30
    v_and_b32 v49, 0xffff0000, v30
    v_add_f32 v48, s73, v48
    v_add_f32 v49, s73, v49
    v_cvt_pk_bf16_f32 v30, v48, v49
    v_lshlrev_b32 v48, 16, v31
    v_and_b32 v49, 0xffff0000, v31
    v_add_f32 v48, s73, v48
    v_add_f32 v49, s73, v49
    v_cvt_pk_bf16_f32 v31, v48, v49
    s_branch phi_17_done
C_ex1:
    ds_write_b32 v227, v96 offset:4608
    ds_write_b128 v224, v[240:243] offset:32768
    ds_write_b128 v224, v[244:247] offset:33792
    s_nop 4
    v_mov_b32 v96, v60
    v_mov_b32 v240, v248
    v_mov_b32 v241, v249
    v_mov_b32 v242, v250
    v_mov_b32 v243, v251
    v_mov_b32 v244, v252
    v_mov_b32 v245, v253
    v_mov_b32 v246, v254
    v_mov_b32 v247, v255
    s_branch C_ex2
phi_18_fix:
    v_lshlrev_b32 v48, 16, v32
    v_and_b32 v49, 0xffff0000, v32
    v_add_f32 v48, s73, v48
    v_add_f32 v49, s73, v49
    v_cvt_pk_bf16_f32 v32, v48, v49
    v_lshlrev_b32 v48, 16, v33
    v_and_b32 v49, 0xffff0000, v33
    v_add_f32 v48, s73, v48
    v_add_f32 v49, s73, v49
    v_cvt_pk_bf16_f32 v33, v48, v49
    v_lshlrev_b32 v48, 16, v34
    v_and_b32 v49, 0xffff0000, v34
    v_add_f32 v48, s73, v48
    v_add_f32 v49, s73, v49
    v_cvt_pk_bf16_f32 v34, v48, v49
    v_lshlrev_b32 v48, 16, v35
    v_and_b32 v49, 0xffff0000, v35
    v_add_f32 v48, s73, v48
    v_add_f32 v49, s73, v49
    v_cvt_pk_bf16_f32 v35, v48, v49
    v_lshlrev_b32 v48, 16, v36
    v_and_b32 v49, 0xffff0000, v36
    v_add_f32 v48, s73, v48
    v_add_f32 v49, s73, v49
    v_cvt_pk_bf16_f32 v36, v48, v49
    v_lshlrev_b32 v48, 16, v37
    v_and_b32 v49, 0xffff0000, v37
    v_add_f32 v48, s73, v48
    v_add_f32 v49, s73, v49
    v_cvt_pk_bf16_f32 v37, v48, v49
    v_lshlrev_b32 v48, 16, v38
    v_and_b32 v49, 0xffff0000, v38
    v_add_f32 v48, s73, v48
    v_add_f32 v49, s73, v49
    v_cvt_pk_bf16_f32 v38, v48, v49
    v_lshlrev_b32 v48, 16, v39
    v_and_b32 v49, 0xffff0000, v39
    v_add_f32 v48, s73, v48
    v_add_f32 v49, s73, v49
    v_cvt_pk_bf16_f32 v39, v48, v49
    s_branch phi_18_done
phi_19_fix:
    v_lshlrev_b32 v48, 16, v40
    v_and_b32 v49, 0xffff0000, v40
    v_add_f32 v48, s73, v48
    v_add_f32 v49, s73, v49
    v_cvt_pk_bf16_f32 v40, v48, v49
    v_lshlrev_b32 v48, 16, v41
    v_and_b32 v49, 0xffff0000, v41
    v_add_f32 v48, s73, v48
    v_add_f32 v49, s73, v49
    v_cvt_pk_bf16_f32 v41, v48, v49
    v_lshlrev_b32 v48, 16, v42
    v_and_b32 v49, 0xffff0000, v42
    v_add_f32 v48, s73, v48
    v_add_f32 v49, s73, v49
    v_cvt_pk_bf16_f32 v42, v48, v49
    v_lshlrev_b32 v48, 16, v43
    v_and_b32 v49, 0xffff0000, v43
    v_add_f32 v48, s73, v48
    v_add_f32 v49, s73, v49
    v_cvt_pk_bf16_f32 v43, v48, v49
    v_lshlrev_b32 v48, 16, v44
    v_and_b32 v49, 0xffff0000, v44
    v_add_f32 v48, s73, v48
    v_add_f32 v49, s73, v49
    v_cvt_pk_bf16_f32 v44, v48, v49
    v_lshlrev_b32 v48, 16, v45
    v_and_b32 v49, 0xffff0000, v45
    v_add_f32 v48, s73, v48
    v_add_f32 v49, s73, v49
    v_cvt_pk_bf16_f32 v45, v48, v49
    v_lshlrev_b32 v48, 16, v46
    v_and_b32 v49, 0xffff0000, v46
    v_add_f32 v48, s73, v48
    v_add_f32 v49, s73, v49
    v_cvt_pk_bf16_f32 v46, v48, v49
    v_lshlrev_b32 v48, 16, v47
    v_and_b32 v49, 0xffff0000, v47
    v_add_f32 v48, s73, v48
    v_add_f32 v49, s73, v49
    v_cvt_pk_bf16_f32 v47, v48, v49
    s_branch phi_19_done
P2_ys:
    v_lshrrev_b32 v13, 4, v2
    v_lshlrev_b32 v13, 12, v13
    v_and_b32 v208, 15, v2
    v_lshl_add_u32 v13, v208, 4, v13
    s_lshl_b32 s64, s5, 8
    s_lshl_b32 s65, s3, 16
    s_add_u32 s64, s64, s65
    v_add_u32 v13, s64, v13
    s_lshl_b32 s64, s67, 11
    s_lshl_b32 s65, s5, 7
    s_add_u32 s64, s64, s65
    v_lshl_add_u32 v209, v2, 1, s64
    s_lshl_b32 s64, s67, 2
    s_add_u32 s64, s64, 6709248
    v_mov_b32 v215, s64
    s_branch P2_ysd
P2_yl:
    s_cmp_gt_u32 s70, 7
    s_cbranch_scc1 P2_nyl
    buffer_load_ushort v211, v209, s[8:11], 0 offen
    buffer_load_dword v212, v215, s[16:19], 0 offen sc1
    s_mov_b32 s69, 6447104
    buffer_load_dwordx4 v[192:195], v13, s[16:19], s69 offen sc1
    s_mov_b32 s69, 6463488
    buffer_load_dwordx4 v[196:199], v13, s[16:19], s69 offen sc1
    s_mov_b32 s69, 6479872
    buffer_load_dwordx4 v[200:203], v13, s[16:19], s69 offen sc1
    s_mov_b32 s69, 6496256
    buffer_load_dwordx4 v[204:207], v13, s[16:19], s69 offen sc1
    s_mov_b32 s47, 1
    s_branch P2_nyl
P2_y:
    s_mov_b32 s66, 0
    s_cmp_lg_u32 s47, 0
    s_cbranch_scc1 P2_ychk
P2_yre:
    buffer_load_ushort v211, v209, s[8:11], 0 offen
    buffer_load_dword v212, v215, s[16:19], 0 offen sc1
    s_mov_b32 s69, 6447104
    buffer_load_dwordx4 v[192:195], v13, s[16:19], s69 offen sc1
    s_mov_b32 s69, 6463488
    buffer_load_dwordx4 v[196:199], v13, s[16:19], s69 offen sc1
    s_mov_b32 s69, 6479872
    buffer_load_dwordx4 v[200:203], v13, s[16:19], s69 offen sc1
    s_mov_b32 s69, 6496256
    buffer_load_dwordx4 v[204:207], v13, s[16:19], s69 offen sc1
P2_ychk:
    s_waitcnt vmcnt(0)
    v_max3_u32 v10, v192, v193, v194
    v_max3_u32 v10, v195, v196, v10
    v_max3_u32 v10, v197, v198, v10
    v_max3_u32 v10, v199, v200, v10
    v_max3_u32 v10, v201, v202, v10
    v_max3_u32 v10, v203, v204, v10
    v_max3_u32 v10, v205, v206, v10
    v_max_u32 v10, v207, v10
    v_cmp_eq_u32 vcc, -1, v10
    s_cbranch_vccz P2_yok
    s_add_u32 s66, s66, 1
    s_cmp_ge_u32 s66, 40000
    s_cbranch_scc1 P2_yok
    s_sleep 4
    s_branch P2_yre
P2_yok:
    v_pk_add_f32 v[192:193], v[192:193], v[200:201]
    v_pk_add_f32 v[194:195], v[194:195], v[202:203]
    v_pk_add_f32 v[196:197], v[196:197], v[204:205]
    v_pk_add_f32 v[198:199], v[198:199], v[206:207]
    v_pk_add_f32 v[192:193], v[192:193], v[196:197]
    v_pk_add_f32 v[194:195], v[194:195], v[198:199]
    v_mov_b32 v196, v192
    v_mov_b32 v197, v193
    v_mov_b32 v198, v194
    v_mov_b32 v199, v195
    s_nop 0
    v_permlane16_swap_b32 v192, v196
    v_permlane16_swap_b32 v193, v197
    v_permlane16_swap_b32 v194, v198
    v_permlane16_swap_b32 v195, v199
    v_add_f32 v192, v192, v196
    v_add_f32 v193, v193, v197
    v_add_f32 v194, v194, v198
    v_add_f32 v195, v195, v199
    v_mov_b32 v196, v192
    v_mov_b32 v197, v193
    v_mov_b32 v198, v194
    v_mov_b32 v199, v195
    s_nop 0
    v_permlane32_swap_b32 v192, v196
    v_permlane32_swap_b32 v193, v197
    v_permlane32_swap_b32 v194, v198
    v_permlane32_swap_b32 v195, v199
    v_add_f32 v192, v192, v196
    v_add_f32 v193, v193, v197
    v_add_f32 v194, v194, v198
    v_add_f32 v195, v195, v199
    s_lshl_b32 s64, s3, 8
    v_lshl_add_u32 v208, v208, 4, s64
    ds_write_b128 v208, v[192:195] offset:5888
    v_mov_b32 v208, 0
    v_mov_b32 v214, 1
    s_mov_b64 exec, 1
    ds_add_rtn_u32 v210, v208, v214 offset:4304
    s_mov_b64 exec, -1
    s_and_b32 s64, s75, 0xffff0000
    s_xor_b32 s65, s64, 0x80000000
    s_not_b32 s69, s64
    s_and_b32 s69, s69, 0xffff0000
    s_cmp_ge_u32 s64, 0x80000000
    s_cselect_b32 s64, s65, s69
    v_mov_b32 v213, s64
    v_lshlrev_b32 v208, 2, v2
    s_waitcnt lgkmcnt(0)
    v_readfirstlane_b32 s64, v210
    s_cmp_lg_u32 s64, 3
    s_cbranch_scc1 P2_ny
    ds_read_b32 v192, v208 offset:5888
    ds_read_b32 v193, v208 offset:6144
    ds_read_b32 v194, v208 offset:6400
    ds_read_b32 v195, v208 offset:6656
    v_mul_f32 v213, s72, v213
    v_exp_f32 v213, -v213
    s_nop 0
    v_add_f32 v213, 1.0, v213
    v_rcp_f32 v213, v213
    s_nop 0
    v_cvt_pk_bf16_f32 v213, v213, v213
    v_lshlrev_b32 v213, 16, v213
    v_sub_f32 v214, 1.0, v212
    v_cvt_pk_bf16_f32 v214, v214, v214
    v_lshlrev_b32 v214, 16, v214
    v_lshlrev_b32 v211, 16, v211
    s_waitcnt lgkmcnt(0)
    v_add_f32 v192, v192, v193
    v_add_f32 v194, v194, v195
    v_add_f32 v210, v192, v194
    v_cvt_pk_bf16_f32 v210, v210, v210
    v_lshlrev_b32 v210, 16, v210
    v_mul_f32 v210, v210, v213
    v_cvt_pk_bf16_f32 v210, v210, v210
    v_lshlrev_b32 v210, 16, v210
    v_add_f32 v210, v211, v210
    v_cvt_pk_bf16_f32 v210, v210, v210
    v_lshlrev_b32 v210, 16, v210
    v_mul_f32 v210, v210, v214
    v_cvt_pk_bf16_f32 v210, v210, v210
    v_lshlrev_b32 v210, 16, v210
    ds_write_b32 v208, v210 offset:5632
    s_waitcnt lgkmcnt(0)
    s_branch P2_ny
P2_fix:
    s_mov_b64 exec, s[70:71]
    ds_read_b128 v[232:235], v9 offset:5632
    ds_read_b128 v[236:239], v9 offset:5648
    ds_read_b128 v[240:243], v9 offset:5760
    ds_read_b128 v[244:247], v9 offset:5776
    s_mov_b64 exec, -1
    s_branch P2_nr
CODE_END:
.section .rodata,"a"
.p2align 6
.amdhsa_kernel gated_mix__linear_attn_block__moe_arch_mod__prompt_kernel
  .amdhsa_next_free_vgpr 256
  .amdhsa_next_free_sgpr 102
  .amdhsa_accum_offset 256
  .amdhsa_group_segment_fixed_size 0
  .amdhsa_kernarg_size 96
  .amdhsa_user_sgpr_count 2
  .amdhsa_user_sgpr_kernarg_segment_ptr 1
  .amdhsa_system_sgpr_workgroup_id_x 1
.end_amdhsa_kernel
```

```asm
; @launch grid=(256,1,1) block=(512,1,1) lds=163840
.amdgcn_target "amdgcn-amd-amdhsa--gfx950"
.text
.globl gated_mix__linear_attn_block__moe_arch_mod__prompt_kernel
.p2align 8
.type gated_mix__linear_attn_block__moe_arch_mod__prompt_kernel,@function
gated_mix__linear_attn_block__moe_arch_mod__prompt_kernel:
    s_load_dwordx16 s[40:55], s[0:1], 0
    s_load_dwordx8 s[56:63], s[0:1], 64
    s_cmp_ge_u32 s2, 256
    s_cbranch_scc1 K_end
    v_lshrrev_b32 v1, 6, v0
    v_and_b32 v2, 63, v0
    s_and_b32 s6, s2, 7
    v_readfirstlane_b32 s3, v1
    s_lshr_b32 s7, s2, 3
    s_and_b32 s4, s6, 1
    s_lshl_b32 s4, s4, 3
    s_and_b32 s64, s7, 7
    s_add_u32 s4, s4, s64
    s_lshr_b32 s5, s6, 1
    s_lshl_b32 s5, s5, 2
    s_lshr_b32 s64, s7, 3
    s_add_u32 s5, s5, s64
    s_and_b32 s74, s4, 3
    s_lshl_b32 s74, s74, 2
    s_add_u32 s74, s74, s6
    v_lshrrev_b32 v6, 3, v2
    s_lshl_b32 s65, s3, 3
    v_add_u32 v6, s65, v6
    s_lshl_b32 s64, s4, 7
    v_add_u32 v7, s64, v6
    v_lshlrev_b32 v7, 11, v7
    v_lshrrev_b32 v8, 4, v2
    s_and_b32 s64, s3, 1
    s_lshl_b32 s64, s64, 2
    v_add_u32 v9, s64, v8
    v_and_b32 v10, 7, v2
    v_xor_b32 v9, v9, v10
    v_lshl_add_u32 v7, v9, 4, v7
    v_mul_u32_u24 v6, 6144, v6
    v_and_b32 v9, 1, v8
    s_lshr_b32 s64, s64, 1
    v_lshl_add_u32 v9, v9, 2, s64
    v_xor_b32 v9, v9, v10
    v_lshl_add_u32 v6, v9, 4, v6
    s_lshl_b32 s64, s5, 7
    v_add_u32 v6, s64, v6
    s_lshl_b32 s66, s3, 10
    s_mov_b32 s10, 4194304
    s_mov_b32 s11, 0x00020000
    s_mov_b32 s14, 6291456
    s_mov_b32 s15, 0x00020000
    s_add_u32 s65, s74, 0
    s_and_b32 s65, s65, 15
    s_lshl_b32 s67, s65, 7
    s_mul_i32 s65, s65, 393216
    s_waitcnt lgkmcnt(0)
    s_mov_b32 s8, s40
    s_mov_b32 s9, s41
    s_mov_b32 s12, s42
    s_mov_b32 s13, s43
    s_add_u32 m0, s66, 8192
    s_add_u32 s64, s67, 0
    buffer_load_dwordx4 v7, s[8:11], s64 offen lds
    s_add_u32 m0, s66, 16384
    s_add_u32 s64, s67, 131072
    buffer_load_dwordx4 v7, s[8:11], s64 offen lds
    s_add_u32 m0, s66, 24576
    s_add_u32 s64, s65, 0
    buffer_load_dwordx4 v6, s[12:15], s64 offen lds
    s_add_u32 m0, s66, 32768
    s_add_u32 s64, s65, 2048
    buffer_load_dwordx4 v6, s[12:15], s64 offen lds
    s_add_u32 m0, s66, 40960
    s_add_u32 s64, s65, 4096
    buffer_load_dwordx4 v6, s[12:15], s64 offen lds
    s_cmp_lt_u32 s3, 4
    s_cbranch_scc1 K_nt
    s_lshl_b32 s64, s2, 2
    s_add_u32 s64, s64, s3
    s_sub_u32 s64, s64, 4
    s_mul_i32 s64, s64, 6144
    s_add_u32 s46, s12, s64
    s_addc_u32 s47, s13, 0
    s_load_dword s43, s[46:47], 384
    s_load_dword s43, s[46:47], 448
    s_load_dword s43, s[46:47], 1408
    s_load_dword s43, s[46:47], 1472
    s_load_dword s43, s[46:47], 2432
    s_load_dword s43, s[46:47], 2496
    s_load_dword s43, s[46:47], 3456
    s_load_dword s43, s[46:47], 3520
    s_load_dword s43, s[46:47], 4480
    s_load_dword s43, s[46:47], 4544
    s_load_dword s43, s[46:47], 5504
    s_load_dword s43, s[46:47], 5568
K_nt:
    s_barrier
    s_mov_b32 s72, 0x3fb8aa3b
    s_mov_b32 s73, 0x358637bd
    s_mov_b32 s16, s62
    s_mov_b32 s17, s63
    s_mov_b32 s18, 0x10000000
    s_mov_b32 s19, 0x00020000
    s_cmp_lt_u32 s3, 4
    s_cbranch_scc1 C_start
    s_sub_u32 s6, s3, 4
    s_lshl_b32 s7, s6, 10
    v_lshrrev_b32 v6, 3, v2
    s_lshl_b32 s64, s4, 7
    s_lshl_b32 s65, s6, 3
    s_add_u32 s64, s64, s65
    v_add_u32 v7, s64, v6
    v_lshlrev_b32 v7, 11, v7
    s_and_b32 s64, s6, 1
    s_lshl_b32 s64, s64, 2
    v_add_u32 v9, s64, v8
    v_xor_b32 v9, v9, v10
    v_lshl_add_u32 v4, v9, 4, v7
    v_add_u32 v7, s65, v6
    v_mul_u32_u24 v7, 6144, v7
    v_and_b32 v9, 1, v8
    s_lshr_b32 s64, s64, 1
    v_lshl_add_u32 v9, v9, 2, s64
    v_xor_b32 v9, v9, v10
    v_lshl_add_u32 v7, v9, 4, v7
    s_lshl_b32 s64, s5, 7
    v_add_u32 v5, s64, v7
    v_lshlrev_b32 v6, 4, v2
    s_and_b32 s64, s2, 1
    s_lshl_b32 s68, s64, 10
    s_bfe_u32 s64, s2, 0x20001
    s_lshl_b32 s64, s64, 8
    s_add_u32 s68, s68, s64
    s_and_b32 s64, s2, 0xf8
    s_add_u32 s68, s68, s64
    s_lshl_b32 s64, s6, 1
    s_add_u32 s68, s68, s64
    s_lshl_b32 s64, s68, 11
    v_add_u32 v13, s64, v6
    s_add_u32 s41, s74, 1
    s_and_b32 s41, s41, 15
    s_lshl_b32 s42, s41, 7
    s_mul_i32 s41, s41, 393216
    s_add_u32 m0, s7, 49152
    s_add_u32 s40, s42, 0
    buffer_load_dwordx4 v4, s[8:11], s40 offen lds
    s_add_u32 m0, s7, 53248
    s_add_u32 s40, s42, 65536
    buffer_load_dwordx4 v4, s[8:11], s40 offen lds
    s_add_u32 m0, s7, 57344
    s_add_u32 s40, s42, 131072
    buffer_load_dwordx4 v4, s[8:11], s40 offen lds
    s_add_u32 m0, s7, 61440
    s_add_u32 s40, s42, 196608
    buffer_load_dwordx4 v4, s[8:11], s40 offen lds
    s_add_u32 m0, s7, 65536
    s_add_u32 s40, s41, 0
    buffer_load_dwordx4 v5, s[12:15], s40 offen lds
    s_add_u32 m0, s7, 69632
    s_add_u32 s40, s41, 196608
    buffer_load_dwordx4 v5, s[12:15], s40 offen lds
    s_add_u32 m0, s7, 73728
    s_add_u32 s40, s41, 2048
    buffer_load_dwordx4 v5, s[12:15], s40 offen lds
    s_add_u32 m0, s7, 77824
    s_add_u32 s40, s41, 198656
    buffer_load_dwordx4 v5, s[12:15], s40 offen lds
    s_add_u32 m0, s7, 81920
    s_add_u32 s40, s41, 4096
    buffer_load_dwordx4 v5, s[12:15], s40 offen lds
    s_add_u32 m0, s7, 86016
    s_add_u32 s40, s41, 200704
    buffer_load_dwordx4 v5, s[12:15], s40 offen lds
    s_mov_b32 s32, s50
    s_mov_b32 s33, s51
    s_mov_b32 s34, 0x700000
    s_mov_b32 s35, 0x00020000
    s_mov_b32 s36, s52
    s_mov_b32 s37, s53
    s_mov_b32 s38, 0x700000
    s_mov_b32 s39, 0x00020000
    s_or_b32 s64, s2, s6
    s_cmp_lg_u32 s64, 0
    s_cbranch_scc1 H_nn
    s_mov_b32 s64, 6717440
    s_load_dwordx2 s[66:67], s[62:63], s64
    s_mov_b32 s20, s60
    s_mov_b32 s21, s61
    s_mov_b32 s22, 0x100
    s_mov_b32 s23, 0x00020000
    s_waitcnt lgkmcnt(0)
    s_xor_b32 s64, s66, s67
    s_add_u32 s64, s64, 1
    s_max_u32 s64, s64, 1
    v_mov_b32 v72, s64
    v_mov_b32 v73, 0
    s_mov_b64 exec, 1
    buffer_store_dword v72, v73, s[20:23], 0 offen sc0 sc1
    s_mov_b64 exec, -1
H_nn:
    s_mov_b32 s20, s60
    s_mov_b32 s21, s61
    s_mov_b32 s22, 0x100
    s_mov_b32 s23, 0x00020000
    s_mov_b32 s24, s48
    s_mov_b32 s25, s49
    s_mov_b32 s26, 0x800
    s_mov_b32 s27, 0x00020000
    s_mov_b32 s28, s56
    s_mov_b32 s29, s57
    s_mov_b32 s30, 0x800
    s_mov_b32 s31, 0x00020000
    s_lshr_b32 s69, s2, 3
    s_and_b32 s64, s2, 7
    v_and_b32 v9, 15, v2
    v_min_u32 v9, 13, v9
    s_lshl_b32 s65, s69, 5
    v_lshl_add_u32 v7, v8, 3, s65
    v_mul_u32_u24 v7, 7168, v7
    s_mul_i32 s65, s64, 896
    s_mul_i32 s66, s6, 224
    s_add_u32 s65, s65, s66
    v_lshl_add_u32 v7, v9, 4, v7
    v_add_u32 v11, s65, v7
    v_cmp_le_u32 vcc, 7, v9
    v_mov_b32 v15, 16160
    s_nop 0
    v_cndmask_b32 v7, 0, v15, vcc
    v_lshl_add_u32 v7, v9, 5, v7
    v_lshrrev_b32 v15, 1, v8
    v_lshl_add_u32 v7, v15, 13, v7
    v_and_b32 v15, 1, v8
    v_lshl_add_u32 v7, v15, 4, v7
    s_lshl_b32 s64, s64, 17
    s_lshl_b32 s65, s6, 15
    s_add_u32 s64, s64, s65
    s_lshl_b32 s65, s69, 8
    s_add_u32 s64, s64, s65
    s_add_u32 s64, s64, 5398528
    v_add_u32 v12, s64, v7
    s_lshl_b32 s70, s5, 2
    s_add_u32 s70, s70, s6
    s_mul_i32 s70, s70, 18432
    s_add_u32 s70, s70, 4194304
    s_mul_i32 s64, s4, 1152
    s_add_u32 s64, s64, s70
    s_mov_b32 s67, s64
    v_lshl_add_u32 v15, v2, 2, s64
    v_add_u32 v15, 960, v15
    s_lshl_b32 s64, s5, 2
    s_add_u32 s64, s64, s6
    s_lshl_b32 s64, s64, 7
    s_add_u32 s64, s64, 5373952
    v_mov_b32 v23, s64
    s_lshl_b32 s65, s4, 10
    s_add_u32 s65, s65, 5382016
    v_lshl_add_u32 v20, v2, 7, s65
    v_cmp_gt_u32 vcc, 16, v2
    s_nop 1
    v_cndmask_b32 v15, v15, v20, vcc
    v_writelane_b32 v15, s64, 0
    s_cmp_eq_u32 s4, 0
    s_cselect_b32 s75, 1, 0
    s_or_b32 s64, s5, s6
    s_cmp_eq_u32 s64, 0
    s_cselect_b32 s64, 0x1fe, 0
    s_or_b32 s75, s75, s64
    s_or_b32 s75, s75, 0xffff0000
    v_lshlrev_b32 v22, 4, v2
    v_add_u32 v22, s67, v22
    v_mov_b32 v16, -1
    v_mov_b32 v17, -1
    v_mov_b32 v18, -1
    v_mov_b32 v19, -1
    v_cndmask_b32 v20, -1, 0, vcc
    s_waitcnt vmcnt(10)
    s_barrier
    s_add_u32 s41, s74, 2
    s_and_b32 s41, s41, 15
    s_lshl_b32 s42, s41, 7
    s_mul_i32 s41, s41, 393216
    s_add_u32 m0, s7, 90112
    s_add_u32 s40, s42, 0
    buffer_load_dwordx4 v4, s[8:11], s40 offen lds
    s_add_u32 m0, s7, 94208
    s_add_u32 s40, s42, 65536
    buffer_load_dwordx4 v4, s[8:11], s40 offen lds
    s_add_u32 m0, s7, 98304
    s_add_u32 s40, s42, 131072
    buffer_load_dwordx4 v4, s[8:11], s40 offen lds
    s_add_u32 m0, s7, 102400
    s_add_u32 s40, s42, 196608
    buffer_load_dwordx4 v4, s[8:11], s40 offen lds
    s_add_u32 m0, s7, 106496
    s_add_u32 s40, s41, 0
    buffer_load_dwordx4 v5, s[12:15], s40 offen lds
    s_add_u32 m0, s7, 110592
    s_add_u32 s40, s41, 196608
    buffer_load_dwordx4 v5, s[12:15], s40 offen lds
    s_add_u32 m0, s7, 114688
    s_add_u32 s40, s41, 2048
    buffer_load_dwordx4 v5, s[12:15], s40 offen lds
    s_add_u32 m0, s7, 118784
    s_add_u32 s40, s41, 198656
    buffer_load_dwordx4 v5, s[12:15], s40 offen lds
    s_add_u32 m0, s7, 122880
    s_add_u32 s40, s41, 4096
    buffer_load_dwordx4 v5, s[12:15], s40 offen lds
    s_add_u32 m0, s7, 126976
    s_add_u32 s40, s41, 200704
    buffer_load_dwordx4 v5, s[12:15], s40 offen lds
    s_getpc_b64 s[66:67]
pc_1:
    s_sub_u32 s66, s66, pc_1-gated_mix__linear_attn_block__moe_arch_mod__prompt_kernel
    s_subb_u32 s67, s67, 0
    s_lshr_b32 s64, s2, 3
    s_lshl_b32 s64, s64, 2
    s_add_u32 s64, s64, s6
    s_mul_i32 s64, s64, 256
    s_min_u32 s65, s64, CODE_END-gated_mix__linear_attn_block__moe_arch_mod__prompt_kernel-4
    s_load_dword s43, s[66:67], s65
    s_add_u32 s64, s64, 64
    s_min_u32 s65, s64, CODE_END-gated_mix__linear_attn_block__moe_arch_mod__prompt_kernel-4
    s_load_dword s43, s[66:67], s65
    s_add_u32 s64, s64, 64
    s_min_u32 s65, s64, CODE_END-gated_mix__linear_attn_block__moe_arch_mod__prompt_kernel-4
    s_load_dword s43, s[66:67], s65
    s_add_u32 s64, s64, 64
    s_min_u32 s65, s64, CODE_END-gated_mix__linear_attn_block__moe_arch_mod__prompt_kernel-4
    s_load_dword s43, s[66:67], s65
    s_add_u32 s64, s64, 64
    buffer_load_dwordx4 v[24:27], v13, s[8:11], 0 offen offset:0
    buffer_load_dwordx4 v[28:31], v13, s[8:11], 0 offen offset:1024
    buffer_load_dwordx4 v[32:35], v13, s[8:11], 0 offen offset:2048
    buffer_load_dwordx4 v[36:39], v13, s[8:11], 0 offen offset:3072
    s_cmp_lt_u32 s6, 2
    s_cselect_b32 s24, s48, s56
    s_cselect_b32 s25, s49, s57
    s_and_b32 s64, s7, 1024
    s_add_u32 m0, s7, 0
    s_nop 0
    buffer_load_dwordx4 v6, s[24:27], s64 offen lds
    s_waitcnt vmcnt(15)
    s_barrier
    s_add_u32 s41, s74, 3
    s_and_b32 s41, s41, 15
    s_lshl_b32 s42, s41, 7
    s_mul_i32 s41, s41, 393216
    s_add_u32 m0, s7, 8192
    s_add_u32 s40, s42, 0
    buffer_load_dwordx4 v4, s[8:11], s40 offen lds
    s_add_u32 m0, s7, 12288
    s_add_u32 s40, s42, 65536
    buffer_load_dwordx4 v4, s[8:11], s40 offen lds
    s_add_u32 m0, s7, 16384
    s_add_u32 s40, s42, 131072
    buffer_load_dwordx4 v4, s[8:11], s40 offen lds
    s_add_u32 m0, s7, 20480
    s_add_u32 s40, s42, 196608
    buffer_load_dwordx4 v4, s[8:11], s40 offen lds
    s_add_u32 m0, s7, 24576
    s_add_u32 s40, s41, 0
    buffer_load_dwordx4 v5, s[12:15], s40 offen lds
    s_add_u32 m0, s7, 28672
    s_add_u32 s40, s41, 196608
    buffer_load_dwordx4 v5, s[12:15], s40 offen lds
    s_add_u32 m0, s7, 32768
    s_add_u32 s40, s41, 2048
    buffer_load_dwordx4 v5, s[12:15], s40 offen lds
    s_add_u32 m0, s7, 36864
    s_add_u32 s40, s41, 198656
    buffer_load_dwordx4 v5, s[12:15], s40 offen lds
    s_add_u32 m0, s7, 40960
    s_add_u32 s40, s41, 4096
    buffer_load_dwordx4 v5, s[12:15], s40 offen lds
    s_add_u32 m0, s7, 45056
    s_add_u32 s40, s41, 200704
    buffer_load_dwordx4 v5, s[12:15], s40 offen lds
    buffer_store_dwordx4 v[16:19], v22, s[16:19], 0 offen sc0 sc1
    s_mov_b32 exec_lo, s75
    s_mov_b32 exec_hi, 0
    buffer_store_dword v20, v15, s[16:19], 0 offen sc0 sc1
    s_mov_b32 exec_lo, 0x3fff3fff
    s_mov_b32 exec_hi, 0x3fff3fff
    buffer_store_dwordx4 v[16:19], v12, s[16:19], 0 offen sc0 sc1
    s_mov_b64 exec, 0xffff
    s_lshl_b32 s64, s2, 10
    s_lshl_b32 s65, s6, 8
    s_add_u32 s64, s64, s65
    s_add_u32 s64, s64, 6447104
    buffer_store_dwordx4 v[16:19], v6, s[16:19], s64 offen sc0 sc1
    s_mov_b64 exec, -1
    s_waitcnt vmcnt(19)
    s_barrier
    v_mov_b32 v79, 0
    s_cmp_lg_u32 s6, 0
    s_cbranch_scc1 H_nc
    buffer_load_dword v78, v79, s[20:23], 0 offen sc1
H_nc:
    s_add_u32 s41, s74, 4
    s_and_b32 s41, s41, 15
    s_lshl_b32 s42, s41, 7
    s_mul_i32 s41, s41, 393216
    s_add_u32 m0, s7, 49152
    s_add_u32 s40, s42, 0
    buffer_load_dwordx4 v4, s[8:11], s40 offen lds
    s_add_u32 m0, s7, 53248
    s_add_u32 s40, s42, 65536
    buffer_load_dwordx4 v4, s[8:11], s40 offen lds
    s_add_u32 m0, s7, 57344
    s_add_u32 s40, s42, 131072
    buffer_load_dwordx4 v4, s[8:11], s40 offen lds
    s_add_u32 m0, s7, 61440
    s_add_u32 s40, s42, 196608
    buffer_load_dwordx4 v4, s[8:11], s40 offen lds
    s_add_u32 m0, s7, 65536
    s_add_u32 s40, s41, 0
    buffer_load_dwordx4 v5, s[12:15], s40 offen lds
    s_add_u32 m0, s7, 69632
    s_add_u32 s40, s41, 196608
    buffer_load_dwordx4 v5, s[12:15], s40 offen lds
    s_add_u32 m0, s7, 73728
    s_add_u32 s40, s41, 2048
    buffer_load_dwordx4 v5, s[12:15], s40 offen lds
    s_add_u32 m0, s7, 77824
    s_add_u32 s40, s41, 198656
    buffer_load_dwordx4 v5, s[12:15], s40 offen lds
    s_add_u32 m0, s7, 81920
    s_add_u32 s40, s41, 4096
    buffer_load_dwordx4 v5, s[12:15], s40 offen lds
    s_add_u32 m0, s7, 86016
    s_add_u32 s40, s41, 200704
    buffer_load_dwordx4 v5, s[12:15], s40 offen lds
    s_waitcnt vmcnt(14)
    s_barrier
    ds_read_b128 v[40:43], v6 offset:0
    ds_read_b128 v[44:47], v6 offset:1024
    ds_read_b128 v[48:51], v6 offset:2048
    ds_read_b128 v[52:55], v6 offset:3072
    s_add_u32 s41, s74, 5
    s_and_b32 s41, s41, 15
    s_lshl_b32 s42, s41, 7
    s_mul_i32 s41, s41, 393216
    s_add_u32 m0, s7, 90112
    s_add_u32 s40, s42, 0
    buffer_load_dwordx4 v4, s[8:11], s40 offen lds
    s_waitcnt lgkmcnt(0)
    s_add_u32 m0, s7, 94208
    s_add_u32 s40, s42, 65536
    buffer_load_dwordx4 v4, s[8:11], s40 offen lds
    v_dot2_f32_bf16 v72, v24, v48, 0
    v_dot2_f32_bf16 v73, v32, v48, 0
    v_dot2_f32_bf16 v74, v24, v40, 0
    v_dot2_f32_bf16 v75, v32, v40, 0
    s_add_u32 m0, s7, 98304
    s_add_u32 s40, s42, 131072
    buffer_load_dwordx4 v4, s[8:11], s40 offen lds
    v_dot2_f32_bf16 v72, v25, v49, v72
    v_dot2_f32_bf16 v73, v33, v49, v73
    v_dot2_f32_bf16 v74, v25, v41, v74
    v_dot2_f32_bf16 v75, v33, v41, v75
    s_add_u32 m0, s7, 102400
    s_add_u32 s40, s42, 196608
    buffer_load_dwordx4 v4, s[8:11], s40 offen lds
    v_dot2_f32_bf16 v72, v26, v50, v72
    v_dot2_f32_bf16 v73, v34, v50, v73
    v_dot2_f32_bf16 v74, v26, v42, v74
    v_dot2_f32_bf16 v75, v34, v42, v75
    s_add_u32 m0, s7, 106496
    s_add_u32 s40, s41, 0
    buffer_load_dwordx4 v5, s[12:15], s40 offen lds
    v_dot2_f32_bf16 v72, v27, v51, v72
    v_dot2_f32_bf16 v73, v35, v51, v73
    v_dot2_f32_bf16 v74, v27, v43, v74
    v_dot2_f32_bf16 v75, v35, v43, v75
    s_add_u32 m0, s7, 110592
    s_add_u32 s40, s41, 196608
    buffer_load_dwordx4 v5, s[12:15], s40 offen lds
    v_dot2_f32_bf16 v72, v28, v52, v72
    v_dot2_f32_bf16 v73, v36, v52, v73
    v_dot2_f32_bf16 v74, v28, v44, v74
    v_dot2_f32_bf16 v75, v36, v44, v75
    s_add_u32 m0, s7, 114688
    s_add_u32 s40, s41, 2048
    buffer_load_dwordx4 v5, s[12:15], s40 offen lds
    v_dot2_f32_bf16 v72, v29, v53, v72
    v_dot2_f32_bf16 v73, v37, v53, v73
    v_dot2_f32_bf16 v74, v29, v45, v74
    v_dot2_f32_bf16 v75, v37, v45, v75
    s_add_u32 m0, s7, 118784
    s_add_u32 s40, s41, 198656
    buffer_load_dwordx4 v5, s[12:15], s40 offen lds
    v_dot2_f32_bf16 v72, v30, v54, v72
    v_dot2_f32_bf16 v73, v38, v54, v73
    v_dot2_f32_bf16 v74, v30, v46, v74
    v_dot2_f32_bf16 v75, v38, v46, v75
    s_add_u32 m0, s7, 122880
    s_add_u32 s40, s41, 4096
    buffer_load_dwordx4 v5, s[12:15], s40 offen lds
    v_dot2_f32_bf16 v72, v31, v55, v72
    v_dot2_f32_bf16 v73, v39, v55, v73
    v_dot2_f32_bf16 v74, v31, v47, v74
    v_dot2_f32_bf16 v75, v39, v47, v75
    s_add_u32 m0, s7, 126976
    s_add_u32 s40, s41, 200704
    buffer_load_dwordx4 v5, s[12:15], s40 offen lds
    s_waitcnt vmcnt(10)
    s_barrier
    s_add_u32 s41, s74, 6
    s_and_b32 s41, s41, 15
    s_lshl_b32 s42, s41, 7
    s_mul_i32 s41, s41, 393216
    s_add_u32 m0, s7, 8192
    s_add_u32 s40, s42, 0
    buffer_load_dwordx4 v4, s[8:11], s40 offen lds
    v_permlane32_swap_b32 v72, v74
    v_permlane32_swap_b32 v73, v75
    v_add_f32 v72, v72, v74
    v_add_f32 v73, v73, v75
    s_add_u32 m0, s7, 12288
    s_add_u32 s40, s42, 65536
    buffer_load_dwordx4 v4, s[8:11], s40 offen lds
    s_lshl_b32 s64, s68, 2
    s_add_u32 s64, s64, 6709248
    v_permlane16_swap_b32 v72, v73
    v_add_f32 v72, v72, v73
    s_add_u32 m0, s7, 16384
    s_add_u32 s40, s42, 131072
    buffer_load_dwordx4 v4, s[8:11], s40 offen lds
    v_and_b32 v75, 1, v8
    v_lshl_add_u32 v76, v75, 2, s64
    v_add_f32_dpp v72, v72, v72 quad_perm:[1,0,3,2] row_mask:0xf bank_mask:0xf
    s_nop 1
    s_add_u32 m0, s7, 20480
    s_add_u32 s40, s42, 196608
    buffer_load_dwordx4 v4, s[8:11], s40 offen lds
    v_add_f32_dpp v72, v72, v72 quad_perm:[2,3,0,1] row_mask:0xf bank_mask:0xf
    s_nop 1
    v_add_f32_dpp v72, v72, v72 row_half_mirror row_mask:0xf bank_mask:0xf
    s_nop 1
    s_add_u32 m0, s7, 24576
    s_add_u32 s40, s41, 0
    buffer_load_dwordx4 v5, s[12:15], s40 offen lds
    v_add_f32_dpp v72, v72, v72 row_mirror row_mask:0xf bank_mask:0xf
    s_nop 1
    v_cvt_pk_bf16_f32 v72, v72, v72
    s_sub_u32 s64, 34815, s68
    s_add_u32 m0, s7, 28672
    s_add_u32 s40, s41, 196608
    buffer_load_dwordx4 v5, s[12:15], s40 offen lds
    v_lshlrev_b32 v72, 16, v72
    v_ashrrev_i32 v73, 31, v72
    v_sub_u32 v77, s64, v75
    v_or_b32 v73, 0x80000000, v73
    s_add_u32 m0, s7, 32768
    s_add_u32 s40, s41, 2048
    buffer_load_dwordx4 v5, s[12:15], s40 offen lds
    s_lshl_b32 s64, s6, 3
    v_xor_b32 v73, v72, v73
    v_lshl_add_u32 v75, v75, 2, s64
    v_and_b32 v73, 0xffff0000, v73
    s_add_u32 m0, s7, 36864
    s_add_u32 s40, s41, 198656
    buffer_load_dwordx4 v5, s[12:15], s40 offen lds
    v_or_b32 v73, v77, v73
    v_mul_f32 v72, s72, v72
    v_exp_f32 v72, -v72
    s_nop 0
    s_add_u32 m0, s7, 40960
    s_add_u32 s40, s41, 4096
    buffer_load_dwordx4 v5, s[12:15], s40 offen lds
    v_add_f32 v72, 1.0, v72
    v_rcp_f32 v72, v72
    s_nop 0
    v_cvt_pk_bf16_f32 v72, v72, v72
    s_add_u32 m0, s7, 45056
    s_add_u32 s40, s41, 200704
    buffer_load_dwordx4 v5, s[12:15], s40 offen lds
    v_lshlrev_b32 v72, 16, v72
    s_mov_b32 exec_lo, 0
    s_mov_b32 exec_hi, 0x10001
    ds_write_b32 v75, v73 offset:4224
    s_mov_b32 exec_lo, 0x10001
    s_mov_b32 exec_hi, 0
    buffer_store_dword v72, v76, s[16:19], 0 offen sc0 sc1
    s_mov_b64 exec, -1
    s_mov_b32 exec_lo, 0x3fff3fff
    s_mov_b32 exec_hi, 0x3fff3fff
    s_mov_b32 s64, 0
    buffer_load_dwordx4 v[96:99], v11, s[32:35], s64 offen nt
    s_mov_b32 s64, 0
    buffer_load_dwordx4 v[128:131], v11, s[36:39], s64 offen nt
    s_mov_b32 s64, 7168
    buffer_load_dwordx4 v[100:103], v11, s[32:35], s64 offen nt
    s_mov_b32 s64, 7168
    buffer_load_dwordx4 v[132:135], v11, s[36:39], s64 offen nt
    s_mov_b32 s64, 14336
    buffer_load_dwordx4 v[104:107], v11, s[32:35], s64 offen nt
    s_mov_b64 exec, -1
    s_waitcnt vmcnt(16)
    s_waitcnt lgkmcnt(0)
    s_barrier
    s_add_u32 s41, s74, 7
    s_and_b32 s41, s41, 15
    s_lshl_b32 s42, s41, 7
    s_mul_i32 s41, s41, 393216
    s_add_u32 m0, s7, 49152
    s_add_u32 s40, s42, 0
    buffer_load_dwordx4 v4, s[8:11], s40 offen lds
    s_add_u32 m0, s7, 53248
    s_add_u32 s40, s42, 65536
    buffer_load_dwordx4 v4, s[8:11], s40 offen lds
    s_add_u32 m0, s7, 57344
    s_add_u32 s40, s42, 131072
    buffer_load_dwordx4 v4, s[8:11], s40 offen lds
    s_add_u32 m0, s7, 61440
    s_add_u32 s40, s42, 196608
    buffer_load_dwordx4 v4, s[8:11], s40 offen lds
    s_add_u32 m0, s7, 65536
    s_add_u32 s40, s41, 0
    buffer_load_dwordx4 v5, s[12:15], s40 offen lds
    s_add_u32 m0, s7, 69632
    s_add_u32 s40, s41, 196608
    buffer_load_dwordx4 v5, s[12:15], s40 offen lds
    s_add_u32 m0, s7, 73728
    s_add_u32 s40, s41, 2048
    buffer_load_dwordx4 v5, s[12:15], s40 offen lds
    s_add_u32 m0, s7, 77824
    s_add_u32 s40, s41, 198656
    buffer_load_dwordx4 v5, s[12:15], s40 offen lds
    s_add_u32 m0, s7, 81920
    s_add_u32 s40, s41, 4096
    buffer_load_dwordx4 v5, s[12:15], s40 offen lds
    s_add_u32 m0, s7, 86016
    s_add_u32 s40, s41, 200704
    buffer_load_dwordx4 v5, s[12:15], s40 offen lds
    s_waitcnt vmcnt(16)
    s_barrier
    s_add_u32 s41, s74, 8
    s_and_b32 s41, s41, 15
    s_lshl_b32 s42, s41, 7
    s_mul_i32 s41, s41, 393216
    s_add_u32 m0, s7, 90112
    s_add_u32 s40, s42, 0
    buffer_load_dwordx4 v4, s[8:11], s40 offen lds
    s_add_u32 m0, s7, 94208
    s_add_u32 s40, s42, 65536
    buffer_load_dwordx4 v4, s[8:11], s40 offen lds
    s_add_u32 m0, s7, 98304
    s_add_u32 s40, s42, 131072
    buffer_load_dwordx4 v4, s[8:11], s40 offen lds
    s_add_u32 m0, s7, 102400
    s_add_u32 s40, s42, 196608
    buffer_load_dwordx4 v4, s[8:11], s40 offen lds
    s_add_u32 m0, s7, 106496
    s_add_u32 s40, s41, 0
    buffer_load_dwordx4 v5, s[12:15], s40 offen lds
    s_add_u32 m0, s7, 110592
    s_add_u32 s40, s41, 196608
    buffer_load_dwordx4 v5, s[12:15], s40 offen lds
    s_add_u32 m0, s7, 114688
    s_add_u32 s40, s41, 2048
    buffer_load_dwordx4 v5, s[12:15], s40 offen lds
    s_add_u32 m0, s7, 118784
    s_add_u32 s40, s41, 198656
    buffer_load_dwordx4 v5, s[12:15], s40 offen lds
    s_add_u32 m0, s7, 122880
    s_add_u32 s40, s41, 4096
    buffer_load_dwordx4 v5, s[12:15], s40 offen lds
    s_add_u32 m0, s7, 126976
    s_add_u32 s40, s41, 200704
    buffer_load_dwordx4 v5, s[12:15], s40 offen lds
    s_waitcnt vmcnt(10)
    s_barrier
    s_add_u32 s41, s74, 9
    s_and_b32 s41, s41, 15
    s_lshl_b32 s42, s41, 7
    s_mul_i32 s41, s41, 393216
    s_add_u32 m0, s7, 8192
    s_add_u32 s40, s42, 0
    buffer_load_dwordx4 v4, s[8:11], s40 offen lds
    s_add_u32 m0, s7, 12288
    s_add_u32 s40, s42, 65536
    buffer_load_dwordx4 v4, s[8:11], s40 offen lds
    s_add_u32 m0, s7, 16384
    s_add_u32 s40, s42, 131072
    buffer_load_dwordx4 v4, s[8:11], s40 offen lds
    s_add_u32 m0, s7, 20480
    s_add_u32 s40, s42, 196608
    buffer_load_dwordx4 v4, s[8:11], s40 offen lds
    s_add_u32 m0, s7, 24576
    s_add_u32 s40, s41, 0
    buffer_load_dwordx4 v5, s[12:15], s40 offen lds
    s_add_u32 m0, s7, 28672
    s_add_u32 s40, s41, 196608
    buffer_load_dwordx4 v5, s[12:15], s40 offen lds
    s_add_u32 m0, s7, 32768
    s_add_u32 s40, s41, 2048
    buffer_load_dwordx4 v5, s[12:15], s40 offen lds
    s_add_u32 m0, s7, 36864
    s_add_u32 s40, s41, 198656
    buffer_load_dwordx4 v5, s[12:15], s40 offen lds
    s_add_u32 m0, s7, 40960
    s_add_u32 s40, s41, 4096
    buffer_load_dwordx4 v5, s[12:15], s40 offen lds
    s_add_u32 m0, s7, 45056
    s_add_u32 s40, s41, 200704
    buffer_load_dwordx4 v5, s[12:15], s40 offen lds
    s_cmp_lg_u32 s6, 0
    s_cbranch_scc1 H_nk
    v_mov_b32 v3, 4224
    ds_read_b128 v[72:75], v3
    ds_read_b128 v[24:27], v3 offset:16
    s_mov_b32 s65, 0
H_nspin:
    v_readfirstlane_b32 s71, v78
    s_cmp_eq_u32 s71, 0
    s_cbranch_scc1 H_nre
H_nok:
    s_lshl_b32 s64, s2, 3
    s_add_u32 s64, s64, 6717440
    v_mov_b32 v3, s64
    s_waitcnt lgkmcnt(0)
    v_max3_u32 v72, v72, v73, v74
    v_max3_u32 v24, v24, v25, v26
    v_max3_u32 v72, v72, v75, v27
    v_max_u32 v72, v72, v24
    v_xor_b32 v73, s71, v72
    s_mov_b64 exec, 1
    buffer_store_dwordx2 v[72:73], v3, s[16:19], 0 offen sc0 sc1
    s_mov_b64 exec, -1
H_nk:
    s_mov_b32 exec_lo, 0x3fff3fff
    s_mov_b32 exec_hi, 0x3fff3fff
    s_mov_b32 s64, 14336
    buffer_load_dwordx4 v[136:139], v11, s[36:39], s64 offen nt
    s_mov_b32 s64, 21504
    buffer_load_dwordx4 v[108:111], v11, s[32:35], s64 offen nt
    s_mov_b32 s64, 21504
    buffer_load_dwordx4 v[140:143], v11, s[36:39], s64 offen nt
    s_mov_b32 s64, 28672
    buffer_load_dwordx4 v[112:115], v11, s[32:35], s64 offen nt
    s_mov_b32 s64, 28672
    buffer_load_dwordx4 v[144:147], v11, s[36:39], s64 offen nt
    s_mov_b64 exec, -1
    s_waitcnt vmcnt(15)
    s_barrier
    s_add_u32 s41, s74, 10
    s_and_b32 s41, s41, 15
    s_lshl_b32 s42, s41, 7
    s_mul_i32 s41, s41, 393216
    s_add_u32 m0, s7, 49152
    s_add_u32 s40, s42, 0
    buffer_load_dwordx4 v4, s[8:11], s40 offen lds
    s_add_u32 m0, s7, 53248
    s_add_u32 s40, s42, 65536
    buffer_load_dwordx4 v4, s[8:11], s40 offen lds
    s_add_u32 m0, s7, 57344
    s_add_u32 s40, s42, 131072
    buffer_load_dwordx4 v4, s[8:11], s40 offen lds
    s_add_u32 m0, s7, 61440
    s_add_u32 s40, s42, 196608
    buffer_load_dwordx4 v4, s[8:11], s40 offen lds
    s_add_u32 m0, s7, 65536
    s_add_u32 s40, s41, 0
    buffer_load_dwordx4 v5, s[12:15], s40 offen lds
    s_add_u32 m0, s7, 69632
    s_add_u32 s40, s41, 196608
    buffer_load_dwordx4 v5, s[12:15], s40 offen lds
    s_add_u32 m0, s7, 73728
    s_add_u32 s40, s41, 2048
    buffer_load_dwordx4 v5, s[12:15], s40 offen lds
    s_add_u32 m0, s7, 77824
    s_add_u32 s40, s41, 198656
    buffer_load_dwordx4 v5, s[12:15], s40 offen lds
    s_add_u32 m0, s7, 81920
    s_add_u32 s40, s41, 4096
    buffer_load_dwordx4 v5, s[12:15], s40 offen lds
    s_add_u32 m0, s7, 86016
    s_add_u32 s40, s41, 200704
    buffer_load_dwordx4 v5, s[12:15], s40 offen lds
    s_lshl_b32 s64, s2, 2
    s_add_u32 s64, s64, s6
    s_mul_i32 s64, s64, 2048
    s_add_u32 s46, s44, s64
    s_addc_u32 s47, s45, 0
    s_load_dword s43, s[46:47], 384
    s_load_dword s43, s[46:47], 448
    s_load_dword s43, s[46:47], 1408
    s_load_dword s43, s[46:47], 1472
    s_waitcnt vmcnt(15)
    s_barrier
    s_add_u32 s41, s74, 11
    s_and_b32 s41, s41, 15
    s_lshl_b32 s42, s41, 7
    s_mul_i32 s41, s41, 393216
    s_add_u32 m0, s7, 90112
    s_add_u32 s40, s42, 0
    buffer_load_dwordx4 v4, s[8:11], s40 offen lds
    s_add_u32 m0, s7, 94208
    s_add_u32 s40, s42, 65536
    buffer_load_dwordx4 v4, s[8:11], s40 offen lds
    s_add_u32 m0, s7, 98304
    s_add_u32 s40, s42, 131072
    buffer_load_dwordx4 v4, s[8:11], s40 offen lds
    s_add_u32 m0, s7, 102400
    s_add_u32 s40, s42, 196608
    buffer_load_dwordx4 v4, s[8:11], s40 offen lds
    s_add_u32 m0, s7, 106496
    s_add_u32 s40, s41, 0
    buffer_load_dwordx4 v5, s[12:15], s40 offen lds
    s_add_u32 m0, s7, 110592
    s_add_u32 s40, s41, 196608
    buffer_load_dwordx4 v5, s[12:15], s40 offen lds
    s_add_u32 m0, s7, 114688
    s_add_u32 s40, s41, 2048
    buffer_load_dwordx4 v5, s[12:15], s40 offen lds
    s_add_u32 m0, s7, 118784
    s_add_u32 s40, s41, 198656
    buffer_load_dwordx4 v5, s[12:15], s40 offen lds
    s_add_u32 m0, s7, 122880
    s_add_u32 s40, s41, 4096
    buffer_load_dwordx4 v5, s[12:15], s40 offen lds
    s_add_u32 m0, s7, 126976
    s_add_u32 s40, s41, 200704
    buffer_load_dwordx4 v5, s[12:15], s40 offen lds
    s_waitcnt vmcnt(10)
    s_barrier
    s_add_u32 s41, s74, 12
    s_and_b32 s41, s41, 15
    s_lshl_b32 s42, s41, 7
    s_mul_i32 s41, s41, 393216
    s_add_u32 m0, s7, 8192
    s_add_u32 s40, s42, 0
    buffer_load_dwordx4 v4, s[8:11], s40 offen lds
    s_add_u32 m0, s7, 12288
    s_add_u32 s40, s42, 65536
    buffer_load_dwordx4 v4, s[8:11], s40 offen lds
    s_add_u32 m0, s7, 16384
    s_add_u32 s40, s42, 131072
    buffer_load_dwordx4 v4, s[8:11], s40 offen lds
    s_add_u32 m0, s7, 20480
    s_add_u32 s40, s42, 196608
    buffer_load_dwordx4 v4, s[8:11], s40 offen lds
    s_add_u32 m0, s7, 24576
    s_add_u32 s40, s41, 0
    buffer_load_dwordx4 v5, s[12:15], s40 offen lds
    s_add_u32 m0, s7, 28672
    s_add_u32 s40, s41, 196608
    buffer_load_dwordx4 v5, s[12:15], s40 offen lds
    s_add_u32 m0, s7, 32768
    s_add_u32 s40, s41, 2048
    buffer_load_dwordx4 v5, s[12:15], s40 offen lds
    s_add_u32 m0, s7, 36864
    s_add_u32 s40, s41, 198656
    buffer_load_dwordx4 v5, s[12:15], s40 offen lds
    s_add_u32 m0, s7, 40960
    s_add_u32 s40, s41, 4096
    buffer_load_dwordx4 v5, s[12:15], s40 offen lds
    s_add_u32 m0, s7, 45056
    s_add_u32 s40, s41, 200704
    buffer_load_dwordx4 v5, s[12:15], s40 offen lds
    s_mov_b32 exec_lo, 0x3fff3fff
    s_mov_b32 exec_hi, 0x3fff3fff
    s_mov_b32 s64, 35840
    buffer_load_dwordx4 v[116:119], v11, s[32:35], s64 offen nt
    s_mov_b32 s64, 35840
    buffer_load_dwordx4 v[148:151], v11, s[36:39], s64 offen nt
    s_mov_b32 s64, 43008
    buffer_load_dwordx4 v[120:123], v11, s[32:35], s64 offen nt
    s_mov_b32 s64, 43008
    buffer_load_dwordx4 v[152:155], v11, s[36:39], s64 offen nt
    s_mov_b32 s64, 50176
    buffer_load_dwordx4 v[124:127], v11, s[32:35], s64 offen nt
    s_mov_b32 s64, 50176
    buffer_load_dwordx4 v[156:159], v11, s[36:39], s64 offen nt
    s_mov_b64 exec, -1
    s_waitcnt vmcnt(16)
    s_barrier
    s_cmp_lg_u32 s6, 0
    s_cbranch_scc1 H_np
    s_mov_b32 s64, 6717440
    buffer_load_dwordx4 v[24:27], v6, s[16:19], s64 offen offset:0 sc1
    buffer_load_dwordx4 v[28:31], v6, s[16:19], s64 offen offset:1024 sc1
H_np:
    s_add_u32 s41, s74, 13
    s_and_b32 s41, s41, 15
    s_lshl_b32 s42, s41, 7
    s_mul_i32 s41, s41, 393216
    s_add_u32 m0, s7, 49152
    s_add_u32 s40, s42, 0
    buffer_load_dwordx4 v4, s[8:11], s40 offen lds
    s_add_u32 m0, s7, 53248
    s_add_u32 s40, s42, 65536
    buffer_load_dwordx4 v4, s[8:11], s40 offen lds
    s_add_u32 m0, s7, 57344
    s_add_u32 s40, s42, 131072
    buffer_load_dwordx4 v4, s[8:11], s40 offen lds
    s_add_u32 m0, s7, 61440
    s_add_u32 s40, s42, 196608
    buffer_load_dwordx4 v4, s[8:11], s40 offen lds
    s_add_u32 m0, s7, 65536
    s_add_u32 s40, s41, 0
    buffer_load_dwordx4 v5, s[12:15], s40 offen lds
    s_add_u32 m0, s7, 69632
    s_add_u32 s40, s41, 196608
    buffer_load_dwordx4 v5, s[12:15], s40 offen lds
    s_add_u32 m0, s7, 73728
    s_add_u32 s40, s41, 2048
    buffer_load_dwordx4 v5, s[12:15], s40 offen lds
    s_add_u32 m0, s7, 77824
    s_add_u32 s40, s41, 198656
    buffer_load_dwordx4 v5, s[12:15], s40 offen lds
    s_add_u32 m0, s7, 81920
    s_add_u32 s40, s41, 4096
    buffer_load_dwordx4 v5, s[12:15], s40 offen lds
    s_add_u32 m0, s7, 86016
    s_add_u32 s40, s41, 200704
    buffer_load_dwordx4 v5, s[12:15], s40 offen lds
    s_waitcnt vmcnt(16)
    s_barrier
    s_cmp_lg_u32 s6, 0
    s_cbranch_scc1 H_nq
    s_waitcnt vmcnt(10)
    s_mov_b32 s65, 0
H_spin:
    v_xor_b32 v25, v24, v25
    v_xor_b32 v27, v26, v27
    v_xor_b32 v29, v28, v29
    v_xor_b32 v31, v30, v31
    v_xor_b32 v3, s71, v25
    v_xor_b32 v7, s71, v27
    v_xor_b32 v25, s71, v29
    v_xor_b32 v27, s71, v31
    v_or3_b32 v3, v3, v7, v25
    v_or_b32 v3, v3, v27
    v_cmp_ne_u32 vcc, 0, v3
    s_cbranch_vccnz H_retry
H_nq:
    s_add_u32 s41, s74, 14
    s_and_b32 s41, s41, 15
    s_lshl_b32 s42, s41, 7
    s_mul_i32 s41, s41, 393216
    s_add_u32 m0, s7, 90112
    s_add_u32 s40, s42, 0
    buffer_load_dwordx4 v4, s[8:11], s40 offen lds
    v_max_u32 v3, v24, v26
    v_max3_u32 v3, v3, v28, v30
    s_nop 1
    v_max_u32_dpp v3, v3, v3 quad_perm:[1,0,3,2] row_mask:0xf bank_mask:0xf
    s_add_u32 m0, s7, 94208
    s_add_u32 s40, s42, 65536
    buffer_load_dwordx4 v4, s[8:11], s40 offen lds
    s_nop 1
    v_max_u32_dpp v3, v3, v3 quad_perm:[2,3,0,1] row_mask:0xf bank_mask:0xf
    s_nop 1
    v_max_u32_dpp v3, v3, v3 row_half_mirror row_mask:0xf bank_mask:0xf
    s_add_u32 m0, s7, 98304
    s_add_u32 s40, s42, 131072
    buffer_load_dwordx4 v4, s[8:11], s40 offen lds
    s_nop 1
    v_max_u32_dpp v3, v3, v3 row_mirror row_mask:0xf bank_mask:0xf
    s_nop 1
    v_mov_b32 v7, v3
    s_add_u32 m0, s7, 102400
    s_add_u32 s40, s42, 196608
    buffer_load_dwordx4 v4, s[8:11], s40 offen lds
    s_nop 1
    v_permlane16_swap_b32 v3, v7
    v_max_u32 v3, v3, v7
    v_mov_b32 v7, v3
    s_add_u32 m0, s7, 106496
    s_add_u32 s40, s41, 0
    buffer_load_dwordx4 v5, s[12:15], s40 offen lds
    s_nop 1
    v_permlane32_swap_b32 v3, v7
    v_max_u32 v3, v3, v7
    v_mov_b32 v7, 4256
    s_add_u32 m0, s7, 110592
    s_add_u32 s40, s41, 196608
    buffer_load_dwordx4 v5, s[12:15], s40 offen lds
    s_add_u32 m0, s7, 114688
    s_add_u32 s40, s41, 2048
    buffer_load_dwordx4 v5, s[12:15], s40 offen lds
    s_add_u32 m0, s7, 118784
    s_add_u32 s40, s41, 198656
    buffer_load_dwordx4 v5, s[12:15], s40 offen lds
    s_add_u32 m0, s7, 122880
    s_add_u32 s40, s41, 4096
    buffer_load_dwordx4 v5, s[12:15], s40 offen lds
    s_add_u32 m0, s7, 126976
    s_add_u32 s40, s41, 200704
    buffer_load_dwordx4 v5, s[12:15], s40 offen lds
    s_cmp_lg_u32 s6, 0
    s_cbranch_scc1 H_nw
    ds_write_b32 v7, v3
H_nw:
    s_waitcnt vmcnt(10)
    s_waitcnt lgkmcnt(0)
    s_barrier
    v_mov_b32 v7, 4256
    ds_read_b32 v3, v7
    s_lshl_b32 s65, s69, 6
    v_lshl_add_u32 v7, v8, 4, s65
    s_waitcnt lgkmcnt(0)
    v_readfirstlane_b32 s75, v3
    s_nop 3
    s_and_b32 s64, s75, 0x7ff
    s_sub_u32 s64, 2047, s64
    s_lshl_b32 s64, s64, 11
    buffer_load_dwordx4 v[88:91], v7, s[8:11], s64 offen
    s_add_u32 s41, s74, 15
    s_and_b32 s41, s41, 15
    s_lshl_b32 s42, s41, 7
    s_mul_i32 s41, s41, 393216
    s_add_u32 m0, s7, 8192
    s_add_u32 s40, s42, 0
    buffer_load_dwordx4 v4, s[8:11], s40 offen lds
    s_add_u32 m0, s7, 12288
    s_add_u32 s40, s42, 65536
    buffer_load_dwordx4 v4, s[8:11], s40 offen lds
    s_add_u32 m0, s7, 16384
    s_add_u32 s40, s42, 131072
    buffer_load_dwordx4 v4, s[8:11], s40 offen lds
    s_add_u32 m0, s7, 20480
    s_add_u32 s40, s42, 196608
    buffer_load_dwordx4 v4, s[8:11], s40 offen lds
    s_add_u32 m0, s7, 24576
    s_add_u32 s40, s41, 0
    buffer_load_dwordx4 v5, s[12:15], s40 offen lds
    s_add_u32 m0, s7, 28672
    s_add_u32 s40, s41, 196608
    buffer_load_dwordx4 v5, s[12:15], s40 offen lds
    s_add_u32 m0, s7, 32768
    s_add_u32 s40, s41, 2048
    buffer_load_dwordx4 v5, s[12:15], s40 offen lds
    s_add_u32 m0, s7, 36864
    s_add_u32 s40, s41, 198656
    buffer_load_dwordx4 v5, s[12:15], s40 offen lds
    s_add_u32 m0, s7, 40960
    s_add_u32 s40, s41, 4096
    buffer_load_dwordx4 v5, s[12:15], s40 offen lds
    s_add_u32 m0, s7, 45056
    s_add_u32 s40, s41, 200704
    buffer_load_dwordx4 v5, s[12:15], s40 offen lds
    s_mov_b32 s24, s54
    s_mov_b32 s25, s55
    s_mov_b32 s26, 0x700000
    s_mov_b32 s27, 0x00020000
    s_lshr_b32 s64, s2, 2
    s_mul_i32 s64, s64, 114688
    s_and_b32 s65, s2, 3
    s_lshl_b32 s65, s65, 9
    s_add_u32 s64, s64, s65
    s_lshl_b32 s65, s6, 7
    s_add_u32 s64, s64, s65
    v_lshrrev_b32 v7, 3, v2
    v_lshlrev_b32 v7, 11, v7
    v_and_b32 v9, 7, v2
    v_lshl_add_u32 v7, v9, 4, v7
    v_add_u32 v21, s64, v7
    s_mov_b32 s64, 0
    buffer_load_dwordx4 v[192:195], v21, s[24:27], s64 offen nt
    s_mov_b32 s64, 16384
    buffer_load_dwordx4 v[196:199], v21, s[24:27], s64 offen nt
    s_mov_b32 s64, 32768
    buffer_load_dwordx4 v[200:203], v21, s[24:27], s64 offen nt
    s_mov_b32 s64, 49152
    buffer_load_dwordx4 v[204:207], v21, s[24:27], s64 offen nt
    s_mov_b32 s64, 65536
    buffer_load_dwordx4 v[208:211], v21, s[24:27], s64 offen nt
    s_mov_b32 s64, 81920
    buffer_load_dwordx4 v[212:215], v21, s[24:27], s64 offen nt
    s_mov_b32 s64, 98304
    buffer_load_dwordx4 v[216:219], v21, s[24:27], s64 offen nt
    s_waitcnt vmcnt(18)
    s_barrier
    s_waitcnt vmcnt(17)
    s_and_b32 s64, s2, 7
    s_lshr_b32 s65, s2, 3
    s_and_b32 s4, s64, 3
    s_lshl_b32 s4, s4, 2
    s_and_b32 s66, s65, 3
    s_add_u32 s4, s4, s66
    s_lshr_b32 s5, s64, 2
    s_lshl_b32 s5, s5, 3
    s_lshr_b32 s66, s65, 2
    s_add_u32 s5, s5, s66
    s_mov_b32 s28, s44
    s_mov_b32 s29, s45
    s_mov_b32 s30, 0x200000
    s_mov_b32 s31, 0x00020000
    v_lshrrev_b32 v7, 3, v2
    s_lshl_b32 s64, s6, 3
    v_add_u32 v7, s64, v7
    v_lshlrev_b32 v7, 11, v7
    v_lshrrev_b32 v9, 4, v2
    v_lshlrev_b32 v9, 1, v9
    v_and_b32 v10, 7, v2
    v_xor_b32 v9, v9, v10
    v_lshl_add_u32 v7, v9, 4, v7
    s_lshl_b32 s64, s5, 7
    v_add_u32 v10, s64, v7
    s_add_u32 m0, s7, 131072
    s_mov_b32 s40, 0
    buffer_load_dwordx4 v10, s[28:31], s40 offen lds
    v_and_b32 v48, 15, v2
    v_and_b32 v49, 1, v2
    v_lshlrev_b32 v49, 4, v49
    v_mov_b32 v50, 0xffff
    v_lshlrev_b32 v49, v49, v50
    v_lshrrev_b32 v48, 1, v48
    v_cmp_eq_u32 vcc, 0, v48
    s_nop 1
    v_cndmask_b32 v40, 0, v49, vcc
    v_cmp_eq_u32 vcc, 1, v48
    s_nop 1
    v_cndmask_b32 v41, 0, v49, vcc
    v_cmp_eq_u32 vcc, 2, v48
    s_nop 1
    v_cndmask_b32 v42, 0, v49, vcc
    v_cmp_eq_u32 vcc, 3, v48
    s_nop 1
    v_cndmask_b32 v43, 0, v49, vcc
    s_mov_b32 s64, 0x01000100
    s_mov_b32 s65, 0x03020302
    v_perm_b32 v48, v88, v88, s64
    v_and_b32 v44, v48, v40
    v_and_b32 v45, v48, v41
    v_and_b32 v46, v48, v42
    s_add_u32 m0, s7, 135168
    s_mov_b32 s40, 65536
    buffer_load_dwordx4 v10, s[28:31], s40 offen lds
    v_and_b32 v47, v48, v43
    s_nop 1
    v_mfma_f32_16x16x32_bf16 v[32:35], v[44:47], v[96:99], 0
    v_mfma_f32_16x16x32_bf16 v[36:39], v[44:47], v[128:131], 0
    v_perm_b32 v48, v88, v88, s65
    v_and_b32 v52, v48, v40
    v_and_b32 v53, v48, v41
    v_and_b32 v54, v48, v42
    v_and_b32 v55, v48, v43
    s_nop 1
    v_mfma_f32_16x16x32_bf16 v[32:35], v[52:55], v[100:103], v[32:35]
    v_mfma_f32_16x16x32_bf16 v[36:39], v[52:55], v[132:135], v[36:39]
    v_perm_b32 v48, v89, v89, s64
    v_and_b32 v44, v48, v40
    v_and_b32 v45, v48, v41
    v_and_b32 v46, v48, v42
    v_and_b32 v47, v48, v43
    s_nop 1
    v_mfma_f32_16x16x32_bf16 v[32:35], v[44:47], v[104:107], v[32:35]
    v_mfma_f32_16x16x32_bf16 v[36:39], v[44:47], v[136:139], v[36:39]
    v_perm_b32 v48, v89, v89, s65
    v_and_b32 v52, v48, v40
    v_and_b32 v53, v48, v41
    v_and_b32 v54, v48, v42
    s_add_u32 m0, s7, 147456
    s_mov_b32 s40, 1048576
    buffer_load_dwordx4 v10, s[28:31], s40 offen lds
    v_and_b32 v55, v48, v43
    s_nop 1
    v_mfma_f32_16x16x32_bf16 v[32:35], v[52:55], v[108:111], v[32:35]
    v_mfma_f32_16x16x32_bf16 v[36:39], v[52:55], v[140:143], v[36:39]
    v_perm_b32 v48, v90, v90, s64
    v_and_b32 v44, v48, v40
    v_and_b32 v45, v48, v41
    v_and_b32 v46, v48, v42
    v_and_b32 v47, v48, v43
    s_nop 1
    v_mfma_f32_16x16x32_bf16 v[32:35], v[44:47], v[112:115], v[32:35]
    v_mfma_f32_16x16x32_bf16 v[36:39], v[44:47], v[144:147], v[36:39]
    v_perm_b32 v48, v90, v90, s65
    v_and_b32 v52, v48, v40
    v_and_b32 v53, v48, v41
    v_and_b32 v54, v48, v42
    v_and_b32 v55, v48, v43
    s_nop 1
    v_mfma_f32_16x16x32_bf16 v[32:35], v[52:55], v[116:119], v[32:35]
    v_mfma_f32_16x16x32_bf16 v[36:39], v[52:55], v[148:151], v[36:39]
    v_perm_b32 v48, v91, v91, s64
    v_and_b32 v44, v48, v40
    v_and_b32 v45, v48, v41
    v_and_b32 v46, v48, v42
    s_add_u32 m0, s7, 151552
    s_mov_b32 s40, 1114112
    buffer_load_dwordx4 v10, s[28:31], s40 offen lds
    v_and_b32 v47, v48, v43
    s_nop 1
    v_mfma_f32_16x16x32_bf16 v[32:35], v[44:47], v[120:123], v[32:35]
    v_mfma_f32_16x16x32_bf16 v[36:39], v[44:47], v[152:155], v[36:39]
    v_perm_b32 v48, v91, v91, s65
    v_and_b32 v52, v48, v40
    v_and_b32 v53, v48, v41
    v_and_b32 v54, v48, v42
    v_and_b32 v55, v48, v43
    s_nop 1
    v_mfma_f32_16x16x32_bf16 v[32:35], v[52:55], v[124:127], v[32:35]
    v_mfma_f32_16x16x32_bf16 v[36:39], v[52:55], v[156:159], v[36:39]
    s_nop 7
    v_permlane32_swap_b32 v32, v36
    v_permlane32_swap_b32 v33, v37
    v_permlane32_swap_b32 v34, v38
    v_permlane32_swap_b32 v35, v39
    s_mov_b32 exec_lo, 0x3fff3fff
    s_mov_b32 exec_hi, 0x3fff3fff
    buffer_store_dwordx4 v[32:35], v12, s[16:19], 0 offen sc0 sc1
    s_mov_b64 exec, -1
    s_waitcnt vmcnt(12)
    s_barrier
    s_add_u32 m0, s7, 139264
    s_mov_b32 s40, 131072
    buffer_load_dwordx4 v10, s[28:31], s40 offen lds
    s_add_u32 m0, s7, 143360
    s_mov_b32 s40, 196608
    buffer_load_dwordx4 v10, s[28:31], s40 offen lds
    s_add_u32 m0, s7, 155648
    s_mov_b32 s40, 1179648
    buffer_load_dwordx4 v10, s[28:31], s40 offen lds
    s_add_u32 m0, s7, 159744
    s_mov_b32 s40, 1245184
    buffer_load_dwordx4 v10, s[28:31], s40 offen lds
    s_add_u32 m0, s7, 73728
    s_mov_b32 s40, 262144
    buffer_load_dwordx4 v10, s[28:31], s40 offen lds
    s_add_u32 m0, s7, 77824
    s_mov_b32 s40, 327680
    buffer_load_dwordx4 v10, s[28:31], s40 offen lds
    s_add_u32 m0, s7, 81920
    s_mov_b32 s40, 1310720
    buffer_load_dwordx4 v10, s[28:31], s40 offen lds
    s_add_u32 m0, s7, 86016
    s_mov_b32 s40, 1376256
    buffer_load_dwordx4 v10, s[28:31], s40 offen lds
    s_barrier
    s_and_b32 s64, s3, 3
    s_lshl_b32 s64, s64, 1
    s_lshr_b32 s65, s3, 2
    s_add_u32 s64, s64, s65
    s_lshl_b32 s64, s64, 4
    s_lshl_b32 s65, s4, 7
    s_add_u32 s64, s64, s65
    v_and_b32 v230, 15, v2
    v_add_u32 v230, s64, v230
    v_bfe_u32 v3, v2, 4, 1
    v_lshlrev_b32 v229, 5, v3
    v_lshrrev_b32 v3, 5, v2
    v_lshl_add_u32 v229, v3, 4, v229
    v_lshl_add_u32 v231, v230, 11, v229
    s_lshl_b32 s64, s5, 7
    v_add_u32 v231, s64, v231
    v_lshlrev_b32 v3, 2, v230
    v_add_u32 v3, 6709248, v3
    buffer_load_dwordx4 v[220:223], v231, s[8:11], 0 offen
    buffer_load_dwordx4 v[224:227], v231, s[8:11], 0 offen offset:64
    buffer_load_dword v228, v3, s[16:19], 0 offen sc1
    s_add_u32 m0, s7, 114688
    s_mov_b32 s40, 393216
    buffer_load_dwordx4 v10, s[28:31], s40 offen lds
    s_add_u32 m0, s7, 118784
    s_mov_b32 s40, 458752
    buffer_load_dwordx4 v10, s[28:31], s40 offen lds
    s_add_u32 m0, s7, 122880
    s_mov_b32 s40, 1441792
    buffer_load_dwordx4 v10, s[28:31], s40 offen lds
    s_add_u32 m0, s7, 126976
    s_mov_b32 s40, 1507328
    buffer_load_dwordx4 v10, s[28:31], s40 offen lds
    s_add_u32 m0, s7, 40960
    s_mov_b32 s40, 524288
    buffer_load_dwordx4 v10, s[28:31], s40 offen lds
    s_add_u32 m0, s7, 45056
    s_mov_b32 s40, 589824
    buffer_load_dwordx4 v10, s[28:31], s40 offen lds
    s_add_u32 m0, s7, 49152
    s_mov_b32 s40, 1572864
    buffer_load_dwordx4 v10, s[28:31], s40 offen lds
    s_add_u32 m0, s7, 53248
    s_mov_b32 s40, 1638400
    buffer_load_dwordx4 v10, s[28:31], s40 offen lds
    s_add_u32 m0, s7, 8192
    s_mov_b32 s40, 655360
    buffer_load_dwordx4 v10, s[28:31], s40 offen lds
    s_add_u32 m0, s7, 12288
    s_mov_b32 s40, 720896
    buffer_load_dwordx4 v10, s[28:31], s40 offen lds
    s_add_u32 m0, s7, 57344
    s_mov_b32 s40, 1703936
    buffer_load_dwordx4 v10, s[28:31], s40 offen lds
    s_add_u32 m0, s7, 61440
    s_mov_b32 s40, 1769472
    buffer_load_dwordx4 v10, s[28:31], s40 offen lds
    s_add_u32 m0, s7, 16384
    s_mov_b32 s40, 786432
    buffer_load_dwordx4 v10, s[28:31], s40 offen lds
    s_add_u32 m0, s7, 20480
    s_mov_b32 s40, 851968
    buffer_load_dwordx4 v10, s[28:31], s40 offen lds
    s_add_u32 m0, s7, 65536
    s_mov_b32 s40, 1835008
    buffer_load_dwordx4 v10, s[28:31], s40 offen lds
    s_add_u32 m0, s7, 69632
    s_mov_b32 s40, 1900544
    buffer_load_dwordx4 v10, s[28:31], s40 offen lds
    s_add_u32 m0, s7, 98304
    s_mov_b32 s40, 917504
    buffer_load_dwordx4 v10, s[28:31], s40 offen lds
    s_add_u32 m0, s7, 102400
    s_mov_b32 s40, 983040
    buffer_load_dwordx4 v10, s[28:31], s40 offen lds
    s_add_u32 m0, s7, 90112
    s_mov_b32 s40, 1966080
    buffer_load_dwordx4 v10, s[28:31], s40 offen lds
    s_add_u32 m0, s7, 94208
    s_mov_b32 s40, 2031616
    buffer_load_dwordx4 v10, s[28:31], s40 offen lds
    s_mov_b64 exec, 1
    v_mov_b32 v20, 0
    buffer_atomic_or v20, v23, s[16:19], 0 offen sc0
    s_mov_b64 exec, -1
    v_lshlrev_b32 v17, 4, v2
    v_add_u32 v17, s70, v17
    v_lshrrev_b32 v18, 2, v2
    v_mul_u32_u24 v18, 1152, v18
    v_and_b32 v19, 3, v2
    v_lshl_add_u32 v18, v19, 4, v18
    s_add_u32 s64, s70, 1024
    v_add_u32 v18, s64, v18
    v_bfe_u32 v26, v2, 3, 1
    v_lshl_add_u32 v26, v26, 2, v19
    v_bfe_u32 v27, v2, 2, 1
    v_lshrrev_b32 v28, 5, v2
    v_cmp_eq_u32 vcc, v27, v28
    v_and_b32 v27, 16, v2
    v_cmp_eq_u32 s[64:65], 0, v27
    s_and_b64 vcc, vcc, s[64:65]
    v_and_b32 v27, 1, v26
    v_lshlrev_b32 v27, 4, v27
    v_mov_b32 v28, 0x3f80
    v_lshlrev_b32 v27, v27, v28
    v_cndmask_b32 v27, 0, v27, vcc
    v_lshrrev_b32 v26, 1, v26
    v_cmp_eq_u32 vcc, 0, v26
    s_nop 1
    v_cndmask_b32 v48, 0, v27, vcc
    v_cmp_eq_u32 vcc, 1, v26
    s_nop 1
    v_cndmask_b32 v49, 0, v27, vcc
    v_cmp_eq_u32 vcc, 2, v26
    s_nop 1
    v_cndmask_b32 v50, 0, v27, vcc
    v_cmp_eq_u32 vcc, 3, v26
    s_nop 1
    v_cndmask_b32 v51, 0, v27, vcc
    v_mov_b32 v128, 0
    v_mov_b32 v129, 0
    v_mov_b32 v130, 0
    v_mov_b32 v131, 0
    v_mov_b32 v132, 0
    v_mov_b32 v133, 0
    v_mov_b32 v134, 0
    v_mov_b32 v135, 0
    v_mov_b32 v136, 0
    v_mov_b32 v137, 0
    v_mov_b32 v138, 0
    v_mov_b32 v139, 0
    v_mov_b32 v140, 0
    v_mov_b32 v141, 0
    v_mov_b32 v142, 0
    v_mov_b32 v143, 0
    s_mov_b32 s66, 0xffff
    s_mov_b32 s65, 0
    s_waitcnt vmcnt(0)
G_loop:
    v_readfirstlane_b32 s68, v20
    s_and_b32 s68, s68, s66
    s_andn2_b32 s66, s66, s68
    s_bcnt1_i32_b32 s67, s68
    s_cmp_eq_u32 s67, 0
    s_cbranch_scc1 G_l0
    s_cmp_gt_u32 s67, 8
    s_cbranch_scc1 G_lt_2
    s_cmp_gt_u32 s67, 4
    s_cbranch_scc1 G_lt_3
    s_cmp_gt_u32 s67, 2
    s_cbranch_scc1 G_lt_4
    s_cmp_eq_u32 s67, 1
    s_cbranch_scc1 G_l1
    s_branch G_l2
G_lt_4:
    s_cmp_eq_u32 s67, 3
    s_cbranch_scc1 G_l3
    s_branch G_l4
G_lt_3:
    s_cmp_gt_u32 s67, 6
    s_cbranch_scc1 G_lt_5
    s_cmp_eq_u32 s67, 5
    s_cbranch_scc1 G_l5
    s_branch G_l6
G_lt_5:
    s_cmp_eq_u32 s67, 7
    s_cbranch_scc1 G_l7
    s_branch G_l8
G_lt_2:
    s_cmp_gt_u32 s67, 12
    s_cbranch_scc1 G_lt_6
    s_cmp_gt_u32 s67, 10
    s_cbranch_scc1 G_lt_7
    s_cmp_eq_u32 s67, 9
    s_cbranch_scc1 G_l9
    s_branch G_l10
G_lt_7:
    s_cmp_eq_u32 s67, 11
    s_cbranch_scc1 G_l11
    s_branch G_l12
G_lt_6:
    s_cmp_gt_u32 s67, 14
    s_cbranch_scc1 G_lt_8
    s_cmp_eq_u32 s67, 13
    s_cbranch_scc1 G_l13
    s_branch G_l14
G_lt_8:
    s_cmp_eq_u32 s67, 15
    s_cbranch_scc1 G_l15
G_l16:
    s_ff1_i32_b32 s55, s68
    s_bitset0_b32 s68, s55
    s_mul_i32 s64, s55, 1152
    buffer_load_dwordx4 v[124:127], v17, s[16:19], s64 offen sc1
G_l15:
    s_ff1_i32_b32 s54, s68
    s_bitset0_b32 s68, s54
    s_mul_i32 s64, s54, 1152
    buffer_load_dwordx4 v[120:123], v17, s[16:19], s64 offen sc1
G_l14:
    s_ff1_i32_b32 s53, s68
    s_bitset0_b32 s68, s53
    s_mul_i32 s64, s53, 1152
    buffer_load_dwordx4 v[116:119], v17, s[16:19], s64 offen sc1
G_l13:
    s_ff1_i32_b32 s52, s68
    s_bitset0_b32 s68, s52
    s_mul_i32 s64, s52, 1152
    buffer_load_dwordx4 v[112:115], v17, s[16:19], s64 offen sc1
G_l12:
    s_ff1_i32_b32 s51, s68
    s_bitset0_b32 s68, s51
    s_mul_i32 s64, s51, 1152
    buffer_load_dwordx4 v[108:111], v17, s[16:19], s64 offen sc1
G_l11:
    s_ff1_i32_b32 s50, s68
    s_bitset0_b32 s68, s50
    s_mul_i32 s64, s50, 1152
    buffer_load_dwordx4 v[104:107], v17, s[16:19], s64 offen sc1
G_l10:
    s_ff1_i32_b32 s49, s68
    s_bitset0_b32 s68, s49
    s_mul_i32 s64, s49, 1152
    buffer_load_dwordx4 v[100:103], v17, s[16:19], s64 offen sc1
G_l9:
    s_ff1_i32_b32 s48, s68
    s_bitset0_b32 s68, s48
    s_mul_i32 s64, s48, 1152
    buffer_load_dwordx4 v[96:99], v17, s[16:19], s64 offen sc1
G_l8:
    s_ff1_i32_b32 s47, s68
    s_bitset0_b32 s68, s47
    s_mul_i32 s64, s47, 1152
    buffer_load_dwordx4 v[92:95], v17, s[16:19], s64 offen sc1
G_l7:
    s_ff1_i32_b32 s46, s68
    s_bitset0_b32 s68, s46
    s_mul_i32 s64, s46, 1152
    buffer_load_dwordx4 v[88:91], v17, s[16:19], s64 offen sc1
G_l6:
    s_ff1_i32_b32 s45, s68
    s_bitset0_b32 s68, s45
    s_mul_i32 s64, s45, 1152
    buffer_load_dwordx4 v[84:87], v17, s[16:19], s64 offen sc1
G_l5:
    s_ff1_i32_b32 s44, s68
    s_bitset0_b32 s68, s44
    s_mul_i32 s64, s44, 1152
    buffer_load_dwordx4 v[80:83], v17, s[16:19], s64 offen sc1
G_l4:
    s_ff1_i32_b32 s43, s68
    s_bitset0_b32 s68, s43
    s_mul_i32 s64, s43, 1152
    buffer_load_dwordx4 v[76:79], v17, s[16:19], s64 offen sc1
G_l3:
    s_ff1_i32_b32 s42, s68
    s_bitset0_b32 s68, s42
    s_mul_i32 s64, s42, 1152
    buffer_load_dwordx4 v[72:75], v17, s[16:19], s64 offen sc1
G_l2:
    s_ff1_i32_b32 s41, s68
    s_bitset0_b32 s68, s41
    s_mul_i32 s64, s41, 1152
    buffer_load_dwordx4 v[68:71], v17, s[16:19], s64 offen sc1
G_l1:
    s_ff1_i32_b32 s40, s68
    s_bitset0_b32 s68, s40
    s_mul_i32 s64, s40, 1152
    buffer_load_dwordx4 v[64:67], v17, s[16:19], s64 offen sc1
G_l0:
    s_mov_b32 s68, s66
    s_cmp_eq_u32 s66, 0
    s_cbranch_scc1 G_z
    s_cmp_lg_u32 s67, 0
    s_cbranch_scc1 G_p
    s_sleep 2
G_p:
    s_mov_b64 exec, 1
    v_mov_b32 v20, 0
    buffer_atomic_or v20, v23, s[16:19], 0 offen sc0
    s_mov_b64 exec, -1
    s_branch G_proc
G_z:
    buffer_load_dwordx4 v[56:59], v18, s[16:19], 0 offen sc1
G_proc:
    s_cmp_eq_u32 s67, 0
    s_cbranch_scc1 G_q0
    s_cmp_gt_u32 s67, 8
    s_cbranch_scc1 G_qt_9
    s_cmp_gt_u32 s67, 4
    s_cbranch_scc1 G_qt_10
    s_cmp_gt_u32 s67, 2
    s_cbranch_scc1 G_qt_11
    s_cmp_eq_u32 s67, 1
    s_cbranch_scc1 G_q1
    s_branch G_q2
G_qt_11:
    s_cmp_eq_u32 s67, 3
    s_cbranch_scc1 G_q3
    s_branch G_q4
G_qt_10:
    s_cmp_gt_u32 s67, 6
    s_cbranch_scc1 G_qt_12
    s_cmp_eq_u32 s67, 5
    s_cbranch_scc1 G_q5
    s_branch G_q6
G_qt_12:
    s_cmp_eq_u32 s67, 7
    s_cbranch_scc1 G_q7
    s_branch G_q8
G_qt_9:
    s_cmp_gt_u32 s67, 12
    s_cbranch_scc1 G_qt_13
    s_cmp_gt_u32 s67, 10
    s_cbranch_scc1 G_qt_14
    s_cmp_eq_u32 s67, 9
    s_cbranch_scc1 G_q9
    s_branch G_q10
G_qt_14:
    s_cmp_eq_u32 s67, 11
    s_cbranch_scc1 G_q11
    s_branch G_q12
G_qt_13:
    s_cmp_gt_u32 s67, 14
    s_cbranch_scc1 G_qt_15
    s_cmp_eq_u32 s67, 13
    s_cbranch_scc1 G_q13
    s_branch G_q14
G_qt_15:
    s_cmp_eq_u32 s67, 15
    s_cbranch_scc1 G_q15
G_q16:
    s_waitcnt vmcnt(16)
    v_max3_u32 v21, v124, v125, v126
    v_max_u32 v21, v21, v127
    v_cmp_eq_u32 vcc, -1, v21
    s_cbranch_vccnz G_f15
    v_mfma_f32_32x32x16_bf16 v[128:143], v[48:51], v[124:127], v[128:143]
G_q15:
    s_waitcnt vmcnt(15)
    v_max3_u32 v21, v120, v121, v122
    v_max_u32 v21, v21, v123
    v_cmp_eq_u32 vcc, -1, v21
    s_cbranch_vccnz G_f14
    v_mfma_f32_32x32x16_bf16 v[128:143], v[48:51], v[120:123], v[128:143]
G_q14:
    s_waitcnt vmcnt(14)
    v_max3_u32 v21, v116, v117, v118
    v_max_u32 v21, v21, v119
    v_cmp_eq_u32 vcc, -1, v21
    s_cbranch_vccnz G_f13
    v_mfma_f32_32x32x16_bf16 v[128:143], v[48:51], v[116:119], v[128:143]
G_q13:
    s_waitcnt vmcnt(13)
    v_max3_u32 v21, v112, v113, v114
    v_max_u32 v21, v21, v115
    v_cmp_eq_u32 vcc, -1, v21
    s_cbranch_vccnz G_f12
    v_mfma_f32_32x32x16_bf16 v[128:143], v[48:51], v[112:115], v[128:143]
G_q12:
    s_waitcnt vmcnt(12)
    v_max3_u32 v21, v108, v109, v110
    v_max_u32 v21, v21, v111
    v_cmp_eq_u32 vcc, -1, v21
    s_cbranch_vccnz G_f11
    v_mfma_f32_32x32x16_bf16 v[128:143], v[48:51], v[108:111], v[128:143]
G_q11:
    s_waitcnt vmcnt(11)
    v_max3_u32 v21, v104, v105, v106
    v_max_u32 v21, v21, v107
    v_cmp_eq_u32 vcc, -1, v21
    s_cbranch_vccnz G_f10
    v_mfma_f32_32x32x16_bf16 v[128:143], v[48:51], v[104:107], v[128:143]
G_q10:
    s_waitcnt vmcnt(10)
    v_max3_u32 v21, v100, v101, v102
    v_max_u32 v21, v21, v103
    v_cmp_eq_u32 vcc, -1, v21
    s_cbranch_vccnz G_f9
    v_mfma_f32_32x32x16_bf16 v[128:143], v[48:51], v[100:103], v[128:143]
G_q9:
    s_waitcnt vmcnt(9)
    v_max3_u32 v21, v96, v97, v98
    v_max_u32 v21, v21, v99
    v_cmp_eq_u32 vcc, -1, v21
    s_cbranch_vccnz G_f8
    v_mfma_f32_32x32x16_bf16 v[128:143], v[48:51], v[96:99], v[128:143]
G_q8:
    s_waitcnt vmcnt(8)
    v_max3_u32 v21, v92, v93, v94
    v_max_u32 v21, v21, v95
    v_cmp_eq_u32 vcc, -1, v21
    s_cbranch_vccnz G_f7
    v_mfma_f32_32x32x16_bf16 v[128:143], v[48:51], v[92:95], v[128:143]
G_q7:
    s_waitcnt vmcnt(7)
    v_max3_u32 v21, v88, v89, v90
    v_max_u32 v21, v21, v91
    v_cmp_eq_u32 vcc, -1, v21
    s_cbranch_vccnz G_f6
    v_mfma_f32_32x32x16_bf16 v[128:143], v[48:51], v[88:91], v[128:143]
G_q6:
    s_waitcnt vmcnt(6)
    v_max3_u32 v21, v84, v85, v86
    v_max_u32 v21, v21, v87
    v_cmp_eq_u32 vcc, -1, v21
    s_cbranch_vccnz G_f5
    v_mfma_f32_32x32x16_bf16 v[128:143], v[48:51], v[84:87], v[128:143]
G_q5:
    s_waitcnt vmcnt(5)
    v_max3_u32 v21, v80, v81, v82
    v_max_u32 v21, v21, v83
    v_cmp_eq_u32 vcc, -1, v21
    s_cbranch_vccnz G_f4
    v_mfma_f32_32x32x16_bf16 v[128:143], v[48:51], v[80:83], v[128:143]
G_q4:
    s_waitcnt vmcnt(4)
    v_max3_u32 v21, v76, v77, v78
    v_max_u32 v21, v21, v79
    v_cmp_eq_u32 vcc, -1, v21
    s_cbranch_vccnz G_f3
    v_mfma_f32_32x32x16_bf16 v[128:143], v[48:51], v[76:79], v[128:143]
G_q3:
    s_waitcnt vmcnt(3)
    v_max3_u32 v21, v72, v73, v74
    v_max_u32 v21, v21, v75
    v_cmp_eq_u32 vcc, -1, v21
    s_cbranch_vccnz G_f2
    v_mfma_f32_32x32x16_bf16 v[128:143], v[48:51], v[72:75], v[128:143]
G_q2:
    s_waitcnt vmcnt(2)
    v_max3_u32 v21, v68, v69, v70
    v_max_u32 v21, v21, v71
    v_cmp_eq_u32 vcc, -1, v21
    s_cbranch_vccnz G_f1
    v_mfma_f32_32x32x16_bf16 v[128:143], v[48:51], v[68:71], v[128:143]
G_q1:
    s_waitcnt vmcnt(1)
    v_max3_u32 v21, v64, v65, v66
    v_max_u32 v21, v21, v67
    v_cmp_eq_u32 vcc, -1, v21
    s_cbranch_vccnz G_f0
    v_mfma_f32_32x32x16_bf16 v[128:143], v[48:51], v[64:67], v[128:143]
G_q0:
    s_waitcnt vmcnt(0)
    s_add_u32 s65, s65, 1
    s_cmp_ge_u32 s65, 40000
    s_cbranch_scc1 G_done
    s_cmp_lg_u32 s68, 0
    s_cbranch_scc1 G_loop
    v_mov_b32 v20, -1
    s_cmp_lg_u32 s66, 0
    s_cbranch_scc1 G_loop
    v_max3_u32 v21, v56, v57, v58
    v_max_u32 v21, v21, v59
    v_cmp_eq_u32 vcc, -1, v21
    s_cbranch_vccnz G_loop
G_done:
    v_add_u32 v16, s7, v6
    v_add_f32_dpp v56, v56, v56 row_ror:4 row_mask:0xf bank_mask:0xf
    v_add_f32_dpp v57, v57, v57 row_ror:4 row_mask:0xf bank_mask:0xf
    v_add_f32_dpp v58, v58, v58 row_ror:4 row_mask:0xf bank_mask:0xf
    v_add_f32_dpp v59, v59, v59 row_ror:4 row_mask:0xf bank_mask:0xf
    v_add_f32_dpp v56, v56, v56 row_ror:8 row_mask:0xf bank_mask:0xf
    v_add_f32_dpp v57, v57, v57 row_ror:8 row_mask:0xf bank_mask:0xf
    v_add_f32_dpp v58, v58, v58 row_ror:8 row_mask:0xf bank_mask:0xf
    v_add_f32_dpp v59, v59, v59 row_ror:8 row_mask:0xf bank_mask:0xf
    v_mov_b32 v64, v56
    v_mov_b32 v65, v57
    v_mov_b32 v66, v58
    v_mov_b32 v67, v59
    s_nop 0
    v_permlane16_swap_b32 v56, v64
    v_permlane16_swap_b32 v57, v65
    v_permlane16_swap_b32 v58, v66
    v_permlane16_swap_b32 v59, v67
    v_add_f32 v56, v56, v64
    v_add_f32 v57, v57, v65
    v_add_f32 v58, v58, v66
    v_add_f32 v59, v59, v67
    v_mov_b32 v64, v56
    v_mov_b32 v65, v57
    v_mov_b32 v66, v58
    v_mov_b32 v67, v59
    s_nop 0
    v_permlane32_swap_b32 v56, v64
    v_permlane32_swap_b32 v57, v65
    v_permlane32_swap_b32 v58, v66
    v_permlane32_swap_b32 v59, v67
    v_add_f32 v56, v56, v64
    v_add_f32 v57, v57, v65
    v_add_f32 v58, v58, v66
    v_add_f32 v59, v59, v67
    v_cvt_pk_bf16_f32 v60, v128, v129
    v_cvt_pk_bf16_f32 v61, v130, v131
    v_cvt_pk_bf16_f32 v62, v132, v133
    v_cvt_pk_bf16_f32 v63, v134, v135
    ds_write_b128 v16, v[60:63] offset:0
    v_cvt_pk_bf16_f32 v56, v56, v57
    v_cvt_pk_bf16_f32 v57, v58, v59
    s_lshr_b32 s64, s6, 1
    s_lshl_b32 s64, s64, 6
    s_and_b32 s65, s6, 1
    s_lshl_b32 s65, s65, 3
    s_add_u32 s64, s64, s65
    v_lshl_add_u32 v16, v2, 4, s64
    s_mov_b64 exec, 15
    ds_write_b64 v16, v[56:57] offset:4096
    s_mov_b64 exec, -1
    s_waitcnt lgkmcnt(0)
    s_barrier
    v_lshrrev_b32 v18, 3, v2
    v_lshlrev_b32 v18, 2, v18
    ds_read_b32 v24, v18 offset:4352
    ds_read_b32 v25, v18 offset:4384
    ds_read_b32 v26, v18 offset:4416
    ds_read_b32 v27, v18 offset:4448
    ds_read_b32 v28, v18 offset:4480
    ds_read_b32 v29, v18 offset:4512
    ds_read_b32 v30, v18 offset:4544
    s_waitcnt lgkmcnt(0)
    v_lshlrev_b32 v48, 16, v192
    v_and_b32 v49, 0xffff0000, v192
    v_mul_f32 v32, v48, v24
    v_mul_f32 v33, v49, v24
    v_lshlrev_b32 v48, 16, v193
    v_and_b32 v49, 0xffff0000, v193
    v_mul_f32 v34, v48, v24
    v_mul_f32 v35, v49, v24
    v_lshlrev_b32 v48, 16, v194
    v_and_b32 v49, 0xffff0000, v194
    v_mul_f32 v36, v48, v24
    v_mul_f32 v37, v49, v24
    v_lshlrev_b32 v48, 16, v195
    v_and_b32 v49, 0xffff0000, v195
    v_mul_f32 v38, v48, v24
    v_mul_f32 v39, v49, v24
    v_lshlrev_b32 v48, 16, v196
    v_and_b32 v49, 0xffff0000, v196
    v_fmac_f32 v32, v48, v25
    v_fmac_f32 v33, v49, v25
    v_lshlrev_b32 v48, 16, v197
    v_and_b32 v49, 0xffff0000, v197
    v_fmac_f32 v34, v48, v25
    v_fmac_f32 v35, v49, v25
    v_lshlrev_b32 v48, 16, v198
    v_and_b32 v49, 0xffff0000, v198
    v_fmac_f32 v36, v48, v25
    v_fmac_f32 v37, v49, v25
    v_lshlrev_b32 v48, 16, v199
    v_and_b32 v49, 0xffff0000, v199
    v_fmac_f32 v38, v48, v25
    v_fmac_f32 v39, v49, v25
    v_lshlrev_b32 v48, 16, v200
    v_and_b32 v49, 0xffff0000, v200
    v_fmac_f32 v32, v48, v26
    v_fmac_f32 v33, v49, v26
    v_lshlrev_b32 v48, 16, v201
    v_and_b32 v49, 0xffff0000, v201
    v_fmac_f32 v34, v48, v26
    v_fmac_f32 v35, v49, v26
    v_lshlrev_b32 v48, 16, v202
    v_and_b32 v49, 0xffff0000, v202
    v_fmac_f32 v36, v48, v26
    v_fmac_f32 v37, v49, v26
    v_lshlrev_b32 v48, 16, v203
    v_and_b32 v49, 0xffff0000, v203
    v_fmac_f32 v38, v48, v26
    v_fmac_f32 v39, v49, v26
    v_lshlrev_b32 v48, 16, v204
    v_and_b32 v49, 0xffff0000, v204
    v_fmac_f32 v32, v48, v27
    v_fmac_f32 v33, v49, v27
    v_lshlrev_b32 v48, 16, v205
    v_and_b32 v49, 0xffff0000, v205
    v_fmac_f32 v34, v48, v27
    v_fmac_f32 v35, v49, v27
    v_lshlrev_b32 v48, 16, v206
    v_and_b32 v49, 0xffff0000, v206
    v_fmac_f32 v36, v48, v27
    v_fmac_f32 v37, v49, v27
    v_lshlrev_b32 v48, 16, v207
    v_and_b32 v49, 0xffff0000, v207
    v_fmac_f32 v38, v48, v27
    v_fmac_f32 v39, v49, v27
    v_lshlrev_b32 v48, 16, v208
    v_and_b32 v49, 0xffff0000, v208
    v_fmac_f32 v32, v48, v28
    v_fmac_f32 v33, v49, v28
    v_lshlrev_b32 v48, 16, v209
    v_and_b32 v49, 0xffff0000, v209
    v_fmac_f32 v34, v48, v28
    v_fmac_f32 v35, v49, v28
    v_lshlrev_b32 v48, 16, v210
    v_and_b32 v49, 0xffff0000, v210
    v_fmac_f32 v36, v48, v28
    v_fmac_f32 v37, v49, v28
    v_lshlrev_b32 v48, 16, v211
    v_and_b32 v49, 0xffff0000, v211
    v_fmac_f32 v38, v48, v28
    v_fmac_f32 v39, v49, v28
    v_lshlrev_b32 v48, 16, v212
    v_and_b32 v49, 0xffff0000, v212
    v_fmac_f32 v32, v48, v29
    v_fmac_f32 v33, v49, v29
    v_lshlrev_b32 v48, 16, v213
    v_and_b32 v49, 0xffff0000, v213
    v_fmac_f32 v34, v48, v29
    v_fmac_f32 v35, v49, v29
    v_lshlrev_b32 v48, 16, v214
    v_and_b32 v49, 0xffff0000, v214
    v_fmac_f32 v36, v48, v29
    v_fmac_f32 v37, v49, v29
    v_lshlrev_b32 v48, 16, v215
    v_and_b32 v49, 0xffff0000, v215
    v_fmac_f32 v38, v48, v29
    v_fmac_f32 v39, v49, v29
    v_lshlrev_b32 v48, 16, v216
    v_and_b32 v49, 0xffff0000, v216
    v_fmac_f32 v32, v48, v30
    v_fmac_f32 v33, v49, v30
    v_lshlrev_b32 v48, 16, v217
    v_and_b32 v49, 0xffff0000, v217
    v_fmac_f32 v34, v48, v30
    v_fmac_f32 v35, v49, v30
    v_lshlrev_b32 v48, 16, v218
    v_and_b32 v49, 0xffff0000, v218
    v_fmac_f32 v36, v48, v30
    v_fmac_f32 v37, v49, v30
    v_lshlrev_b32 v48, 16, v219
    v_and_b32 v49, 0xffff0000, v219
    v_fmac_f32 v38, v48, v30
    v_fmac_f32 v39, v49, v30
    s_nop 1
    v_permlane32_swap_b32 v32, v36
    v_permlane32_swap_b32 v33, v37
    v_permlane32_swap_b32 v34, v38
    v_permlane32_swap_b32 v35, v39
    v_add_f32 v32, v32, v36
    v_add_f32 v33, v33, v37
    v_add_f32 v34, v34, v38
    v_add_f32 v35, v35, v39
    s_nop 1
    v_permlane16_swap_b32 v32, v34
    v_permlane16_swap_b32 v33, v35
    v_add_f32 v32, v32, v34
    v_add_f32 v33, v33, v35
    s_nop 1
    v_add_f32_dpp v32, v32, v32 row_ror:8 row_mask:0xf bank_mask:0xf
    v_add_f32_dpp v33, v33, v33 row_ror:8 row_mask:0xf bank_mask:0xf
    v_and_b32 v16, 7, v2
    v_lshlrev_b32 v16, 5, v16
    v_lshl_add_u32 v16, v8, 3, v16
    s_lshl_b32 s64, s2, 10
    s_lshl_b32 s65, s6, 8
    s_add_u32 s64, s64, s65
    s_add_u32 s64, s64, 6447104
    s_mov_b32 exec_lo, 0x00ff00ff
    s_mov_b32 exec_hi, 0x00ff00ff
    buffer_store_dwordx2 v[32:33], v16, s[16:19], s64 offen sc0 sc1
    s_mov_b64 exec, -1
    s_lshl_b32 s64, s4, 3
    s_add_u32 s64, s64, s3
    s_lshl_b32 s64, s64, 7
    s_add_u32 s64, s64, 5382144
    v_mov_b32 v14, s64
    s_mov_b64 exec, 1
    v_mov_b32 v15, 0
    buffer_atomic_or v15, v14, s[16:19], 0 offen sc0
    s_mov_b64 exec, -1
    v_sub_f32 v248, 1.0, v228
    v_cvt_pk_bf16_f32 v248, v248, v248
    v_lshlrev_b32 v248, 16, v248
    v_lshlrev_b32 v232, 16, v220
    v_and_b32 v233, 0xffff0000, v220
    v_mul_f32 v232, v232, v248
    v_mul_f32 v233, v233, v248
    v_cvt_pk_bf16_f32 v3, v232, v233
    v_lshlrev_b32 v232, 16, v3
    v_and_b32 v233, 0xffff0000, v3
    v_lshlrev_b32 v234, 16, v221
    v_and_b32 v235, 0xffff0000, v221
    v_mul_f32 v234, v234, v248
    v_mul_f32 v235, v235, v248
    v_cvt_pk_bf16_f32 v3, v234, v235
    v_lshlrev_b32 v234, 16, v3
    v_and_b32 v235, 0xffff0000, v3
    v_lshlrev_b32 v236, 16, v222
    v_and_b32 v237, 0xffff0000, v222
    v_mul_f32 v236, v236, v248
    v_mul_f32 v237, v237, v248
    v_cvt_pk_bf16_f32 v3, v236, v237
    v_lshlrev_b32 v236, 16, v3
    v_and_b32 v237, 0xffff0000, v3
    v_lshlrev_b32 v238, 16, v223
    v_and_b32 v239, 0xffff0000, v223
    v_mul_f32 v238, v238, v248
    v_mul_f32 v239, v239, v248
    v_cvt_pk_bf16_f32 v3, v238, v239
    v_lshlrev_b32 v238, 16, v3
    v_and_b32 v239, 0xffff0000, v3
    v_lshlrev_b32 v240, 16, v224
    v_and_b32 v241, 0xffff0000, v224
    v_mul_f32 v240, v240, v248
    v_mul_f32 v241, v241, v248
    v_cvt_pk_bf16_f32 v3, v240, v241
    v_lshlrev_b32 v240, 16, v3
    v_and_b32 v241, 0xffff0000, v3
    v_lshlrev_b32 v242, 16, v225
    v_and_b32 v243, 0xffff0000, v225
    v_mul_f32 v242, v242, v248
    v_mul_f32 v243, v243, v248
    v_cvt_pk_bf16_f32 v3, v242, v243
    v_lshlrev_b32 v242, 16, v3
    v_and_b32 v243, 0xffff0000, v3
    v_lshlrev_b32 v244, 16, v226
    v_and_b32 v245, 0xffff0000, v226
    v_mul_f32 v244, v244, v248
    v_mul_f32 v245, v245, v248
    v_cvt_pk_bf16_f32 v3, v244, v245
    v_lshlrev_b32 v244, 16, v3
    v_and_b32 v245, 0xffff0000, v3
    v_lshlrev_b32 v246, 16, v227
    v_and_b32 v247, 0xffff0000, v227
    v_mul_f32 v246, v246, v248
    v_mul_f32 v247, v247, v248
    v_cvt_pk_bf16_f32 v3, v246, v247
    v_lshlrev_b32 v246, 16, v3
    v_and_b32 v247, 0xffff0000, v3
    v_mov_b32 v254, v14
    s_branch P2_start
C_start:
    s_and_b32 s6, s3, 1
    s_lshr_b32 s7, s3, 1
    v_and_b32 v3, 15, v2
    s_lshl_b32 s64, s6, 6
    v_add_u32 v3, s64, v3
    v_lshlrev_b32 v3, 7, v3
    v_add_u32 v3, 8192, v3
    v_bfe_u32 v56, v2, 1, 3
    v_lshrrev_b32 v57, 4, v2
    v_xor_b32 v56, v56, v57
    v_lshl_add_u32 v4, v56, 4, v3
    v_xor_b32 v5, 64, v4
    v_bfe_u32 v56, v2, 2, 2
    v_lshl_add_u32 v58, v57, 3, v56
    v_lshlrev_b32 v58, 7, v58
    v_lshrrev_b32 v56, 1, v56
    v_xor_b32 v56, s7, v56
    v_lshl_add_u32 v58, v56, 6, v58
    v_and_b32 v57, 1, v57
    v_lshl_add_u32 v58, v57, 5, v58
    v_and_b32 v56, 3, v2
    v_lshl_add_u32 v58, v56, 3, v58
    v_add_u32 v6, 24576, v58
    v_xor_b32 v7, 32, v6
    v_mov_b32 v8, v4
    v_mov_b32 v10, v6
    v_mov_b32 v9, v5
    v_mov_b32 v11, v7
    v_mov_b32 v64, 0
    v_mov_b32 v65, 0
    v_mov_b32 v66, 0
    v_mov_b32 v67, 0
    v_mov_b32 v68, 0
    v_mov_b32 v69, 0
    v_mov_b32 v70, 0
    v_mov_b32 v71, 0
    v_mov_b32 v72, 0
    v_mov_b32 v73, 0
    v_mov_b32 v74, 0
    v_mov_b32 v75, 0
    v_mov_b32 v76, 0
    v_mov_b32 v77, 0
    v_mov_b32 v78, 0
    v_mov_b32 v79, 0
    v_mov_b32 v80, 0
    v_mov_b32 v81, 0
    v_mov_b32 v82, 0
    v_mov_b32 v83, 0
    v_mov_b32 v84, 0
    v_mov_b32 v85, 0
    v_mov_b32 v86, 0
    v_mov_b32 v87, 0
    v_mov_b32 v88, 0
    v_mov_b32 v89, 0
    v_mov_b32 v90, 0
    v_mov_b32 v91, 0
    v_mov_b32 v92, 0
    v_mov_b32 v93, 0
    v_mov_b32 v94, 0
    v_mov_b32 v95, 0
    v_mov_b32 v96, 0
    v_mov_b32 v97, 0
    v_mov_b32 v98, 0
    v_mov_b32 v99, 0
    v_mov_b32 v100, 0
    v_mov_b32 v101, 0
    v_mov_b32 v102, 0
    v_mov_b32 v103, 0
    v_mov_b32 v104, 0
    v_mov_b32 v105, 0
    v_mov_b32 v106, 0
    v_mov_b32 v107, 0
    v_mov_b32 v108, 0
    v_mov_b32 v109, 0
    v_mov_b32 v110, 0
    v_mov_b32 v111, 0
    v_mov_b32 v112, 0
    v_mov_b32 v113, 0
    v_mov_b32 v114, 0
    v_mov_b32 v115, 0
    v_mov_b32 v116, 0
    v_mov_b32 v117, 0
    v_mov_b32 v118, 0
    v_mov_b32 v119, 0
    v_mov_b32 v120, 0
    v_mov_b32 v121, 0
    v_mov_b32 v122, 0
    v_mov_b32 v123, 0
    v_mov_b32 v124, 0
    v_mov_b32 v125, 0
    v_mov_b32 v126, 0
    v_mov_b32 v127, 0
    v_mov_b32 v128, 0
    v_mov_b32 v129, 0
    v_mov_b32 v130, 0
    v_mov_b32 v131, 0
    v_mov_b32 v132, 0
    v_mov_b32 v133, 0
    v_mov_b32 v134, 0
    v_mov_b32 v135, 0
    v_mov_b32 v136, 0
    v_mov_b32 v137, 0
    v_mov_b32 v138, 0
    v_mov_b32 v139, 0
    v_mov_b32 v140, 0
    v_mov_b32 v141, 0
    v_mov_b32 v142, 0
    v_mov_b32 v143, 0
    v_mov_b32 v144, 0
    v_mov_b32 v145, 0
    v_mov_b32 v146, 0
    v_mov_b32 v147, 0
    v_mov_b32 v148, 0
    v_mov_b32 v149, 0
    v_mov_b32 v150, 0
    v_mov_b32 v151, 0
    v_mov_b32 v152, 0
    v_mov_b32 v153, 0
    v_mov_b32 v154, 0
    v_mov_b32 v155, 0
    v_mov_b32 v156, 0
    v_mov_b32 v157, 0
    v_mov_b32 v158, 0
    v_mov_b32 v159, 0
    s_lshl_b32 s64, s3, 2
    v_mov_b32 v229, s64
    ds_write_b32 v229, v64 offset:4288
    ds_write_b32 v229, v64 offset:4304
    v_lshlrev_b32 v3, 4, v2
    s_lshl_b32 s64, s3, 11
    v_add_u32 v224, s64, v3
    v_xor_b32 v225, 2048, v224
    s_lshl_b32 s64, s3, 8
    v_lshl_add_u32 v227, v2, 2, s64
    v_xor_b32 v228, 256, v227
    v_xor_b32 v230, 4, v229
    v_mov_b32 v231, 1
    v_lshlrev_b32 v232, 2, v2
    s_lshl_b32 s64, 1, s4
    v_mov_b32 v233, s64
    s_lshl_b32 s43, s5, 2
    s_add_u32 s43, s43, s3
    s_lshl_b32 s64, s43, 7
    s_add_u32 s64, s64, 5373952
    v_mov_b32 v234, s64
    s_lshl_b32 s43, s43, 4
    s_add_u32 s43, s43, s4
    s_mul_i32 s43, s43, 1152
    s_add_u32 s43, s43, 4194304
    s_lshl_b32 s42, s4, 2
    s_lshl_b32 s64, s6, 1
    s_add_u32 s42, s42, s64
    s_lshl_b32 s42, s42, 5
    s_lshl_b32 s64, s5, 1
    s_add_u32 s42, s42, s64
    s_add_u32 s42, s42, s7
    s_lshl_b32 s42, s42, 11
    s_and_b32 s64, s5, 7
    s_lshl_b32 s64, s64, 1
    s_add_u32 s64, s64, s7
    s_lshl_b32 s64, 1, s64
    v_mov_b32 v13, s64
    s_lshr_b32 s64, s5, 3
    s_lshl_b32 s64, s64, 1
    s_add_u32 s64, s64, s6
    s_lshl_b32 s64, s64, 8
    s_lshl_b32 s65, s4, 10
    s_add_u32 s64, s64, s65
    s_add_u32 s64, s64, 5382144
    v_lshl_add_u32 v15, v2, 7, s64
    v_lshlrev_b32 v1, 4, v2
    s_and_b32 s64, s2, 7
    s_lshr_b32 s65, s2, 3
    s_and_b32 s4, s64, 3
    s_lshl_b32 s4, s4, 2
    s_and_b32 s66, s65, 3
    s_add_u32 s4, s4, s66
    s_lshr_b32 s5, s64, 2
    s_lshl_b32 s5, s5, 3
    s_lshr_b32 s66, s65, 2
    s_add_u32 s5, s5, s66
    s_mov_b32 s65, 0
    s_mov_b32 s66, 0
    v_mov_b32 v236, 0x3f803f80
    v_mov_b32 v237, 0x3f803f80
    v_mov_b32 v238, 0x3f803f80
    v_mov_b32 v239, 0x3f803f80
    s_waitcnt vmcnt(0) lgkmcnt(0)
    s_barrier
    ds_read_b64_tr_b16 v[16:17], v10 offset:0
    ds_read_b64_tr_b16 v[18:19], v10 offset:512
    ds_read_b128 v[192:195], v8 offset:0
    ds_read_b128 v[196:199], v8 offset:2048
    ds_read_b128 v[200:203], v8 offset:4096
    ds_read_b128 v[204:207], v8 offset:6144
    ds_read_b64_tr_b16 v[20:21], v11 offset:0
    ds_read_b64_tr_b16 v[22:23], v11 offset:512
    ds_read_b64_tr_b16 v[24:25], v10 offset:8192
    ds_read_b64_tr_b16 v[26:27], v10 offset:8704
    ds_read_b64_tr_b16 v[28:29], v11 offset:8192
    ds_read_b64_tr_b16 v[30:31], v11 offset:8704
    ds_read_b64_tr_b16 v[32:33], v10 offset:16384
    ds_read_b64_tr_b16 v[34:35], v10 offset:16896
    ds_read_b64_tr_b16 v[36:37], v11 offset:16384
    ds_read_b64_tr_b16 v[38:39], v11 offset:16896
.p2align 3
C_loop:
    s_waitcnt lgkmcnt(0)
    v_mfma_f32_16x16x32_bf16 v[64:67], v[16:19], v[192:195], v[64:67]
    ds_read_b64_tr_b16 v[40:41], v10 offset:4096
    v_mfma_f32_16x16x32_bf16 v[72:75], v[16:19], v[196:199], v[72:75]
    ds_read_b64_tr_b16 v[42:43], v10 offset:4608
    v_mfma_f32_16x16x32_bf16 v[80:83], v[16:19], v[200:203], v[80:83]
    ds_read_b128 v[208:211], v9 offset:0
    v_mfma_f32_16x16x32_bf16 v[88:91], v[16:19], v[204:207], v[88:91]
    ds_read_b128 v[212:215], v9 offset:2048
    v_mfma_f32_16x16x32_bf16 v[68:71], v[20:23], v[192:195], v[68:71]
    ds_read_b128 v[216:219], v9 offset:4096
    v_mfma_f32_16x16x32_bf16 v[76:79], v[20:23], v[196:199], v[76:79]
    ds_read_b128 v[220:223], v9 offset:6144
    v_mfma_f32_16x16x32_bf16 v[84:87], v[20:23], v[200:203], v[84:87]
    ds_read_b64_tr_b16 v[44:45], v11 offset:4096
    v_mfma_f32_16x16x32_bf16 v[92:95], v[20:23], v[204:207], v[92:95]
    ds_read_b64_tr_b16 v[46:47], v11 offset:4608
    v_mfma_f32_16x16x32_bf16 v[96:99], v[192:195], v[24:27], v[96:99]
    ds_read_b64_tr_b16 v[48:49], v10 offset:12288
    v_mfma_f32_16x16x32_bf16 v[100:103], v[196:199], v[24:27], v[100:103]
    ds_read_b64_tr_b16 v[50:51], v10 offset:12800
    v_mfma_f32_16x16x32_bf16 v[112:115], v[200:203], v[24:27], v[112:115]
    ds_read_b64_tr_b16 v[52:53], v11 offset:12288
    v_mfma_f32_16x16x32_bf16 v[116:119], v[204:207], v[24:27], v[116:119]
    ds_read_b64_tr_b16 v[54:55], v11 offset:12800
    v_mfma_f32_16x16x32_bf16 v[104:107], v[192:195], v[28:31], v[104:107]
    ds_read_b64_tr_b16 v[56:57], v10 offset:20480
    v_mfma_f32_16x16x32_bf16 v[108:111], v[196:199], v[28:31], v[108:111]
    ds_read_b64_tr_b16 v[58:59], v10 offset:20992
    v_mfma_f32_16x16x32_bf16 v[120:123], v[200:203], v[28:31], v[120:123]
    ds_read_b64_tr_b16 v[60:61], v11 offset:20480
    v_mfma_f32_16x16x32_bf16 v[124:127], v[204:207], v[28:31], v[124:127]
    ds_read_b64_tr_b16 v[62:63], v11 offset:20992
    v_mfma_f32_16x16x32_bf16 v[128:131], v[192:195], v[32:35], v[128:131]
    v_mfma_f32_16x16x32_bf16 v[132:135], v[196:199], v[32:35], v[132:135]
    v_mfma_f32_16x16x32_bf16 v[144:147], v[200:203], v[32:35], v[144:147]
    v_mfma_f32_16x16x32_bf16 v[148:151], v[204:207], v[32:35], v[148:151]
    v_mfma_f32_16x16x32_bf16 v[136:139], v[192:195], v[36:39], v[136:139]
    v_mfma_f32_16x16x32_bf16 v[140:143], v[196:199], v[36:39], v[140:143]
    v_mfma_f32_16x16x32_bf16 v[152:155], v[200:203], v[36:39], v[152:155]
    v_mfma_f32_16x16x32_bf16 v[156:159], v[204:207], v[36:39], v[156:159]
    s_waitcnt lgkmcnt(0)
    s_barrier
    s_add_u32 s65, s65, 40960
    s_cmp_eq_u32 s65, 122880
    s_cselect_b32 s65, 0, s65
    v_mfma_f32_16x16x32_bf16 v[64:67], v[40:43], v[208:211], v[64:67]
    v_add_u32 v10, s65, v6
    v_add_u32 v8, s65, v4
    v_mfma_f32_16x16x32_bf16 v[72:75], v[40:43], v[212:215], v[72:75]
    ds_read_b64_tr_b16 v[16:17], v10 offset:0
    v_mfma_f32_16x16x32_bf16 v[80:83], v[40:43], v[216:219], v[80:83]
    ds_read_b64_tr_b16 v[18:19], v10 offset:512
    v_mfma_f32_16x16x32_bf16 v[88:91], v[40:43], v[220:223], v[88:91]
    ds_read_b128 v[192:195], v8 offset:0
    v_mfma_f32_16x16x32_bf16 v[68:71], v[44:47], v[208:211], v[68:71]
    ds_read_b128 v[196:199], v8 offset:2048
    v_mfma_f32_16x16x32_bf16 v[76:79], v[44:47], v[212:215], v[76:79]
    ds_read_b128 v[200:203], v8 offset:4096
    v_mfma_f32_16x16x32_bf16 v[84:87], v[44:47], v[216:219], v[84:87]
    ds_read_b128 v[204:207], v8 offset:6144
    v_mfma_f32_16x16x32_bf16 v[92:95], v[44:47], v[220:223], v[92:95]
    v_add_u32 v11, s65, v7
    v_mfma_f32_16x16x32_bf16 v[96:99], v[208:211], v[48:51], v[96:99]
    ds_read_b64_tr_b16 v[20:21], v11 offset:0
    v_mfma_f32_16x16x32_bf16 v[100:103], v[212:215], v[48:51], v[100:103]
    ds_read_b64_tr_b16 v[22:23], v11 offset:512
    v_mfma_f32_16x16x32_bf16 v[112:115], v[216:219], v[48:51], v[112:115]
    ds_read_b64_tr_b16 v[24:25], v10 offset:8192
    v_mfma_f32_16x16x32_bf16 v[116:119], v[220:223], v[48:51], v[116:119]
    ds_read_b64_tr_b16 v[26:27], v10 offset:8704
    v_mfma_f32_16x16x32_bf16 v[104:107], v[208:211], v[52:55], v[104:107]
    ds_read_b64_tr_b16 v[28:29], v11 offset:8192
    v_mfma_f32_16x16x32_bf16 v[108:111], v[212:215], v[52:55], v[108:111]
    ds_read_b64_tr_b16 v[30:31], v11 offset:8704
    v_mfma_f32_16x16x32_bf16 v[120:123], v[216:219], v[52:55], v[120:123]
    ds_read_b64_tr_b16 v[32:33], v10 offset:16384
    v_mfma_f32_16x16x32_bf16 v[124:127], v[220:223], v[52:55], v[124:127]
    ds_read_b64_tr_b16 v[34:35], v10 offset:16896
    v_mfma_f32_16x16x32_bf16 v[128:131], v[208:211], v[56:59], v[128:131]
    ds_read_b64_tr_b16 v[36:37], v11 offset:16384
    v_mfma_f32_16x16x32_bf16 v[132:135], v[212:215], v[56:59], v[132:135]
    ds_read_b64_tr_b16 v[38:39], v11 offset:16896
    v_mfma_f32_16x16x32_bf16 v[144:147], v[216:219], v[56:59], v[144:147]
    v_add_u32 v9, s65, v5
    v_mfma_f32_16x16x32_bf16 v[148:151], v[220:223], v[56:59], v[148:151]
    v_mfma_f32_16x16x32_bf16 v[136:139], v[208:211], v[60:63], v[136:139]
    v_mfma_f32_16x16x32_bf16 v[140:143], v[212:215], v[60:63], v[140:143]
    v_mfma_f32_16x16x32_bf16 v[152:155], v[216:219], v[60:63], v[152:155]
    v_mfma_f32_16x16x32_bf16 v[156:159], v[220:223], v[60:63], v[156:159]
    s_add_u32 s66, s66, 1
    s_cmp_lt_u32 s66, 14
    s_cbranch_scc1 C_loop
    s_waitcnt lgkmcnt(0)
    v_mfma_f32_16x16x32_bf16 v[96:99], v[192:195], v[24:27], v[96:99]
    ds_read_b64_tr_b16 v[48:49], v10 offset:12288
    v_mfma_f32_16x16x32_bf16 v[100:103], v[196:199], v[24:27], v[100:103]
    ds_read_b64_tr_b16 v[50:51], v10 offset:12800
    v_mfma_f32_16x16x32_bf16 v[112:115], v[200:203], v[24:27], v[112:115]
    ds_read_b128 v[160:163], v9 offset:0
    v_mfma_f32_16x16x32_bf16 v[116:119], v[204:207], v[24:27], v[116:119]
    ds_read_b128 v[164:167], v9 offset:2048
    v_mfma_f32_16x16x32_bf16 v[104:107], v[192:195], v[28:31], v[104:107]
    ds_read_b128 v[168:171], v9 offset:4096
    v_mfma_f32_16x16x32_bf16 v[108:111], v[196:199], v[28:31], v[108:111]
    ds_read_b128 v[172:175], v9 offset:6144
    v_mfma_f32_16x16x32_bf16 v[120:123], v[200:203], v[28:31], v[120:123]
    ds_read_b64_tr_b16 v[52:53], v11 offset:12288
    v_mfma_f32_16x16x32_bf16 v[124:127], v[204:207], v[28:31], v[124:127]
    ds_read_b64_tr_b16 v[54:55], v11 offset:12800
    v_mfma_f32_16x16x32_bf16 v[128:131], v[192:195], v[32:35], v[128:131]
    ds_read_b64_tr_b16 v[56:57], v10 offset:20480
    v_mfma_f32_16x16x32_bf16 v[132:135], v[196:199], v[32:35], v[132:135]
    ds_read_b64_tr_b16 v[58:59], v10 offset:20992
    v_mfma_f32_16x16x32_bf16 v[144:147], v[200:203], v[32:35], v[144:147]
    ds_read_b64_tr_b16 v[60:61], v11 offset:20480
    v_mfma_f32_16x16x32_bf16 v[148:151], v[204:207], v[32:35], v[148:151]
    ds_read_b64_tr_b16 v[62:63], v11 offset:20992
    v_mfma_f32_16x16x32_bf16 v[136:139], v[192:195], v[36:39], v[136:139]
    v_mfma_f32_16x16x32_bf16 v[140:143], v[196:199], v[36:39], v[140:143]
    v_mfma_f32_16x16x32_bf16 v[152:155], v[200:203], v[36:39], v[152:155]
    v_mfma_f32_16x16x32_bf16 v[156:159], v[204:207], v[36:39], v[156:159]
    s_waitcnt lgkmcnt(0)
    s_barrier
    s_add_u32 s66, s66, 1
    v_mfma_f32_16x16x32_bf16 v[96:99], v[160:163], v[48:51], v[96:99]
    v_mov_b32 v10, v6
    v_mov_b32 v8, v4
    v_mfma_f32_16x16x32_bf16 v[100:103], v[164:167], v[48:51], v[100:103]
    ds_read_b64_tr_b16 v[24:25], v10 offset:8192
    v_mfma_f32_16x16x32_bf16 v[112:115], v[168:171], v[48:51], v[112:115]
    ds_read_b64_tr_b16 v[26:27], v10 offset:8704
    v_mfma_f32_16x16x32_bf16 v[116:119], v[172:175], v[48:51], v[116:119]
    v_mov_b32 v11, v7
    v_mov_b32 v9, v5
    v_mfma_f32_16x16x32_bf16 v[104:107], v[160:163], v[52:55], v[104:107]
    ds_read_b128 v[176:179], v8 offset:0
    v_mfma_f32_16x16x32_bf16 v[108:111], v[164:167], v[52:55], v[108:111]
    ds_read_b128 v[180:183], v8 offset:2048
    v_mfma_f32_16x16x32_bf16 v[120:123], v[168:171], v[52:55], v[120:123]
    ds_read_b128 v[184:187], v8 offset:4096
    v_mfma_f32_16x16x32_bf16 v[124:127], v[172:175], v[52:55], v[124:127]
    ds_read_b128 v[188:191], v8 offset:6144
    v_mfma_f32_16x16x32_bf16 v[128:131], v[160:163], v[56:59], v[128:131]
    ds_read_b64_tr_b16 v[28:29], v11 offset:8192
    v_mfma_f32_16x16x32_bf16 v[132:135], v[164:167], v[56:59], v[132:135]
    ds_read_b64_tr_b16 v[30:31], v11 offset:8704
    v_mfma_f32_16x16x32_bf16 v[144:147], v[168:171], v[56:59], v[144:147]
    ds_read_b64_tr_b16 v[32:33], v10 offset:16384
    v_mfma_f32_16x16x32_bf16 v[148:151], v[172:175], v[56:59], v[148:151]
    ds_read_b64_tr_b16 v[34:35], v10 offset:16896
    v_mfma_f32_16x16x32_bf16 v[136:139], v[160:163], v[60:63], v[136:139]
    ds_read_b64_tr_b16 v[36:37], v11 offset:16384
    v_mfma_f32_16x16x32_bf16 v[140:143], v[164:167], v[60:63], v[140:143]
    ds_read_b64_tr_b16 v[38:39], v11 offset:16896
    v_mfma_f32_16x16x32_bf16 v[152:155], v[168:171], v[60:63], v[152:155]
    v_mfma_f32_16x16x32_bf16 v[156:159], v[172:175], v[60:63], v[156:159]
    s_waitcnt lgkmcnt(0)
    v_mfma_f32_16x16x32_bf16 v[96:99], v[176:179], v[24:27], v[96:99]
    ds_read_b64_tr_b16 v[48:49], v10 offset:12288
    v_mfma_f32_16x16x32_bf16 v[100:103], v[180:183], v[24:27], v[100:103]
    ds_read_b64_tr_b16 v[50:51], v10 offset:12800
    v_mfma_f32_16x16x32_bf16 v[112:115], v[184:187], v[24:27], v[112:115]
    ds_read_b128 v[208:211], v9 offset:0
    v_mfma_f32_16x16x32_bf16 v[116:119], v[188:191], v[24:27], v[116:119]
    ds_read_b128 v[212:215], v9 offset:2048
    v_mfma_f32_16x16x32_bf16 v[104:107], v[176:179], v[28:31], v[104:107]
    ds_read_b128 v[216:219], v9 offset:4096
    v_mfma_f32_16x16x32_bf16 v[108:111], v[180:183], v[28:31], v[108:111]
    ds_read_b128 v[220:223], v9 offset:6144
    v_mfma_f32_16x16x32_bf16 v[120:123], v[184:187], v[28:31], v[120:123]
    ds_read_b64_tr_b16 v[52:53], v11 offset:12288
    v_mfma_f32_16x16x32_bf16 v[124:127], v[188:191], v[28:31], v[124:127]
    ds_read_b64_tr_b16 v[54:55], v11 offset:12800
    v_mfma_f32_16x16x32_bf16 v[128:131], v[176:179], v[32:35], v[128:131]
    ds_read_b64_tr_b16 v[56:57], v10 offset:20480
    v_mfma_f32_16x16x32_bf16 v[132:135], v[180:183], v[32:35], v[132:135]
    ds_read_b64_tr_b16 v[58:59], v10 offset:20992
    v_mfma_f32_16x16x32_bf16 v[144:147], v[184:187], v[32:35], v[144:147]
    ds_read_b64_tr_b16 v[60:61], v11 offset:20480
    v_mfma_f32_16x16x32_bf16 v[148:151], v[188:191], v[32:35], v[148:151]
    ds_read_b64_tr_b16 v[62:63], v11 offset:20992
    v_mfma_f32_16x16x32_bf16 v[136:139], v[176:179], v[36:39], v[136:139]
    v_mfma_f32_16x16x32_bf16 v[140:143], v[180:183], v[36:39], v[140:143]
    v_mfma_f32_16x16x32_bf16 v[152:155], v[184:187], v[36:39], v[152:155]
    v_mfma_f32_16x16x32_bf16 v[156:159], v[188:191], v[36:39], v[156:159]
    s_waitcnt lgkmcnt(0)
    s_barrier
    v_mfma_f32_16x16x32_bf16 v[96:99], v[208:211], v[48:51], v[96:99]
    v_mfma_f32_16x16x32_bf16 v[100:103], v[212:215], v[48:51], v[100:103]
    v_mfma_f32_16x16x32_bf16 v[112:115], v[216:219], v[48:51], v[112:115]
    v_mfma_f32_16x16x32_bf16 v[116:119], v[220:223], v[48:51], v[116:119]
    v_mfma_f32_16x16x32_bf16 v[104:107], v[208:211], v[52:55], v[104:107]
    v_mfma_f32_16x16x32_bf16 v[108:111], v[212:215], v[52:55], v[108:111]
    v_mfma_f32_16x16x32_bf16 v[120:123], v[216:219], v[52:55], v[120:123]
    v_mfma_f32_16x16x32_bf16 v[124:127], v[220:223], v[52:55], v[124:127]
    v_mfma_f32_16x16x32_bf16 v[128:131], v[208:211], v[56:59], v[128:131]
    v_mfma_f32_16x16x32_bf16 v[132:135], v[212:215], v[56:59], v[132:135]
    v_mfma_f32_16x16x32_bf16 v[144:147], v[216:219], v[56:59], v[144:147]
    v_mfma_f32_16x16x32_bf16 v[148:151], v[220:223], v[56:59], v[148:151]
    v_mfma_f32_16x16x32_bf16 v[136:139], v[208:211], v[60:63], v[136:139]
    v_mfma_f32_16x16x32_bf16 v[140:143], v[212:215], v[60:63], v[140:143]
    v_mfma_f32_16x16x32_bf16 v[152:155], v[216:219], v[60:63], v[152:155]
    v_mfma_f32_16x16x32_bf16 v[156:159], v[220:223], v[60:63], v[156:159]
    v_add_u32 v10, 81920, v6
    v_add_u32 v11, 81920, v7
    v_cvt_pk_bf16_f32 v16, v96, v97
    v_lshlrev_b32 v48, 16, v16
    v_and_b32 v49, 0xffff0000, v16
    v_mul_f32 v50, s72, v48
    v_mul_f32 v51, s72, v49
    v_exp_f32 v50, v50 clamp
    v_exp_f32 v51, v51 clamp
    v_max_f32 v48, 0, v48
    v_max_f32 v49, 0, v49
    v_add_f32 v48, v48, v50
    v_add_f32 v49, v49, v51
    v_min_f32 v56, v48, v49
    v_cvt_pk_bf16_f32 v16, v48, v49
    v_cvt_pk_bf16_f32 v17, v98, v99
    v_lshlrev_b32 v48, 16, v17
    v_and_b32 v49, 0xffff0000, v17
    v_mul_f32 v50, s72, v48
    v_mul_f32 v51, s72, v49
    v_exp_f32 v50, v50 clamp
    v_exp_f32 v51, v51 clamp
    v_max_f32 v48, 0, v48
    v_max_f32 v49, 0, v49
    v_add_f32 v48, v48, v50
    v_add_f32 v49, v49, v51
    v_min3_f32 v56, v48, v49, v56
    v_cvt_pk_bf16_f32 v17, v48, v49
    v_cvt_pk_bf16_f32 v18, v100, v101
    v_lshlrev_b32 v48, 16, v18
    v_and_b32 v49, 0xffff0000, v18
    v_mul_f32 v50, s72, v48
    v_mul_f32 v51, s72, v49
    v_exp_f32 v50, v50 clamp
    v_exp_f32 v51, v51 clamp
    v_max_f32 v48, 0, v48
    v_max_f32 v49, 0, v49
    v_add_f32 v48, v48, v50
    v_add_f32 v49, v49, v51
    v_min3_f32 v56, v48, v49, v56
    v_cvt_pk_bf16_f32 v18, v48, v49
    v_cvt_pk_bf16_f32 v19, v102, v103
    v_lshlrev_b32 v48, 16, v19
    v_and_b32 v49, 0xffff0000, v19
    v_mul_f32 v50, s72, v48
    v_mul_f32 v51, s72, v49
    v_exp_f32 v50, v50 clamp
    v_exp_f32 v51, v51 clamp
    v_max_f32 v48, 0, v48
    v_max_f32 v49, 0, v49
    v_add_f32 v48, v48, v50
    v_add_f32 v49, v49, v51
    v_min3_f32 v56, v48, v49, v56
    v_cvt_pk_bf16_f32 v19, v48, v49
    v_cvt_pk_bf16_f32 v20, v104, v105
    v_lshlrev_b32 v48, 16, v20
    v_and_b32 v49, 0xffff0000, v20
    v_mul_f32 v50, s72, v48
    v_mul_f32 v51, s72, v49
    v_exp_f32 v50, v50 clamp
    v_exp_f32 v51, v51 clamp
    v_max_f32 v48, 0, v48
    v_max_f32 v49, 0, v49
    v_add_f32 v48, v48, v50
    v_add_f32 v49, v49, v51
    v_min3_f32 v56, v48, v49, v56
    v_cvt_pk_bf16_f32 v20, v48, v49
    v_cvt_pk_bf16_f32 v21, v106, v107
    v_lshlrev_b32 v48, 16, v21
    v_and_b32 v49, 0xffff0000, v21
    v_mul_f32 v50, s72, v48
    v_mul_f32 v51, s72, v49
    v_exp_f32 v50, v50 clamp
    v_exp_f32 v51, v51 clamp
    v_max_f32 v48, 0, v48
    v_max_f32 v49, 0, v49
    v_add_f32 v48, v48, v50
    v_add_f32 v49, v49, v51
    v_min3_f32 v56, v48, v49, v56
    v_cvt_pk_bf16_f32 v21, v48, v49
    v_cvt_pk_bf16_f32 v22, v108, v109
    v_lshlrev_b32 v48, 16, v22
    v_and_b32 v49, 0xffff0000, v22
    v_mul_f32 v50, s72, v48
    v_mul_f32 v51, s72, v49
    v_exp_f32 v50, v50 clamp
    v_exp_f32 v51, v51 clamp
    v_max_f32 v48, 0, v48
    v_max_f32 v49, 0, v49
    v_add_f32 v48, v48, v50
    v_add_f32 v49, v49, v51
    v_min3_f32 v56, v48, v49, v56
    v_cvt_pk_bf16_f32 v22, v48, v49
    v_cvt_pk_bf16_f32 v23, v110, v111
    v_lshlrev_b32 v48, 16, v23
    v_and_b32 v49, 0xffff0000, v23
    v_mul_f32 v50, s72, v48
    v_mul_f32 v51, s72, v49
    v_exp_f32 v50, v50 clamp
    v_exp_f32 v51, v51 clamp
    v_max_f32 v48, 0, v48
    v_max_f32 v49, 0, v49
    v_add_f32 v48, v48, v50
    v_add_f32 v49, v49, v51
    v_min3_f32 v56, v48, v49, v56
    v_cvt_pk_bf16_f32 v23, v48, v49
    v_cmp_gt_f32 vcc, 0x3a800000, v56
    s_cbranch_vccnz phi_16_fix
phi_16_done:
    v_cvt_pk_bf16_f32 v32, v128, v129
    v_cvt_pk_bf16_f32 v33, v130, v131
    v_mfma_f32_16x16x32_bf16 v[96:99], v[236:239], v[16:19], 0
    v_cvt_pk_bf16_f32 v34, v132, v133
    v_mfma_f32_16x16x32_bf16 v[60:63], v[236:239], v[20:23], 0
    v_cvt_pk_bf16_f32 v35, v134, v135
    v_cvt_pk_bf16_f32 v36, v136, v137
    v_cvt_pk_bf16_f32 v37, v138, v139
    v_mfma_f32_16x16x32_bf16 v[240:243], v[16:19], v[32:35], 0
    v_cvt_pk_bf16_f32 v38, v140, v141
    v_mfma_f32_16x16x32_bf16 v[244:247], v[20:23], v[32:35], 0
    v_cvt_pk_bf16_f32 v39, v142, v143
    s_nop 1
    v_mfma_f32_16x16x32_bf16 v[248:251], v[16:19], v[36:39], 0
    v_mfma_f32_16x16x32_bf16 v[252:255], v[20:23], v[36:39], 0
    v_cvt_pk_bf16_f32 v24, v112, v113
    v_lshlrev_b32 v48, 16, v24
    v_and_b32 v49, 0xffff0000, v24
    v_mul_f32 v50, s72, v48
    v_mul_f32 v51, s72, v49
    v_exp_f32 v50, v50 clamp
    v_exp_f32 v51, v51 clamp
    v_max_f32 v48, 0, v48
    v_max_f32 v49, 0, v49
    v_add_f32 v48, v48, v50
    v_add_f32 v49, v49, v51
    v_min_f32 v56, v48, v49
    v_cvt_pk_bf16_f32 v24, v48, v49
    v_cvt_pk_bf16_f32 v25, v114, v115
    v_lshlrev_b32 v48, 16, v25
    v_and_b32 v49, 0xffff0000, v25
    v_mul_f32 v50, s72, v48
    v_mul_f32 v51, s72, v49
    v_exp_f32 v50, v50 clamp
    v_exp_f32 v51, v51 clamp
    v_max_f32 v48, 0, v48
    v_max_f32 v49, 0, v49
    v_add_f32 v48, v48, v50
    v_add_f32 v49, v49, v51
    v_min3_f32 v56, v48, v49, v56
    v_cvt_pk_bf16_f32 v25, v48, v49
    v_cvt_pk_bf16_f32 v26, v116, v117
    v_lshlrev_b32 v48, 16, v26
    v_and_b32 v49, 0xffff0000, v26
    v_mul_f32 v50, s72, v48
    v_mul_f32 v51, s72, v49
    v_exp_f32 v50, v50 clamp
    v_exp_f32 v51, v51 clamp
    v_max_f32 v48, 0, v48
    v_max_f32 v49, 0, v49
    v_add_f32 v48, v48, v50
    v_add_f32 v49, v49, v51
    v_min3_f32 v56, v48, v49, v56
    v_cvt_pk_bf16_f32 v26, v48, v49
    v_cvt_pk_bf16_f32 v27, v118, v119
    v_lshlrev_b32 v48, 16, v27
    v_and_b32 v49, 0xffff0000, v27
    v_mul_f32 v50, s72, v48
    v_mul_f32 v51, s72, v49
    v_exp_f32 v50, v50 clamp
    v_exp_f32 v51, v51 clamp
    v_max_f32 v48, 0, v48
    v_max_f32 v49, 0, v49
    v_add_f32 v48, v48, v50
    v_add_f32 v49, v49, v51
    v_min3_f32 v56, v48, v49, v56
    v_cvt_pk_bf16_f32 v27, v48, v49
    v_cvt_pk_bf16_f32 v28, v120, v121
    v_lshlrev_b32 v48, 16, v28
    v_and_b32 v49, 0xffff0000, v28
    v_mul_f32 v50, s72, v48
    v_mul_f32 v51, s72, v49
    v_exp_f32 v50, v50 clamp
    v_exp_f32 v51, v51 clamp
    v_max_f32 v48, 0, v48
    v_max_f32 v49, 0, v49
    v_add_f32 v48, v48, v50
    v_add_f32 v49, v49, v51
    v_min3_f32 v56, v48, v49, v56
    v_cvt_pk_bf16_f32 v28, v48, v49
    v_cvt_pk_bf16_f32 v29, v122, v123
    v_lshlrev_b32 v48, 16, v29
    v_and_b32 v49, 0xffff0000, v29
    v_mul_f32 v50, s72, v48
    v_mul_f32 v51, s72, v49
    v_exp_f32 v50, v50 clamp
    v_exp_f32 v51, v51 clamp
    v_max_f32 v48, 0, v48
    v_max_f32 v49, 0, v49
    v_add_f32 v48, v48, v50
    v_add_f32 v49, v49, v51
    v_min3_f32 v56, v48, v49, v56
    v_cvt_pk_bf16_f32 v29, v48, v49
    v_cvt_pk_bf16_f32 v30, v124, v125
    v_lshlrev_b32 v48, 16, v30
    v_and_b32 v49, 0xffff0000, v30
    v_mul_f32 v50, s72, v48
    v_mul_f32 v51, s72, v49
    v_exp_f32 v50, v50 clamp
    v_exp_f32 v51, v51 clamp
    v_max_f32 v48, 0, v48
    v_max_f32 v49, 0, v49
    v_add_f32 v48, v48, v50
    v_add_f32 v49, v49, v51
    v_min3_f32 v56, v48, v49, v56
    v_cvt_pk_bf16_f32 v30, v48, v49
    v_cvt_pk_bf16_f32 v31, v126, v127
    v_lshlrev_b32 v48, 16, v31
    v_and_b32 v49, 0xffff0000, v31
    v_mul_f32 v50, s72, v48
    v_mul_f32 v51, s72, v49
    v_exp_f32 v50, v50 clamp
    v_exp_f32 v51, v51 clamp
    v_max_f32 v48, 0, v48
    v_max_f32 v49, 0, v49
    v_add_f32 v48, v48, v50
    v_add_f32 v49, v49, v51
    v_min3_f32 v56, v48, v49, v56
    v_cvt_pk_bf16_f32 v31, v48, v49
    v_cmp_gt_f32 vcc, 0x3a800000, v56
    s_cbranch_vccnz phi_17_fix
phi_17_done:
    v_cvt_pk_bf16_f32 v40, v144, v145
    v_cvt_pk_bf16_f32 v41, v146, v147
    v_mfma_f32_16x16x32_bf16 v[96:99], v[236:239], v[24:27], v[96:99]
    v_cvt_pk_bf16_f32 v42, v148, v149
    v_mfma_f32_16x16x32_bf16 v[60:63], v[236:239], v[28:31], v[60:63]
    v_cvt_pk_bf16_f32 v43, v150, v151
    v_cvt_pk_bf16_f32 v44, v152, v153
    v_cvt_pk_bf16_f32 v45, v154, v155
    v_mfma_f32_16x16x32_bf16 v[240:243], v[24:27], v[40:43], v[240:243]
    v_cvt_pk_bf16_f32 v46, v156, v157
    v_mfma_f32_16x16x32_bf16 v[244:247], v[28:31], v[40:43], v[244:247]
    v_cvt_pk_bf16_f32 v47, v158, v159
    s_nop 1
    v_mfma_f32_16x16x32_bf16 v[248:251], v[24:27], v[44:47], v[248:251]
    v_mfma_f32_16x16x32_bf16 v[252:255], v[28:31], v[44:47], v[252:255]
    s_cmp_eq_u32 s6, 0
    s_cbranch_scc0 C_ex1
    ds_write_b32 v227, v60 offset:4608
    s_nop 5
    ds_write_b128 v224, v[248:251] offset:32768
    ds_write_b128 v224, v[252:255] offset:33792
C_ex2:
    ds_write_b32 v229, v231 offset:4288
C_ps:
    ds_read_b32 v25, v230 offset:4288
    ds_read_b128 v[16:19], v225 offset:32768
    ds_read_b128 v[20:23], v225 offset:33792
    ds_read_b32 v24, v228 offset:4608
    s_waitcnt lgkmcnt(0)
    v_cmp_eq_u32 vcc, 0, v25
    s_cbranch_vccnz C_ps
    v_add_f32 v16, v16, v240
    v_add_f32 v17, v17, v241
    v_add_f32 v18, v18, v242
    v_add_f32 v19, v19, v243
    v_add_f32 v20, v20, v244
    v_add_f32 v21, v21, v245
    v_add_f32 v22, v22, v246
    v_add_f32 v23, v23, v247
    v_add_f32 v24, v24, v96
    v_cvt_pk_bf16_f32 v28, v16, v17
    v_cvt_pk_bf16_f32 v29, v18, v19
    v_cvt_pk_bf16_f32 v30, v20, v21
    v_cvt_pk_bf16_f32 v31, v22, v23
    buffer_store_dwordx4 v[28:31], v1, s[16:19], s43 offen sc0 sc1
    s_mov_b64 exec, 0xffff
    buffer_store_dword v24, v232, s[16:19], s43 offen offset:1024 sc0 sc1
    s_mov_b64 exec, 1
    buffer_atomic_or v233, v234, s[16:19], 0 offen
    s_mov_b64 exec, -1
    ds_read_b64_tr_b16 v[96:97], v10 offset:0
    ds_read_b64_tr_b16 v[98:99], v10 offset:512
    ds_read_b64_tr_b16 v[100:101], v11 offset:0
    ds_read_b64_tr_b16 v[102:103], v11 offset:512
    ds_read_b64_tr_b16 v[104:105], v10 offset:4096
    ds_read_b64_tr_b16 v[106:107], v10 offset:4608
    ds_read_b64_tr_b16 v[108:109], v11 offset:4096
    ds_read_b64_tr_b16 v[110:111], v11 offset:4608
    ds_read_b64_tr_b16 v[112:113], v6 offset:0
    ds_read_b64_tr_b16 v[114:115], v6 offset:512
    ds_read_b64_tr_b16 v[116:117], v7 offset:0
    ds_read_b64_tr_b16 v[118:119], v7 offset:512
    ds_read_b64_tr_b16 v[120:121], v6 offset:4096
    ds_read_b64_tr_b16 v[122:123], v6 offset:4608
    ds_read_b64_tr_b16 v[124:125], v7 offset:4096
    ds_read_b64_tr_b16 v[126:127], v7 offset:4608
    s_waitcnt lgkmcnt(12)
    v_mfma_f32_16x16x32_bf16 v[64:67], v[96:99], v[192:195], v[64:67]
    v_mfma_f32_16x16x32_bf16 v[72:75], v[96:99], v[196:199], v[72:75]
    v_mfma_f32_16x16x32_bf16 v[80:83], v[96:99], v[200:203], v[80:83]
    v_mfma_f32_16x16x32_bf16 v[88:91], v[96:99], v[204:207], v[88:91]
    v_mfma_f32_16x16x32_bf16 v[68:71], v[100:103], v[192:195], v[68:71]
    v_mfma_f32_16x16x32_bf16 v[76:79], v[100:103], v[196:199], v[76:79]
    v_mfma_f32_16x16x32_bf16 v[84:87], v[100:103], v[200:203], v[84:87]
    v_mfma_f32_16x16x32_bf16 v[92:95], v[100:103], v[204:207], v[92:95]
    s_waitcnt lgkmcnt(8)
    v_mfma_f32_16x16x32_bf16 v[64:67], v[104:107], v[160:163], v[64:67]
    v_mfma_f32_16x16x32_bf16 v[72:75], v[104:107], v[164:167], v[72:75]
    v_mfma_f32_16x16x32_bf16 v[80:83], v[104:107], v[168:171], v[80:83]
    v_mfma_f32_16x16x32_bf16 v[88:91], v[104:107], v[172:175], v[88:91]
    v_mfma_f32_16x16x32_bf16 v[68:71], v[108:111], v[160:163], v[68:71]
    v_mfma_f32_16x16x32_bf16 v[76:79], v[108:111], v[164:167], v[76:79]
    v_mfma_f32_16x16x32_bf16 v[84:87], v[108:111], v[168:171], v[84:87]
    v_mfma_f32_16x16x32_bf16 v[92:95], v[108:111], v[172:175], v[92:95]
    s_waitcnt lgkmcnt(4)
    v_mfma_f32_16x16x32_bf16 v[64:67], v[112:115], v[176:179], v[64:67]
    v_mfma_f32_16x16x32_bf16 v[72:75], v[112:115], v[180:183], v[72:75]
    v_mfma_f32_16x16x32_bf16 v[80:83], v[112:115], v[184:187], v[80:83]
    v_mfma_f32_16x16x32_bf16 v[88:91], v[112:115], v[188:191], v[88:91]
    v_mfma_f32_16x16x32_bf16 v[68:71], v[116:119], v[176:179], v[68:71]
    v_mfma_f32_16x16x32_bf16 v[76:79], v[116:119], v[180:183], v[76:79]
    v_mfma_f32_16x16x32_bf16 v[84:87], v[116:119], v[184:187], v[84:87]
    v_mfma_f32_16x16x32_bf16 v[92:95], v[116:119], v[188:191], v[92:95]
    s_waitcnt lgkmcnt(0)
    v_mfma_f32_16x16x32_bf16 v[64:67], v[120:123], v[208:211], v[64:67]
    v_mfma_f32_16x16x32_bf16 v[72:75], v[120:123], v[212:215], v[72:75]
    v_mfma_f32_16x16x32_bf16 v[80:83], v[120:123], v[216:219], v[80:83]
    v_mfma_f32_16x16x32_bf16 v[88:91], v[120:123], v[220:223], v[88:91]
    v_mfma_f32_16x16x32_bf16 v[68:71], v[124:127], v[208:211], v[68:71]
    v_mfma_f32_16x16x32_bf16 v[76:79], v[124:127], v[212:215], v[76:79]
    v_mfma_f32_16x16x32_bf16 v[84:87], v[124:127], v[216:219], v[84:87]
    v_mfma_f32_16x16x32_bf16 v[92:95], v[124:127], v[220:223], v[92:95]
    v_mov_b32 v254, v15
    v_mov_b32 v255, v13
    s_and_b32 s64, s3, 3
    s_lshl_b32 s64, s64, 1
    s_lshr_b32 s65, s3, 2
    s_add_u32 s64, s64, s65
    s_lshl_b32 s64, s64, 4
    s_lshl_b32 s65, s4, 7
    s_add_u32 s64, s64, s65
    v_and_b32 v230, 15, v2
    v_add_u32 v230, s64, v230
    v_bfe_u32 v3, v2, 4, 1
    v_lshlrev_b32 v229, 5, v3
    v_lshrrev_b32 v3, 5, v2
    v_lshl_add_u32 v229, v3, 4, v229
    v_lshl_add_u32 v231, v230, 11, v229
    s_lshl_b32 s64, s5, 7
    v_add_u32 v231, s64, v231
    v_lshlrev_b32 v3, 2, v230
    v_add_u32 v3, 6709248, v3
    buffer_load_dwordx4 v[220:223], v231, s[8:11], 0 offen
    buffer_load_dwordx4 v[224:227], v231, s[8:11], 0 offen offset:64
    buffer_load_dword v228, v3, s[16:19], 0 offen sc1
    v_lshlrev_b32 v3, 4, v2
    s_lshl_b32 s64, s7, 11
    v_add_u32 v4, s64, v3
    v_lshrrev_b32 v5, 4, v2
    v_lshlrev_b32 v5, 4, v5
    s_lshl_b32 s64, s7, 6
    v_add_u32 v5, s64, v5
    v_mov_b32 v6, 4256
    ds_read_b32 v6, v6
    v_cvt_pk_bf16_f32 v32, v64, v65
    v_lshlrev_b32 v48, 16, v32
    v_and_b32 v49, 0xffff0000, v32
    v_mul_f32 v50, s72, v48
    v_mul_f32 v51, s72, v49
    v_exp_f32 v50, v50 clamp
    v_exp_f32 v51, v51 clamp
    v_max_f32 v48, 0, v48
    v_max_f32 v49, 0, v49
    v_add_f32 v48, v48, v50
    v_add_f32 v49, v49, v51
    v_min_f32 v56, v48, v49
    v_cvt_pk_bf16_f32 v32, v48, v49
    v_cvt_pk_bf16_f32 v33, v66, v67
    v_lshlrev_b32 v48, 16, v33
    v_and_b32 v49, 0xffff0000, v33
    v_mul_f32 v50, s72, v48
    v_mul_f32 v51, s72, v49
    v_exp_f32 v50, v50 clamp
    v_exp_f32 v51, v51 clamp
    v_max_f32 v48, 0, v48
    v_max_f32 v49, 0, v49
    v_add_f32 v48, v48, v50
    v_add_f32 v49, v49, v51
    v_min3_f32 v56, v48, v49, v56
    v_cvt_pk_bf16_f32 v33, v48, v49
    v_cvt_pk_bf16_f32 v34, v68, v69
    v_lshlrev_b32 v48, 16, v34
    v_and_b32 v49, 0xffff0000, v34
    v_mul_f32 v50, s72, v48
    v_mul_f32 v51, s72, v49
    v_exp_f32 v50, v50 clamp
    v_exp_f32 v51, v51 clamp
    v_max_f32 v48, 0, v48
    v_max_f32 v49, 0, v49
    v_add_f32 v48, v48, v50
    v_add_f32 v49, v49, v51
    v_min3_f32 v56, v48, v49, v56
    v_cvt_pk_bf16_f32 v34, v48, v49
    v_cvt_pk_bf16_f32 v35, v70, v71
    v_lshlrev_b32 v48, 16, v35
    v_and_b32 v49, 0xffff0000, v35
    v_mul_f32 v50, s72, v48
    v_mul_f32 v51, s72, v49
    v_exp_f32 v50, v50 clamp
    v_exp_f32 v51, v51 clamp
    v_max_f32 v48, 0, v48
    v_max_f32 v49, 0, v49
    v_add_f32 v48, v48, v50
    v_add_f32 v49, v49, v51
    v_min3_f32 v56, v48, v49, v56
    v_cvt_pk_bf16_f32 v35, v48, v49
    v_cvt_pk_bf16_f32 v36, v72, v73
    v_lshlrev_b32 v48, 16, v36
    v_and_b32 v49, 0xffff0000, v36
    v_mul_f32 v50, s72, v48
    v_mul_f32 v51, s72, v49
    v_exp_f32 v50, v50 clamp
    v_exp_f32 v51, v51 clamp
    v_max_f32 v48, 0, v48
    v_max_f32 v49, 0, v49
    v_add_f32 v48, v48, v50
    v_add_f32 v49, v49, v51
    v_min3_f32 v56, v48, v49, v56
    v_cvt_pk_bf16_f32 v36, v48, v49
    v_cvt_pk_bf16_f32 v37, v74, v75
    v_lshlrev_b32 v48, 16, v37
    v_and_b32 v49, 0xffff0000, v37
    v_mul_f32 v50, s72, v48
    v_mul_f32 v51, s72, v49
    v_exp_f32 v50, v50 clamp
    v_exp_f32 v51, v51 clamp
    v_max_f32 v48, 0, v48
    v_max_f32 v49, 0, v49
    v_add_f32 v48, v48, v50
    v_add_f32 v49, v49, v51
    v_min3_f32 v56, v48, v49, v56
    v_cvt_pk_bf16_f32 v37, v48, v49
    v_cvt_pk_bf16_f32 v38, v76, v77
    v_lshlrev_b32 v48, 16, v38
    v_and_b32 v49, 0xffff0000, v38
    v_mul_f32 v50, s72, v48
    v_mul_f32 v51, s72, v49
    v_exp_f32 v50, v50 clamp
    v_exp_f32 v51, v51 clamp
    v_max_f32 v48, 0, v48
    v_max_f32 v49, 0, v49
    v_add_f32 v48, v48, v50
    v_add_f32 v49, v49, v51
    v_min3_f32 v56, v48, v49, v56
    v_cvt_pk_bf16_f32 v38, v48, v49
    v_cvt_pk_bf16_f32 v39, v78, v79
    v_lshlrev_b32 v48, 16, v39
    v_and_b32 v49, 0xffff0000, v39
    v_mul_f32 v50, s72, v48
    v_mul_f32 v51, s72, v49
    v_exp_f32 v50, v50 clamp
    v_exp_f32 v51, v51 clamp
    v_max_f32 v48, 0, v48
    v_max_f32 v49, 0, v49
    v_add_f32 v48, v48, v50
    v_add_f32 v49, v49, v51
    v_min3_f32 v56, v48, v49, v56
    v_cvt_pk_bf16_f32 v39, v48, v49
    v_cmp_gt_f32 vcc, 0x3a800000, v56
    s_cbranch_vccnz phi_18_fix
phi_18_done:
    v_cvt_pk_bf16_f32 v40, v80, v81
    v_lshlrev_b32 v48, 16, v40
    v_and_b32 v49, 0xffff0000, v40
    v_mul_f32 v50, s72, v48
    v_mul_f32 v51, s72, v49
    v_exp_f32 v50, v50 clamp
    v_exp_f32 v51, v51 clamp
    v_max_f32 v48, 0, v48
    v_max_f32 v49, 0, v49
    v_add_f32 v48, v48, v50
    v_add_f32 v49, v49, v51
    v_min_f32 v56, v48, v49
    v_cvt_pk_bf16_f32 v40, v48, v49
    v_cvt_pk_bf16_f32 v41, v82, v83
    v_lshlrev_b32 v48, 16, v41
    v_and_b32 v49, 0xffff0000, v41
    v_mul_f32 v50, s72, v48
    v_mul_f32 v51, s72, v49
    v_exp_f32 v50, v50 clamp
    v_exp_f32 v51, v51 clamp
    v_max_f32 v48, 0, v48
    v_max_f32 v49, 0, v49
    v_add_f32 v48, v48, v50
    v_add_f32 v49, v49, v51
    v_min3_f32 v56, v48, v49, v56
    v_cvt_pk_bf16_f32 v41, v48, v49
    v_cvt_pk_bf16_f32 v42, v84, v85
    v_lshlrev_b32 v48, 16, v42
    v_and_b32 v49, 0xffff0000, v42
    v_mul_f32 v50, s72, v48
    v_mul_f32 v51, s72, v49
    v_exp_f32 v50, v50 clamp
    v_exp_f32 v51, v51 clamp
    v_max_f32 v48, 0, v48
    v_max_f32 v49, 0, v49
    v_add_f32 v48, v48, v50
    v_add_f32 v49, v49, v51
    v_min3_f32 v56, v48, v49, v56
    v_cvt_pk_bf16_f32 v42, v48, v49
    v_cvt_pk_bf16_f32 v43, v86, v87
    v_lshlrev_b32 v48, 16, v43
    v_and_b32 v49, 0xffff0000, v43
    v_mul_f32 v50, s72, v48
    v_mul_f32 v51, s72, v49
    v_exp_f32 v50, v50 clamp
    v_exp_f32 v51, v51 clamp
    v_max_f32 v48, 0, v48
    v_max_f32 v49, 0, v49
    v_add_f32 v48, v48, v50
    v_add_f32 v49, v49, v51
    v_min3_f32 v56, v48, v49, v56
    v_cvt_pk_bf16_f32 v43, v48, v49
    v_cvt_pk_bf16_f32 v44, v88, v89
    v_lshlrev_b32 v48, 16, v44
    v_and_b32 v49, 0xffff0000, v44
    v_mul_f32 v50, s72, v48
    v_mul_f32 v51, s72, v49
    v_exp_f32 v50, v50 clamp
    v_exp_f32 v51, v51 clamp
    v_max_f32 v48, 0, v48
    v_max_f32 v49, 0, v49
    v_add_f32 v48, v48, v50
    v_add_f32 v49, v49, v51
    v_min3_f32 v56, v48, v49, v56
    v_cvt_pk_bf16_f32 v44, v48, v49
    v_cvt_pk_bf16_f32 v45, v90, v91
    v_lshlrev_b32 v48, 16, v45
    v_and_b32 v49, 0xffff0000, v45
    v_mul_f32 v50, s72, v48
    v_mul_f32 v51, s72, v49
    v_exp_f32 v50, v50 clamp
    v_exp_f32 v51, v51 clamp
    v_max_f32 v48, 0, v48
    v_max_f32 v49, 0, v49
    v_add_f32 v48, v48, v50
    v_add_f32 v49, v49, v51
    v_min3_f32 v56, v48, v49, v56
    v_cvt_pk_bf16_f32 v45, v48, v49
    v_cvt_pk_bf16_f32 v46, v92, v93
    v_lshlrev_b32 v48, 16, v46
    v_and_b32 v49, 0xffff0000, v46
    v_mul_f32 v50, s72, v48
    v_mul_f32 v51, s72, v49
    v_exp_f32 v50, v50 clamp
    v_exp_f32 v51, v51 clamp
    v_max_f32 v48, 0, v48
    v_max_f32 v49, 0, v49
    v_add_f32 v48, v48, v50
    v_add_f32 v49, v49, v51
    v_min3_f32 v56, v48, v49, v56
    v_cvt_pk_bf16_f32 v46, v48, v49
    v_cvt_pk_bf16_f32 v47, v94, v95
    v_lshlrev_b32 v48, 16, v47
    v_and_b32 v49, 0xffff0000, v47
    v_mul_f32 v50, s72, v48
    v_mul_f32 v51, s72, v49
    v_exp_f32 v50, v50 clamp
    v_exp_f32 v51, v51 clamp
    v_max_f32 v48, 0, v48
    v_max_f32 v49, 0, v49
    v_add_f32 v48, v48, v50
    v_add_f32 v49, v49, v51
    v_min3_f32 v56, v48, v49, v56
    v_cvt_pk_bf16_f32 v47, v48, v49
    v_cmp_gt_f32 vcc, 0x3a800000, v56
    s_cbranch_vccnz phi_19_fix
phi_19_done:
    s_waitcnt lgkmcnt(0)
    v_readfirstlane_b32 s75, v6
    s_waitcnt vmcnt(0)
    v_sub_f32 v248, 1.0, v228
    v_cvt_pk_bf16_f32 v248, v248, v248
    v_lshlrev_b32 v248, 16, v248
    v_lshlrev_b32 v232, 16, v220
    v_and_b32 v233, 0xffff0000, v220
    v_mul_f32 v232, v232, v248
    v_mul_f32 v233, v233, v248
    v_cvt_pk_bf16_f32 v3, v232, v233
    v_lshlrev_b32 v232, 16, v3
    v_and_b32 v233, 0xffff0000, v3
    v_lshlrev_b32 v234, 16, v221
    v_and_b32 v235, 0xffff0000, v221
    v_mul_f32 v234, v234, v248
    v_mul_f32 v235, v235, v248
    v_cvt_pk_bf16_f32 v3, v234, v235
    v_lshlrev_b32 v234, 16, v3
    v_and_b32 v235, 0xffff0000, v3
    v_lshlrev_b32 v236, 16, v222
    v_and_b32 v237, 0xffff0000, v222
    v_mul_f32 v236, v236, v248
    v_mul_f32 v237, v237, v248
    v_cvt_pk_bf16_f32 v3, v236, v237
    v_lshlrev_b32 v236, 16, v3
    v_and_b32 v237, 0xffff0000, v3
    v_lshlrev_b32 v238, 16, v223
    v_and_b32 v239, 0xffff0000, v223
    v_mul_f32 v238, v238, v248
    v_mul_f32 v239, v239, v248
    v_cvt_pk_bf16_f32 v3, v238, v239
    v_lshlrev_b32 v238, 16, v3
    v_and_b32 v239, 0xffff0000, v3
    v_lshlrev_b32 v240, 16, v224
    v_and_b32 v241, 0xffff0000, v224
    v_mul_f32 v240, v240, v248
    v_mul_f32 v241, v241, v248
    v_cvt_pk_bf16_f32 v3, v240, v241
    v_lshlrev_b32 v240, 16, v3
    v_and_b32 v241, 0xffff0000, v3
    v_lshlrev_b32 v242, 16, v225
    v_and_b32 v243, 0xffff0000, v225
    v_mul_f32 v242, v242, v248
    v_mul_f32 v243, v243, v248
    v_cvt_pk_bf16_f32 v3, v242, v243
    v_lshlrev_b32 v242, 16, v3
    v_and_b32 v243, 0xffff0000, v3
    v_lshlrev_b32 v244, 16, v226
    v_and_b32 v245, 0xffff0000, v226
    v_mul_f32 v244, v244, v248
    v_mul_f32 v245, v245, v248
    v_cvt_pk_bf16_f32 v3, v244, v245
    v_lshlrev_b32 v244, 16, v3
    v_and_b32 v245, 0xffff0000, v3
    v_lshlrev_b32 v246, 16, v227
    v_and_b32 v247, 0xffff0000, v227
    v_mul_f32 v246, v246, v248
    v_mul_f32 v247, v247, v248
    v_cvt_pk_bf16_f32 v3, v246, v247
    v_lshlrev_b32 v246, 16, v3
    v_and_b32 v247, 0xffff0000, v3
    s_cmp_lg_u32 s3, 0
    s_cbranch_scc1 C_nh
    s_lshr_b32 s64, s2, 2
    s_lshl_b32 s64, s64, 14
    s_add_u32 s64, s64, 5398528
    v_lshl_add_u32 v16, v2, 4, s64
    v_lshrrev_b32 v8, 4, v2
    s_mov_b32 s65, 0
H_hl:
    s_mov_b32 s64, 0
    buffer_load_dwordx4 v[64:67], v16, s[16:19], s64 offen offset:0 sc1
    s_mov_b32 s64, 0
    buffer_load_dwordx4 v[68:71], v16, s[16:19], s64 offen offset:1024 sc1
    s_mov_b32 s64, 0
    buffer_load_dwordx4 v[72:75], v16, s[16:19], s64 offen offset:2048 sc1
    s_mov_b32 s64, 0
    buffer_load_dwordx4 v[76:79], v16, s[16:19], s64 offen offset:3072 sc1
    s_mov_b32 s64, 4096
    buffer_load_dwordx4 v[80:83], v16, s[16:19], s64 offen offset:0 sc1
    s_mov_b32 s64, 4096
    buffer_load_dwordx4 v[84:87], v16, s[16:19], s64 offen offset:1024 sc1
    s_mov_b32 s64, 4096
    buffer_load_dwordx4 v[88:91], v16, s[16:19], s64 offen offset:2048 sc1
    s_mov_b32 s64, 4096
    buffer_load_dwordx4 v[92:95], v16, s[16:19], s64 offen offset:3072 sc1
    s_mov_b32 s64, 8192
    buffer_load_dwordx4 v[96:99], v16, s[16:19], s64 offen offset:0 sc1
    s_mov_b32 s64, 8192
    buffer_load_dwordx4 v[100:103], v16, s[16:19], s64 offen offset:1024 sc1
    s_mov_b32 s64, 8192
    buffer_load_dwordx4 v[104:107], v16, s[16:19], s64 offen offset:2048 sc1
    s_mov_b32 s64, 8192
    buffer_load_dwordx4 v[108:111], v16, s[16:19], s64 offen offset:3072 sc1
    s_mov_b32 s64, 12288
    buffer_load_dwordx4 v[112:115], v16, s[16:19], s64 offen offset:0 sc1
    s_mov_b32 s64, 12288
    buffer_load_dwordx4 v[116:119], v16, s[16:19], s64 offen offset:1024 sc1
    s_mov_b32 s64, 12288
    buffer_load_dwordx4 v[120:123], v16, s[16:19], s64 offen offset:2048 sc1
    s_mov_b32 s64, 12288
    buffer_load_dwordx4 v[124:127], v16, s[16:19], s64 offen offset:3072 sc1
    s_waitcnt vmcnt(0)
    v_max3_u32 v17, v64, v65, v66
    v_max3_u32 v17, v67, v68, v17
    v_max3_u32 v17, v69, v70, v17
    v_max3_u32 v17, v71, v72, v17
    v_max3_u32 v17, v73, v74, v17
    v_max3_u32 v17, v75, v76, v17
    v_max3_u32 v17, v77, v78, v17
    v_max3_u32 v17, v79, v80, v17
    v_max3_u32 v17, v81, v82, v17
    v_max3_u32 v17, v83, v84, v17
    v_max3_u32 v17, v85, v86, v17
    v_max3_u32 v17, v87, v88, v17
    v_max3_u32 v17, v89, v90, v17
    v_max3_u32 v17, v91, v92, v17
    v_max3_u32 v17, v93, v94, v17
    v_max3_u32 v17, v95, v96, v17
    v_max3_u32 v17, v97, v98, v17
    v_max3_u32 v17, v99, v100, v17
    v_max3_u32 v17, v101, v102, v17
    v_max3_u32 v17, v103, v104, v17
    v_max3_u32 v17, v105, v106, v17
    v_max3_u32 v17, v107, v108, v17
    v_max3_u32 v17, v109, v110, v17
    v_max3_u32 v17, v111, v112, v17
    v_max3_u32 v17, v113, v114, v17
    v_max3_u32 v17, v115, v116, v17
    v_max3_u32 v17, v117, v118, v17
    v_max3_u32 v17, v119, v120, v17
    v_max3_u32 v17, v121, v122, v17
    v_max3_u32 v17, v123, v124, v17
    v_max3_u32 v17, v125, v126, v17
    v_max_u32 v17, v127, v17
    s_mov_b32 exec_lo, 0x3fff3fff
    s_mov_b32 exec_hi, 0x3fff3fff
    v_cmp_eq_u32 vcc, -1, v17
    s_mov_b64 exec, -1
    s_cbranch_vccz H_hok
    s_add_u32 s65, s65, 1
    s_cmp_ge_u32 s65, 100000
    s_cbranch_scc1 H_hok
    s_sleep 8
    s_branch H_hl
H_hok:
    v_add_f32 v64, v64, v68
    v_add_f32 v65, v65, v69
    v_add_f32 v66, v66, v70
    v_add_f32 v67, v67, v71
    v_add_f32 v64, v64, v72
    v_add_f32 v65, v65, v73
    v_add_f32 v66, v66, v74
    v_add_f32 v67, v67, v75
    v_add_f32 v64, v64, v76
    v_add_f32 v65, v65, v77
    v_add_f32 v66, v66, v78
    v_add_f32 v67, v67, v79
    v_add_f32 v64, v64, v80
    v_add_f32 v65, v65, v81
    v_add_f32 v66, v66, v82
    v_add_f32 v67, v67, v83
    v_add_f32 v64, v64, v84
    v_add_f32 v65, v65, v85
    v_add_f32 v66, v66, v86
    v_add_f32 v67, v67, v87
    v_add_f32 v64, v64, v88
    v_add_f32 v65, v65, v89
    v_add_f32 v66, v66, v90
    v_add_f32 v67, v67, v91
    v_add_f32 v64, v64, v92
    v_add_f32 v65, v65, v93
    v_add_f32 v66, v66, v94
    v_add_f32 v67, v67, v95
    v_add_f32 v96, v96, v100
    v_add_f32 v97, v97, v101
    v_add_f32 v98, v98, v102
    v_add_f32 v99, v99, v103
    v_add_f32 v96, v96, v104
    v_add_f32 v97, v97, v105
    v_add_f32 v98, v98, v106
    v_add_f32 v99, v99, v107
    v_add_f32 v96, v96, v108
    v_add_f32 v97, v97, v109
    v_add_f32 v98, v98, v110
    v_add_f32 v99, v99, v111
    v_add_f32 v96, v96, v112
    v_add_f32 v97, v97, v113
    v_add_f32 v98, v98, v114
    v_add_f32 v99, v99, v115
    v_add_f32 v96, v96, v116
    v_add_f32 v97, v97, v117
    v_add_f32 v98, v98, v118
    v_add_f32 v99, v99, v119
    v_add_f32 v96, v96, v120
    v_add_f32 v97, v97, v121
    v_add_f32 v98, v98, v122
    v_add_f32 v99, v99, v123
    v_add_f32 v96, v96, v124
    v_add_f32 v97, v97, v125
    v_add_f32 v98, v98, v126
    v_add_f32 v99, v99, v127
    s_nop 1
    v_permlane16_swap_b32 v64, v96
    v_permlane16_swap_b32 v65, v97
    v_permlane16_swap_b32 v66, v98
    v_permlane16_swap_b32 v67, v99
    v_add_f32 v64, v64, v96
    v_add_f32 v65, v65, v97
    v_add_f32 v66, v66, v98
    v_add_f32 v67, v67, v99
    s_nop 1
    v_permlane32_swap_b32 v64, v66
    v_permlane32_swap_b32 v65, v67
    v_add_f32 v64, v64, v66
    v_add_f32 v65, v65, v67
    s_nop 1
    v_permlane16_swap_b32 v64, v65
    v_cvt_pk_bf16_f32 v66, v64, v65
    v_lshlrev_b32 v64, 16, v66
    v_and_b32 v65, 0xffff0000, v66
    v_mul_f32 v66, s72, v64
    v_exp_f32 v66, -v66
    v_and_b32 v16, 15, v2
    v_add_f32 v66, 1.0, v66
    v_rcp_f32 v66, v66
    v_lshl_add_u32 v16, v16, 2, v8
    v_mul_f32 v66, v66, v64
    v_cvt_pk_bf16_f32 v66, v66, v66
    v_lshlrev_b32 v66, 16, v66
    v_mul_f32 v66, v66, v65
    v_cvt_pk_bf16_f32 v66, v66, v66
    v_lshlrev_b32 v66, 16, v66
    v_lshlrev_b32 v16, 2, v16
    ds_write_b32 v16, v66 offset:4352
    s_waitcnt lgkmcnt(0)
C_nh:
    v_lshlrev_b32 v3, 4, v2
    s_barrier
    ds_read_b128 v[24:27], v5 offset:4096
    ds_read_b128 v[16:19], v4 offset:0
    ds_read_b128 v[20:23], v4 offset:1024
    s_waitcnt lgkmcnt(2)
    v_mfma_f32_16x16x32_bf16 v[96:99], v[24:27], v[32:35], 0
    v_mfma_f32_16x16x32_bf16 v[100:103], v[24:27], v[36:39], 0
    v_mfma_f32_16x16x32_bf16 v[104:107], v[24:27], v[40:43], 0
    v_mfma_f32_16x16x32_bf16 v[108:111], v[24:27], v[44:47], 0
    s_waitcnt lgkmcnt(0)
    v_mfma_f32_16x16x32_bf16 v[64:67], v[16:19], v[32:35], 0
    v_mfma_f32_16x16x32_bf16 v[68:71], v[20:23], v[32:35], 0
    v_mfma_f32_16x16x32_bf16 v[72:75], v[16:19], v[36:39], 0
    v_mfma_f32_16x16x32_bf16 v[76:79], v[20:23], v[36:39], 0
    v_mfma_f32_16x16x32_bf16 v[80:83], v[16:19], v[40:43], 0
    v_mfma_f32_16x16x32_bf16 v[84:87], v[20:23], v[40:43], 0
    v_mfma_f32_16x16x32_bf16 v[88:91], v[16:19], v[44:47], 0
    v_mfma_f32_16x16x32_bf16 v[92:95], v[20:23], v[44:47], 0
    v_cvt_pk_bf16_f32 v48, v96, v96
    v_cvt_pk_bf16_f32 v49, v100, v100
    v_cvt_pk_bf16_f32 v50, v104, v104
    v_cvt_pk_bf16_f32 v51, v108, v108
    v_lshlrev_b32 v48, 16, v48
    v_lshlrev_b32 v49, 16, v49
    v_lshlrev_b32 v50, 16, v50
    v_lshlrev_b32 v51, 16, v51
    v_add_f32 v48, s73, v48
    v_add_f32 v49, s73, v49
    v_add_f32 v50, s73, v50
    v_add_f32 v51, s73, v51
    v_cvt_pk_bf16_f32 v48, v48, v48
    v_cvt_pk_bf16_f32 v49, v49, v49
    v_cvt_pk_bf16_f32 v50, v50, v50
    v_cvt_pk_bf16_f32 v51, v51, v51
    v_lshlrev_b32 v48, 16, v48
    v_lshlrev_b32 v49, 16, v49
    v_lshlrev_b32 v50, 16, v50
    v_lshlrev_b32 v51, 16, v51
    v_rcp_f32 v48, v48
    v_rcp_f32 v49, v49
    v_rcp_f32 v50, v50
    v_rcp_f32 v51, v51
    s_nop 0
    v_mul_f32 v64, v64, v48
    v_mul_f32 v65, v65, v48
    v_cvt_pk_bf16_f32 v128, v64, v65
    v_mul_f32 v66, v66, v48
    v_mul_f32 v67, v67, v48
    v_cvt_pk_bf16_f32 v129, v66, v67
    v_mul_f32 v68, v68, v48
    v_mul_f32 v69, v69, v48
    v_cvt_pk_bf16_f32 v130, v68, v69
    v_mul_f32 v70, v70, v48
    v_mul_f32 v71, v71, v48
    v_cvt_pk_bf16_f32 v131, v70, v71
    buffer_store_dwordx4 v[128:131], v1, s[16:19], s42 offen offset:0 sc0 sc1
    v_mul_f32 v72, v72, v49
    v_mul_f32 v73, v73, v49
    v_cvt_pk_bf16_f32 v132, v72, v73
    v_mul_f32 v74, v74, v49
    v_mul_f32 v75, v75, v49
    v_cvt_pk_bf16_f32 v133, v74, v75
    v_mul_f32 v76, v76, v49
    v_mul_f32 v77, v77, v49
    v_cvt_pk_bf16_f32 v134, v76, v77
    v_mul_f32 v78, v78, v49
    v_mul_f32 v79, v79, v49
    v_cvt_pk_bf16_f32 v135, v78, v79
    buffer_store_dwordx4 v[132:135], v1, s[16:19], s42 offen offset:1024 sc0 sc1
    s_add_u32 s42, s42, 65536
    v_mul_f32 v80, v80, v50
    v_mul_f32 v81, v81, v50
    v_cvt_pk_bf16_f32 v136, v80, v81
    v_mul_f32 v82, v82, v50
    v_mul_f32 v83, v83, v50
    v_cvt_pk_bf16_f32 v137, v82, v83
    v_mul_f32 v84, v84, v50
    v_mul_f32 v85, v85, v50
    v_cvt_pk_bf16_f32 v138, v84, v85
    v_mul_f32 v86, v86, v50
    v_mul_f32 v87, v87, v50
    v_cvt_pk_bf16_f32 v139, v86, v87
    buffer_store_dwordx4 v[136:139], v1, s[16:19], s42 offen offset:0 sc0 sc1
    v_mul_f32 v88, v88, v51
    v_mul_f32 v89, v89, v51
    v_cvt_pk_bf16_f32 v140, v88, v89
    v_mul_f32 v90, v90, v51
    v_mul_f32 v91, v91, v51
    v_cvt_pk_bf16_f32 v141, v90, v91
    v_mul_f32 v92, v92, v51
    v_mul_f32 v93, v93, v51
    v_cvt_pk_bf16_f32 v142, v92, v93
    v_mul_f32 v94, v94, v51
    v_mul_f32 v95, v95, v51
    v_cvt_pk_bf16_f32 v143, v94, v95
    buffer_store_dwordx4 v[140:143], v1, s[16:19], s42 offen offset:1024 sc0 sc1
    s_lshl_b32 s64, s4, 3
    s_add_u32 s64, s64, s3
    s_lshl_b32 s64, s64, 7
    s_add_u32 s64, s64, 5382144
    v_mov_b32 v14, s64
    s_mov_b64 exec, 1
    v_mov_b32 v15, 0
    buffer_atomic_or v15, v14, s[16:19], 0 offen sc0
    s_mov_b64 exec, -1
P2_start:
    s_and_b32 s6, s3, 3
    s_lshr_b32 s7, s3, 2
    s_mov_b32 s20, s58
    s_mov_b32 s21, s59
    s_mov_b32 s22, 0x400000
    s_mov_b32 s23, 0x00020000
    s_and_b32 s67, s75, 0x7ff
    s_sub_u32 s67, 2047, s67
    s_lshl_b32 s64, s4, 2
    s_add_u32 s64, s64, s6
    s_lshl_b32 s64, s64, 16
    s_lshl_b32 s65, s7, 15
    s_add_u32 s64, s64, s65
    s_lshl_b32 s65, s7, 10
    s_add_u32 s66, s64, s65
    s_xor_b32 s64, s66, 1024
    v_lshlrev_b32 v12, 4, v2
    v_add_u32 v4, s66, v12
    v_add_u32 v12, s64, v12
    v_lshrrev_b32 v10, 4, v2
    v_bfe_u32 v11, v2, 2, 2
    v_lshl_add_u32 v10, v10, 2, v11
    v_bfe_u32 v13, v10, 1, 2
    v_lshlrev_b32 v10, 7, v10
    v_lshl_add_u32 v10, v13, 5, v10
    v_and_b32 v13, 3, v2
    v_lshl_add_u32 v5, v13, 3, v10
    v_xor_b32 v6, 32, v5
    v_xor_b32 v1, 64, v5
    v_xor_b32 v3, 96, v5
    s_and_b32 s74, s5, 7
    s_lshl_b32 s74, s74, 1
    s_cmp_eq_u32 s7, 0
    s_mov_b32 s64, 147456
    s_cselect_b32 s64, 131072, s64
    s_sub_u32 m0, 16, s74
    s_and_b32 m0, m0, 15
    v_writelane_b32 v7, s64, m0
    s_cmp_eq_u32 s7, 0
    s_mov_b32 s64, 155648
    s_cselect_b32 s64, 139264, s64
    s_sub_u32 m0, 18, s74
    s_and_b32 m0, m0, 15
    v_writelane_b32 v7, s64, m0
    s_cmp_eq_u32 s7, 0
    s_mov_b32 s64, 81920
    s_cselect_b32 s64, 73728, s64
    s_sub_u32 m0, 20, s74
    s_and_b32 m0, m0, 15
    v_writelane_b32 v7, s64, m0
    s_cmp_eq_u32 s7, 0
    s_mov_b32 s64, 122880
    s_cselect_b32 s64, 114688, s64
    s_sub_u32 m0, 22, s74
    s_and_b32 m0, m0, 15
    v_writelane_b32 v7, s64, m0
    s_cmp_eq_u32 s7, 0
    s_mov_b32 s64, 49152
    s_cselect_b32 s64, 40960, s64
    s_sub_u32 m0, 24, s74
    s_and_b32 m0, m0, 15
    v_writelane_b32 v7, s64, m0
    s_cmp_eq_u32 s7, 0
    s_mov_b32 s64, 57344
    s_cselect_b32 s64, 8192, s64
    s_sub_u32 m0, 26, s74
    s_and_b32 m0, m0, 15
    v_writelane_b32 v7, s64, m0
    s_cmp_eq_u32 s7, 0
    s_mov_b32 s64, 65536
    s_cselect_b32 s64, 16384, s64
    s_sub_u32 m0, 28, s74
    s_and_b32 m0, m0, 15
    v_writelane_b32 v7, s64, m0
    s_cmp_eq_u32 s7, 0
    s_mov_b32 s64, 90112
    s_cselect_b32 s64, 98304, s64
    s_sub_u32 m0, 30, s74
    s_and_b32 m0, m0, 15
    v_writelane_b32 v7, s64, m0
    s_cmp_eq_u32 s7, 0
    v_mov_b32 v16, 0
    v_mov_b32 v17, 0
    v_mov_b32 v18, 0
    v_mov_b32 v19, 0
    v_mov_b32 v20, 0
    v_mov_b32 v21, 0
    v_mov_b32 v22, 0
    v_mov_b32 v23, 0
    v_mov_b32 v24, 0
    v_mov_b32 v25, 0
    v_mov_b32 v26, 0
    v_mov_b32 v27, 0
    v_mov_b32 v28, 0
    v_mov_b32 v29, 0
    v_mov_b32 v30, 0
    v_mov_b32 v31, 0
    v_mov_b32 v32, 0
    v_mov_b32 v33, 0
    v_mov_b32 v34, 0
    v_mov_b32 v35, 0
    v_mov_b32 v36, 0
    v_mov_b32 v37, 0
    v_mov_b32 v38, 0
    v_mov_b32 v39, 0
    v_mov_b32 v40, 0
    v_mov_b32 v41, 0
    v_mov_b32 v42, 0
    v_mov_b32 v43, 0
    v_mov_b32 v44, 0
    v_mov_b32 v45, 0
    v_mov_b32 v46, 0
    v_mov_b32 v47, 0
    v_mov_b32 v209, 0
    v_mov_b32 v215, 0
    s_lshr_b32 s46, s67, 7
    s_xor_b32 s46, s46, s4
    s_or_b32 s46, s46, s7
    s_mov_b32 s47, 0
    s_cbranch_scc0 P2_ys
P2_ysd:
    s_mov_b32 s66, 0x5555
    s_mov_b32 s65, 0
    s_cmp_lt_u32 s3, 4
    s_cbranch_scc0 D_wait
    s_waitcnt vmcnt(1)
    s_mov_b64 exec, 3
    buffer_atomic_or v255, v254, s[16:19], 0 offen
    s_mov_b64 exec, -1
    s_waitcnt vmcnt(1)
    s_branch D_got
D_wait:
    s_waitcnt vmcnt(0)
D_got:
    v_readfirstlane_b32 s68, v15
    s_mul_i32 s68, s68, 0x10001
    s_lshr_b32 s68, s68, s74
    s_lshr_b32 s64, s68, 1
    s_and_b32 s68, s68, s64
    s_and_b32 s68, s68, s66
    s_cbranch_scc1 D_go
    s_add_u32 s65, s65, 1
    s_cmp_ge_u32 s65, 40000
    s_cbranch_scc1 D_end
    s_sleep 1
    s_mov_b64 exec, 1
    v_mov_b32 v15, 0
    buffer_atomic_or v15, v14, s[16:19], 0 offen sc0
    s_mov_b64 exec, -1
    s_branch D_wait
D_go:
    s_andn2_b32 s66, s66, s68
    s_bcnt1_i32_b32 s70, s68
    s_or_b32 s64, s46, s66
    s_cbranch_scc0 P2_yl
P2_nyl:
    s_cmp_gt_u32 s70, 4
    s_cbranch_scc1 D_t58
    s_cmp_gt_u32 s70, 2
    s_cbranch_scc1 D_t34
    s_cmp_eq_u32 s70, 2
    s_cbranch_scc1 D_e2
D_e1:
    s_ff1_i32_b32 s64, s68
    s_bitset0_b32 s68, s64
    v_readlane_b32 s32, v7, s64
    s_add_u32 s69, s64, s74
    s_and_b32 s69, s69, 15
    s_lshl_b32 s69, s69, 11
    buffer_load_dwordx4 v[80:83], v4, s[16:19], s69 offen sc1
    buffer_load_dwordx4 v[84:87], v12, s[16:19], s69 offen sc1
    s_add_u32 s69, s69, 2048
    buffer_load_dwordx4 v[88:91], v4, s[16:19], s69 offen sc1
    buffer_load_dwordx4 v[92:95], v12, s[16:19], s69 offen sc1
    s_mov_b64 exec, 1
    v_mov_b32 v15, 0
    buffer_atomic_or v15, v14, s[16:19], 0 offen sc0
    s_mov_b64 exec, -1
    v_add_u32 v8, s32, v5
    ds_read_b64_tr_b16 v[48:49], v8 offset:0
    ds_read_b64_tr_b16 v[50:51], v8 offset:2048
    v_add_u32 v9, s32, v6
    ds_read_b64_tr_b16 v[52:53], v9 offset:0
    ds_read_b64_tr_b16 v[54:55], v9 offset:2048
    v_add_u32 v10, s32, v1
    ds_read_b64_tr_b16 v[56:57], v10 offset:0
    ds_read_b64_tr_b16 v[58:59], v10 offset:2048
    v_add_u32 v11, s32, v3
    ds_read_b64_tr_b16 v[60:61], v11 offset:0
    ds_read_b64_tr_b16 v[62:63], v11 offset:2048
    s_branch D_p0
D_e2:
    s_ff1_i32_b32 s64, s68
    s_bitset0_b32 s68, s64
    v_readlane_b32 s33, v7, s64
    s_add_u32 s69, s64, s74
    s_and_b32 s69, s69, 15
    s_lshl_b32 s69, s69, 11
    buffer_load_dwordx4 v[96:99], v4, s[16:19], s69 offen sc1
    buffer_load_dwordx4 v[100:103], v12, s[16:19], s69 offen sc1
    s_add_u32 s69, s69, 2048
    buffer_load_dwordx4 v[104:107], v4, s[16:19], s69 offen sc1
    buffer_load_dwordx4 v[108:111], v12, s[16:19], s69 offen sc1
    s_ff1_i32_b32 s64, s68
    s_bitset0_b32 s68, s64
    v_readlane_b32 s32, v7, s64
    s_add_u32 s69, s64, s74
    s_and_b32 s69, s69, 15
    s_lshl_b32 s69, s69, 11
    buffer_load_dwordx4 v[80:83], v4, s[16:19], s69 offen sc1
    buffer_load_dwordx4 v[84:87], v12, s[16:19], s69 offen sc1
    s_add_u32 s69, s69, 2048
    buffer_load_dwordx4 v[88:91], v4, s[16:19], s69 offen sc1
    buffer_load_dwordx4 v[92:95], v12, s[16:19], s69 offen sc1
    s_mov_b64 exec, 1
    v_mov_b32 v15, 0
    buffer_atomic_or v15, v14, s[16:19], 0 offen sc0
    s_mov_b64 exec, -1
    v_add_u32 v8, s33, v5
    ds_read_b64_tr_b16 v[48:49], v8 offset:0
    ds_read_b64_tr_b16 v[50:51], v8 offset:2048
    v_add_u32 v9, s33, v6
    ds_read_b64_tr_b16 v[52:53], v9 offset:0
    ds_read_b64_tr_b16 v[54:55], v9 offset:2048
    v_add_u32 v10, s33, v1
    ds_read_b64_tr_b16 v[56:57], v10 offset:0
    ds_read_b64_tr_b16 v[58:59], v10 offset:2048
    v_add_u32 v11, s33, v3
    ds_read_b64_tr_b16 v[60:61], v11 offset:0
    ds_read_b64_tr_b16 v[62:63], v11 offset:2048
    s_branch D_p1
D_t34:
    s_cmp_eq_u32 s70, 4
    s_cbranch_scc1 D_e4
D_e3:
    s_ff1_i32_b32 s64, s68
    s_bitset0_b32 s68, s64
    v_readlane_b32 s34, v7, s64
    s_add_u32 s69, s64, s74
    s_and_b32 s69, s69, 15
    s_lshl_b32 s69, s69, 11
    buffer_load_dwordx4 v[112:115], v4, s[16:19], s69 offen sc1
    buffer_load_dwordx4 v[116:119], v12, s[16:19], s69 offen sc1
    s_add_u32 s69, s69, 2048
    buffer_load_dwordx4 v[120:123], v4, s[16:19], s69 offen sc1
    buffer_load_dwordx4 v[124:127], v12, s[16:19], s69 offen sc1
    s_ff1_i32_b32 s64, s68
    s_bitset0_b32 s68, s64
    v_readlane_b32 s33, v7, s64
    s_add_u32 s69, s64, s74
    s_and_b32 s69, s69, 15
    s_lshl_b32 s69, s69, 11
    buffer_load_dwordx4 v[96:99], v4, s[16:19], s69 offen sc1
    buffer_load_dwordx4 v[100:103], v12, s[16:19], s69 offen sc1
    s_add_u32 s69, s69, 2048
    buffer_load_dwordx4 v[104:107], v4, s[16:19], s69 offen sc1
    buffer_load_dwordx4 v[108:111], v12, s[16:19], s69 offen sc1
    v_add_u32 v8, s34, v5
    ds_read_b64_tr_b16 v[48:49], v8 offset:0
    ds_read_b64_tr_b16 v[50:51], v8 offset:2048
    v_add_u32 v9, s34, v6
    ds_read_b64_tr_b16 v[52:53], v9 offset:0
    ds_read_b64_tr_b16 v[54:55], v9 offset:2048
    v_add_u32 v10, s34, v1
    ds_read_b64_tr_b16 v[56:57], v10 offset:0
    ds_read_b64_tr_b16 v[58:59], v10 offset:2048
    v_add_u32 v11, s34, v3
    ds_read_b64_tr_b16 v[60:61], v11 offset:0
    ds_read_b64_tr_b16 v[62:63], v11 offset:2048
    s_branch D_p2
D_e4:
    s_ff1_i32_b32 s64, s68
    s_bitset0_b32 s68, s64
    v_readlane_b32 s35, v7, s64
    s_add_u32 s69, s64, s74
    s_and_b32 s69, s69, 15
    s_lshl_b32 s69, s69, 11
    buffer_load_dwordx4 v[128:131], v4, s[16:19], s69 offen sc1
    buffer_load_dwordx4 v[132:135], v12, s[16:19], s69 offen sc1
    s_add_u32 s69, s69, 2048
    buffer_load_dwordx4 v[136:139], v4, s[16:19], s69 offen sc1
    buffer_load_dwordx4 v[140:143], v12, s[16:19], s69 offen sc1
    s_ff1_i32_b32 s64, s68
    s_bitset0_b32 s68, s64
    v_readlane_b32 s34, v7, s64
    s_add_u32 s69, s64, s74
    s_and_b32 s69, s69, 15
    s_lshl_b32 s69, s69, 11
    buffer_load_dwordx4 v[112:115], v4, s[16:19], s69 offen sc1
    buffer_load_dwordx4 v[116:119], v12, s[16:19], s69 offen sc1
    s_add_u32 s69, s69, 2048
    buffer_load_dwordx4 v[120:123], v4, s[16:19], s69 offen sc1
    buffer_load_dwordx4 v[124:127], v12, s[16:19], s69 offen sc1
    v_add_u32 v8, s35, v5
    ds_read_b64_tr_b16 v[48:49], v8 offset:0
    ds_read_b64_tr_b16 v[50:51], v8 offset:2048
    v_add_u32 v9, s35, v6
    ds_read_b64_tr_b16 v[52:53], v9 offset:0
    ds_read_b64_tr_b16 v[54:55], v9 offset:2048
    v_add_u32 v10, s35, v1
    ds_read_b64_tr_b16 v[56:57], v10 offset:0
    ds_read_b64_tr_b16 v[58:59], v10 offset:2048
    v_add_u32 v11, s35, v3
    ds_read_b64_tr_b16 v[60:61], v11 offset:0
    ds_read_b64_tr_b16 v[62:63], v11 offset:2048
    s_branch D_p3
D_t58:
    s_cmp_gt_u32 s70, 6
    s_cbranch_scc1 D_t78
    s_cmp_eq_u32 s70, 6
    s_cbranch_scc1 D_e6
D_e5:
    s_ff1_i32_b32 s64, s68
    s_bitset0_b32 s68, s64
    v_readlane_b32 s36, v7, s64
    s_add_u32 s69, s64, s74
    s_and_b32 s69, s69, 15
    s_lshl_b32 s69, s69, 11
    buffer_load_dwordx4 v[144:147], v4, s[16:19], s69 offen sc1
    buffer_load_dwordx4 v[148:151], v12, s[16:19], s69 offen sc1
    s_add_u32 s69, s69, 2048
    buffer_load_dwordx4 v[152:155], v4, s[16:19], s69 offen sc1
    buffer_load_dwordx4 v[156:159], v12, s[16:19], s69 offen sc1
    s_ff1_i32_b32 s64, s68
    s_bitset0_b32 s68, s64
    v_readlane_b32 s35, v7, s64
    s_add_u32 s69, s64, s74
    s_and_b32 s69, s69, 15
    s_lshl_b32 s69, s69, 11
    buffer_load_dwordx4 v[128:131], v4, s[16:19], s69 offen sc1
    buffer_load_dwordx4 v[132:135], v12, s[16:19], s69 offen sc1
    s_add_u32 s69, s69, 2048
    buffer_load_dwordx4 v[136:139], v4, s[16:19], s69 offen sc1
    buffer_load_dwordx4 v[140:143], v12, s[16:19], s69 offen sc1
    v_add_u32 v8, s36, v5
    ds_read_b64_tr_b16 v[48:49], v8 offset:0
    ds_read_b64_tr_b16 v[50:51], v8 offset:2048
    v_add_u32 v9, s36, v6
    ds_read_b64_tr_b16 v[52:53], v9 offset:0
    ds_read_b64_tr_b16 v[54:55], v9 offset:2048
    v_add_u32 v10, s36, v1
    ds_read_b64_tr_b16 v[56:57], v10 offset:0
    ds_read_b64_tr_b16 v[58:59], v10 offset:2048
    v_add_u32 v11, s36, v3
    ds_read_b64_tr_b16 v[60:61], v11 offset:0
    ds_read_b64_tr_b16 v[62:63], v11 offset:2048
    s_branch D_p4
D_e6:
    s_ff1_i32_b32 s64, s68
    s_bitset0_b32 s68, s64
    v_readlane_b32 s37, v7, s64
    s_add_u32 s69, s64, s74
    s_and_b32 s69, s69, 15
    s_lshl_b32 s69, s69, 11
    buffer_load_dwordx4 v[160:163], v4, s[16:19], s69 offen sc1
    buffer_load_dwordx4 v[164:167], v12, s[16:19], s69 offen sc1
    s_add_u32 s69, s69, 2048
    buffer_load_dwordx4 v[168:171], v4, s[16:19], s69 offen sc1
    buffer_load_dwordx4 v[172:175], v12, s[16:19], s69 offen sc1
    s_ff1_i32_b32 s64, s68
    s_bitset0_b32 s68, s64
    v_readlane_b32 s36, v7, s64
    s_add_u32 s69, s64, s74
    s_and_b32 s69, s69, 15
    s_lshl_b32 s69, s69, 11
    buffer_load_dwordx4 v[144:147], v4, s[16:19], s69 offen sc1
    buffer_load_dwordx4 v[148:151], v12, s[16:19], s69 offen sc1
    s_add_u32 s69, s69, 2048
    buffer_load_dwordx4 v[152:155], v4, s[16:19], s69 offen sc1
    buffer_load_dwordx4 v[156:159], v12, s[16:19], s69 offen sc1
    v_add_u32 v8, s37, v5
    ds_read_b64_tr_b16 v[48:49], v8 offset:0
    ds_read_b64_tr_b16 v[50:51], v8 offset:2048
    v_add_u32 v9, s37, v6
    ds_read_b64_tr_b16 v[52:53], v9 offset:0
    ds_read_b64_tr_b16 v[54:55], v9 offset:2048
    v_add_u32 v10, s37, v1
    ds_read_b64_tr_b16 v[56:57], v10 offset:0
    ds_read_b64_tr_b16 v[58:59], v10 offset:2048
    v_add_u32 v11, s37, v3
    ds_read_b64_tr_b16 v[60:61], v11 offset:0
    ds_read_b64_tr_b16 v[62:63], v11 offset:2048
    s_branch D_p5
D_t78:
    s_cmp_eq_u32 s70, 8
    s_cbranch_scc1 D_e8
D_e7:
    s_ff1_i32_b32 s64, s68
    s_bitset0_b32 s68, s64
    v_readlane_b32 s38, v7, s64
    s_add_u32 s69, s64, s74
    s_and_b32 s69, s69, 15
    s_lshl_b32 s69, s69, 11
    buffer_load_dwordx4 v[176:179], v4, s[16:19], s69 offen sc1
    buffer_load_dwordx4 v[180:183], v12, s[16:19], s69 offen sc1
    s_add_u32 s69, s69, 2048
    buffer_load_dwordx4 v[184:187], v4, s[16:19], s69 offen sc1
    buffer_load_dwordx4 v[188:191], v12, s[16:19], s69 offen sc1
    s_ff1_i32_b32 s64, s68
    s_bitset0_b32 s68, s64
    v_readlane_b32 s37, v7, s64
    s_add_u32 s69, s64, s74
    s_and_b32 s69, s69, 15
    s_lshl_b32 s69, s69, 11
    buffer_load_dwordx4 v[160:163], v4, s[16:19], s69 offen sc1
    buffer_load_dwordx4 v[164:167], v12, s[16:19], s69 offen sc1
    s_add_u32 s69, s69, 2048
    buffer_load_dwordx4 v[168:171], v4, s[16:19], s69 offen sc1
    buffer_load_dwordx4 v[172:175], v12, s[16:19], s69 offen sc1
    v_add_u32 v8, s38, v5
    ds_read_b64_tr_b16 v[48:49], v8 offset:0
    ds_read_b64_tr_b16 v[50:51], v8 offset:2048
    v_add_u32 v9, s38, v6
    ds_read_b64_tr_b16 v[52:53], v9 offset:0
    ds_read_b64_tr_b16 v[54:55], v9 offset:2048
    v_add_u32 v10, s38, v1
    ds_read_b64_tr_b16 v[56:57], v10 offset:0
    ds_read_b64_tr_b16 v[58:59], v10 offset:2048
    v_add_u32 v11, s38, v3
    ds_read_b64_tr_b16 v[60:61], v11 offset:0
    ds_read_b64_tr_b16 v[62:63], v11 offset:2048
    s_branch D_p6
D_e8:
    s_ff1_i32_b32 s64, s68
    s_bitset0_b32 s68, s64
    v_readlane_b32 s39, v7, s64
    s_add_u32 s69, s64, s74
    s_and_b32 s69, s69, 15
    s_lshl_b32 s69, s69, 11
    buffer_load_dwordx4 v[192:195], v4, s[16:19], s69 offen sc1
    buffer_load_dwordx4 v[196:199], v12, s[16:19], s69 offen sc1
    s_add_u32 s69, s69, 2048
    buffer_load_dwordx4 v[200:203], v4, s[16:19], s69 offen sc1
    buffer_load_dwordx4 v[204:207], v12, s[16:19], s69 offen sc1
    s_ff1_i32_b32 s64, s68
    s_bitset0_b32 s68, s64
    v_readlane_b32 s38, v7, s64
    s_add_u32 s69, s64, s74
    s_and_b32 s69, s69, 15
    s_lshl_b32 s69, s69, 11
    buffer_load_dwordx4 v[176:179], v4, s[16:19], s69 offen sc1
    buffer_load_dwordx4 v[180:183], v12, s[16:19], s69 offen sc1
    s_add_u32 s69, s69, 2048
    buffer_load_dwordx4 v[184:187], v4, s[16:19], s69 offen sc1
    buffer_load_dwordx4 v[188:191], v12, s[16:19], s69 offen sc1
    v_add_u32 v8, s39, v5
    ds_read_b64_tr_b16 v[48:49], v8 offset:0
    ds_read_b64_tr_b16 v[50:51], v8 offset:2048
    v_add_u32 v9, s39, v6
    ds_read_b64_tr_b16 v[52:53], v9 offset:0
    ds_read_b64_tr_b16 v[54:55], v9 offset:2048
    v_add_u32 v10, s39, v1
    ds_read_b64_tr_b16 v[56:57], v10 offset:0
    ds_read_b64_tr_b16 v[58:59], v10 offset:2048
    v_add_u32 v11, s39, v3
    ds_read_b64_tr_b16 v[60:61], v11 offset:0
    ds_read_b64_tr_b16 v[62:63], v11 offset:2048
D_p7:
    s_waitcnt vmcnt(4) lgkmcnt(0)
    v_mfma_f32_16x16x32_bf16 v[16:19], v[48:51], v[192:195], v[16:19]
    ds_read_b64_tr_b16 v[64:65], v8 offset:4096
    ds_read_b64_tr_b16 v[66:67], v8 offset:6144
    v_mfma_f32_16x16x32_bf16 v[32:35], v[48:51], v[196:199], v[32:35]
    ds_read_b64_tr_b16 v[68:69], v9 offset:4096
    ds_read_b64_tr_b16 v[70:71], v9 offset:6144
    v_mfma_f32_16x16x32_bf16 v[20:23], v[52:55], v[192:195], v[20:23]
    ds_read_b64_tr_b16 v[72:73], v10 offset:4096
    ds_read_b64_tr_b16 v[74:75], v10 offset:6144
    v_mfma_f32_16x16x32_bf16 v[36:39], v[52:55], v[196:199], v[36:39]
    ds_read_b64_tr_b16 v[76:77], v11 offset:4096
    ds_read_b64_tr_b16 v[78:79], v11 offset:6144
    s_ff1_i32_b32 s64, s68
    s_bitset0_b32 s68, s64
    v_readlane_b32 s37, v7, s64
    s_add_u32 s69, s64, s74
    s_and_b32 s69, s69, 15
    s_lshl_b32 s69, s69, 11
    buffer_load_dwordx4 v[160:163], v4, s[16:19], s69 offen sc1
    v_mfma_f32_16x16x32_bf16 v[24:27], v[56:59], v[192:195], v[24:27]
    v_mfma_f32_16x16x32_bf16 v[40:43], v[56:59], v[196:199], v[40:43]
    v_mfma_f32_16x16x32_bf16 v[28:31], v[60:63], v[192:195], v[28:31]
    buffer_load_dwordx4 v[164:167], v12, s[16:19], s69 offen sc1
    v_mfma_f32_16x16x32_bf16 v[44:47], v[60:63], v[196:199], v[44:47]
    s_waitcnt lgkmcnt(0)
    v_mfma_f32_16x16x32_bf16 v[16:19], v[64:67], v[200:203], v[16:19]
    v_add_u32 v8, s38, v5
    ds_read_b64_tr_b16 v[48:49], v8 offset:0
    v_mfma_f32_16x16x32_bf16 v[32:35], v[64:67], v[204:207], v[32:35]
    ds_read_b64_tr_b16 v[50:51], v8 offset:2048
    v_add_u32 v9, s38, v6
    v_mfma_f32_16x16x32_bf16 v[20:23], v[68:71], v[200:203], v[20:23]
    ds_read_b64_tr_b16 v[52:53], v9 offset:0
    ds_read_b64_tr_b16 v[54:55], v9 offset:2048
    v_mfma_f32_16x16x32_bf16 v[36:39], v[68:71], v[204:207], v[36:39]
    v_add_u32 v10, s38, v1
    ds_read_b64_tr_b16 v[56:57], v10 offset:0
    s_add_u32 s69, s69, 2048
    buffer_load_dwordx4 v[168:171], v4, s[16:19], s69 offen sc1
    v_mfma_f32_16x16x32_bf16 v[24:27], v[72:75], v[200:203], v[24:27]
    ds_read_b64_tr_b16 v[58:59], v10 offset:2048
    v_add_u32 v11, s38, v3
    v_mfma_f32_16x16x32_bf16 v[40:43], v[72:75], v[204:207], v[40:43]
    ds_read_b64_tr_b16 v[60:61], v11 offset:0
    ds_read_b64_tr_b16 v[62:63], v11 offset:2048
    v_mfma_f32_16x16x32_bf16 v[28:31], v[76:79], v[200:203], v[28:31]
    buffer_load_dwordx4 v[172:175], v12, s[16:19], s69 offen sc1
    v_mfma_f32_16x16x32_bf16 v[44:47], v[76:79], v[204:207], v[44:47]
D_p6:
    s_waitcnt vmcnt(4) lgkmcnt(0)
    v_mfma_f32_16x16x32_bf16 v[16:19], v[48:51], v[176:179], v[16:19]
    ds_read_b64_tr_b16 v[64:65], v8 offset:4096
    ds_read_b64_tr_b16 v[66:67], v8 offset:6144
    v_mfma_f32_16x16x32_bf16 v[32:35], v[48:51], v[180:183], v[32:35]
    ds_read_b64_tr_b16 v[68:69], v9 offset:4096
    ds_read_b64_tr_b16 v[70:71], v9 offset:6144
    v_mfma_f32_16x16x32_bf16 v[20:23], v[52:55], v[176:179], v[20:23]
    ds_read_b64_tr_b16 v[72:73], v10 offset:4096
    ds_read_b64_tr_b16 v[74:75], v10 offset:6144
    v_mfma_f32_16x16x32_bf16 v[36:39], v[52:55], v[180:183], v[36:39]
    ds_read_b64_tr_b16 v[76:77], v11 offset:4096
    ds_read_b64_tr_b16 v[78:79], v11 offset:6144
    s_ff1_i32_b32 s64, s68
    s_bitset0_b32 s68, s64
    v_readlane_b32 s36, v7, s64
    s_add_u32 s69, s64, s74
    s_and_b32 s69, s69, 15
    s_lshl_b32 s69, s69, 11
    buffer_load_dwordx4 v[144:147], v4, s[16:19], s69 offen sc1
    v_mfma_f32_16x16x32_bf16 v[24:27], v[56:59], v[176:179], v[24:27]
    v_mfma_f32_16x16x32_bf16 v[40:43], v[56:59], v[180:183], v[40:43]
    v_mfma_f32_16x16x32_bf16 v[28:31], v[60:63], v[176:179], v[28:31]
    buffer_load_dwordx4 v[148:151], v12, s[16:19], s69 offen sc1
    v_mfma_f32_16x16x32_bf16 v[44:47], v[60:63], v[180:183], v[44:47]
    s_waitcnt lgkmcnt(0)
    v_mfma_f32_16x16x32_bf16 v[16:19], v[64:67], v[184:187], v[16:19]
    v_add_u32 v8, s37, v5
    ds_read_b64_tr_b16 v[48:49], v8 offset:0
    v_mfma_f32_16x16x32_bf16 v[32:35], v[64:67], v[188:191], v[32:35]
    ds_read_b64_tr_b16 v[50:51], v8 offset:2048
    v_add_u32 v9, s37, v6
    v_mfma_f32_16x16x32_bf16 v[20:23], v[68:71], v[184:187], v[20:23]
    ds_read_b64_tr_b16 v[52:53], v9 offset:0
    ds_read_b64_tr_b16 v[54:55], v9 offset:2048
    v_mfma_f32_16x16x32_bf16 v[36:39], v[68:71], v[188:191], v[36:39]
    v_add_u32 v10, s37, v1
    ds_read_b64_tr_b16 v[56:57], v10 offset:0
    s_add_u32 s69, s69, 2048
    buffer_load_dwordx4 v[152:155], v4, s[16:19], s69 offen sc1
    v_mfma_f32_16x16x32_bf16 v[24:27], v[72:75], v[184:187], v[24:27]
    ds_read_b64_tr_b16 v[58:59], v10 offset:2048
    v_add_u32 v11, s37, v3
    v_mfma_f32_16x16x32_bf16 v[40:43], v[72:75], v[188:191], v[40:43]
    ds_read_b64_tr_b16 v[60:61], v11 offset:0
    ds_read_b64_tr_b16 v[62:63], v11 offset:2048
    v_mfma_f32_16x16x32_bf16 v[28:31], v[76:79], v[184:187], v[28:31]
    buffer_load_dwordx4 v[156:159], v12, s[16:19], s69 offen sc1
    v_mfma_f32_16x16x32_bf16 v[44:47], v[76:79], v[188:191], v[44:47]
D_p5:
    s_waitcnt vmcnt(4) lgkmcnt(0)
    v_mfma_f32_16x16x32_bf16 v[16:19], v[48:51], v[160:163], v[16:19]
    ds_read_b64_tr_b16 v[64:65], v8 offset:4096
    ds_read_b64_tr_b16 v[66:67], v8 offset:6144
    v_mfma_f32_16x16x32_bf16 v[32:35], v[48:51], v[164:167], v[32:35]
    ds_read_b64_tr_b16 v[68:69], v9 offset:4096
    ds_read_b64_tr_b16 v[70:71], v9 offset:6144
    v_mfma_f32_16x16x32_bf16 v[20:23], v[52:55], v[160:163], v[20:23]
    ds_read_b64_tr_b16 v[72:73], v10 offset:4096
    ds_read_b64_tr_b16 v[74:75], v10 offset:6144
    v_mfma_f32_16x16x32_bf16 v[36:39], v[52:55], v[164:167], v[36:39]
    ds_read_b64_tr_b16 v[76:77], v11 offset:4096
    ds_read_b64_tr_b16 v[78:79], v11 offset:6144
    s_ff1_i32_b32 s64, s68
    s_bitset0_b32 s68, s64
    v_readlane_b32 s35, v7, s64
    s_add_u32 s69, s64, s74
    s_and_b32 s69, s69, 15
    s_lshl_b32 s69, s69, 11
    buffer_load_dwordx4 v[128:131], v4, s[16:19], s69 offen sc1
    v_mfma_f32_16x16x32_bf16 v[24:27], v[56:59], v[160:163], v[24:27]
    v_mfma_f32_16x16x32_bf16 v[40:43], v[56:59], v[164:167], v[40:43]
    v_mfma_f32_16x16x32_bf16 v[28:31], v[60:63], v[160:163], v[28:31]
    buffer_load_dwordx4 v[132:135], v12, s[16:19], s69 offen sc1
    v_mfma_f32_16x16x32_bf16 v[44:47], v[60:63], v[164:167], v[44:47]
    s_waitcnt lgkmcnt(0)
    v_mfma_f32_16x16x32_bf16 v[16:19], v[64:67], v[168:171], v[16:19]
    v_add_u32 v8, s36, v5
    ds_read_b64_tr_b16 v[48:49], v8 offset:0
    v_mfma_f32_16x16x32_bf16 v[32:35], v[64:67], v[172:175], v[32:35]
    ds_read_b64_tr_b16 v[50:51], v8 offset:2048
    v_add_u32 v9, s36, v6
    v_mfma_f32_16x16x32_bf16 v[20:23], v[68:71], v[168:171], v[20:23]
    ds_read_b64_tr_b16 v[52:53], v9 offset:0
    ds_read_b64_tr_b16 v[54:55], v9 offset:2048
    v_mfma_f32_16x16x32_bf16 v[36:39], v[68:71], v[172:175], v[36:39]
    v_add_u32 v10, s36, v1
    ds_read_b64_tr_b16 v[56:57], v10 offset:0
    s_add_u32 s69, s69, 2048
    buffer_load_dwordx4 v[136:139], v4, s[16:19], s69 offen sc1
    v_mfma_f32_16x16x32_bf16 v[24:27], v[72:75], v[168:171], v[24:27]
    ds_read_b64_tr_b16 v[58:59], v10 offset:2048
    v_add_u32 v11, s36, v3
    v_mfma_f32_16x16x32_bf16 v[40:43], v[72:75], v[172:175], v[40:43]
    ds_read_b64_tr_b16 v[60:61], v11 offset:0
    ds_read_b64_tr_b16 v[62:63], v11 offset:2048
    v_mfma_f32_16x16x32_bf16 v[28:31], v[76:79], v[168:171], v[28:31]
    buffer_load_dwordx4 v[140:143], v12, s[16:19], s69 offen sc1
    v_mfma_f32_16x16x32_bf16 v[44:47], v[76:79], v[172:175], v[44:47]
D_p4:
    s_waitcnt vmcnt(4) lgkmcnt(0)
    v_mfma_f32_16x16x32_bf16 v[16:19], v[48:51], v[144:147], v[16:19]
    ds_read_b64_tr_b16 v[64:65], v8 offset:4096
    ds_read_b64_tr_b16 v[66:67], v8 offset:6144
    v_mfma_f32_16x16x32_bf16 v[32:35], v[48:51], v[148:151], v[32:35]
    ds_read_b64_tr_b16 v[68:69], v9 offset:4096
    ds_read_b64_tr_b16 v[70:71], v9 offset:6144
    v_mfma_f32_16x16x32_bf16 v[20:23], v[52:55], v[144:147], v[20:23]
    ds_read_b64_tr_b16 v[72:73], v10 offset:4096
    ds_read_b64_tr_b16 v[74:75], v10 offset:6144
    v_mfma_f32_16x16x32_bf16 v[36:39], v[52:55], v[148:151], v[36:39]
    ds_read_b64_tr_b16 v[76:77], v11 offset:4096
    ds_read_b64_tr_b16 v[78:79], v11 offset:6144
    s_ff1_i32_b32 s64, s68
    s_bitset0_b32 s68, s64
    v_readlane_b32 s34, v7, s64
    s_add_u32 s69, s64, s74
    s_and_b32 s69, s69, 15
    s_lshl_b32 s69, s69, 11
    buffer_load_dwordx4 v[112:115], v4, s[16:19], s69 offen sc1
    v_mfma_f32_16x16x32_bf16 v[24:27], v[56:59], v[144:147], v[24:27]
    v_mfma_f32_16x16x32_bf16 v[40:43], v[56:59], v[148:151], v[40:43]
    v_mfma_f32_16x16x32_bf16 v[28:31], v[60:63], v[144:147], v[28:31]
    buffer_load_dwordx4 v[116:119], v12, s[16:19], s69 offen sc1
    v_mfma_f32_16x16x32_bf16 v[44:47], v[60:63], v[148:151], v[44:47]
    s_waitcnt lgkmcnt(0)
    v_mfma_f32_16x16x32_bf16 v[16:19], v[64:67], v[152:155], v[16:19]
    v_add_u32 v8, s35, v5
    ds_read_b64_tr_b16 v[48:49], v8 offset:0
    v_mfma_f32_16x16x32_bf16 v[32:35], v[64:67], v[156:159], v[32:35]
    ds_read_b64_tr_b16 v[50:51], v8 offset:2048
    v_add_u32 v9, s35, v6
    v_mfma_f32_16x16x32_bf16 v[20:23], v[68:71], v[152:155], v[20:23]
    ds_read_b64_tr_b16 v[52:53], v9 offset:0
    ds_read_b64_tr_b16 v[54:55], v9 offset:2048
    v_mfma_f32_16x16x32_bf16 v[36:39], v[68:71], v[156:159], v[36:39]
    v_add_u32 v10, s35, v1
    ds_read_b64_tr_b16 v[56:57], v10 offset:0
    s_add_u32 s69, s69, 2048
    buffer_load_dwordx4 v[120:123], v4, s[16:19], s69 offen sc1
    v_mfma_f32_16x16x32_bf16 v[24:27], v[72:75], v[152:155], v[24:27]
    ds_read_b64_tr_b16 v[58:59], v10 offset:2048
    v_add_u32 v11, s35, v3
    v_mfma_f32_16x16x32_bf16 v[40:43], v[72:75], v[156:159], v[40:43]
    ds_read_b64_tr_b16 v[60:61], v11 offset:0
    ds_read_b64_tr_b16 v[62:63], v11 offset:2048
    v_mfma_f32_16x16x32_bf16 v[28:31], v[76:79], v[152:155], v[28:31]
    buffer_load_dwordx4 v[124:127], v12, s[16:19], s69 offen sc1
    v_mfma_f32_16x16x32_bf16 v[44:47], v[76:79], v[156:159], v[44:47]
D_p3:
    s_waitcnt vmcnt(4) lgkmcnt(0)
    v_mfma_f32_16x16x32_bf16 v[16:19], v[48:51], v[128:131], v[16:19]
    ds_read_b64_tr_b16 v[64:65], v8 offset:4096
    ds_read_b64_tr_b16 v[66:67], v8 offset:6144
    v_mfma_f32_16x16x32_bf16 v[32:35], v[48:51], v[132:135], v[32:35]
    ds_read_b64_tr_b16 v[68:69], v9 offset:4096
    ds_read_b64_tr_b16 v[70:71], v9 offset:6144
    v_mfma_f32_16x16x32_bf16 v[20:23], v[52:55], v[128:131], v[20:23]
    ds_read_b64_tr_b16 v[72:73], v10 offset:4096
    ds_read_b64_tr_b16 v[74:75], v10 offset:6144
    v_mfma_f32_16x16x32_bf16 v[36:39], v[52:55], v[132:135], v[36:39]
    ds_read_b64_tr_b16 v[76:77], v11 offset:4096
    ds_read_b64_tr_b16 v[78:79], v11 offset:6144
    s_ff1_i32_b32 s64, s68
    s_bitset0_b32 s68, s64
    v_readlane_b32 s33, v7, s64
    s_add_u32 s69, s64, s74
    s_and_b32 s69, s69, 15
    s_lshl_b32 s69, s69, 11
    buffer_load_dwordx4 v[96:99], v4, s[16:19], s69 offen sc1
    v_mfma_f32_16x16x32_bf16 v[24:27], v[56:59], v[128:131], v[24:27]
    v_mfma_f32_16x16x32_bf16 v[40:43], v[56:59], v[132:135], v[40:43]
    v_mfma_f32_16x16x32_bf16 v[28:31], v[60:63], v[128:131], v[28:31]
    buffer_load_dwordx4 v[100:103], v12, s[16:19], s69 offen sc1
    v_mfma_f32_16x16x32_bf16 v[44:47], v[60:63], v[132:135], v[44:47]
    s_waitcnt lgkmcnt(0)
    v_mfma_f32_16x16x32_bf16 v[16:19], v[64:67], v[136:139], v[16:19]
    v_add_u32 v8, s34, v5
    ds_read_b64_tr_b16 v[48:49], v8 offset:0
    v_mfma_f32_16x16x32_bf16 v[32:35], v[64:67], v[140:143], v[32:35]
    ds_read_b64_tr_b16 v[50:51], v8 offset:2048
    v_add_u32 v9, s34, v6
    v_mfma_f32_16x16x32_bf16 v[20:23], v[68:71], v[136:139], v[20:23]
    ds_read_b64_tr_b16 v[52:53], v9 offset:0
    ds_read_b64_tr_b16 v[54:55], v9 offset:2048
    v_mfma_f32_16x16x32_bf16 v[36:39], v[68:71], v[140:143], v[36:39]
    v_add_u32 v10, s34, v1
    ds_read_b64_tr_b16 v[56:57], v10 offset:0
    s_add_u32 s69, s69, 2048
    buffer_load_dwordx4 v[104:107], v4, s[16:19], s69 offen sc1
    v_mfma_f32_16x16x32_bf16 v[24:27], v[72:75], v[136:139], v[24:27]
    ds_read_b64_tr_b16 v[58:59], v10 offset:2048
    v_add_u32 v11, s34, v3
    v_mfma_f32_16x16x32_bf16 v[40:43], v[72:75], v[140:143], v[40:43]
    ds_read_b64_tr_b16 v[60:61], v11 offset:0
    ds_read_b64_tr_b16 v[62:63], v11 offset:2048
    v_mfma_f32_16x16x32_bf16 v[28:31], v[76:79], v[136:139], v[28:31]
    buffer_load_dwordx4 v[108:111], v12, s[16:19], s69 offen sc1
    v_mfma_f32_16x16x32_bf16 v[44:47], v[76:79], v[140:143], v[44:47]
D_p2:
    s_waitcnt vmcnt(4) lgkmcnt(0)
    v_mfma_f32_16x16x32_bf16 v[16:19], v[48:51], v[112:115], v[16:19]
    ds_read_b64_tr_b16 v[64:65], v8 offset:4096
    ds_read_b64_tr_b16 v[66:67], v8 offset:6144
    v_mfma_f32_16x16x32_bf16 v[32:35], v[48:51], v[116:119], v[32:35]
    ds_read_b64_tr_b16 v[68:69], v9 offset:4096
    ds_read_b64_tr_b16 v[70:71], v9 offset:6144
    v_mfma_f32_16x16x32_bf16 v[20:23], v[52:55], v[112:115], v[20:23]
    ds_read_b64_tr_b16 v[72:73], v10 offset:4096
    ds_read_b64_tr_b16 v[74:75], v10 offset:6144
    v_mfma_f32_16x16x32_bf16 v[36:39], v[52:55], v[116:119], v[36:39]
    ds_read_b64_tr_b16 v[76:77], v11 offset:4096
    ds_read_b64_tr_b16 v[78:79], v11 offset:6144
    s_ff1_i32_b32 s64, s68
    s_bitset0_b32 s68, s64
    v_readlane_b32 s32, v7, s64
    s_add_u32 s69, s64, s74
    s_and_b32 s69, s69, 15
    s_lshl_b32 s69, s69, 11
    buffer_load_dwordx4 v[80:83], v4, s[16:19], s69 offen sc1
    v_mfma_f32_16x16x32_bf16 v[24:27], v[56:59], v[112:115], v[24:27]
    v_mfma_f32_16x16x32_bf16 v[40:43], v[56:59], v[116:119], v[40:43]
    v_mfma_f32_16x16x32_bf16 v[28:31], v[60:63], v[112:115], v[28:31]
    buffer_load_dwordx4 v[84:87], v12, s[16:19], s69 offen sc1
    v_mfma_f32_16x16x32_bf16 v[44:47], v[60:63], v[116:119], v[44:47]
    s_waitcnt lgkmcnt(0)
    v_mfma_f32_16x16x32_bf16 v[16:19], v[64:67], v[120:123], v[16:19]
    v_add_u32 v8, s33, v5
    ds_read_b64_tr_b16 v[48:49], v8 offset:0
    v_mfma_f32_16x16x32_bf16 v[32:35], v[64:67], v[124:127], v[32:35]
    ds_read_b64_tr_b16 v[50:51], v8 offset:2048
    v_add_u32 v9, s33, v6
    v_mfma_f32_16x16x32_bf16 v[20:23], v[68:71], v[120:123], v[20:23]
    ds_read_b64_tr_b16 v[52:53], v9 offset:0
    ds_read_b64_tr_b16 v[54:55], v9 offset:2048
    v_mfma_f32_16x16x32_bf16 v[36:39], v[68:71], v[124:127], v[36:39]
    v_add_u32 v10, s33, v1
    ds_read_b64_tr_b16 v[56:57], v10 offset:0
    s_add_u32 s69, s69, 2048
    buffer_load_dwordx4 v[88:91], v4, s[16:19], s69 offen sc1
    v_mfma_f32_16x16x32_bf16 v[24:27], v[72:75], v[120:123], v[24:27]
    ds_read_b64_tr_b16 v[58:59], v10 offset:2048
    v_add_u32 v11, s33, v3
    v_mfma_f32_16x16x32_bf16 v[40:43], v[72:75], v[124:127], v[40:43]
    ds_read_b64_tr_b16 v[60:61], v11 offset:0
    ds_read_b64_tr_b16 v[62:63], v11 offset:2048
    v_mfma_f32_16x16x32_bf16 v[28:31], v[76:79], v[120:123], v[28:31]
    buffer_load_dwordx4 v[92:95], v12, s[16:19], s69 offen sc1
    s_mov_b64 exec, 1
    v_mov_b32 v15, 0
    buffer_atomic_or v15, v14, s[16:19], 0 offen sc0
    s_mov_b64 exec, -1
    v_mfma_f32_16x16x32_bf16 v[44:47], v[76:79], v[124:127], v[44:47]
D_p1:
    s_waitcnt vmcnt(5) lgkmcnt(0)
    v_mfma_f32_16x16x32_bf16 v[16:19], v[48:51], v[96:99], v[16:19]
    ds_read_b64_tr_b16 v[64:65], v8 offset:4096
    ds_read_b64_tr_b16 v[66:67], v8 offset:6144
    v_mfma_f32_16x16x32_bf16 v[32:35], v[48:51], v[100:103], v[32:35]
    ds_read_b64_tr_b16 v[68:69], v9 offset:4096
    ds_read_b64_tr_b16 v[70:71], v9 offset:6144
    v_mfma_f32_16x16x32_bf16 v[20:23], v[52:55], v[96:99], v[20:23]
    ds_read_b64_tr_b16 v[72:73], v10 offset:4096
    ds_read_b64_tr_b16 v[74:75], v10 offset:6144
    v_mfma_f32_16x16x32_bf16 v[36:39], v[52:55], v[100:103], v[36:39]
    ds_read_b64_tr_b16 v[76:77], v11 offset:4096
    ds_read_b64_tr_b16 v[78:79], v11 offset:6144
    v_mfma_f32_16x16x32_bf16 v[24:27], v[56:59], v[96:99], v[24:27]
    v_mfma_f32_16x16x32_bf16 v[40:43], v[56:59], v[100:103], v[40:43]
    v_mfma_f32_16x16x32_bf16 v[28:31], v[60:63], v[96:99], v[28:31]
    v_mfma_f32_16x16x32_bf16 v[44:47], v[60:63], v[100:103], v[44:47]
    s_waitcnt lgkmcnt(0)
    v_mfma_f32_16x16x32_bf16 v[16:19], v[64:67], v[104:107], v[16:19]
    v_add_u32 v8, s32, v5
    ds_read_b64_tr_b16 v[48:49], v8 offset:0
    v_mfma_f32_16x16x32_bf16 v[32:35], v[64:67], v[108:111], v[32:35]
    ds_read_b64_tr_b16 v[50:51], v8 offset:2048
    v_add_u32 v9, s32, v6
    v_mfma_f32_16x16x32_bf16 v[20:23], v[68:71], v[104:107], v[20:23]
    ds_read_b64_tr_b16 v[52:53], v9 offset:0
    ds_read_b64_tr_b16 v[54:55], v9 offset:2048
    v_mfma_f32_16x16x32_bf16 v[36:39], v[68:71], v[108:111], v[36:39]
    v_add_u32 v10, s32, v1
    ds_read_b64_tr_b16 v[56:57], v10 offset:0
    v_mfma_f32_16x16x32_bf16 v[24:27], v[72:75], v[104:107], v[24:27]
    ds_read_b64_tr_b16 v[58:59], v10 offset:2048
    v_add_u32 v11, s32, v3
    v_mfma_f32_16x16x32_bf16 v[40:43], v[72:75], v[108:111], v[40:43]
    ds_read_b64_tr_b16 v[60:61], v11 offset:0
    ds_read_b64_tr_b16 v[62:63], v11 offset:2048
    v_mfma_f32_16x16x32_bf16 v[28:31], v[76:79], v[104:107], v[28:31]
    v_mfma_f32_16x16x32_bf16 v[44:47], v[76:79], v[108:111], v[44:47]
D_p0:
    s_waitcnt vmcnt(1) lgkmcnt(0)
    v_mfma_f32_16x16x32_bf16 v[16:19], v[48:51], v[80:83], v[16:19]
    ds_read_b64_tr_b16 v[64:65], v8 offset:4096
    ds_read_b64_tr_b16 v[66:67], v8 offset:6144
    v_mfma_f32_16x16x32_bf16 v[32:35], v[48:51], v[84:87], v[32:35]
    ds_read_b64_tr_b16 v[68:69], v9 offset:4096
    ds_read_b64_tr_b16 v[70:71], v9 offset:6144
    v_mfma_f32_16x16x32_bf16 v[20:23], v[52:55], v[80:83], v[20:23]
    ds_read_b64_tr_b16 v[72:73], v10 offset:4096
    ds_read_b64_tr_b16 v[74:75], v10 offset:6144
    v_mfma_f32_16x16x32_bf16 v[36:39], v[52:55], v[84:87], v[36:39]
    ds_read_b64_tr_b16 v[76:77], v11 offset:4096
    ds_read_b64_tr_b16 v[78:79], v11 offset:6144
    v_mfma_f32_16x16x32_bf16 v[24:27], v[56:59], v[80:83], v[24:27]
    v_mfma_f32_16x16x32_bf16 v[40:43], v[56:59], v[84:87], v[40:43]
    v_mfma_f32_16x16x32_bf16 v[28:31], v[60:63], v[80:83], v[28:31]
    v_mfma_f32_16x16x32_bf16 v[44:47], v[60:63], v[84:87], v[44:47]
    s_waitcnt lgkmcnt(0)
    v_mfma_f32_16x16x32_bf16 v[16:19], v[64:67], v[88:91], v[16:19]
    v_mfma_f32_16x16x32_bf16 v[32:35], v[64:67], v[92:95], v[32:35]
    v_mfma_f32_16x16x32_bf16 v[20:23], v[68:71], v[88:91], v[20:23]
    v_mfma_f32_16x16x32_bf16 v[36:39], v[68:71], v[92:95], v[36:39]
    v_mfma_f32_16x16x32_bf16 v[24:27], v[72:75], v[88:91], v[24:27]
    v_mfma_f32_16x16x32_bf16 v[40:43], v[72:75], v[92:95], v[40:43]
    v_mfma_f32_16x16x32_bf16 v[28:31], v[76:79], v[88:91], v[28:31]
    v_mfma_f32_16x16x32_bf16 v[44:47], v[76:79], v[92:95], v[44:47]
    s_cmp_lg_u32 s66, 0
    s_cbranch_scc1 D_wait
D_end:
    s_lshl_b32 s64, s3, 12
    s_add_u32 s64, s64, 8192
    v_lshl_add_u32 v8, v2, 4, s64
    s_xor_b32 s65, s3, 4
    s_lshl_b32 s65, s65, 12
    s_add_u32 s65, s65, 8192
    v_lshl_add_u32 v5, v2, 4, s65
    v_lshlrev_b32 v9, 1, v229
    v_cmp_eq_u32 s[70:71], s67, v230
    s_cmp_eq_u32 s46, 0
    s_cbranch_scc1 P2_y
P2_ny:
    s_barrier
    ds_write_b128 v8, v[32:35] offset:0
    ds_write_b128 v8, v[36:39] offset:1024
    ds_write_b128 v8, v[40:43] offset:2048
    ds_write_b128 v8, v[44:47] offset:3072
    s_cmp_lg_u64 s[70:71], 0
    s_cbranch_scc1 P2_fix
P2_nr:
    s_waitcnt lgkmcnt(0)
    s_barrier
    ds_read_b128 v[64:67], v5 offset:0
    ds_read_b128 v[68:71], v5 offset:1024
    ds_read_b128 v[72:75], v5 offset:2048
    ds_read_b128 v[76:79], v5 offset:3072
    s_waitcnt lgkmcnt(2)
    v_pk_add_f32 v[16:17], v[16:17], v[64:65]
    v_pk_add_f32 v[18:19], v[18:19], v[66:67]
    v_pk_add_f32 v[20:21], v[20:21], v[68:69]
    v_pk_add_f32 v[22:23], v[22:23], v[70:71]
    v_cvt_pk_bf16_f32 v48, v16, v17
    v_cvt_pk_bf16_f32 v49, v18, v19
    v_cvt_pk_bf16_f32 v50, v20, v21
    v_cvt_pk_bf16_f32 v51, v22, v23
    s_nop 0
    v_permlane16_swap_b32 v48, v50
    v_permlane16_swap_b32 v49, v51
    v_lshlrev_b32 v16, 16, v48
    v_and_b32 v17, 0xffff0000, v48
    v_lshlrev_b32 v18, 16, v49
    v_and_b32 v19, 0xffff0000, v49
    v_lshlrev_b32 v20, 16, v50
    v_and_b32 v21, 0xffff0000, v50
    v_lshlrev_b32 v22, 16, v51
    v_and_b32 v23, 0xffff0000, v51
    v_pk_mul_f32 v[16:17], v[16:17], v[228:229] op_sel_hi:[1,0]
    v_pk_mul_f32 v[18:19], v[18:19], v[228:229] op_sel_hi:[1,0]
    v_pk_mul_f32 v[20:21], v[20:21], v[228:229] op_sel_hi:[1,0]
    v_pk_mul_f32 v[22:23], v[22:23], v[228:229] op_sel_hi:[1,0]
    v_cvt_pk_bf16_f32 v48, v16, v17
    v_cvt_pk_bf16_f32 v49, v18, v19
    v_cvt_pk_bf16_f32 v50, v20, v21
    v_cvt_pk_bf16_f32 v51, v22, v23
    v_lshlrev_b32 v16, 16, v48
    v_and_b32 v17, 0xffff0000, v48
    v_lshlrev_b32 v18, 16, v49
    v_and_b32 v19, 0xffff0000, v49
    v_lshlrev_b32 v20, 16, v50
    v_and_b32 v21, 0xffff0000, v50
    v_lshlrev_b32 v22, 16, v51
    v_and_b32 v23, 0xffff0000, v51
    v_pk_add_f32 v[16:17], v[16:17], v[232:233]
    v_pk_add_f32 v[18:19], v[18:19], v[234:235]
    v_pk_add_f32 v[20:21], v[20:21], v[236:237]
    v_pk_add_f32 v[22:23], v[22:23], v[238:239]
    v_cvt_pk_bf16_f32 v120, v16, v17
    v_cvt_pk_bf16_f32 v121, v18, v19
    v_cvt_pk_bf16_f32 v122, v20, v21
    v_cvt_pk_bf16_f32 v123, v22, v23
    v_and_b32 v6, 1, v2
    v_mul_u32_u24 v6, 1984, v6
    v_sub_u32 v231, v231, v6
    s_mov_b32 vcc_lo, 0x55555555
    s_mov_b32 vcc_hi, 0x55555555
    s_waitcnt lgkmcnt(0)
    v_pk_add_f32 v[24:25], v[24:25], v[72:73]
    v_pk_add_f32 v[26:27], v[26:27], v[74:75]
    v_pk_add_f32 v[28:29], v[28:29], v[76:77]
    v_pk_add_f32 v[30:31], v[30:31], v[78:79]
    v_cvt_pk_bf16_f32 v52, v24, v25
    v_cvt_pk_bf16_f32 v53, v26, v27
    v_cvt_pk_bf16_f32 v54, v28, v29
    v_cvt_pk_bf16_f32 v55, v30, v31
    s_nop 0
    v_permlane16_swap_b32 v52, v54
    v_permlane16_swap_b32 v53, v55
    v_lshlrev_b32 v24, 16, v52
    v_and_b32 v25, 0xffff0000, v52
    v_lshlrev_b32 v26, 16, v53
    v_and_b32 v27, 0xffff0000, v53
    v_lshlrev_b32 v28, 16, v54
    v_and_b32 v29, 0xffff0000, v54
    v_lshlrev_b32 v30, 16, v55
    v_and_b32 v31, 0xffff0000, v55
    v_pk_mul_f32 v[24:25], v[24:25], v[228:229] op_sel_hi:[1,0]
    v_pk_mul_f32 v[26:27], v[26:27], v[228:229] op_sel_hi:[1,0]
    v_pk_mul_f32 v[28:29], v[28:29], v[228:229] op_sel_hi:[1,0]
    v_pk_mul_f32 v[30:31], v[30:31], v[228:229] op_sel_hi:[1,0]
    v_cvt_pk_bf16_f32 v52, v24, v25
    v_cvt_pk_bf16_f32 v53, v26, v27
    v_cvt_pk_bf16_f32 v54, v28, v29
    v_cvt_pk_bf16_f32 v55, v30, v31
    v_lshlrev_b32 v24, 16, v52
    v_and_b32 v25, 0xffff0000, v52
    v_lshlrev_b32 v26, 16, v53
    v_and_b32 v27, 0xffff0000, v53
    v_lshlrev_b32 v28, 16, v54
    v_and_b32 v29, 0xffff0000, v54
    v_lshlrev_b32 v30, 16, v55
    v_and_b32 v31, 0xffff0000, v55
    v_pk_add_f32 v[24:25], v[24:25], v[240:241]
    v_pk_add_f32 v[26:27], v[26:27], v[242:243]
    v_pk_add_f32 v[28:29], v[28:29], v[244:245]
    v_pk_add_f32 v[30:31], v[30:31], v[246:247]
    v_cvt_pk_bf16_f32 v124, v24, v25
    v_cvt_pk_bf16_f32 v125, v26, v27
    v_cvt_pk_bf16_f32 v126, v28, v29
    v_cvt_pk_bf16_f32 v127, v30, v31
    s_nop 1
    v_cndmask_b32_dpp v56, v124, v120, vcc quad_perm:[1,0,3,2] row_mask:0xf bank_mask:0xf
    v_cndmask_b32_dpp v57, v125, v121, vcc quad_perm:[1,0,3,2] row_mask:0xf bank_mask:0xf
    v_cndmask_b32_dpp v58, v126, v122, vcc quad_perm:[1,0,3,2] row_mask:0xf bank_mask:0xf
    v_cndmask_b32_dpp v59, v127, v123, vcc quad_perm:[1,0,3,2] row_mask:0xf bank_mask:0xf
    buffer_store_dwordx4 v[56:59], v231, s[20:23], 0 offen nt
    s_not_b64 vcc, vcc
    v_cndmask_b32_dpp v60, v120, v124, vcc quad_perm:[1,0,3,2] row_mask:0xf bank_mask:0xf
    v_cndmask_b32_dpp v61, v121, v125, vcc quad_perm:[1,0,3,2] row_mask:0xf bank_mask:0xf
    v_cndmask_b32_dpp v62, v122, v126, vcc quad_perm:[1,0,3,2] row_mask:0xf bank_mask:0xf
    v_cndmask_b32_dpp v63, v123, v127, vcc quad_perm:[1,0,3,2] row_mask:0xf bank_mask:0xf
    buffer_store_dwordx4 v[60:63], v231, s[20:23], 0 offen offset:2048 nt
K_end:
    s_endpgm
H_nre:
    s_add_u32 s65, s65, 1
    s_cmp_ge_u32 s65, 200000
    s_cbranch_scc1 H_nok
    s_sleep 4
    buffer_load_dword v78, v79, s[20:23], 0 offen sc1
    s_waitcnt vmcnt(0)
    s_branch H_nspin
H_retry:
    s_add_u32 s65, s65, 1
    s_cmp_ge_u32 s65, 200000
    s_cbranch_scc1 H_nq
    s_sleep 8
    s_mov_b32 s64, 6717440
    buffer_load_dwordx4 v[24:27], v6, s[16:19], s64 offen offset:0 sc1
    buffer_load_dwordx4 v[28:31], v6, s[16:19], s64 offen offset:1024 sc1
    s_waitcnt vmcnt(0)
    s_branch H_spin
G_f15:
    s_bitset1_b32 s66, s55
    s_branch G_q15
G_f14:
    s_bitset1_b32 s66, s54
    s_branch G_q14
G_f13:
    s_bitset1_b32 s66, s53
    s_branch G_q13
G_f12:
    s_bitset1_b32 s66, s52
    s_branch G_q12
G_f11:
    s_bitset1_b32 s66, s51
    s_branch G_q11
G_f10:
    s_bitset1_b32 s66, s50
    s_branch G_q10
G_f9:
    s_bitset1_b32 s66, s49
    s_branch G_q9
G_f8:
    s_bitset1_b32 s66, s48
    s_branch G_q8
G_f7:
    s_bitset1_b32 s66, s47
    s_branch G_q7
G_f6:
    s_bitset1_b32 s66, s46
    s_branch G_q6
G_f5:
    s_bitset1_b32 s66, s45
    s_branch G_q5
G_f4:
    s_bitset1_b32 s66, s44
    s_branch G_q4
G_f3:
    s_bitset1_b32 s66, s43
    s_branch G_q3
G_f2:
    s_bitset1_b32 s66, s42
    s_branch G_q2
G_f1:
    s_bitset1_b32 s66, s41
    s_branch G_q1
G_f0:
    s_bitset1_b32 s66, s40
    s_branch G_q0
phi_16_fix:
    v_lshlrev_b32 v48, 16, v16
    v_and_b32 v49, 0xffff0000, v16
    v_add_f32 v48, s73, v48
    v_add_f32 v49, s73, v49
    v_cvt_pk_bf16_f32 v16, v48, v49
    v_lshlrev_b32 v48, 16, v17
    v_and_b32 v49, 0xffff0000, v17
    v_add_f32 v48, s73, v48
    v_add_f32 v49, s73, v49
    v_cvt_pk_bf16_f32 v17, v48, v49
    v_lshlrev_b32 v48, 16, v18
    v_and_b32 v49, 0xffff0000, v18
    v_add_f32 v48, s73, v48
    v_add_f32 v49, s73, v49
    v_cvt_pk_bf16_f32 v18, v48, v49
    v_lshlrev_b32 v48, 16, v19
    v_and_b32 v49, 0xffff0000, v19
    v_add_f32 v48, s73, v48
    v_add_f32 v49, s73, v49
    v_cvt_pk_bf16_f32 v19, v48, v49
    v_lshlrev_b32 v48, 16, v20
    v_and_b32 v49, 0xffff0000, v20
    v_add_f32 v48, s73, v48
    v_add_f32 v49, s73, v49
    v_cvt_pk_bf16_f32 v20, v48, v49
    v_lshlrev_b32 v48, 16, v21
    v_and_b32 v49, 0xffff0000, v21
    v_add_f32 v48, s73, v48
    v_add_f32 v49, s73, v49
    v_cvt_pk_bf16_f32 v21, v48, v49
    v_lshlrev_b32 v48, 16, v22
    v_and_b32 v49, 0xffff0000, v22
    v_add_f32 v48, s73, v48
    v_add_f32 v49, s73, v49
    v_cvt_pk_bf16_f32 v22, v48, v49
    v_lshlrev_b32 v48, 16, v23
    v_and_b32 v49, 0xffff0000, v23
    v_add_f32 v48, s73, v48
    v_add_f32 v49, s73, v49
    v_cvt_pk_bf16_f32 v23, v48, v49
    s_branch phi_16_done
phi_17_fix:
    v_lshlrev_b32 v48, 16, v24
    v_and_b32 v49, 0xffff0000, v24
    v_add_f32 v48, s73, v48
    v_add_f32 v49, s73, v49
    v_cvt_pk_bf16_f32 v24, v48, v49
    v_lshlrev_b32 v48, 16, v25
    v_and_b32 v49, 0xffff0000, v25
    v_add_f32 v48, s73, v48
    v_add_f32 v49, s73, v49
    v_cvt_pk_bf16_f32 v25, v48, v49
    v_lshlrev_b32 v48, 16, v26
    v_and_b32 v49, 0xffff0000, v26
    v_add_f32 v48, s73, v48
    v_add_f32 v49, s73, v49
    v_cvt_pk_bf16_f32 v26, v48, v49
    v_lshlrev_b32 v48, 16, v27
    v_and_b32 v49, 0xffff0000, v27
    v_add_f32 v48, s73, v48
    v_add_f32 v49, s73, v49
    v_cvt_pk_bf16_f32 v27, v48, v49
    v_lshlrev_b32 v48, 16, v28
    v_and_b32 v49, 0xffff0000, v28
    v_add_f32 v48, s73, v48
    v_add_f32 v49, s73, v49
    v_cvt_pk_bf16_f32 v28, v48, v49
    v_lshlrev_b32 v48, 16, v29
    v_and_b32 v49, 0xffff0000, v29
    v_add_f32 v48, s73, v48
    v_add_f32 v49, s73, v49
    v_cvt_pk_bf16_f32 v29, v48, v49
    v_lshlrev_b32 v48, 16, v30
    v_and_b32 v49, 0xffff0000, v30
    v_add_f32 v48, s73, v48
    v_add_f32 v49, s73, v49
    v_cvt_pk_bf16_f32 v30, v48, v49
    v_lshlrev_b32 v48, 16, v31
    v_and_b32 v49, 0xffff0000, v31
    v_add_f32 v48, s73, v48
    v_add_f32 v49, s73, v49
    v_cvt_pk_bf16_f32 v31, v48, v49
    s_branch phi_17_done
C_ex1:
    ds_write_b32 v227, v96 offset:4608
    ds_write_b128 v224, v[240:243] offset:32768
    ds_write_b128 v224, v[244:247] offset:33792
    s_nop 4
    v_mov_b32 v96, v60
    v_mov_b32 v240, v248
    v_mov_b32 v241, v249
    v_mov_b32 v242, v250
    v_mov_b32 v243, v251
    v_mov_b32 v244, v252
    v_mov_b32 v245, v253
    v_mov_b32 v246, v254
    v_mov_b32 v247, v255
    s_branch C_ex2
phi_18_fix:
    v_lshlrev_b32 v48, 16, v32
    v_and_b32 v49, 0xffff0000, v32
    v_add_f32 v48, s73, v48
    v_add_f32 v49, s73, v49
    v_cvt_pk_bf16_f32 v32, v48, v49
    v_lshlrev_b32 v48, 16, v33
    v_and_b32 v49, 0xffff0000, v33
    v_add_f32 v48, s73, v48
    v_add_f32 v49, s73, v49
    v_cvt_pk_bf16_f32 v33, v48, v49
    v_lshlrev_b32 v48, 16, v34
    v_and_b32 v49, 0xffff0000, v34
    v_add_f32 v48, s73, v48
    v_add_f32 v49, s73, v49
    v_cvt_pk_bf16_f32 v34, v48, v49
    v_lshlrev_b32 v48, 16, v35
    v_and_b32 v49, 0xffff0000, v35
    v_add_f32 v48, s73, v48
    v_add_f32 v49, s73, v49
    v_cvt_pk_bf16_f32 v35, v48, v49
    v_lshlrev_b32 v48, 16, v36
    v_and_b32 v49, 0xffff0000, v36
    v_add_f32 v48, s73, v48
    v_add_f32 v49, s73, v49
    v_cvt_pk_bf16_f32 v36, v48, v49
    v_lshlrev_b32 v48, 16, v37
    v_and_b32 v49, 0xffff0000, v37
    v_add_f32 v48, s73, v48
    v_add_f32 v49, s73, v49
    v_cvt_pk_bf16_f32 v37, v48, v49
    v_lshlrev_b32 v48, 16, v38
    v_and_b32 v49, 0xffff0000, v38
    v_add_f32 v48, s73, v48
    v_add_f32 v49, s73, v49
    v_cvt_pk_bf16_f32 v38, v48, v49
    v_lshlrev_b32 v48, 16, v39
    v_and_b32 v49, 0xffff0000, v39
    v_add_f32 v48, s73, v48
    v_add_f32 v49, s73, v49
    v_cvt_pk_bf16_f32 v39, v48, v49
    s_branch phi_18_done
phi_19_fix:
    v_lshlrev_b32 v48, 16, v40
    v_and_b32 v49, 0xffff0000, v40
    v_add_f32 v48, s73, v48
    v_add_f32 v49, s73, v49
    v_cvt_pk_bf16_f32 v40, v48, v49
    v_lshlrev_b32 v48, 16, v41
    v_and_b32 v49, 0xffff0000, v41
    v_add_f32 v48, s73, v48
    v_add_f32 v49, s73, v49
    v_cvt_pk_bf16_f32 v41, v48, v49
    v_lshlrev_b32 v48, 16, v42
    v_and_b32 v49, 0xffff0000, v42
    v_add_f32 v48, s73, v48
    v_add_f32 v49, s73, v49
    v_cvt_pk_bf16_f32 v42, v48, v49
    v_lshlrev_b32 v48, 16, v43
    v_and_b32 v49, 0xffff0000, v43
    v_add_f32 v48, s73, v48
    v_add_f32 v49, s73, v49
    v_cvt_pk_bf16_f32 v43, v48, v49
    v_lshlrev_b32 v48, 16, v44
    v_and_b32 v49, 0xffff0000, v44
    v_add_f32 v48, s73, v48
    v_add_f32 v49, s73, v49
    v_cvt_pk_bf16_f32 v44, v48, v49
    v_lshlrev_b32 v48, 16, v45
    v_and_b32 v49, 0xffff0000, v45
    v_add_f32 v48, s73, v48
    v_add_f32 v49, s73, v49
    v_cvt_pk_bf16_f32 v45, v48, v49
    v_lshlrev_b32 v48, 16, v46
    v_and_b32 v49, 0xffff0000, v46
    v_add_f32 v48, s73, v48
    v_add_f32 v49, s73, v49
    v_cvt_pk_bf16_f32 v46, v48, v49
    v_lshlrev_b32 v48, 16, v47
    v_and_b32 v49, 0xffff0000, v47
    v_add_f32 v48, s73, v48
    v_add_f32 v49, s73, v49
    v_cvt_pk_bf16_f32 v47, v48, v49
    s_branch phi_19_done
P2_ys:
    v_lshrrev_b32 v13, 4, v2
    v_lshlrev_b32 v13, 12, v13
    v_and_b32 v208, 15, v2
    v_lshl_add_u32 v13, v208, 4, v13
    s_lshl_b32 s64, s5, 8
    s_lshl_b32 s65, s3, 16
    s_add_u32 s64, s64, s65
    v_add_u32 v13, s64, v13
    s_lshl_b32 s64, s67, 11
    s_lshl_b32 s65, s5, 7
    s_add_u32 s64, s64, s65
    v_lshl_add_u32 v209, v2, 1, s64
    s_lshl_b32 s64, s67, 2
    s_add_u32 s64, s64, 6709248
    v_mov_b32 v215, s64
    s_branch P2_ysd
P2_yl:
    s_cmp_gt_u32 s70, 7
    s_cbranch_scc1 P2_nyl
    buffer_load_ushort v211, v209, s[8:11], 0 offen
    buffer_load_dword v212, v215, s[16:19], 0 offen sc1
    s_mov_b32 s69, 6447104
    buffer_load_dwordx4 v[192:195], v13, s[16:19], s69 offen sc1
    s_mov_b32 s69, 6463488
    buffer_load_dwordx4 v[196:199], v13, s[16:19], s69 offen sc1
    s_mov_b32 s69, 6479872
    buffer_load_dwordx4 v[200:203], v13, s[16:19], s69 offen sc1
    s_mov_b32 s69, 6496256
    buffer_load_dwordx4 v[204:207], v13, s[16:19], s69 offen sc1
    s_mov_b32 s47, 1
    s_branch P2_nyl
P2_y:
    s_mov_b32 s66, 0
    s_cmp_lg_u32 s47, 0
    s_cbranch_scc1 P2_ychk
P2_yre:
    buffer_load_ushort v211, v209, s[8:11], 0 offen
    buffer_load_dword v212, v215, s[16:19], 0 offen sc1
    s_mov_b32 s69, 6447104
    buffer_load_dwordx4 v[192:195], v13, s[16:19], s69 offen sc1
    s_mov_b32 s69, 6463488
    buffer_load_dwordx4 v[196:199], v13, s[16:19], s69 offen sc1
    s_mov_b32 s69, 6479872
    buffer_load_dwordx4 v[200:203], v13, s[16:19], s69 offen sc1
    s_mov_b32 s69, 6496256
    buffer_load_dwordx4 v[204:207], v13, s[16:19], s69 offen sc1
P2_ychk:
    s_waitcnt vmcnt(0)
    v_max3_u32 v10, v192, v193, v194
    v_max3_u32 v10, v195, v196, v10
    v_max3_u32 v10, v197, v198, v10
    v_max3_u32 v10, v199, v200, v10
    v_max3_u32 v10, v201, v202, v10
    v_max3_u32 v10, v203, v204, v10
    v_max3_u32 v10, v205, v206, v10
    v_max_u32 v10, v207, v10
    v_cmp_eq_u32 vcc, -1, v10
    s_cbranch_vccz P2_yok
    s_add_u32 s66, s66, 1
    s_cmp_ge_u32 s66, 40000
    s_cbranch_scc1 P2_yok
    s_sleep 4
    s_branch P2_yre
P2_yok:
    v_pk_add_f32 v[192:193], v[192:193], v[200:201]
    v_pk_add_f32 v[194:195], v[194:195], v[202:203]
    v_pk_add_f32 v[196:197], v[196:197], v[204:205]
    v_pk_add_f32 v[198:199], v[198:199], v[206:207]
    v_pk_add_f32 v[192:193], v[192:193], v[196:197]
    v_pk_add_f32 v[194:195], v[194:195], v[198:199]
    v_mov_b32 v196, v192
    v_mov_b32 v197, v193
    v_mov_b32 v198, v194
    v_mov_b32 v199, v195
    s_nop 0
    v_permlane16_swap_b32 v192, v196
    v_permlane16_swap_b32 v193, v197
    v_permlane16_swap_b32 v194, v198
    v_permlane16_swap_b32 v195, v199
    v_add_f32 v192, v192, v196
    v_add_f32 v193, v193, v197
    v_add_f32 v194, v194, v198
    v_add_f32 v195, v195, v199
    v_mov_b32 v196, v192
    v_mov_b32 v197, v193
    v_mov_b32 v198, v194
    v_mov_b32 v199, v195
    s_nop 0
    v_permlane32_swap_b32 v192, v196
    v_permlane32_swap_b32 v193, v197
    v_permlane32_swap_b32 v194, v198
    v_permlane32_swap_b32 v195, v199
    v_add_f32 v192, v192, v196
    v_add_f32 v193, v193, v197
    v_add_f32 v194, v194, v198
    v_add_f32 v195, v195, v199
    s_lshl_b32 s64, s3, 8
    v_lshl_add_u32 v208, v208, 4, s64
    ds_write_b128 v208, v[192:195] offset:5888
    v_mov_b32 v208, 0
    v_mov_b32 v214, 1
    s_mov_b64 exec, 1
    ds_add_rtn_u32 v210, v208, v214 offset:4304
    s_mov_b64 exec, -1
    s_and_b32 s64, s75, 0xffff0000
    s_xor_b32 s65, s64, 0x80000000
    s_not_b32 s69, s64
    s_and_b32 s69, s69, 0xffff0000
    s_cmp_ge_u32 s64, 0x80000000
    s_cselect_b32 s64, s65, s69
    v_mov_b32 v213, s64
    v_lshlrev_b32 v208, 2, v2
    s_waitcnt lgkmcnt(0)
    v_readfirstlane_b32 s64, v210
    s_cmp_lg_u32 s64, 3
    s_cbranch_scc1 P2_ny
    ds_read_b32 v192, v208 offset:5888
    ds_read_b32 v193, v208 offset:6144
    ds_read_b32 v194, v208 offset:6400
    ds_read_b32 v195, v208 offset:6656
    v_mul_f32 v213, s72, v213
    v_exp_f32 v213, -v213
    s_nop 0
    v_add_f32 v213, 1.0, v213
    v_rcp_f32 v213, v213
    s_nop 0
    v_cvt_pk_bf16_f32 v213, v213, v213
    v_lshlrev_b32 v213, 16, v213
    v_sub_f32 v214, 1.0, v212
    v_cvt_pk_bf16_f32 v214, v214, v214
    v_lshlrev_b32 v214, 16, v214
    v_lshlrev_b32 v211, 16, v211
    s_waitcnt lgkmcnt(0)
    v_add_f32 v192, v192, v193
    v_add_f32 v194, v194, v195
    v_add_f32 v210, v192, v194
    v_cvt_pk_bf16_f32 v210, v210, v210
    v_lshlrev_b32 v210, 16, v210
    v_mul_f32 v210, v210, v213
    v_cvt_pk_bf16_f32 v210, v210, v210
    v_lshlrev_b32 v210, 16, v210
    v_add_f32 v210, v211, v210
    v_cvt_pk_bf16_f32 v210, v210, v210
    v_lshlrev_b32 v210, 16, v210
    v_mul_f32 v210, v210, v214
    v_cvt_pk_bf16_f32 v210, v210, v210
    v_lshlrev_b32 v210, 16, v210
    ds_write_b32 v208, v210 offset:5632
    s_waitcnt lgkmcnt(0)
    s_branch P2_ny
P2_fix:
    s_mov_b64 exec, s[70:71]
    ds_read_b128 v[232:235], v9 offset:5632
    ds_read_b128 v[236:239], v9 offset:5648
    ds_read_b128 v[240:243], v9 offset:5760
    ds_read_b128 v[244:247], v9 offset:5776
    s_mov_b64 exec, -1
    s_branch P2_nr
CODE_END:
.section .rodata,"a"
.p2align 6
.amdhsa_kernel gated_mix__linear_attn_block__moe_arch_mod__prompt_kernel
  .amdhsa_next_free_vgpr 256
  .amdhsa_next_free_sgpr 102
  .amdhsa_accum_offset 256
  .amdhsa_group_segment_fixed_size 0
  .amdhsa_kernarg_size 96
  .amdhsa_user_sgpr_count 2
  .amdhsa_user_sgpr_kernarg_segment_ptr 1
  .amdhsa_system_sgpr_workgroup_id_x 1
.end_amdhsa_kernel
```

```asm
; @launch grid=(256,1,1) block=(512,1,1) lds=163840
.amdgcn_target "amdgcn-amd-amdhsa--gfx950"
.text
.globl gated_mix__linear_attn_block__moe_arch_mod__prompt_kernel
.p2align 8
.type gated_mix__linear_attn_block__moe_arch_mod__prompt_kernel,@function
gated_mix__linear_attn_block__moe_arch_mod__prompt_kernel:
    s_load_dwordx16 s[40:55], s[0:1], 0
    s_load_dwordx8 s[56:63], s[0:1], 64
    s_cmp_ge_u32 s2, 256
    s_cbranch_scc1 K_end
    v_lshrrev_b32 v1, 6, v0
    v_and_b32 v2, 63, v0
    s_and_b32 s6, s2, 7
    v_readfirstlane_b32 s3, v1
    s_lshr_b32 s7, s2, 3
    s_and_b32 s4, s6, 1
    s_lshl_b32 s4, s4, 3
    s_and_b32 s64, s7, 7
    s_add_u32 s4, s4, s64
    s_lshr_b32 s5, s6, 1
    s_lshl_b32 s5, s5, 2
    s_lshr_b32 s64, s7, 3
    s_add_u32 s5, s5, s64
    s_and_b32 s74, s4, 3
    s_lshl_b32 s74, s74, 2
    s_add_u32 s74, s74, s6
    v_lshrrev_b32 v6, 3, v2
    s_lshl_b32 s65, s3, 3
    v_add_u32 v6, s65, v6
    s_lshl_b32 s64, s4, 7
    v_add_u32 v7, s64, v6
    v_lshlrev_b32 v7, 11, v7
    v_lshrrev_b32 v8, 4, v2
    s_and_b32 s64, s3, 1
    s_lshl_b32 s64, s64, 2
    v_add_u32 v9, s64, v8
    v_and_b32 v10, 7, v2
    v_xor_b32 v9, v9, v10
    v_lshl_add_u32 v7, v9, 4, v7
    v_mul_u32_u24 v6, 6144, v6
    v_and_b32 v9, 1, v8
    s_lshr_b32 s64, s64, 1
    v_lshl_add_u32 v9, v9, 2, s64
    v_xor_b32 v9, v9, v10
    v_lshl_add_u32 v6, v9, 4, v6
    s_lshl_b32 s64, s5, 7
    v_add_u32 v6, s64, v6
    s_lshl_b32 s66, s3, 10
    s_mov_b32 s10, 4194304
    s_mov_b32 s11, 0x00020000
    s_mov_b32 s14, 6291456
    s_mov_b32 s15, 0x00020000
    s_add_u32 s65, s74, 0
    s_and_b32 s65, s65, 15
    s_lshl_b32 s67, s65, 7
    s_mul_i32 s65, s65, 393216
    s_waitcnt lgkmcnt(0)
    s_mov_b32 s8, s40
    s_mov_b32 s9, s41
    s_mov_b32 s12, s42
    s_mov_b32 s13, s43
    s_add_u32 m0, s66, 8192
    s_add_u32 s64, s67, 0
    buffer_load_dwordx4 v7, s[8:11], s64 offen lds
    s_add_u32 m0, s66, 16384
    s_add_u32 s64, s67, 131072
    buffer_load_dwordx4 v7, s[8:11], s64 offen lds
    s_add_u32 m0, s66, 24576
    s_add_u32 s64, s65, 0
    buffer_load_dwordx4 v6, s[12:15], s64 offen lds
    s_add_u32 m0, s66, 32768
    s_add_u32 s64, s65, 2048
    buffer_load_dwordx4 v6, s[12:15], s64 offen lds
    s_add_u32 m0, s66, 40960
    s_add_u32 s64, s65, 4096
    buffer_load_dwordx4 v6, s[12:15], s64 offen lds
    s_cmp_lt_u32 s3, 4
    s_cbranch_scc1 K_nt
    s_lshl_b32 s64, s2, 2
    s_add_u32 s64, s64, s3
    s_sub_u32 s64, s64, 4
    s_mul_i32 s64, s64, 6144
    s_add_u32 s46, s12, s64
    s_addc_u32 s47, s13, 0
    s_load_dword s43, s[46:47], 384
    s_load_dword s43, s[46:47], 448
    s_load_dword s43, s[46:47], 1408
    s_load_dword s43, s[46:47], 1472
    s_load_dword s43, s[46:47], 2432
    s_load_dword s43, s[46:47], 2496
    s_load_dword s43, s[46:47], 3456
    s_load_dword s43, s[46:47], 3520
    s_load_dword s43, s[46:47], 4480
    s_load_dword s43, s[46:47], 4544
    s_load_dword s43, s[46:47], 5504
    s_load_dword s43, s[46:47], 5568
K_nt:
    s_barrier
    s_mov_b32 s72, 0x3fb8aa3b
    s_mov_b32 s73, 0x358637bd
    s_mov_b32 s16, s62
    s_mov_b32 s17, s63
    s_mov_b32 s18, 0x10000000
    s_mov_b32 s19, 0x00020000
    s_cmp_lt_u32 s3, 4
    s_cbranch_scc1 C_start
    s_sub_u32 s6, s3, 4
    s_lshl_b32 s7, s6, 10
    v_lshrrev_b32 v6, 3, v2
    s_lshl_b32 s64, s4, 7
    s_lshl_b32 s65, s6, 3
    s_add_u32 s64, s64, s65
    v_add_u32 v7, s64, v6
    v_lshlrev_b32 v7, 11, v7
    s_and_b32 s64, s6, 1
    s_lshl_b32 s64, s64, 2
    v_add_u32 v9, s64, v8
    v_xor_b32 v9, v9, v10
    v_lshl_add_u32 v4, v9, 4, v7
    v_add_u32 v7, s65, v6
    v_mul_u32_u24 v7, 6144, v7
    v_and_b32 v9, 1, v8
    s_lshr_b32 s64, s64, 1
    v_lshl_add_u32 v9, v9, 2, s64
    v_xor_b32 v9, v9, v10
    v_lshl_add_u32 v7, v9, 4, v7
    s_lshl_b32 s64, s5, 7
    v_add_u32 v5, s64, v7
    v_lshlrev_b32 v6, 4, v2
    s_and_b32 s64, s2, 1
    s_lshl_b32 s68, s64, 10
    s_bfe_u32 s64, s2, 0x20001
    s_lshl_b32 s64, s64, 8
    s_add_u32 s68, s68, s64
    s_and_b32 s64, s2, 0xf8
    s_add_u32 s68, s68, s64
    s_lshl_b32 s64, s6, 1
    s_add_u32 s68, s68, s64
    s_lshl_b32 s64, s68, 11
    v_add_u32 v13, s64, v6
    s_add_u32 s41, s74, 1
    s_and_b32 s41, s41, 15
    s_lshl_b32 s42, s41, 7
    s_mul_i32 s41, s41, 393216
    s_add_u32 m0, s7, 49152
    s_add_u32 s40, s42, 0
    buffer_load_dwordx4 v4, s[8:11], s40 offen lds
    s_add_u32 m0, s7, 53248
    s_add_u32 s40, s42, 65536
    buffer_load_dwordx4 v4, s[8:11], s40 offen lds
    s_add_u32 m0, s7, 57344
    s_add_u32 s40, s42, 131072
    buffer_load_dwordx4 v4, s[8:11], s40 offen lds
    s_add_u32 m0, s7, 61440
    s_add_u32 s40, s42, 196608
    buffer_load_dwordx4 v4, s[8:11], s40 offen lds
    s_add_u32 m0, s7, 65536
    s_add_u32 s40, s41, 0
    buffer_load_dwordx4 v5, s[12:15], s40 offen lds
    s_add_u32 m0, s7, 69632
    s_add_u32 s40, s41, 196608
    buffer_load_dwordx4 v5, s[12:15], s40 offen lds
    s_add_u32 m0, s7, 73728
    s_add_u32 s40, s41, 2048
    buffer_load_dwordx4 v5, s[12:15], s40 offen lds
    s_add_u32 m0, s7, 77824
    s_add_u32 s40, s41, 198656
    buffer_load_dwordx4 v5, s[12:15], s40 offen lds
    s_add_u32 m0, s7, 81920
    s_add_u32 s40, s41, 4096
    buffer_load_dwordx4 v5, s[12:15], s40 offen lds
    s_add_u32 m0, s7, 86016
    s_add_u32 s40, s41, 200704
    buffer_load_dwordx4 v5, s[12:15], s40 offen lds
    s_mov_b32 s32, s50
    s_mov_b32 s33, s51
    s_mov_b32 s34, 0x700000
    s_mov_b32 s35, 0x00020000
    s_mov_b32 s36, s52
    s_mov_b32 s37, s53
    s_mov_b32 s38, 0x700000
    s_mov_b32 s39, 0x00020000
    s_or_b32 s64, s2, s6
    s_cmp_lg_u32 s64, 0
    s_cbranch_scc1 H_nn
    s_mov_b32 s64, 6717440
    s_load_dwordx2 s[66:67], s[62:63], s64
    s_mov_b32 s20, s60
    s_mov_b32 s21, s61
    s_mov_b32 s22, 0x100
    s_mov_b32 s23, 0x00020000
    s_waitcnt lgkmcnt(0)
    s_xor_b32 s64, s66, s67
    s_add_u32 s64, s64, 1
    s_max_u32 s64, s64, 1
    v_mov_b32 v72, s64
    v_mov_b32 v73, 0
    s_mov_b64 exec, 1
    buffer_store_dword v72, v73, s[20:23], 0 offen sc0 sc1
    s_mov_b64 exec, -1
H_nn:
    s_mov_b32 s20, s60
    s_mov_b32 s21, s61
    s_mov_b32 s22, 0x100
    s_mov_b32 s23, 0x00020000
    s_mov_b32 s24, s48
    s_mov_b32 s25, s49
    s_mov_b32 s26, 0x800
    s_mov_b32 s27, 0x00020000
    s_mov_b32 s28, s56
    s_mov_b32 s29, s57
    s_mov_b32 s30, 0x800
    s_mov_b32 s31, 0x00020000
    s_lshr_b32 s69, s2, 3
    s_and_b32 s64, s2, 7
    v_and_b32 v9, 15, v2
    v_min_u32 v9, 13, v9
    s_lshl_b32 s65, s69, 5
    v_lshl_add_u32 v7, v8, 3, s65
    v_mul_u32_u24 v7, 7168, v7
    s_mul_i32 s65, s64, 896
    s_mul_i32 s66, s6, 224
    s_add_u32 s65, s65, s66
    v_lshl_add_u32 v7, v9, 4, v7
    v_add_u32 v11, s65, v7
    v_cmp_le_u32 vcc, 7, v9
    v_mov_b32 v15, 16160
    s_nop 0
    v_cndmask_b32 v7, 0, v15, vcc
    v_lshl_add_u32 v7, v9, 5, v7
    v_lshrrev_b32 v15, 1, v8
    v_lshl_add_u32 v7, v15, 13, v7
    v_and_b32 v15, 1, v8
    v_lshl_add_u32 v7, v15, 4, v7
    s_lshl_b32 s64, s64, 17
    s_lshl_b32 s65, s6, 15
    s_add_u32 s64, s64, s65
    s_lshl_b32 s65, s69, 8
    s_add_u32 s64, s64, s65
    s_add_u32 s64, s64, 5398528
    v_add_u32 v12, s64, v7
    s_lshl_b32 s70, s5, 2
    s_add_u32 s70, s70, s6
    s_mul_i32 s70, s70, 18432
    s_add_u32 s70, s70, 4194304
    s_mul_i32 s64, s4, 1152
    s_add_u32 s64, s64, s70
    s_mov_b32 s67, s64
    v_lshl_add_u32 v15, v2, 2, s64
    v_add_u32 v15, 960, v15
    s_lshl_b32 s64, s5, 2
    s_add_u32 s64, s64, s6
    s_lshl_b32 s64, s64, 7
    s_add_u32 s64, s64, 5373952
    v_mov_b32 v23, s64
    s_lshl_b32 s65, s4, 10
    s_add_u32 s65, s65, 5382016
    v_lshl_add_u32 v20, v2, 7, s65
    v_cmp_gt_u32 vcc, 16, v2
    s_nop 1
    v_cndmask_b32 v15, v15, v20, vcc
    v_writelane_b32 v15, s64, 0
    s_cmp_eq_u32 s4, 0
    s_cselect_b32 s75, 1, 0
    s_or_b32 s64, s5, s6
    s_cmp_eq_u32 s64, 0
    s_cselect_b32 s64, 0x1fe, 0
    s_or_b32 s75, s75, s64
    s_or_b32 s75, s75, 0xffff0000
    v_lshlrev_b32 v22, 4, v2
    v_add_u32 v22, s67, v22
    v_mov_b32 v16, -1
    v_mov_b32 v17, -1
    v_mov_b32 v18, -1
    v_mov_b32 v19, -1
    v_cndmask_b32 v20, -1, 0, vcc
    s_waitcnt vmcnt(10)
    s_barrier
    s_add_u32 s41, s74, 2
    s_and_b32 s41, s41, 15
    s_lshl_b32 s42, s41, 7
    s_mul_i32 s41, s41, 393216
    s_add_u32 m0, s7, 90112
    s_add_u32 s40, s42, 0
    buffer_load_dwordx4 v4, s[8:11], s40 offen lds
    s_add_u32 m0, s7, 94208
    s_add_u32 s40, s42, 65536
    buffer_load_dwordx4 v4, s[8:11], s40 offen lds
    s_add_u32 m0, s7, 98304
    s_add_u32 s40, s42, 131072
    buffer_load_dwordx4 v4, s[8:11], s40 offen lds
    s_add_u32 m0, s7, 102400
    s_add_u32 s40, s42, 196608
    buffer_load_dwordx4 v4, s[8:11], s40 offen lds
    s_add_u32 m0, s7, 106496
    s_add_u32 s40, s41, 0
    buffer_load_dwordx4 v5, s[12:15], s40 offen lds
    s_add_u32 m0, s7, 110592
    s_add_u32 s40, s41, 196608
    buffer_load_dwordx4 v5, s[12:15], s40 offen lds
    s_add_u32 m0, s7, 114688
    s_add_u32 s40, s41, 2048
    buffer_load_dwordx4 v5, s[12:15], s40 offen lds
    s_add_u32 m0, s7, 118784
    s_add_u32 s40, s41, 198656
    buffer_load_dwordx4 v5, s[12:15], s40 offen lds
    s_add_u32 m0, s7, 122880
    s_add_u32 s40, s41, 4096
    buffer_load_dwordx4 v5, s[12:15], s40 offen lds
    s_add_u32 m0, s7, 126976
    s_add_u32 s40, s41, 200704
    buffer_load_dwordx4 v5, s[12:15], s40 offen lds
    s_getpc_b64 s[66:67]
pc_1:
    s_sub_u32 s66, s66, pc_1-gated_mix__linear_attn_block__moe_arch_mod__prompt_kernel
    s_subb_u32 s67, s67, 0
    s_lshr_b32 s64, s2, 3
    s_lshl_b32 s64, s64, 2
    s_add_u32 s64, s64, s6
    s_mul_i32 s64, s64, 256
    s_min_u32 s65, s64, CODE_END-gated_mix__linear_attn_block__moe_arch_mod__prompt_kernel-4
    s_load_dword s43, s[66:67], s65
    s_add_u32 s64, s64, 64
    s_min_u32 s65, s64, CODE_END-gated_mix__linear_attn_block__moe_arch_mod__prompt_kernel-4
    s_load_dword s43, s[66:67], s65
    s_add_u32 s64, s64, 64
    s_min_u32 s65, s64, CODE_END-gated_mix__linear_attn_block__moe_arch_mod__prompt_kernel-4
    s_load_dword s43, s[66:67], s65
    s_add_u32 s64, s64, 64
    s_min_u32 s65, s64, CODE_END-gated_mix__linear_attn_block__moe_arch_mod__prompt_kernel-4
    s_load_dword s43, s[66:67], s65
    s_add_u32 s64, s64, 64
    buffer_load_dwordx4 v[24:27], v13, s[8:11], 0 offen offset:0
    buffer_load_dwordx4 v[28:31], v13, s[8:11], 0 offen offset:1024
    buffer_load_dwordx4 v[32:35], v13, s[8:11], 0 offen offset:2048
    buffer_load_dwordx4 v[36:39], v13, s[8:11], 0 offen offset:3072
    s_cmp_lt_u32 s6, 2
    s_cselect_b32 s24, s48, s56
    s_cselect_b32 s25, s49, s57
    s_and_b32 s64, s7, 1024
    s_add_u32 m0, s7, 0
    s_nop 0
    buffer_load_dwordx4 v6, s[24:27], s64 offen lds
    s_waitcnt vmcnt(15)
    s_barrier
    s_add_u32 s41, s74, 3
    s_and_b32 s41, s41, 15
    s_lshl_b32 s42, s41, 7
    s_mul_i32 s41, s41, 393216
    s_add_u32 m0, s7, 8192
    s_add_u32 s40, s42, 0
    buffer_load_dwordx4 v4, s[8:11], s40 offen lds
    s_add_u32 m0, s7, 12288
    s_add_u32 s40, s42, 65536
    buffer_load_dwordx4 v4, s[8:11], s40 offen lds
    s_add_u32 m0, s7, 16384
    s_add_u32 s40, s42, 131072
    buffer_load_dwordx4 v4, s[8:11], s40 offen lds
    s_add_u32 m0, s7, 20480
    s_add_u32 s40, s42, 196608
    buffer_load_dwordx4 v4, s[8:11], s40 offen lds
    s_add_u32 m0, s7, 24576
    s_add_u32 s40, s41, 0
    buffer_load_dwordx4 v5, s[12:15], s40 offen lds
    s_add_u32 m0, s7, 28672
    s_add_u32 s40, s41, 196608
    buffer_load_dwordx4 v5, s[12:15], s40 offen lds
    s_add_u32 m0, s7, 32768
    s_add_u32 s40, s41, 2048
    buffer_load_dwordx4 v5, s[12:15], s40 offen lds
    s_add_u32 m0, s7, 36864
    s_add_u32 s40, s41, 198656
    buffer_load_dwordx4 v5, s[12:15], s40 offen lds
    s_add_u32 m0, s7, 40960
    s_add_u32 s40, s41, 4096
    buffer_load_dwordx4 v5, s[12:15], s40 offen lds
    s_add_u32 m0, s7, 45056
    s_add_u32 s40, s41, 200704
    buffer_load_dwordx4 v5, s[12:15], s40 offen lds
    buffer_store_dwordx4 v[16:19], v22, s[16:19], 0 offen sc0 sc1
    s_mov_b32 exec_lo, s75
    s_mov_b32 exec_hi, 0
    buffer_store_dword v20, v15, s[16:19], 0 offen sc0 sc1
    s_mov_b32 exec_lo, 0x3fff3fff
    s_mov_b32 exec_hi, 0x3fff3fff
    buffer_store_dwordx4 v[16:19], v12, s[16:19], 0 offen sc0 sc1
    s_mov_b64 exec, 0xffff
    s_lshl_b32 s64, s2, 10
    s_lshl_b32 s65, s6, 8
    s_add_u32 s64, s64, s65
    s_add_u32 s64, s64, 6447104
    buffer_store_dwordx4 v[16:19], v6, s[16:19], s64 offen sc0 sc1
    s_mov_b64 exec, -1
    s_waitcnt vmcnt(19)
    s_barrier
    v_mov_b32 v79, 0
    s_cmp_lg_u32 s6, 0
    s_cbranch_scc1 H_nc
    buffer_load_dword v78, v79, s[20:23], 0 offen sc1
H_nc:
    s_add_u32 s41, s74, 4
    s_and_b32 s41, s41, 15
    s_lshl_b32 s42, s41, 7
    s_mul_i32 s41, s41, 393216
    s_add_u32 m0, s7, 49152
    s_add_u32 s40, s42, 0
    buffer_load_dwordx4 v4, s[8:11], s40 offen lds
    s_add_u32 m0, s7, 53248
    s_add_u32 s40, s42, 65536
    buffer_load_dwordx4 v4, s[8:11], s40 offen lds
    s_add_u32 m0, s7, 57344
    s_add_u32 s40, s42, 131072
    buffer_load_dwordx4 v4, s[8:11], s40 offen lds
    s_add_u32 m0, s7, 61440
    s_add_u32 s40, s42, 196608
    buffer_load_dwordx4 v4, s[8:11], s40 offen lds
    s_add_u32 m0, s7, 65536
    s_add_u32 s40, s41, 0
    buffer_load_dwordx4 v5, s[12:15], s40 offen lds
    s_add_u32 m0, s7, 69632
    s_add_u32 s40, s41, 196608
    buffer_load_dwordx4 v5, s[12:15], s40 offen lds
    s_add_u32 m0, s7, 73728
    s_add_u32 s40, s41, 2048
    buffer_load_dwordx4 v5, s[12:15], s40 offen lds
    s_add_u32 m0, s7, 77824
    s_add_u32 s40, s41, 198656
    buffer_load_dwordx4 v5, s[12:15], s40 offen lds
    s_add_u32 m0, s7, 81920
    s_add_u32 s40, s41, 4096
    buffer_load_dwordx4 v5, s[12:15], s40 offen lds
    s_add_u32 m0, s7, 86016
    s_add_u32 s40, s41, 200704
    buffer_load_dwordx4 v5, s[12:15], s40 offen lds
    s_waitcnt vmcnt(14)
    s_barrier
    ds_read_b128 v[40:43], v6 offset:0
    ds_read_b128 v[44:47], v6 offset:1024
    ds_read_b128 v[48:51], v6 offset:2048
    ds_read_b128 v[52:55], v6 offset:3072
    s_add_u32 s41, s74, 5
    s_and_b32 s41, s41, 15
    s_lshl_b32 s42, s41, 7
    s_mul_i32 s41, s41, 393216
    s_add_u32 m0, s7, 90112
    s_add_u32 s40, s42, 0
    buffer_load_dwordx4 v4, s[8:11], s40 offen lds
    s_waitcnt lgkmcnt(0)
    s_add_u32 m0, s7, 94208
    s_add_u32 s40, s42, 65536
    buffer_load_dwordx4 v4, s[8:11], s40 offen lds
    v_dot2_f32_bf16 v72, v24, v48, 0
    v_dot2_f32_bf16 v73, v32, v48, 0
    v_dot2_f32_bf16 v74, v24, v40, 0
    v_dot2_f32_bf16 v75, v32, v40, 0
    s_add_u32 m0, s7, 98304
    s_add_u32 s40, s42, 131072
    buffer_load_dwordx4 v4, s[8:11], s40 offen lds
    v_dot2_f32_bf16 v72, v25, v49, v72
    v_dot2_f32_bf16 v73, v33, v49, v73
    v_dot2_f32_bf16 v74, v25, v41, v74
    v_dot2_f32_bf16 v75, v33, v41, v75
    s_add_u32 m0, s7, 102400
    s_add_u32 s40, s42, 196608
    buffer_load_dwordx4 v4, s[8:11], s40 offen lds
    v_dot2_f32_bf16 v72, v26, v50, v72
    v_dot2_f32_bf16 v73, v34, v50, v73
    v_dot2_f32_bf16 v74, v26, v42, v74
    v_dot2_f32_bf16 v75, v34, v42, v75
    s_add_u32 m0, s7, 106496
    s_add_u32 s40, s41, 0
    buffer_load_dwordx4 v5, s[12:15], s40 offen lds
    v_dot2_f32_bf16 v72, v27, v51, v72
    v_dot2_f32_bf16 v73, v35, v51, v73
    v_dot2_f32_bf16 v74, v27, v43, v74
    v_dot2_f32_bf16 v75, v35, v43, v75
    s_add_u32 m0, s7, 110592
    s_add_u32 s40, s41, 196608
    buffer_load_dwordx4 v5, s[12:15], s40 offen lds
    v_dot2_f32_bf16 v72, v28, v52, v72
    v_dot2_f32_bf16 v73, v36, v52, v73
    v_dot2_f32_bf16 v74, v28, v44, v74
    v_dot2_f32_bf16 v75, v36, v44, v75
    s_add_u32 m0, s7, 114688
    s_add_u32 s40, s41, 2048
    buffer_load_dwordx4 v5, s[12:15], s40 offen lds
    v_dot2_f32_bf16 v72, v29, v53, v72
    v_dot2_f32_bf16 v73, v37, v53, v73
    v_dot2_f32_bf16 v74, v29, v45, v74
    v_dot2_f32_bf16 v75, v37, v45, v75
    s_add_u32 m0, s7, 118784
    s_add_u32 s40, s41, 198656
    buffer_load_dwordx4 v5, s[12:15], s40 offen lds
    v_dot2_f32_bf16 v72, v30, v54, v72
    v_dot2_f32_bf16 v73, v38, v54, v73
    v_dot2_f32_bf16 v74, v30, v46, v74
    v_dot2_f32_bf16 v75, v38, v46, v75
    s_add_u32 m0, s7, 122880
    s_add_u32 s40, s41, 4096
    buffer_load_dwordx4 v5, s[12:15], s40 offen lds
    v_dot2_f32_bf16 v72, v31, v55, v72
    v_dot2_f32_bf16 v73, v39, v55, v73
    v_dot2_f32_bf16 v74, v31, v47, v74
    v_dot2_f32_bf16 v75, v39, v47, v75
    s_add_u32 m0, s7, 126976
    s_add_u32 s40, s41, 200704
    buffer_load_dwordx4 v5, s[12:15], s40 offen lds
    s_waitcnt vmcnt(10)
    s_barrier
    s_add_u32 s41, s74, 6
    s_and_b32 s41, s41, 15
    s_lshl_b32 s42, s41, 7
    s_mul_i32 s41, s41, 393216
    s_add_u32 m0, s7, 8192
    s_add_u32 s40, s42, 0
    buffer_load_dwordx4 v4, s[8:11], s40 offen lds
    v_permlane32_swap_b32 v72, v74
    v_permlane32_swap_b32 v73, v75
    v_add_f32 v72, v72, v74
    v_add_f32 v73, v73, v75
    s_add_u32 m0, s7, 12288
    s_add_u32 s40, s42, 65536
    buffer_load_dwordx4 v4, s[8:11], s40 offen lds
    s_lshl_b32 s64, s68, 2
    s_add_u32 s64, s64, 6709248
    v_permlane16_swap_b32 v72, v73
    v_add_f32 v72, v72, v73
    s_add_u32 m0, s7, 16384
    s_add_u32 s40, s42, 131072
    buffer_load_dwordx4 v4, s[8:11], s40 offen lds
    v_and_b32 v75, 1, v8
    v_lshl_add_u32 v76, v75, 2, s64
    v_add_f32_dpp v72, v72, v72 quad_perm:[1,0,3,2] row_mask:0xf bank_mask:0xf
    s_nop 1
    s_add_u32 m0, s7, 20480
    s_add_u32 s40, s42, 196608
    buffer_load_dwordx4 v4, s[8:11], s40 offen lds
    v_add_f32_dpp v72, v72, v72 quad_perm:[2,3,0,1] row_mask:0xf bank_mask:0xf
    s_nop 1
    v_add_f32_dpp v72, v72, v72 row_half_mirror row_mask:0xf bank_mask:0xf
    s_nop 1
    s_add_u32 m0, s7, 24576
    s_add_u32 s40, s41, 0
    buffer_load_dwordx4 v5, s[12:15], s40 offen lds
    v_add_f32_dpp v72, v72, v72 row_mirror row_mask:0xf bank_mask:0xf
    s_nop 1
    v_cvt_pk_bf16_f32 v72, v72, v72
    s_sub_u32 s64, 34815, s68
    s_add_u32 m0, s7, 28672
    s_add_u32 s40, s41, 196608
    buffer_load_dwordx4 v5, s[12:15], s40 offen lds
    v_lshlrev_b32 v72, 16, v72
    v_ashrrev_i32 v73, 31, v72
    v_sub_u32 v77, s64, v75
    v_or_b32 v73, 0x80000000, v73
    s_add_u32 m0, s7, 32768
    s_add_u32 s40, s41, 2048
    buffer_load_dwordx4 v5, s[12:15], s40 offen lds
    s_lshl_b32 s64, s6, 3
    v_xor_b32 v73, v72, v73
    v_lshl_add_u32 v75, v75, 2, s64
    v_and_b32 v73, 0xffff0000, v73
    s_add_u32 m0, s7, 36864
    s_add_u32 s40, s41, 198656
    buffer_load_dwordx4 v5, s[12:15], s40 offen lds
    v_or_b32 v73, v77, v73
    v_mul_f32 v72, s72, v72
    v_exp_f32 v72, -v72
    s_nop 0
    s_add_u32 m0, s7, 40960
    s_add_u32 s40, s41, 4096
    buffer_load_dwordx4 v5, s[12:15], s40 offen lds
    v_add_f32 v72, 1.0, v72
    v_rcp_f32 v72, v72
    s_nop 0
    v_cvt_pk_bf16_f32 v72, v72, v72
    s_add_u32 m0, s7, 45056
    s_add_u32 s40, s41, 200704
    buffer_load_dwordx4 v5, s[12:15], s40 offen lds
    v_lshlrev_b32 v72, 16, v72
    s_mov_b32 exec_lo, 0
    s_mov_b32 exec_hi, 0x10001
    ds_write_b32 v75, v73 offset:4224
    s_mov_b32 exec_lo, 0x10001
    s_mov_b32 exec_hi, 0
    buffer_store_dword v72, v76, s[16:19], 0 offen sc0 sc1
    s_mov_b64 exec, -1
    s_mov_b32 exec_lo, 0x3fff3fff
    s_mov_b32 exec_hi, 0x3fff3fff
    s_mov_b32 s64, 0
    buffer_load_dwordx4 v[96:99], v11, s[32:35], s64 offen nt
    s_mov_b32 s64, 0
    buffer_load_dwordx4 v[128:131], v11, s[36:39], s64 offen nt
    s_mov_b32 s64, 7168
    buffer_load_dwordx4 v[100:103], v11, s[32:35], s64 offen nt
    s_mov_b32 s64, 7168
    buffer_load_dwordx4 v[132:135], v11, s[36:39], s64 offen nt
    s_mov_b32 s64, 14336
    buffer_load_dwordx4 v[104:107], v11, s[32:35], s64 offen nt
    s_mov_b64 exec, -1
    s_waitcnt vmcnt(16)
    s_waitcnt lgkmcnt(0)
    s_barrier
    s_add_u32 s41, s74, 7
    s_and_b32 s41, s41, 15
    s_lshl_b32 s42, s41, 7
    s_mul_i32 s41, s41, 393216
    s_add_u32 m0, s7, 49152
    s_add_u32 s40, s42, 0
    buffer_load_dwordx4 v4, s[8:11], s40 offen lds
    s_add_u32 m0, s7, 53248
    s_add_u32 s40, s42, 65536
    buffer_load_dwordx4 v4, s[8:11], s40 offen lds
    s_add_u32 m0, s7, 57344
    s_add_u32 s40, s42, 131072
    buffer_load_dwordx4 v4, s[8:11], s40 offen lds
    s_add_u32 m0, s7, 61440
    s_add_u32 s40, s42, 196608
    buffer_load_dwordx4 v4, s[8:11], s40 offen lds
    s_add_u32 m0, s7, 65536
    s_add_u32 s40, s41, 0
    buffer_load_dwordx4 v5, s[12:15], s40 offen lds
    s_add_u32 m0, s7, 69632
    s_add_u32 s40, s41, 196608
    buffer_load_dwordx4 v5, s[12:15], s40 offen lds
    s_add_u32 m0, s7, 73728
    s_add_u32 s40, s41, 2048
    buffer_load_dwordx4 v5, s[12:15], s40 offen lds
    s_add_u32 m0, s7, 77824
    s_add_u32 s40, s41, 198656
    buffer_load_dwordx4 v5, s[12:15], s40 offen lds
    s_add_u32 m0, s7, 81920
    s_add_u32 s40, s41, 4096
    buffer_load_dwordx4 v5, s[12:15], s40 offen lds
    s_add_u32 m0, s7, 86016
    s_add_u32 s40, s41, 200704
    buffer_load_dwordx4 v5, s[12:15], s40 offen lds
    s_waitcnt vmcnt(16)
    s_barrier
    s_add_u32 s41, s74, 8
    s_and_b32 s41, s41, 15
    s_lshl_b32 s42, s41, 7
    s_mul_i32 s41, s41, 393216
    s_add_u32 m0, s7, 90112
    s_add_u32 s40, s42, 0
    buffer_load_dwordx4 v4, s[8:11], s40 offen lds
    s_add_u32 m0, s7, 94208
    s_add_u32 s40, s42, 65536
    buffer_load_dwordx4 v4, s[8:11], s40 offen lds
    s_add_u32 m0, s7, 98304
    s_add_u32 s40, s42, 131072
    buffer_load_dwordx4 v4, s[8:11], s40 offen lds
    s_add_u32 m0, s7, 102400
    s_add_u32 s40, s42, 196608
    buffer_load_dwordx4 v4, s[8:11], s40 offen lds
    s_add_u32 m0, s7, 106496
    s_add_u32 s40, s41, 0
    buffer_load_dwordx4 v5, s[12:15], s40 offen lds
    s_add_u32 m0, s7, 110592
    s_add_u32 s40, s41, 196608
    buffer_load_dwordx4 v5, s[12:15], s40 offen lds
    s_add_u32 m0, s7, 114688
    s_add_u32 s40, s41, 2048
    buffer_load_dwordx4 v5, s[12:15], s40 offen lds
    s_add_u32 m0, s7, 118784
    s_add_u32 s40, s41, 198656
    buffer_load_dwordx4 v5, s[12:15], s40 offen lds
    s_add_u32 m0, s7, 122880
    s_add_u32 s40, s41, 4096
    buffer_load_dwordx4 v5, s[12:15], s40 offen lds
    s_add_u32 m0, s7, 126976
    s_add_u32 s40, s41, 200704
    buffer_load_dwordx4 v5, s[12:15], s40 offen lds
    s_waitcnt vmcnt(10)
    s_barrier
    s_add_u32 s41, s74, 9
    s_and_b32 s41, s41, 15
    s_lshl_b32 s42, s41, 7
    s_mul_i32 s41, s41, 393216
    s_add_u32 m0, s7, 8192
    s_add_u32 s40, s42, 0
    buffer_load_dwordx4 v4, s[8:11], s40 offen lds
    s_add_u32 m0, s7, 12288
    s_add_u32 s40, s42, 65536
    buffer_load_dwordx4 v4, s[8:11], s40 offen lds
    s_add_u32 m0, s7, 16384
    s_add_u32 s40, s42, 131072
    buffer_load_dwordx4 v4, s[8:11], s40 offen lds
    s_add_u32 m0, s7, 20480
    s_add_u32 s40, s42, 196608
    buffer_load_dwordx4 v4, s[8:11], s40 offen lds
    s_add_u32 m0, s7, 24576
    s_add_u32 s40, s41, 0
    buffer_load_dwordx4 v5, s[12:15], s40 offen lds
    s_add_u32 m0, s7, 28672
    s_add_u32 s40, s41, 196608
    buffer_load_dwordx4 v5, s[12:15], s40 offen lds
    s_add_u32 m0, s7, 32768
    s_add_u32 s40, s41, 2048
    buffer_load_dwordx4 v5, s[12:15], s40 offen lds
    s_add_u32 m0, s7, 36864
    s_add_u32 s40, s41, 198656
    buffer_load_dwordx4 v5, s[12:15], s40 offen lds
    s_add_u32 m0, s7, 40960
    s_add_u32 s40, s41, 4096
    buffer_load_dwordx4 v5, s[12:15], s40 offen lds
    s_add_u32 m0, s7, 45056
    s_add_u32 s40, s41, 200704
    buffer_load_dwordx4 v5, s[12:15], s40 offen lds
    s_cmp_lg_u32 s6, 0
    s_cbranch_scc1 H_nk
    v_mov_b32 v3, 4224
    ds_read_b128 v[72:75], v3
    ds_read_b128 v[24:27], v3 offset:16
    s_mov_b32 s65, 0
H_nspin:
    v_readfirstlane_b32 s71, v78
    s_cmp_eq_u32 s71, 0
    s_cbranch_scc1 H_nre
H_nok:
    s_lshl_b32 s64, s2, 3
    s_add_u32 s64, s64, 6717440
    v_mov_b32 v3, s64
    s_waitcnt lgkmcnt(0)
    v_max3_u32 v72, v72, v73, v74
    v_max3_u32 v24, v24, v25, v26
    v_max3_u32 v72, v72, v75, v27
    v_max_u32 v72, v72, v24
    v_xor_b32 v73, s71, v72
    s_mov_b64 exec, 1
    buffer_store_dwordx2 v[72:73], v3, s[16:19], 0 offen sc0 sc1
    s_mov_b64 exec, -1
H_nk:
    s_mov_b32 exec_lo, 0x3fff3fff
    s_mov_b32 exec_hi, 0x3fff3fff
    s_mov_b32 s64, 14336
    buffer_load_dwordx4 v[136:139], v11, s[36:39], s64 offen nt
    s_mov_b32 s64, 21504
    buffer_load_dwordx4 v[108:111], v11, s[32:35], s64 offen nt
    s_mov_b32 s64, 21504
    buffer_load_dwordx4 v[140:143], v11, s[36:39], s64 offen nt
    s_mov_b32 s64, 28672
    buffer_load_dwordx4 v[112:115], v11, s[32:35], s64 offen nt
    s_mov_b32 s64, 28672
    buffer_load_dwordx4 v[144:147], v11, s[36:39], s64 offen nt
    s_mov_b64 exec, -1
    s_waitcnt vmcnt(15)
    s_barrier
    s_add_u32 s41, s74, 10
    s_and_b32 s41, s41, 15
    s_lshl_b32 s42, s41, 7
    s_mul_i32 s41, s41, 393216
    s_add_u32 m0, s7, 49152
    s_add_u32 s40, s42, 0
    buffer_load_dwordx4 v4, s[8:11], s40 offen lds
    s_add_u32 m0, s7, 53248
    s_add_u32 s40, s42, 65536
    buffer_load_dwordx4 v4, s[8:11], s40 offen lds
    s_add_u32 m0, s7, 57344
    s_add_u32 s40, s42, 131072
    buffer_load_dwordx4 v4, s[8:11], s40 offen lds
    s_add_u32 m0, s7, 61440
    s_add_u32 s40, s42, 196608
    buffer_load_dwordx4 v4, s[8:11], s40 offen lds
    s_add_u32 m0, s7, 65536
    s_add_u32 s40, s41, 0
    buffer_load_dwordx4 v5, s[12:15], s40 offen lds
    s_add_u32 m0, s7, 69632
    s_add_u32 s40, s41, 196608
    buffer_load_dwordx4 v5, s[12:15], s40 offen lds
    s_add_u32 m0, s7, 73728
    s_add_u32 s40, s41, 2048
    buffer_load_dwordx4 v5, s[12:15], s40 offen lds
    s_add_u32 m0, s7, 77824
    s_add_u32 s40, s41, 198656
    buffer_load_dwordx4 v5, s[12:15], s40 offen lds
    s_add_u32 m0, s7, 81920
    s_add_u32 s40, s41, 4096
    buffer_load_dwordx4 v5, s[12:15], s40 offen lds
    s_add_u32 m0, s7, 86016
    s_add_u32 s40, s41, 200704
    buffer_load_dwordx4 v5, s[12:15], s40 offen lds
    s_lshl_b32 s64, s2, 2
    s_add_u32 s64, s64, s6
    s_mul_i32 s64, s64, 2048
    s_add_u32 s46, s44, s64
    s_addc_u32 s47, s45, 0
    s_load_dword s43, s[46:47], 384
    s_load_dword s43, s[46:47], 448
    s_load_dword s43, s[46:47], 1408
    s_load_dword s43, s[46:47], 1472
    s_waitcnt vmcnt(15)
    s_barrier
    s_add_u32 s41, s74, 11
    s_and_b32 s41, s41, 15
    s_lshl_b32 s42, s41, 7
    s_mul_i32 s41, s41, 393216
    s_add_u32 m0, s7, 90112
    s_add_u32 s40, s42, 0
    buffer_load_dwordx4 v4, s[8:11], s40 offen lds
    s_add_u32 m0, s7, 94208
    s_add_u32 s40, s42, 65536
    buffer_load_dwordx4 v4, s[8:11], s40 offen lds
    s_add_u32 m0, s7, 98304
    s_add_u32 s40, s42, 131072
    buffer_load_dwordx4 v4, s[8:11], s40 offen lds
    s_add_u32 m0, s7, 102400
    s_add_u32 s40, s42, 196608
    buffer_load_dwordx4 v4, s[8:11], s40 offen lds
    s_add_u32 m0, s7, 106496
    s_add_u32 s40, s41, 0
    buffer_load_dwordx4 v5, s[12:15], s40 offen lds
    s_add_u32 m0, s7, 110592
    s_add_u32 s40, s41, 196608
    buffer_load_dwordx4 v5, s[12:15], s40 offen lds
    s_add_u32 m0, s7, 114688
    s_add_u32 s40, s41, 2048
    buffer_load_dwordx4 v5, s[12:15], s40 offen lds
    s_add_u32 m0, s7, 118784
    s_add_u32 s40, s41, 198656
    buffer_load_dwordx4 v5, s[12:15], s40 offen lds
    s_add_u32 m0, s7, 122880
    s_add_u32 s40, s41, 4096
    buffer_load_dwordx4 v5, s[12:15], s40 offen lds
    s_add_u32 m0, s7, 126976
    s_add_u32 s40, s41, 200704
    buffer_load_dwordx4 v5, s[12:15], s40 offen lds
    s_waitcnt vmcnt(10)
    s_barrier
    s_add_u32 s41, s74, 12
    s_and_b32 s41, s41, 15
    s_lshl_b32 s42, s41, 7
    s_mul_i32 s41, s41, 393216
    s_add_u32 m0, s7, 8192
    s_add_u32 s40, s42, 0
    buffer_load_dwordx4 v4, s[8:11], s40 offen lds
    s_add_u32 m0, s7, 12288
    s_add_u32 s40, s42, 65536
    buffer_load_dwordx4 v4, s[8:11], s40 offen lds
    s_add_u32 m0, s7, 16384
    s_add_u32 s40, s42, 131072
    buffer_load_dwordx4 v4, s[8:11], s40 offen lds
    s_add_u32 m0, s7, 20480
    s_add_u32 s40, s42, 196608
    buffer_load_dwordx4 v4, s[8:11], s40 offen lds
    s_add_u32 m0, s7, 24576
    s_add_u32 s40, s41, 0
    buffer_load_dwordx4 v5, s[12:15], s40 offen lds
    s_add_u32 m0, s7, 28672
    s_add_u32 s40, s41, 196608
    buffer_load_dwordx4 v5, s[12:15], s40 offen lds
    s_add_u32 m0, s7, 32768
    s_add_u32 s40, s41, 2048
    buffer_load_dwordx4 v5, s[12:15], s40 offen lds
    s_add_u32 m0, s7, 36864
    s_add_u32 s40, s41, 198656
    buffer_load_dwordx4 v5, s[12:15], s40 offen lds
    s_add_u32 m0, s7, 40960
    s_add_u32 s40, s41, 4096
    buffer_load_dwordx4 v5, s[12:15], s40 offen lds
    s_add_u32 m0, s7, 45056
    s_add_u32 s40, s41, 200704
    buffer_load_dwordx4 v5, s[12:15], s40 offen lds
    s_mov_b32 exec_lo, 0x3fff3fff
    s_mov_b32 exec_hi, 0x3fff3fff
    s_mov_b32 s64, 35840
    buffer_load_dwordx4 v[116:119], v11, s[32:35], s64 offen nt
    s_mov_b32 s64, 35840
    buffer_load_dwordx4 v[148:151], v11, s[36:39], s64 offen nt
    s_mov_b32 s64, 43008
    buffer_load_dwordx4 v[120:123], v11, s[32:35], s64 offen nt
    s_mov_b32 s64, 43008
    buffer_load_dwordx4 v[152:155], v11, s[36:39], s64 offen nt
    s_mov_b32 s64, 50176
    buffer_load_dwordx4 v[124:127], v11, s[32:35], s64 offen nt
    s_mov_b32 s64, 50176
    buffer_load_dwordx4 v[156:159], v11, s[36:39], s64 offen nt
    s_mov_b64 exec, -1
    s_waitcnt vmcnt(16)
    s_barrier
    s_cmp_lg_u32 s6, 0
    s_cbranch_scc1 H_np
    s_mov_b32 s64, 6717440
    buffer_load_dwordx4 v[24:27], v6, s[16:19], s64 offen offset:0 sc1
    buffer_load_dwordx4 v[28:31], v6, s[16:19], s64 offen offset:1024 sc1
H_np:
    s_add_u32 s41, s74, 13
    s_and_b32 s41, s41, 15
    s_lshl_b32 s42, s41, 7
    s_mul_i32 s41, s41, 393216
    s_add_u32 m0, s7, 49152
    s_add_u32 s40, s42, 0
    buffer_load_dwordx4 v4, s[8:11], s40 offen lds
    s_add_u32 m0, s7, 53248
    s_add_u32 s40, s42, 65536
    buffer_load_dwordx4 v4, s[8:11], s40 offen lds
    s_add_u32 m0, s7, 57344
    s_add_u32 s40, s42, 131072
    buffer_load_dwordx4 v4, s[8:11], s40 offen lds
    s_add_u32 m0, s7, 61440
    s_add_u32 s40, s42, 196608
    buffer_load_dwordx4 v4, s[8:11], s40 offen lds
    s_add_u32 m0, s7, 65536
    s_add_u32 s40, s41, 0
    buffer_load_dwordx4 v5, s[12:15], s40 offen lds
    s_add_u32 m0, s7, 69632
    s_add_u32 s40, s41, 196608
    buffer_load_dwordx4 v5, s[12:15], s40 offen lds
    s_add_u32 m0, s7, 73728
    s_add_u32 s40, s41, 2048
    buffer_load_dwordx4 v5, s[12:15], s40 offen lds
    s_add_u32 m0, s7, 77824
    s_add_u32 s40, s41, 198656
    buffer_load_dwordx4 v5, s[12:15], s40 offen lds
    s_add_u32 m0, s7, 81920
    s_add_u32 s40, s41, 4096
    buffer_load_dwordx4 v5, s[12:15], s40 offen lds
    s_add_u32 m0, s7, 86016
    s_add_u32 s40, s41, 200704
    buffer_load_dwordx4 v5, s[12:15], s40 offen lds
    s_waitcnt vmcnt(16)
    s_barrier
    s_cmp_lg_u32 s6, 0
    s_cbranch_scc1 H_nq
    s_waitcnt vmcnt(10)
    s_mov_b32 s65, 0
H_spin:
    v_xor_b32 v25, v24, v25
    v_xor_b32 v27, v26, v27
    v_xor_b32 v29, v28, v29
    v_xor_b32 v31, v30, v31
    v_xor_b32 v3, s71, v25
    v_xor_b32 v7, s71, v27
    v_xor_b32 v25, s71, v29
    v_xor_b32 v27, s71, v31
    v_or3_b32 v3, v3, v7, v25
    v_or_b32 v3, v3, v27
    v_cmp_ne_u32 vcc, 0, v3
    s_cbranch_vccnz H_retry
H_nq:
    s_add_u32 s41, s74, 14
    s_and_b32 s41, s41, 15
    s_lshl_b32 s42, s41, 7
    s_mul_i32 s41, s41, 393216
    s_add_u32 m0, s7, 90112
    s_add_u32 s40, s42, 0
    buffer_load_dwordx4 v4, s[8:11], s40 offen lds
    v_max_u32 v3, v24, v26
    v_max3_u32 v3, v3, v28, v30
    s_nop 1
    v_max_u32_dpp v3, v3, v3 quad_perm:[1,0,3,2] row_mask:0xf bank_mask:0xf
    s_add_u32 m0, s7, 94208
    s_add_u32 s40, s42, 65536
    buffer_load_dwordx4 v4, s[8:11], s40 offen lds
    s_nop 1
    v_max_u32_dpp v3, v3, v3 quad_perm:[2,3,0,1] row_mask:0xf bank_mask:0xf
    s_nop 1
    v_max_u32_dpp v3, v3, v3 row_half_mirror row_mask:0xf bank_mask:0xf
    s_add_u32 m0, s7, 98304
    s_add_u32 s40, s42, 131072
    buffer_load_dwordx4 v4, s[8:11], s40 offen lds
    s_nop 1
    v_max_u32_dpp v3, v3, v3 row_mirror row_mask:0xf bank_mask:0xf
    s_nop 1
    v_mov_b32 v7, v3
    s_add_u32 m0, s7, 102400
    s_add_u32 s40, s42, 196608
    buffer_load_dwordx4 v4, s[8:11], s40 offen lds
    s_nop 1
    v_permlane16_swap_b32 v3, v7
    v_max_u32 v3, v3, v7
    v_mov_b32 v7, v3
    s_add_u32 m0, s7, 106496
    s_add_u32 s40, s41, 0
    buffer_load_dwordx4 v5, s[12:15], s40 offen lds
    s_nop 1
    v_permlane32_swap_b32 v3, v7
    v_max_u32 v3, v3, v7
    v_mov_b32 v7, 4256
    s_add_u32 m0, s7, 110592
    s_add_u32 s40, s41, 196608
    buffer_load_dwordx4 v5, s[12:15], s40 offen lds
    s_add_u32 m0, s7, 114688
    s_add_u32 s40, s41, 2048
    buffer_load_dwordx4 v5, s[12:15], s40 offen lds
    s_add_u32 m0, s7, 118784
    s_add_u32 s40, s41, 198656
    buffer_load_dwordx4 v5, s[12:15], s40 offen lds
    s_add_u32 m0, s7, 122880
    s_add_u32 s40, s41, 4096
    buffer_load_dwordx4 v5, s[12:15], s40 offen lds
    s_add_u32 m0, s7, 126976
    s_add_u32 s40, s41, 200704
    buffer_load_dwordx4 v5, s[12:15], s40 offen lds
    s_cmp_lg_u32 s6, 0
    s_cbranch_scc1 H_nw
    ds_write_b32 v7, v3
H_nw:
    s_waitcnt vmcnt(10)
    s_waitcnt lgkmcnt(0)
    s_barrier
    v_mov_b32 v7, 4256
    ds_read_b32 v3, v7
    s_lshl_b32 s65, s69, 6
    v_lshl_add_u32 v7, v8, 4, s65
    s_waitcnt lgkmcnt(0)
    v_readfirstlane_b32 s75, v3
    s_nop 3
    s_and_b32 s64, s75, 0x7ff
    s_sub_u32 s64, 2047, s64
    s_lshl_b32 s64, s64, 11
    buffer_load_dwordx4 v[88:91], v7, s[8:11], s64 offen
    s_add_u32 s41, s74, 15
    s_and_b32 s41, s41, 15
    s_lshl_b32 s42, s41, 7
    s_mul_i32 s41, s41, 393216
    s_add_u32 m0, s7, 8192
    s_add_u32 s40, s42, 0
    buffer_load_dwordx4 v4, s[8:11], s40 offen lds
    s_add_u32 m0, s7, 12288
    s_add_u32 s40, s42, 65536
    buffer_load_dwordx4 v4, s[8:11], s40 offen lds
    s_add_u32 m0, s7, 16384
    s_add_u32 s40, s42, 131072
    buffer_load_dwordx4 v4, s[8:11], s40 offen lds
    s_add_u32 m0, s7, 20480
    s_add_u32 s40, s42, 196608
    buffer_load_dwordx4 v4, s[8:11], s40 offen lds
    s_add_u32 m0, s7, 24576
    s_add_u32 s40, s41, 0
    buffer_load_dwordx4 v5, s[12:15], s40 offen lds
    s_add_u32 m0, s7, 28672
    s_add_u32 s40, s41, 196608
    buffer_load_dwordx4 v5, s[12:15], s40 offen lds
    s_add_u32 m0, s7, 32768
    s_add_u32 s40, s41, 2048
    buffer_load_dwordx4 v5, s[12:15], s40 offen lds
    s_add_u32 m0, s7, 36864
    s_add_u32 s40, s41, 198656
    buffer_load_dwordx4 v5, s[12:15], s40 offen lds
    s_add_u32 m0, s7, 40960
    s_add_u32 s40, s41, 4096
    buffer_load_dwordx4 v5, s[12:15], s40 offen lds
    s_add_u32 m0, s7, 45056
    s_add_u32 s40, s41, 200704
    buffer_load_dwordx4 v5, s[12:15], s40 offen lds
    s_mov_b32 s24, s54
    s_mov_b32 s25, s55
    s_mov_b32 s26, 0x700000
    s_mov_b32 s27, 0x00020000
    s_lshr_b32 s64, s2, 2
    s_mul_i32 s64, s64, 114688
    s_and_b32 s65, s2, 3
    s_lshl_b32 s65, s65, 9
    s_add_u32 s64, s64, s65
    s_lshl_b32 s65, s6, 7
    s_add_u32 s64, s64, s65
    v_lshrrev_b32 v7, 3, v2
    v_lshlrev_b32 v7, 11, v7
    v_and_b32 v9, 7, v2
    v_lshl_add_u32 v7, v9, 4, v7
    v_add_u32 v21, s64, v7
    s_mov_b32 s64, 0
    buffer_load_dwordx4 v[192:195], v21, s[24:27], s64 offen nt
    s_mov_b32 s64, 16384
    buffer_load_dwordx4 v[196:199], v21, s[24:27], s64 offen nt
    s_mov_b32 s64, 32768
    buffer_load_dwordx4 v[200:203], v21, s[24:27], s64 offen nt
    s_mov_b32 s64, 49152
    buffer_load_dwordx4 v[204:207], v21, s[24:27], s64 offen nt
    s_mov_b32 s64, 65536
    buffer_load_dwordx4 v[208:211], v21, s[24:27], s64 offen nt
    s_mov_b32 s64, 81920
    buffer_load_dwordx4 v[212:215], v21, s[24:27], s64 offen nt
    s_mov_b32 s64, 98304
    buffer_load_dwordx4 v[216:219], v21, s[24:27], s64 offen nt
    s_waitcnt vmcnt(18)
    s_barrier
    s_waitcnt vmcnt(17)
    s_and_b32 s64, s2, 7
    s_lshr_b32 s65, s2, 3
    s_and_b32 s4, s64, 3
    s_lshl_b32 s4, s4, 2
    s_and_b32 s66, s65, 3
    s_add_u32 s4, s4, s66
    s_lshr_b32 s5, s64, 2
    s_lshl_b32 s5, s5, 3
    s_lshr_b32 s66, s65, 2
    s_add_u32 s5, s5, s66
    s_mov_b32 s28, s44
    s_mov_b32 s29, s45
    s_mov_b32 s30, 0x200000
    s_mov_b32 s31, 0x00020000
    v_lshrrev_b32 v7, 3, v2
    s_lshl_b32 s64, s6, 3
    v_add_u32 v7, s64, v7
    v_lshlrev_b32 v7, 11, v7
    v_lshrrev_b32 v9, 4, v2
    v_lshlrev_b32 v9, 1, v9
    v_and_b32 v10, 7, v2
    v_xor_b32 v9, v9, v10
    v_lshl_add_u32 v7, v9, 4, v7
    s_lshl_b32 s64, s5, 7
    v_add_u32 v10, s64, v7
    s_add_u32 m0, s7, 131072
    s_mov_b32 s40, 0
    buffer_load_dwordx4 v10, s[28:31], s40 offen lds
    v_and_b32 v48, 15, v2
    v_and_b32 v49, 1, v2
    v_lshlrev_b32 v49, 4, v49
    v_mov_b32 v50, 0xffff
    v_lshlrev_b32 v49, v49, v50
    v_lshrrev_b32 v48, 1, v48
    v_cmp_eq_u32 vcc, 0, v48
    s_nop 1
    v_cndmask_b32 v40, 0, v49, vcc
    v_cmp_eq_u32 vcc, 1, v48
    s_nop 1
    v_cndmask_b32 v41, 0, v49, vcc
    v_cmp_eq_u32 vcc, 2, v48
    s_nop 1
    v_cndmask_b32 v42, 0, v49, vcc
    v_cmp_eq_u32 vcc, 3, v48
    s_nop 1
    v_cndmask_b32 v43, 0, v49, vcc
    s_mov_b32 s64, 0x01000100
    s_mov_b32 s65, 0x03020302
    v_perm_b32 v48, v88, v88, s64
    v_and_b32 v44, v48, v40
    v_and_b32 v45, v48, v41
    v_and_b32 v46, v48, v42
    s_add_u32 m0, s7, 135168
    s_mov_b32 s40, 65536
    buffer_load_dwordx4 v10, s[28:31], s40 offen lds
    v_and_b32 v47, v48, v43
    s_nop 1
    v_mfma_f32_16x16x32_bf16 v[32:35], v[44:47], v[96:99], 0
    v_mfma_f32_16x16x32_bf16 v[36:39], v[44:47], v[128:131], 0
    v_perm_b32 v48, v88, v88, s65
    v_and_b32 v52, v48, v40
    v_and_b32 v53, v48, v41
    v_and_b32 v54, v48, v42
    v_and_b32 v55, v48, v43
    s_nop 1
    v_mfma_f32_16x16x32_bf16 v[32:35], v[52:55], v[100:103], v[32:35]
    v_mfma_f32_16x16x32_bf16 v[36:39], v[52:55], v[132:135], v[36:39]
    v_perm_b32 v48, v89, v89, s64
    v_and_b32 v44, v48, v40
    v_and_b32 v45, v48, v41
    v_and_b32 v46, v48, v42
    v_and_b32 v47, v48, v43
    s_nop 1
    v_mfma_f32_16x16x32_bf16 v[32:35], v[44:47], v[104:107], v[32:35]
    v_mfma_f32_16x16x32_bf16 v[36:39], v[44:47], v[136:139], v[36:39]
    v_perm_b32 v48, v89, v89, s65
    v_and_b32 v52, v48, v40
    v_and_b32 v53, v48, v41
    v_and_b32 v54, v48, v42
    s_add_u32 m0, s7, 147456
    s_mov_b32 s40, 1048576
    buffer_load_dwordx4 v10, s[28:31], s40 offen lds
    v_and_b32 v55, v48, v43
    s_nop 1
    v_mfma_f32_16x16x32_bf16 v[32:35], v[52:55], v[108:111], v[32:35]
    v_mfma_f32_16x16x32_bf16 v[36:39], v[52:55], v[140:143], v[36:39]
    v_perm_b32 v48, v90, v90, s64
    v_and_b32 v44, v48, v40
    v_and_b32 v45, v48, v41
    v_and_b32 v46, v48, v42
    v_and_b32 v47, v48, v43
    s_nop 1
    v_mfma_f32_16x16x32_bf16 v[32:35], v[44:47], v[112:115], v[32:35]
    v_mfma_f32_16x16x32_bf16 v[36:39], v[44:47], v[144:147], v[36:39]
    v_perm_b32 v48, v90, v90, s65
    v_and_b32 v52, v48, v40
    v_and_b32 v53, v48, v41
    v_and_b32 v54, v48, v42
    v_and_b32 v55, v48, v43
    s_nop 1
    v_mfma_f32_16x16x32_bf16 v[32:35], v[52:55], v[116:119], v[32:35]
    v_mfma_f32_16x16x32_bf16 v[36:39], v[52:55], v[148:151], v[36:39]
    v_perm_b32 v48, v91, v91, s64
    v_and_b32 v44, v48, v40
    v_and_b32 v45, v48, v41
    v_and_b32 v46, v48, v42
    s_add_u32 m0, s7, 151552
    s_mov_b32 s40, 1114112
    buffer_load_dwordx4 v10, s[28:31], s40 offen lds
    v_and_b32 v47, v48, v43
    s_nop 1
    v_mfma_f32_16x16x32_bf16 v[32:35], v[44:47], v[120:123], v[32:35]
    v_mfma_f32_16x16x32_bf16 v[36:39], v[44:47], v[152:155], v[36:39]
    v_perm_b32 v48, v91, v91, s65
    v_and_b32 v52, v48, v40
    v_and_b32 v53, v48, v41
    v_and_b32 v54, v48, v42
    v_and_b32 v55, v48, v43
    s_nop 1
    v_mfma_f32_16x16x32_bf16 v[32:35], v[52:55], v[124:127], v[32:35]
    v_mfma_f32_16x16x32_bf16 v[36:39], v[52:55], v[156:159], v[36:39]
    s_nop 7
    v_permlane32_swap_b32 v32, v36
    v_permlane32_swap_b32 v33, v37
    v_permlane32_swap_b32 v34, v38
    v_permlane32_swap_b32 v35, v39
    s_mov_b32 exec_lo, 0x3fff3fff
    s_mov_b32 exec_hi, 0x3fff3fff
    buffer_store_dwordx4 v[32:35], v12, s[16:19], 0 offen sc0 sc1
    s_mov_b64 exec, -1
    s_waitcnt vmcnt(12)
    s_barrier
    s_add_u32 m0, s7, 139264
    s_mov_b32 s40, 131072
    buffer_load_dwordx4 v10, s[28:31], s40 offen lds
    s_add_u32 m0, s7, 143360
    s_mov_b32 s40, 196608
    buffer_load_dwordx4 v10, s[28:31], s40 offen lds
    s_add_u32 m0, s7, 155648
    s_mov_b32 s40, 1179648
    buffer_load_dwordx4 v10, s[28:31], s40 offen lds
    s_add_u32 m0, s7, 159744
    s_mov_b32 s40, 1245184
    buffer_load_dwordx4 v10, s[28:31], s40 offen lds
    s_add_u32 m0, s7, 73728
    s_mov_b32 s40, 262144
    buffer_load_dwordx4 v10, s[28:31], s40 offen lds
    s_add_u32 m0, s7, 77824
    s_mov_b32 s40, 327680
    buffer_load_dwordx4 v10, s[28:31], s40 offen lds
    s_add_u32 m0, s7, 81920
    s_mov_b32 s40, 1310720
    buffer_load_dwordx4 v10, s[28:31], s40 offen lds
    s_add_u32 m0, s7, 86016
    s_mov_b32 s40, 1376256
    buffer_load_dwordx4 v10, s[28:31], s40 offen lds
    s_barrier
    s_and_b32 s64, s3, 3
    s_lshl_b32 s64, s64, 1
    s_lshr_b32 s65, s3, 2
    s_add_u32 s64, s64, s65
    s_lshl_b32 s64, s64, 4
    s_lshl_b32 s65, s4, 7
    s_add_u32 s64, s64, s65
    v_and_b32 v230, 15, v2
    v_add_u32 v230, s64, v230
    v_bfe_u32 v3, v2, 4, 1
    v_lshlrev_b32 v229, 5, v3
    v_lshrrev_b32 v3, 5, v2
    v_lshl_add_u32 v229, v3, 4, v229
    v_lshl_add_u32 v231, v230, 11, v229
    s_lshl_b32 s64, s5, 7
    v_add_u32 v231, s64, v231
    v_lshlrev_b32 v3, 2, v230
    v_add_u32 v3, 6709248, v3
    buffer_load_dwordx4 v[220:223], v231, s[8:11], 0 offen
    buffer_load_dwordx4 v[224:227], v231, s[8:11], 0 offen offset:64
    buffer_load_dword v228, v3, s[16:19], 0 offen sc1
    s_add_u32 m0, s7, 114688
    s_mov_b32 s40, 393216
    buffer_load_dwordx4 v10, s[28:31], s40 offen lds
    s_add_u32 m0, s7, 118784
    s_mov_b32 s40, 458752
    buffer_load_dwordx4 v10, s[28:31], s40 offen lds
    s_add_u32 m0, s7, 122880
    s_mov_b32 s40, 1441792
    buffer_load_dwordx4 v10, s[28:31], s40 offen lds
    s_add_u32 m0, s7, 126976
    s_mov_b32 s40, 1507328
    buffer_load_dwordx4 v10, s[28:31], s40 offen lds
    s_add_u32 m0, s7, 40960
    s_mov_b32 s40, 524288
    buffer_load_dwordx4 v10, s[28:31], s40 offen lds
    s_add_u32 m0, s7, 45056
    s_mov_b32 s40, 589824
    buffer_load_dwordx4 v10, s[28:31], s40 offen lds
    s_add_u32 m0, s7, 49152
    s_mov_b32 s40, 1572864
    buffer_load_dwordx4 v10, s[28:31], s40 offen lds
    s_add_u32 m0, s7, 53248
    s_mov_b32 s40, 1638400
    buffer_load_dwordx4 v10, s[28:31], s40 offen lds
    s_add_u32 m0, s7, 8192
    s_mov_b32 s40, 655360
    buffer_load_dwordx4 v10, s[28:31], s40 offen lds
    s_add_u32 m0, s7, 12288
    s_mov_b32 s40, 720896
    buffer_load_dwordx4 v10, s[28:31], s40 offen lds
    s_add_u32 m0, s7, 57344
    s_mov_b32 s40, 1703936
    buffer_load_dwordx4 v10, s[28:31], s40 offen lds
    s_add_u32 m0, s7, 61440
    s_mov_b32 s40, 1769472
    buffer_load_dwordx4 v10, s[28:31], s40 offen lds
    s_add_u32 m0, s7, 16384
    s_mov_b32 s40, 786432
    buffer_load_dwordx4 v10, s[28:31], s40 offen lds
    s_add_u32 m0, s7, 20480
    s_mov_b32 s40, 851968
    buffer_load_dwordx4 v10, s[28:31], s40 offen lds
    s_add_u32 m0, s7, 65536
    s_mov_b32 s40, 1835008
    buffer_load_dwordx4 v10, s[28:31], s40 offen lds
    s_add_u32 m0, s7, 69632
    s_mov_b32 s40, 1900544
    buffer_load_dwordx4 v10, s[28:31], s40 offen lds
    s_add_u32 m0, s7, 98304
    s_mov_b32 s40, 917504
    buffer_load_dwordx4 v10, s[28:31], s40 offen lds
    s_add_u32 m0, s7, 102400
    s_mov_b32 s40, 983040
    buffer_load_dwordx4 v10, s[28:31], s40 offen lds
    s_add_u32 m0, s7, 90112
    s_mov_b32 s40, 1966080
    buffer_load_dwordx4 v10, s[28:31], s40 offen lds
    s_add_u32 m0, s7, 94208
    s_mov_b32 s40, 2031616
    buffer_load_dwordx4 v10, s[28:31], s40 offen lds
    s_mov_b64 exec, 1
    v_mov_b32 v20, 0
    buffer_atomic_or v20, v23, s[16:19], 0 offen sc0
    s_mov_b64 exec, -1
    v_lshlrev_b32 v17, 4, v2
    v_add_u32 v17, s70, v17
    v_lshrrev_b32 v18, 2, v2
    v_mul_u32_u24 v18, 1152, v18
    v_and_b32 v19, 3, v2
    v_lshl_add_u32 v18, v19, 4, v18
    s_add_u32 s64, s70, 1024
    v_add_u32 v18, s64, v18
    v_bfe_u32 v26, v2, 3, 1
    v_lshl_add_u32 v26, v26, 2, v19
    v_bfe_u32 v27, v2, 2, 1
    v_lshrrev_b32 v28, 5, v2
    v_cmp_eq_u32 vcc, v27, v28
    v_and_b32 v27, 16, v2
    v_cmp_eq_u32 s[64:65], 0, v27
    s_and_b64 vcc, vcc, s[64:65]
    v_and_b32 v27, 1, v26
    v_lshlrev_b32 v27, 4, v27
    v_mov_b32 v28, 0x3f80
    v_lshlrev_b32 v27, v27, v28
    v_cndmask_b32 v27, 0, v27, vcc
    v_lshrrev_b32 v26, 1, v26
    v_cmp_eq_u32 vcc, 0, v26
    s_nop 1
    v_cndmask_b32 v48, 0, v27, vcc
    v_cmp_eq_u32 vcc, 1, v26
    s_nop 1
    v_cndmask_b32 v49, 0, v27, vcc
    v_cmp_eq_u32 vcc, 2, v26
    s_nop 1
    v_cndmask_b32 v50, 0, v27, vcc
    v_cmp_eq_u32 vcc, 3, v26
    s_nop 1
    v_cndmask_b32 v51, 0, v27, vcc
    v_mov_b32 v128, 0
    v_mov_b32 v129, 0
    v_mov_b32 v130, 0
    v_mov_b32 v131, 0
    v_mov_b32 v132, 0
    v_mov_b32 v133, 0
    v_mov_b32 v134, 0
    v_mov_b32 v135, 0
    v_mov_b32 v136, 0
    v_mov_b32 v137, 0
    v_mov_b32 v138, 0
    v_mov_b32 v139, 0
    v_mov_b32 v140, 0
    v_mov_b32 v141, 0
    v_mov_b32 v142, 0
    v_mov_b32 v143, 0
    s_mov_b32 s66, 0xffff
    s_mov_b32 s65, 0
    s_waitcnt vmcnt(21)
    v_sub_f32 v248, 1.0, v228
    v_cvt_pk_bf16_f32 v248, v248, v248
    v_lshlrev_b32 v248, 16, v248
    v_lshlrev_b32 v232, 16, v220
    v_and_b32 v233, 0xffff0000, v220
    v_mul_f32 v232, v232, v248
    v_mul_f32 v233, v233, v248
    v_cvt_pk_bf16_f32 v3, v232, v233
    v_lshlrev_b32 v232, 16, v3
    v_and_b32 v233, 0xffff0000, v3
    v_lshlrev_b32 v234, 16, v221
    v_and_b32 v235, 0xffff0000, v221
    v_mul_f32 v234, v234, v248
    v_mul_f32 v235, v235, v248
    v_cvt_pk_bf16_f32 v3, v234, v235
    v_lshlrev_b32 v234, 16, v3
    v_and_b32 v235, 0xffff0000, v3
    v_lshlrev_b32 v236, 16, v222
    v_and_b32 v237, 0xffff0000, v222
    v_mul_f32 v236, v236, v248
    v_mul_f32 v237, v237, v248
    v_cvt_pk_bf16_f32 v3, v236, v237
    v_lshlrev_b32 v236, 16, v3
    v_and_b32 v237, 0xffff0000, v3
    v_lshlrev_b32 v238, 16, v223
    v_and_b32 v239, 0xffff0000, v223
    v_mul_f32 v238, v238, v248
    v_mul_f32 v239, v239, v248
    v_cvt_pk_bf16_f32 v3, v238, v239
    v_lshlrev_b32 v238, 16, v3
    v_and_b32 v239, 0xffff0000, v3
    v_lshlrev_b32 v240, 16, v224
    v_and_b32 v241, 0xffff0000, v224
    v_mul_f32 v240, v240, v248
    v_mul_f32 v241, v241, v248
    v_cvt_pk_bf16_f32 v3, v240, v241
    v_lshlrev_b32 v240, 16, v3
    v_and_b32 v241, 0xffff0000, v3
    v_lshlrev_b32 v242, 16, v225
    v_and_b32 v243, 0xffff0000, v225
    v_mul_f32 v242, v242, v248
    v_mul_f32 v243, v243, v248
    v_cvt_pk_bf16_f32 v3, v242, v243
    v_lshlrev_b32 v242, 16, v3
    v_and_b32 v243, 0xffff0000, v3
    v_lshlrev_b32 v244, 16, v226
    v_and_b32 v245, 0xffff0000, v226
    v_mul_f32 v244, v244, v248
    v_mul_f32 v245, v245, v248
    v_cvt_pk_bf16_f32 v3, v244, v245
    v_lshlrev_b32 v244, 16, v3
    v_and_b32 v245, 0xffff0000, v3
    v_lshlrev_b32 v246, 16, v227
    v_and_b32 v247, 0xffff0000, v227
    v_mul_f32 v246, v246, v248
    v_mul_f32 v247, v247, v248
    v_cvt_pk_bf16_f32 v3, v246, v247
    v_lshlrev_b32 v246, 16, v3
    v_and_b32 v247, 0xffff0000, v3
    s_waitcnt vmcnt(0)
G_loop:
    v_readfirstlane_b32 s68, v20
    s_and_b32 s68, s68, s66
    s_andn2_b32 s66, s66, s68
    s_bcnt1_i32_b32 s67, s68
    s_cmp_eq_u32 s67, 0
    s_cbranch_scc1 G_l0
    s_cmp_gt_u32 s67, 8
    s_cbranch_scc1 G_lt_2
    s_cmp_gt_u32 s67, 4
    s_cbranch_scc1 G_lt_3
    s_cmp_gt_u32 s67, 2
    s_cbranch_scc1 G_lt_4
    s_cmp_eq_u32 s67, 1
    s_cbranch_scc1 G_l1
    s_branch G_l2
G_lt_4:
    s_cmp_eq_u32 s67, 3
    s_cbranch_scc1 G_l3
    s_branch G_l4
G_lt_3:
    s_cmp_gt_u32 s67, 6
    s_cbranch_scc1 G_lt_5
    s_cmp_eq_u32 s67, 5
    s_cbranch_scc1 G_l5
    s_branch G_l6
G_lt_5:
    s_cmp_eq_u32 s67, 7
    s_cbranch_scc1 G_l7
    s_branch G_l8
G_lt_2:
    s_cmp_gt_u32 s67, 12
    s_cbranch_scc1 G_lt_6
    s_cmp_gt_u32 s67, 10
    s_cbranch_scc1 G_lt_7
    s_cmp_eq_u32 s67, 9
    s_cbranch_scc1 G_l9
    s_branch G_l10
G_lt_7:
    s_cmp_eq_u32 s67, 11
    s_cbranch_scc1 G_l11
    s_branch G_l12
G_lt_6:
    s_cmp_gt_u32 s67, 14
    s_cbranch_scc1 G_lt_8
    s_cmp_eq_u32 s67, 13
    s_cbranch_scc1 G_l13
    s_branch G_l14
G_lt_8:
    s_cmp_eq_u32 s67, 15
    s_cbranch_scc1 G_l15
G_l16:
    s_ff1_i32_b32 s55, s68
    s_bitset0_b32 s68, s55
    s_mul_i32 s64, s55, 1152
    buffer_load_dwordx4 v[124:127], v17, s[16:19], s64 offen sc1
G_l15:
    s_ff1_i32_b32 s54, s68
    s_bitset0_b32 s68, s54
    s_mul_i32 s64, s54, 1152
    buffer_load_dwordx4 v[120:123], v17, s[16:19], s64 offen sc1
G_l14:
    s_ff1_i32_b32 s53, s68
    s_bitset0_b32 s68, s53
    s_mul_i32 s64, s53, 1152
    buffer_load_dwordx4 v[116:119], v17, s[16:19], s64 offen sc1
G_l13:
    s_ff1_i32_b32 s52, s68
    s_bitset0_b32 s68, s52
    s_mul_i32 s64, s52, 1152
    buffer_load_dwordx4 v[112:115], v17, s[16:19], s64 offen sc1
G_l12:
    s_ff1_i32_b32 s51, s68
    s_bitset0_b32 s68, s51
    s_mul_i32 s64, s51, 1152
    buffer_load_dwordx4 v[108:111], v17, s[16:19], s64 offen sc1
G_l11:
    s_ff1_i32_b32 s50, s68
    s_bitset0_b32 s68, s50
    s_mul_i32 s64, s50, 1152
    buffer_load_dwordx4 v[104:107], v17, s[16:19], s64 offen sc1
G_l10:
    s_ff1_i32_b32 s49, s68
    s_bitset0_b32 s68, s49
    s_mul_i32 s64, s49, 1152
    buffer_load_dwordx4 v[100:103], v17, s[16:19], s64 offen sc1
G_l9:
    s_ff1_i32_b32 s48, s68
    s_bitset0_b32 s68, s48
    s_mul_i32 s64, s48, 1152
    buffer_load_dwordx4 v[96:99], v17, s[16:19], s64 offen sc1
G_l8:
    s_ff1_i32_b32 s47, s68
    s_bitset0_b32 s68, s47
    s_mul_i32 s64, s47, 1152
    buffer_load_dwordx4 v[92:95], v17, s[16:19], s64 offen sc1
G_l7:
    s_ff1_i32_b32 s46, s68
    s_bitset0_b32 s68, s46
    s_mul_i32 s64, s46, 1152
    buffer_load_dwordx4 v[88:91], v17, s[16:19], s64 offen sc1
G_l6:
    s_ff1_i32_b32 s45, s68
    s_bitset0_b32 s68, s45
    s_mul_i32 s64, s45, 1152
    buffer_load_dwordx4 v[84:87], v17, s[16:19], s64 offen sc1
G_l5:
    s_ff1_i32_b32 s44, s68
    s_bitset0_b32 s68, s44
    s_mul_i32 s64, s44, 1152
    buffer_load_dwordx4 v[80:83], v17, s[16:19], s64 offen sc1
G_l4:
    s_ff1_i32_b32 s43, s68
    s_bitset0_b32 s68, s43
    s_mul_i32 s64, s43, 1152
    buffer_load_dwordx4 v[76:79], v17, s[16:19], s64 offen sc1
G_l3:
    s_ff1_i32_b32 s42, s68
    s_bitset0_b32 s68, s42
    s_mul_i32 s64, s42, 1152
    buffer_load_dwordx4 v[72:75], v17, s[16:19], s64 offen sc1
G_l2:
    s_ff1_i32_b32 s41, s68
    s_bitset0_b32 s68, s41
    s_mul_i32 s64, s41, 1152
    buffer_load_dwordx4 v[68:71], v17, s[16:19], s64 offen sc1
G_l1:
    s_ff1_i32_b32 s40, s68
    s_bitset0_b32 s68, s40
    s_mul_i32 s64, s40, 1152
    buffer_load_dwordx4 v[64:67], v17, s[16:19], s64 offen sc1
G_l0:
    s_mov_b32 s68, s66
    s_cmp_eq_u32 s66, 0
    s_cbranch_scc1 G_z
    s_cmp_lg_u32 s67, 0
    s_cbranch_scc1 G_p
    s_sleep 2
G_p:
    s_mov_b64 exec, 1
    v_mov_b32 v20, 0
    buffer_atomic_or v20, v23, s[16:19], 0 offen sc0
    s_mov_b64 exec, -1
    s_branch G_proc
G_z:
    buffer_load_dwordx4 v[56:59], v18, s[16:19], 0 offen sc1
G_proc:
    s_cmp_eq_u32 s67, 0
    s_cbranch_scc1 G_q0
    s_cmp_gt_u32 s67, 8
    s_cbranch_scc1 G_qt_9
    s_cmp_gt_u32 s67, 4
    s_cbranch_scc1 G_qt_10
    s_cmp_gt_u32 s67, 2
    s_cbranch_scc1 G_qt_11
    s_cmp_eq_u32 s67, 1
    s_cbranch_scc1 G_q1
    s_branch G_q2
G_qt_11:
    s_cmp_eq_u32 s67, 3
    s_cbranch_scc1 G_q3
    s_branch G_q4
G_qt_10:
    s_cmp_gt_u32 s67, 6
    s_cbranch_scc1 G_qt_12
    s_cmp_eq_u32 s67, 5
    s_cbranch_scc1 G_q5
    s_branch G_q6
G_qt_12:
    s_cmp_eq_u32 s67, 7
    s_cbranch_scc1 G_q7
    s_branch G_q8
G_qt_9:
    s_cmp_gt_u32 s67, 12
    s_cbranch_scc1 G_qt_13
    s_cmp_gt_u32 s67, 10
    s_cbranch_scc1 G_qt_14
    s_cmp_eq_u32 s67, 9
    s_cbranch_scc1 G_q9
    s_branch G_q10
G_qt_14:
    s_cmp_eq_u32 s67, 11
    s_cbranch_scc1 G_q11
    s_branch G_q12
G_qt_13:
    s_cmp_gt_u32 s67, 14
    s_cbranch_scc1 G_qt_15
    s_cmp_eq_u32 s67, 13
    s_cbranch_scc1 G_q13
    s_branch G_q14
G_qt_15:
    s_cmp_eq_u32 s67, 15
    s_cbranch_scc1 G_q15
G_q16:
    s_waitcnt vmcnt(16)
    v_max3_u32 v21, v124, v125, v126
    v_max_u32 v21, v21, v127
    v_cmp_eq_u32 vcc, -1, v21
    s_cbranch_vccnz G_f15
    v_mfma_f32_32x32x16_bf16 v[128:143], v[48:51], v[124:127], v[128:143]
G_q15:
    s_waitcnt vmcnt(15)
    v_max3_u32 v21, v120, v121, v122
    v_max_u32 v21, v21, v123
    v_cmp_eq_u32 vcc, -1, v21
    s_cbranch_vccnz G_f14
    v_mfma_f32_32x32x16_bf16 v[128:143], v[48:51], v[120:123], v[128:143]
G_q14:
    s_waitcnt vmcnt(14)
    v_max3_u32 v21, v116, v117, v118
    v_max_u32 v21, v21, v119
    v_cmp_eq_u32 vcc, -1, v21
    s_cbranch_vccnz G_f13
    v_mfma_f32_32x32x16_bf16 v[128:143], v[48:51], v[116:119], v[128:143]
G_q13:
    s_waitcnt vmcnt(13)
    v_max3_u32 v21, v112, v113, v114
    v_max_u32 v21, v21, v115
    v_cmp_eq_u32 vcc, -1, v21
    s_cbranch_vccnz G_f12
    v_mfma_f32_32x32x16_bf16 v[128:143], v[48:51], v[112:115], v[128:143]
G_q12:
    s_waitcnt vmcnt(12)
    v_max3_u32 v21, v108, v109, v110
    v_max_u32 v21, v21, v111
    v_cmp_eq_u32 vcc, -1, v21
    s_cbranch_vccnz G_f11
    v_mfma_f32_32x32x16_bf16 v[128:143], v[48:51], v[108:111], v[128:143]
G_q11:
    s_waitcnt vmcnt(11)
    v_max3_u32 v21, v104, v105, v106
    v_max_u32 v21, v21, v107
    v_cmp_eq_u32 vcc, -1, v21
    s_cbranch_vccnz G_f10
    v_mfma_f32_32x32x16_bf16 v[128:143], v[48:51], v[104:107], v[128:143]
G_q10:
    s_waitcnt vmcnt(10)
    v_max3_u32 v21, v100, v101, v102
    v_max_u32 v21, v21, v103
    v_cmp_eq_u32 vcc, -1, v21
    s_cbranch_vccnz G_f9
    v_mfma_f32_32x32x16_bf16 v[128:143], v[48:51], v[100:103], v[128:143]
G_q9:
    s_waitcnt vmcnt(9)
    v_max3_u32 v21, v96, v97, v98
    v_max_u32 v21, v21, v99
    v_cmp_eq_u32 vcc, -1, v21
    s_cbranch_vccnz G_f8
    v_mfma_f32_32x32x16_bf16 v[128:143], v[48:51], v[96:99], v[128:143]
G_q8:
    s_waitcnt vmcnt(8)
    v_max3_u32 v21, v92, v93, v94
    v_max_u32 v21, v21, v95
    v_cmp_eq_u32 vcc, -1, v21
    s_cbranch_vccnz G_f7
    v_mfma_f32_32x32x16_bf16 v[128:143], v[48:51], v[92:95], v[128:143]
G_q7:
    s_waitcnt vmcnt(7)
    v_max3_u32 v21, v88, v89, v90
    v_max_u32 v21, v21, v91
    v_cmp_eq_u32 vcc, -1, v21
    s_cbranch_vccnz G_f6
    v_mfma_f32_32x32x16_bf16 v[128:143], v[48:51], v[88:91], v[128:143]
G_q6:
    s_waitcnt vmcnt(6)
    v_max3_u32 v21, v84, v85, v86
    v_max_u32 v21, v21, v87
    v_cmp_eq_u32 vcc, -1, v21
    s_cbranch_vccnz G_f5
    v_mfma_f32_32x32x16_bf16 v[128:143], v[48:51], v[84:87], v[128:143]
G_q5:
    s_waitcnt vmcnt(5)
    v_max3_u32 v21, v80, v81, v82
    v_max_u32 v21, v21, v83
    v_cmp_eq_u32 vcc, -1, v21
    s_cbranch_vccnz G_f4
    v_mfma_f32_32x32x16_bf16 v[128:143], v[48:51], v[80:83], v[128:143]
G_q4:
    s_waitcnt vmcnt(4)
    v_max3_u32 v21, v76, v77, v78
    v_max_u32 v21, v21, v79
    v_cmp_eq_u32 vcc, -1, v21
    s_cbranch_vccnz G_f3
    v_mfma_f32_32x32x16_bf16 v[128:143], v[48:51], v[76:79], v[128:143]
G_q3:
    s_waitcnt vmcnt(3)
    v_max3_u32 v21, v72, v73, v74
    v_max_u32 v21, v21, v75
    v_cmp_eq_u32 vcc, -1, v21
    s_cbranch_vccnz G_f2
    v_mfma_f32_32x32x16_bf16 v[128:143], v[48:51], v[72:75], v[128:143]
G_q2:
    s_waitcnt vmcnt(2)
    v_max3_u32 v21, v68, v69, v70
    v_max_u32 v21, v21, v71
    v_cmp_eq_u32 vcc, -1, v21
    s_cbranch_vccnz G_f1
    v_mfma_f32_32x32x16_bf16 v[128:143], v[48:51], v[68:71], v[128:143]
G_q1:
    s_waitcnt vmcnt(1)
    v_max3_u32 v21, v64, v65, v66
    v_max_u32 v21, v21, v67
    v_cmp_eq_u32 vcc, -1, v21
    s_cbranch_vccnz G_f0
    v_mfma_f32_32x32x16_bf16 v[128:143], v[48:51], v[64:67], v[128:143]
G_q0:
    s_waitcnt vmcnt(0)
    s_add_u32 s65, s65, 1
    s_cmp_ge_u32 s65, 40000
    s_cbranch_scc1 G_done
    s_cmp_lg_u32 s68, 0
    s_cbranch_scc1 G_loop
    v_mov_b32 v20, -1
    s_cmp_lg_u32 s66, 0
    s_cbranch_scc1 G_loop
    v_max3_u32 v21, v56, v57, v58
    v_max_u32 v21, v21, v59
    v_cmp_eq_u32 vcc, -1, v21
    s_cbranch_vccnz G_loop
G_done:
    v_add_u32 v16, s7, v6
    v_add_f32_dpp v56, v56, v56 row_ror:4 row_mask:0xf bank_mask:0xf
    v_add_f32_dpp v57, v57, v57 row_ror:4 row_mask:0xf bank_mask:0xf
    v_add_f32_dpp v58, v58, v58 row_ror:4 row_mask:0xf bank_mask:0xf
    v_add_f32_dpp v59, v59, v59 row_ror:4 row_mask:0xf bank_mask:0xf
    v_add_f32_dpp v56, v56, v56 row_ror:8 row_mask:0xf bank_mask:0xf
    v_add_f32_dpp v57, v57, v57 row_ror:8 row_mask:0xf bank_mask:0xf
    v_add_f32_dpp v58, v58, v58 row_ror:8 row_mask:0xf bank_mask:0xf
    v_add_f32_dpp v59, v59, v59 row_ror:8 row_mask:0xf bank_mask:0xf
    v_mov_b32 v64, v56
    v_mov_b32 v65, v57
    v_mov_b32 v66, v58
    v_mov_b32 v67, v59
    s_nop 0
    v_permlane16_swap_b32 v56, v64
    v_permlane16_swap_b32 v57, v65
    v_permlane16_swap_b32 v58, v66
    v_permlane16_swap_b32 v59, v67
    v_add_f32 v56, v56, v64
    v_add_f32 v57, v57, v65
    v_add_f32 v58, v58, v66
    v_add_f32 v59, v59, v67
    v_mov_b32 v64, v56
    v_mov_b32 v65, v57
    v_mov_b32 v66, v58
    v_mov_b32 v67, v59
    s_nop 0
    v_permlane32_swap_b32 v56, v64
    v_permlane32_swap_b32 v57, v65
    v_permlane32_swap_b32 v58, v66
    v_permlane32_swap_b32 v59, v67
    v_add_f32 v56, v56, v64
    v_add_f32 v57, v57, v65
    v_add_f32 v58, v58, v66
    v_add_f32 v59, v59, v67
    v_cvt_pk_bf16_f32 v60, v128, v129
    v_cvt_pk_bf16_f32 v61, v130, v131
    v_cvt_pk_bf16_f32 v62, v132, v133
    v_cvt_pk_bf16_f32 v63, v134, v135
    ds_write_b128 v16, v[60:63] offset:0
    v_cvt_pk_bf16_f32 v56, v56, v57
    v_cvt_pk_bf16_f32 v57, v58, v59
    s_lshr_b32 s64, s6, 1
    s_lshl_b32 s64, s64, 6
    s_and_b32 s65, s6, 1
    s_lshl_b32 s65, s65, 3
    s_add_u32 s64, s64, s65
    v_lshl_add_u32 v16, v2, 4, s64
    s_mov_b64 exec, 15
    ds_write_b64 v16, v[56:57] offset:4096
    s_mov_b64 exec, -1
    s_waitcnt lgkmcnt(0)
    s_barrier
    v_lshrrev_b32 v18, 3, v2
    v_lshlrev_b32 v18, 2, v18
    ds_read_b32 v24, v18 offset:4352
    ds_read_b32 v25, v18 offset:4384
    ds_read_b32 v26, v18 offset:4416
    ds_read_b32 v27, v18 offset:4448
    ds_read_b32 v28, v18 offset:4480
    ds_read_b32 v29, v18 offset:4512
    ds_read_b32 v30, v18 offset:4544
    s_waitcnt lgkmcnt(0)
    s_mov_b32 s64, 0x05040100
    s_mov_b32 s65, 0x07060302
    v_cvt_pk_bf16_f32 v24, v24, v25
    v_cvt_pk_bf16_f32 v25, v26, v27
    v_cvt_pk_bf16_f32 v26, v28, v29
    v_cvt_pk_bf16_f32 v27, v30, 0
    v_perm_b32 v48, v196, v192, s64
    v_perm_b32 v49, v196, v192, s65
    v_dot2_f32_bf16 v32, v48, v24, 0
    v_dot2_f32_bf16 v33, v49, v24, 0
    v_perm_b32 v50, v197, v193, s64
    v_perm_b32 v51, v197, v193, s65
    v_dot2_f32_bf16 v34, v50, v24, 0
    v_dot2_f32_bf16 v35, v51, v24, 0
    v_perm_b32 v48, v198, v194, s64
    v_perm_b32 v49, v198, v194, s65
    v_dot2_f32_bf16 v36, v48, v24, 0
    v_dot2_f32_bf16 v37, v49, v24, 0
    v_perm_b32 v50, v199, v195, s64
    v_perm_b32 v51, v199, v195, s65
    v_dot2_f32_bf16 v38, v50, v24, 0
    v_dot2_f32_bf16 v39, v51, v24, 0
    v_perm_b32 v48, v204, v200, s64
    v_perm_b32 v49, v204, v200, s65
    v_dot2_f32_bf16 v32, v48, v25, v32
    v_dot2_f32_bf16 v33, v49, v25, v33
    v_perm_b32 v50, v205, v201, s64
    v_perm_b32 v51, v205, v201, s65
    v_dot2_f32_bf16 v34, v50, v25, v34
    v_dot2_f32_bf16 v35, v51, v25, v35
    v_perm_b32 v48, v206, v202, s64
    v_perm_b32 v49, v206, v202, s65
    v_dot2_f32_bf16 v36, v48, v25, v36
    v_dot2_f32_bf16 v37, v49, v25, v37
    v_perm_b32 v50, v207, v203, s64
    v_perm_b32 v51, v207, v203, s65
    v_dot2_f32_bf16 v38, v50, v25, v38
    v_dot2_f32_bf16 v39, v51, v25, v39
    v_perm_b32 v48, v212, v208, s64
    v_perm_b32 v49, v212, v208, s65
    v_dot2_f32_bf16 v32, v48, v26, v32
    v_dot2_f32_bf16 v33, v49, v26, v33
    v_perm_b32 v50, v213, v209, s64
    v_perm_b32 v51, v213, v209, s65
    v_dot2_f32_bf16 v34, v50, v26, v34
    v_dot2_f32_bf16 v35, v51, v26, v35
    v_perm_b32 v48, v214, v210, s64
    v_perm_b32 v49, v214, v210, s65
    v_dot2_f32_bf16 v36, v48, v26, v36
    v_dot2_f32_bf16 v37, v49, v26, v37
    v_perm_b32 v50, v215, v211, s64
    v_perm_b32 v51, v215, v211, s65
    v_dot2_f32_bf16 v38, v50, v26, v38
    v_dot2_f32_bf16 v39, v51, v26, v39
    v_perm_b32 v48, v216, v216, s64
    v_perm_b32 v49, v216, v216, s65
    v_dot2_f32_bf16 v32, v48, v27, v32
    v_dot2_f32_bf16 v33, v49, v27, v33
    v_perm_b32 v50, v217, v217, s64
    v_perm_b32 v51, v217, v217, s65
    v_dot2_f32_bf16 v34, v50, v27, v34
    v_dot2_f32_bf16 v35, v51, v27, v35
    v_perm_b32 v48, v218, v218, s64
    v_perm_b32 v49, v218, v218, s65
    v_dot2_f32_bf16 v36, v48, v27, v36
    v_dot2_f32_bf16 v37, v49, v27, v37
    v_perm_b32 v50, v219, v219, s64
    v_perm_b32 v51, v219, v219, s65
    v_dot2_f32_bf16 v38, v50, v27, v38
    v_dot2_f32_bf16 v39, v51, v27, v39
    s_nop 1
    s_nop 1
    v_permlane32_swap_b32 v32, v36
    v_permlane32_swap_b32 v33, v37
    v_permlane32_swap_b32 v34, v38
    v_permlane32_swap_b32 v35, v39
    v_add_f32 v32, v32, v36
    v_add_f32 v33, v33, v37
    v_add_f32 v34, v34, v38
    v_add_f32 v35, v35, v39
    s_nop 1
    v_permlane16_swap_b32 v32, v34
    v_permlane16_swap_b32 v33, v35
    v_add_f32 v32, v32, v34
    v_add_f32 v33, v33, v35
    s_nop 1
    v_add_f32_dpp v32, v32, v32 row_ror:8 row_mask:0xf bank_mask:0xf
    v_add_f32_dpp v33, v33, v33 row_ror:8 row_mask:0xf bank_mask:0xf
    v_and_b32 v16, 7, v2
    v_lshlrev_b32 v16, 5, v16
    v_lshl_add_u32 v16, v8, 3, v16
    s_lshl_b32 s64, s2, 10
    s_lshl_b32 s65, s6, 8
    s_add_u32 s64, s64, s65
    s_add_u32 s64, s64, 6447104
    s_mov_b32 exec_lo, 0x00ff00ff
    s_mov_b32 exec_hi, 0x00ff00ff
    buffer_store_dwordx2 v[32:33], v16, s[16:19], s64 offen sc0 sc1
    s_mov_b64 exec, -1
    s_lshl_b32 s64, s4, 3
    s_add_u32 s64, s64, s3
    s_lshl_b32 s64, s64, 7
    s_add_u32 s64, s64, 5382144
    v_mov_b32 v14, s64
    s_mov_b64 exec, 1
    v_mov_b32 v15, 0
    buffer_atomic_or v15, v14, s[16:19], 0 offen sc0
    s_mov_b64 exec, -1
    v_mov_b32 v254, v14
    s_branch P2_start
C_start:
    s_and_b32 s6, s3, 1
    s_lshr_b32 s7, s3, 1
    v_and_b32 v3, 15, v2
    s_lshl_b32 s64, s6, 6
    v_add_u32 v3, s64, v3
    v_lshlrev_b32 v3, 7, v3
    v_add_u32 v3, 8192, v3
    v_bfe_u32 v56, v2, 1, 3
    v_lshrrev_b32 v57, 4, v2
    v_xor_b32 v56, v56, v57
    v_lshl_add_u32 v4, v56, 4, v3
    v_xor_b32 v5, 64, v4
    v_bfe_u32 v56, v2, 2, 2
    v_lshl_add_u32 v58, v57, 3, v56
    v_lshlrev_b32 v58, 7, v58
    v_lshrrev_b32 v56, 1, v56
    v_xor_b32 v56, s7, v56
    v_lshl_add_u32 v58, v56, 6, v58
    v_and_b32 v57, 1, v57
    v_lshl_add_u32 v58, v57, 5, v58
    v_and_b32 v56, 3, v2
    v_lshl_add_u32 v58, v56, 3, v58
    v_add_u32 v6, 24576, v58
    v_xor_b32 v7, 32, v6
    v_mov_b32 v8, v4
    v_mov_b32 v10, v6
    v_mov_b32 v9, v5
    v_mov_b32 v11, v7
    v_mov_b32 v64, 0
    v_mov_b32 v65, 0
    v_mov_b32 v66, 0
    v_mov_b32 v67, 0
    v_mov_b32 v68, 0
    v_mov_b32 v69, 0
    v_mov_b32 v70, 0
    v_mov_b32 v71, 0
    v_mov_b32 v72, 0
    v_mov_b32 v73, 0
    v_mov_b32 v74, 0
    v_mov_b32 v75, 0
    v_mov_b32 v76, 0
    v_mov_b32 v77, 0
    v_mov_b32 v78, 0
    v_mov_b32 v79, 0
    v_mov_b32 v80, 0
    v_mov_b32 v81, 0
    v_mov_b32 v82, 0
    v_mov_b32 v83, 0
    v_mov_b32 v84, 0
    v_mov_b32 v85, 0
    v_mov_b32 v86, 0
    v_mov_b32 v87, 0
    v_mov_b32 v88, 0
    v_mov_b32 v89, 0
    v_mov_b32 v90, 0
    v_mov_b32 v91, 0
    v_mov_b32 v92, 0
    v_mov_b32 v93, 0
    v_mov_b32 v94, 0
    v_mov_b32 v95, 0
    v_mov_b32 v96, 0
    v_mov_b32 v97, 0
    v_mov_b32 v98, 0
    v_mov_b32 v99, 0
    v_mov_b32 v100, 0
    v_mov_b32 v101, 0
    v_mov_b32 v102, 0
    v_mov_b32 v103, 0
    v_mov_b32 v104, 0
    v_mov_b32 v105, 0
    v_mov_b32 v106, 0
    v_mov_b32 v107, 0
    v_mov_b32 v108, 0
    v_mov_b32 v109, 0
    v_mov_b32 v110, 0
    v_mov_b32 v111, 0
    v_mov_b32 v112, 0
    v_mov_b32 v113, 0
    v_mov_b32 v114, 0
    v_mov_b32 v115, 0
    v_mov_b32 v116, 0
    v_mov_b32 v117, 0
    v_mov_b32 v118, 0
    v_mov_b32 v119, 0
    v_mov_b32 v120, 0
    v_mov_b32 v121, 0
    v_mov_b32 v122, 0
    v_mov_b32 v123, 0
    v_mov_b32 v124, 0
    v_mov_b32 v125, 0
    v_mov_b32 v126, 0
    v_mov_b32 v127, 0
    v_mov_b32 v128, 0
    v_mov_b32 v129, 0
    v_mov_b32 v130, 0
    v_mov_b32 v131, 0
    v_mov_b32 v132, 0
    v_mov_b32 v133, 0
    v_mov_b32 v134, 0
    v_mov_b32 v135, 0
    v_mov_b32 v136, 0
    v_mov_b32 v137, 0
    v_mov_b32 v138, 0
    v_mov_b32 v139, 0
    v_mov_b32 v140, 0
    v_mov_b32 v141, 0
    v_mov_b32 v142, 0
    v_mov_b32 v143, 0
    v_mov_b32 v144, 0
    v_mov_b32 v145, 0
    v_mov_b32 v146, 0
    v_mov_b32 v147, 0
    v_mov_b32 v148, 0
    v_mov_b32 v149, 0
    v_mov_b32 v150, 0
    v_mov_b32 v151, 0
    v_mov_b32 v152, 0
    v_mov_b32 v153, 0
    v_mov_b32 v154, 0
    v_mov_b32 v155, 0
    v_mov_b32 v156, 0
    v_mov_b32 v157, 0
    v_mov_b32 v158, 0
    v_mov_b32 v159, 0
    s_lshl_b32 s64, s3, 2
    v_mov_b32 v229, s64
    ds_write_b32 v229, v64 offset:4288
    ds_write_b32 v229, v64 offset:4304
    v_lshlrev_b32 v3, 4, v2
    s_lshl_b32 s64, s3, 11
    v_add_u32 v224, s64, v3
    v_xor_b32 v225, 2048, v224
    s_lshl_b32 s64, s3, 8
    v_lshl_add_u32 v227, v2, 2, s64
    v_xor_b32 v228, 256, v227
    v_xor_b32 v230, 4, v229
    v_mov_b32 v231, 1
    v_lshlrev_b32 v232, 2, v2
    s_lshl_b32 s64, 1, s4
    v_mov_b32 v233, s64
    s_lshl_b32 s43, s5, 2
    s_add_u32 s43, s43, s3
    s_lshl_b32 s64, s43, 7
    s_add_u32 s64, s64, 5373952
    v_mov_b32 v234, s64
    s_lshl_b32 s43, s43, 4
    s_add_u32 s43, s43, s4
    s_mul_i32 s43, s43, 1152
    s_add_u32 s43, s43, 4194304
    s_lshl_b32 s42, s4, 2
    s_lshl_b32 s64, s6, 1
    s_add_u32 s42, s42, s64
    s_lshl_b32 s42, s42, 5
    s_lshl_b32 s64, s5, 1
    s_add_u32 s42, s42, s64
    s_add_u32 s42, s42, s7
    s_lshl_b32 s42, s42, 11
    s_and_b32 s64, s5, 7
    s_lshl_b32 s64, s64, 1
    s_add_u32 s64, s64, s7
    s_lshl_b32 s64, 1, s64
    v_mov_b32 v13, s64
    s_lshr_b32 s64, s5, 3
    s_lshl_b32 s64, s64, 1
    s_add_u32 s64, s64, s6
    s_lshl_b32 s64, s64, 8
    s_lshl_b32 s65, s4, 10
    s_add_u32 s64, s64, s65
    s_add_u32 s64, s64, 5382144
    v_lshl_add_u32 v15, v2, 7, s64
    v_lshlrev_b32 v1, 4, v2
    s_and_b32 s64, s2, 7
    s_lshr_b32 s65, s2, 3
    s_and_b32 s4, s64, 3
    s_lshl_b32 s4, s4, 2
    s_and_b32 s66, s65, 3
    s_add_u32 s4, s4, s66
    s_lshr_b32 s5, s64, 2
    s_lshl_b32 s5, s5, 3
    s_lshr_b32 s66, s65, 2
    s_add_u32 s5, s5, s66
    s_mov_b32 s65, 0
    s_mov_b32 s66, 0
    v_mov_b32 v236, 0x3f803f80
    v_mov_b32 v237, 0x3f803f80
    v_mov_b32 v238, 0x3f803f80
    v_mov_b32 v239, 0x3f803f80
    s_waitcnt vmcnt(0) lgkmcnt(0)
    s_barrier
    ds_read_b64_tr_b16 v[16:17], v10 offset:0
    ds_read_b64_tr_b16 v[18:19], v10 offset:512
    ds_read_b128 v[192:195], v8 offset:0
    ds_read_b128 v[196:199], v8 offset:2048
    ds_read_b128 v[200:203], v8 offset:4096
    ds_read_b128 v[204:207], v8 offset:6144
    ds_read_b64_tr_b16 v[20:21], v11 offset:0
    ds_read_b64_tr_b16 v[22:23], v11 offset:512
    ds_read_b64_tr_b16 v[24:25], v10 offset:8192
    ds_read_b64_tr_b16 v[26:27], v10 offset:8704
    ds_read_b64_tr_b16 v[28:29], v11 offset:8192
    ds_read_b64_tr_b16 v[30:31], v11 offset:8704
    ds_read_b64_tr_b16 v[32:33], v10 offset:16384
    ds_read_b64_tr_b16 v[34:35], v10 offset:16896
    ds_read_b64_tr_b16 v[36:37], v11 offset:16384
    ds_read_b64_tr_b16 v[38:39], v11 offset:16896
.p2align 3
C_loop:
    s_waitcnt lgkmcnt(0)
    v_mfma_f32_16x16x32_bf16 v[64:67], v[16:19], v[192:195], v[64:67]
    ds_read_b64_tr_b16 v[40:41], v10 offset:4096
    v_mfma_f32_16x16x32_bf16 v[72:75], v[16:19], v[196:199], v[72:75]
    ds_read_b64_tr_b16 v[42:43], v10 offset:4608
    v_mfma_f32_16x16x32_bf16 v[80:83], v[16:19], v[200:203], v[80:83]
    ds_read_b128 v[208:211], v9 offset:0
    v_mfma_f32_16x16x32_bf16 v[88:91], v[16:19], v[204:207], v[88:91]
    ds_read_b128 v[212:215], v9 offset:2048
    v_mfma_f32_16x16x32_bf16 v[68:71], v[20:23], v[192:195], v[68:71]
    ds_read_b128 v[216:219], v9 offset:4096
    v_mfma_f32_16x16x32_bf16 v[76:79], v[20:23], v[196:199], v[76:79]
    ds_read_b128 v[220:223], v9 offset:6144
    v_mfma_f32_16x16x32_bf16 v[84:87], v[20:23], v[200:203], v[84:87]
    ds_read_b64_tr_b16 v[44:45], v11 offset:4096
    v_mfma_f32_16x16x32_bf16 v[92:95], v[20:23], v[204:207], v[92:95]
    ds_read_b64_tr_b16 v[46:47], v11 offset:4608
    v_mfma_f32_16x16x32_bf16 v[96:99], v[192:195], v[24:27], v[96:99]
    ds_read_b64_tr_b16 v[48:49], v10 offset:12288
    v_mfma_f32_16x16x32_bf16 v[100:103], v[196:199], v[24:27], v[100:103]
    ds_read_b64_tr_b16 v[50:51], v10 offset:12800
    v_mfma_f32_16x16x32_bf16 v[112:115], v[200:203], v[24:27], v[112:115]
    ds_read_b64_tr_b16 v[52:53], v11 offset:12288
    v_mfma_f32_16x16x32_bf16 v[116:119], v[204:207], v[24:27], v[116:119]
    ds_read_b64_tr_b16 v[54:55], v11 offset:12800
    v_mfma_f32_16x16x32_bf16 v[104:107], v[192:195], v[28:31], v[104:107]
    ds_read_b64_tr_b16 v[56:57], v10 offset:20480
    v_mfma_f32_16x16x32_bf16 v[108:111], v[196:199], v[28:31], v[108:111]
    ds_read_b64_tr_b16 v[58:59], v10 offset:20992
    v_mfma_f32_16x16x32_bf16 v[120:123], v[200:203], v[28:31], v[120:123]
    ds_read_b64_tr_b16 v[60:61], v11 offset:20480
    v_mfma_f32_16x16x32_bf16 v[124:127], v[204:207], v[28:31], v[124:127]
    ds_read_b64_tr_b16 v[62:63], v11 offset:20992
    v_mfma_f32_16x16x32_bf16 v[128:131], v[192:195], v[32:35], v[128:131]
    v_mfma_f32_16x16x32_bf16 v[132:135], v[196:199], v[32:35], v[132:135]
    v_mfma_f32_16x16x32_bf16 v[144:147], v[200:203], v[32:35], v[144:147]
    v_mfma_f32_16x16x32_bf16 v[148:151], v[204:207], v[32:35], v[148:151]
    v_mfma_f32_16x16x32_bf16 v[136:139], v[192:195], v[36:39], v[136:139]
    v_mfma_f32_16x16x32_bf16 v[140:143], v[196:199], v[36:39], v[140:143]
    v_mfma_f32_16x16x32_bf16 v[152:155], v[200:203], v[36:39], v[152:155]
    v_mfma_f32_16x16x32_bf16 v[156:159], v[204:207], v[36:39], v[156:159]
    s_waitcnt lgkmcnt(0)
    s_barrier
    s_add_u32 s65, s65, 40960
    s_cmp_eq_u32 s65, 122880
    s_cselect_b32 s65, 0, s65
    v_mfma_f32_16x16x32_bf16 v[64:67], v[40:43], v[208:211], v[64:67]
    v_add_u32 v10, s65, v6
    v_add_u32 v8, s65, v4
    v_mfma_f32_16x16x32_bf16 v[72:75], v[40:43], v[212:215], v[72:75]
    ds_read_b64_tr_b16 v[16:17], v10 offset:0
    v_mfma_f32_16x16x32_bf16 v[80:83], v[40:43], v[216:219], v[80:83]
    ds_read_b64_tr_b16 v[18:19], v10 offset:512
    v_mfma_f32_16x16x32_bf16 v[88:91], v[40:43], v[220:223], v[88:91]
    ds_read_b128 v[192:195], v8 offset:0
    v_mfma_f32_16x16x32_bf16 v[68:71], v[44:47], v[208:211], v[68:71]
    ds_read_b128 v[196:199], v8 offset:2048
    v_mfma_f32_16x16x32_bf16 v[76:79], v[44:47], v[212:215], v[76:79]
    ds_read_b128 v[200:203], v8 offset:4096
    v_mfma_f32_16x16x32_bf16 v[84:87], v[44:47], v[216:219], v[84:87]
    ds_read_b128 v[204:207], v8 offset:6144
    v_mfma_f32_16x16x32_bf16 v[92:95], v[44:47], v[220:223], v[92:95]
    v_add_u32 v11, s65, v7
    v_mfma_f32_16x16x32_bf16 v[96:99], v[208:211], v[48:51], v[96:99]
    ds_read_b64_tr_b16 v[20:21], v11 offset:0
    v_mfma_f32_16x16x32_bf16 v[100:103], v[212:215], v[48:51], v[100:103]
    ds_read_b64_tr_b16 v[22:23], v11 offset:512
    v_mfma_f32_16x16x32_bf16 v[112:115], v[216:219], v[48:51], v[112:115]
    ds_read_b64_tr_b16 v[24:25], v10 offset:8192
    v_mfma_f32_16x16x32_bf16 v[116:119], v[220:223], v[48:51], v[116:119]
    ds_read_b64_tr_b16 v[26:27], v10 offset:8704
    v_mfma_f32_16x16x32_bf16 v[104:107], v[208:211], v[52:55], v[104:107]
    ds_read_b64_tr_b16 v[28:29], v11 offset:8192
    v_mfma_f32_16x16x32_bf16 v[108:111], v[212:215], v[52:55], v[108:111]
    ds_read_b64_tr_b16 v[30:31], v11 offset:8704
    v_mfma_f32_16x16x32_bf16 v[120:123], v[216:219], v[52:55], v[120:123]
    ds_read_b64_tr_b16 v[32:33], v10 offset:16384
    v_mfma_f32_16x16x32_bf16 v[124:127], v[220:223], v[52:55], v[124:127]
    ds_read_b64_tr_b16 v[34:35], v10 offset:16896
    v_mfma_f32_16x16x32_bf16 v[128:131], v[208:211], v[56:59], v[128:131]
    ds_read_b64_tr_b16 v[36:37], v11 offset:16384
    v_mfma_f32_16x16x32_bf16 v[132:135], v[212:215], v[56:59], v[132:135]
    ds_read_b64_tr_b16 v[38:39], v11 offset:16896
    v_mfma_f32_16x16x32_bf16 v[144:147], v[216:219], v[56:59], v[144:147]
    v_add_u32 v9, s65, v5
    v_mfma_f32_16x16x32_bf16 v[148:151], v[220:223], v[56:59], v[148:151]
    v_mfma_f32_16x16x32_bf16 v[136:139], v[208:211], v[60:63], v[136:139]
    v_mfma_f32_16x16x32_bf16 v[140:143], v[212:215], v[60:63], v[140:143]
    v_mfma_f32_16x16x32_bf16 v[152:155], v[216:219], v[60:63], v[152:155]
    v_mfma_f32_16x16x32_bf16 v[156:159], v[220:223], v[60:63], v[156:159]
    s_add_u32 s66, s66, 1
    s_cmp_lt_u32 s66, 14
    s_cbranch_scc1 C_loop
    s_waitcnt lgkmcnt(0)
    v_mfma_f32_16x16x32_bf16 v[96:99], v[192:195], v[24:27], v[96:99]
    ds_read_b64_tr_b16 v[48:49], v10 offset:12288
    v_mfma_f32_16x16x32_bf16 v[100:103], v[196:199], v[24:27], v[100:103]
    ds_read_b64_tr_b16 v[50:51], v10 offset:12800
    v_mfma_f32_16x16x32_bf16 v[112:115], v[200:203], v[24:27], v[112:115]
    ds_read_b128 v[160:163], v9 offset:0
    v_mfma_f32_16x16x32_bf16 v[116:119], v[204:207], v[24:27], v[116:119]
    ds_read_b128 v[164:167], v9 offset:2048
    v_mfma_f32_16x16x32_bf16 v[104:107], v[192:195], v[28:31], v[104:107]
    ds_read_b128 v[168:171], v9 offset:4096
    v_mfma_f32_16x16x32_bf16 v[108:111], v[196:199], v[28:31], v[108:111]
    ds_read_b128 v[172:175], v9 offset:6144
    v_mfma_f32_16x16x32_bf16 v[120:123], v[200:203], v[28:31], v[120:123]
    ds_read_b64_tr_b16 v[52:53], v11 offset:12288
    v_mfma_f32_16x16x32_bf16 v[124:127], v[204:207], v[28:31], v[124:127]
    ds_read_b64_tr_b16 v[54:55], v11 offset:12800
    v_mfma_f32_16x16x32_bf16 v[128:131], v[192:195], v[32:35], v[128:131]
    ds_read_b64_tr_b16 v[56:57], v10 offset:20480
    v_mfma_f32_16x16x32_bf16 v[132:135], v[196:199], v[32:35], v[132:135]
    ds_read_b64_tr_b16 v[58:59], v10 offset:20992
    v_mfma_f32_16x16x32_bf16 v[144:147], v[200:203], v[32:35], v[144:147]
    ds_read_b64_tr_b16 v[60:61], v11 offset:20480
    v_mfma_f32_16x16x32_bf16 v[148:151], v[204:207], v[32:35], v[148:151]
    ds_read_b64_tr_b16 v[62:63], v11 offset:20992
    v_mfma_f32_16x16x32_bf16 v[136:139], v[192:195], v[36:39], v[136:139]
    v_mfma_f32_16x16x32_bf16 v[140:143], v[196:199], v[36:39], v[140:143]
    v_mfma_f32_16x16x32_bf16 v[152:155], v[200:203], v[36:39], v[152:155]
    v_mfma_f32_16x16x32_bf16 v[156:159], v[204:207], v[36:39], v[156:159]
    s_waitcnt lgkmcnt(0)
    s_barrier
    s_add_u32 s66, s66, 1
    v_mfma_f32_16x16x32_bf16 v[96:99], v[160:163], v[48:51], v[96:99]
    v_mov_b32 v10, v6
    v_mov_b32 v8, v4
    v_mfma_f32_16x16x32_bf16 v[100:103], v[164:167], v[48:51], v[100:103]
    ds_read_b64_tr_b16 v[24:25], v10 offset:8192
    v_mfma_f32_16x16x32_bf16 v[112:115], v[168:171], v[48:51], v[112:115]
    ds_read_b64_tr_b16 v[26:27], v10 offset:8704
    v_mfma_f32_16x16x32_bf16 v[116:119], v[172:175], v[48:51], v[116:119]
    v_mov_b32 v11, v7
    v_mov_b32 v9, v5
    v_mfma_f32_16x16x32_bf16 v[104:107], v[160:163], v[52:55], v[104:107]
    ds_read_b128 v[176:179], v8 offset:0
    v_mfma_f32_16x16x32_bf16 v[108:111], v[164:167], v[52:55], v[108:111]
    ds_read_b128 v[180:183], v8 offset:2048
    v_mfma_f32_16x16x32_bf16 v[120:123], v[168:171], v[52:55], v[120:123]
    ds_read_b128 v[184:187], v8 offset:4096
    v_mfma_f32_16x16x32_bf16 v[124:127], v[172:175], v[52:55], v[124:127]
    ds_read_b128 v[188:191], v8 offset:6144
    v_mfma_f32_16x16x32_bf16 v[128:131], v[160:163], v[56:59], v[128:131]
    ds_read_b64_tr_b16 v[28:29], v11 offset:8192
    v_mfma_f32_16x16x32_bf16 v[132:135], v[164:167], v[56:59], v[132:135]
    ds_read_b64_tr_b16 v[30:31], v11 offset:8704
    v_mfma_f32_16x16x32_bf16 v[144:147], v[168:171], v[56:59], v[144:147]
    ds_read_b64_tr_b16 v[32:33], v10 offset:16384
    v_mfma_f32_16x16x32_bf16 v[148:151], v[172:175], v[56:59], v[148:151]
    ds_read_b64_tr_b16 v[34:35], v10 offset:16896
    v_mfma_f32_16x16x32_bf16 v[136:139], v[160:163], v[60:63], v[136:139]
    ds_read_b64_tr_b16 v[36:37], v11 offset:16384
    v_mfma_f32_16x16x32_bf16 v[140:143], v[164:167], v[60:63], v[140:143]
    ds_read_b64_tr_b16 v[38:39], v11 offset:16896
    v_mfma_f32_16x16x32_bf16 v[152:155], v[168:171], v[60:63], v[152:155]
    v_mfma_f32_16x16x32_bf16 v[156:159], v[172:175], v[60:63], v[156:159]
    s_waitcnt lgkmcnt(0)
    v_mfma_f32_16x16x32_bf16 v[96:99], v[176:179], v[24:27], v[96:99]
    ds_read_b64_tr_b16 v[48:49], v10 offset:12288
    v_mfma_f32_16x16x32_bf16 v[100:103], v[180:183], v[24:27], v[100:103]
    ds_read_b64_tr_b16 v[50:51], v10 offset:12800
    v_mfma_f32_16x16x32_bf16 v[112:115], v[184:187], v[24:27], v[112:115]
    ds_read_b128 v[208:211], v9 offset:0
    v_mfma_f32_16x16x32_bf16 v[116:119], v[188:191], v[24:27], v[116:119]
    ds_read_b128 v[212:215], v9 offset:2048
    v_mfma_f32_16x16x32_bf16 v[104:107], v[176:179], v[28:31], v[104:107]
    ds_read_b128 v[216:219], v9 offset:4096
    v_mfma_f32_16x16x32_bf16 v[108:111], v[180:183], v[28:31], v[108:111]
    ds_read_b128 v[220:223], v9 offset:6144
    v_mfma_f32_16x16x32_bf16 v[120:123], v[184:187], v[28:31], v[120:123]
    ds_read_b64_tr_b16 v[52:53], v11 offset:12288
    v_mfma_f32_16x16x32_bf16 v[124:127], v[188:191], v[28:31], v[124:127]
    ds_read_b64_tr_b16 v[54:55], v11 offset:12800
    v_mfma_f32_16x16x32_bf16 v[128:131], v[176:179], v[32:35], v[128:131]
    ds_read_b64_tr_b16 v[56:57], v10 offset:20480
    v_mfma_f32_16x16x32_bf16 v[132:135], v[180:183], v[32:35], v[132:135]
    ds_read_b64_tr_b16 v[58:59], v10 offset:20992
    v_mfma_f32_16x16x32_bf16 v[144:147], v[184:187], v[32:35], v[144:147]
    ds_read_b64_tr_b16 v[60:61], v11 offset:20480
    v_mfma_f32_16x16x32_bf16 v[148:151], v[188:191], v[32:35], v[148:151]
    ds_read_b64_tr_b16 v[62:63], v11 offset:20992
    v_mfma_f32_16x16x32_bf16 v[136:139], v[176:179], v[36:39], v[136:139]
    v_mfma_f32_16x16x32_bf16 v[140:143], v[180:183], v[36:39], v[140:143]
    v_mfma_f32_16x16x32_bf16 v[152:155], v[184:187], v[36:39], v[152:155]
    v_mfma_f32_16x16x32_bf16 v[156:159], v[188:191], v[36:39], v[156:159]
    s_waitcnt lgkmcnt(0)
    s_barrier
    v_mfma_f32_16x16x32_bf16 v[96:99], v[208:211], v[48:51], v[96:99]
    v_mfma_f32_16x16x32_bf16 v[100:103], v[212:215], v[48:51], v[100:103]
    v_mfma_f32_16x16x32_bf16 v[112:115], v[216:219], v[48:51], v[112:115]
    v_mfma_f32_16x16x32_bf16 v[116:119], v[220:223], v[48:51], v[116:119]
    v_mfma_f32_16x16x32_bf16 v[104:107], v[208:211], v[52:55], v[104:107]
    v_mfma_f32_16x16x32_bf16 v[108:111], v[212:215], v[52:55], v[108:111]
    v_mfma_f32_16x16x32_bf16 v[120:123], v[216:219], v[52:55], v[120:123]
    v_mfma_f32_16x16x32_bf16 v[124:127], v[220:223], v[52:55], v[124:127]
    v_mfma_f32_16x16x32_bf16 v[128:131], v[208:211], v[56:59], v[128:131]
    v_mfma_f32_16x16x32_bf16 v[132:135], v[212:215], v[56:59], v[132:135]
    v_mfma_f32_16x16x32_bf16 v[144:147], v[216:219], v[56:59], v[144:147]
    v_mfma_f32_16x16x32_bf16 v[148:151], v[220:223], v[56:59], v[148:151]
    v_mfma_f32_16x16x32_bf16 v[136:139], v[208:211], v[60:63], v[136:139]
    v_mfma_f32_16x16x32_bf16 v[140:143], v[212:215], v[60:63], v[140:143]
    v_mfma_f32_16x16x32_bf16 v[152:155], v[216:219], v[60:63], v[152:155]
    v_mfma_f32_16x16x32_bf16 v[156:159], v[220:223], v[60:63], v[156:159]
    v_add_u32 v10, 81920, v6
    v_add_u32 v11, 81920, v7
    v_cvt_pk_bf16_f32 v16, v96, v97
    v_lshlrev_b32 v48, 16, v16
    v_and_b32 v49, 0xffff0000, v16
    v_mul_f32 v50, s72, v48
    v_mul_f32 v51, s72, v49
    v_exp_f32 v50, v50 clamp
    v_exp_f32 v51, v51 clamp
    v_max_f32 v48, 0, v48
    v_max_f32 v49, 0, v49
    v_add_f32 v48, v48, v50
    v_add_f32 v49, v49, v51
    v_min_f32 v56, v48, v49
    v_cvt_pk_bf16_f32 v16, v48, v49
    v_cvt_pk_bf16_f32 v17, v98, v99
    v_lshlrev_b32 v48, 16, v17
    v_and_b32 v49, 0xffff0000, v17
    v_mul_f32 v50, s72, v48
    v_mul_f32 v51, s72, v49
    v_exp_f32 v50, v50 clamp
    v_exp_f32 v51, v51 clamp
    v_max_f32 v48, 0, v48
    v_max_f32 v49, 0, v49
    v_add_f32 v48, v48, v50
    v_add_f32 v49, v49, v51
    v_min3_f32 v56, v48, v49, v56
    v_cvt_pk_bf16_f32 v17, v48, v49
    v_cvt_pk_bf16_f32 v18, v100, v101
    v_lshlrev_b32 v48, 16, v18
    v_and_b32 v49, 0xffff0000, v18
    v_mul_f32 v50, s72, v48
    v_mul_f32 v51, s72, v49
    v_exp_f32 v50, v50 clamp
    v_exp_f32 v51, v51 clamp
    v_max_f32 v48, 0, v48
    v_max_f32 v49, 0, v49
    v_add_f32 v48, v48, v50
    v_add_f32 v49, v49, v51
    v_min3_f32 v56, v48, v49, v56
    v_cvt_pk_bf16_f32 v18, v48, v49
    v_cvt_pk_bf16_f32 v19, v102, v103
    v_lshlrev_b32 v48, 16, v19
    v_and_b32 v49, 0xffff0000, v19
    v_mul_f32 v50, s72, v48
    v_mul_f32 v51, s72, v49
    v_exp_f32 v50, v50 clamp
    v_exp_f32 v51, v51 clamp
    v_max_f32 v48, 0, v48
    v_max_f32 v49, 0, v49
    v_add_f32 v48, v48, v50
    v_add_f32 v49, v49, v51
    v_min3_f32 v56, v48, v49, v56
    v_cvt_pk_bf16_f32 v19, v48, v49
    v_cvt_pk_bf16_f32 v20, v104, v105
    v_lshlrev_b32 v48, 16, v20
    v_and_b32 v49, 0xffff0000, v20
    v_mul_f32 v50, s72, v48
    v_mul_f32 v51, s72, v49
    v_exp_f32 v50, v50 clamp
    v_exp_f32 v51, v51 clamp
    v_max_f32 v48, 0, v48
    v_max_f32 v49, 0, v49
    v_add_f32 v48, v48, v50
    v_add_f32 v49, v49, v51
    v_min3_f32 v56, v48, v49, v56
    v_cvt_pk_bf16_f32 v20, v48, v49
    v_cvt_pk_bf16_f32 v21, v106, v107
    v_lshlrev_b32 v48, 16, v21
    v_and_b32 v49, 0xffff0000, v21
    v_mul_f32 v50, s72, v48
    v_mul_f32 v51, s72, v49
    v_exp_f32 v50, v50 clamp
    v_exp_f32 v51, v51 clamp
    v_max_f32 v48, 0, v48
    v_max_f32 v49, 0, v49
    v_add_f32 v48, v48, v50
    v_add_f32 v49, v49, v51
    v_min3_f32 v56, v48, v49, v56
    v_cvt_pk_bf16_f32 v21, v48, v49
    v_cvt_pk_bf16_f32 v22, v108, v109
    v_lshlrev_b32 v48, 16, v22
    v_and_b32 v49, 0xffff0000, v22
    v_mul_f32 v50, s72, v48
    v_mul_f32 v51, s72, v49
    v_exp_f32 v50, v50 clamp
    v_exp_f32 v51, v51 clamp
    v_max_f32 v48, 0, v48
    v_max_f32 v49, 0, v49
    v_add_f32 v48, v48, v50
    v_add_f32 v49, v49, v51
    v_min3_f32 v56, v48, v49, v56
    v_cvt_pk_bf16_f32 v22, v48, v49
    v_cvt_pk_bf16_f32 v23, v110, v111
    v_lshlrev_b32 v48, 16, v23
    v_and_b32 v49, 0xffff0000, v23
    v_mul_f32 v50, s72, v48
    v_mul_f32 v51, s72, v49
    v_exp_f32 v50, v50 clamp
    v_exp_f32 v51, v51 clamp
    v_max_f32 v48, 0, v48
    v_max_f32 v49, 0, v49
    v_add_f32 v48, v48, v50
    v_add_f32 v49, v49, v51
    v_min3_f32 v56, v48, v49, v56
    v_cvt_pk_bf16_f32 v23, v48, v49
    v_cmp_gt_f32 vcc, 0x3a800000, v56
    s_cbranch_vccnz phi_16_fix
phi_16_done:
    v_cvt_pk_bf16_f32 v32, v128, v129
    v_cvt_pk_bf16_f32 v33, v130, v131
    v_mfma_f32_16x16x32_bf16 v[96:99], v[236:239], v[16:19], 0
    v_cvt_pk_bf16_f32 v34, v132, v133
    v_mfma_f32_16x16x32_bf16 v[60:63], v[236:239], v[20:23], 0
    v_cvt_pk_bf16_f32 v35, v134, v135
    v_cvt_pk_bf16_f32 v36, v136, v137
    v_cvt_pk_bf16_f32 v37, v138, v139
    v_mfma_f32_16x16x32_bf16 v[240:243], v[16:19], v[32:35], 0
    v_cvt_pk_bf16_f32 v38, v140, v141
    v_mfma_f32_16x16x32_bf16 v[244:247], v[20:23], v[32:35], 0
    v_cvt_pk_bf16_f32 v39, v142, v143
    s_nop 1
    v_mfma_f32_16x16x32_bf16 v[248:251], v[16:19], v[36:39], 0
    v_mfma_f32_16x16x32_bf16 v[252:255], v[20:23], v[36:39], 0
    v_cvt_pk_bf16_f32 v24, v112, v113
    v_lshlrev_b32 v48, 16, v24
    v_and_b32 v49, 0xffff0000, v24
    v_mul_f32 v50, s72, v48
    v_mul_f32 v51, s72, v49
    v_exp_f32 v50, v50 clamp
    v_exp_f32 v51, v51 clamp
    v_max_f32 v48, 0, v48
    v_max_f32 v49, 0, v49
    v_add_f32 v48, v48, v50
    v_add_f32 v49, v49, v51
    v_min_f32 v56, v48, v49
    v_cvt_pk_bf16_f32 v24, v48, v49
    v_cvt_pk_bf16_f32 v25, v114, v115
    v_lshlrev_b32 v48, 16, v25
    v_and_b32 v49, 0xffff0000, v25
    v_mul_f32 v50, s72, v48
    v_mul_f32 v51, s72, v49
    v_exp_f32 v50, v50 clamp
    v_exp_f32 v51, v51 clamp
    v_max_f32 v48, 0, v48
    v_max_f32 v49, 0, v49
    v_add_f32 v48, v48, v50
    v_add_f32 v49, v49, v51
    v_min3_f32 v56, v48, v49, v56
    v_cvt_pk_bf16_f32 v25, v48, v49
    v_cvt_pk_bf16_f32 v26, v116, v117
    v_lshlrev_b32 v48, 16, v26
    v_and_b32 v49, 0xffff0000, v26
    v_mul_f32 v50, s72, v48
    v_mul_f32 v51, s72, v49
    v_exp_f32 v50, v50 clamp
    v_exp_f32 v51, v51 clamp
    v_max_f32 v48, 0, v48
    v_max_f32 v49, 0, v49
    v_add_f32 v48, v48, v50
    v_add_f32 v49, v49, v51
    v_min3_f32 v56, v48, v49, v56
    v_cvt_pk_bf16_f32 v26, v48, v49
    v_cvt_pk_bf16_f32 v27, v118, v119
    v_lshlrev_b32 v48, 16, v27
    v_and_b32 v49, 0xffff0000, v27
    v_mul_f32 v50, s72, v48
    v_mul_f32 v51, s72, v49
    v_exp_f32 v50, v50 clamp
    v_exp_f32 v51, v51 clamp
    v_max_f32 v48, 0, v48
    v_max_f32 v49, 0, v49
    v_add_f32 v48, v48, v50
    v_add_f32 v49, v49, v51
    v_min3_f32 v56, v48, v49, v56
    v_cvt_pk_bf16_f32 v27, v48, v49
    v_cvt_pk_bf16_f32 v28, v120, v121
    v_lshlrev_b32 v48, 16, v28
    v_and_b32 v49, 0xffff0000, v28
    v_mul_f32 v50, s72, v48
    v_mul_f32 v51, s72, v49
    v_exp_f32 v50, v50 clamp
    v_exp_f32 v51, v51 clamp
    v_max_f32 v48, 0, v48
    v_max_f32 v49, 0, v49
    v_add_f32 v48, v48, v50
    v_add_f32 v49, v49, v51
    v_min3_f32 v56, v48, v49, v56
    v_cvt_pk_bf16_f32 v28, v48, v49
    v_cvt_pk_bf16_f32 v29, v122, v123
    v_lshlrev_b32 v48, 16, v29
    v_and_b32 v49, 0xffff0000, v29
    v_mul_f32 v50, s72, v48
    v_mul_f32 v51, s72, v49
    v_exp_f32 v50, v50 clamp
    v_exp_f32 v51, v51 clamp
    v_max_f32 v48, 0, v48
    v_max_f32 v49, 0, v49
    v_add_f32 v48, v48, v50
    v_add_f32 v49, v49, v51
    v_min3_f32 v56, v48, v49, v56
    v_cvt_pk_bf16_f32 v29, v48, v49
    v_cvt_pk_bf16_f32 v30, v124, v125
    v_lshlrev_b32 v48, 16, v30
    v_and_b32 v49, 0xffff0000, v30
    v_mul_f32 v50, s72, v48
    v_mul_f32 v51, s72, v49
    v_exp_f32 v50, v50 clamp
    v_exp_f32 v51, v51 clamp
    v_max_f32 v48, 0, v48
    v_max_f32 v49, 0, v49
    v_add_f32 v48, v48, v50
    v_add_f32 v49, v49, v51
    v_min3_f32 v56, v48, v49, v56
    v_cvt_pk_bf16_f32 v30, v48, v49
    v_cvt_pk_bf16_f32 v31, v126, v127
    v_lshlrev_b32 v48, 16, v31
    v_and_b32 v49, 0xffff0000, v31
    v_mul_f32 v50, s72, v48
    v_mul_f32 v51, s72, v49
    v_exp_f32 v50, v50 clamp
    v_exp_f32 v51, v51 clamp
    v_max_f32 v48, 0, v48
    v_max_f32 v49, 0, v49
    v_add_f32 v48, v48, v50
    v_add_f32 v49, v49, v51
    v_min3_f32 v56, v48, v49, v56
    v_cvt_pk_bf16_f32 v31, v48, v49
    v_cmp_gt_f32 vcc, 0x3a800000, v56
    s_cbranch_vccnz phi_17_fix
phi_17_done:
    v_cvt_pk_bf16_f32 v40, v144, v145
    v_cvt_pk_bf16_f32 v41, v146, v147
    v_mfma_f32_16x16x32_bf16 v[96:99], v[236:239], v[24:27], v[96:99]
    v_cvt_pk_bf16_f32 v42, v148, v149
    v_mfma_f32_16x16x32_bf16 v[60:63], v[236:239], v[28:31], v[60:63]
    v_cvt_pk_bf16_f32 v43, v150, v151
    v_cvt_pk_bf16_f32 v44, v152, v153
    v_cvt_pk_bf16_f32 v45, v154, v155
    v_mfma_f32_16x16x32_bf16 v[240:243], v[24:27], v[40:43], v[240:243]
    v_cvt_pk_bf16_f32 v46, v156, v157
    v_mfma_f32_16x16x32_bf16 v[244:247], v[28:31], v[40:43], v[244:247]
    v_cvt_pk_bf16_f32 v47, v158, v159
    s_nop 1
    v_mfma_f32_16x16x32_bf16 v[248:251], v[24:27], v[44:47], v[248:251]
    v_mfma_f32_16x16x32_bf16 v[252:255], v[28:31], v[44:47], v[252:255]
    s_cmp_eq_u32 s6, 0
    s_cbranch_scc0 C_ex1
    ds_write_b32 v227, v60 offset:4608
    s_nop 5
    ds_write_b128 v224, v[248:251] offset:32768
    ds_write_b128 v224, v[252:255] offset:33792
C_ex2:
    ds_write_b32 v229, v231 offset:4288
C_ps:
    ds_read_b32 v25, v230 offset:4288
    ds_read_b128 v[16:19], v225 offset:32768
    ds_read_b128 v[20:23], v225 offset:33792
    ds_read_b32 v24, v228 offset:4608
    s_waitcnt lgkmcnt(0)
    v_cmp_eq_u32 vcc, 0, v25
    s_cbranch_vccnz C_ps
    v_add_f32 v16, v16, v240
    v_add_f32 v17, v17, v241
    v_add_f32 v18, v18, v242
    v_add_f32 v19, v19, v243
    v_add_f32 v20, v20, v244
    v_add_f32 v21, v21, v245
    v_add_f32 v22, v22, v246
    v_add_f32 v23, v23, v247
    v_add_f32 v24, v24, v96
    v_cvt_pk_bf16_f32 v28, v16, v17
    v_cvt_pk_bf16_f32 v29, v18, v19
    v_cvt_pk_bf16_f32 v30, v20, v21
    v_cvt_pk_bf16_f32 v31, v22, v23
    buffer_store_dwordx4 v[28:31], v1, s[16:19], s43 offen sc0 sc1
    s_mov_b64 exec, 0xffff
    buffer_store_dword v24, v232, s[16:19], s43 offen offset:1024 sc0 sc1
    s_mov_b64 exec, 1
    buffer_atomic_or v233, v234, s[16:19], 0 offen
    s_mov_b64 exec, -1
    ds_read_b64_tr_b16 v[96:97], v10 offset:0
    ds_read_b64_tr_b16 v[98:99], v10 offset:512
    ds_read_b64_tr_b16 v[100:101], v11 offset:0
    ds_read_b64_tr_b16 v[102:103], v11 offset:512
    ds_read_b64_tr_b16 v[104:105], v10 offset:4096
    ds_read_b64_tr_b16 v[106:107], v10 offset:4608
    ds_read_b64_tr_b16 v[108:109], v11 offset:4096
    ds_read_b64_tr_b16 v[110:111], v11 offset:4608
    ds_read_b64_tr_b16 v[112:113], v6 offset:0
    ds_read_b64_tr_b16 v[114:115], v6 offset:512
    ds_read_b64_tr_b16 v[116:117], v7 offset:0
    ds_read_b64_tr_b16 v[118:119], v7 offset:512
    ds_read_b64_tr_b16 v[120:121], v6 offset:4096
    ds_read_b64_tr_b16 v[122:123], v6 offset:4608
    ds_read_b64_tr_b16 v[124:125], v7 offset:4096
    ds_read_b64_tr_b16 v[126:127], v7 offset:4608
    s_waitcnt lgkmcnt(12)
    v_mfma_f32_16x16x32_bf16 v[64:67], v[96:99], v[192:195], v[64:67]
    v_mfma_f32_16x16x32_bf16 v[72:75], v[96:99], v[196:199], v[72:75]
    v_mfma_f32_16x16x32_bf16 v[80:83], v[96:99], v[200:203], v[80:83]
    v_mfma_f32_16x16x32_bf16 v[88:91], v[96:99], v[204:207], v[88:91]
    v_mfma_f32_16x16x32_bf16 v[68:71], v[100:103], v[192:195], v[68:71]
    v_mfma_f32_16x16x32_bf16 v[76:79], v[100:103], v[196:199], v[76:79]
    v_mfma_f32_16x16x32_bf16 v[84:87], v[100:103], v[200:203], v[84:87]
    v_mfma_f32_16x16x32_bf16 v[92:95], v[100:103], v[204:207], v[92:95]
    s_waitcnt lgkmcnt(8)
    v_mfma_f32_16x16x32_bf16 v[64:67], v[104:107], v[160:163], v[64:67]
    v_mfma_f32_16x16x32_bf16 v[72:75], v[104:107], v[164:167], v[72:75]
    v_mfma_f32_16x16x32_bf16 v[80:83], v[104:107], v[168:171], v[80:83]
    v_mfma_f32_16x16x32_bf16 v[88:91], v[104:107], v[172:175], v[88:91]
    v_mfma_f32_16x16x32_bf16 v[68:71], v[108:111], v[160:163], v[68:71]
    v_mfma_f32_16x16x32_bf16 v[76:79], v[108:111], v[164:167], v[76:79]
    v_mfma_f32_16x16x32_bf16 v[84:87], v[108:111], v[168:171], v[84:87]
    v_mfma_f32_16x16x32_bf16 v[92:95], v[108:111], v[172:175], v[92:95]
    s_waitcnt lgkmcnt(4)
    v_mfma_f32_16x16x32_bf16 v[64:67], v[112:115], v[176:179], v[64:67]
    v_mfma_f32_16x16x32_bf16 v[72:75], v[112:115], v[180:183], v[72:75]
    v_mfma_f32_16x16x32_bf16 v[80:83], v[112:115], v[184:187], v[80:83]
    v_mfma_f32_16x16x32_bf16 v[88:91], v[112:115], v[188:191], v[88:91]
    v_mfma_f32_16x16x32_bf16 v[68:71], v[116:119], v[176:179], v[68:71]
    v_mfma_f32_16x16x32_bf16 v[76:79], v[116:119], v[180:183], v[76:79]
    v_mfma_f32_16x16x32_bf16 v[84:87], v[116:119], v[184:187], v[84:87]
    v_mfma_f32_16x16x32_bf16 v[92:95], v[116:119], v[188:191], v[92:95]
    s_waitcnt lgkmcnt(0)
    v_mfma_f32_16x16x32_bf16 v[64:67], v[120:123], v[208:211], v[64:67]
    v_mfma_f32_16x16x32_bf16 v[72:75], v[120:123], v[212:215], v[72:75]
    v_mfma_f32_16x16x32_bf16 v[80:83], v[120:123], v[216:219], v[80:83]
    v_mfma_f32_16x16x32_bf16 v[88:91], v[120:123], v[220:223], v[88:91]
    v_mfma_f32_16x16x32_bf16 v[68:71], v[124:127], v[208:211], v[68:71]
    v_mfma_f32_16x16x32_bf16 v[76:79], v[124:127], v[212:215], v[76:79]
    v_mfma_f32_16x16x32_bf16 v[84:87], v[124:127], v[216:219], v[84:87]
    v_mfma_f32_16x16x32_bf16 v[92:95], v[124:127], v[220:223], v[92:95]
    v_mov_b32 v254, v15
    v_mov_b32 v255, v13
    s_and_b32 s64, s3, 3
    s_lshl_b32 s64, s64, 1
    s_lshr_b32 s65, s3, 2
    s_add_u32 s64, s64, s65
    s_lshl_b32 s64, s64, 4
    s_lshl_b32 s65, s4, 7
    s_add_u32 s64, s64, s65
    v_and_b32 v230, 15, v2
    v_add_u32 v230, s64, v230
    v_bfe_u32 v3, v2, 4, 1
    v_lshlrev_b32 v229, 5, v3
    v_lshrrev_b32 v3, 5, v2
    v_lshl_add_u32 v229, v3, 4, v229
    v_lshl_add_u32 v231, v230, 11, v229
    s_lshl_b32 s64, s5, 7
    v_add_u32 v231, s64, v231
    v_lshlrev_b32 v3, 2, v230
    v_add_u32 v3, 6709248, v3
    buffer_load_dwordx4 v[220:223], v231, s[8:11], 0 offen
    buffer_load_dwordx4 v[224:227], v231, s[8:11], 0 offen offset:64
    buffer_load_dword v228, v3, s[16:19], 0 offen sc1
    v_lshlrev_b32 v3, 4, v2
    s_lshl_b32 s64, s7, 11
    v_add_u32 v4, s64, v3
    v_lshrrev_b32 v5, 4, v2
    v_lshlrev_b32 v5, 4, v5
    s_lshl_b32 s64, s7, 6
    v_add_u32 v5, s64, v5
    v_mov_b32 v6, 4256
    ds_read_b32 v6, v6
    v_cvt_pk_bf16_f32 v32, v64, v65
    v_lshlrev_b32 v48, 16, v32
    v_and_b32 v49, 0xffff0000, v32
    v_mul_f32 v50, s72, v48
    v_mul_f32 v51, s72, v49
    v_exp_f32 v50, v50 clamp
    v_exp_f32 v51, v51 clamp
    v_max_f32 v48, 0, v48
    v_max_f32 v49, 0, v49
    v_add_f32 v48, v48, v50
    v_add_f32 v49, v49, v51
    v_min_f32 v56, v48, v49
    v_cvt_pk_bf16_f32 v32, v48, v49
    v_cvt_pk_bf16_f32 v33, v66, v67
    v_lshlrev_b32 v48, 16, v33
    v_and_b32 v49, 0xffff0000, v33
    v_mul_f32 v50, s72, v48
    v_mul_f32 v51, s72, v49
    v_exp_f32 v50, v50 clamp
    v_exp_f32 v51, v51 clamp
    v_max_f32 v48, 0, v48
    v_max_f32 v49, 0, v49
    v_add_f32 v48, v48, v50
    v_add_f32 v49, v49, v51
    v_min3_f32 v56, v48, v49, v56
    v_cvt_pk_bf16_f32 v33, v48, v49
    v_cvt_pk_bf16_f32 v34, v68, v69
    v_lshlrev_b32 v48, 16, v34
    v_and_b32 v49, 0xffff0000, v34
    v_mul_f32 v50, s72, v48
    v_mul_f32 v51, s72, v49
    v_exp_f32 v50, v50 clamp
    v_exp_f32 v51, v51 clamp
    v_max_f32 v48, 0, v48
    v_max_f32 v49, 0, v49
    v_add_f32 v48, v48, v50
    v_add_f32 v49, v49, v51
    v_min3_f32 v56, v48, v49, v56
    v_cvt_pk_bf16_f32 v34, v48, v49
    v_cvt_pk_bf16_f32 v35, v70, v71
    v_lshlrev_b32 v48, 16, v35
    v_and_b32 v49, 0xffff0000, v35
    v_mul_f32 v50, s72, v48
    v_mul_f32 v51, s72, v49
    v_exp_f32 v50, v50 clamp
    v_exp_f32 v51, v51 clamp
    v_max_f32 v48, 0, v48
    v_max_f32 v49, 0, v49
    v_add_f32 v48, v48, v50
    v_add_f32 v49, v49, v51
    v_min3_f32 v56, v48, v49, v56
    v_cvt_pk_bf16_f32 v35, v48, v49
    v_cvt_pk_bf16_f32 v36, v72, v73
    v_lshlrev_b32 v48, 16, v36
    v_and_b32 v49, 0xffff0000, v36
    v_mul_f32 v50, s72, v48
    v_mul_f32 v51, s72, v49
    v_exp_f32 v50, v50 clamp
    v_exp_f32 v51, v51 clamp
    v_max_f32 v48, 0, v48
    v_max_f32 v49, 0, v49
    v_add_f32 v48, v48, v50
    v_add_f32 v49, v49, v51
    v_min3_f32 v56, v48, v49, v56
    v_cvt_pk_bf16_f32 v36, v48, v49
    v_cvt_pk_bf16_f32 v37, v74, v75
    v_lshlrev_b32 v48, 16, v37
    v_and_b32 v49, 0xffff0000, v37
    v_mul_f32 v50, s72, v48
    v_mul_f32 v51, s72, v49
    v_exp_f32 v50, v50 clamp
    v_exp_f32 v51, v51 clamp
    v_max_f32 v48, 0, v48
    v_max_f32 v49, 0, v49
    v_add_f32 v48, v48, v50
    v_add_f32 v49, v49, v51
    v_min3_f32 v56, v48, v49, v56
    v_cvt_pk_bf16_f32 v37, v48, v49
    v_cvt_pk_bf16_f32 v38, v76, v77
    v_lshlrev_b32 v48, 16, v38
    v_and_b32 v49, 0xffff0000, v38
    v_mul_f32 v50, s72, v48
    v_mul_f32 v51, s72, v49
    v_exp_f32 v50, v50 clamp
    v_exp_f32 v51, v51 clamp
    v_max_f32 v48, 0, v48
    v_max_f32 v49, 0, v49
    v_add_f32 v48, v48, v50
    v_add_f32 v49, v49, v51
    v_min3_f32 v56, v48, v49, v56
    v_cvt_pk_bf16_f32 v38, v48, v49
    v_cvt_pk_bf16_f32 v39, v78, v79
    v_lshlrev_b32 v48, 16, v39
    v_and_b32 v49, 0xffff0000, v39
    v_mul_f32 v50, s72, v48
    v_mul_f32 v51, s72, v49
    v_exp_f32 v50, v50 clamp
    v_exp_f32 v51, v51 clamp
    v_max_f32 v48, 0, v48
    v_max_f32 v49, 0, v49
    v_add_f32 v48, v48, v50
    v_add_f32 v49, v49, v51
    v_min3_f32 v56, v48, v49, v56
    v_cvt_pk_bf16_f32 v39, v48, v49
    v_cmp_gt_f32 vcc, 0x3a800000, v56
    s_cbranch_vccnz phi_18_fix
phi_18_done:
    v_cvt_pk_bf16_f32 v40, v80, v81
    v_lshlrev_b32 v48, 16, v40
    v_and_b32 v49, 0xffff0000, v40
    v_mul_f32 v50, s72, v48
    v_mul_f32 v51, s72, v49
    v_exp_f32 v50, v50 clamp
    v_exp_f32 v51, v51 clamp
    v_max_f32 v48, 0, v48
    v_max_f32 v49, 0, v49
    v_add_f32 v48, v48, v50
    v_add_f32 v49, v49, v51
    v_min_f32 v56, v48, v49
    v_cvt_pk_bf16_f32 v40, v48, v49
    v_cvt_pk_bf16_f32 v41, v82, v83
    v_lshlrev_b32 v48, 16, v41
    v_and_b32 v49, 0xffff0000, v41
    v_mul_f32 v50, s72, v48
    v_mul_f32 v51, s72, v49
    v_exp_f32 v50, v50 clamp
    v_exp_f32 v51, v51 clamp
    v_max_f32 v48, 0, v48
    v_max_f32 v49, 0, v49
    v_add_f32 v48, v48, v50
    v_add_f32 v49, v49, v51
    v_min3_f32 v56, v48, v49, v56
    v_cvt_pk_bf16_f32 v41, v48, v49
    v_cvt_pk_bf16_f32 v42, v84, v85
    v_lshlrev_b32 v48, 16, v42
    v_and_b32 v49, 0xffff0000, v42
    v_mul_f32 v50, s72, v48
    v_mul_f32 v51, s72, v49
    v_exp_f32 v50, v50 clamp
    v_exp_f32 v51, v51 clamp
    v_max_f32 v48, 0, v48
    v_max_f32 v49, 0, v49
    v_add_f32 v48, v48, v50
    v_add_f32 v49, v49, v51
    v_min3_f32 v56, v48, v49, v56
    v_cvt_pk_bf16_f32 v42, v48, v49
    v_cvt_pk_bf16_f32 v43, v86, v87
    v_lshlrev_b32 v48, 16, v43
    v_and_b32 v49, 0xffff0000, v43
    v_mul_f32 v50, s72, v48
    v_mul_f32 v51, s72, v49
    v_exp_f32 v50, v50 clamp
    v_exp_f32 v51, v51 clamp
    v_max_f32 v48, 0, v48
    v_max_f32 v49, 0, v49
    v_add_f32 v48, v48, v50
    v_add_f32 v49, v49, v51
    v_min3_f32 v56, v48, v49, v56
    v_cvt_pk_bf16_f32 v43, v48, v49
    v_cvt_pk_bf16_f32 v44, v88, v89
    v_lshlrev_b32 v48, 16, v44
    v_and_b32 v49, 0xffff0000, v44
    v_mul_f32 v50, s72, v48
    v_mul_f32 v51, s72, v49
    v_exp_f32 v50, v50 clamp
    v_exp_f32 v51, v51 clamp
    v_max_f32 v48, 0, v48
    v_max_f32 v49, 0, v49
    v_add_f32 v48, v48, v50
    v_add_f32 v49, v49, v51
    v_min3_f32 v56, v48, v49, v56
    v_cvt_pk_bf16_f32 v44, v48, v49
    v_cvt_pk_bf16_f32 v45, v90, v91
    v_lshlrev_b32 v48, 16, v45
    v_and_b32 v49, 0xffff0000, v45
    v_mul_f32 v50, s72, v48
    v_mul_f32 v51, s72, v49
    v_exp_f32 v50, v50 clamp
    v_exp_f32 v51, v51 clamp
    v_max_f32 v48, 0, v48
    v_max_f32 v49, 0, v49
    v_add_f32 v48, v48, v50
    v_add_f32 v49, v49, v51
    v_min3_f32 v56, v48, v49, v56
    v_cvt_pk_bf16_f32 v45, v48, v49
    v_cvt_pk_bf16_f32 v46, v92, v93
    v_lshlrev_b32 v48, 16, v46
    v_and_b32 v49, 0xffff0000, v46
    v_mul_f32 v50, s72, v48
    v_mul_f32 v51, s72, v49
    v_exp_f32 v50, v50 clamp
    v_exp_f32 v51, v51 clamp
    v_max_f32 v48, 0, v48
    v_max_f32 v49, 0, v49
    v_add_f32 v48, v48, v50
    v_add_f32 v49, v49, v51
    v_min3_f32 v56, v48, v49, v56
    v_cvt_pk_bf16_f32 v46, v48, v49
    v_cvt_pk_bf16_f32 v47, v94, v95
    v_lshlrev_b32 v48, 16, v47
    v_and_b32 v49, 0xffff0000, v47
    v_mul_f32 v50, s72, v48
    v_mul_f32 v51, s72, v49
    v_exp_f32 v50, v50 clamp
    v_exp_f32 v51, v51 clamp
    v_max_f32 v48, 0, v48
    v_max_f32 v49, 0, v49
    v_add_f32 v48, v48, v50
    v_add_f32 v49, v49, v51
    v_min3_f32 v56, v48, v49, v56
    v_cvt_pk_bf16_f32 v47, v48, v49
    v_cmp_gt_f32 vcc, 0x3a800000, v56
    s_cbranch_vccnz phi_19_fix
phi_19_done:
    s_waitcnt lgkmcnt(0)
    v_readfirstlane_b32 s75, v6
    s_waitcnt vmcnt(0)
    v_sub_f32 v248, 1.0, v228
    v_cvt_pk_bf16_f32 v248, v248, v248
    v_lshlrev_b32 v248, 16, v248
    v_lshlrev_b32 v232, 16, v220
    v_and_b32 v233, 0xffff0000, v220
    v_mul_f32 v232, v232, v248
    v_mul_f32 v233, v233, v248
    v_cvt_pk_bf16_f32 v3, v232, v233
    v_lshlrev_b32 v232, 16, v3
    v_and_b32 v233, 0xffff0000, v3
    v_lshlrev_b32 v234, 16, v221
    v_and_b32 v235, 0xffff0000, v221
    v_mul_f32 v234, v234, v248
    v_mul_f32 v235, v235, v248
    v_cvt_pk_bf16_f32 v3, v234, v235
    v_lshlrev_b32 v234, 16, v3
    v_and_b32 v235, 0xffff0000, v3
    v_lshlrev_b32 v236, 16, v222
    v_and_b32 v237, 0xffff0000, v222
    v_mul_f32 v236, v236, v248
    v_mul_f32 v237, v237, v248
    v_cvt_pk_bf16_f32 v3, v236, v237
    v_lshlrev_b32 v236, 16, v3
    v_and_b32 v237, 0xffff0000, v3
    v_lshlrev_b32 v238, 16, v223
    v_and_b32 v239, 0xffff0000, v223
    v_mul_f32 v238, v238, v248
    v_mul_f32 v239, v239, v248
    v_cvt_pk_bf16_f32 v3, v238, v239
    v_lshlrev_b32 v238, 16, v3
    v_and_b32 v239, 0xffff0000, v3
    v_lshlrev_b32 v240, 16, v224
    v_and_b32 v241, 0xffff0000, v224
    v_mul_f32 v240, v240, v248
    v_mul_f32 v241, v241, v248
    v_cvt_pk_bf16_f32 v3, v240, v241
    v_lshlrev_b32 v240, 16, v3
    v_and_b32 v241, 0xffff0000, v3
    v_lshlrev_b32 v242, 16, v225
    v_and_b32 v243, 0xffff0000, v225
    v_mul_f32 v242, v242, v248
    v_mul_f32 v243, v243, v248
    v_cvt_pk_bf16_f32 v3, v242, v243
    v_lshlrev_b32 v242, 16, v3
    v_and_b32 v243, 0xffff0000, v3
    v_lshlrev_b32 v244, 16, v226
    v_and_b32 v245, 0xffff0000, v226
    v_mul_f32 v244, v244, v248
    v_mul_f32 v245, v245, v248
    v_cvt_pk_bf16_f32 v3, v244, v245
    v_lshlrev_b32 v244, 16, v3
    v_and_b32 v245, 0xffff0000, v3
    v_lshlrev_b32 v246, 16, v227
    v_and_b32 v247, 0xffff0000, v227
    v_mul_f32 v246, v246, v248
    v_mul_f32 v247, v247, v248
    v_cvt_pk_bf16_f32 v3, v246, v247
    v_lshlrev_b32 v246, 16, v3
    v_and_b32 v247, 0xffff0000, v3
    s_cmp_lg_u32 s3, 0
    s_cbranch_scc1 C_nh
    s_lshr_b32 s64, s2, 2
    s_lshl_b32 s64, s64, 14
    s_add_u32 s64, s64, 5398528
    v_lshl_add_u32 v16, v2, 4, s64
    v_lshrrev_b32 v8, 4, v2
    s_mov_b32 s65, 0
H_hl:
    s_mov_b32 s64, 0
    buffer_load_dwordx4 v[64:67], v16, s[16:19], s64 offen offset:0 sc1
    s_mov_b32 s64, 0
    buffer_load_dwordx4 v[68:71], v16, s[16:19], s64 offen offset:1024 sc1
    s_mov_b32 s64, 0
    buffer_load_dwordx4 v[72:75], v16, s[16:19], s64 offen offset:2048 sc1
    s_mov_b32 s64, 0
    buffer_load_dwordx4 v[76:79], v16, s[16:19], s64 offen offset:3072 sc1
    s_mov_b32 s64, 4096
    buffer_load_dwordx4 v[80:83], v16, s[16:19], s64 offen offset:0 sc1
    s_mov_b32 s64, 4096
    buffer_load_dwordx4 v[84:87], v16, s[16:19], s64 offen offset:1024 sc1
    s_mov_b32 s64, 4096
    buffer_load_dwordx4 v[88:91], v16, s[16:19], s64 offen offset:2048 sc1
    s_mov_b32 s64, 4096
    buffer_load_dwordx4 v[92:95], v16, s[16:19], s64 offen offset:3072 sc1
    s_mov_b32 s64, 8192
    buffer_load_dwordx4 v[96:99], v16, s[16:19], s64 offen offset:0 sc1
    s_mov_b32 s64, 8192
    buffer_load_dwordx4 v[100:103], v16, s[16:19], s64 offen offset:1024 sc1
    s_mov_b32 s64, 8192
    buffer_load_dwordx4 v[104:107], v16, s[16:19], s64 offen offset:2048 sc1
    s_mov_b32 s64, 8192
    buffer_load_dwordx4 v[108:111], v16, s[16:19], s64 offen offset:3072 sc1
    s_mov_b32 s64, 12288
    buffer_load_dwordx4 v[112:115], v16, s[16:19], s64 offen offset:0 sc1
    s_mov_b32 s64, 12288
    buffer_load_dwordx4 v[116:119], v16, s[16:19], s64 offen offset:1024 sc1
    s_mov_b32 s64, 12288
    buffer_load_dwordx4 v[120:123], v16, s[16:19], s64 offen offset:2048 sc1
    s_mov_b32 s64, 12288
    buffer_load_dwordx4 v[124:127], v16, s[16:19], s64 offen offset:3072 sc1
    s_waitcnt vmcnt(0)
    v_max3_u32 v17, v64, v65, v66
    v_max3_u32 v17, v67, v68, v17
    v_max3_u32 v17, v69, v70, v17
    v_max3_u32 v17, v71, v72, v17
    v_max3_u32 v17, v73, v74, v17
    v_max3_u32 v17, v75, v76, v17
    v_max3_u32 v17, v77, v78, v17
    v_max3_u32 v17, v79, v80, v17
    v_max3_u32 v17, v81, v82, v17
    v_max3_u32 v17, v83, v84, v17
    v_max3_u32 v17, v85, v86, v17
    v_max3_u32 v17, v87, v88, v17
    v_max3_u32 v17, v89, v90, v17
    v_max3_u32 v17, v91, v92, v17
    v_max3_u32 v17, v93, v94, v17
    v_max3_u32 v17, v95, v96, v17
    v_max3_u32 v17, v97, v98, v17
    v_max3_u32 v17, v99, v100, v17
    v_max3_u32 v17, v101, v102, v17
    v_max3_u32 v17, v103, v104, v17
    v_max3_u32 v17, v105, v106, v17
    v_max3_u32 v17, v107, v108, v17
    v_max3_u32 v17, v109, v110, v17
    v_max3_u32 v17, v111, v112, v17
    v_max3_u32 v17, v113, v114, v17
    v_max3_u32 v17, v115, v116, v17
    v_max3_u32 v17, v117, v118, v17
    v_max3_u32 v17, v119, v120, v17
    v_max3_u32 v17, v121, v122, v17
    v_max3_u32 v17, v123, v124, v17
    v_max3_u32 v17, v125, v126, v17
    v_max_u32 v17, v127, v17
    s_mov_b32 exec_lo, 0x3fff3fff
    s_mov_b32 exec_hi, 0x3fff3fff
    v_cmp_eq_u32 vcc, -1, v17
    s_mov_b64 exec, -1
    s_cbranch_vccz H_hok
    s_add_u32 s65, s65, 1
    s_cmp_ge_u32 s65, 100000
    s_cbranch_scc1 H_hok
    s_sleep 8
    s_branch H_hl
H_hok:
    v_add_f32 v64, v64, v68
    v_add_f32 v65, v65, v69
    v_add_f32 v66, v66, v70
    v_add_f32 v67, v67, v71
    v_add_f32 v64, v64, v72
    v_add_f32 v65, v65, v73
    v_add_f32 v66, v66, v74
    v_add_f32 v67, v67, v75
    v_add_f32 v64, v64, v76
    v_add_f32 v65, v65, v77
    v_add_f32 v66, v66, v78
    v_add_f32 v67, v67, v79
    v_add_f32 v64, v64, v80
    v_add_f32 v65, v65, v81
    v_add_f32 v66, v66, v82
    v_add_f32 v67, v67, v83
    v_add_f32 v64, v64, v84
    v_add_f32 v65, v65, v85
    v_add_f32 v66, v66, v86
    v_add_f32 v67, v67, v87
    v_add_f32 v64, v64, v88
    v_add_f32 v65, v65, v89
    v_add_f32 v66, v66, v90
    v_add_f32 v67, v67, v91
    v_add_f32 v64, v64, v92
    v_add_f32 v65, v65, v93
    v_add_f32 v66, v66, v94
    v_add_f32 v67, v67, v95
    v_add_f32 v96, v96, v100
    v_add_f32 v97, v97, v101
    v_add_f32 v98, v98, v102
    v_add_f32 v99, v99, v103
    v_add_f32 v96, v96, v104
    v_add_f32 v97, v97, v105
    v_add_f32 v98, v98, v106
    v_add_f32 v99, v99, v107
    v_add_f32 v96, v96, v108
    v_add_f32 v97, v97, v109
    v_add_f32 v98, v98, v110
    v_add_f32 v99, v99, v111
    v_add_f32 v96, v96, v112
    v_add_f32 v97, v97, v113
    v_add_f32 v98, v98, v114
    v_add_f32 v99, v99, v115
    v_add_f32 v96, v96, v116
    v_add_f32 v97, v97, v117
    v_add_f32 v98, v98, v118
    v_add_f32 v99, v99, v119
    v_add_f32 v96, v96, v120
    v_add_f32 v97, v97, v121
    v_add_f32 v98, v98, v122
    v_add_f32 v99, v99, v123
    v_add_f32 v96, v96, v124
    v_add_f32 v97, v97, v125
    v_add_f32 v98, v98, v126
    v_add_f32 v99, v99, v127
    s_nop 1
    v_permlane16_swap_b32 v64, v96
    v_permlane16_swap_b32 v65, v97
    v_permlane16_swap_b32 v66, v98
    v_permlane16_swap_b32 v67, v99
    v_add_f32 v64, v64, v96
    v_add_f32 v65, v65, v97
    v_add_f32 v66, v66, v98
    v_add_f32 v67, v67, v99
    s_nop 1
    v_permlane32_swap_b32 v64, v66
    v_permlane32_swap_b32 v65, v67
    v_add_f32 v64, v64, v66
    v_add_f32 v65, v65, v67
    s_nop 1
    v_permlane16_swap_b32 v64, v65
    v_cvt_pk_bf16_f32 v66, v64, v65
    v_lshlrev_b32 v64, 16, v66
    v_and_b32 v65, 0xffff0000, v66
    v_mul_f32 v66, s72, v64
    v_exp_f32 v66, -v66
    v_and_b32 v16, 15, v2
    v_add_f32 v66, 1.0, v66
    v_rcp_f32 v66, v66
    v_lshl_add_u32 v16, v16, 2, v8
    v_mul_f32 v66, v66, v64
    v_cvt_pk_bf16_f32 v66, v66, v66
    v_lshlrev_b32 v66, 16, v66
    v_mul_f32 v66, v66, v65
    v_cvt_pk_bf16_f32 v66, v66, v66
    v_lshlrev_b32 v66, 16, v66
    v_lshlrev_b32 v16, 2, v16
    ds_write_b32 v16, v66 offset:4352
    s_waitcnt lgkmcnt(0)
C_nh:
    v_lshlrev_b32 v3, 4, v2
    s_barrier
    ds_read_b128 v[24:27], v5 offset:4096
    ds_read_b128 v[16:19], v4 offset:0
    ds_read_b128 v[20:23], v4 offset:1024
    s_waitcnt lgkmcnt(2)
    v_mfma_f32_16x16x32_bf16 v[96:99], v[24:27], v[32:35], 0
    v_mfma_f32_16x16x32_bf16 v[100:103], v[24:27], v[36:39], 0
    v_mfma_f32_16x16x32_bf16 v[104:107], v[24:27], v[40:43], 0
    v_mfma_f32_16x16x32_bf16 v[108:111], v[24:27], v[44:47], 0
    s_waitcnt lgkmcnt(0)
    v_mfma_f32_16x16x32_bf16 v[64:67], v[16:19], v[32:35], 0
    v_mfma_f32_16x16x32_bf16 v[68:71], v[20:23], v[32:35], 0
    v_mfma_f32_16x16x32_bf16 v[72:75], v[16:19], v[36:39], 0
    v_mfma_f32_16x16x32_bf16 v[76:79], v[20:23], v[36:39], 0
    v_mfma_f32_16x16x32_bf16 v[80:83], v[16:19], v[40:43], 0
    v_mfma_f32_16x16x32_bf16 v[84:87], v[20:23], v[40:43], 0
    v_mfma_f32_16x16x32_bf16 v[88:91], v[16:19], v[44:47], 0
    v_mfma_f32_16x16x32_bf16 v[92:95], v[20:23], v[44:47], 0
    v_cvt_pk_bf16_f32 v48, v96, v96
    v_cvt_pk_bf16_f32 v49, v100, v100
    v_cvt_pk_bf16_f32 v50, v104, v104
    v_cvt_pk_bf16_f32 v51, v108, v108
    v_lshlrev_b32 v48, 16, v48
    v_lshlrev_b32 v49, 16, v49
    v_lshlrev_b32 v50, 16, v50
    v_lshlrev_b32 v51, 16, v51
    v_add_f32 v48, s73, v48
    v_add_f32 v49, s73, v49
    v_add_f32 v50, s73, v50
    v_add_f32 v51, s73, v51
    v_cvt_pk_bf16_f32 v48, v48, v48
    v_cvt_pk_bf16_f32 v49, v49, v49
    v_cvt_pk_bf16_f32 v50, v50, v50
    v_cvt_pk_bf16_f32 v51, v51, v51
    v_lshlrev_b32 v48, 16, v48
    v_lshlrev_b32 v49, 16, v49
    v_lshlrev_b32 v50, 16, v50
    v_lshlrev_b32 v51, 16, v51
    v_rcp_f32 v48, v48
    v_rcp_f32 v49, v49
    v_rcp_f32 v50, v50
    v_rcp_f32 v51, v51
    s_nop 0
    v_mul_f32 v64, v64, v48
    v_mul_f32 v65, v65, v48
    v_cvt_pk_bf16_f32 v128, v64, v65
    v_mul_f32 v66, v66, v48
    v_mul_f32 v67, v67, v48
    v_cvt_pk_bf16_f32 v129, v66, v67
    v_mul_f32 v68, v68, v48
    v_mul_f32 v69, v69, v48
    v_cvt_pk_bf16_f32 v130, v68, v69
    v_mul_f32 v70, v70, v48
    v_mul_f32 v71, v71, v48
    v_cvt_pk_bf16_f32 v131, v70, v71
    buffer_store_dwordx4 v[128:131], v1, s[16:19], s42 offen offset:0 sc0 sc1
    v_mul_f32 v72, v72, v49
    v_mul_f32 v73, v73, v49
    v_cvt_pk_bf16_f32 v132, v72, v73
    v_mul_f32 v74, v74, v49
    v_mul_f32 v75, v75, v49
    v_cvt_pk_bf16_f32 v133, v74, v75
    v_mul_f32 v76, v76, v49
    v_mul_f32 v77, v77, v49
    v_cvt_pk_bf16_f32 v134, v76, v77
    v_mul_f32 v78, v78, v49
    v_mul_f32 v79, v79, v49
    v_cvt_pk_bf16_f32 v135, v78, v79
    buffer_store_dwordx4 v[132:135], v1, s[16:19], s42 offen offset:1024 sc0 sc1
    s_add_u32 s42, s42, 65536
    v_mul_f32 v80, v80, v50
    v_mul_f32 v81, v81, v50
    v_cvt_pk_bf16_f32 v136, v80, v81
    v_mul_f32 v82, v82, v50
    v_mul_f32 v83, v83, v50
    v_cvt_pk_bf16_f32 v137, v82, v83
    v_mul_f32 v84, v84, v50
    v_mul_f32 v85, v85, v50
    v_cvt_pk_bf16_f32 v138, v84, v85
    v_mul_f32 v86, v86, v50
    v_mul_f32 v87, v87, v50
    v_cvt_pk_bf16_f32 v139, v86, v87
    buffer_store_dwordx4 v[136:139], v1, s[16:19], s42 offen offset:0 sc0 sc1
    v_mul_f32 v88, v88, v51
    v_mul_f32 v89, v89, v51
    v_cvt_pk_bf16_f32 v140, v88, v89
    v_mul_f32 v90, v90, v51
    v_mul_f32 v91, v91, v51
    v_cvt_pk_bf16_f32 v141, v90, v91
    v_mul_f32 v92, v92, v51
    v_mul_f32 v93, v93, v51
    v_cvt_pk_bf16_f32 v142, v92, v93
    v_mul_f32 v94, v94, v51
    v_mul_f32 v95, v95, v51
    v_cvt_pk_bf16_f32 v143, v94, v95
    buffer_store_dwordx4 v[140:143], v1, s[16:19], s42 offen offset:1024 sc0 sc1
    s_lshl_b32 s64, s4, 3
    s_add_u32 s64, s64, s3
    s_lshl_b32 s64, s64, 7
    s_add_u32 s64, s64, 5382144
    v_mov_b32 v14, s64
    s_mov_b64 exec, 1
    v_mov_b32 v15, 0
    buffer_atomic_or v15, v14, s[16:19], 0 offen sc0
    s_mov_b64 exec, -1
P2_start:
    s_and_b32 s6, s3, 3
    s_lshr_b32 s7, s3, 2
    s_mov_b32 s20, s58
    s_mov_b32 s21, s59
    s_mov_b32 s22, 0x400000
    s_mov_b32 s23, 0x00020000
    s_and_b32 s67, s75, 0x7ff
    s_sub_u32 s67, 2047, s67
    s_lshl_b32 s64, s4, 2
    s_add_u32 s64, s64, s6
    s_lshl_b32 s64, s64, 16
    s_lshl_b32 s65, s7, 15
    s_add_u32 s64, s64, s65
    s_lshl_b32 s65, s7, 10
    s_add_u32 s66, s64, s65
    s_xor_b32 s64, s66, 1024
    v_lshlrev_b32 v12, 4, v2
    v_add_u32 v4, s66, v12
    v_add_u32 v12, s64, v12
    v_lshrrev_b32 v10, 4, v2
    v_bfe_u32 v11, v2, 2, 2
    v_lshl_add_u32 v10, v10, 2, v11
    v_bfe_u32 v13, v10, 1, 2
    v_lshlrev_b32 v10, 7, v10
    v_lshl_add_u32 v10, v13, 5, v10
    v_and_b32 v13, 3, v2
    v_lshl_add_u32 v5, v13, 3, v10
    v_xor_b32 v6, 32, v5
    v_xor_b32 v1, 64, v5
    v_xor_b32 v3, 96, v5
    s_and_b32 s74, s5, 7
    s_lshl_b32 s74, s74, 1
    s_cmp_eq_u32 s7, 0
    s_mov_b32 s64, 147456
    s_cselect_b32 s64, 131072, s64
    s_sub_u32 m0, 16, s74
    s_and_b32 m0, m0, 15
    v_writelane_b32 v7, s64, m0
    s_cmp_eq_u32 s7, 0
    s_mov_b32 s64, 155648
    s_cselect_b32 s64, 139264, s64
    s_sub_u32 m0, 18, s74
    s_and_b32 m0, m0, 15
    v_writelane_b32 v7, s64, m0
    s_cmp_eq_u32 s7, 0
    s_mov_b32 s64, 81920
    s_cselect_b32 s64, 73728, s64
    s_sub_u32 m0, 20, s74
    s_and_b32 m0, m0, 15
    v_writelane_b32 v7, s64, m0
    s_cmp_eq_u32 s7, 0
    s_mov_b32 s64, 122880
    s_cselect_b32 s64, 114688, s64
    s_sub_u32 m0, 22, s74
    s_and_b32 m0, m0, 15
    v_writelane_b32 v7, s64, m0
    s_cmp_eq_u32 s7, 0
    s_mov_b32 s64, 49152
    s_cselect_b32 s64, 40960, s64
    s_sub_u32 m0, 24, s74
    s_and_b32 m0, m0, 15
    v_writelane_b32 v7, s64, m0
    s_cmp_eq_u32 s7, 0
    s_mov_b32 s64, 57344
    s_cselect_b32 s64, 8192, s64
    s_sub_u32 m0, 26, s74
    s_and_b32 m0, m0, 15
    v_writelane_b32 v7, s64, m0
    s_cmp_eq_u32 s7, 0
    s_mov_b32 s64, 65536
    s_cselect_b32 s64, 16384, s64
    s_sub_u32 m0, 28, s74
    s_and_b32 m0, m0, 15
    v_writelane_b32 v7, s64, m0
    s_cmp_eq_u32 s7, 0
    s_mov_b32 s64, 90112
    s_cselect_b32 s64, 98304, s64
    s_sub_u32 m0, 30, s74
    s_and_b32 m0, m0, 15
    v_writelane_b32 v7, s64, m0
    s_cmp_eq_u32 s7, 0
    v_mov_b32 v16, 0
    v_mov_b32 v17, 0
    v_mov_b32 v18, 0
    v_mov_b32 v19, 0
    v_mov_b32 v20, 0
    v_mov_b32 v21, 0
    v_mov_b32 v22, 0
    v_mov_b32 v23, 0
    v_mov_b32 v24, 0
    v_mov_b32 v25, 0
    v_mov_b32 v26, 0
    v_mov_b32 v27, 0
    v_mov_b32 v28, 0
    v_mov_b32 v29, 0
    v_mov_b32 v30, 0
    v_mov_b32 v31, 0
    v_mov_b32 v32, 0
    v_mov_b32 v33, 0
    v_mov_b32 v34, 0
    v_mov_b32 v35, 0
    v_mov_b32 v36, 0
    v_mov_b32 v37, 0
    v_mov_b32 v38, 0
    v_mov_b32 v39, 0
    v_mov_b32 v40, 0
    v_mov_b32 v41, 0
    v_mov_b32 v42, 0
    v_mov_b32 v43, 0
    v_mov_b32 v44, 0
    v_mov_b32 v45, 0
    v_mov_b32 v46, 0
    v_mov_b32 v47, 0
    v_mov_b32 v209, 0
    v_mov_b32 v215, 0
    s_lshr_b32 s46, s67, 7
    s_xor_b32 s46, s46, s4
    s_or_b32 s46, s46, s7
    s_mov_b32 s47, 0
    s_cbranch_scc0 P2_ys
P2_ysd:
    s_mov_b32 s66, 0x5555
    s_mov_b32 s65, 0
    s_cmp_lt_u32 s3, 4
    s_cbranch_scc0 D_wait
    s_waitcnt vmcnt(1)
    s_mov_b64 exec, 3
    buffer_atomic_or v255, v254, s[16:19], 0 offen
    s_mov_b64 exec, -1
    s_waitcnt vmcnt(1)
    s_branch D_got
D_wait:
    s_waitcnt vmcnt(0)
D_got:
    v_readfirstlane_b32 s68, v15
    s_mul_i32 s68, s68, 0x10001
    s_lshr_b32 s68, s68, s74
    s_lshr_b32 s64, s68, 1
    s_and_b32 s68, s68, s64
    s_and_b32 s68, s68, s66
    s_cbranch_scc1 D_go
    s_add_u32 s65, s65, 1
    s_cmp_ge_u32 s65, 40000
    s_cbranch_scc1 D_end
    s_sleep 1
    s_mov_b64 exec, 1
    v_mov_b32 v15, 0
    buffer_atomic_or v15, v14, s[16:19], 0 offen sc0
    s_mov_b64 exec, -1
    s_branch D_wait
D_go:
    s_andn2_b32 s66, s66, s68
    s_bcnt1_i32_b32 s70, s68
    s_or_b32 s64, s46, s66
    s_cbranch_scc0 P2_yl
P2_nyl:
    s_cmp_gt_u32 s70, 4
    s_cbranch_scc1 D_t58
    s_cmp_gt_u32 s70, 2
    s_cbranch_scc1 D_t34
    s_cmp_eq_u32 s70, 2
    s_cbranch_scc1 D_e2
D_e1:
    s_ff1_i32_b32 s64, s68
    s_bitset0_b32 s68, s64
    v_readlane_b32 s32, v7, s64
    s_add_u32 s69, s64, s74
    s_and_b32 s69, s69, 15
    s_lshl_b32 s69, s69, 11
    buffer_load_dwordx4 v[80:83], v4, s[16:19], s69 offen sc1
    buffer_load_dwordx4 v[84:87], v12, s[16:19], s69 offen sc1
    s_add_u32 s69, s69, 2048
    buffer_load_dwordx4 v[88:91], v4, s[16:19], s69 offen sc1
    buffer_load_dwordx4 v[92:95], v12, s[16:19], s69 offen sc1
    s_mov_b64 exec, 1
    v_mov_b32 v15, 0
    buffer_atomic_or v15, v14, s[16:19], 0 offen sc0
    s_mov_b64 exec, -1
    v_add_u32 v8, s32, v5
    ds_read_b64_tr_b16 v[48:49], v8 offset:0
    ds_read_b64_tr_b16 v[50:51], v8 offset:2048
    v_add_u32 v9, s32, v6
    ds_read_b64_tr_b16 v[52:53], v9 offset:0
    ds_read_b64_tr_b16 v[54:55], v9 offset:2048
    v_add_u32 v10, s32, v1
    ds_read_b64_tr_b16 v[56:57], v10 offset:0
    ds_read_b64_tr_b16 v[58:59], v10 offset:2048
    v_add_u32 v11, s32, v3
    ds_read_b64_tr_b16 v[60:61], v11 offset:0
    ds_read_b64_tr_b16 v[62:63], v11 offset:2048
    s_branch D_p0
D_e2:
    s_ff1_i32_b32 s64, s68
    s_bitset0_b32 s68, s64
    v_readlane_b32 s33, v7, s64
    s_add_u32 s69, s64, s74
    s_and_b32 s69, s69, 15
    s_lshl_b32 s69, s69, 11
    buffer_load_dwordx4 v[96:99], v4, s[16:19], s69 offen sc1
    buffer_load_dwordx4 v[100:103], v12, s[16:19], s69 offen sc1
    s_add_u32 s69, s69, 2048
    buffer_load_dwordx4 v[104:107], v4, s[16:19], s69 offen sc1
    buffer_load_dwordx4 v[108:111], v12, s[16:19], s69 offen sc1
    s_ff1_i32_b32 s64, s68
    s_bitset0_b32 s68, s64
    v_readlane_b32 s32, v7, s64
    s_add_u32 s69, s64, s74
    s_and_b32 s69, s69, 15
    s_lshl_b32 s69, s69, 11
    buffer_load_dwordx4 v[80:83], v4, s[16:19], s69 offen sc1
    buffer_load_dwordx4 v[84:87], v12, s[16:19], s69 offen sc1
    s_add_u32 s69, s69, 2048
    buffer_load_dwordx4 v[88:91], v4, s[16:19], s69 offen sc1
    buffer_load_dwordx4 v[92:95], v12, s[16:19], s69 offen sc1
    s_mov_b64 exec, 1
    v_mov_b32 v15, 0
    buffer_atomic_or v15, v14, s[16:19], 0 offen sc0
    s_mov_b64 exec, -1
    v_add_u32 v8, s33, v5
    ds_read_b64_tr_b16 v[48:49], v8 offset:0
    ds_read_b64_tr_b16 v[50:51], v8 offset:2048
    v_add_u32 v9, s33, v6
    ds_read_b64_tr_b16 v[52:53], v9 offset:0
    ds_read_b64_tr_b16 v[54:55], v9 offset:2048
    v_add_u32 v10, s33, v1
    ds_read_b64_tr_b16 v[56:57], v10 offset:0
    ds_read_b64_tr_b16 v[58:59], v10 offset:2048
    v_add_u32 v11, s33, v3
    ds_read_b64_tr_b16 v[60:61], v11 offset:0
    ds_read_b64_tr_b16 v[62:63], v11 offset:2048
    s_branch D_p1
D_t34:
    s_cmp_eq_u32 s70, 4
    s_cbranch_scc1 D_e4
D_e3:
    s_ff1_i32_b32 s64, s68
    s_bitset0_b32 s68, s64
    v_readlane_b32 s34, v7, s64
    s_add_u32 s69, s64, s74
    s_and_b32 s69, s69, 15
    s_lshl_b32 s69, s69, 11
    buffer_load_dwordx4 v[112:115], v4, s[16:19], s69 offen sc1
    buffer_load_dwordx4 v[116:119], v12, s[16:19], s69 offen sc1
    s_add_u32 s69, s69, 2048
    buffer_load_dwordx4 v[120:123], v4, s[16:19], s69 offen sc1
    buffer_load_dwordx4 v[124:127], v12, s[16:19], s69 offen sc1
    s_ff1_i32_b32 s64, s68
    s_bitset0_b32 s68, s64
    v_readlane_b32 s33, v7, s64
    s_add_u32 s69, s64, s74
    s_and_b32 s69, s69, 15
    s_lshl_b32 s69, s69, 11
    buffer_load_dwordx4 v[96:99], v4, s[16:19], s69 offen sc1
    buffer_load_dwordx4 v[100:103], v12, s[16:19], s69 offen sc1
    s_add_u32 s69, s69, 2048
    buffer_load_dwordx4 v[104:107], v4, s[16:19], s69 offen sc1
    buffer_load_dwordx4 v[108:111], v12, s[16:19], s69 offen sc1
    v_add_u32 v8, s34, v5
    ds_read_b64_tr_b16 v[48:49], v8 offset:0
    ds_read_b64_tr_b16 v[50:51], v8 offset:2048
    v_add_u32 v9, s34, v6
    ds_read_b64_tr_b16 v[52:53], v9 offset:0
    ds_read_b64_tr_b16 v[54:55], v9 offset:2048
    v_add_u32 v10, s34, v1
    ds_read_b64_tr_b16 v[56:57], v10 offset:0
    ds_read_b64_tr_b16 v[58:59], v10 offset:2048
    v_add_u32 v11, s34, v3
    ds_read_b64_tr_b16 v[60:61], v11 offset:0
    ds_read_b64_tr_b16 v[62:63], v11 offset:2048
    s_branch D_p2
D_e4:
    s_ff1_i32_b32 s64, s68
    s_bitset0_b32 s68, s64
    v_readlane_b32 s35, v7, s64
    s_add_u32 s69, s64, s74
    s_and_b32 s69, s69, 15
    s_lshl_b32 s69, s69, 11
    buffer_load_dwordx4 v[128:131], v4, s[16:19], s69 offen sc1
    buffer_load_dwordx4 v[132:135], v12, s[16:19], s69 offen sc1
    s_add_u32 s69, s69, 2048
    buffer_load_dwordx4 v[136:139], v4, s[16:19], s69 offen sc1
    buffer_load_dwordx4 v[140:143], v12, s[16:19], s69 offen sc1
    s_ff1_i32_b32 s64, s68
    s_bitset0_b32 s68, s64
    v_readlane_b32 s34, v7, s64
    s_add_u32 s69, s64, s74
    s_and_b32 s69, s69, 15
    s_lshl_b32 s69, s69, 11
    buffer_load_dwordx4 v[112:115], v4, s[16:19], s69 offen sc1
    buffer_load_dwordx4 v[116:119], v12, s[16:19], s69 offen sc1
    s_add_u32 s69, s69, 2048
    buffer_load_dwordx4 v[120:123], v4, s[16:19], s69 offen sc1
    buffer_load_dwordx4 v[124:127], v12, s[16:19], s69 offen sc1
    v_add_u32 v8, s35, v5
    ds_read_b64_tr_b16 v[48:49], v8 offset:0
    ds_read_b64_tr_b16 v[50:51], v8 offset:2048
    v_add_u32 v9, s35, v6
    ds_read_b64_tr_b16 v[52:53], v9 offset:0
    ds_read_b64_tr_b16 v[54:55], v9 offset:2048
    v_add_u32 v10, s35, v1
    ds_read_b64_tr_b16 v[56:57], v10 offset:0
    ds_read_b64_tr_b16 v[58:59], v10 offset:2048
    v_add_u32 v11, s35, v3
    ds_read_b64_tr_b16 v[60:61], v11 offset:0
    ds_read_b64_tr_b16 v[62:63], v11 offset:2048
    s_branch D_p3
D_t58:
    s_cmp_gt_u32 s70, 6
    s_cbranch_scc1 D_t78
    s_cmp_eq_u32 s70, 6
    s_cbranch_scc1 D_e6
D_e5:
    s_ff1_i32_b32 s64, s68
    s_bitset0_b32 s68, s64
    v_readlane_b32 s36, v7, s64
    s_add_u32 s69, s64, s74
    s_and_b32 s69, s69, 15
    s_lshl_b32 s69, s69, 11
    buffer_load_dwordx4 v[144:147], v4, s[16:19], s69 offen sc1
    buffer_load_dwordx4 v[148:151], v12, s[16:19], s69 offen sc1
    s_add_u32 s69, s69, 2048
    buffer_load_dwordx4 v[152:155], v4, s[16:19], s69 offen sc1
    buffer_load_dwordx4 v[156:159], v12, s[16:19], s69 offen sc1
    s_ff1_i32_b32 s64, s68
    s_bitset0_b32 s68, s64
    v_readlane_b32 s35, v7, s64
    s_add_u32 s69, s64, s74
    s_and_b32 s69, s69, 15
    s_lshl_b32 s69, s69, 11
    buffer_load_dwordx4 v[128:131], v4, s[16:19], s69 offen sc1
    buffer_load_dwordx4 v[132:135], v12, s[16:19], s69 offen sc1
    s_add_u32 s69, s69, 2048
    buffer_load_dwordx4 v[136:139], v4, s[16:19], s69 offen sc1
    buffer_load_dwordx4 v[140:143], v12, s[16:19], s69 offen sc1
    v_add_u32 v8, s36, v5
    ds_read_b64_tr_b16 v[48:49], v8 offset:0
    ds_read_b64_tr_b16 v[50:51], v8 offset:2048
    v_add_u32 v9, s36, v6
    ds_read_b64_tr_b16 v[52:53], v9 offset:0
    ds_read_b64_tr_b16 v[54:55], v9 offset:2048
    v_add_u32 v10, s36, v1
    ds_read_b64_tr_b16 v[56:57], v10 offset:0
    ds_read_b64_tr_b16 v[58:59], v10 offset:2048
    v_add_u32 v11, s36, v3
    ds_read_b64_tr_b16 v[60:61], v11 offset:0
    ds_read_b64_tr_b16 v[62:63], v11 offset:2048
    s_branch D_p4
D_e6:
    s_ff1_i32_b32 s64, s68
    s_bitset0_b32 s68, s64
    v_readlane_b32 s37, v7, s64
    s_add_u32 s69, s64, s74
    s_and_b32 s69, s69, 15
    s_lshl_b32 s69, s69, 11
    buffer_load_dwordx4 v[160:163], v4, s[16:19], s69 offen sc1
    buffer_load_dwordx4 v[164:167], v12, s[16:19], s69 offen sc1
    s_add_u32 s69, s69, 2048
    buffer_load_dwordx4 v[168:171], v4, s[16:19], s69 offen sc1
    buffer_load_dwordx4 v[172:175], v12, s[16:19], s69 offen sc1
    s_ff1_i32_b32 s64, s68
    s_bitset0_b32 s68, s64
    v_readlane_b32 s36, v7, s64
    s_add_u32 s69, s64, s74
    s_and_b32 s69, s69, 15
    s_lshl_b32 s69, s69, 11
    buffer_load_dwordx4 v[144:147], v4, s[16:19], s69 offen sc1
    buffer_load_dwordx4 v[148:151], v12, s[16:19], s69 offen sc1
    s_add_u32 s69, s69, 2048
    buffer_load_dwordx4 v[152:155], v4, s[16:19], s69 offen sc1
    buffer_load_dwordx4 v[156:159], v12, s[16:19], s69 offen sc1
    v_add_u32 v8, s37, v5
    ds_read_b64_tr_b16 v[48:49], v8 offset:0
    ds_read_b64_tr_b16 v[50:51], v8 offset:2048
    v_add_u32 v9, s37, v6
    ds_read_b64_tr_b16 v[52:53], v9 offset:0
    ds_read_b64_tr_b16 v[54:55], v9 offset:2048
    v_add_u32 v10, s37, v1
    ds_read_b64_tr_b16 v[56:57], v10 offset:0
    ds_read_b64_tr_b16 v[58:59], v10 offset:2048
    v_add_u32 v11, s37, v3
    ds_read_b64_tr_b16 v[60:61], v11 offset:0
    ds_read_b64_tr_b16 v[62:63], v11 offset:2048
    s_branch D_p5
D_t78:
    s_cmp_eq_u32 s70, 8
    s_cbranch_scc1 D_e8
D_e7:
    s_ff1_i32_b32 s64, s68
    s_bitset0_b32 s68, s64
    v_readlane_b32 s38, v7, s64
    s_add_u32 s69, s64, s74
    s_and_b32 s69, s69, 15
    s_lshl_b32 s69, s69, 11
    buffer_load_dwordx4 v[176:179], v4, s[16:19], s69 offen sc1
    buffer_load_dwordx4 v[180:183], v12, s[16:19], s69 offen sc1
    s_add_u32 s69, s69, 2048
    buffer_load_dwordx4 v[184:187], v4, s[16:19], s69 offen sc1
    buffer_load_dwordx4 v[188:191], v12, s[16:19], s69 offen sc1
    s_ff1_i32_b32 s64, s68
    s_bitset0_b32 s68, s64
    v_readlane_b32 s37, v7, s64
    s_add_u32 s69, s64, s74
    s_and_b32 s69, s69, 15
    s_lshl_b32 s69, s69, 11
    buffer_load_dwordx4 v[160:163], v4, s[16:19], s69 offen sc1
    buffer_load_dwordx4 v[164:167], v12, s[16:19], s69 offen sc1
    s_add_u32 s69, s69, 2048
    buffer_load_dwordx4 v[168:171], v4, s[16:19], s69 offen sc1
    buffer_load_dwordx4 v[172:175], v12, s[16:19], s69 offen sc1
    v_add_u32 v8, s38, v5
    ds_read_b64_tr_b16 v[48:49], v8 offset:0
    ds_read_b64_tr_b16 v[50:51], v8 offset:2048
    v_add_u32 v9, s38, v6
    ds_read_b64_tr_b16 v[52:53], v9 offset:0
    ds_read_b64_tr_b16 v[54:55], v9 offset:2048
    v_add_u32 v10, s38, v1
    ds_read_b64_tr_b16 v[56:57], v10 offset:0
    ds_read_b64_tr_b16 v[58:59], v10 offset:2048
    v_add_u32 v11, s38, v3
    ds_read_b64_tr_b16 v[60:61], v11 offset:0
    ds_read_b64_tr_b16 v[62:63], v11 offset:2048
    s_branch D_p6
D_e8:
    s_ff1_i32_b32 s64, s68
    s_bitset0_b32 s68, s64
    v_readlane_b32 s39, v7, s64
    s_add_u32 s69, s64, s74
    s_and_b32 s69, s69, 15
    s_lshl_b32 s69, s69, 11
    buffer_load_dwordx4 v[192:195], v4, s[16:19], s69 offen sc1
    buffer_load_dwordx4 v[196:199], v12, s[16:19], s69 offen sc1
    s_add_u32 s69, s69, 2048
    buffer_load_dwordx4 v[200:203], v4, s[16:19], s69 offen sc1
    buffer_load_dwordx4 v[204:207], v12, s[16:19], s69 offen sc1
    s_ff1_i32_b32 s64, s68
    s_bitset0_b32 s68, s64
    v_readlane_b32 s38, v7, s64
    s_add_u32 s69, s64, s74
    s_and_b32 s69, s69, 15
    s_lshl_b32 s69, s69, 11
    buffer_load_dwordx4 v[176:179], v4, s[16:19], s69 offen sc1
    buffer_load_dwordx4 v[180:183], v12, s[16:19], s69 offen sc1
    s_add_u32 s69, s69, 2048
    buffer_load_dwordx4 v[184:187], v4, s[16:19], s69 offen sc1
    buffer_load_dwordx4 v[188:191], v12, s[16:19], s69 offen sc1
    v_add_u32 v8, s39, v5
    ds_read_b64_tr_b16 v[48:49], v8 offset:0
    ds_read_b64_tr_b16 v[50:51], v8 offset:2048
    v_add_u32 v9, s39, v6
    ds_read_b64_tr_b16 v[52:53], v9 offset:0
    ds_read_b64_tr_b16 v[54:55], v9 offset:2048
    v_add_u32 v10, s39, v1
    ds_read_b64_tr_b16 v[56:57], v10 offset:0
    ds_read_b64_tr_b16 v[58:59], v10 offset:2048
    v_add_u32 v11, s39, v3
    ds_read_b64_tr_b16 v[60:61], v11 offset:0
    ds_read_b64_tr_b16 v[62:63], v11 offset:2048
D_p7:
    s_waitcnt vmcnt(4) lgkmcnt(0)
    v_mfma_f32_16x16x32_bf16 v[16:19], v[48:51], v[192:195], v[16:19]
    ds_read_b64_tr_b16 v[64:65], v8 offset:4096
    ds_read_b64_tr_b16 v[66:67], v8 offset:6144
    v_mfma_f32_16x16x32_bf16 v[32:35], v[48:51], v[196:199], v[32:35]
    ds_read_b64_tr_b16 v[68:69], v9 offset:4096
    ds_read_b64_tr_b16 v[70:71], v9 offset:6144
    v_mfma_f32_16x16x32_bf16 v[20:23], v[52:55], v[192:195], v[20:23]
    ds_read_b64_tr_b16 v[72:73], v10 offset:4096
    ds_read_b64_tr_b16 v[74:75], v10 offset:6144
    v_mfma_f32_16x16x32_bf16 v[36:39], v[52:55], v[196:199], v[36:39]
    ds_read_b64_tr_b16 v[76:77], v11 offset:4096
    ds_read_b64_tr_b16 v[78:79], v11 offset:6144
    s_ff1_i32_b32 s64, s68
    s_bitset0_b32 s68, s64
    v_readlane_b32 s37, v7, s64
    s_add_u32 s69, s64, s74
    s_and_b32 s69, s69, 15
    s_lshl_b32 s69, s69, 11
    buffer_load_dwordx4 v[160:163], v4, s[16:19], s69 offen sc1
    v_mfma_f32_16x16x32_bf16 v[24:27], v[56:59], v[192:195], v[24:27]
    v_mfma_f32_16x16x32_bf16 v[40:43], v[56:59], v[196:199], v[40:43]
    v_mfma_f32_16x16x32_bf16 v[28:31], v[60:63], v[192:195], v[28:31]
    buffer_load_dwordx4 v[164:167], v12, s[16:19], s69 offen sc1
    v_mfma_f32_16x16x32_bf16 v[44:47], v[60:63], v[196:199], v[44:47]
    s_waitcnt lgkmcnt(0)
    v_mfma_f32_16x16x32_bf16 v[16:19], v[64:67], v[200:203], v[16:19]
    v_add_u32 v8, s38, v5
    ds_read_b64_tr_b16 v[48:49], v8 offset:0
    v_mfma_f32_16x16x32_bf16 v[32:35], v[64:67], v[204:207], v[32:35]
    ds_read_b64_tr_b16 v[50:51], v8 offset:2048
    v_add_u32 v9, s38, v6
    v_mfma_f32_16x16x32_bf16 v[20:23], v[68:71], v[200:203], v[20:23]
    ds_read_b64_tr_b16 v[52:53], v9 offset:0
    ds_read_b64_tr_b16 v[54:55], v9 offset:2048
    v_mfma_f32_16x16x32_bf16 v[36:39], v[68:71], v[204:207], v[36:39]
    v_add_u32 v10, s38, v1
    ds_read_b64_tr_b16 v[56:57], v10 offset:0
    s_add_u32 s69, s69, 2048
    buffer_load_dwordx4 v[168:171], v4, s[16:19], s69 offen sc1
    v_mfma_f32_16x16x32_bf16 v[24:27], v[72:75], v[200:203], v[24:27]
    ds_read_b64_tr_b16 v[58:59], v10 offset:2048
    v_add_u32 v11, s38, v3
    v_mfma_f32_16x16x32_bf16 v[40:43], v[72:75], v[204:207], v[40:43]
    ds_read_b64_tr_b16 v[60:61], v11 offset:0
    ds_read_b64_tr_b16 v[62:63], v11 offset:2048
    v_mfma_f32_16x16x32_bf16 v[28:31], v[76:79], v[200:203], v[28:31]
    buffer_load_dwordx4 v[172:175], v12, s[16:19], s69 offen sc1
    v_mfma_f32_16x16x32_bf16 v[44:47], v[76:79], v[204:207], v[44:47]
D_p6:
    s_waitcnt vmcnt(4) lgkmcnt(0)
    v_mfma_f32_16x16x32_bf16 v[16:19], v[48:51], v[176:179], v[16:19]
    ds_read_b64_tr_b16 v[64:65], v8 offset:4096
    ds_read_b64_tr_b16 v[66:67], v8 offset:6144
    v_mfma_f32_16x16x32_bf16 v[32:35], v[48:51], v[180:183], v[32:35]
    ds_read_b64_tr_b16 v[68:69], v9 offset:4096
    ds_read_b64_tr_b16 v[70:71], v9 offset:6144
    v_mfma_f32_16x16x32_bf16 v[20:23], v[52:55], v[176:179], v[20:23]
    ds_read_b64_tr_b16 v[72:73], v10 offset:4096
    ds_read_b64_tr_b16 v[74:75], v10 offset:6144
    v_mfma_f32_16x16x32_bf16 v[36:39], v[52:55], v[180:183], v[36:39]
    ds_read_b64_tr_b16 v[76:77], v11 offset:4096
    ds_read_b64_tr_b16 v[78:79], v11 offset:6144
    s_ff1_i32_b32 s64, s68
    s_bitset0_b32 s68, s64
    v_readlane_b32 s36, v7, s64
    s_add_u32 s69, s64, s74
    s_and_b32 s69, s69, 15
    s_lshl_b32 s69, s69, 11
    buffer_load_dwordx4 v[144:147], v4, s[16:19], s69 offen sc1
    v_mfma_f32_16x16x32_bf16 v[24:27], v[56:59], v[176:179], v[24:27]
    v_mfma_f32_16x16x32_bf16 v[40:43], v[56:59], v[180:183], v[40:43]
    v_mfma_f32_16x16x32_bf16 v[28:31], v[60:63], v[176:179], v[28:31]
    buffer_load_dwordx4 v[148:151], v12, s[16:19], s69 offen sc1
    v_mfma_f32_16x16x32_bf16 v[44:47], v[60:63], v[180:183], v[44:47]
    s_waitcnt lgkmcnt(0)
    v_mfma_f32_16x16x32_bf16 v[16:19], v[64:67], v[184:187], v[16:19]
    v_add_u32 v8, s37, v5
    ds_read_b64_tr_b16 v[48:49], v8 offset:0
    v_mfma_f32_16x16x32_bf16 v[32:35], v[64:67], v[188:191], v[32:35]
    ds_read_b64_tr_b16 v[50:51], v8 offset:2048
    v_add_u32 v9, s37, v6
    v_mfma_f32_16x16x32_bf16 v[20:23], v[68:71], v[184:187], v[20:23]
    ds_read_b64_tr_b16 v[52:53], v9 offset:0
    ds_read_b64_tr_b16 v[54:55], v9 offset:2048
    v_mfma_f32_16x16x32_bf16 v[36:39], v[68:71], v[188:191], v[36:39]
    v_add_u32 v10, s37, v1
    ds_read_b64_tr_b16 v[56:57], v10 offset:0
    s_add_u32 s69, s69, 2048
    buffer_load_dwordx4 v[152:155], v4, s[16:19], s69 offen sc1
    v_mfma_f32_16x16x32_bf16 v[24:27], v[72:75], v[184:187], v[24:27]
    ds_read_b64_tr_b16 v[58:59], v10 offset:2048
    v_add_u32 v11, s37, v3
    v_mfma_f32_16x16x32_bf16 v[40:43], v[72:75], v[188:191], v[40:43]
    ds_read_b64_tr_b16 v[60:61], v11 offset:0
    ds_read_b64_tr_b16 v[62:63], v11 offset:2048
    v_mfma_f32_16x16x32_bf16 v[28:31], v[76:79], v[184:187], v[28:31]
    buffer_load_dwordx4 v[156:159], v12, s[16:19], s69 offen sc1
    v_mfma_f32_16x16x32_bf16 v[44:47], v[76:79], v[188:191], v[44:47]
D_p5:
    s_waitcnt vmcnt(4) lgkmcnt(0)
    v_mfma_f32_16x16x32_bf16 v[16:19], v[48:51], v[160:163], v[16:19]
    ds_read_b64_tr_b16 v[64:65], v8 offset:4096
    ds_read_b64_tr_b16 v[66:67], v8 offset:6144
    v_mfma_f32_16x16x32_bf16 v[32:35], v[48:51], v[164:167], v[32:35]
    ds_read_b64_tr_b16 v[68:69], v9 offset:4096
    ds_read_b64_tr_b16 v[70:71], v9 offset:6144
    v_mfma_f32_16x16x32_bf16 v[20:23], v[52:55], v[160:163], v[20:23]
    ds_read_b64_tr_b16 v[72:73], v10 offset:4096
    ds_read_b64_tr_b16 v[74:75], v10 offset:6144
    v_mfma_f32_16x16x32_bf16 v[36:39], v[52:55], v[164:167], v[36:39]
    ds_read_b64_tr_b16 v[76:77], v11 offset:4096
    ds_read_b64_tr_b16 v[78:79], v11 offset:6144
    s_ff1_i32_b32 s64, s68
    s_bitset0_b32 s68, s64
    v_readlane_b32 s35, v7, s64
    s_add_u32 s69, s64, s74
    s_and_b32 s69, s69, 15
    s_lshl_b32 s69, s69, 11
    buffer_load_dwordx4 v[128:131], v4, s[16:19], s69 offen sc1
    v_mfma_f32_16x16x32_bf16 v[24:27], v[56:59], v[160:163], v[24:27]
    v_mfma_f32_16x16x32_bf16 v[40:43], v[56:59], v[164:167], v[40:43]
    v_mfma_f32_16x16x32_bf16 v[28:31], v[60:63], v[160:163], v[28:31]
    buffer_load_dwordx4 v[132:135], v12, s[16:19], s69 offen sc1
    v_mfma_f32_16x16x32_bf16 v[44:47], v[60:63], v[164:167], v[44:47]
    s_waitcnt lgkmcnt(0)
    v_mfma_f32_16x16x32_bf16 v[16:19], v[64:67], v[168:171], v[16:19]
    v_add_u32 v8, s36, v5
    ds_read_b64_tr_b16 v[48:49], v8 offset:0
    v_mfma_f32_16x16x32_bf16 v[32:35], v[64:67], v[172:175], v[32:35]
    ds_read_b64_tr_b16 v[50:51], v8 offset:2048
    v_add_u32 v9, s36, v6
    v_mfma_f32_16x16x32_bf16 v[20:23], v[68:71], v[168:171], v[20:23]
    ds_read_b64_tr_b16 v[52:53], v9 offset:0
    ds_read_b64_tr_b16 v[54:55], v9 offset:2048
    v_mfma_f32_16x16x32_bf16 v[36:39], v[68:71], v[172:175], v[36:39]
    v_add_u32 v10, s36, v1
    ds_read_b64_tr_b16 v[56:57], v10 offset:0
    s_add_u32 s69, s69, 2048
    buffer_load_dwordx4 v[136:139], v4, s[16:19], s69 offen sc1
    v_mfma_f32_16x16x32_bf16 v[24:27], v[72:75], v[168:171], v[24:27]
    ds_read_b64_tr_b16 v[58:59], v10 offset:2048
    v_add_u32 v11, s36, v3
    v_mfma_f32_16x16x32_bf16 v[40:43], v[72:75], v[172:175], v[40:43]
    ds_read_b64_tr_b16 v[60:61], v11 offset:0
    ds_read_b64_tr_b16 v[62:63], v11 offset:2048
    v_mfma_f32_16x16x32_bf16 v[28:31], v[76:79], v[168:171], v[28:31]
    buffer_load_dwordx4 v[140:143], v12, s[16:19], s69 offen sc1
    v_mfma_f32_16x16x32_bf16 v[44:47], v[76:79], v[172:175], v[44:47]
D_p4:
    s_waitcnt vmcnt(4) lgkmcnt(0)
    v_mfma_f32_16x16x32_bf16 v[16:19], v[48:51], v[144:147], v[16:19]
    ds_read_b64_tr_b16 v[64:65], v8 offset:4096
    ds_read_b64_tr_b16 v[66:67], v8 offset:6144
    v_mfma_f32_16x16x32_bf16 v[32:35], v[48:51], v[148:151], v[32:35]
    ds_read_b64_tr_b16 v[68:69], v9 offset:4096
    ds_read_b64_tr_b16 v[70:71], v9 offset:6144
    v_mfma_f32_16x16x32_bf16 v[20:23], v[52:55], v[144:147], v[20:23]
    ds_read_b64_tr_b16 v[72:73], v10 offset:4096
    ds_read_b64_tr_b16 v[74:75], v10 offset:6144
    v_mfma_f32_16x16x32_bf16 v[36:39], v[52:55], v[148:151], v[36:39]
    ds_read_b64_tr_b16 v[76:77], v11 offset:4096
    ds_read_b64_tr_b16 v[78:79], v11 offset:6144
    s_ff1_i32_b32 s64, s68
    s_bitset0_b32 s68, s64
    v_readlane_b32 s34, v7, s64
    s_add_u32 s69, s64, s74
    s_and_b32 s69, s69, 15
    s_lshl_b32 s69, s69, 11
    buffer_load_dwordx4 v[112:115], v4, s[16:19], s69 offen sc1
    v_mfma_f32_16x16x32_bf16 v[24:27], v[56:59], v[144:147], v[24:27]
    v_mfma_f32_16x16x32_bf16 v[40:43], v[56:59], v[148:151], v[40:43]
    v_mfma_f32_16x16x32_bf16 v[28:31], v[60:63], v[144:147], v[28:31]
    buffer_load_dwordx4 v[116:119], v12, s[16:19], s69 offen sc1
    v_mfma_f32_16x16x32_bf16 v[44:47], v[60:63], v[148:151], v[44:47]
    s_waitcnt lgkmcnt(0)
    v_mfma_f32_16x16x32_bf16 v[16:19], v[64:67], v[152:155], v[16:19]
    v_add_u32 v8, s35, v5
    ds_read_b64_tr_b16 v[48:49], v8 offset:0
    v_mfma_f32_16x16x32_bf16 v[32:35], v[64:67], v[156:159], v[32:35]
    ds_read_b64_tr_b16 v[50:51], v8 offset:2048
    v_add_u32 v9, s35, v6
    v_mfma_f32_16x16x32_bf16 v[20:23], v[68:71], v[152:155], v[20:23]
    ds_read_b64_tr_b16 v[52:53], v9 offset:0
    ds_read_b64_tr_b16 v[54:55], v9 offset:2048
    v_mfma_f32_16x16x32_bf16 v[36:39], v[68:71], v[156:159], v[36:39]
    v_add_u32 v10, s35, v1
    ds_read_b64_tr_b16 v[56:57], v10 offset:0
    s_add_u32 s69, s69, 2048
    buffer_load_dwordx4 v[120:123], v4, s[16:19], s69 offen sc1
    v_mfma_f32_16x16x32_bf16 v[24:27], v[72:75], v[152:155], v[24:27]
    ds_read_b64_tr_b16 v[58:59], v10 offset:2048
    v_add_u32 v11, s35, v3
    v_mfma_f32_16x16x32_bf16 v[40:43], v[72:75], v[156:159], v[40:43]
    ds_read_b64_tr_b16 v[60:61], v11 offset:0
    ds_read_b64_tr_b16 v[62:63], v11 offset:2048
    v_mfma_f32_16x16x32_bf16 v[28:31], v[76:79], v[152:155], v[28:31]
    buffer_load_dwordx4 v[124:127], v12, s[16:19], s69 offen sc1
    v_mfma_f32_16x16x32_bf16 v[44:47], v[76:79], v[156:159], v[44:47]
D_p3:
    s_waitcnt vmcnt(4) lgkmcnt(0)
    v_mfma_f32_16x16x32_bf16 v[16:19], v[48:51], v[128:131], v[16:19]
    ds_read_b64_tr_b16 v[64:65], v8 offset:4096
    ds_read_b64_tr_b16 v[66:67], v8 offset:6144
    v_mfma_f32_16x16x32_bf16 v[32:35], v[48:51], v[132:135], v[32:35]
    ds_read_b64_tr_b16 v[68:69], v9 offset:4096
    ds_read_b64_tr_b16 v[70:71], v9 offset:6144
    v_mfma_f32_16x16x32_bf16 v[20:23], v[52:55], v[128:131], v[20:23]
    ds_read_b64_tr_b16 v[72:73], v10 offset:4096
    ds_read_b64_tr_b16 v[74:75], v10 offset:6144
    v_mfma_f32_16x16x32_bf16 v[36:39], v[52:55], v[132:135], v[36:39]
    ds_read_b64_tr_b16 v[76:77], v11 offset:4096
    ds_read_b64_tr_b16 v[78:79], v11 offset:6144
    s_ff1_i32_b32 s64, s68
    s_bitset0_b32 s68, s64
    v_readlane_b32 s33, v7, s64
    s_add_u32 s69, s64, s74
    s_and_b32 s69, s69, 15
    s_lshl_b32 s69, s69, 11
    buffer_load_dwordx4 v[96:99], v4, s[16:19], s69 offen sc1
    v_mfma_f32_16x16x32_bf16 v[24:27], v[56:59], v[128:131], v[24:27]
    v_mfma_f32_16x16x32_bf16 v[40:43], v[56:59], v[132:135], v[40:43]
    v_mfma_f32_16x16x32_bf16 v[28:31], v[60:63], v[128:131], v[28:31]
    buffer_load_dwordx4 v[100:103], v12, s[16:19], s69 offen sc1
    v_mfma_f32_16x16x32_bf16 v[44:47], v[60:63], v[132:135], v[44:47]
    s_waitcnt lgkmcnt(0)
    v_mfma_f32_16x16x32_bf16 v[16:19], v[64:67], v[136:139], v[16:19]
    v_add_u32 v8, s34, v5
    ds_read_b64_tr_b16 v[48:49], v8 offset:0
    v_mfma_f32_16x16x32_bf16 v[32:35], v[64:67], v[140:143], v[32:35]
    ds_read_b64_tr_b16 v[50:51], v8 offset:2048
    v_add_u32 v9, s34, v6
    v_mfma_f32_16x16x32_bf16 v[20:23], v[68:71], v[136:139], v[20:23]
    ds_read_b64_tr_b16 v[52:53], v9 offset:0
    ds_read_b64_tr_b16 v[54:55], v9 offset:2048
    v_mfma_f32_16x16x32_bf16 v[36:39], v[68:71], v[140:143], v[36:39]
    v_add_u32 v10, s34, v1
    ds_read_b64_tr_b16 v[56:57], v10 offset:0
    s_add_u32 s69, s69, 2048
    buffer_load_dwordx4 v[104:107], v4, s[16:19], s69 offen sc1
    v_mfma_f32_16x16x32_bf16 v[24:27], v[72:75], v[136:139], v[24:27]
    ds_read_b64_tr_b16 v[58:59], v10 offset:2048
    v_add_u32 v11, s34, v3
    v_mfma_f32_16x16x32_bf16 v[40:43], v[72:75], v[140:143], v[40:43]
    ds_read_b64_tr_b16 v[60:61], v11 offset:0
    ds_read_b64_tr_b16 v[62:63], v11 offset:2048
    v_mfma_f32_16x16x32_bf16 v[28:31], v[76:79], v[136:139], v[28:31]
    buffer_load_dwordx4 v[108:111], v12, s[16:19], s69 offen sc1
    v_mfma_f32_16x16x32_bf16 v[44:47], v[76:79], v[140:143], v[44:47]
D_p2:
    s_waitcnt vmcnt(4) lgkmcnt(0)
    v_mfma_f32_16x16x32_bf16 v[16:19], v[48:51], v[112:115], v[16:19]
    ds_read_b64_tr_b16 v[64:65], v8 offset:4096
    ds_read_b64_tr_b16 v[66:67], v8 offset:6144
    v_mfma_f32_16x16x32_bf16 v[32:35], v[48:51], v[116:119], v[32:35]
    ds_read_b64_tr_b16 v[68:69], v9 offset:4096
    ds_read_b64_tr_b16 v[70:71], v9 offset:6144
    v_mfma_f32_16x16x32_bf16 v[20:23], v[52:55], v[112:115], v[20:23]
    ds_read_b64_tr_b16 v[72:73], v10 offset:4096
    ds_read_b64_tr_b16 v[74:75], v10 offset:6144
    v_mfma_f32_16x16x32_bf16 v[36:39], v[52:55], v[116:119], v[36:39]
    ds_read_b64_tr_b16 v[76:77], v11 offset:4096
    ds_read_b64_tr_b16 v[78:79], v11 offset:6144
    s_ff1_i32_b32 s64, s68
    s_bitset0_b32 s68, s64
    v_readlane_b32 s32, v7, s64
    s_add_u32 s69, s64, s74
    s_and_b32 s69, s69, 15
    s_lshl_b32 s69, s69, 11
    buffer_load_dwordx4 v[80:83], v4, s[16:19], s69 offen sc1
    v_mfma_f32_16x16x32_bf16 v[24:27], v[56:59], v[112:115], v[24:27]
    v_mfma_f32_16x16x32_bf16 v[40:43], v[56:59], v[116:119], v[40:43]
    v_mfma_f32_16x16x32_bf16 v[28:31], v[60:63], v[112:115], v[28:31]
    buffer_load_dwordx4 v[84:87], v12, s[16:19], s69 offen sc1
    v_mfma_f32_16x16x32_bf16 v[44:47], v[60:63], v[116:119], v[44:47]
    s_waitcnt lgkmcnt(0)
    v_mfma_f32_16x16x32_bf16 v[16:19], v[64:67], v[120:123], v[16:19]
    v_add_u32 v8, s33, v5
    ds_read_b64_tr_b16 v[48:49], v8 offset:0
    v_mfma_f32_16x16x32_bf16 v[32:35], v[64:67], v[124:127], v[32:35]
    ds_read_b64_tr_b16 v[50:51], v8 offset:2048
    v_add_u32 v9, s33, v6
    v_mfma_f32_16x16x32_bf16 v[20:23], v[68:71], v[120:123], v[20:23]
    ds_read_b64_tr_b16 v[52:53], v9 offset:0
    ds_read_b64_tr_b16 v[54:55], v9 offset:2048
    v_mfma_f32_16x16x32_bf16 v[36:39], v[68:71], v[124:127], v[36:39]
    v_add_u32 v10, s33, v1
    ds_read_b64_tr_b16 v[56:57], v10 offset:0
    s_add_u32 s69, s69, 2048
    buffer_load_dwordx4 v[88:91], v4, s[16:19], s69 offen sc1
    v_mfma_f32_16x16x32_bf16 v[24:27], v[72:75], v[120:123], v[24:27]
    ds_read_b64_tr_b16 v[58:59], v10 offset:2048
    v_add_u32 v11, s33, v3
    v_mfma_f32_16x16x32_bf16 v[40:43], v[72:75], v[124:127], v[40:43]
    ds_read_b64_tr_b16 v[60:61], v11 offset:0
    ds_read_b64_tr_b16 v[62:63], v11 offset:2048
    v_mfma_f32_16x16x32_bf16 v[28:31], v[76:79], v[120:123], v[28:31]
    buffer_load_dwordx4 v[92:95], v12, s[16:19], s69 offen sc1
    s_mov_b64 exec, 1
    v_mov_b32 v15, 0
    buffer_atomic_or v15, v14, s[16:19], 0 offen sc0
    s_mov_b64 exec, -1
    v_mfma_f32_16x16x32_bf16 v[44:47], v[76:79], v[124:127], v[44:47]
D_p1:
    s_waitcnt vmcnt(5) lgkmcnt(0)
    v_mfma_f32_16x16x32_bf16 v[16:19], v[48:51], v[96:99], v[16:19]
    ds_read_b64_tr_b16 v[64:65], v8 offset:4096
    ds_read_b64_tr_b16 v[66:67], v8 offset:6144
    v_mfma_f32_16x16x32_bf16 v[32:35], v[48:51], v[100:103], v[32:35]
    ds_read_b64_tr_b16 v[68:69], v9 offset:4096
    ds_read_b64_tr_b16 v[70:71], v9 offset:6144
    v_mfma_f32_16x16x32_bf16 v[20:23], v[52:55], v[96:99], v[20:23]
    ds_read_b64_tr_b16 v[72:73], v10 offset:4096
    ds_read_b64_tr_b16 v[74:75], v10 offset:6144
    v_mfma_f32_16x16x32_bf16 v[36:39], v[52:55], v[100:103], v[36:39]
    ds_read_b64_tr_b16 v[76:77], v11 offset:4096
    ds_read_b64_tr_b16 v[78:79], v11 offset:6144
    v_mfma_f32_16x16x32_bf16 v[24:27], v[56:59], v[96:99], v[24:27]
    v_mfma_f32_16x16x32_bf16 v[40:43], v[56:59], v[100:103], v[40:43]
    v_mfma_f32_16x16x32_bf16 v[28:31], v[60:63], v[96:99], v[28:31]
    v_mfma_f32_16x16x32_bf16 v[44:47], v[60:63], v[100:103], v[44:47]
    s_waitcnt lgkmcnt(0)
    v_mfma_f32_16x16x32_bf16 v[16:19], v[64:67], v[104:107], v[16:19]
    v_add_u32 v8, s32, v5
    ds_read_b64_tr_b16 v[48:49], v8 offset:0
    v_mfma_f32_16x16x32_bf16 v[32:35], v[64:67], v[108:111], v[32:35]
    ds_read_b64_tr_b16 v[50:51], v8 offset:2048
    v_add_u32 v9, s32, v6
    v_mfma_f32_16x16x32_bf16 v[20:23], v[68:71], v[104:107], v[20:23]
    ds_read_b64_tr_b16 v[52:53], v9 offset:0
    ds_read_b64_tr_b16 v[54:55], v9 offset:2048
    v_mfma_f32_16x16x32_bf16 v[36:39], v[68:71], v[108:111], v[36:39]
    v_add_u32 v10, s32, v1
    ds_read_b64_tr_b16 v[56:57], v10 offset:0
    v_mfma_f32_16x16x32_bf16 v[24:27], v[72:75], v[104:107], v[24:27]
    ds_read_b64_tr_b16 v[58:59], v10 offset:2048
    v_add_u32 v11, s32, v3
    v_mfma_f32_16x16x32_bf16 v[40:43], v[72:75], v[108:111], v[40:43]
    ds_read_b64_tr_b16 v[60:61], v11 offset:0
    ds_read_b64_tr_b16 v[62:63], v11 offset:2048
    v_mfma_f32_16x16x32_bf16 v[28:31], v[76:79], v[104:107], v[28:31]
    v_mfma_f32_16x16x32_bf16 v[44:47], v[76:79], v[108:111], v[44:47]
D_p0:
    s_waitcnt vmcnt(1) lgkmcnt(0)
    v_mfma_f32_16x16x32_bf16 v[16:19], v[48:51], v[80:83], v[16:19]
    ds_read_b64_tr_b16 v[64:65], v8 offset:4096
    ds_read_b64_tr_b16 v[66:67], v8 offset:6144
    v_mfma_f32_16x16x32_bf16 v[32:35], v[48:51], v[84:87], v[32:35]
    ds_read_b64_tr_b16 v[68:69], v9 offset:4096
    ds_read_b64_tr_b16 v[70:71], v9 offset:6144
    v_mfma_f32_16x16x32_bf16 v[20:23], v[52:55], v[80:83], v[20:23]
    ds_read_b64_tr_b16 v[72:73], v10 offset:4096
    ds_read_b64_tr_b16 v[74:75], v10 offset:6144
    v_mfma_f32_16x16x32_bf16 v[36:39], v[52:55], v[84:87], v[36:39]
    ds_read_b64_tr_b16 v[76:77], v11 offset:4096
    ds_read_b64_tr_b16 v[78:79], v11 offset:6144
    v_mfma_f32_16x16x32_bf16 v[24:27], v[56:59], v[80:83], v[24:27]
    v_mfma_f32_16x16x32_bf16 v[40:43], v[56:59], v[84:87], v[40:43]
    v_mfma_f32_16x16x32_bf16 v[28:31], v[60:63], v[80:83], v[28:31]
    v_mfma_f32_16x16x32_bf16 v[44:47], v[60:63], v[84:87], v[44:47]
    s_waitcnt lgkmcnt(0)
    v_mfma_f32_16x16x32_bf16 v[16:19], v[64:67], v[88:91], v[16:19]
    v_mfma_f32_16x16x32_bf16 v[32:35], v[64:67], v[92:95], v[32:35]
    v_mfma_f32_16x16x32_bf16 v[20:23], v[68:71], v[88:91], v[20:23]
    v_mfma_f32_16x16x32_bf16 v[36:39], v[68:71], v[92:95], v[36:39]
    v_mfma_f32_16x16x32_bf16 v[24:27], v[72:75], v[88:91], v[24:27]
    v_mfma_f32_16x16x32_bf16 v[40:43], v[72:75], v[92:95], v[40:43]
    v_mfma_f32_16x16x32_bf16 v[28:31], v[76:79], v[88:91], v[28:31]
    v_mfma_f32_16x16x32_bf16 v[44:47], v[76:79], v[92:95], v[44:47]
    s_cmp_lg_u32 s66, 0
    s_cbranch_scc1 D_wait
D_end:
    s_lshl_b32 s64, s3, 12
    s_add_u32 s64, s64, 8192
    v_lshl_add_u32 v8, v2, 4, s64
    s_xor_b32 s65, s3, 4
    s_lshl_b32 s65, s65, 12
    s_add_u32 s65, s65, 8192
    v_lshl_add_u32 v5, v2, 4, s65
    v_lshlrev_b32 v9, 1, v229
    v_cmp_eq_u32 s[70:71], s67, v230
    s_cmp_eq_u32 s46, 0
    s_cbranch_scc1 P2_y
P2_ny:
    s_barrier
    ds_write_b128 v8, v[32:35] offset:0
    ds_write_b128 v8, v[36:39] offset:1024
    ds_write_b128 v8, v[40:43] offset:2048
    ds_write_b128 v8, v[44:47] offset:3072
    s_cmp_lg_u64 s[70:71], 0
    s_cbranch_scc1 P2_fix
P2_nr:
    s_waitcnt lgkmcnt(0)
    s_barrier
    ds_read_b128 v[64:67], v5 offset:0
    ds_read_b128 v[68:71], v5 offset:1024
    ds_read_b128 v[72:75], v5 offset:2048
    ds_read_b128 v[76:79], v5 offset:3072
    s_waitcnt lgkmcnt(2)
    v_pk_add_f32 v[16:17], v[16:17], v[64:65]
    v_pk_add_f32 v[18:19], v[18:19], v[66:67]
    v_pk_add_f32 v[20:21], v[20:21], v[68:69]
    v_pk_add_f32 v[22:23], v[22:23], v[70:71]
    v_cvt_pk_bf16_f32 v48, v16, v17
    v_cvt_pk_bf16_f32 v49, v18, v19
    v_cvt_pk_bf16_f32 v50, v20, v21
    v_cvt_pk_bf16_f32 v51, v22, v23
    s_nop 0
    v_permlane16_swap_b32 v48, v50
    v_permlane16_swap_b32 v49, v51
    v_lshlrev_b32 v16, 16, v48
    v_and_b32 v17, 0xffff0000, v48
    v_lshlrev_b32 v18, 16, v49
    v_and_b32 v19, 0xffff0000, v49
    v_lshlrev_b32 v20, 16, v50
    v_and_b32 v21, 0xffff0000, v50
    v_lshlrev_b32 v22, 16, v51
    v_and_b32 v23, 0xffff0000, v51
    v_pk_mul_f32 v[16:17], v[16:17], v[228:229] op_sel_hi:[1,0]
    v_pk_mul_f32 v[18:19], v[18:19], v[228:229] op_sel_hi:[1,0]
    v_pk_mul_f32 v[20:21], v[20:21], v[228:229] op_sel_hi:[1,0]
    v_pk_mul_f32 v[22:23], v[22:23], v[228:229] op_sel_hi:[1,0]
    v_cvt_pk_bf16_f32 v48, v16, v17
    v_cvt_pk_bf16_f32 v49, v18, v19
    v_cvt_pk_bf16_f32 v50, v20, v21
    v_cvt_pk_bf16_f32 v51, v22, v23
    v_lshlrev_b32 v16, 16, v48
    v_and_b32 v17, 0xffff0000, v48
    v_lshlrev_b32 v18, 16, v49
    v_and_b32 v19, 0xffff0000, v49
    v_lshlrev_b32 v20, 16, v50
    v_and_b32 v21, 0xffff0000, v50
    v_lshlrev_b32 v22, 16, v51
    v_and_b32 v23, 0xffff0000, v51
    v_pk_add_f32 v[16:17], v[16:17], v[232:233]
    v_pk_add_f32 v[18:19], v[18:19], v[234:235]
    v_pk_add_f32 v[20:21], v[20:21], v[236:237]
    v_pk_add_f32 v[22:23], v[22:23], v[238:239]
    v_cvt_pk_bf16_f32 v120, v16, v17
    v_cvt_pk_bf16_f32 v121, v18, v19
    v_cvt_pk_bf16_f32 v122, v20, v21
    v_cvt_pk_bf16_f32 v123, v22, v23
    v_and_b32 v6, 1, v2
    v_mul_u32_u24 v6, 1984, v6
    v_sub_u32 v231, v231, v6
    s_mov_b32 vcc_lo, 0x55555555
    s_mov_b32 vcc_hi, 0x55555555
    s_waitcnt lgkmcnt(0)
    v_pk_add_f32 v[24:25], v[24:25], v[72:73]
    v_pk_add_f32 v[26:27], v[26:27], v[74:75]
    v_pk_add_f32 v[28:29], v[28:29], v[76:77]
    v_pk_add_f32 v[30:31], v[30:31], v[78:79]
    v_cvt_pk_bf16_f32 v52, v24, v25
    v_cvt_pk_bf16_f32 v53, v26, v27
    v_cvt_pk_bf16_f32 v54, v28, v29
    v_cvt_pk_bf16_f32 v55, v30, v31
    s_nop 0
    v_permlane16_swap_b32 v52, v54
    v_permlane16_swap_b32 v53, v55
    v_lshlrev_b32 v24, 16, v52
    v_and_b32 v25, 0xffff0000, v52
    v_lshlrev_b32 v26, 16, v53
    v_and_b32 v27, 0xffff0000, v53
    v_lshlrev_b32 v28, 16, v54
    v_and_b32 v29, 0xffff0000, v54
    v_lshlrev_b32 v30, 16, v55
    v_and_b32 v31, 0xffff0000, v55
    v_pk_mul_f32 v[24:25], v[24:25], v[228:229] op_sel_hi:[1,0]
    v_pk_mul_f32 v[26:27], v[26:27], v[228:229] op_sel_hi:[1,0]
    v_pk_mul_f32 v[28:29], v[28:29], v[228:229] op_sel_hi:[1,0]
    v_pk_mul_f32 v[30:31], v[30:31], v[228:229] op_sel_hi:[1,0]
    v_cvt_pk_bf16_f32 v52, v24, v25
    v_cvt_pk_bf16_f32 v53, v26, v27
    v_cvt_pk_bf16_f32 v54, v28, v29
    v_cvt_pk_bf16_f32 v55, v30, v31
    v_lshlrev_b32 v24, 16, v52
    v_and_b32 v25, 0xffff0000, v52
    v_lshlrev_b32 v26, 16, v53
    v_and_b32 v27, 0xffff0000, v53
    v_lshlrev_b32 v28, 16, v54
    v_and_b32 v29, 0xffff0000, v54
    v_lshlrev_b32 v30, 16, v55
    v_and_b32 v31, 0xffff0000, v55
    v_pk_add_f32 v[24:25], v[24:25], v[240:241]
    v_pk_add_f32 v[26:27], v[26:27], v[242:243]
    v_pk_add_f32 v[28:29], v[28:29], v[244:245]
    v_pk_add_f32 v[30:31], v[30:31], v[246:247]
    v_cvt_pk_bf16_f32 v124, v24, v25
    v_cvt_pk_bf16_f32 v125, v26, v27
    v_cvt_pk_bf16_f32 v126, v28, v29
    v_cvt_pk_bf16_f32 v127, v30, v31
    s_nop 1
    v_cndmask_b32_dpp v56, v124, v120, vcc quad_perm:[1,0,3,2] row_mask:0xf bank_mask:0xf
    v_cndmask_b32_dpp v57, v125, v121, vcc quad_perm:[1,0,3,2] row_mask:0xf bank_mask:0xf
    v_cndmask_b32_dpp v58, v126, v122, vcc quad_perm:[1,0,3,2] row_mask:0xf bank_mask:0xf
    v_cndmask_b32_dpp v59, v127, v123, vcc quad_perm:[1,0,3,2] row_mask:0xf bank_mask:0xf
    buffer_store_dwordx4 v[56:59], v231, s[20:23], 0 offen nt
    s_not_b64 vcc, vcc
    v_cndmask_b32_dpp v60, v120, v124, vcc quad_perm:[1,0,3,2] row_mask:0xf bank_mask:0xf
    v_cndmask_b32_dpp v61, v121, v125, vcc quad_perm:[1,0,3,2] row_mask:0xf bank_mask:0xf
    v_cndmask_b32_dpp v62, v122, v126, vcc quad_perm:[1,0,3,2] row_mask:0xf bank_mask:0xf
    v_cndmask_b32_dpp v63, v123, v127, vcc quad_perm:[1,0,3,2] row_mask:0xf bank_mask:0xf
    buffer_store_dwordx4 v[60:63], v231, s[20:23], 0 offen offset:2048 nt
K_end:
    s_endpgm
H_nre:
    s_add_u32 s65, s65, 1
    s_cmp_ge_u32 s65, 200000
    s_cbranch_scc1 H_nok
    s_sleep 4
    buffer_load_dword v78, v79, s[20:23], 0 offen sc1
    s_waitcnt vmcnt(0)
    s_branch H_nspin
H_retry:
    s_add_u32 s65, s65, 1
    s_cmp_ge_u32 s65, 200000
    s_cbranch_scc1 H_nq
    s_sleep 8
    s_mov_b32 s64, 6717440
    buffer_load_dwordx4 v[24:27], v6, s[16:19], s64 offen offset:0 sc1
    buffer_load_dwordx4 v[28:31], v6, s[16:19], s64 offen offset:1024 sc1
    s_waitcnt vmcnt(0)
    s_branch H_spin
G_f15:
    s_bitset1_b32 s66, s55
    s_branch G_q15
G_f14:
    s_bitset1_b32 s66, s54
    s_branch G_q14
G_f13:
    s_bitset1_b32 s66, s53
    s_branch G_q13
G_f12:
    s_bitset1_b32 s66, s52
    s_branch G_q12
G_f11:
    s_bitset1_b32 s66, s51
    s_branch G_q11
G_f10:
    s_bitset1_b32 s66, s50
    s_branch G_q10
G_f9:
    s_bitset1_b32 s66, s49
    s_branch G_q9
G_f8:
    s_bitset1_b32 s66, s48
    s_branch G_q8
G_f7:
    s_bitset1_b32 s66, s47
    s_branch G_q7
G_f6:
    s_bitset1_b32 s66, s46
    s_branch G_q6
G_f5:
    s_bitset1_b32 s66, s45
    s_branch G_q5
G_f4:
    s_bitset1_b32 s66, s44
    s_branch G_q4
G_f3:
    s_bitset1_b32 s66, s43
    s_branch G_q3
G_f2:
    s_bitset1_b32 s66, s42
    s_branch G_q2
G_f1:
    s_bitset1_b32 s66, s41
    s_branch G_q1
G_f0:
    s_bitset1_b32 s66, s40
    s_branch G_q0
phi_16_fix:
    v_lshlrev_b32 v48, 16, v16
    v_and_b32 v49, 0xffff0000, v16
    v_add_f32 v48, s73, v48
    v_add_f32 v49, s73, v49
    v_cvt_pk_bf16_f32 v16, v48, v49
    v_lshlrev_b32 v48, 16, v17
    v_and_b32 v49, 0xffff0000, v17
    v_add_f32 v48, s73, v48
    v_add_f32 v49, s73, v49
    v_cvt_pk_bf16_f32 v17, v48, v49
    v_lshlrev_b32 v48, 16, v18
    v_and_b32 v49, 0xffff0000, v18
    v_add_f32 v48, s73, v48
    v_add_f32 v49, s73, v49
    v_cvt_pk_bf16_f32 v18, v48, v49
    v_lshlrev_b32 v48, 16, v19
    v_and_b32 v49, 0xffff0000, v19
    v_add_f32 v48, s73, v48
    v_add_f32 v49, s73, v49
    v_cvt_pk_bf16_f32 v19, v48, v49
    v_lshlrev_b32 v48, 16, v20
    v_and_b32 v49, 0xffff0000, v20
    v_add_f32 v48, s73, v48
    v_add_f32 v49, s73, v49
    v_cvt_pk_bf16_f32 v20, v48, v49
    v_lshlrev_b32 v48, 16, v21
    v_and_b32 v49, 0xffff0000, v21
    v_add_f32 v48, s73, v48
    v_add_f32 v49, s73, v49
    v_cvt_pk_bf16_f32 v21, v48, v49
    v_lshlrev_b32 v48, 16, v22
    v_and_b32 v49, 0xffff0000, v22
    v_add_f32 v48, s73, v48
    v_add_f32 v49, s73, v49
    v_cvt_pk_bf16_f32 v22, v48, v49
    v_lshlrev_b32 v48, 16, v23
    v_and_b32 v49, 0xffff0000, v23
    v_add_f32 v48, s73, v48
    v_add_f32 v49, s73, v49
    v_cvt_pk_bf16_f32 v23, v48, v49
    s_branch phi_16_done
phi_17_fix:
    v_lshlrev_b32 v48, 16, v24
    v_and_b32 v49, 0xffff0000, v24
    v_add_f32 v48, s73, v48
    v_add_f32 v49, s73, v49
    v_cvt_pk_bf16_f32 v24, v48, v49
    v_lshlrev_b32 v48, 16, v25
    v_and_b32 v49, 0xffff0000, v25
    v_add_f32 v48, s73, v48
    v_add_f32 v49, s73, v49
    v_cvt_pk_bf16_f32 v25, v48, v49
    v_lshlrev_b32 v48, 16, v26
    v_and_b32 v49, 0xffff0000, v26
    v_add_f32 v48, s73, v48
    v_add_f32 v49, s73, v49
    v_cvt_pk_bf16_f32 v26, v48, v49
    v_lshlrev_b32 v48, 16, v27
    v_and_b32 v49, 0xffff0000, v27
    v_add_f32 v48, s73, v48
    v_add_f32 v49, s73, v49
    v_cvt_pk_bf16_f32 v27, v48, v49
    v_lshlrev_b32 v48, 16, v28
    v_and_b32 v49, 0xffff0000, v28
    v_add_f32 v48, s73, v48
    v_add_f32 v49, s73, v49
    v_cvt_pk_bf16_f32 v28, v48, v49
    v_lshlrev_b32 v48, 16, v29
    v_and_b32 v49, 0xffff0000, v29
    v_add_f32 v48, s73, v48
    v_add_f32 v49, s73, v49
    v_cvt_pk_bf16_f32 v29, v48, v49
    v_lshlrev_b32 v48, 16, v30
    v_and_b32 v49, 0xffff0000, v30
    v_add_f32 v48, s73, v48
    v_add_f32 v49, s73, v49
    v_cvt_pk_bf16_f32 v30, v48, v49
    v_lshlrev_b32 v48, 16, v31
    v_and_b32 v49, 0xffff0000, v31
    v_add_f32 v48, s73, v48
    v_add_f32 v49, s73, v49
    v_cvt_pk_bf16_f32 v31, v48, v49
    s_branch phi_17_done
C_ex1:
    ds_write_b32 v227, v96 offset:4608
    ds_write_b128 v224, v[240:243] offset:32768
    ds_write_b128 v224, v[244:247] offset:33792
    s_nop 4
    v_mov_b32 v96, v60
    v_mov_b32 v240, v248
    v_mov_b32 v241, v249
    v_mov_b32 v242, v250
    v_mov_b32 v243, v251
    v_mov_b32 v244, v252
    v_mov_b32 v245, v253
    v_mov_b32 v246, v254
    v_mov_b32 v247, v255
    s_branch C_ex2
phi_18_fix:
    v_lshlrev_b32 v48, 16, v32
    v_and_b32 v49, 0xffff0000, v32
    v_add_f32 v48, s73, v48
    v_add_f32 v49, s73, v49
    v_cvt_pk_bf16_f32 v32, v48, v49
    v_lshlrev_b32 v48, 16, v33
    v_and_b32 v49, 0xffff0000, v33
    v_add_f32 v48, s73, v48
    v_add_f32 v49, s73, v49
    v_cvt_pk_bf16_f32 v33, v48, v49
    v_lshlrev_b32 v48, 16, v34
    v_and_b32 v49, 0xffff0000, v34
    v_add_f32 v48, s73, v48
    v_add_f32 v49, s73, v49
    v_cvt_pk_bf16_f32 v34, v48, v49
    v_lshlrev_b32 v48, 16, v35
    v_and_b32 v49, 0xffff0000, v35
    v_add_f32 v48, s73, v48
    v_add_f32 v49, s73, v49
    v_cvt_pk_bf16_f32 v35, v48, v49
    v_lshlrev_b32 v48, 16, v36
    v_and_b32 v49, 0xffff0000, v36
    v_add_f32 v48, s73, v48
    v_add_f32 v49, s73, v49
    v_cvt_pk_bf16_f32 v36, v48, v49
    v_lshlrev_b32 v48, 16, v37
    v_and_b32 v49, 0xffff0000, v37
    v_add_f32 v48, s73, v48
    v_add_f32 v49, s73, v49
    v_cvt_pk_bf16_f32 v37, v48, v49
    v_lshlrev_b32 v48, 16, v38
    v_and_b32 v49, 0xffff0000, v38
    v_add_f32 v48, s73, v48
    v_add_f32 v49, s73, v49
    v_cvt_pk_bf16_f32 v38, v48, v49
    v_lshlrev_b32 v48, 16, v39
    v_and_b32 v49, 0xffff0000, v39
    v_add_f32 v48, s73, v48
    v_add_f32 v49, s73, v49
    v_cvt_pk_bf16_f32 v39, v48, v49
    s_branch phi_18_done
phi_19_fix:
    v_lshlrev_b32 v48, 16, v40
    v_and_b32 v49, 0xffff0000, v40
    v_add_f32 v48, s73, v48
    v_add_f32 v49, s73, v49
    v_cvt_pk_bf16_f32 v40, v48, v49
    v_lshlrev_b32 v48, 16, v41
    v_and_b32 v49, 0xffff0000, v41
    v_add_f32 v48, s73, v48
    v_add_f32 v49, s73, v49
    v_cvt_pk_bf16_f32 v41, v48, v49
    v_lshlrev_b32 v48, 16, v42
    v_and_b32 v49, 0xffff0000, v42
    v_add_f32 v48, s73, v48
    v_add_f32 v49, s73, v49
    v_cvt_pk_bf16_f32 v42, v48, v49
    v_lshlrev_b32 v48, 16, v43
    v_and_b32 v49, 0xffff0000, v43
    v_add_f32 v48, s73, v48
    v_add_f32 v49, s73, v49
    v_cvt_pk_bf16_f32 v43, v48, v49
    v_lshlrev_b32 v48, 16, v44
    v_and_b32 v49, 0xffff0000, v44
    v_add_f32 v48, s73, v48
    v_add_f32 v49, s73, v49
    v_cvt_pk_bf16_f32 v44, v48, v49
    v_lshlrev_b32 v48, 16, v45
    v_and_b32 v49, 0xffff0000, v45
    v_add_f32 v48, s73, v48
    v_add_f32 v49, s73, v49
    v_cvt_pk_bf16_f32 v45, v48, v49
    v_lshlrev_b32 v48, 16, v46
    v_and_b32 v49, 0xffff0000, v46
    v_add_f32 v48, s73, v48
    v_add_f32 v49, s73, v49
    v_cvt_pk_bf16_f32 v46, v48, v49
    v_lshlrev_b32 v48, 16, v47
    v_and_b32 v49, 0xffff0000, v47
    v_add_f32 v48, s73, v48
    v_add_f32 v49, s73, v49
    v_cvt_pk_bf16_f32 v47, v48, v49
    s_branch phi_19_done
P2_ys:
    v_lshrrev_b32 v13, 4, v2
    v_lshlrev_b32 v13, 12, v13
    v_and_b32 v208, 15, v2
    v_lshl_add_u32 v13, v208, 4, v13
    s_lshl_b32 s64, s5, 8
    s_lshl_b32 s65, s3, 16
    s_add_u32 s64, s64, s65
    v_add_u32 v13, s64, v13
    s_lshl_b32 s64, s67, 11
    s_lshl_b32 s65, s5, 7
    s_add_u32 s64, s64, s65
    v_lshl_add_u32 v209, v2, 1, s64
    s_lshl_b32 s64, s67, 2
    s_add_u32 s64, s64, 6709248
    v_mov_b32 v215, s64
    s_branch P2_ysd
P2_yl:
    s_cmp_gt_u32 s70, 7
    s_cbranch_scc1 P2_nyl
    buffer_load_ushort v211, v209, s[8:11], 0 offen
    buffer_load_dword v212, v215, s[16:19], 0 offen sc1
    s_mov_b32 s69, 6447104
    buffer_load_dwordx4 v[192:195], v13, s[16:19], s69 offen sc1
    s_mov_b32 s69, 6463488
    buffer_load_dwordx4 v[196:199], v13, s[16:19], s69 offen sc1
    s_mov_b32 s69, 6479872
    buffer_load_dwordx4 v[200:203], v13, s[16:19], s69 offen sc1
    s_mov_b32 s69, 6496256
    buffer_load_dwordx4 v[204:207], v13, s[16:19], s69 offen sc1
    s_mov_b32 s47, 1
    s_branch P2_nyl
P2_y:
    s_mov_b32 s66, 0
    s_cmp_lg_u32 s47, 0
    s_cbranch_scc1 P2_ychk
P2_yre:
    buffer_load_ushort v211, v209, s[8:11], 0 offen
    buffer_load_dword v212, v215, s[16:19], 0 offen sc1
    s_mov_b32 s69, 6447104
    buffer_load_dwordx4 v[192:195], v13, s[16:19], s69 offen sc1
    s_mov_b32 s69, 6463488
    buffer_load_dwordx4 v[196:199], v13, s[16:19], s69 offen sc1
    s_mov_b32 s69, 6479872
    buffer_load_dwordx4 v[200:203], v13, s[16:19], s69 offen sc1
    s_mov_b32 s69, 6496256
    buffer_load_dwordx4 v[204:207], v13, s[16:19], s69 offen sc1
P2_ychk:
    s_waitcnt vmcnt(0)
    v_max3_u32 v10, v192, v193, v194
    v_max3_u32 v10, v195, v196, v10
    v_max3_u32 v10, v197, v198, v10
    v_max3_u32 v10, v199, v200, v10
    v_max3_u32 v10, v201, v202, v10
    v_max3_u32 v10, v203, v204, v10
    v_max3_u32 v10, v205, v206, v10
    v_max_u32 v10, v207, v10
    v_cmp_eq_u32 vcc, -1, v10
    s_cbranch_vccz P2_yok
    s_add_u32 s66, s66, 1
    s_cmp_ge_u32 s66, 40000
    s_cbranch_scc1 P2_yok
    s_sleep 4
    s_branch P2_yre
P2_yok:
    v_pk_add_f32 v[192:193], v[192:193], v[200:201]
    v_pk_add_f32 v[194:195], v[194:195], v[202:203]
    v_pk_add_f32 v[196:197], v[196:197], v[204:205]
    v_pk_add_f32 v[198:199], v[198:199], v[206:207]
    v_pk_add_f32 v[192:193], v[192:193], v[196:197]
    v_pk_add_f32 v[194:195], v[194:195], v[198:199]
    v_mov_b32 v196, v192
    v_mov_b32 v197, v193
    v_mov_b32 v198, v194
    v_mov_b32 v199, v195
    s_nop 0
    v_permlane16_swap_b32 v192, v196
    v_permlane16_swap_b32 v193, v197
    v_permlane16_swap_b32 v194, v198
    v_permlane16_swap_b32 v195, v199
    v_add_f32 v192, v192, v196
    v_add_f32 v193, v193, v197
    v_add_f32 v194, v194, v198
    v_add_f32 v195, v195, v199
    v_mov_b32 v196, v192
    v_mov_b32 v197, v193
    v_mov_b32 v198, v194
    v_mov_b32 v199, v195
    s_nop 0
    v_permlane32_swap_b32 v192, v196
    v_permlane32_swap_b32 v193, v197
    v_permlane32_swap_b32 v194, v198
    v_permlane32_swap_b32 v195, v199
    v_add_f32 v192, v192, v196
    v_add_f32 v193, v193, v197
    v_add_f32 v194, v194, v198
    v_add_f32 v195, v195, v199
    s_lshl_b32 s64, s3, 8
    v_lshl_add_u32 v208, v208, 4, s64
    ds_write_b128 v208, v[192:195] offset:5888
    v_mov_b32 v208, 0
    v_mov_b32 v214, 1
    s_mov_b64 exec, 1
    ds_add_rtn_u32 v210, v208, v214 offset:4304
    s_mov_b64 exec, -1
    s_and_b32 s64, s75, 0xffff0000
    s_xor_b32 s65, s64, 0x80000000
    s_not_b32 s69, s64
    s_and_b32 s69, s69, 0xffff0000
    s_cmp_ge_u32 s64, 0x80000000
    s_cselect_b32 s64, s65, s69
    v_mov_b32 v213, s64
    v_lshlrev_b32 v208, 2, v2
    s_waitcnt lgkmcnt(0)
    v_readfirstlane_b32 s64, v210
    s_cmp_lg_u32 s64, 3
    s_cbranch_scc1 P2_ny
    ds_read_b32 v192, v208 offset:5888
    ds_read_b32 v193, v208 offset:6144
    ds_read_b32 v194, v208 offset:6400
    ds_read_b32 v195, v208 offset:6656
    v_mul_f32 v213, s72, v213
    v_exp_f32 v213, -v213
    s_nop 0
    v_add_f32 v213, 1.0, v213
    v_rcp_f32 v213, v213
    s_nop 0
    v_cvt_pk_bf16_f32 v213, v213, v213
    v_lshlrev_b32 v213, 16, v213
    v_sub_f32 v214, 1.0, v212
    v_cvt_pk_bf16_f32 v214, v214, v214
    v_lshlrev_b32 v214, 16, v214
    v_lshlrev_b32 v211, 16, v211
    s_waitcnt lgkmcnt(0)
    v_add_f32 v192, v192, v193
    v_add_f32 v194, v194, v195
    v_add_f32 v210, v192, v194
    v_cvt_pk_bf16_f32 v210, v210, v210
    v_lshlrev_b32 v210, 16, v210
    v_mul_f32 v210, v210, v213
    v_cvt_pk_bf16_f32 v210, v210, v210
    v_lshlrev_b32 v210, 16, v210
    v_add_f32 v210, v211, v210
    v_cvt_pk_bf16_f32 v210, v210, v210
    v_lshlrev_b32 v210, 16, v210
    v_mul_f32 v210, v210, v214
    v_cvt_pk_bf16_f32 v210, v210, v210
    v_lshlrev_b32 v210, 16, v210
    ds_write_b32 v208, v210 offset:5632
    s_waitcnt lgkmcnt(0)
    s_branch P2_ny
P2_fix:
    s_mov_b64 exec, s[70:71]
    ds_read_b128 v[232:235], v9 offset:5632
    ds_read_b128 v[236:239], v9 offset:5648
    ds_read_b128 v[240:243], v9 offset:5760
    ds_read_b128 v[244:247], v9 offset:5776
    s_mov_b64 exec, -1
    s_branch P2_nr
CODE_END:
.section .rodata,"a"
.p2align 6
.amdhsa_kernel gated_mix__linear_attn_block__moe_arch_mod__prompt_kernel
  .amdhsa_next_free_vgpr 256
  .amdhsa_next_free_sgpr 102
  .amdhsa_accum_offset 256
  .amdhsa_group_segment_fixed_size 0
  .amdhsa_kernarg_size 96
  .amdhsa_user_sgpr_count 2
  .amdhsa_user_sgpr_kernarg_segment_ptr 1
  .amdhsa_system_sgpr_workgroup_id_x 1
.end_amdhsa_kernel
```

```asm
; @launch grid=(256,1,1) block=(512,1,1) lds=163840
.amdgcn_target "amdgcn-amd-amdhsa--gfx950"
.text
.globl gated_mix__linear_attn_block__moe_arch_mod__prompt_kernel
.p2align 8
.type gated_mix__linear_attn_block__moe_arch_mod__prompt_kernel,@function
gated_mix__linear_attn_block__moe_arch_mod__prompt_kernel:
    s_load_dwordx16 s[40:55], s[0:1], 0
    s_load_dwordx8 s[56:63], s[0:1], 64
    s_cmp_ge_u32 s2, 256
    s_cbranch_scc1 K_end
    v_lshrrev_b32 v1, 6, v0
    v_and_b32 v2, 63, v0
    s_and_b32 s6, s2, 7
    v_readfirstlane_b32 s3, v1
    s_lshr_b32 s7, s2, 3
    s_and_b32 s4, s6, 1
    s_lshl_b32 s4, s4, 3
    s_and_b32 s64, s7, 7
    s_add_u32 s4, s4, s64
    s_lshr_b32 s5, s6, 1
    s_lshl_b32 s5, s5, 2
    s_lshr_b32 s64, s7, 3
    s_add_u32 s5, s5, s64
    s_and_b32 s74, s4, 3
    s_lshl_b32 s74, s74, 2
    s_add_u32 s74, s74, s6
    v_lshrrev_b32 v6, 3, v2
    s_lshl_b32 s65, s3, 3
    v_add_u32 v6, s65, v6
    s_lshl_b32 s64, s4, 7
    v_add_u32 v7, s64, v6
    v_lshlrev_b32 v7, 11, v7
    v_lshrrev_b32 v8, 4, v2
    s_and_b32 s64, s3, 1
    s_lshl_b32 s64, s64, 2
    v_add_u32 v9, s64, v8
    v_and_b32 v10, 7, v2
    v_xor_b32 v9, v9, v10
    v_lshl_add_u32 v7, v9, 4, v7
    v_mul_u32_u24 v6, 6144, v6
    v_and_b32 v9, 1, v8
    s_lshr_b32 s64, s64, 1
    v_lshl_add_u32 v9, v9, 2, s64
    v_xor_b32 v9, v9, v10
    v_lshl_add_u32 v6, v9, 4, v6
    s_lshl_b32 s64, s5, 7
    v_add_u32 v6, s64, v6
    s_lshl_b32 s66, s3, 10
    s_mov_b32 s10, 4194304
    s_mov_b32 s11, 0x00020000
    s_mov_b32 s14, 6291456
    s_mov_b32 s15, 0x00020000
    s_add_u32 s65, s74, 0
    s_and_b32 s65, s65, 15
    s_lshl_b32 s67, s65, 7
    s_mul_i32 s65, s65, 393216
    s_waitcnt lgkmcnt(0)
    s_mov_b32 s8, s40
    s_mov_b32 s9, s41
    s_mov_b32 s12, s42
    s_mov_b32 s13, s43
    s_add_u32 m0, s66, 8192
    s_add_u32 s64, s67, 0
    buffer_load_dwordx4 v7, s[8:11], s64 offen lds
    s_add_u32 m0, s66, 16384
    s_add_u32 s64, s67, 131072
    buffer_load_dwordx4 v7, s[8:11], s64 offen lds
    s_add_u32 m0, s66, 24576
    s_add_u32 s64, s65, 0
    buffer_load_dwordx4 v6, s[12:15], s64 offen lds
    s_add_u32 m0, s66, 32768
    s_add_u32 s64, s65, 2048
    buffer_load_dwordx4 v6, s[12:15], s64 offen lds
    s_add_u32 m0, s66, 40960
    s_add_u32 s64, s65, 4096
    buffer_load_dwordx4 v6, s[12:15], s64 offen lds
    s_cmp_lt_u32 s3, 4
    s_cbranch_scc1 K_nt
    s_lshl_b32 s64, s2, 2
    s_add_u32 s64, s64, s3
    s_sub_u32 s64, s64, 4
    s_mul_i32 s64, s64, 6144
    s_add_u32 s46, s12, s64
    s_addc_u32 s47, s13, 0
    s_load_dword s43, s[46:47], 384
    s_load_dword s43, s[46:47], 448
    s_load_dword s43, s[46:47], 1408
    s_load_dword s43, s[46:47], 1472
    s_load_dword s43, s[46:47], 2432
    s_load_dword s43, s[46:47], 2496
    s_load_dword s43, s[46:47], 3456
    s_load_dword s43, s[46:47], 3520
    s_load_dword s43, s[46:47], 4480
    s_load_dword s43, s[46:47], 4544
    s_load_dword s43, s[46:47], 5504
    s_load_dword s43, s[46:47], 5568
K_nt:
    s_barrier
    s_mov_b32 s72, 0x3fb8aa3b
    s_mov_b32 s73, 0x358637bd
    s_mov_b32 s16, s62
    s_mov_b32 s17, s63
    s_mov_b32 s18, 0x10000000
    s_mov_b32 s19, 0x00020000
    s_cmp_lt_u32 s3, 4
    s_cbranch_scc1 C_start
    s_sub_u32 s6, s3, 4
    s_lshl_b32 s7, s6, 10
    v_lshrrev_b32 v6, 3, v2
    s_lshl_b32 s64, s4, 7
    s_lshl_b32 s65, s6, 3
    s_add_u32 s64, s64, s65
    v_add_u32 v7, s64, v6
    v_lshlrev_b32 v7, 11, v7
    s_and_b32 s64, s6, 1
    s_lshl_b32 s64, s64, 2
    v_add_u32 v9, s64, v8
    v_xor_b32 v9, v9, v10
    v_lshl_add_u32 v4, v9, 4, v7
    v_add_u32 v7, s65, v6
    v_mul_u32_u24 v7, 6144, v7
    v_and_b32 v9, 1, v8
    s_lshr_b32 s64, s64, 1
    v_lshl_add_u32 v9, v9, 2, s64
    v_xor_b32 v9, v9, v10
    v_lshl_add_u32 v7, v9, 4, v7
    s_lshl_b32 s64, s5, 7
    v_add_u32 v5, s64, v7
    v_lshlrev_b32 v6, 4, v2
    s_and_b32 s64, s2, 1
    s_lshl_b32 s68, s64, 10
    s_bfe_u32 s64, s2, 0x20001
    s_lshl_b32 s64, s64, 8
    s_add_u32 s68, s68, s64
    s_and_b32 s64, s2, 0xf8
    s_add_u32 s68, s68, s64
    s_lshl_b32 s64, s6, 1
    s_add_u32 s68, s68, s64
    s_lshl_b32 s64, s68, 11
    v_add_u32 v13, s64, v6
    s_add_u32 s41, s74, 1
    s_and_b32 s41, s41, 15
    s_lshl_b32 s42, s41, 7
    s_mul_i32 s41, s41, 393216
    s_add_u32 m0, s7, 49152
    s_add_u32 s40, s42, 0
    buffer_load_dwordx4 v4, s[8:11], s40 offen lds
    s_add_u32 m0, s7, 53248
    s_add_u32 s40, s42, 65536
    buffer_load_dwordx4 v4, s[8:11], s40 offen lds
    s_add_u32 m0, s7, 57344
    s_add_u32 s40, s42, 131072
    buffer_load_dwordx4 v4, s[8:11], s40 offen lds
    s_add_u32 m0, s7, 61440
    s_add_u32 s40, s42, 196608
    buffer_load_dwordx4 v4, s[8:11], s40 offen lds
    s_add_u32 m0, s7, 65536
    s_add_u32 s40, s41, 0
    buffer_load_dwordx4 v5, s[12:15], s40 offen lds
    s_add_u32 m0, s7, 69632
    s_add_u32 s40, s41, 196608
    buffer_load_dwordx4 v5, s[12:15], s40 offen lds
    s_add_u32 m0, s7, 73728
    s_add_u32 s40, s41, 2048
    buffer_load_dwordx4 v5, s[12:15], s40 offen lds
    s_add_u32 m0, s7, 77824
    s_add_u32 s40, s41, 198656
    buffer_load_dwordx4 v5, s[12:15], s40 offen lds
    s_add_u32 m0, s7, 81920
    s_add_u32 s40, s41, 4096
    buffer_load_dwordx4 v5, s[12:15], s40 offen lds
    s_add_u32 m0, s7, 86016
    s_add_u32 s40, s41, 200704
    buffer_load_dwordx4 v5, s[12:15], s40 offen lds
    s_mov_b32 s32, s50
    s_mov_b32 s33, s51
    s_mov_b32 s34, 0x700000
    s_mov_b32 s35, 0x00020000
    s_mov_b32 s36, s52
    s_mov_b32 s37, s53
    s_mov_b32 s38, 0x700000
    s_mov_b32 s39, 0x00020000
    s_or_b32 s64, s2, s6
    s_cmp_lg_u32 s64, 0
    s_cbranch_scc1 H_nn
    s_mov_b32 s64, 6717440
    s_load_dwordx2 s[66:67], s[62:63], s64
    s_mov_b32 s20, s60
    s_mov_b32 s21, s61
    s_mov_b32 s22, 0x100
    s_mov_b32 s23, 0x00020000
    s_waitcnt lgkmcnt(0)
    s_xor_b32 s64, s66, s67
    s_add_u32 s64, s64, 1
    s_max_u32 s64, s64, 1
    v_mov_b32 v72, s64
    v_mov_b32 v73, 0
    s_mov_b64 exec, 1
    buffer_store_dword v72, v73, s[20:23], 0 offen sc0 sc1
    s_mov_b64 exec, -1
H_nn:
    s_mov_b32 s20, s60
    s_mov_b32 s21, s61
    s_mov_b32 s22, 0x100
    s_mov_b32 s23, 0x00020000
    s_mov_b32 s24, s48
    s_mov_b32 s25, s49
    s_mov_b32 s26, 0x800
    s_mov_b32 s27, 0x00020000
    s_mov_b32 s28, s56
    s_mov_b32 s29, s57
    s_mov_b32 s30, 0x800
    s_mov_b32 s31, 0x00020000
    s_lshr_b32 s69, s2, 3
    s_and_b32 s64, s2, 7
    v_and_b32 v9, 15, v2
    v_min_u32 v9, 13, v9
    s_lshl_b32 s65, s69, 5
    v_lshl_add_u32 v7, v8, 3, s65
    v_mul_u32_u24 v7, 7168, v7
    s_mul_i32 s65, s64, 896
    s_mul_i32 s66, s6, 224
    s_add_u32 s65, s65, s66
    v_lshl_add_u32 v7, v9, 4, v7
    v_add_u32 v11, s65, v7
    v_cmp_le_u32 vcc, 7, v9
    v_mov_b32 v15, 16160
    s_nop 0
    v_cndmask_b32 v7, 0, v15, vcc
    v_lshl_add_u32 v7, v9, 5, v7
    v_lshrrev_b32 v15, 1, v8
    v_lshl_add_u32 v7, v15, 13, v7
    v_and_b32 v15, 1, v8
    v_lshl_add_u32 v7, v15, 4, v7
    s_lshl_b32 s64, s64, 17
    s_lshl_b32 s65, s6, 15
    s_add_u32 s64, s64, s65
    s_lshl_b32 s65, s69, 8
    s_add_u32 s64, s64, s65
    s_add_u32 s64, s64, 5398528
    v_add_u32 v12, s64, v7
    s_lshl_b32 s70, s5, 2
    s_add_u32 s70, s70, s6
    s_mul_i32 s70, s70, 18432
    s_add_u32 s70, s70, 4194304
    s_mul_i32 s64, s4, 1152
    s_add_u32 s64, s64, s70
    s_mov_b32 s67, s64
    v_lshl_add_u32 v15, v2, 2, s64
    v_add_u32 v15, 960, v15
    s_lshl_b32 s64, s5, 2
    s_add_u32 s64, s64, s6
    s_lshl_b32 s64, s64, 7
    s_add_u32 s64, s64, 5373952
    v_mov_b32 v23, s64
    s_lshl_b32 s65, s4, 10
    s_add_u32 s65, s65, 5382016
    v_lshl_add_u32 v20, v2, 7, s65
    v_cmp_gt_u32 vcc, 16, v2
    s_nop 1
    v_cndmask_b32 v15, v15, v20, vcc
    v_writelane_b32 v15, s64, 0
    s_cmp_eq_u32 s4, 0
    s_cselect_b32 s75, 1, 0
    s_or_b32 s64, s5, s6
    s_cmp_eq_u32 s64, 0
    s_cselect_b32 s64, 0x1fe, 0
    s_or_b32 s75, s75, s64
    s_or_b32 s75, s75, 0xffff0000
    v_lshlrev_b32 v22, 4, v2
    v_add_u32 v22, s67, v22
    v_mov_b32 v16, -1
    v_mov_b32 v17, -1
    v_mov_b32 v18, -1
    v_mov_b32 v19, -1
    v_cndmask_b32 v20, -1, 0, vcc
    s_waitcnt vmcnt(10)
    s_barrier
    s_add_u32 s41, s74, 2
    s_and_b32 s41, s41, 15
    s_lshl_b32 s42, s41, 7
    s_mul_i32 s41, s41, 393216
    s_add_u32 m0, s7, 90112
    s_add_u32 s40, s42, 0
    buffer_load_dwordx4 v4, s[8:11], s40 offen lds
    s_add_u32 m0, s7, 94208
    s_add_u32 s40, s42, 65536
    buffer_load_dwordx4 v4, s[8:11], s40 offen lds
    s_add_u32 m0, s7, 98304
    s_add_u32 s40, s42, 131072
    buffer_load_dwordx4 v4, s[8:11], s40 offen lds
    s_add_u32 m0, s7, 102400
    s_add_u32 s40, s42, 196608
    buffer_load_dwordx4 v4, s[8:11], s40 offen lds
    s_add_u32 m0, s7, 106496
    s_add_u32 s40, s41, 0
    buffer_load_dwordx4 v5, s[12:15], s40 offen lds
    s_add_u32 m0, s7, 110592
    s_add_u32 s40, s41, 196608
    buffer_load_dwordx4 v5, s[12:15], s40 offen lds
    s_add_u32 m0, s7, 114688
    s_add_u32 s40, s41, 2048
    buffer_load_dwordx4 v5, s[12:15], s40 offen lds
    s_add_u32 m0, s7, 118784
    s_add_u32 s40, s41, 198656
    buffer_load_dwordx4 v5, s[12:15], s40 offen lds
    s_add_u32 m0, s7, 122880
    s_add_u32 s40, s41, 4096
    buffer_load_dwordx4 v5, s[12:15], s40 offen lds
    s_add_u32 m0, s7, 126976
    s_add_u32 s40, s41, 200704
    buffer_load_dwordx4 v5, s[12:15], s40 offen lds
    s_getpc_b64 s[66:67]
pc_1:
    s_sub_u32 s66, s66, pc_1-gated_mix__linear_attn_block__moe_arch_mod__prompt_kernel
    s_subb_u32 s67, s67, 0
    s_lshr_b32 s64, s2, 3
    s_lshl_b32 s64, s64, 2
    s_add_u32 s64, s64, s6
    s_mul_i32 s64, s64, 256
    s_min_u32 s65, s64, CODE_END-gated_mix__linear_attn_block__moe_arch_mod__prompt_kernel-4
    s_load_dword s43, s[66:67], s65
    s_add_u32 s64, s64, 64
    s_min_u32 s65, s64, CODE_END-gated_mix__linear_attn_block__moe_arch_mod__prompt_kernel-4
    s_load_dword s43, s[66:67], s65
    s_add_u32 s64, s64, 64
    s_min_u32 s65, s64, CODE_END-gated_mix__linear_attn_block__moe_arch_mod__prompt_kernel-4
    s_load_dword s43, s[66:67], s65
    s_add_u32 s64, s64, 64
    s_min_u32 s65, s64, CODE_END-gated_mix__linear_attn_block__moe_arch_mod__prompt_kernel-4
    s_load_dword s43, s[66:67], s65
    s_add_u32 s64, s64, 64
    buffer_load_dwordx4 v[24:27], v13, s[8:11], 0 offen offset:0
    buffer_load_dwordx4 v[28:31], v13, s[8:11], 0 offen offset:1024
    buffer_load_dwordx4 v[32:35], v13, s[8:11], 0 offen offset:2048
    buffer_load_dwordx4 v[36:39], v13, s[8:11], 0 offen offset:3072
    s_cmp_lt_u32 s6, 2
    s_cselect_b32 s24, s48, s56
    s_cselect_b32 s25, s49, s57
    s_and_b32 s64, s7, 1024
    s_add_u32 m0, s7, 0
    s_nop 0
    buffer_load_dwordx4 v6, s[24:27], s64 offen lds
    s_waitcnt vmcnt(15)
    s_barrier
    s_add_u32 s41, s74, 3
    s_and_b32 s41, s41, 15
    s_lshl_b32 s42, s41, 7
    s_mul_i32 s41, s41, 393216
    s_add_u32 m0, s7, 8192
    s_add_u32 s40, s42, 0
    buffer_load_dwordx4 v4, s[8:11], s40 offen lds
    s_add_u32 m0, s7, 12288
    s_add_u32 s40, s42, 65536
    buffer_load_dwordx4 v4, s[8:11], s40 offen lds
    s_add_u32 m0, s7, 16384
    s_add_u32 s40, s42, 131072
    buffer_load_dwordx4 v4, s[8:11], s40 offen lds
    s_add_u32 m0, s7, 20480
    s_add_u32 s40, s42, 196608
    buffer_load_dwordx4 v4, s[8:11], s40 offen lds
    s_add_u32 m0, s7, 24576
    s_add_u32 s40, s41, 0
    buffer_load_dwordx4 v5, s[12:15], s40 offen lds
    s_add_u32 m0, s7, 28672
    s_add_u32 s40, s41, 196608
    buffer_load_dwordx4 v5, s[12:15], s40 offen lds
    s_add_u32 m0, s7, 32768
    s_add_u32 s40, s41, 2048
    buffer_load_dwordx4 v5, s[12:15], s40 offen lds
    s_add_u32 m0, s7, 36864
    s_add_u32 s40, s41, 198656
    buffer_load_dwordx4 v5, s[12:15], s40 offen lds
    s_add_u32 m0, s7, 40960
    s_add_u32 s40, s41, 4096
    buffer_load_dwordx4 v5, s[12:15], s40 offen lds
    s_add_u32 m0, s7, 45056
    s_add_u32 s40, s41, 200704
    buffer_load_dwordx4 v5, s[12:15], s40 offen lds
    buffer_store_dwordx4 v[16:19], v22, s[16:19], 0 offen sc0 sc1
    s_mov_b32 exec_lo, s75
    s_mov_b32 exec_hi, 0
    buffer_store_dword v20, v15, s[16:19], 0 offen sc0 sc1
    s_mov_b32 exec_lo, 0x3fff3fff
    s_mov_b32 exec_hi, 0x3fff3fff
    buffer_store_dwordx4 v[16:19], v12, s[16:19], 0 offen sc0 sc1
    s_mov_b64 exec, 0xffff
    s_lshl_b32 s64, s2, 10
    s_lshl_b32 s65, s6, 8
    s_add_u32 s64, s64, s65
    s_add_u32 s64, s64, 6447104
    buffer_store_dwordx4 v[16:19], v6, s[16:19], s64 offen sc0 sc1
    s_mov_b64 exec, -1
    s_waitcnt vmcnt(19)
    s_barrier
    v_mov_b32 v79, 0
    s_cmp_lg_u32 s6, 0
    s_cbranch_scc1 H_nc
    buffer_load_dword v78, v79, s[20:23], 0 offen sc1
H_nc:
    s_add_u32 s41, s74, 4
    s_and_b32 s41, s41, 15
    s_lshl_b32 s42, s41, 7
    s_mul_i32 s41, s41, 393216
    s_add_u32 m0, s7, 49152
    s_add_u32 s40, s42, 0
    buffer_load_dwordx4 v4, s[8:11], s40 offen lds
    s_add_u32 m0, s7, 53248
    s_add_u32 s40, s42, 65536
    buffer_load_dwordx4 v4, s[8:11], s40 offen lds
    s_add_u32 m0, s7, 57344
    s_add_u32 s40, s42, 131072
    buffer_load_dwordx4 v4, s[8:11], s40 offen lds
    s_add_u32 m0, s7, 61440
    s_add_u32 s40, s42, 196608
    buffer_load_dwordx4 v4, s[8:11], s40 offen lds
    s_add_u32 m0, s7, 65536
    s_add_u32 s40, s41, 0
    buffer_load_dwordx4 v5, s[12:15], s40 offen lds
    s_add_u32 m0, s7, 69632
    s_add_u32 s40, s41, 196608
    buffer_load_dwordx4 v5, s[12:15], s40 offen lds
    s_add_u32 m0, s7, 73728
    s_add_u32 s40, s41, 2048
    buffer_load_dwordx4 v5, s[12:15], s40 offen lds
    s_add_u32 m0, s7, 77824
    s_add_u32 s40, s41, 198656
    buffer_load_dwordx4 v5, s[12:15], s40 offen lds
    s_add_u32 m0, s7, 81920
    s_add_u32 s40, s41, 4096
    buffer_load_dwordx4 v5, s[12:15], s40 offen lds
    s_add_u32 m0, s7, 86016
    s_add_u32 s40, s41, 200704
    buffer_load_dwordx4 v5, s[12:15], s40 offen lds
    s_waitcnt vmcnt(14)
    s_barrier
    ds_read_b128 v[40:43], v6 offset:0
    ds_read_b128 v[44:47], v6 offset:1024
    ds_read_b128 v[48:51], v6 offset:2048
    ds_read_b128 v[52:55], v6 offset:3072
    s_add_u32 s41, s74, 5
    s_and_b32 s41, s41, 15
    s_lshl_b32 s42, s41, 7
    s_mul_i32 s41, s41, 393216
    s_add_u32 m0, s7, 90112
    s_add_u32 s40, s42, 0
    buffer_load_dwordx4 v4, s[8:11], s40 offen lds
    s_waitcnt lgkmcnt(0)
    s_add_u32 m0, s7, 94208
    s_add_u32 s40, s42, 65536
    buffer_load_dwordx4 v4, s[8:11], s40 offen lds
    v_dot2_f32_bf16 v72, v24, v48, 0
    v_dot2_f32_bf16 v73, v32, v48, 0
    v_dot2_f32_bf16 v74, v24, v40, 0
    v_dot2_f32_bf16 v75, v32, v40, 0
    s_add_u32 m0, s7, 98304
    s_add_u32 s40, s42, 131072
    buffer_load_dwordx4 v4, s[8:11], s40 offen lds
    v_dot2_f32_bf16 v72, v25, v49, v72
    v_dot2_f32_bf16 v73, v33, v49, v73
    v_dot2_f32_bf16 v74, v25, v41, v74
    v_dot2_f32_bf16 v75, v33, v41, v75
    s_add_u32 m0, s7, 102400
    s_add_u32 s40, s42, 196608
    buffer_load_dwordx4 v4, s[8:11], s40 offen lds
    v_dot2_f32_bf16 v72, v26, v50, v72
    v_dot2_f32_bf16 v73, v34, v50, v73
    v_dot2_f32_bf16 v74, v26, v42, v74
    v_dot2_f32_bf16 v75, v34, v42, v75
    s_add_u32 m0, s7, 106496
    s_add_u32 s40, s41, 0
    buffer_load_dwordx4 v5, s[12:15], s40 offen lds
    v_dot2_f32_bf16 v72, v27, v51, v72
    v_dot2_f32_bf16 v73, v35, v51, v73
    v_dot2_f32_bf16 v74, v27, v43, v74
    v_dot2_f32_bf16 v75, v35, v43, v75
    s_add_u32 m0, s7, 110592
    s_add_u32 s40, s41, 196608
    buffer_load_dwordx4 v5, s[12:15], s40 offen lds
    v_dot2_f32_bf16 v72, v28, v52, v72
    v_dot2_f32_bf16 v73, v36, v52, v73
    v_dot2_f32_bf16 v74, v28, v44, v74
    v_dot2_f32_bf16 v75, v36, v44, v75
    s_add_u32 m0, s7, 114688
    s_add_u32 s40, s41, 2048
    buffer_load_dwordx4 v5, s[12:15], s40 offen lds
    v_dot2_f32_bf16 v72, v29, v53, v72
    v_dot2_f32_bf16 v73, v37, v53, v73
    v_dot2_f32_bf16 v74, v29, v45, v74
    v_dot2_f32_bf16 v75, v37, v45, v75
    s_add_u32 m0, s7, 118784
    s_add_u32 s40, s41, 198656
    buffer_load_dwordx4 v5, s[12:15], s40 offen lds
    v_dot2_f32_bf16 v72, v30, v54, v72
    v_dot2_f32_bf16 v73, v38, v54, v73
    v_dot2_f32_bf16 v74, v30, v46, v74
    v_dot2_f32_bf16 v75, v38, v46, v75
    s_add_u32 m0, s7, 122880
    s_add_u32 s40, s41, 4096
    buffer_load_dwordx4 v5, s[12:15], s40 offen lds
    v_dot2_f32_bf16 v72, v31, v55, v72
    v_dot2_f32_bf16 v73, v39, v55, v73
    v_dot2_f32_bf16 v74, v31, v47, v74
    v_dot2_f32_bf16 v75, v39, v47, v75
    s_add_u32 m0, s7, 126976
    s_add_u32 s40, s41, 200704
    buffer_load_dwordx4 v5, s[12:15], s40 offen lds
    s_waitcnt vmcnt(10)
    s_barrier
    s_add_u32 s41, s74, 6
    s_and_b32 s41, s41, 15
    s_lshl_b32 s42, s41, 7
    s_mul_i32 s41, s41, 393216
    s_add_u32 m0, s7, 8192
    s_add_u32 s40, s42, 0
    buffer_load_dwordx4 v4, s[8:11], s40 offen lds
    v_permlane32_swap_b32 v72, v74
    v_permlane32_swap_b32 v73, v75
    v_add_f32 v72, v72, v74
    v_add_f32 v73, v73, v75
    s_add_u32 m0, s7, 12288
    s_add_u32 s40, s42, 65536
    buffer_load_dwordx4 v4, s[8:11], s40 offen lds
    s_lshl_b32 s64, s68, 2
    s_add_u32 s64, s64, 6709248
    v_permlane16_swap_b32 v72, v73
    v_add_f32 v72, v72, v73
    s_add_u32 m0, s7, 16384
    s_add_u32 s40, s42, 131072
    buffer_load_dwordx4 v4, s[8:11], s40 offen lds
    v_and_b32 v75, 1, v8
    v_lshl_add_u32 v76, v75, 2, s64
    v_add_f32_dpp v72, v72, v72 quad_perm:[1,0,3,2] row_mask:0xf bank_mask:0xf
    s_nop 1
    s_add_u32 m0, s7, 20480
    s_add_u32 s40, s42, 196608
    buffer_load_dwordx4 v4, s[8:11], s40 offen lds
    v_add_f32_dpp v72, v72, v72 quad_perm:[2,3,0,1] row_mask:0xf bank_mask:0xf
    s_nop 1
    v_add_f32_dpp v72, v72, v72 row_half_mirror row_mask:0xf bank_mask:0xf
    s_nop 1
    s_add_u32 m0, s7, 24576
    s_add_u32 s40, s41, 0
    buffer_load_dwordx4 v5, s[12:15], s40 offen lds
    v_add_f32_dpp v72, v72, v72 row_mirror row_mask:0xf bank_mask:0xf
    s_nop 1
    v_cvt_pk_bf16_f32 v72, v72, v72
    s_sub_u32 s64, 34815, s68
    s_add_u32 m0, s7, 28672
    s_add_u32 s40, s41, 196608
    buffer_load_dwordx4 v5, s[12:15], s40 offen lds
    v_lshlrev_b32 v72, 16, v72
    v_ashrrev_i32 v73, 31, v72
    v_sub_u32 v77, s64, v75
    v_or_b32 v73, 0x80000000, v73
    s_add_u32 m0, s7, 32768
    s_add_u32 s40, s41, 2048
    buffer_load_dwordx4 v5, s[12:15], s40 offen lds
    s_lshl_b32 s64, s6, 3
    v_xor_b32 v73, v72, v73
    v_lshl_add_u32 v75, v75, 2, s64
    v_and_b32 v73, 0xffff0000, v73
    s_add_u32 m0, s7, 36864
    s_add_u32 s40, s41, 198656
    buffer_load_dwordx4 v5, s[12:15], s40 offen lds
    v_or_b32 v73, v77, v73
    v_mul_f32 v72, s72, v72
    v_exp_f32 v72, -v72
    s_nop 0
    s_add_u32 m0, s7, 40960
    s_add_u32 s40, s41, 4096
    buffer_load_dwordx4 v5, s[12:15], s40 offen lds
    v_add_f32 v72, 1.0, v72
    v_rcp_f32 v72, v72
    s_nop 0
    v_cvt_pk_bf16_f32 v72, v72, v72
    s_add_u32 m0, s7, 45056
    s_add_u32 s40, s41, 200704
    buffer_load_dwordx4 v5, s[12:15], s40 offen lds
    v_lshlrev_b32 v72, 16, v72
    s_mov_b32 exec_lo, 0
    s_mov_b32 exec_hi, 0x10001
    ds_write_b32 v75, v73 offset:4224
    s_mov_b32 exec_lo, 0x10001
    s_mov_b32 exec_hi, 0
    buffer_store_dword v72, v76, s[16:19], 0 offen sc0 sc1
    s_mov_b64 exec, -1
    s_mov_b32 exec_lo, 0x3fff3fff
    s_mov_b32 exec_hi, 0x3fff3fff
    s_mov_b32 s64, 0
    buffer_load_dwordx4 v[96:99], v11, s[32:35], s64 offen nt
    s_mov_b32 s64, 0
    buffer_load_dwordx4 v[128:131], v11, s[36:39], s64 offen nt
    s_mov_b32 s64, 7168
    buffer_load_dwordx4 v[100:103], v11, s[32:35], s64 offen nt
    s_mov_b32 s64, 7168
    buffer_load_dwordx4 v[132:135], v11, s[36:39], s64 offen nt
    s_mov_b32 s64, 14336
    buffer_load_dwordx4 v[104:107], v11, s[32:35], s64 offen nt
    s_mov_b64 exec, -1
    s_waitcnt vmcnt(16)
    s_waitcnt lgkmcnt(0)
    s_barrier
    s_add_u32 s41, s74, 7
    s_and_b32 s41, s41, 15
    s_lshl_b32 s42, s41, 7
    s_mul_i32 s41, s41, 393216
    s_add_u32 m0, s7, 49152
    s_add_u32 s40, s42, 0
    buffer_load_dwordx4 v4, s[8:11], s40 offen lds
    s_add_u32 m0, s7, 53248
    s_add_u32 s40, s42, 65536
    buffer_load_dwordx4 v4, s[8:11], s40 offen lds
    s_add_u32 m0, s7, 57344
    s_add_u32 s40, s42, 131072
    buffer_load_dwordx4 v4, s[8:11], s40 offen lds
    s_add_u32 m0, s7, 61440
    s_add_u32 s40, s42, 196608
    buffer_load_dwordx4 v4, s[8:11], s40 offen lds
    s_add_u32 m0, s7, 65536
    s_add_u32 s40, s41, 0
    buffer_load_dwordx4 v5, s[12:15], s40 offen lds
    s_add_u32 m0, s7, 69632
    s_add_u32 s40, s41, 196608
    buffer_load_dwordx4 v5, s[12:15], s40 offen lds
    s_add_u32 m0, s7, 73728
    s_add_u32 s40, s41, 2048
    buffer_load_dwordx4 v5, s[12:15], s40 offen lds
    s_add_u32 m0, s7, 77824
    s_add_u32 s40, s41, 198656
    buffer_load_dwordx4 v5, s[12:15], s40 offen lds
    s_add_u32 m0, s7, 81920
    s_add_u32 s40, s41, 4096
    buffer_load_dwordx4 v5, s[12:15], s40 offen lds
    s_add_u32 m0, s7, 86016
    s_add_u32 s40, s41, 200704
    buffer_load_dwordx4 v5, s[12:15], s40 offen lds
    s_waitcnt vmcnt(16)
    s_barrier
    s_add_u32 s41, s74, 8
    s_and_b32 s41, s41, 15
    s_lshl_b32 s42, s41, 7
    s_mul_i32 s41, s41, 393216
    s_add_u32 m0, s7, 90112
    s_add_u32 s40, s42, 0
    buffer_load_dwordx4 v4, s[8:11], s40 offen lds
    s_add_u32 m0, s7, 94208
    s_add_u32 s40, s42, 65536
    buffer_load_dwordx4 v4, s[8:11], s40 offen lds
    s_add_u32 m0, s7, 98304
    s_add_u32 s40, s42, 131072
    buffer_load_dwordx4 v4, s[8:11], s40 offen lds
    s_add_u32 m0, s7, 102400
    s_add_u32 s40, s42, 196608
    buffer_load_dwordx4 v4, s[8:11], s40 offen lds
    s_add_u32 m0, s7, 106496
    s_add_u32 s40, s41, 0
    buffer_load_dwordx4 v5, s[12:15], s40 offen lds
    s_add_u32 m0, s7, 110592
    s_add_u32 s40, s41, 196608
    buffer_load_dwordx4 v5, s[12:15], s40 offen lds
    s_add_u32 m0, s7, 114688
    s_add_u32 s40, s41, 2048
    buffer_load_dwordx4 v5, s[12:15], s40 offen lds
    s_add_u32 m0, s7, 118784
    s_add_u32 s40, s41, 198656
    buffer_load_dwordx4 v5, s[12:15], s40 offen lds
    s_add_u32 m0, s7, 122880
    s_add_u32 s40, s41, 4096
    buffer_load_dwordx4 v5, s[12:15], s40 offen lds
    s_add_u32 m0, s7, 126976
    s_add_u32 s40, s41, 200704
    buffer_load_dwordx4 v5, s[12:15], s40 offen lds
    s_waitcnt vmcnt(10)
    s_barrier
    s_add_u32 s41, s74, 9
    s_and_b32 s41, s41, 15
    s_lshl_b32 s42, s41, 7
    s_mul_i32 s41, s41, 393216
    s_add_u32 m0, s7, 8192
    s_add_u32 s40, s42, 0
    buffer_load_dwordx4 v4, s[8:11], s40 offen lds
    s_add_u32 m0, s7, 12288
    s_add_u32 s40, s42, 65536
    buffer_load_dwordx4 v4, s[8:11], s40 offen lds
    s_add_u32 m0, s7, 16384
    s_add_u32 s40, s42, 131072
    buffer_load_dwordx4 v4, s[8:11], s40 offen lds
    s_add_u32 m0, s7, 20480
    s_add_u32 s40, s42, 196608
    buffer_load_dwordx4 v4, s[8:11], s40 offen lds
    s_add_u32 m0, s7, 24576
    s_add_u32 s40, s41, 0
    buffer_load_dwordx4 v5, s[12:15], s40 offen lds
    s_add_u32 m0, s7, 28672
    s_add_u32 s40, s41, 196608
    buffer_load_dwordx4 v5, s[12:15], s40 offen lds
    s_add_u32 m0, s7, 32768
    s_add_u32 s40, s41, 2048
    buffer_load_dwordx4 v5, s[12:15], s40 offen lds
    s_add_u32 m0, s7, 36864
    s_add_u32 s40, s41, 198656
    buffer_load_dwordx4 v5, s[12:15], s40 offen lds
    s_add_u32 m0, s7, 40960
    s_add_u32 s40, s41, 4096
    buffer_load_dwordx4 v5, s[12:15], s40 offen lds
    s_add_u32 m0, s7, 45056
    s_add_u32 s40, s41, 200704
    buffer_load_dwordx4 v5, s[12:15], s40 offen lds
    s_cmp_lg_u32 s6, 0
    s_cbranch_scc1 H_nk
    v_mov_b32 v3, 4224
    ds_read_b128 v[72:75], v3
    ds_read_b128 v[24:27], v3 offset:16
    s_mov_b32 s65, 0
H_nspin:
    v_readfirstlane_b32 s71, v78
    s_cmp_eq_u32 s71, 0
    s_cbranch_scc1 H_nre
H_nok:
    s_lshl_b32 s64, s2, 3
    s_add_u32 s64, s64, 6717440
    v_mov_b32 v3, s64
    s_waitcnt lgkmcnt(0)
    v_max3_u32 v72, v72, v73, v74
    v_max3_u32 v24, v24, v25, v26
    v_max3_u32 v72, v72, v75, v27
    v_max_u32 v72, v72, v24
    v_xor_b32 v73, s71, v72
    s_mov_b64 exec, 1
    buffer_store_dwordx2 v[72:73], v3, s[16:19], 0 offen sc0 sc1
    s_mov_b64 exec, -1
H_nk:
    s_mov_b32 exec_lo, 0x3fff3fff
    s_mov_b32 exec_hi, 0x3fff3fff
    s_mov_b32 s64, 14336
    buffer_load_dwordx4 v[136:139], v11, s[36:39], s64 offen nt
    s_mov_b32 s64, 21504
    buffer_load_dwordx4 v[108:111], v11, s[32:35], s64 offen nt
    s_mov_b32 s64, 21504
    buffer_load_dwordx4 v[140:143], v11, s[36:39], s64 offen nt
    s_mov_b32 s64, 28672
    buffer_load_dwordx4 v[112:115], v11, s[32:35], s64 offen nt
    s_mov_b32 s64, 28672
    buffer_load_dwordx4 v[144:147], v11, s[36:39], s64 offen nt
    s_mov_b64 exec, -1
    s_waitcnt vmcnt(15)
    s_barrier
    s_add_u32 s41, s74, 10
    s_and_b32 s41, s41, 15
    s_lshl_b32 s42, s41, 7
    s_mul_i32 s41, s41, 393216
    s_add_u32 m0, s7, 49152
    s_add_u32 s40, s42, 0
    buffer_load_dwordx4 v4, s[8:11], s40 offen lds
    s_add_u32 m0, s7, 53248
    s_add_u32 s40, s42, 65536
    buffer_load_dwordx4 v4, s[8:11], s40 offen lds
    s_add_u32 m0, s7, 57344
    s_add_u32 s40, s42, 131072
    buffer_load_dwordx4 v4, s[8:11], s40 offen lds
    s_add_u32 m0, s7, 61440
    s_add_u32 s40, s42, 196608
    buffer_load_dwordx4 v4, s[8:11], s40 offen lds
    s_add_u32 m0, s7, 65536
    s_add_u32 s40, s41, 0
    buffer_load_dwordx4 v5, s[12:15], s40 offen lds
    s_add_u32 m0, s7, 69632
    s_add_u32 s40, s41, 196608
    buffer_load_dwordx4 v5, s[12:15], s40 offen lds
    s_add_u32 m0, s7, 73728
    s_add_u32 s40, s41, 2048
    buffer_load_dwordx4 v5, s[12:15], s40 offen lds
    s_add_u32 m0, s7, 77824
    s_add_u32 s40, s41, 198656
    buffer_load_dwordx4 v5, s[12:15], s40 offen lds
    s_add_u32 m0, s7, 81920
    s_add_u32 s40, s41, 4096
    buffer_load_dwordx4 v5, s[12:15], s40 offen lds
    s_add_u32 m0, s7, 86016
    s_add_u32 s40, s41, 200704
    buffer_load_dwordx4 v5, s[12:15], s40 offen lds
    s_lshl_b32 s64, s2, 2
    s_add_u32 s64, s64, s6
    s_mul_i32 s64, s64, 2048
    s_add_u32 s46, s44, s64
    s_addc_u32 s47, s45, 0
    s_load_dword s43, s[46:47], 384
    s_load_dword s43, s[46:47], 448
    s_load_dword s43, s[46:47], 1408
    s_load_dword s43, s[46:47], 1472
    s_waitcnt vmcnt(15)
    s_barrier
    s_add_u32 s41, s74, 11
    s_and_b32 s41, s41, 15
    s_lshl_b32 s42, s41, 7
    s_mul_i32 s41, s41, 393216
    s_add_u32 m0, s7, 90112
    s_add_u32 s40, s42, 0
    buffer_load_dwordx4 v4, s[8:11], s40 offen lds
    s_add_u32 m0, s7, 94208
    s_add_u32 s40, s42, 65536
    buffer_load_dwordx4 v4, s[8:11], s40 offen lds
    s_add_u32 m0, s7, 98304
    s_add_u32 s40, s42, 131072
    buffer_load_dwordx4 v4, s[8:11], s40 offen lds
    s_add_u32 m0, s7, 102400
    s_add_u32 s40, s42, 196608
    buffer_load_dwordx4 v4, s[8:11], s40 offen lds
    s_add_u32 m0, s7, 106496
    s_add_u32 s40, s41, 0
    buffer_load_dwordx4 v5, s[12:15], s40 offen lds
    s_add_u32 m0, s7, 110592
    s_add_u32 s40, s41, 196608
    buffer_load_dwordx4 v5, s[12:15], s40 offen lds
    s_add_u32 m0, s7, 114688
    s_add_u32 s40, s41, 2048
    buffer_load_dwordx4 v5, s[12:15], s40 offen lds
    s_add_u32 m0, s7, 118784
    s_add_u32 s40, s41, 198656
    buffer_load_dwordx4 v5, s[12:15], s40 offen lds
    s_add_u32 m0, s7, 122880
    s_add_u32 s40, s41, 4096
    buffer_load_dwordx4 v5, s[12:15], s40 offen lds
    s_add_u32 m0, s7, 126976
    s_add_u32 s40, s41, 200704
    buffer_load_dwordx4 v5, s[12:15], s40 offen lds
    s_waitcnt vmcnt(10)
    s_barrier
    s_add_u32 s41, s74, 12
    s_and_b32 s41, s41, 15
    s_lshl_b32 s42, s41, 7
    s_mul_i32 s41, s41, 393216
    s_add_u32 m0, s7, 8192
    s_add_u32 s40, s42, 0
    buffer_load_dwordx4 v4, s[8:11], s40 offen lds
    s_add_u32 m0, s7, 12288
    s_add_u32 s40, s42, 65536
    buffer_load_dwordx4 v4, s[8:11], s40 offen lds
    s_add_u32 m0, s7, 16384
    s_add_u32 s40, s42, 131072
    buffer_load_dwordx4 v4, s[8:11], s40 offen lds
    s_add_u32 m0, s7, 20480
    s_add_u32 s40, s42, 196608
    buffer_load_dwordx4 v4, s[8:11], s40 offen lds
    s_add_u32 m0, s7, 24576
    s_add_u32 s40, s41, 0
    buffer_load_dwordx4 v5, s[12:15], s40 offen lds
    s_add_u32 m0, s7, 28672
    s_add_u32 s40, s41, 196608
    buffer_load_dwordx4 v5, s[12:15], s40 offen lds
    s_add_u32 m0, s7, 32768
    s_add_u32 s40, s41, 2048
    buffer_load_dwordx4 v5, s[12:15], s40 offen lds
    s_add_u32 m0, s7, 36864
    s_add_u32 s40, s41, 198656
    buffer_load_dwordx4 v5, s[12:15], s40 offen lds
    s_add_u32 m0, s7, 40960
    s_add_u32 s40, s41, 4096
    buffer_load_dwordx4 v5, s[12:15], s40 offen lds
    s_add_u32 m0, s7, 45056
    s_add_u32 s40, s41, 200704
    buffer_load_dwordx4 v5, s[12:15], s40 offen lds
    s_mov_b32 exec_lo, 0x3fff3fff
    s_mov_b32 exec_hi, 0x3fff3fff
    s_mov_b32 s64, 35840
    buffer_load_dwordx4 v[116:119], v11, s[32:35], s64 offen nt
    s_mov_b32 s64, 35840
    buffer_load_dwordx4 v[148:151], v11, s[36:39], s64 offen nt
    s_mov_b32 s64, 43008
    buffer_load_dwordx4 v[120:123], v11, s[32:35], s64 offen nt
    s_mov_b32 s64, 43008
    buffer_load_dwordx4 v[152:155], v11, s[36:39], s64 offen nt
    s_mov_b32 s64, 50176
    buffer_load_dwordx4 v[124:127], v11, s[32:35], s64 offen nt
    s_mov_b32 s64, 50176
    buffer_load_dwordx4 v[156:159], v11, s[36:39], s64 offen nt
    s_mov_b64 exec, -1
    s_waitcnt vmcnt(16)
    s_barrier
    s_cmp_lg_u32 s6, 0
    s_cbranch_scc1 H_np
    s_mov_b32 s64, 6717440
    buffer_load_dwordx4 v[24:27], v6, s[16:19], s64 offen offset:0 sc1
    buffer_load_dwordx4 v[28:31], v6, s[16:19], s64 offen offset:1024 sc1
H_np:
    s_add_u32 s41, s74, 13
    s_and_b32 s41, s41, 15
    s_lshl_b32 s42, s41, 7
    s_mul_i32 s41, s41, 393216
    s_add_u32 m0, s7, 49152
    s_add_u32 s40, s42, 0
    buffer_load_dwordx4 v4, s[8:11], s40 offen lds
    s_add_u32 m0, s7, 53248
    s_add_u32 s40, s42, 65536
    buffer_load_dwordx4 v4, s[8:11], s40 offen lds
    s_add_u32 m0, s7, 57344
    s_add_u32 s40, s42, 131072
    buffer_load_dwordx4 v4, s[8:11], s40 offen lds
    s_add_u32 m0, s7, 61440
    s_add_u32 s40, s42, 196608
    buffer_load_dwordx4 v4, s[8:11], s40 offen lds
    s_add_u32 m0, s7, 65536
    s_add_u32 s40, s41, 0
    buffer_load_dwordx4 v5, s[12:15], s40 offen lds
    s_add_u32 m0, s7, 69632
    s_add_u32 s40, s41, 196608
    buffer_load_dwordx4 v5, s[12:15], s40 offen lds
    s_add_u32 m0, s7, 73728
    s_add_u32 s40, s41, 2048
    buffer_load_dwordx4 v5, s[12:15], s40 offen lds
    s_add_u32 m0, s7, 77824
    s_add_u32 s40, s41, 198656
    buffer_load_dwordx4 v5, s[12:15], s40 offen lds
    s_add_u32 m0, s7, 81920
    s_add_u32 s40, s41, 4096
    buffer_load_dwordx4 v5, s[12:15], s40 offen lds
    s_add_u32 m0, s7, 86016
    s_add_u32 s40, s41, 200704
    buffer_load_dwordx4 v5, s[12:15], s40 offen lds
    s_waitcnt vmcnt(16)
    s_barrier
    s_cmp_lg_u32 s6, 0
    s_cbranch_scc1 H_nq
    s_waitcnt vmcnt(10)
    s_mov_b32 s65, 0
H_spin:
    v_xor_b32 v25, v24, v25
    v_xor_b32 v27, v26, v27
    v_xor_b32 v29, v28, v29
    v_xor_b32 v31, v30, v31
    v_xor_b32 v3, s71, v25
    v_xor_b32 v7, s71, v27
    v_xor_b32 v25, s71, v29
    v_xor_b32 v27, s71, v31
    v_or3_b32 v3, v3, v7, v25
    v_or_b32 v3, v3, v27
    v_cmp_ne_u32 vcc, 0, v3
    s_cbranch_vccnz H_retry
H_nq:
    s_add_u32 s41, s74, 14
    s_and_b32 s41, s41, 15
    s_lshl_b32 s42, s41, 7
    s_mul_i32 s41, s41, 393216
    s_add_u32 m0, s7, 90112
    s_add_u32 s40, s42, 0
    buffer_load_dwordx4 v4, s[8:11], s40 offen lds
    v_max_u32 v3, v24, v26
    v_max3_u32 v3, v3, v28, v30
    s_nop 1
    v_max_u32_dpp v3, v3, v3 quad_perm:[1,0,3,2] row_mask:0xf bank_mask:0xf
    s_add_u32 m0, s7, 94208
    s_add_u32 s40, s42, 65536
    buffer_load_dwordx4 v4, s[8:11], s40 offen lds
    s_nop 1
    v_max_u32_dpp v3, v3, v3 quad_perm:[2,3,0,1] row_mask:0xf bank_mask:0xf
    s_nop 1
    v_max_u32_dpp v3, v3, v3 row_half_mirror row_mask:0xf bank_mask:0xf
    s_add_u32 m0, s7, 98304
    s_add_u32 s40, s42, 131072
    buffer_load_dwordx4 v4, s[8:11], s40 offen lds
    s_nop 1
    v_max_u32_dpp v3, v3, v3 row_mirror row_mask:0xf bank_mask:0xf
    s_nop 1
    v_mov_b32 v7, v3
    s_add_u32 m0, s7, 102400
    s_add_u32 s40, s42, 196608
    buffer_load_dwordx4 v4, s[8:11], s40 offen lds
    s_nop 1
    v_permlane16_swap_b32 v3, v7
    v_max_u32 v3, v3, v7
    v_mov_b32 v7, v3
    s_add_u32 m0, s7, 106496
    s_add_u32 s40, s41, 0
    buffer_load_dwordx4 v5, s[12:15], s40 offen lds
    s_nop 1
    v_permlane32_swap_b32 v3, v7
    v_max_u32 v3, v3, v7
    v_mov_b32 v7, 4256
    s_add_u32 m0, s7, 110592
    s_add_u32 s40, s41, 196608
    buffer_load_dwordx4 v5, s[12:15], s40 offen lds
    s_add_u32 m0, s7, 114688
    s_add_u32 s40, s41, 2048
    buffer_load_dwordx4 v5, s[12:15], s40 offen lds
    s_add_u32 m0, s7, 118784
    s_add_u32 s40, s41, 198656
    buffer_load_dwordx4 v5, s[12:15], s40 offen lds
    s_add_u32 m0, s7, 122880
    s_add_u32 s40, s41, 4096
    buffer_load_dwordx4 v5, s[12:15], s40 offen lds
    s_add_u32 m0, s7, 126976
    s_add_u32 s40, s41, 200704
    buffer_load_dwordx4 v5, s[12:15], s40 offen lds
    s_cmp_lg_u32 s6, 0
    s_cbranch_scc1 H_nw
    ds_write_b32 v7, v3
H_nw:
    s_waitcnt vmcnt(10)
    s_waitcnt lgkmcnt(0)
    s_barrier
    v_mov_b32 v7, 4256
    ds_read_b32 v3, v7
    s_lshl_b32 s65, s69, 6
    v_lshl_add_u32 v7, v8, 4, s65
    s_waitcnt lgkmcnt(0)
    v_readfirstlane_b32 s75, v3
    s_nop 3
    s_and_b32 s64, s75, 0x7ff
    s_sub_u32 s64, 2047, s64
    s_lshl_b32 s64, s64, 11
    buffer_load_dwordx4 v[88:91], v7, s[8:11], s64 offen
    s_add_u32 s41, s74, 15
    s_and_b32 s41, s41, 15
    s_lshl_b32 s42, s41, 7
    s_mul_i32 s41, s41, 393216
    s_add_u32 m0, s7, 8192
    s_add_u32 s40, s42, 0
    buffer_load_dwordx4 v4, s[8:11], s40 offen lds
    s_add_u32 m0, s7, 12288
    s_add_u32 s40, s42, 65536
    buffer_load_dwordx4 v4, s[8:11], s40 offen lds
    s_add_u32 m0, s7, 16384
    s_add_u32 s40, s42, 131072
    buffer_load_dwordx4 v4, s[8:11], s40 offen lds
    s_add_u32 m0, s7, 20480
    s_add_u32 s40, s42, 196608
    buffer_load_dwordx4 v4, s[8:11], s40 offen lds
    s_add_u32 m0, s7, 24576
    s_add_u32 s40, s41, 0
    buffer_load_dwordx4 v5, s[12:15], s40 offen lds
    s_add_u32 m0, s7, 28672
    s_add_u32 s40, s41, 196608
    buffer_load_dwordx4 v5, s[12:15], s40 offen lds
    s_add_u32 m0, s7, 32768
    s_add_u32 s40, s41, 2048
    buffer_load_dwordx4 v5, s[12:15], s40 offen lds
    s_add_u32 m0, s7, 36864
    s_add_u32 s40, s41, 198656
    buffer_load_dwordx4 v5, s[12:15], s40 offen lds
    s_add_u32 m0, s7, 40960
    s_add_u32 s40, s41, 4096
    buffer_load_dwordx4 v5, s[12:15], s40 offen lds
    s_add_u32 m0, s7, 45056
    s_add_u32 s40, s41, 200704
    buffer_load_dwordx4 v5, s[12:15], s40 offen lds
    s_mov_b32 s24, s54
    s_mov_b32 s25, s55
    s_mov_b32 s26, 0x700000
    s_mov_b32 s27, 0x00020000
    s_lshr_b32 s64, s2, 2
    s_mul_i32 s64, s64, 114688
    s_and_b32 s65, s2, 3
    s_lshl_b32 s65, s65, 9
    s_add_u32 s64, s64, s65
    s_lshl_b32 s65, s6, 7
    s_add_u32 s64, s64, s65
    v_lshrrev_b32 v7, 3, v2
    v_lshlrev_b32 v7, 11, v7
    v_and_b32 v9, 7, v2
    v_lshl_add_u32 v7, v9, 4, v7
    v_add_u32 v21, s64, v7
    s_mov_b32 s64, 0
    buffer_load_dwordx4 v[192:195], v21, s[24:27], s64 offen nt
    s_mov_b32 s64, 16384
    buffer_load_dwordx4 v[196:199], v21, s[24:27], s64 offen nt
    s_mov_b32 s64, 32768
    buffer_load_dwordx4 v[200:203], v21, s[24:27], s64 offen nt
    s_mov_b32 s64, 49152
    buffer_load_dwordx4 v[204:207], v21, s[24:27], s64 offen nt
    s_mov_b32 s64, 65536
    buffer_load_dwordx4 v[208:211], v21, s[24:27], s64 offen nt
    s_mov_b32 s64, 81920
    buffer_load_dwordx4 v[212:215], v21, s[24:27], s64 offen nt
    s_mov_b32 s64, 98304
    buffer_load_dwordx4 v[216:219], v21, s[24:27], s64 offen nt
    s_waitcnt vmcnt(18)
    s_barrier
    s_waitcnt vmcnt(17)
    s_and_b32 s64, s2, 7
    s_lshr_b32 s65, s2, 3
    s_and_b32 s4, s64, 3
    s_lshl_b32 s4, s4, 2
    s_and_b32 s66, s65, 3
    s_add_u32 s4, s4, s66
    s_lshr_b32 s5, s64, 2
    s_lshl_b32 s5, s5, 3
    s_lshr_b32 s66, s65, 2
    s_add_u32 s5, s5, s66
    s_mov_b32 s28, s44
    s_mov_b32 s29, s45
    s_mov_b32 s30, 0x200000
    s_mov_b32 s31, 0x00020000
    v_lshrrev_b32 v7, 3, v2
    s_lshl_b32 s64, s6, 3
    v_add_u32 v7, s64, v7
    v_lshlrev_b32 v7, 11, v7
    v_lshrrev_b32 v9, 4, v2
    v_lshlrev_b32 v9, 1, v9
    v_and_b32 v10, 7, v2
    v_xor_b32 v9, v9, v10
    v_lshl_add_u32 v7, v9, 4, v7
    s_lshl_b32 s64, s5, 7
    v_add_u32 v10, s64, v7
    s_add_u32 m0, s7, 131072
    s_mov_b32 s40, 0
    buffer_load_dwordx4 v10, s[28:31], s40 offen lds
    v_and_b32 v48, 15, v2
    v_and_b32 v49, 1, v2
    v_lshlrev_b32 v49, 4, v49
    v_mov_b32 v50, 0xffff
    v_lshlrev_b32 v49, v49, v50
    v_lshrrev_b32 v48, 1, v48
    v_cmp_eq_u32 vcc, 0, v48
    s_nop 1
    v_cndmask_b32 v40, 0, v49, vcc
    v_cmp_eq_u32 vcc, 1, v48
    s_nop 1
    v_cndmask_b32 v41, 0, v49, vcc
    v_cmp_eq_u32 vcc, 2, v48
    s_nop 1
    v_cndmask_b32 v42, 0, v49, vcc
    v_cmp_eq_u32 vcc, 3, v48
    s_nop 1
    v_cndmask_b32 v43, 0, v49, vcc
    s_mov_b32 s64, 0x01000100
    s_mov_b32 s65, 0x03020302
    v_perm_b32 v48, v88, v88, s64
    v_and_b32 v44, v48, v40
    v_and_b32 v45, v48, v41
    v_and_b32 v46, v48, v42
    s_add_u32 m0, s7, 135168
    s_mov_b32 s40, 65536
    buffer_load_dwordx4 v10, s[28:31], s40 offen lds
    v_and_b32 v47, v48, v43
    s_nop 1
    v_mfma_f32_16x16x32_bf16 v[32:35], v[44:47], v[96:99], 0
    v_mfma_f32_16x16x32_bf16 v[36:39], v[44:47], v[128:131], 0
    v_perm_b32 v48, v88, v88, s65
    v_and_b32 v52, v48, v40
    v_and_b32 v53, v48, v41
    v_and_b32 v54, v48, v42
    v_and_b32 v55, v48, v43
    s_nop 1
    v_mfma_f32_16x16x32_bf16 v[32:35], v[52:55], v[100:103], v[32:35]
    v_mfma_f32_16x16x32_bf16 v[36:39], v[52:55], v[132:135], v[36:39]
    v_perm_b32 v48, v89, v89, s64
    v_and_b32 v44, v48, v40
    v_and_b32 v45, v48, v41
    v_and_b32 v46, v48, v42
    v_and_b32 v47, v48, v43
    s_nop 1
    v_mfma_f32_16x16x32_bf16 v[32:35], v[44:47], v[104:107], v[32:35]
    v_mfma_f32_16x16x32_bf16 v[36:39], v[44:47], v[136:139], v[36:39]
    v_perm_b32 v48, v89, v89, s65
    v_and_b32 v52, v48, v40
    v_and_b32 v53, v48, v41
    v_and_b32 v54, v48, v42
    s_add_u32 m0, s7, 147456
    s_mov_b32 s40, 1048576
    buffer_load_dwordx4 v10, s[28:31], s40 offen lds
    v_and_b32 v55, v48, v43
    s_nop 1
    v_mfma_f32_16x16x32_bf16 v[32:35], v[52:55], v[108:111], v[32:35]
    v_mfma_f32_16x16x32_bf16 v[36:39], v[52:55], v[140:143], v[36:39]
    v_perm_b32 v48, v90, v90, s64
    v_and_b32 v44, v48, v40
    v_and_b32 v45, v48, v41
    v_and_b32 v46, v48, v42
    v_and_b32 v47, v48, v43
    s_nop 1
    v_mfma_f32_16x16x32_bf16 v[32:35], v[44:47], v[112:115], v[32:35]
    v_mfma_f32_16x16x32_bf16 v[36:39], v[44:47], v[144:147], v[36:39]
    v_perm_b32 v48, v90, v90, s65
    v_and_b32 v52, v48, v40
    v_and_b32 v53, v48, v41
    v_and_b32 v54, v48, v42
    v_and_b32 v55, v48, v43
    s_nop 1
    v_mfma_f32_16x16x32_bf16 v[32:35], v[52:55], v[116:119], v[32:35]
    v_mfma_f32_16x16x32_bf16 v[36:39], v[52:55], v[148:151], v[36:39]
    v_perm_b32 v48, v91, v91, s64
    v_and_b32 v44, v48, v40
    v_and_b32 v45, v48, v41
    v_and_b32 v46, v48, v42
    s_add_u32 m0, s7, 151552
    s_mov_b32 s40, 1114112
    buffer_load_dwordx4 v10, s[28:31], s40 offen lds
    v_and_b32 v47, v48, v43
    s_nop 1
    v_mfma_f32_16x16x32_bf16 v[32:35], v[44:47], v[120:123], v[32:35]
    v_mfma_f32_16x16x32_bf16 v[36:39], v[44:47], v[152:155], v[36:39]
    v_perm_b32 v48, v91, v91, s65
    v_and_b32 v52, v48, v40
    v_and_b32 v53, v48, v41
    v_and_b32 v54, v48, v42
    v_and_b32 v55, v48, v43
    s_nop 1
    v_mfma_f32_16x16x32_bf16 v[32:35], v[52:55], v[124:127], v[32:35]
    v_mfma_f32_16x16x32_bf16 v[36:39], v[52:55], v[156:159], v[36:39]
    s_nop 7
    v_permlane32_swap_b32 v32, v36
    v_permlane32_swap_b32 v33, v37
    v_permlane32_swap_b32 v34, v38
    v_permlane32_swap_b32 v35, v39
    s_mov_b32 exec_lo, 0x3fff3fff
    s_mov_b32 exec_hi, 0x3fff3fff
    buffer_store_dwordx4 v[32:35], v12, s[16:19], 0 offen sc0 sc1
    s_mov_b64 exec, -1
    s_waitcnt vmcnt(12)
    s_barrier
    s_add_u32 m0, s7, 139264
    s_mov_b32 s40, 131072
    buffer_load_dwordx4 v10, s[28:31], s40 offen lds
    s_add_u32 m0, s7, 143360
    s_mov_b32 s40, 196608
    buffer_load_dwordx4 v10, s[28:31], s40 offen lds
    s_add_u32 m0, s7, 155648
    s_mov_b32 s40, 1179648
    buffer_load_dwordx4 v10, s[28:31], s40 offen lds
    s_add_u32 m0, s7, 159744
    s_mov_b32 s40, 1245184
    buffer_load_dwordx4 v10, s[28:31], s40 offen lds
    s_add_u32 m0, s7, 73728
    s_mov_b32 s40, 262144
    buffer_load_dwordx4 v10, s[28:31], s40 offen lds
    s_add_u32 m0, s7, 77824
    s_mov_b32 s40, 327680
    buffer_load_dwordx4 v10, s[28:31], s40 offen lds
    s_add_u32 m0, s7, 81920
    s_mov_b32 s40, 1310720
    buffer_load_dwordx4 v10, s[28:31], s40 offen lds
    s_add_u32 m0, s7, 86016
    s_mov_b32 s40, 1376256
    buffer_load_dwordx4 v10, s[28:31], s40 offen lds
    s_barrier
    s_and_b32 s64, s3, 3
    s_lshl_b32 s64, s64, 1
    s_lshr_b32 s65, s3, 2
    s_add_u32 s64, s64, s65
    s_lshl_b32 s64, s64, 4
    s_lshl_b32 s65, s4, 7
    s_add_u32 s64, s64, s65
    v_and_b32 v230, 15, v2
    v_add_u32 v230, s64, v230
    v_bfe_u32 v3, v2, 4, 1
    v_lshlrev_b32 v229, 5, v3
    v_lshrrev_b32 v3, 5, v2
    v_lshl_add_u32 v229, v3, 4, v229
    v_lshl_add_u32 v231, v230, 11, v229
    s_lshl_b32 s64, s5, 7
    v_add_u32 v231, s64, v231
    v_lshlrev_b32 v3, 2, v230
    v_add_u32 v3, 6709248, v3
    buffer_load_dwordx4 v[220:223], v231, s[8:11], 0 offen
    buffer_load_dwordx4 v[224:227], v231, s[8:11], 0 offen offset:64
    buffer_load_dword v228, v3, s[16:19], 0 offen sc1
    s_add_u32 m0, s7, 114688
    s_mov_b32 s40, 393216
    buffer_load_dwordx4 v10, s[28:31], s40 offen lds
    s_add_u32 m0, s7, 118784
    s_mov_b32 s40, 458752
    buffer_load_dwordx4 v10, s[28:31], s40 offen lds
    s_add_u32 m0, s7, 122880
    s_mov_b32 s40, 1441792
    buffer_load_dwordx4 v10, s[28:31], s40 offen lds
    s_add_u32 m0, s7, 126976
    s_mov_b32 s40, 1507328
    buffer_load_dwordx4 v10, s[28:31], s40 offen lds
    s_add_u32 m0, s7, 40960
    s_mov_b32 s40, 524288
    buffer_load_dwordx4 v10, s[28:31], s40 offen lds
    s_add_u32 m0, s7, 45056
    s_mov_b32 s40, 589824
    buffer_load_dwordx4 v10, s[28:31], s40 offen lds
    s_add_u32 m0, s7, 49152
    s_mov_b32 s40, 1572864
    buffer_load_dwordx4 v10, s[28:31], s40 offen lds
    s_add_u32 m0, s7, 53248
    s_mov_b32 s40, 1638400
    buffer_load_dwordx4 v10, s[28:31], s40 offen lds
    s_add_u32 m0, s7, 8192
    s_mov_b32 s40, 655360
    buffer_load_dwordx4 v10, s[28:31], s40 offen lds
    s_add_u32 m0, s7, 12288
    s_mov_b32 s40, 720896
    buffer_load_dwordx4 v10, s[28:31], s40 offen lds
    s_add_u32 m0, s7, 57344
    s_mov_b32 s40, 1703936
    buffer_load_dwordx4 v10, s[28:31], s40 offen lds
    s_add_u32 m0, s7, 61440
    s_mov_b32 s40, 1769472
    buffer_load_dwordx4 v10, s[28:31], s40 offen lds
    s_add_u32 m0, s7, 16384
    s_mov_b32 s40, 786432
    buffer_load_dwordx4 v10, s[28:31], s40 offen lds
    s_add_u32 m0, s7, 20480
    s_mov_b32 s40, 851968
    buffer_load_dwordx4 v10, s[28:31], s40 offen lds
    s_add_u32 m0, s7, 65536
    s_mov_b32 s40, 1835008
    buffer_load_dwordx4 v10, s[28:31], s40 offen lds
    s_add_u32 m0, s7, 69632
    s_mov_b32 s40, 1900544
    buffer_load_dwordx4 v10, s[28:31], s40 offen lds
    s_add_u32 m0, s7, 98304
    s_mov_b32 s40, 917504
    buffer_load_dwordx4 v10, s[28:31], s40 offen lds
    s_add_u32 m0, s7, 102400
    s_mov_b32 s40, 983040
    buffer_load_dwordx4 v10, s[28:31], s40 offen lds
    s_add_u32 m0, s7, 90112
    s_mov_b32 s40, 1966080
    buffer_load_dwordx4 v10, s[28:31], s40 offen lds
    s_add_u32 m0, s7, 94208
    s_mov_b32 s40, 2031616
    buffer_load_dwordx4 v10, s[28:31], s40 offen lds
    s_mov_b64 exec, 1
    v_mov_b32 v20, 0
    buffer_atomic_or v20, v23, s[16:19], 0 offen sc0
    s_mov_b64 exec, -1
    v_lshlrev_b32 v17, 4, v2
    v_add_u32 v17, s70, v17
    v_lshrrev_b32 v18, 2, v2
    v_mul_u32_u24 v18, 1152, v18
    v_and_b32 v19, 3, v2
    v_lshl_add_u32 v18, v19, 4, v18
    s_add_u32 s64, s70, 1024
    v_add_u32 v18, s64, v18
    v_bfe_u32 v26, v2, 3, 1
    v_lshl_add_u32 v26, v26, 2, v19
    v_bfe_u32 v27, v2, 2, 1
    v_lshrrev_b32 v28, 5, v2
    v_cmp_eq_u32 vcc, v27, v28
    v_and_b32 v27, 16, v2
    v_cmp_eq_u32 s[64:65], 0, v27
    s_and_b64 vcc, vcc, s[64:65]
    v_and_b32 v27, 1, v26
    v_lshlrev_b32 v27, 4, v27
    v_mov_b32 v28, 0x3f80
    v_lshlrev_b32 v27, v27, v28
    v_cndmask_b32 v27, 0, v27, vcc
    v_lshrrev_b32 v26, 1, v26
    v_cmp_eq_u32 vcc, 0, v26
    s_nop 1
    v_cndmask_b32 v48, 0, v27, vcc
    v_cmp_eq_u32 vcc, 1, v26
    s_nop 1
    v_cndmask_b32 v49, 0, v27, vcc
    v_cmp_eq_u32 vcc, 2, v26
    s_nop 1
    v_cndmask_b32 v50, 0, v27, vcc
    v_cmp_eq_u32 vcc, 3, v26
    s_nop 1
    v_cndmask_b32 v51, 0, v27, vcc
    v_mov_b32 v128, 0
    v_mov_b32 v129, 0
    v_mov_b32 v130, 0
    v_mov_b32 v131, 0
    v_mov_b32 v132, 0
    v_mov_b32 v133, 0
    v_mov_b32 v134, 0
    v_mov_b32 v135, 0
    v_mov_b32 v136, 0
    v_mov_b32 v137, 0
    v_mov_b32 v138, 0
    v_mov_b32 v139, 0
    v_mov_b32 v140, 0
    v_mov_b32 v141, 0
    v_mov_b32 v142, 0
    v_mov_b32 v143, 0
    s_mov_b32 s66, 0xffff
    s_mov_b32 s65, 0
    s_waitcnt vmcnt(21)
    v_sub_f32 v248, 1.0, v228
    v_cvt_pk_bf16_f32 v248, v248, v248
    v_lshlrev_b32 v248, 16, v248
    v_lshlrev_b32 v232, 16, v220
    v_and_b32 v233, 0xffff0000, v220
    v_mul_f32 v232, v232, v248
    v_mul_f32 v233, v233, v248
    v_cvt_pk_bf16_f32 v3, v232, v233
    v_lshlrev_b32 v232, 16, v3
    v_and_b32 v233, 0xffff0000, v3
    v_lshlrev_b32 v234, 16, v221
    v_and_b32 v235, 0xffff0000, v221
    v_mul_f32 v234, v234, v248
    v_mul_f32 v235, v235, v248
    v_cvt_pk_bf16_f32 v3, v234, v235
    v_lshlrev_b32 v234, 16, v3
    v_and_b32 v235, 0xffff0000, v3
    v_lshlrev_b32 v236, 16, v222
    v_and_b32 v237, 0xffff0000, v222
    v_mul_f32 v236, v236, v248
    v_mul_f32 v237, v237, v248
    v_cvt_pk_bf16_f32 v3, v236, v237
    v_lshlrev_b32 v236, 16, v3
    v_and_b32 v237, 0xffff0000, v3
    v_lshlrev_b32 v238, 16, v223
    v_and_b32 v239, 0xffff0000, v223
    v_mul_f32 v238, v238, v248
    v_mul_f32 v239, v239, v248
    v_cvt_pk_bf16_f32 v3, v238, v239
    v_lshlrev_b32 v238, 16, v3
    v_and_b32 v239, 0xffff0000, v3
    v_lshlrev_b32 v240, 16, v224
    v_and_b32 v241, 0xffff0000, v224
    v_mul_f32 v240, v240, v248
    v_mul_f32 v241, v241, v248
    v_cvt_pk_bf16_f32 v3, v240, v241
    v_lshlrev_b32 v240, 16, v3
    v_and_b32 v241, 0xffff0000, v3
    v_lshlrev_b32 v242, 16, v225
    v_and_b32 v243, 0xffff0000, v225
    v_mul_f32 v242, v242, v248
    v_mul_f32 v243, v243, v248
    v_cvt_pk_bf16_f32 v3, v242, v243
    v_lshlrev_b32 v242, 16, v3
    v_and_b32 v243, 0xffff0000, v3
    v_lshlrev_b32 v244, 16, v226
    v_and_b32 v245, 0xffff0000, v226
    v_mul_f32 v244, v244, v248
    v_mul_f32 v245, v245, v248
    v_cvt_pk_bf16_f32 v3, v244, v245
    v_lshlrev_b32 v244, 16, v3
    v_and_b32 v245, 0xffff0000, v3
    v_lshlrev_b32 v246, 16, v227
    v_and_b32 v247, 0xffff0000, v227
    v_mul_f32 v246, v246, v248
    v_mul_f32 v247, v247, v248
    v_cvt_pk_bf16_f32 v3, v246, v247
    v_lshlrev_b32 v246, 16, v3
    v_and_b32 v247, 0xffff0000, v3
    s_waitcnt vmcnt(0)
G_loop:
    v_readfirstlane_b32 s68, v20
    s_and_b32 s68, s68, s66
G_new:
    s_andn2_b32 s66, s66, s68
    s_bcnt1_i32_b32 s67, s68
    s_cmp_eq_u32 s67, 0
    s_cbranch_scc1 G_l0
    s_cmp_gt_u32 s67, 8
    s_cbranch_scc1 G_lt_2
    s_cmp_gt_u32 s67, 4
    s_cbranch_scc1 G_lt_3
    s_cmp_gt_u32 s67, 2
    s_cbranch_scc1 G_lt_4
    s_cmp_eq_u32 s67, 1
    s_cbranch_scc1 G_l1
    s_branch G_l2
G_lt_4:
    s_cmp_eq_u32 s67, 3
    s_cbranch_scc1 G_l3
    s_branch G_l4
G_lt_3:
    s_cmp_gt_u32 s67, 6
    s_cbranch_scc1 G_lt_5
    s_cmp_eq_u32 s67, 5
    s_cbranch_scc1 G_l5
    s_branch G_l6
G_lt_5:
    s_cmp_eq_u32 s67, 7
    s_cbranch_scc1 G_l7
    s_branch G_l8
G_lt_2:
    s_cmp_gt_u32 s67, 12
    s_cbranch_scc1 G_lt_6
    s_cmp_gt_u32 s67, 10
    s_cbranch_scc1 G_lt_7
    s_cmp_eq_u32 s67, 9
    s_cbranch_scc1 G_l9
    s_branch G_l10
G_lt_7:
    s_cmp_eq_u32 s67, 11
    s_cbranch_scc1 G_l11
    s_branch G_l12
G_lt_6:
    s_cmp_gt_u32 s67, 14
    s_cbranch_scc1 G_lt_8
    s_cmp_eq_u32 s67, 13
    s_cbranch_scc1 G_l13
    s_branch G_l14
G_lt_8:
    s_cmp_eq_u32 s67, 15
    s_cbranch_scc1 G_l15
G_l16:
    s_ff1_i32_b32 s55, s68
    s_bitset0_b32 s68, s55
    s_mul_i32 s64, s55, 1152
    buffer_load_dwordx4 v[124:127], v17, s[16:19], s64 offen sc1
G_l15:
    s_ff1_i32_b32 s54, s68
    s_bitset0_b32 s68, s54
    s_mul_i32 s64, s54, 1152
    buffer_load_dwordx4 v[120:123], v17, s[16:19], s64 offen sc1
G_l14:
    s_ff1_i32_b32 s53, s68
    s_bitset0_b32 s68, s53
    s_mul_i32 s64, s53, 1152
    buffer_load_dwordx4 v[116:119], v17, s[16:19], s64 offen sc1
G_l13:
    s_ff1_i32_b32 s52, s68
    s_bitset0_b32 s68, s52
    s_mul_i32 s64, s52, 1152
    buffer_load_dwordx4 v[112:115], v17, s[16:19], s64 offen sc1
G_l12:
    s_ff1_i32_b32 s51, s68
    s_bitset0_b32 s68, s51
    s_mul_i32 s64, s51, 1152
    buffer_load_dwordx4 v[108:111], v17, s[16:19], s64 offen sc1
G_l11:
    s_ff1_i32_b32 s50, s68
    s_bitset0_b32 s68, s50
    s_mul_i32 s64, s50, 1152
    buffer_load_dwordx4 v[104:107], v17, s[16:19], s64 offen sc1
G_l10:
    s_ff1_i32_b32 s49, s68
    s_bitset0_b32 s68, s49
    s_mul_i32 s64, s49, 1152
    buffer_load_dwordx4 v[100:103], v17, s[16:19], s64 offen sc1
G_l9:
    s_ff1_i32_b32 s48, s68
    s_bitset0_b32 s68, s48
    s_mul_i32 s64, s48, 1152
    buffer_load_dwordx4 v[96:99], v17, s[16:19], s64 offen sc1
G_l8:
    s_ff1_i32_b32 s47, s68
    s_bitset0_b32 s68, s47
    s_mul_i32 s64, s47, 1152
    buffer_load_dwordx4 v[92:95], v17, s[16:19], s64 offen sc1
G_l7:
    s_ff1_i32_b32 s46, s68
    s_bitset0_b32 s68, s46
    s_mul_i32 s64, s46, 1152
    buffer_load_dwordx4 v[88:91], v17, s[16:19], s64 offen sc1
G_l6:
    s_ff1_i32_b32 s45, s68
    s_bitset0_b32 s68, s45
    s_mul_i32 s64, s45, 1152
    buffer_load_dwordx4 v[84:87], v17, s[16:19], s64 offen sc1
G_l5:
    s_ff1_i32_b32 s44, s68
    s_bitset0_b32 s68, s44
    s_mul_i32 s64, s44, 1152
    buffer_load_dwordx4 v[80:83], v17, s[16:19], s64 offen sc1
G_l4:
    s_ff1_i32_b32 s43, s68
    s_bitset0_b32 s68, s43
    s_mul_i32 s64, s43, 1152
    buffer_load_dwordx4 v[76:79], v17, s[16:19], s64 offen sc1
G_l3:
    s_ff1_i32_b32 s42, s68
    s_bitset0_b32 s68, s42
    s_mul_i32 s64, s42, 1152
    buffer_load_dwordx4 v[72:75], v17, s[16:19], s64 offen sc1
G_l2:
    s_ff1_i32_b32 s41, s68
    s_bitset0_b32 s68, s41
    s_mul_i32 s64, s41, 1152
    buffer_load_dwordx4 v[68:71], v17, s[16:19], s64 offen sc1
G_l1:
    s_ff1_i32_b32 s40, s68
    s_bitset0_b32 s68, s40
    s_mul_i32 s64, s40, 1152
    buffer_load_dwordx4 v[64:67], v17, s[16:19], s64 offen sc1
G_l0:
    s_mov_b32 s68, s66
    s_cmp_eq_u32 s66, 0
    s_cbranch_scc1 G_z
    s_cmp_lg_u32 s67, 0
    s_cbranch_scc1 G_p
    s_sleep 2
G_p:
    s_mov_b64 exec, 1
    v_mov_b32 v20, 0
    buffer_atomic_or v20, v23, s[16:19], 0 offen sc0
    s_mov_b64 exec, -1
    s_branch G_proc
G_z:
    buffer_load_dwordx4 v[56:59], v18, s[16:19], 0 offen sc1
G_proc:
    s_cmp_eq_u32 s67, 0
    s_cbranch_scc1 G_q0
    s_cmp_gt_u32 s67, 8
    s_cbranch_scc1 G_qt_9
    s_cmp_gt_u32 s67, 4
    s_cbranch_scc1 G_qt_10
    s_cmp_gt_u32 s67, 2
    s_cbranch_scc1 G_qt_11
    s_cmp_eq_u32 s67, 1
    s_cbranch_scc1 G_q1
    s_branch G_q2
G_qt_11:
    s_cmp_eq_u32 s67, 3
    s_cbranch_scc1 G_q3
    s_branch G_q4
G_qt_10:
    s_cmp_gt_u32 s67, 6
    s_cbranch_scc1 G_qt_12
    s_cmp_eq_u32 s67, 5
    s_cbranch_scc1 G_q5
    s_branch G_q6
G_qt_12:
    s_cmp_eq_u32 s67, 7
    s_cbranch_scc1 G_q7
    s_branch G_q8
G_qt_9:
    s_cmp_gt_u32 s67, 12
    s_cbranch_scc1 G_qt_13
    s_cmp_gt_u32 s67, 10
    s_cbranch_scc1 G_qt_14
    s_cmp_eq_u32 s67, 9
    s_cbranch_scc1 G_q9
    s_branch G_q10
G_qt_14:
    s_cmp_eq_u32 s67, 11
    s_cbranch_scc1 G_q11
    s_branch G_q12
G_qt_13:
    s_cmp_gt_u32 s67, 14
    s_cbranch_scc1 G_qt_15
    s_cmp_eq_u32 s67, 13
    s_cbranch_scc1 G_q13
    s_branch G_q14
G_qt_15:
    s_cmp_eq_u32 s67, 15
    s_cbranch_scc1 G_q15
G_q16:
    s_waitcnt vmcnt(16)
    v_max3_u32 v21, v124, v125, v126
    v_max_u32 v21, v21, v127
    v_cmp_eq_u32 vcc, -1, v21
    s_cbranch_vccnz G_f15
    v_mfma_f32_32x32x16_bf16 v[128:143], v[48:51], v[124:127], v[128:143]
G_q15:
    s_waitcnt vmcnt(15)
    v_max3_u32 v21, v120, v121, v122
    v_max_u32 v21, v21, v123
    v_cmp_eq_u32 vcc, -1, v21
    s_cbranch_vccnz G_f14
    v_mfma_f32_32x32x16_bf16 v[128:143], v[48:51], v[120:123], v[128:143]
G_q14:
    s_waitcnt vmcnt(14)
    v_max3_u32 v21, v116, v117, v118
    v_max_u32 v21, v21, v119
    v_cmp_eq_u32 vcc, -1, v21
    s_cbranch_vccnz G_f13
    v_mfma_f32_32x32x16_bf16 v[128:143], v[48:51], v[116:119], v[128:143]
G_q13:
    s_waitcnt vmcnt(13)
    v_max3_u32 v21, v112, v113, v114
    v_max_u32 v21, v21, v115
    v_cmp_eq_u32 vcc, -1, v21
    s_cbranch_vccnz G_f12
    v_mfma_f32_32x32x16_bf16 v[128:143], v[48:51], v[112:115], v[128:143]
G_q12:
    s_waitcnt vmcnt(12)
    v_max3_u32 v21, v108, v109, v110
    v_max_u32 v21, v21, v111
    v_cmp_eq_u32 vcc, -1, v21
    s_cbranch_vccnz G_f11
    v_mfma_f32_32x32x16_bf16 v[128:143], v[48:51], v[108:111], v[128:143]
G_q11:
    s_waitcnt vmcnt(11)
    v_max3_u32 v21, v104, v105, v106
    v_max_u32 v21, v21, v107
    v_cmp_eq_u32 vcc, -1, v21
    s_cbranch_vccnz G_f10
    v_mfma_f32_32x32x16_bf16 v[128:143], v[48:51], v[104:107], v[128:143]
G_q10:
    s_waitcnt vmcnt(10)
    v_max3_u32 v21, v100, v101, v102
    v_max_u32 v21, v21, v103
    v_cmp_eq_u32 vcc, -1, v21
    s_cbranch_vccnz G_f9
    v_mfma_f32_32x32x16_bf16 v[128:143], v[48:51], v[100:103], v[128:143]
G_q9:
    s_waitcnt vmcnt(9)
    v_max3_u32 v21, v96, v97, v98
    v_max_u32 v21, v21, v99
    v_cmp_eq_u32 vcc, -1, v21
    s_cbranch_vccnz G_f8
    v_mfma_f32_32x32x16_bf16 v[128:143], v[48:51], v[96:99], v[128:143]
G_q8:
    s_waitcnt vmcnt(8)
    v_max3_u32 v21, v92, v93, v94
    v_max_u32 v21, v21, v95
    v_cmp_eq_u32 vcc, -1, v21
    s_cbranch_vccnz G_f7
    v_mfma_f32_32x32x16_bf16 v[128:143], v[48:51], v[92:95], v[128:143]
G_q7:
    s_waitcnt vmcnt(7)
    v_max3_u32 v21, v88, v89, v90
    v_max_u32 v21, v21, v91
    v_cmp_eq_u32 vcc, -1, v21
    s_cbranch_vccnz G_f6
    v_mfma_f32_32x32x16_bf16 v[128:143], v[48:51], v[88:91], v[128:143]
G_q6:
    s_waitcnt vmcnt(6)
    v_max3_u32 v21, v84, v85, v86
    v_max_u32 v21, v21, v87
    v_cmp_eq_u32 vcc, -1, v21
    s_cbranch_vccnz G_f5
    v_mfma_f32_32x32x16_bf16 v[128:143], v[48:51], v[84:87], v[128:143]
G_q5:
    s_waitcnt vmcnt(5)
    v_max3_u32 v21, v80, v81, v82
    v_max_u32 v21, v21, v83
    v_cmp_eq_u32 vcc, -1, v21
    s_cbranch_vccnz G_f4
    v_mfma_f32_32x32x16_bf16 v[128:143], v[48:51], v[80:83], v[128:143]
G_q4:
    s_waitcnt vmcnt(4)
    v_max3_u32 v21, v76, v77, v78
    v_max_u32 v21, v21, v79
    v_cmp_eq_u32 vcc, -1, v21
    s_cbranch_vccnz G_f3
    v_mfma_f32_32x32x16_bf16 v[128:143], v[48:51], v[76:79], v[128:143]
G_q3:
    s_waitcnt vmcnt(3)
    v_max3_u32 v21, v72, v73, v74
    v_max_u32 v21, v21, v75
    v_cmp_eq_u32 vcc, -1, v21
    s_cbranch_vccnz G_f2
    v_mfma_f32_32x32x16_bf16 v[128:143], v[48:51], v[72:75], v[128:143]
G_q2:
    s_waitcnt vmcnt(2)
    v_max3_u32 v21, v68, v69, v70
    v_max_u32 v21, v21, v71
    v_cmp_eq_u32 vcc, -1, v21
    s_cbranch_vccnz G_f1
    v_mfma_f32_32x32x16_bf16 v[128:143], v[48:51], v[68:71], v[128:143]
G_q1:
    s_waitcnt vmcnt(1)
    v_max3_u32 v21, v64, v65, v66
    v_max_u32 v21, v21, v67
    v_cmp_eq_u32 vcc, -1, v21
    s_cbranch_vccnz G_f0
    v_mfma_f32_32x32x16_bf16 v[128:143], v[48:51], v[64:67], v[128:143]
G_q0:
    s_waitcnt vmcnt(0)
    s_add_u32 s65, s65, 1
    s_cmp_ge_u32 s65, 40000
    s_cbranch_scc1 G_done
    s_cmp_lg_u32 s68, 0
    s_cbranch_scc1 G_loop
    v_mov_b32 v20, -1
    s_cmp_lg_u32 s66, 0
    s_cbranch_scc1 G_loop
    v_max3_u32 v21, v56, v57, v58
    v_max_u32 v21, v21, v59
    v_cmp_eq_u32 vcc, -1, v21
    s_cbranch_vccnz G_loop
G_done:
    v_add_u32 v16, s7, v6
    v_add_f32_dpp v56, v56, v56 row_ror:4 row_mask:0xf bank_mask:0xf
    v_add_f32_dpp v57, v57, v57 row_ror:4 row_mask:0xf bank_mask:0xf
    v_add_f32_dpp v58, v58, v58 row_ror:4 row_mask:0xf bank_mask:0xf
    v_add_f32_dpp v59, v59, v59 row_ror:4 row_mask:0xf bank_mask:0xf
    v_add_f32_dpp v56, v56, v56 row_ror:8 row_mask:0xf bank_mask:0xf
    v_add_f32_dpp v57, v57, v57 row_ror:8 row_mask:0xf bank_mask:0xf
    v_add_f32_dpp v58, v58, v58 row_ror:8 row_mask:0xf bank_mask:0xf
    v_add_f32_dpp v59, v59, v59 row_ror:8 row_mask:0xf bank_mask:0xf
    v_mov_b32 v64, v56
    v_mov_b32 v65, v57
    v_mov_b32 v66, v58
    v_mov_b32 v67, v59
    s_nop 0
    v_permlane16_swap_b32 v56, v64
    v_permlane16_swap_b32 v57, v65
    v_permlane16_swap_b32 v58, v66
    v_permlane16_swap_b32 v59, v67
    v_add_f32 v56, v56, v64
    v_add_f32 v57, v57, v65
    v_add_f32 v58, v58, v66
    v_add_f32 v59, v59, v67
    v_mov_b32 v64, v56
    v_mov_b32 v65, v57
    v_mov_b32 v66, v58
    v_mov_b32 v67, v59
    s_nop 0
    v_permlane32_swap_b32 v56, v64
    v_permlane32_swap_b32 v57, v65
    v_permlane32_swap_b32 v58, v66
    v_permlane32_swap_b32 v59, v67
    v_add_f32 v56, v56, v64
    v_add_f32 v57, v57, v65
    v_add_f32 v58, v58, v66
    v_add_f32 v59, v59, v67
    v_cvt_pk_bf16_f32 v60, v128, v129
    v_cvt_pk_bf16_f32 v61, v130, v131
    v_cvt_pk_bf16_f32 v62, v132, v133
    v_cvt_pk_bf16_f32 v63, v134, v135
    ds_write_b128 v16, v[60:63] offset:0
    v_cvt_pk_bf16_f32 v56, v56, v57
    v_cvt_pk_bf16_f32 v57, v58, v59
    s_lshr_b32 s64, s6, 1
    s_lshl_b32 s64, s64, 6
    s_and_b32 s65, s6, 1
    s_lshl_b32 s65, s65, 3
    s_add_u32 s64, s64, s65
    v_lshl_add_u32 v16, v2, 4, s64
    s_mov_b64 exec, 15
    ds_write_b64 v16, v[56:57] offset:4096
    s_mov_b64 exec, -1
    s_waitcnt lgkmcnt(0)
    s_barrier
    v_lshrrev_b32 v18, 3, v2
    v_lshlrev_b32 v18, 2, v18
    ds_read_b32 v24, v18 offset:4352
    ds_read_b32 v25, v18 offset:4384
    ds_read_b32 v26, v18 offset:4416
    ds_read_b32 v27, v18 offset:4448
    ds_read_b32 v28, v18 offset:4480
    ds_read_b32 v29, v18 offset:4512
    ds_read_b32 v30, v18 offset:4544
    s_waitcnt lgkmcnt(0)
    s_mov_b32 s64, 0x05040100
    s_mov_b32 s65, 0x07060302
    v_cvt_pk_bf16_f32 v24, v24, v25
    v_cvt_pk_bf16_f32 v25, v26, v27
    v_cvt_pk_bf16_f32 v26, v28, v29
    v_cvt_pk_bf16_f32 v27, v30, 0
    v_perm_b32 v48, v196, v192, s64
    v_perm_b32 v49, v196, v192, s65
    v_dot2_f32_bf16 v32, v48, v24, 0
    v_dot2_f32_bf16 v33, v49, v24, 0
    v_perm_b32 v50, v197, v193, s64
    v_perm_b32 v51, v197, v193, s65
    v_dot2_f32_bf16 v34, v50, v24, 0
    v_dot2_f32_bf16 v35, v51, v24, 0
    v_perm_b32 v48, v198, v194, s64
    v_perm_b32 v49, v198, v194, s65
    v_dot2_f32_bf16 v36, v48, v24, 0
    v_dot2_f32_bf16 v37, v49, v24, 0
    v_perm_b32 v50, v199, v195, s64
    v_perm_b32 v51, v199, v195, s65
    v_dot2_f32_bf16 v38, v50, v24, 0
    v_dot2_f32_bf16 v39, v51, v24, 0
    v_perm_b32 v48, v204, v200, s64
    v_perm_b32 v49, v204, v200, s65
    v_dot2_f32_bf16 v32, v48, v25, v32
    v_dot2_f32_bf16 v33, v49, v25, v33
    v_perm_b32 v50, v205, v201, s64
    v_perm_b32 v51, v205, v201, s65
    v_dot2_f32_bf16 v34, v50, v25, v34
    v_dot2_f32_bf16 v35, v51, v25, v35
    v_perm_b32 v48, v206, v202, s64
    v_perm_b32 v49, v206, v202, s65
    v_dot2_f32_bf16 v36, v48, v25, v36
    v_dot2_f32_bf16 v37, v49, v25, v37
    v_perm_b32 v50, v207, v203, s64
    v_perm_b32 v51, v207, v203, s65
    v_dot2_f32_bf16 v38, v50, v25, v38
    v_dot2_f32_bf16 v39, v51, v25, v39
    v_perm_b32 v48, v212, v208, s64
    v_perm_b32 v49, v212, v208, s65
    v_dot2_f32_bf16 v32, v48, v26, v32
    v_dot2_f32_bf16 v33, v49, v26, v33
    v_perm_b32 v50, v213, v209, s64
    v_perm_b32 v51, v213, v209, s65
    v_dot2_f32_bf16 v34, v50, v26, v34
    v_dot2_f32_bf16 v35, v51, v26, v35
    v_perm_b32 v48, v214, v210, s64
    v_perm_b32 v49, v214, v210, s65
    v_dot2_f32_bf16 v36, v48, v26, v36
    v_dot2_f32_bf16 v37, v49, v26, v37
    v_perm_b32 v50, v215, v211, s64
    v_perm_b32 v51, v215, v211, s65
    v_dot2_f32_bf16 v38, v50, v26, v38
    v_dot2_f32_bf16 v39, v51, v26, v39
    v_perm_b32 v48, v216, v216, s64
    v_perm_b32 v49, v216, v216, s65
    v_dot2_f32_bf16 v32, v48, v27, v32
    v_dot2_f32_bf16 v33, v49, v27, v33
    v_perm_b32 v50, v217, v217, s64
    v_perm_b32 v51, v217, v217, s65
    v_dot2_f32_bf16 v34, v50, v27, v34
    v_dot2_f32_bf16 v35, v51, v27, v35
    v_perm_b32 v48, v218, v218, s64
    v_perm_b32 v49, v218, v218, s65
    v_dot2_f32_bf16 v36, v48, v27, v36
    v_dot2_f32_bf16 v37, v49, v27, v37
    v_perm_b32 v50, v219, v219, s64
    v_perm_b32 v51, v219, v219, s65
    v_dot2_f32_bf16 v38, v50, v27, v38
    v_dot2_f32_bf16 v39, v51, v27, v39
    s_nop 1
    s_nop 1
    v_permlane32_swap_b32 v32, v36
    v_permlane32_swap_b32 v33, v37
    v_permlane32_swap_b32 v34, v38
    v_permlane32_swap_b32 v35, v39
    v_add_f32 v32, v32, v36
    v_add_f32 v33, v33, v37
    v_add_f32 v34, v34, v38
    v_add_f32 v35, v35, v39
    s_nop 1
    v_permlane16_swap_b32 v32, v34
    v_permlane16_swap_b32 v33, v35
    v_add_f32 v32, v32, v34
    v_add_f32 v33, v33, v35
    s_nop 1
    v_add_f32_dpp v32, v32, v32 row_ror:8 row_mask:0xf bank_mask:0xf
    v_add_f32_dpp v33, v33, v33 row_ror:8 row_mask:0xf bank_mask:0xf
    v_and_b32 v16, 7, v2
    v_lshlrev_b32 v16, 5, v16
    v_lshl_add_u32 v16, v8, 3, v16
    s_lshl_b32 s64, s2, 10
    s_lshl_b32 s65, s6, 8
    s_add_u32 s64, s64, s65
    s_add_u32 s64, s64, 6447104
    s_mov_b32 exec_lo, 0x00ff00ff
    s_mov_b32 exec_hi, 0x00ff00ff
    buffer_store_dwordx2 v[32:33], v16, s[16:19], s64 offen sc0 sc1
    s_mov_b64 exec, -1
    s_lshl_b32 s64, s4, 3
    s_add_u32 s64, s64, s3
    s_lshl_b32 s64, s64, 7
    s_add_u32 s64, s64, 5382144
    v_mov_b32 v14, s64
    s_mov_b64 exec, 1
    v_mov_b32 v15, 0
    buffer_atomic_or v15, v14, s[16:19], 0 offen sc0
    s_mov_b64 exec, -1
    v_mov_b32 v254, v14
    s_branch P2_start
C_start:
    s_and_b32 s6, s3, 1
    s_lshr_b32 s7, s3, 1
    v_and_b32 v3, 15, v2
    s_lshl_b32 s64, s6, 6
    v_add_u32 v3, s64, v3
    v_lshlrev_b32 v3, 7, v3
    v_add_u32 v3, 8192, v3
    v_bfe_u32 v56, v2, 1, 3
    v_lshrrev_b32 v57, 4, v2
    v_xor_b32 v56, v56, v57
    v_lshl_add_u32 v4, v56, 4, v3
    v_xor_b32 v5, 64, v4
    v_bfe_u32 v56, v2, 2, 2
    v_lshl_add_u32 v58, v57, 3, v56
    v_lshlrev_b32 v58, 7, v58
    v_lshrrev_b32 v56, 1, v56
    v_xor_b32 v56, s7, v56
    v_lshl_add_u32 v58, v56, 6, v58
    v_and_b32 v57, 1, v57
    v_lshl_add_u32 v58, v57, 5, v58
    v_and_b32 v56, 3, v2
    v_lshl_add_u32 v58, v56, 3, v58
    v_add_u32 v6, 24576, v58
    v_xor_b32 v7, 32, v6
    v_mov_b32 v8, v4
    v_mov_b32 v10, v6
    v_mov_b32 v9, v5
    v_mov_b32 v11, v7
    v_mov_b32 v64, 0
    v_mov_b32 v65, 0
    v_mov_b32 v66, 0
    v_mov_b32 v67, 0
    v_mov_b32 v68, 0
    v_mov_b32 v69, 0
    v_mov_b32 v70, 0
    v_mov_b32 v71, 0
    v_mov_b32 v72, 0
    v_mov_b32 v73, 0
    v_mov_b32 v74, 0
    v_mov_b32 v75, 0
    v_mov_b32 v76, 0
    v_mov_b32 v77, 0
    v_mov_b32 v78, 0
    v_mov_b32 v79, 0
    v_mov_b32 v80, 0
    v_mov_b32 v81, 0
    v_mov_b32 v82, 0
    v_mov_b32 v83, 0
    v_mov_b32 v84, 0
    v_mov_b32 v85, 0
    v_mov_b32 v86, 0
    v_mov_b32 v87, 0
    v_mov_b32 v88, 0
    v_mov_b32 v89, 0
    v_mov_b32 v90, 0
    v_mov_b32 v91, 0
    v_mov_b32 v92, 0
    v_mov_b32 v93, 0
    v_mov_b32 v94, 0
    v_mov_b32 v95, 0
    v_mov_b32 v96, 0
    v_mov_b32 v97, 0
    v_mov_b32 v98, 0
    v_mov_b32 v99, 0
    v_mov_b32 v100, 0
    v_mov_b32 v101, 0
    v_mov_b32 v102, 0
    v_mov_b32 v103, 0
    v_mov_b32 v104, 0
    v_mov_b32 v105, 0
    v_mov_b32 v106, 0
    v_mov_b32 v107, 0
    v_mov_b32 v108, 0
    v_mov_b32 v109, 0
    v_mov_b32 v110, 0
    v_mov_b32 v111, 0
    v_mov_b32 v112, 0
    v_mov_b32 v113, 0
    v_mov_b32 v114, 0
    v_mov_b32 v115, 0
    v_mov_b32 v116, 0
    v_mov_b32 v117, 0
    v_mov_b32 v118, 0
    v_mov_b32 v119, 0
    v_mov_b32 v120, 0
    v_mov_b32 v121, 0
    v_mov_b32 v122, 0
    v_mov_b32 v123, 0
    v_mov_b32 v124, 0
    v_mov_b32 v125, 0
    v_mov_b32 v126, 0
    v_mov_b32 v127, 0
    v_mov_b32 v128, 0
    v_mov_b32 v129, 0
    v_mov_b32 v130, 0
    v_mov_b32 v131, 0
    v_mov_b32 v132, 0
    v_mov_b32 v133, 0
    v_mov_b32 v134, 0
    v_mov_b32 v135, 0
    v_mov_b32 v136, 0
    v_mov_b32 v137, 0
    v_mov_b32 v138, 0
    v_mov_b32 v139, 0
    v_mov_b32 v140, 0
    v_mov_b32 v141, 0
    v_mov_b32 v142, 0
    v_mov_b32 v143, 0
    v_mov_b32 v144, 0
    v_mov_b32 v145, 0
    v_mov_b32 v146, 0
    v_mov_b32 v147, 0
    v_mov_b32 v148, 0
    v_mov_b32 v149, 0
    v_mov_b32 v150, 0
    v_mov_b32 v151, 0
    v_mov_b32 v152, 0
    v_mov_b32 v153, 0
    v_mov_b32 v154, 0
    v_mov_b32 v155, 0
    v_mov_b32 v156, 0
    v_mov_b32 v157, 0
    v_mov_b32 v158, 0
    v_mov_b32 v159, 0
    s_lshl_b32 s64, s3, 2
    v_mov_b32 v229, s64
    ds_write_b32 v229, v64 offset:4288
    ds_write_b32 v229, v64 offset:4304
    v_lshlrev_b32 v3, 4, v2
    s_lshl_b32 s64, s3, 11
    v_add_u32 v224, s64, v3
    v_xor_b32 v225, 2048, v224
    s_lshl_b32 s64, s3, 8
    v_lshl_add_u32 v227, v2, 2, s64
    v_xor_b32 v228, 256, v227
    v_xor_b32 v230, 4, v229
    v_mov_b32 v231, 1
    v_lshlrev_b32 v232, 2, v2
    s_lshl_b32 s64, 1, s4
    v_mov_b32 v233, s64
    s_lshl_b32 s43, s5, 2
    s_add_u32 s43, s43, s3
    s_lshl_b32 s64, s43, 7
    s_add_u32 s64, s64, 5373952
    v_mov_b32 v234, s64
    s_lshl_b32 s43, s43, 4
    s_add_u32 s43, s43, s4
    s_mul_i32 s43, s43, 1152
    s_add_u32 s43, s43, 4194304
    s_lshl_b32 s42, s4, 2
    s_lshl_b32 s64, s6, 1
    s_add_u32 s42, s42, s64
    s_lshl_b32 s42, s42, 5
    s_lshl_b32 s64, s5, 1
    s_add_u32 s42, s42, s64
    s_add_u32 s42, s42, s7
    s_lshl_b32 s42, s42, 11
    s_and_b32 s64, s5, 7
    s_lshl_b32 s64, s64, 1
    s_add_u32 s64, s64, s7
    s_lshl_b32 s64, 1, s64
    v_mov_b32 v13, s64
    s_lshr_b32 s64, s5, 3
    s_lshl_b32 s64, s64, 1
    s_add_u32 s64, s64, s6
    s_lshl_b32 s64, s64, 8
    s_lshl_b32 s65, s4, 10
    s_add_u32 s64, s64, s65
    s_add_u32 s64, s64, 5382144
    v_lshl_add_u32 v15, v2, 7, s64
    v_lshlrev_b32 v1, 4, v2
    s_and_b32 s64, s2, 7
    s_lshr_b32 s65, s2, 3
    s_and_b32 s4, s64, 3
    s_lshl_b32 s4, s4, 2
    s_and_b32 s66, s65, 3
    s_add_u32 s4, s4, s66
    s_lshr_b32 s5, s64, 2
    s_lshl_b32 s5, s5, 3
    s_lshr_b32 s66, s65, 2
    s_add_u32 s5, s5, s66
    s_mov_b32 s65, 0
    s_mov_b32 s66, 0
    v_mov_b32 v236, 0x3f803f80
    v_mov_b32 v237, 0x3f803f80
    v_mov_b32 v238, 0x3f803f80
    v_mov_b32 v239, 0x3f803f80
    s_waitcnt vmcnt(0) lgkmcnt(0)
    s_barrier
    ds_read_b64_tr_b16 v[16:17], v10 offset:0
    ds_read_b64_tr_b16 v[18:19], v10 offset:512
    ds_read_b128 v[192:195], v8 offset:0
    ds_read_b128 v[196:199], v8 offset:2048
    ds_read_b128 v[200:203], v8 offset:4096
    ds_read_b128 v[204:207], v8 offset:6144
    ds_read_b64_tr_b16 v[20:21], v11 offset:0
    ds_read_b64_tr_b16 v[22:23], v11 offset:512
    ds_read_b64_tr_b16 v[24:25], v10 offset:8192
    ds_read_b64_tr_b16 v[26:27], v10 offset:8704
    ds_read_b64_tr_b16 v[28:29], v11 offset:8192
    ds_read_b64_tr_b16 v[30:31], v11 offset:8704
    ds_read_b64_tr_b16 v[32:33], v10 offset:16384
    ds_read_b64_tr_b16 v[34:35], v10 offset:16896
    ds_read_b64_tr_b16 v[36:37], v11 offset:16384
    ds_read_b64_tr_b16 v[38:39], v11 offset:16896
.p2align 3
C_loop:
    s_waitcnt lgkmcnt(0)
    v_mfma_f32_16x16x32_bf16 v[64:67], v[16:19], v[192:195], v[64:67]
    ds_read_b64_tr_b16 v[40:41], v10 offset:4096
    v_mfma_f32_16x16x32_bf16 v[72:75], v[16:19], v[196:199], v[72:75]
    ds_read_b64_tr_b16 v[42:43], v10 offset:4608
    v_mfma_f32_16x16x32_bf16 v[80:83], v[16:19], v[200:203], v[80:83]
    ds_read_b128 v[208:211], v9 offset:0
    v_mfma_f32_16x16x32_bf16 v[88:91], v[16:19], v[204:207], v[88:91]
    ds_read_b128 v[212:215], v9 offset:2048
    v_mfma_f32_16x16x32_bf16 v[68:71], v[20:23], v[192:195], v[68:71]
    ds_read_b128 v[216:219], v9 offset:4096
    v_mfma_f32_16x16x32_bf16 v[76:79], v[20:23], v[196:199], v[76:79]
    ds_read_b128 v[220:223], v9 offset:6144
    v_mfma_f32_16x16x32_bf16 v[84:87], v[20:23], v[200:203], v[84:87]
    ds_read_b64_tr_b16 v[44:45], v11 offset:4096
    v_mfma_f32_16x16x32_bf16 v[92:95], v[20:23], v[204:207], v[92:95]
    ds_read_b64_tr_b16 v[46:47], v11 offset:4608
    v_mfma_f32_16x16x32_bf16 v[96:99], v[192:195], v[24:27], v[96:99]
    ds_read_b64_tr_b16 v[48:49], v10 offset:12288
    v_mfma_f32_16x16x32_bf16 v[100:103], v[196:199], v[24:27], v[100:103]
    ds_read_b64_tr_b16 v[50:51], v10 offset:12800
    v_mfma_f32_16x16x32_bf16 v[112:115], v[200:203], v[24:27], v[112:115]
    ds_read_b64_tr_b16 v[52:53], v11 offset:12288
    v_mfma_f32_16x16x32_bf16 v[116:119], v[204:207], v[24:27], v[116:119]
    ds_read_b64_tr_b16 v[54:55], v11 offset:12800
    v_mfma_f32_16x16x32_bf16 v[104:107], v[192:195], v[28:31], v[104:107]
    ds_read_b64_tr_b16 v[56:57], v10 offset:20480
    v_mfma_f32_16x16x32_bf16 v[108:111], v[196:199], v[28:31], v[108:111]
    ds_read_b64_tr_b16 v[58:59], v10 offset:20992
    v_mfma_f32_16x16x32_bf16 v[120:123], v[200:203], v[28:31], v[120:123]
    ds_read_b64_tr_b16 v[60:61], v11 offset:20480
    v_mfma_f32_16x16x32_bf16 v[124:127], v[204:207], v[28:31], v[124:127]
    ds_read_b64_tr_b16 v[62:63], v11 offset:20992
    v_mfma_f32_16x16x32_bf16 v[128:131], v[192:195], v[32:35], v[128:131]
    v_mfma_f32_16x16x32_bf16 v[132:135], v[196:199], v[32:35], v[132:135]
    v_mfma_f32_16x16x32_bf16 v[144:147], v[200:203], v[32:35], v[144:147]
    v_mfma_f32_16x16x32_bf16 v[148:151], v[204:207], v[32:35], v[148:151]
    v_mfma_f32_16x16x32_bf16 v[136:139], v[192:195], v[36:39], v[136:139]
    v_mfma_f32_16x16x32_bf16 v[140:143], v[196:199], v[36:39], v[140:143]
    v_mfma_f32_16x16x32_bf16 v[152:155], v[200:203], v[36:39], v[152:155]
    v_mfma_f32_16x16x32_bf16 v[156:159], v[204:207], v[36:39], v[156:159]
    s_waitcnt lgkmcnt(0)
    s_barrier
    s_add_u32 s65, s65, 40960
    s_cmp_eq_u32 s65, 122880
    s_cselect_b32 s65, 0, s65
    v_mfma_f32_16x16x32_bf16 v[64:67], v[40:43], v[208:211], v[64:67]
    v_add_u32 v10, s65, v6
    v_add_u32 v8, s65, v4
    v_mfma_f32_16x16x32_bf16 v[72:75], v[40:43], v[212:215], v[72:75]
    ds_read_b64_tr_b16 v[16:17], v10 offset:0
    v_mfma_f32_16x16x32_bf16 v[80:83], v[40:43], v[216:219], v[80:83]
    ds_read_b64_tr_b16 v[18:19], v10 offset:512
    v_mfma_f32_16x16x32_bf16 v[88:91], v[40:43], v[220:223], v[88:91]
    ds_read_b128 v[192:195], v8 offset:0
    v_mfma_f32_16x16x32_bf16 v[68:71], v[44:47], v[208:211], v[68:71]
    ds_read_b128 v[196:199], v8 offset:2048
    v_mfma_f32_16x16x32_bf16 v[76:79], v[44:47], v[212:215], v[76:79]
    ds_read_b128 v[200:203], v8 offset:4096
    v_mfma_f32_16x16x32_bf16 v[84:87], v[44:47], v[216:219], v[84:87]
    ds_read_b128 v[204:207], v8 offset:6144
    v_mfma_f32_16x16x32_bf16 v[92:95], v[44:47], v[220:223], v[92:95]
    v_add_u32 v11, s65, v7
    v_mfma_f32_16x16x32_bf16 v[96:99], v[208:211], v[48:51], v[96:99]
    ds_read_b64_tr_b16 v[20:21], v11 offset:0
    v_mfma_f32_16x16x32_bf16 v[100:103], v[212:215], v[48:51], v[100:103]
    ds_read_b64_tr_b16 v[22:23], v11 offset:512
    v_mfma_f32_16x16x32_bf16 v[112:115], v[216:219], v[48:51], v[112:115]
    ds_read_b64_tr_b16 v[24:25], v10 offset:8192
    v_mfma_f32_16x16x32_bf16 v[116:119], v[220:223], v[48:51], v[116:119]
    ds_read_b64_tr_b16 v[26:27], v10 offset:8704
    v_mfma_f32_16x16x32_bf16 v[104:107], v[208:211], v[52:55], v[104:107]
    ds_read_b64_tr_b16 v[28:29], v11 offset:8192
    v_mfma_f32_16x16x32_bf16 v[108:111], v[212:215], v[52:55], v[108:111]
    ds_read_b64_tr_b16 v[30:31], v11 offset:8704
    v_mfma_f32_16x16x32_bf16 v[120:123], v[216:219], v[52:55], v[120:123]
    ds_read_b64_tr_b16 v[32:33], v10 offset:16384
    v_mfma_f32_16x16x32_bf16 v[124:127], v[220:223], v[52:55], v[124:127]
    ds_read_b64_tr_b16 v[34:35], v10 offset:16896
    v_mfma_f32_16x16x32_bf16 v[128:131], v[208:211], v[56:59], v[128:131]
    ds_read_b64_tr_b16 v[36:37], v11 offset:16384
    v_mfma_f32_16x16x32_bf16 v[132:135], v[212:215], v[56:59], v[132:135]
    ds_read_b64_tr_b16 v[38:39], v11 offset:16896
    v_mfma_f32_16x16x32_bf16 v[144:147], v[216:219], v[56:59], v[144:147]
    v_add_u32 v9, s65, v5
    v_mfma_f32_16x16x32_bf16 v[148:151], v[220:223], v[56:59], v[148:151]
    v_mfma_f32_16x16x32_bf16 v[136:139], v[208:211], v[60:63], v[136:139]
    v_mfma_f32_16x16x32_bf16 v[140:143], v[212:215], v[60:63], v[140:143]
    v_mfma_f32_16x16x32_bf16 v[152:155], v[216:219], v[60:63], v[152:155]
    v_mfma_f32_16x16x32_bf16 v[156:159], v[220:223], v[60:63], v[156:159]
    s_add_u32 s66, s66, 1
    s_cmp_lt_u32 s66, 14
    s_cbranch_scc1 C_loop
    s_waitcnt lgkmcnt(0)
    v_mfma_f32_16x16x32_bf16 v[96:99], v[192:195], v[24:27], v[96:99]
    ds_read_b64_tr_b16 v[48:49], v10 offset:12288
    v_mfma_f32_16x16x32_bf16 v[100:103], v[196:199], v[24:27], v[100:103]
    ds_read_b64_tr_b16 v[50:51], v10 offset:12800
    v_mfma_f32_16x16x32_bf16 v[112:115], v[200:203], v[24:27], v[112:115]
    ds_read_b128 v[160:163], v9 offset:0
    v_mfma_f32_16x16x32_bf16 v[116:119], v[204:207], v[24:27], v[116:119]
    ds_read_b128 v[164:167], v9 offset:2048
    v_mfma_f32_16x16x32_bf16 v[104:107], v[192:195], v[28:31], v[104:107]
    ds_read_b128 v[168:171], v9 offset:4096
    v_mfma_f32_16x16x32_bf16 v[108:111], v[196:199], v[28:31], v[108:111]
    ds_read_b128 v[172:175], v9 offset:6144
    v_mfma_f32_16x16x32_bf16 v[120:123], v[200:203], v[28:31], v[120:123]
    ds_read_b64_tr_b16 v[52:53], v11 offset:12288
    v_mfma_f32_16x16x32_bf16 v[124:127], v[204:207], v[28:31], v[124:127]
    ds_read_b64_tr_b16 v[54:55], v11 offset:12800
    v_mfma_f32_16x16x32_bf16 v[128:131], v[192:195], v[32:35], v[128:131]
    ds_read_b64_tr_b16 v[56:57], v10 offset:20480
    v_mfma_f32_16x16x32_bf16 v[132:135], v[196:199], v[32:35], v[132:135]
    ds_read_b64_tr_b16 v[58:59], v10 offset:20992
    v_mfma_f32_16x16x32_bf16 v[144:147], v[200:203], v[32:35], v[144:147]
    ds_read_b64_tr_b16 v[60:61], v11 offset:20480
    v_mfma_f32_16x16x32_bf16 v[148:151], v[204:207], v[32:35], v[148:151]
    ds_read_b64_tr_b16 v[62:63], v11 offset:20992
    v_mfma_f32_16x16x32_bf16 v[136:139], v[192:195], v[36:39], v[136:139]
    v_mfma_f32_16x16x32_bf16 v[140:143], v[196:199], v[36:39], v[140:143]
    v_mfma_f32_16x16x32_bf16 v[152:155], v[200:203], v[36:39], v[152:155]
    v_mfma_f32_16x16x32_bf16 v[156:159], v[204:207], v[36:39], v[156:159]
    s_waitcnt lgkmcnt(0)
    s_barrier
    s_add_u32 s66, s66, 1
    v_mfma_f32_16x16x32_bf16 v[96:99], v[160:163], v[48:51], v[96:99]
    v_mov_b32 v10, v6
    v_mov_b32 v8, v4
    v_mfma_f32_16x16x32_bf16 v[100:103], v[164:167], v[48:51], v[100:103]
    ds_read_b64_tr_b16 v[24:25], v10 offset:8192
    v_mfma_f32_16x16x32_bf16 v[112:115], v[168:171], v[48:51], v[112:115]
    ds_read_b64_tr_b16 v[26:27], v10 offset:8704
    v_mfma_f32_16x16x32_bf16 v[116:119], v[172:175], v[48:51], v[116:119]
    v_mov_b32 v11, v7
    v_mov_b32 v9, v5
    v_mfma_f32_16x16x32_bf16 v[104:107], v[160:163], v[52:55], v[104:107]
    ds_read_b128 v[176:179], v8 offset:0
    v_mfma_f32_16x16x32_bf16 v[108:111], v[164:167], v[52:55], v[108:111]
    ds_read_b128 v[180:183], v8 offset:2048
    v_mfma_f32_16x16x32_bf16 v[120:123], v[168:171], v[52:55], v[120:123]
    ds_read_b128 v[184:187], v8 offset:4096
    v_mfma_f32_16x16x32_bf16 v[124:127], v[172:175], v[52:55], v[124:127]
    ds_read_b128 v[188:191], v8 offset:6144
    v_mfma_f32_16x16x32_bf16 v[128:131], v[160:163], v[56:59], v[128:131]
    ds_read_b64_tr_b16 v[28:29], v11 offset:8192
    v_mfma_f32_16x16x32_bf16 v[132:135], v[164:167], v[56:59], v[132:135]
    ds_read_b64_tr_b16 v[30:31], v11 offset:8704
    v_mfma_f32_16x16x32_bf16 v[144:147], v[168:171], v[56:59], v[144:147]
    ds_read_b64_tr_b16 v[32:33], v10 offset:16384
    v_mfma_f32_16x16x32_bf16 v[148:151], v[172:175], v[56:59], v[148:151]
    ds_read_b64_tr_b16 v[34:35], v10 offset:16896
    v_mfma_f32_16x16x32_bf16 v[136:139], v[160:163], v[60:63], v[136:139]
    ds_read_b64_tr_b16 v[36:37], v11 offset:16384
    v_mfma_f32_16x16x32_bf16 v[140:143], v[164:167], v[60:63], v[140:143]
    ds_read_b64_tr_b16 v[38:39], v11 offset:16896
    v_mfma_f32_16x16x32_bf16 v[152:155], v[168:171], v[60:63], v[152:155]
    v_mfma_f32_16x16x32_bf16 v[156:159], v[172:175], v[60:63], v[156:159]
    s_waitcnt lgkmcnt(0)
    v_mfma_f32_16x16x32_bf16 v[96:99], v[176:179], v[24:27], v[96:99]
    ds_read_b64_tr_b16 v[48:49], v10 offset:12288
    v_mfma_f32_16x16x32_bf16 v[100:103], v[180:183], v[24:27], v[100:103]
    ds_read_b64_tr_b16 v[50:51], v10 offset:12800
    v_mfma_f32_16x16x32_bf16 v[112:115], v[184:187], v[24:27], v[112:115]
    ds_read_b128 v[208:211], v9 offset:0
    v_mfma_f32_16x16x32_bf16 v[116:119], v[188:191], v[24:27], v[116:119]
    ds_read_b128 v[212:215], v9 offset:2048
    v_mfma_f32_16x16x32_bf16 v[104:107], v[176:179], v[28:31], v[104:107]
    ds_read_b128 v[216:219], v9 offset:4096
    v_mfma_f32_16x16x32_bf16 v[108:111], v[180:183], v[28:31], v[108:111]
    ds_read_b128 v[220:223], v9 offset:6144
    v_mfma_f32_16x16x32_bf16 v[120:123], v[184:187], v[28:31], v[120:123]
    ds_read_b64_tr_b16 v[52:53], v11 offset:12288
    v_mfma_f32_16x16x32_bf16 v[124:127], v[188:191], v[28:31], v[124:127]
    ds_read_b64_tr_b16 v[54:55], v11 offset:12800
    v_mfma_f32_16x16x32_bf16 v[128:131], v[176:179], v[32:35], v[128:131]
    ds_read_b64_tr_b16 v[56:57], v10 offset:20480
    v_mfma_f32_16x16x32_bf16 v[132:135], v[180:183], v[32:35], v[132:135]
    ds_read_b64_tr_b16 v[58:59], v10 offset:20992
    v_mfma_f32_16x16x32_bf16 v[144:147], v[184:187], v[32:35], v[144:147]
    ds_read_b64_tr_b16 v[60:61], v11 offset:20480
    v_mfma_f32_16x16x32_bf16 v[148:151], v[188:191], v[32:35], v[148:151]
    ds_read_b64_tr_b16 v[62:63], v11 offset:20992
    v_mfma_f32_16x16x32_bf16 v[136:139], v[176:179], v[36:39], v[136:139]
    v_mfma_f32_16x16x32_bf16 v[140:143], v[180:183], v[36:39], v[140:143]
    v_mfma_f32_16x16x32_bf16 v[152:155], v[184:187], v[36:39], v[152:155]
    v_mfma_f32_16x16x32_bf16 v[156:159], v[188:191], v[36:39], v[156:159]
    s_waitcnt lgkmcnt(0)
    s_barrier
    v_mfma_f32_16x16x32_bf16 v[96:99], v[208:211], v[48:51], v[96:99]
    v_mfma_f32_16x16x32_bf16 v[100:103], v[212:215], v[48:51], v[100:103]
    v_mfma_f32_16x16x32_bf16 v[112:115], v[216:219], v[48:51], v[112:115]
    v_mfma_f32_16x16x32_bf16 v[116:119], v[220:223], v[48:51], v[116:119]
    v_mfma_f32_16x16x32_bf16 v[104:107], v[208:211], v[52:55], v[104:107]
    v_mfma_f32_16x16x32_bf16 v[108:111], v[212:215], v[52:55], v[108:111]
    v_mfma_f32_16x16x32_bf16 v[120:123], v[216:219], v[52:55], v[120:123]
    v_mfma_f32_16x16x32_bf16 v[124:127], v[220:223], v[52:55], v[124:127]
    v_mfma_f32_16x16x32_bf16 v[128:131], v[208:211], v[56:59], v[128:131]
    v_mfma_f32_16x16x32_bf16 v[132:135], v[212:215], v[56:59], v[132:135]
    v_mfma_f32_16x16x32_bf16 v[144:147], v[216:219], v[56:59], v[144:147]
    v_mfma_f32_16x16x32_bf16 v[148:151], v[220:223], v[56:59], v[148:151]
    v_mfma_f32_16x16x32_bf16 v[136:139], v[208:211], v[60:63], v[136:139]
    v_mfma_f32_16x16x32_bf16 v[140:143], v[212:215], v[60:63], v[140:143]
    v_mfma_f32_16x16x32_bf16 v[152:155], v[216:219], v[60:63], v[152:155]
    v_mfma_f32_16x16x32_bf16 v[156:159], v[220:223], v[60:63], v[156:159]
    v_add_u32 v10, 81920, v6
    v_add_u32 v11, 81920, v7
    v_cvt_pk_bf16_f32 v16, v96, v97
    v_lshlrev_b32 v48, 16, v16
    v_and_b32 v49, 0xffff0000, v16
    v_mul_f32 v50, s72, v48
    v_mul_f32 v51, s72, v49
    v_exp_f32 v50, v50 clamp
    v_exp_f32 v51, v51 clamp
    v_max_f32 v48, 0, v48
    v_max_f32 v49, 0, v49
    v_add_f32 v48, v48, v50
    v_add_f32 v49, v49, v51
    v_min_f32 v56, v48, v49
    v_cvt_pk_bf16_f32 v16, v48, v49
    v_cvt_pk_bf16_f32 v17, v98, v99
    v_lshlrev_b32 v48, 16, v17
    v_and_b32 v49, 0xffff0000, v17
    v_mul_f32 v50, s72, v48
    v_mul_f32 v51, s72, v49
    v_exp_f32 v50, v50 clamp
    v_exp_f32 v51, v51 clamp
    v_max_f32 v48, 0, v48
    v_max_f32 v49, 0, v49
    v_add_f32 v48, v48, v50
    v_add_f32 v49, v49, v51
    v_min3_f32 v56, v48, v49, v56
    v_cvt_pk_bf16_f32 v17, v48, v49
    v_cvt_pk_bf16_f32 v18, v100, v101
    v_lshlrev_b32 v48, 16, v18
    v_and_b32 v49, 0xffff0000, v18
    v_mul_f32 v50, s72, v48
    v_mul_f32 v51, s72, v49
    v_exp_f32 v50, v50 clamp
    v_exp_f32 v51, v51 clamp
    v_max_f32 v48, 0, v48
    v_max_f32 v49, 0, v49
    v_add_f32 v48, v48, v50
    v_add_f32 v49, v49, v51
    v_min3_f32 v56, v48, v49, v56
    v_cvt_pk_bf16_f32 v18, v48, v49
    v_cvt_pk_bf16_f32 v19, v102, v103
    v_lshlrev_b32 v48, 16, v19
    v_and_b32 v49, 0xffff0000, v19
    v_mul_f32 v50, s72, v48
    v_mul_f32 v51, s72, v49
    v_exp_f32 v50, v50 clamp
    v_exp_f32 v51, v51 clamp
    v_max_f32 v48, 0, v48
    v_max_f32 v49, 0, v49
    v_add_f32 v48, v48, v50
    v_add_f32 v49, v49, v51
    v_min3_f32 v56, v48, v49, v56
    v_cvt_pk_bf16_f32 v19, v48, v49
    v_cvt_pk_bf16_f32 v20, v104, v105
    v_lshlrev_b32 v48, 16, v20
    v_and_b32 v49, 0xffff0000, v20
    v_mul_f32 v50, s72, v48
    v_mul_f32 v51, s72, v49
    v_exp_f32 v50, v50 clamp
    v_exp_f32 v51, v51 clamp
    v_max_f32 v48, 0, v48
    v_max_f32 v49, 0, v49
    v_add_f32 v48, v48, v50
    v_add_f32 v49, v49, v51
    v_min3_f32 v56, v48, v49, v56
    v_cvt_pk_bf16_f32 v20, v48, v49
    v_cvt_pk_bf16_f32 v21, v106, v107
    v_lshlrev_b32 v48, 16, v21
    v_and_b32 v49, 0xffff0000, v21
    v_mul_f32 v50, s72, v48
    v_mul_f32 v51, s72, v49
    v_exp_f32 v50, v50 clamp
    v_exp_f32 v51, v51 clamp
    v_max_f32 v48, 0, v48
    v_max_f32 v49, 0, v49
    v_add_f32 v48, v48, v50
    v_add_f32 v49, v49, v51
    v_min3_f32 v56, v48, v49, v56
    v_cvt_pk_bf16_f32 v21, v48, v49
    v_cvt_pk_bf16_f32 v22, v108, v109
    v_lshlrev_b32 v48, 16, v22
    v_and_b32 v49, 0xffff0000, v22
    v_mul_f32 v50, s72, v48
    v_mul_f32 v51, s72, v49
    v_exp_f32 v50, v50 clamp
    v_exp_f32 v51, v51 clamp
    v_max_f32 v48, 0, v48
    v_max_f32 v49, 0, v49
    v_add_f32 v48, v48, v50
    v_add_f32 v49, v49, v51
    v_min3_f32 v56, v48, v49, v56
    v_cvt_pk_bf16_f32 v22, v48, v49
    v_cvt_pk_bf16_f32 v23, v110, v111
    v_lshlrev_b32 v48, 16, v23
    v_and_b32 v49, 0xffff0000, v23
    v_mul_f32 v50, s72, v48
    v_mul_f32 v51, s72, v49
    v_exp_f32 v50, v50 clamp
    v_exp_f32 v51, v51 clamp
    v_max_f32 v48, 0, v48
    v_max_f32 v49, 0, v49
    v_add_f32 v48, v48, v50
    v_add_f32 v49, v49, v51
    v_min3_f32 v56, v48, v49, v56
    v_cvt_pk_bf16_f32 v23, v48, v49
    v_cmp_gt_f32 vcc, 0x3a800000, v56
    s_cbranch_vccnz phi_16_fix
phi_16_done:
    v_cvt_pk_bf16_f32 v32, v128, v129
    v_cvt_pk_bf16_f32 v33, v130, v131
    v_mfma_f32_16x16x32_bf16 v[96:99], v[236:239], v[16:19], 0
    v_cvt_pk_bf16_f32 v34, v132, v133
    v_mfma_f32_16x16x32_bf16 v[60:63], v[236:239], v[20:23], 0
    v_cvt_pk_bf16_f32 v35, v134, v135
    v_cvt_pk_bf16_f32 v36, v136, v137
    v_cvt_pk_bf16_f32 v37, v138, v139
    v_mfma_f32_16x16x32_bf16 v[240:243], v[16:19], v[32:35], 0
    v_cvt_pk_bf16_f32 v38, v140, v141
    v_mfma_f32_16x16x32_bf16 v[244:247], v[20:23], v[32:35], 0
    v_cvt_pk_bf16_f32 v39, v142, v143
    s_nop 1
    v_mfma_f32_16x16x32_bf16 v[248:251], v[16:19], v[36:39], 0
    v_mfma_f32_16x16x32_bf16 v[252:255], v[20:23], v[36:39], 0
    v_cvt_pk_bf16_f32 v24, v112, v113
    v_lshlrev_b32 v48, 16, v24
    v_and_b32 v49, 0xffff0000, v24
    v_mul_f32 v50, s72, v48
    v_mul_f32 v51, s72, v49
    v_exp_f32 v50, v50 clamp
    v_exp_f32 v51, v51 clamp
    v_max_f32 v48, 0, v48
    v_max_f32 v49, 0, v49
    v_add_f32 v48, v48, v50
    v_add_f32 v49, v49, v51
    v_min_f32 v56, v48, v49
    v_cvt_pk_bf16_f32 v24, v48, v49
    v_cvt_pk_bf16_f32 v25, v114, v115
    v_lshlrev_b32 v48, 16, v25
    v_and_b32 v49, 0xffff0000, v25
    v_mul_f32 v50, s72, v48
    v_mul_f32 v51, s72, v49
    v_exp_f32 v50, v50 clamp
    v_exp_f32 v51, v51 clamp
    v_max_f32 v48, 0, v48
    v_max_f32 v49, 0, v49
    v_add_f32 v48, v48, v50
    v_add_f32 v49, v49, v51
    v_min3_f32 v56, v48, v49, v56
    v_cvt_pk_bf16_f32 v25, v48, v49
    v_cvt_pk_bf16_f32 v26, v116, v117
    v_lshlrev_b32 v48, 16, v26
    v_and_b32 v49, 0xffff0000, v26
    v_mul_f32 v50, s72, v48
    v_mul_f32 v51, s72, v49
    v_exp_f32 v50, v50 clamp
    v_exp_f32 v51, v51 clamp
    v_max_f32 v48, 0, v48
    v_max_f32 v49, 0, v49
    v_add_f32 v48, v48, v50
    v_add_f32 v49, v49, v51
    v_min3_f32 v56, v48, v49, v56
    v_cvt_pk_bf16_f32 v26, v48, v49
    v_cvt_pk_bf16_f32 v27, v118, v119
    v_lshlrev_b32 v48, 16, v27
    v_and_b32 v49, 0xffff0000, v27
    v_mul_f32 v50, s72, v48
    v_mul_f32 v51, s72, v49
    v_exp_f32 v50, v50 clamp
    v_exp_f32 v51, v51 clamp
    v_max_f32 v48, 0, v48
    v_max_f32 v49, 0, v49
    v_add_f32 v48, v48, v50
    v_add_f32 v49, v49, v51
    v_min3_f32 v56, v48, v49, v56
    v_cvt_pk_bf16_f32 v27, v48, v49
    v_cvt_pk_bf16_f32 v28, v120, v121
    v_lshlrev_b32 v48, 16, v28
    v_and_b32 v49, 0xffff0000, v28
    v_mul_f32 v50, s72, v48
    v_mul_f32 v51, s72, v49
    v_exp_f32 v50, v50 clamp
    v_exp_f32 v51, v51 clamp
    v_max_f32 v48, 0, v48
    v_max_f32 v49, 0, v49
    v_add_f32 v48, v48, v50
    v_add_f32 v49, v49, v51
    v_min3_f32 v56, v48, v49, v56
    v_cvt_pk_bf16_f32 v28, v48, v49
    v_cvt_pk_bf16_f32 v29, v122, v123
    v_lshlrev_b32 v48, 16, v29
    v_and_b32 v49, 0xffff0000, v29
    v_mul_f32 v50, s72, v48
    v_mul_f32 v51, s72, v49
    v_exp_f32 v50, v50 clamp
    v_exp_f32 v51, v51 clamp
    v_max_f32 v48, 0, v48
    v_max_f32 v49, 0, v49
    v_add_f32 v48, v48, v50
    v_add_f32 v49, v49, v51
    v_min3_f32 v56, v48, v49, v56
    v_cvt_pk_bf16_f32 v29, v48, v49
    v_cvt_pk_bf16_f32 v30, v124, v125
    v_lshlrev_b32 v48, 16, v30
    v_and_b32 v49, 0xffff0000, v30
    v_mul_f32 v50, s72, v48
    v_mul_f32 v51, s72, v49
    v_exp_f32 v50, v50 clamp
    v_exp_f32 v51, v51 clamp
    v_max_f32 v48, 0, v48
    v_max_f32 v49, 0, v49
    v_add_f32 v48, v48, v50
    v_add_f32 v49, v49, v51
    v_min3_f32 v56, v48, v49, v56
    v_cvt_pk_bf16_f32 v30, v48, v49
    v_cvt_pk_bf16_f32 v31, v126, v127
    v_lshlrev_b32 v48, 16, v31
    v_and_b32 v49, 0xffff0000, v31
    v_mul_f32 v50, s72, v48
    v_mul_f32 v51, s72, v49
    v_exp_f32 v50, v50 clamp
    v_exp_f32 v51, v51 clamp
    v_max_f32 v48, 0, v48
    v_max_f32 v49, 0, v49
    v_add_f32 v48, v48, v50
    v_add_f32 v49, v49, v51
    v_min3_f32 v56, v48, v49, v56
    v_cvt_pk_bf16_f32 v31, v48, v49
    v_cmp_gt_f32 vcc, 0x3a800000, v56
    s_cbranch_vccnz phi_17_fix
phi_17_done:
    v_cvt_pk_bf16_f32 v40, v144, v145
    v_cvt_pk_bf16_f32 v41, v146, v147
    v_mfma_f32_16x16x32_bf16 v[96:99], v[236:239], v[24:27], v[96:99]
    v_cvt_pk_bf16_f32 v42, v148, v149
    v_mfma_f32_16x16x32_bf16 v[60:63], v[236:239], v[28:31], v[60:63]
    v_cvt_pk_bf16_f32 v43, v150, v151
    v_cvt_pk_bf16_f32 v44, v152, v153
    v_cvt_pk_bf16_f32 v45, v154, v155
    v_mfma_f32_16x16x32_bf16 v[240:243], v[24:27], v[40:43], v[240:243]
    v_cvt_pk_bf16_f32 v46, v156, v157
    v_mfma_f32_16x16x32_bf16 v[244:247], v[28:31], v[40:43], v[244:247]
    v_cvt_pk_bf16_f32 v47, v158, v159
    s_nop 1
    v_mfma_f32_16x16x32_bf16 v[248:251], v[24:27], v[44:47], v[248:251]
    v_mfma_f32_16x16x32_bf16 v[252:255], v[28:31], v[44:47], v[252:255]
    s_cmp_eq_u32 s6, 0
    s_cbranch_scc0 C_ex1
    ds_write_b32 v227, v60 offset:4608
    s_nop 5
    ds_write_b128 v224, v[248:251] offset:32768
    ds_write_b128 v224, v[252:255] offset:33792
C_ex2:
    ds_write_b32 v229, v231 offset:4288
C_ps:
    ds_read_b32 v25, v230 offset:4288
    ds_read_b128 v[16:19], v225 offset:32768
    ds_read_b128 v[20:23], v225 offset:33792
    ds_read_b32 v24, v228 offset:4608
    s_waitcnt lgkmcnt(0)
    v_cmp_eq_u32 vcc, 0, v25
    s_cbranch_vccnz C_ps
    v_add_f32 v16, v16, v240
    v_add_f32 v17, v17, v241
    v_add_f32 v18, v18, v242
    v_add_f32 v19, v19, v243
    v_add_f32 v20, v20, v244
    v_add_f32 v21, v21, v245
    v_add_f32 v22, v22, v246
    v_add_f32 v23, v23, v247
    v_add_f32 v24, v24, v96
    v_cvt_pk_bf16_f32 v28, v16, v17
    v_cvt_pk_bf16_f32 v29, v18, v19
    v_cvt_pk_bf16_f32 v30, v20, v21
    v_cvt_pk_bf16_f32 v31, v22, v23
    buffer_store_dwordx4 v[28:31], v1, s[16:19], s43 offen sc0 sc1
    s_mov_b64 exec, 0xffff
    buffer_store_dword v24, v232, s[16:19], s43 offen offset:1024 sc0 sc1
    s_mov_b64 exec, 1
    buffer_atomic_or v233, v234, s[16:19], 0 offen
    s_mov_b64 exec, -1
    ds_read_b64_tr_b16 v[96:97], v10 offset:0
    ds_read_b64_tr_b16 v[98:99], v10 offset:512
    ds_read_b64_tr_b16 v[100:101], v11 offset:0
    ds_read_b64_tr_b16 v[102:103], v11 offset:512
    ds_read_b64_tr_b16 v[104:105], v10 offset:4096
    ds_read_b64_tr_b16 v[106:107], v10 offset:4608
    ds_read_b64_tr_b16 v[108:109], v11 offset:4096
    ds_read_b64_tr_b16 v[110:111], v11 offset:4608
    ds_read_b64_tr_b16 v[112:113], v6 offset:0
    ds_read_b64_tr_b16 v[114:115], v6 offset:512
    ds_read_b64_tr_b16 v[116:117], v7 offset:0
    ds_read_b64_tr_b16 v[118:119], v7 offset:512
    ds_read_b64_tr_b16 v[120:121], v6 offset:4096
    ds_read_b64_tr_b16 v[122:123], v6 offset:4608
    ds_read_b64_tr_b16 v[124:125], v7 offset:4096
    ds_read_b64_tr_b16 v[126:127], v7 offset:4608
    s_waitcnt lgkmcnt(12)
    v_mfma_f32_16x16x32_bf16 v[64:67], v[96:99], v[192:195], v[64:67]
    v_mfma_f32_16x16x32_bf16 v[72:75], v[96:99], v[196:199], v[72:75]
    v_mfma_f32_16x16x32_bf16 v[80:83], v[96:99], v[200:203], v[80:83]
    v_mfma_f32_16x16x32_bf16 v[88:91], v[96:99], v[204:207], v[88:91]
    v_mfma_f32_16x16x32_bf16 v[68:71], v[100:103], v[192:195], v[68:71]
    v_mfma_f32_16x16x32_bf16 v[76:79], v[100:103], v[196:199], v[76:79]
    v_mfma_f32_16x16x32_bf16 v[84:87], v[100:103], v[200:203], v[84:87]
    v_mfma_f32_16x16x32_bf16 v[92:95], v[100:103], v[204:207], v[92:95]
    s_waitcnt lgkmcnt(8)
    v_mfma_f32_16x16x32_bf16 v[64:67], v[104:107], v[160:163], v[64:67]
    v_mfma_f32_16x16x32_bf16 v[72:75], v[104:107], v[164:167], v[72:75]
    v_mfma_f32_16x16x32_bf16 v[80:83], v[104:107], v[168:171], v[80:83]
    v_mfma_f32_16x16x32_bf16 v[88:91], v[104:107], v[172:175], v[88:91]
    v_mfma_f32_16x16x32_bf16 v[68:71], v[108:111], v[160:163], v[68:71]
    v_mfma_f32_16x16x32_bf16 v[76:79], v[108:111], v[164:167], v[76:79]
    v_mfma_f32_16x16x32_bf16 v[84:87], v[108:111], v[168:171], v[84:87]
    v_mfma_f32_16x16x32_bf16 v[92:95], v[108:111], v[172:175], v[92:95]
    s_waitcnt lgkmcnt(4)
    v_mfma_f32_16x16x32_bf16 v[64:67], v[112:115], v[176:179], v[64:67]
    v_mfma_f32_16x16x32_bf16 v[72:75], v[112:115], v[180:183], v[72:75]
    v_mfma_f32_16x16x32_bf16 v[80:83], v[112:115], v[184:187], v[80:83]
    v_mfma_f32_16x16x32_bf16 v[88:91], v[112:115], v[188:191], v[88:91]
    v_mfma_f32_16x16x32_bf16 v[68:71], v[116:119], v[176:179], v[68:71]
    v_mfma_f32_16x16x32_bf16 v[76:79], v[116:119], v[180:183], v[76:79]
    v_mfma_f32_16x16x32_bf16 v[84:87], v[116:119], v[184:187], v[84:87]
    v_mfma_f32_16x16x32_bf16 v[92:95], v[116:119], v[188:191], v[92:95]
    s_waitcnt lgkmcnt(0)
    v_mfma_f32_16x16x32_bf16 v[64:67], v[120:123], v[208:211], v[64:67]
    v_mfma_f32_16x16x32_bf16 v[72:75], v[120:123], v[212:215], v[72:75]
    v_mfma_f32_16x16x32_bf16 v[80:83], v[120:123], v[216:219], v[80:83]
    v_mfma_f32_16x16x32_bf16 v[88:91], v[120:123], v[220:223], v[88:91]
    v_mfma_f32_16x16x32_bf16 v[68:71], v[124:127], v[208:211], v[68:71]
    v_mfma_f32_16x16x32_bf16 v[76:79], v[124:127], v[212:215], v[76:79]
    v_mfma_f32_16x16x32_bf16 v[84:87], v[124:127], v[216:219], v[84:87]
    v_mfma_f32_16x16x32_bf16 v[92:95], v[124:127], v[220:223], v[92:95]
    v_mov_b32 v254, v15
    v_mov_b32 v255, v13
    s_cmp_lg_u32 s3, 0
    s_cbranch_scc1 C_nh0
    s_lshr_b32 s64, s2, 2
    s_lshl_b32 s64, s64, 14
    s_add_u32 s64, s64, 5398528
    v_lshl_add_u32 v152, v2, 4, s64
    s_mov_b32 s64, 0
    buffer_load_dwordx4 v[156:159], v152, s[16:19], s64 offen offset:0 sc1
    s_mov_b32 s64, 0
    buffer_load_dwordx4 v[160:163], v152, s[16:19], s64 offen offset:1024 sc1
    s_mov_b32 s64, 0
    buffer_load_dwordx4 v[164:167], v152, s[16:19], s64 offen offset:2048 sc1
    s_mov_b32 s64, 0
    buffer_load_dwordx4 v[168:171], v152, s[16:19], s64 offen offset:3072 sc1
    s_mov_b32 s64, 4096
    buffer_load_dwordx4 v[172:175], v152, s[16:19], s64 offen offset:0 sc1
    s_mov_b32 s64, 4096
    buffer_load_dwordx4 v[176:179], v152, s[16:19], s64 offen offset:1024 sc1
    s_mov_b32 s64, 4096
    buffer_load_dwordx4 v[180:183], v152, s[16:19], s64 offen offset:2048 sc1
    s_mov_b32 s64, 4096
    buffer_load_dwordx4 v[184:187], v152, s[16:19], s64 offen offset:3072 sc1
    s_mov_b32 s64, 8192
    buffer_load_dwordx4 v[188:191], v152, s[16:19], s64 offen offset:0 sc1
    s_mov_b32 s64, 8192
    buffer_load_dwordx4 v[192:195], v152, s[16:19], s64 offen offset:1024 sc1
    s_mov_b32 s64, 8192
    buffer_load_dwordx4 v[196:199], v152, s[16:19], s64 offen offset:2048 sc1
    s_mov_b32 s64, 8192
    buffer_load_dwordx4 v[200:203], v152, s[16:19], s64 offen offset:3072 sc1
    s_mov_b32 s64, 12288
    buffer_load_dwordx4 v[204:207], v152, s[16:19], s64 offen offset:0 sc1
    s_mov_b32 s64, 12288
    buffer_load_dwordx4 v[208:211], v152, s[16:19], s64 offen offset:1024 sc1
    s_mov_b32 s64, 12288
    buffer_load_dwordx4 v[212:215], v152, s[16:19], s64 offen offset:2048 sc1
    s_mov_b32 s64, 12288
    buffer_load_dwordx4 v[216:219], v152, s[16:19], s64 offen offset:3072 sc1
C_nh0:
    s_and_b32 s64, s3, 3
    s_lshl_b32 s64, s64, 1
    s_lshr_b32 s65, s3, 2
    s_add_u32 s64, s64, s65
    s_lshl_b32 s64, s64, 4
    s_lshl_b32 s65, s4, 7
    s_add_u32 s64, s64, s65
    v_and_b32 v230, 15, v2
    v_add_u32 v230, s64, v230
    v_bfe_u32 v3, v2, 4, 1
    v_lshlrev_b32 v229, 5, v3
    v_lshrrev_b32 v3, 5, v2
    v_lshl_add_u32 v229, v3, 4, v229
    v_lshl_add_u32 v231, v230, 11, v229
    s_lshl_b32 s64, s5, 7
    v_add_u32 v231, s64, v231
    v_lshlrev_b32 v3, 2, v230
    v_add_u32 v3, 6709248, v3
    buffer_load_dwordx4 v[220:223], v231, s[8:11], 0 offen
    buffer_load_dwordx4 v[224:227], v231, s[8:11], 0 offen offset:64
    buffer_load_dword v228, v3, s[16:19], 0 offen sc1
    v_lshlrev_b32 v3, 4, v2
    s_lshl_b32 s64, s7, 11
    v_add_u32 v4, s64, v3
    v_lshrrev_b32 v5, 4, v2
    v_lshlrev_b32 v5, 4, v5
    s_lshl_b32 s64, s7, 6
    v_add_u32 v5, s64, v5
    v_mov_b32 v6, 4256
    ds_read_b32 v6, v6
    v_cvt_pk_bf16_f32 v32, v64, v65
    v_lshlrev_b32 v48, 16, v32
    v_and_b32 v49, 0xffff0000, v32
    v_mul_f32 v50, s72, v48
    v_mul_f32 v51, s72, v49
    v_exp_f32 v50, v50 clamp
    v_exp_f32 v51, v51 clamp
    v_max_f32 v48, 0, v48
    v_max_f32 v49, 0, v49
    v_add_f32 v48, v48, v50
    v_add_f32 v49, v49, v51
    v_min_f32 v56, v48, v49
    v_cvt_pk_bf16_f32 v32, v48, v49
    v_cvt_pk_bf16_f32 v33, v66, v67
    v_lshlrev_b32 v48, 16, v33
    v_and_b32 v49, 0xffff0000, v33
    v_mul_f32 v50, s72, v48
    v_mul_f32 v51, s72, v49
    v_exp_f32 v50, v50 clamp
    v_exp_f32 v51, v51 clamp
    v_max_f32 v48, 0, v48
    v_max_f32 v49, 0, v49
    v_add_f32 v48, v48, v50
    v_add_f32 v49, v49, v51
    v_min3_f32 v56, v48, v49, v56
    v_cvt_pk_bf16_f32 v33, v48, v49
    v_cvt_pk_bf16_f32 v34, v68, v69
    v_lshlrev_b32 v48, 16, v34
    v_and_b32 v49, 0xffff0000, v34
    v_mul_f32 v50, s72, v48
    v_mul_f32 v51, s72, v49
    v_exp_f32 v50, v50 clamp
    v_exp_f32 v51, v51 clamp
    v_max_f32 v48, 0, v48
    v_max_f32 v49, 0, v49
    v_add_f32 v48, v48, v50
    v_add_f32 v49, v49, v51
    v_min3_f32 v56, v48, v49, v56
    v_cvt_pk_bf16_f32 v34, v48, v49
    v_cvt_pk_bf16_f32 v35, v70, v71
    v_lshlrev_b32 v48, 16, v35
    v_and_b32 v49, 0xffff0000, v35
    v_mul_f32 v50, s72, v48
    v_mul_f32 v51, s72, v49
    v_exp_f32 v50, v50 clamp
    v_exp_f32 v51, v51 clamp
    v_max_f32 v48, 0, v48
    v_max_f32 v49, 0, v49
    v_add_f32 v48, v48, v50
    v_add_f32 v49, v49, v51
    v_min3_f32 v56, v48, v49, v56
    v_cvt_pk_bf16_f32 v35, v48, v49
    v_cvt_pk_bf16_f32 v36, v72, v73
    v_lshlrev_b32 v48, 16, v36
    v_and_b32 v49, 0xffff0000, v36
    v_mul_f32 v50, s72, v48
    v_mul_f32 v51, s72, v49
    v_exp_f32 v50, v50 clamp
    v_exp_f32 v51, v51 clamp
    v_max_f32 v48, 0, v48
    v_max_f32 v49, 0, v49
    v_add_f32 v48, v48, v50
    v_add_f32 v49, v49, v51
    v_min3_f32 v56, v48, v49, v56
    v_cvt_pk_bf16_f32 v36, v48, v49
    v_cvt_pk_bf16_f32 v37, v74, v75
    v_lshlrev_b32 v48, 16, v37
    v_and_b32 v49, 0xffff0000, v37
    v_mul_f32 v50, s72, v48
    v_mul_f32 v51, s72, v49
    v_exp_f32 v50, v50 clamp
    v_exp_f32 v51, v51 clamp
    v_max_f32 v48, 0, v48
    v_max_f32 v49, 0, v49
    v_add_f32 v48, v48, v50
    v_add_f32 v49, v49, v51
    v_min3_f32 v56, v48, v49, v56
    v_cvt_pk_bf16_f32 v37, v48, v49
    v_cvt_pk_bf16_f32 v38, v76, v77
    v_lshlrev_b32 v48, 16, v38
    v_and_b32 v49, 0xffff0000, v38
    v_mul_f32 v50, s72, v48
    v_mul_f32 v51, s72, v49
    v_exp_f32 v50, v50 clamp
    v_exp_f32 v51, v51 clamp
    v_max_f32 v48, 0, v48
    v_max_f32 v49, 0, v49
    v_add_f32 v48, v48, v50
    v_add_f32 v49, v49, v51
    v_min3_f32 v56, v48, v49, v56
    v_cvt_pk_bf16_f32 v38, v48, v49
    v_cvt_pk_bf16_f32 v39, v78, v79
    v_lshlrev_b32 v48, 16, v39
    v_and_b32 v49, 0xffff0000, v39
    v_mul_f32 v50, s72, v48
    v_mul_f32 v51, s72, v49
    v_exp_f32 v50, v50 clamp
    v_exp_f32 v51, v51 clamp
    v_max_f32 v48, 0, v48
    v_max_f32 v49, 0, v49
    v_add_f32 v48, v48, v50
    v_add_f32 v49, v49, v51
    v_min3_f32 v56, v48, v49, v56
    v_cvt_pk_bf16_f32 v39, v48, v49
    v_cmp_gt_f32 vcc, 0x3a800000, v56
    s_cbranch_vccnz phi_18_fix
phi_18_done:
    v_cvt_pk_bf16_f32 v40, v80, v81
    v_lshlrev_b32 v48, 16, v40
    v_and_b32 v49, 0xffff0000, v40
    v_mul_f32 v50, s72, v48
    v_mul_f32 v51, s72, v49
    v_exp_f32 v50, v50 clamp
    v_exp_f32 v51, v51 clamp
    v_max_f32 v48, 0, v48
    v_max_f32 v49, 0, v49
    v_add_f32 v48, v48, v50
    v_add_f32 v49, v49, v51
    v_min_f32 v56, v48, v49
    v_cvt_pk_bf16_f32 v40, v48, v49
    v_cvt_pk_bf16_f32 v41, v82, v83
    v_lshlrev_b32 v48, 16, v41
    v_and_b32 v49, 0xffff0000, v41
    v_mul_f32 v50, s72, v48
    v_mul_f32 v51, s72, v49
    v_exp_f32 v50, v50 clamp
    v_exp_f32 v51, v51 clamp
    v_max_f32 v48, 0, v48
    v_max_f32 v49, 0, v49
    v_add_f32 v48, v48, v50
    v_add_f32 v49, v49, v51
    v_min3_f32 v56, v48, v49, v56
    v_cvt_pk_bf16_f32 v41, v48, v49
    v_cvt_pk_bf16_f32 v42, v84, v85
    v_lshlrev_b32 v48, 16, v42
    v_and_b32 v49, 0xffff0000, v42
    v_mul_f32 v50, s72, v48
    v_mul_f32 v51, s72, v49
    v_exp_f32 v50, v50 clamp
    v_exp_f32 v51, v51 clamp
    v_max_f32 v48, 0, v48
    v_max_f32 v49, 0, v49
    v_add_f32 v48, v48, v50
    v_add_f32 v49, v49, v51
    v_min3_f32 v56, v48, v49, v56
    v_cvt_pk_bf16_f32 v42, v48, v49
    v_cvt_pk_bf16_f32 v43, v86, v87
    v_lshlrev_b32 v48, 16, v43
    v_and_b32 v49, 0xffff0000, v43
    v_mul_f32 v50, s72, v48
    v_mul_f32 v51, s72, v49
    v_exp_f32 v50, v50 clamp
    v_exp_f32 v51, v51 clamp
    v_max_f32 v48, 0, v48
    v_max_f32 v49, 0, v49
    v_add_f32 v48, v48, v50
    v_add_f32 v49, v49, v51
    v_min3_f32 v56, v48, v49, v56
    v_cvt_pk_bf16_f32 v43, v48, v49
    v_cvt_pk_bf16_f32 v44, v88, v89
    v_lshlrev_b32 v48, 16, v44
    v_and_b32 v49, 0xffff0000, v44
    v_mul_f32 v50, s72, v48
    v_mul_f32 v51, s72, v49
    v_exp_f32 v50, v50 clamp
    v_exp_f32 v51, v51 clamp
    v_max_f32 v48, 0, v48
    v_max_f32 v49, 0, v49
    v_add_f32 v48, v48, v50
    v_add_f32 v49, v49, v51
    v_min3_f32 v56, v48, v49, v56
    v_cvt_pk_bf16_f32 v44, v48, v49
    v_cvt_pk_bf16_f32 v45, v90, v91
    v_lshlrev_b32 v48, 16, v45
    v_and_b32 v49, 0xffff0000, v45
    v_mul_f32 v50, s72, v48
    v_mul_f32 v51, s72, v49
    v_exp_f32 v50, v50 clamp
    v_exp_f32 v51, v51 clamp
    v_max_f32 v48, 0, v48
    v_max_f32 v49, 0, v49
    v_add_f32 v48, v48, v50
    v_add_f32 v49, v49, v51
    v_min3_f32 v56, v48, v49, v56
    v_cvt_pk_bf16_f32 v45, v48, v49
    v_cvt_pk_bf16_f32 v46, v92, v93
    v_lshlrev_b32 v48, 16, v46
    v_and_b32 v49, 0xffff0000, v46
    v_mul_f32 v50, s72, v48
    v_mul_f32 v51, s72, v49
    v_exp_f32 v50, v50 clamp
    v_exp_f32 v51, v51 clamp
    v_max_f32 v48, 0, v48
    v_max_f32 v49, 0, v49
    v_add_f32 v48, v48, v50
    v_add_f32 v49, v49, v51
    v_min3_f32 v56, v48, v49, v56
    v_cvt_pk_bf16_f32 v46, v48, v49
    v_cvt_pk_bf16_f32 v47, v94, v95
    v_lshlrev_b32 v48, 16, v47
    v_and_b32 v49, 0xffff0000, v47
    v_mul_f32 v50, s72, v48
    v_mul_f32 v51, s72, v49
    v_exp_f32 v50, v50 clamp
    v_exp_f32 v51, v51 clamp
    v_max_f32 v48, 0, v48
    v_max_f32 v49, 0, v49
    v_add_f32 v48, v48, v50
    v_add_f32 v49, v49, v51
    v_min3_f32 v56, v48, v49, v56
    v_cvt_pk_bf16_f32 v47, v48, v49
    v_cmp_gt_f32 vcc, 0x3a800000, v56
    s_cbranch_vccnz phi_19_fix
phi_19_done:
    s_waitcnt lgkmcnt(0)
    v_readfirstlane_b32 s75, v6
    s_waitcnt vmcnt(0)
    v_sub_f32 v248, 1.0, v228
    v_cvt_pk_bf16_f32 v248, v248, v248
    v_lshlrev_b32 v248, 16, v248
    v_lshlrev_b32 v232, 16, v220
    v_and_b32 v233, 0xffff0000, v220
    v_mul_f32 v232, v232, v248
    v_mul_f32 v233, v233, v248
    v_cvt_pk_bf16_f32 v3, v232, v233
    v_lshlrev_b32 v232, 16, v3
    v_and_b32 v233, 0xffff0000, v3
    v_lshlrev_b32 v234, 16, v221
    v_and_b32 v235, 0xffff0000, v221
    v_mul_f32 v234, v234, v248
    v_mul_f32 v235, v235, v248
    v_cvt_pk_bf16_f32 v3, v234, v235
    v_lshlrev_b32 v234, 16, v3
    v_and_b32 v235, 0xffff0000, v3
    v_lshlrev_b32 v236, 16, v222
    v_and_b32 v237, 0xffff0000, v222
    v_mul_f32 v236, v236, v248
    v_mul_f32 v237, v237, v248
    v_cvt_pk_bf16_f32 v3, v236, v237
    v_lshlrev_b32 v236, 16, v3
    v_and_b32 v237, 0xffff0000, v3
    v_lshlrev_b32 v238, 16, v223
    v_and_b32 v239, 0xffff0000, v223
    v_mul_f32 v238, v238, v248
    v_mul_f32 v239, v239, v248
    v_cvt_pk_bf16_f32 v3, v238, v239
    v_lshlrev_b32 v238, 16, v3
    v_and_b32 v239, 0xffff0000, v3
    v_lshlrev_b32 v240, 16, v224
    v_and_b32 v241, 0xffff0000, v224
    v_mul_f32 v240, v240, v248
    v_mul_f32 v241, v241, v248
    v_cvt_pk_bf16_f32 v3, v240, v241
    v_lshlrev_b32 v240, 16, v3
    v_and_b32 v241, 0xffff0000, v3
    v_lshlrev_b32 v242, 16, v225
    v_and_b32 v243, 0xffff0000, v225
    v_mul_f32 v242, v242, v248
    v_mul_f32 v243, v243, v248
    v_cvt_pk_bf16_f32 v3, v242, v243
    v_lshlrev_b32 v242, 16, v3
    v_and_b32 v243, 0xffff0000, v3
    v_lshlrev_b32 v244, 16, v226
    v_and_b32 v245, 0xffff0000, v226
    v_mul_f32 v244, v244, v248
    v_mul_f32 v245, v245, v248
    v_cvt_pk_bf16_f32 v3, v244, v245
    v_lshlrev_b32 v244, 16, v3
    v_and_b32 v245, 0xffff0000, v3
    v_lshlrev_b32 v246, 16, v227
    v_and_b32 v247, 0xffff0000, v227
    v_mul_f32 v246, v246, v248
    v_mul_f32 v247, v247, v248
    v_cvt_pk_bf16_f32 v3, v246, v247
    v_lshlrev_b32 v246, 16, v3
    v_and_b32 v247, 0xffff0000, v3
    s_cmp_lg_u32 s3, 0
    s_cbranch_scc1 C_nh
    s_mov_b32 s65, 0
    v_lshrrev_b32 v155, 4, v2
H_hl:
    v_max3_u32 v153, v156, v157, v158
    v_max3_u32 v153, v159, v160, v153
    v_max3_u32 v153, v161, v162, v153
    v_max3_u32 v153, v163, v164, v153
    v_max3_u32 v153, v165, v166, v153
    v_max3_u32 v153, v167, v168, v153
    v_max3_u32 v153, v169, v170, v153
    v_max3_u32 v153, v171, v172, v153
    v_max3_u32 v153, v173, v174, v153
    v_max3_u32 v153, v175, v176, v153
    v_max3_u32 v153, v177, v178, v153
    v_max3_u32 v153, v179, v180, v153
    v_max3_u32 v153, v181, v182, v153
    v_max3_u32 v153, v183, v184, v153
    v_max3_u32 v153, v185, v186, v153
    v_max3_u32 v153, v187, v188, v153
    v_max3_u32 v153, v189, v190, v153
    v_max3_u32 v153, v191, v192, v153
    v_max3_u32 v153, v193, v194, v153
    v_max3_u32 v153, v195, v196, v153
    v_max3_u32 v153, v197, v198, v153
    v_max3_u32 v153, v199, v200, v153
    v_max3_u32 v153, v201, v202, v153
    v_max3_u32 v153, v203, v204, v153
    v_max3_u32 v153, v205, v206, v153
    v_max3_u32 v153, v207, v208, v153
    v_max3_u32 v153, v209, v210, v153
    v_max3_u32 v153, v211, v212, v153
    v_max3_u32 v153, v213, v214, v153
    v_max3_u32 v153, v215, v216, v153
    v_max3_u32 v153, v217, v218, v153
    v_max_u32 v153, v219, v153
    s_mov_b32 exec_lo, 0x3fff3fff
    s_mov_b32 exec_hi, 0x3fff3fff
    v_cmp_eq_u32 vcc, -1, v153
    s_mov_b64 exec, -1
    s_cbranch_vccz H_hok
    s_add_u32 s65, s65, 1
    s_cmp_ge_u32 s65, 100000
    s_cbranch_scc1 H_hok
    s_sleep 8
    s_lshr_b32 s64, s2, 2
    s_lshl_b32 s64, s64, 14
    s_add_u32 s64, s64, 5398528
    v_lshl_add_u32 v152, v2, 4, s64
    s_mov_b32 s64, 0
    buffer_load_dwordx4 v[156:159], v152, s[16:19], s64 offen offset:0 sc1
    s_mov_b32 s64, 0
    buffer_load_dwordx4 v[160:163], v152, s[16:19], s64 offen offset:1024 sc1
    s_mov_b32 s64, 0
    buffer_load_dwordx4 v[164:167], v152, s[16:19], s64 offen offset:2048 sc1
    s_mov_b32 s64, 0
    buffer_load_dwordx4 v[168:171], v152, s[16:19], s64 offen offset:3072 sc1
    s_mov_b32 s64, 4096
    buffer_load_dwordx4 v[172:175], v152, s[16:19], s64 offen offset:0 sc1
    s_mov_b32 s64, 4096
    buffer_load_dwordx4 v[176:179], v152, s[16:19], s64 offen offset:1024 sc1
    s_mov_b32 s64, 4096
    buffer_load_dwordx4 v[180:183], v152, s[16:19], s64 offen offset:2048 sc1
    s_mov_b32 s64, 4096
    buffer_load_dwordx4 v[184:187], v152, s[16:19], s64 offen offset:3072 sc1
    s_mov_b32 s64, 8192
    buffer_load_dwordx4 v[188:191], v152, s[16:19], s64 offen offset:0 sc1
    s_mov_b32 s64, 8192
    buffer_load_dwordx4 v[192:195], v152, s[16:19], s64 offen offset:1024 sc1
    s_mov_b32 s64, 8192
    buffer_load_dwordx4 v[196:199], v152, s[16:19], s64 offen offset:2048 sc1
    s_mov_b32 s64, 8192
    buffer_load_dwordx4 v[200:203], v152, s[16:19], s64 offen offset:3072 sc1
    s_mov_b32 s64, 12288
    buffer_load_dwordx4 v[204:207], v152, s[16:19], s64 offen offset:0 sc1
    s_mov_b32 s64, 12288
    buffer_load_dwordx4 v[208:211], v152, s[16:19], s64 offen offset:1024 sc1
    s_mov_b32 s64, 12288
    buffer_load_dwordx4 v[212:215], v152, s[16:19], s64 offen offset:2048 sc1
    s_mov_b32 s64, 12288
    buffer_load_dwordx4 v[216:219], v152, s[16:19], s64 offen offset:3072 sc1
    s_waitcnt vmcnt(0)
    s_branch H_hl
H_hok:
    v_add_f32 v156, v156, v160
    v_add_f32 v157, v157, v161
    v_add_f32 v158, v158, v162
    v_add_f32 v159, v159, v163
    v_add_f32 v156, v156, v164
    v_add_f32 v157, v157, v165
    v_add_f32 v158, v158, v166
    v_add_f32 v159, v159, v167
    v_add_f32 v156, v156, v168
    v_add_f32 v157, v157, v169
    v_add_f32 v158, v158, v170
    v_add_f32 v159, v159, v171
    v_add_f32 v156, v156, v172
    v_add_f32 v157, v157, v173
    v_add_f32 v158, v158, v174
    v_add_f32 v159, v159, v175
    v_add_f32 v156, v156, v176
    v_add_f32 v157, v157, v177
    v_add_f32 v158, v158, v178
    v_add_f32 v159, v159, v179
    v_add_f32 v156, v156, v180
    v_add_f32 v157, v157, v181
    v_add_f32 v158, v158, v182
    v_add_f32 v159, v159, v183
    v_add_f32 v156, v156, v184
    v_add_f32 v157, v157, v185
    v_add_f32 v158, v158, v186
    v_add_f32 v159, v159, v187
    v_add_f32 v188, v188, v192
    v_add_f32 v189, v189, v193
    v_add_f32 v190, v190, v194
    v_add_f32 v191, v191, v195
    v_add_f32 v188, v188, v196
    v_add_f32 v189, v189, v197
    v_add_f32 v190, v190, v198
    v_add_f32 v191, v191, v199
    v_add_f32 v188, v188, v200
    v_add_f32 v189, v189, v201
    v_add_f32 v190, v190, v202
    v_add_f32 v191, v191, v203
    v_add_f32 v188, v188, v204
    v_add_f32 v189, v189, v205
    v_add_f32 v190, v190, v206
    v_add_f32 v191, v191, v207
    v_add_f32 v188, v188, v208
    v_add_f32 v189, v189, v209
    v_add_f32 v190, v190, v210
    v_add_f32 v191, v191, v211
    v_add_f32 v188, v188, v212
    v_add_f32 v189, v189, v213
    v_add_f32 v190, v190, v214
    v_add_f32 v191, v191, v215
    v_add_f32 v188, v188, v216
    v_add_f32 v189, v189, v217
    v_add_f32 v190, v190, v218
    v_add_f32 v191, v191, v219
    s_nop 1
    v_permlane16_swap_b32 v156, v188
    v_permlane16_swap_b32 v157, v189
    v_permlane16_swap_b32 v158, v190
    v_permlane16_swap_b32 v159, v191
    v_add_f32 v156, v156, v188
    v_add_f32 v157, v157, v189
    v_add_f32 v158, v158, v190
    v_add_f32 v159, v159, v191
    s_nop 1
    v_permlane32_swap_b32 v156, v158
    v_permlane32_swap_b32 v157, v159
    v_add_f32 v156, v156, v158
    v_add_f32 v157, v157, v159
    s_nop 1
    v_permlane16_swap_b32 v156, v157
    v_cvt_pk_bf16_f32 v158, v156, v157
    v_lshlrev_b32 v156, 16, v158
    v_and_b32 v157, 0xffff0000, v158
    v_mul_f32 v158, s72, v156
    v_exp_f32 v158, -v158
    v_and_b32 v154, 15, v2
    v_add_f32 v158, 1.0, v158
    v_rcp_f32 v158, v158
    v_lshl_add_u32 v154, v154, 2, v155
    v_mul_f32 v158, v158, v156
    v_cvt_pk_bf16_f32 v158, v158, v158
    v_lshlrev_b32 v158, 16, v158
    v_mul_f32 v158, v158, v157
    v_cvt_pk_bf16_f32 v158, v158, v158
    v_lshlrev_b32 v158, 16, v158
    v_lshlrev_b32 v154, 2, v154
    ds_write_b32 v154, v158 offset:4352
    s_waitcnt lgkmcnt(0)
C_nh:
    v_lshlrev_b32 v3, 4, v2
    s_barrier
    ds_read_b128 v[24:27], v5 offset:4096
    ds_read_b128 v[16:19], v4 offset:0
    ds_read_b128 v[20:23], v4 offset:1024
    s_waitcnt lgkmcnt(2)
    v_mfma_f32_16x16x32_bf16 v[96:99], v[24:27], v[32:35], 0
    v_mfma_f32_16x16x32_bf16 v[100:103], v[24:27], v[36:39], 0
    v_mfma_f32_16x16x32_bf16 v[104:107], v[24:27], v[40:43], 0
    v_mfma_f32_16x16x32_bf16 v[108:111], v[24:27], v[44:47], 0
    s_waitcnt lgkmcnt(0)
    v_mfma_f32_16x16x32_bf16 v[64:67], v[16:19], v[32:35], 0
    v_mfma_f32_16x16x32_bf16 v[68:71], v[20:23], v[32:35], 0
    v_mfma_f32_16x16x32_bf16 v[72:75], v[16:19], v[36:39], 0
    v_mfma_f32_16x16x32_bf16 v[76:79], v[20:23], v[36:39], 0
    v_mfma_f32_16x16x32_bf16 v[80:83], v[16:19], v[40:43], 0
    v_mfma_f32_16x16x32_bf16 v[84:87], v[20:23], v[40:43], 0
    v_mfma_f32_16x16x32_bf16 v[88:91], v[16:19], v[44:47], 0
    v_mfma_f32_16x16x32_bf16 v[92:95], v[20:23], v[44:47], 0
    v_cvt_pk_bf16_f32 v48, v96, v96
    v_cvt_pk_bf16_f32 v49, v100, v100
    v_cvt_pk_bf16_f32 v50, v104, v104
    v_cvt_pk_bf16_f32 v51, v108, v108
    v_lshlrev_b32 v48, 16, v48
    v_lshlrev_b32 v49, 16, v49
    v_lshlrev_b32 v50, 16, v50
    v_lshlrev_b32 v51, 16, v51
    v_add_f32 v48, s73, v48
    v_add_f32 v49, s73, v49
    v_add_f32 v50, s73, v50
    v_add_f32 v51, s73, v51
    v_cvt_pk_bf16_f32 v48, v48, v48
    v_cvt_pk_bf16_f32 v49, v49, v49
    v_cvt_pk_bf16_f32 v50, v50, v50
    v_cvt_pk_bf16_f32 v51, v51, v51
    v_lshlrev_b32 v48, 16, v48
    v_lshlrev_b32 v49, 16, v49
    v_lshlrev_b32 v50, 16, v50
    v_lshlrev_b32 v51, 16, v51
    v_rcp_f32 v48, v48
    v_rcp_f32 v49, v49
    v_rcp_f32 v50, v50
    v_rcp_f32 v51, v51
    s_nop 0
    v_mul_f32 v64, v64, v48
    v_mul_f32 v65, v65, v48
    v_cvt_pk_bf16_f32 v128, v64, v65
    v_mul_f32 v66, v66, v48
    v_mul_f32 v67, v67, v48
    v_cvt_pk_bf16_f32 v129, v66, v67
    v_mul_f32 v68, v68, v48
    v_mul_f32 v69, v69, v48
    v_cvt_pk_bf16_f32 v130, v68, v69
    v_mul_f32 v70, v70, v48
    v_mul_f32 v71, v71, v48
    v_cvt_pk_bf16_f32 v131, v70, v71
    buffer_store_dwordx4 v[128:131], v1, s[16:19], s42 offen offset:0 sc0 sc1
    v_mul_f32 v72, v72, v49
    v_mul_f32 v73, v73, v49
    v_cvt_pk_bf16_f32 v132, v72, v73
    v_mul_f32 v74, v74, v49
    v_mul_f32 v75, v75, v49
    v_cvt_pk_bf16_f32 v133, v74, v75
    v_mul_f32 v76, v76, v49
    v_mul_f32 v77, v77, v49
    v_cvt_pk_bf16_f32 v134, v76, v77
    v_mul_f32 v78, v78, v49
    v_mul_f32 v79, v79, v49
    v_cvt_pk_bf16_f32 v135, v78, v79
    buffer_store_dwordx4 v[132:135], v1, s[16:19], s42 offen offset:1024 sc0 sc1
    s_add_u32 s42, s42, 65536
    v_mul_f32 v80, v80, v50
    v_mul_f32 v81, v81, v50
    v_cvt_pk_bf16_f32 v136, v80, v81
    v_mul_f32 v82, v82, v50
    v_mul_f32 v83, v83, v50
    v_cvt_pk_bf16_f32 v137, v82, v83
    v_mul_f32 v84, v84, v50
    v_mul_f32 v85, v85, v50
    v_cvt_pk_bf16_f32 v138, v84, v85
    v_mul_f32 v86, v86, v50
    v_mul_f32 v87, v87, v50
    v_cvt_pk_bf16_f32 v139, v86, v87
    buffer_store_dwordx4 v[136:139], v1, s[16:19], s42 offen offset:0 sc0 sc1
    v_mul_f32 v88, v88, v51
    v_mul_f32 v89, v89, v51
    v_cvt_pk_bf16_f32 v140, v88, v89
    v_mul_f32 v90, v90, v51
    v_mul_f32 v91, v91, v51
    v_cvt_pk_bf16_f32 v141, v90, v91
    v_mul_f32 v92, v92, v51
    v_mul_f32 v93, v93, v51
    v_cvt_pk_bf16_f32 v142, v92, v93
    v_mul_f32 v94, v94, v51
    v_mul_f32 v95, v95, v51
    v_cvt_pk_bf16_f32 v143, v94, v95
    buffer_store_dwordx4 v[140:143], v1, s[16:19], s42 offen offset:1024 sc0 sc1
    s_lshl_b32 s64, s4, 3
    s_add_u32 s64, s64, s3
    s_lshl_b32 s64, s64, 7
    s_add_u32 s64, s64, 5382144
    v_mov_b32 v14, s64
    s_mov_b64 exec, 1
    v_mov_b32 v15, 0
    buffer_atomic_or v15, v14, s[16:19], 0 offen sc0
    s_mov_b64 exec, -1
P2_start:
    s_and_b32 s6, s3, 3
    s_lshr_b32 s7, s3, 2
    s_mov_b32 s20, s58
    s_mov_b32 s21, s59
    s_mov_b32 s22, 0x400000
    s_mov_b32 s23, 0x00020000
    s_and_b32 s67, s75, 0x7ff
    s_sub_u32 s67, 2047, s67
    s_lshl_b32 s64, s4, 2
    s_add_u32 s64, s64, s6
    s_lshl_b32 s64, s64, 16
    s_lshl_b32 s65, s7, 15
    s_add_u32 s64, s64, s65
    s_lshl_b32 s65, s7, 10
    s_add_u32 s66, s64, s65
    s_xor_b32 s64, s66, 1024
    v_lshlrev_b32 v12, 4, v2
    v_add_u32 v4, s66, v12
    v_add_u32 v12, s64, v12
    v_lshrrev_b32 v10, 4, v2
    v_bfe_u32 v11, v2, 2, 2
    v_lshl_add_u32 v10, v10, 2, v11
    v_bfe_u32 v13, v10, 1, 2
    v_lshlrev_b32 v10, 7, v10
    v_lshl_add_u32 v10, v13, 5, v10
    v_and_b32 v13, 3, v2
    v_lshl_add_u32 v5, v13, 3, v10
    v_xor_b32 v6, 32, v5
    v_xor_b32 v1, 64, v5
    v_xor_b32 v3, 96, v5
    s_and_b32 s74, s5, 7
    s_lshl_b32 s74, s74, 1
    s_cmp_eq_u32 s7, 0
    s_mov_b32 s64, 147456
    s_cselect_b32 s64, 131072, s64
    s_sub_u32 m0, 16, s74
    s_and_b32 m0, m0, 15
    v_writelane_b32 v7, s64, m0
    s_cmp_eq_u32 s7, 0
    s_mov_b32 s64, 155648
    s_cselect_b32 s64, 139264, s64
    s_sub_u32 m0, 18, s74
    s_and_b32 m0, m0, 15
    v_writelane_b32 v7, s64, m0
    s_cmp_eq_u32 s7, 0
    s_mov_b32 s64, 81920
    s_cselect_b32 s64, 73728, s64
    s_sub_u32 m0, 20, s74
    s_and_b32 m0, m0, 15
    v_writelane_b32 v7, s64, m0
    s_cmp_eq_u32 s7, 0
    s_mov_b32 s64, 122880
    s_cselect_b32 s64, 114688, s64
    s_sub_u32 m0, 22, s74
    s_and_b32 m0, m0, 15
    v_writelane_b32 v7, s64, m0
    s_cmp_eq_u32 s7, 0
    s_mov_b32 s64, 49152
    s_cselect_b32 s64, 40960, s64
    s_sub_u32 m0, 24, s74
    s_and_b32 m0, m0, 15
    v_writelane_b32 v7, s64, m0
    s_cmp_eq_u32 s7, 0
    s_mov_b32 s64, 57344
    s_cselect_b32 s64, 8192, s64
    s_sub_u32 m0, 26, s74
    s_and_b32 m0, m0, 15
    v_writelane_b32 v7, s64, m0
    s_cmp_eq_u32 s7, 0
    s_mov_b32 s64, 65536
    s_cselect_b32 s64, 16384, s64
    s_sub_u32 m0, 28, s74
    s_and_b32 m0, m0, 15
    v_writelane_b32 v7, s64, m0
    s_cmp_eq_u32 s7, 0
    s_mov_b32 s64, 90112
    s_cselect_b32 s64, 98304, s64
    s_sub_u32 m0, 30, s74
    s_and_b32 m0, m0, 15
    v_writelane_b32 v7, s64, m0
    s_cmp_eq_u32 s7, 0
    v_mov_b32 v16, 0
    v_mov_b32 v17, 0
    v_mov_b32 v18, 0
    v_mov_b32 v19, 0
    v_mov_b32 v20, 0
    v_mov_b32 v21, 0
    v_mov_b32 v22, 0
    v_mov_b32 v23, 0
    v_mov_b32 v24, 0
    v_mov_b32 v25, 0
    v_mov_b32 v26, 0
    v_mov_b32 v27, 0
    v_mov_b32 v28, 0
    v_mov_b32 v29, 0
    v_mov_b32 v30, 0
    v_mov_b32 v31, 0
    v_mov_b32 v32, 0
    v_mov_b32 v33, 0
    v_mov_b32 v34, 0
    v_mov_b32 v35, 0
    v_mov_b32 v36, 0
    v_mov_b32 v37, 0
    v_mov_b32 v38, 0
    v_mov_b32 v39, 0
    v_mov_b32 v40, 0
    v_mov_b32 v41, 0
    v_mov_b32 v42, 0
    v_mov_b32 v43, 0
    v_mov_b32 v44, 0
    v_mov_b32 v45, 0
    v_mov_b32 v46, 0
    v_mov_b32 v47, 0
    v_mov_b32 v209, 0
    v_mov_b32 v215, 0
    s_lshr_b32 s46, s67, 7
    s_xor_b32 s46, s46, s4
    s_or_b32 s46, s46, s7
    s_mov_b32 s47, 0
    s_cbranch_scc0 P2_ys
P2_ysd:
    s_mov_b32 s66, 0x5555
    s_mov_b32 s65, 0
    s_cmp_lt_u32 s3, 4
    s_cbranch_scc0 D_wait
    s_waitcnt vmcnt(1)
    s_mov_b64 exec, 3
    buffer_atomic_or v255, v254, s[16:19], 0 offen
    s_mov_b64 exec, -1
    s_waitcnt vmcnt(1)
    s_branch D_got
D_wait:
    s_waitcnt vmcnt(0)
D_got:
    v_readfirstlane_b32 s68, v15
    s_mul_i32 s68, s68, 0x10001
    s_lshr_b32 s68, s68, s74
    s_lshr_b32 s64, s68, 1
    s_and_b32 s68, s68, s64
    s_and_b32 s68, s68, s66
    s_cbranch_scc1 D_go
    s_add_u32 s65, s65, 1
    s_cmp_ge_u32 s65, 40000
    s_cbranch_scc1 D_end
    s_sleep 1
    s_mov_b64 exec, 1
    v_mov_b32 v15, 0
    buffer_atomic_or v15, v14, s[16:19], 0 offen sc0
    s_mov_b64 exec, -1
    s_branch D_wait
D_go:
    s_andn2_b32 s66, s66, s68
    s_bcnt1_i32_b32 s70, s68
    s_or_b32 s64, s46, s66
    s_cbranch_scc0 P2_yl
P2_nyl:
    s_cmp_gt_u32 s70, 4
    s_cbranch_scc1 D_t58
    s_cmp_gt_u32 s70, 2
    s_cbranch_scc1 D_t34
    s_cmp_eq_u32 s70, 2
    s_cbranch_scc1 D_e2
D_e1:
    s_ff1_i32_b32 s64, s68
    s_bitset0_b32 s68, s64
    v_readlane_b32 s32, v7, s64
    s_add_u32 s69, s64, s74
    s_and_b32 s69, s69, 15
    s_lshl_b32 s69, s69, 11
    buffer_load_dwordx4 v[80:83], v4, s[16:19], s69 offen sc1
    buffer_load_dwordx4 v[84:87], v12, s[16:19], s69 offen sc1
    s_add_u32 s69, s69, 2048
    buffer_load_dwordx4 v[88:91], v4, s[16:19], s69 offen sc1
    buffer_load_dwordx4 v[92:95], v12, s[16:19], s69 offen sc1
    s_mov_b64 exec, 1
    v_mov_b32 v15, 0
    buffer_atomic_or v15, v14, s[16:19], 0 offen sc0
    s_mov_b64 exec, -1
    v_add_u32 v8, s32, v5
    ds_read_b64_tr_b16 v[48:49], v8 offset:0
    ds_read_b64_tr_b16 v[50:51], v8 offset:2048
    v_add_u32 v9, s32, v6
    ds_read_b64_tr_b16 v[52:53], v9 offset:0
    ds_read_b64_tr_b16 v[54:55], v9 offset:2048
    v_add_u32 v10, s32, v1
    ds_read_b64_tr_b16 v[56:57], v10 offset:0
    ds_read_b64_tr_b16 v[58:59], v10 offset:2048
    v_add_u32 v11, s32, v3
    ds_read_b64_tr_b16 v[60:61], v11 offset:0
    ds_read_b64_tr_b16 v[62:63], v11 offset:2048
    s_branch D_p0
D_e2:
    s_ff1_i32_b32 s64, s68
    s_bitset0_b32 s68, s64
    v_readlane_b32 s33, v7, s64
    s_add_u32 s69, s64, s74
    s_and_b32 s69, s69, 15
    s_lshl_b32 s69, s69, 11
    buffer_load_dwordx4 v[96:99], v4, s[16:19], s69 offen sc1
    buffer_load_dwordx4 v[100:103], v12, s[16:19], s69 offen sc1
    s_add_u32 s69, s69, 2048
    buffer_load_dwordx4 v[104:107], v4, s[16:19], s69 offen sc1
    buffer_load_dwordx4 v[108:111], v12, s[16:19], s69 offen sc1
    s_ff1_i32_b32 s64, s68
    s_bitset0_b32 s68, s64
    v_readlane_b32 s32, v7, s64
    s_add_u32 s69, s64, s74
    s_and_b32 s69, s69, 15
    s_lshl_b32 s69, s69, 11
    buffer_load_dwordx4 v[80:83], v4, s[16:19], s69 offen sc1
    buffer_load_dwordx4 v[84:87], v12, s[16:19], s69 offen sc1
    s_add_u32 s69, s69, 2048
    buffer_load_dwordx4 v[88:91], v4, s[16:19], s69 offen sc1
    buffer_load_dwordx4 v[92:95], v12, s[16:19], s69 offen sc1
    s_mov_b64 exec, 1
    v_mov_b32 v15, 0
    buffer_atomic_or v15, v14, s[16:19], 0 offen sc0
    s_mov_b64 exec, -1
    v_add_u32 v8, s33, v5
    ds_read_b64_tr_b16 v[48:49], v8 offset:0
    ds_read_b64_tr_b16 v[50:51], v8 offset:2048
    v_add_u32 v9, s33, v6
    ds_read_b64_tr_b16 v[52:53], v9 offset:0
    ds_read_b64_tr_b16 v[54:55], v9 offset:2048
    v_add_u32 v10, s33, v1
    ds_read_b64_tr_b16 v[56:57], v10 offset:0
    ds_read_b64_tr_b16 v[58:59], v10 offset:2048
    v_add_u32 v11, s33, v3
    ds_read_b64_tr_b16 v[60:61], v11 offset:0
    ds_read_b64_tr_b16 v[62:63], v11 offset:2048
    s_branch D_p1
D_t34:
    s_cmp_eq_u32 s70, 4
    s_cbranch_scc1 D_e4
D_e3:
    s_ff1_i32_b32 s64, s68
    s_bitset0_b32 s68, s64
    v_readlane_b32 s34, v7, s64
    s_add_u32 s69, s64, s74
    s_and_b32 s69, s69, 15
    s_lshl_b32 s69, s69, 11
    buffer_load_dwordx4 v[112:115], v4, s[16:19], s69 offen sc1
    buffer_load_dwordx4 v[116:119], v12, s[16:19], s69 offen sc1
    s_add_u32 s69, s69, 2048
    buffer_load_dwordx4 v[120:123], v4, s[16:19], s69 offen sc1
    buffer_load_dwordx4 v[124:127], v12, s[16:19], s69 offen sc1
    s_ff1_i32_b32 s64, s68
    s_bitset0_b32 s68, s64
    v_readlane_b32 s33, v7, s64
    s_add_u32 s69, s64, s74
    s_and_b32 s69, s69, 15
    s_lshl_b32 s69, s69, 11
    buffer_load_dwordx4 v[96:99], v4, s[16:19], s69 offen sc1
    buffer_load_dwordx4 v[100:103], v12, s[16:19], s69 offen sc1
    s_add_u32 s69, s69, 2048
    buffer_load_dwordx4 v[104:107], v4, s[16:19], s69 offen sc1
    buffer_load_dwordx4 v[108:111], v12, s[16:19], s69 offen sc1
    v_add_u32 v8, s34, v5
    ds_read_b64_tr_b16 v[48:49], v8 offset:0
    ds_read_b64_tr_b16 v[50:51], v8 offset:2048
    v_add_u32 v9, s34, v6
    ds_read_b64_tr_b16 v[52:53], v9 offset:0
    ds_read_b64_tr_b16 v[54:55], v9 offset:2048
    v_add_u32 v10, s34, v1
    ds_read_b64_tr_b16 v[56:57], v10 offset:0
    ds_read_b64_tr_b16 v[58:59], v10 offset:2048
    v_add_u32 v11, s34, v3
    ds_read_b64_tr_b16 v[60:61], v11 offset:0
    ds_read_b64_tr_b16 v[62:63], v11 offset:2048
    s_branch D_p2
D_e4:
    s_ff1_i32_b32 s64, s68
    s_bitset0_b32 s68, s64
    v_readlane_b32 s35, v7, s64
    s_add_u32 s69, s64, s74
    s_and_b32 s69, s69, 15
    s_lshl_b32 s69, s69, 11
    buffer_load_dwordx4 v[128:131], v4, s[16:19], s69 offen sc1
    buffer_load_dwordx4 v[132:135], v12, s[16:19], s69 offen sc1
    s_add_u32 s69, s69, 2048
    buffer_load_dwordx4 v[136:139], v4, s[16:19], s69 offen sc1
    buffer_load_dwordx4 v[140:143], v12, s[16:19], s69 offen sc1
    s_ff1_i32_b32 s64, s68
    s_bitset0_b32 s68, s64
    v_readlane_b32 s34, v7, s64
    s_add_u32 s69, s64, s74
    s_and_b32 s69, s69, 15
    s_lshl_b32 s69, s69, 11
    buffer_load_dwordx4 v[112:115], v4, s[16:19], s69 offen sc1
    buffer_load_dwordx4 v[116:119], v12, s[16:19], s69 offen sc1
    s_add_u32 s69, s69, 2048
    buffer_load_dwordx4 v[120:123], v4, s[16:19], s69 offen sc1
    buffer_load_dwordx4 v[124:127], v12, s[16:19], s69 offen sc1
    v_add_u32 v8, s35, v5
    ds_read_b64_tr_b16 v[48:49], v8 offset:0
    ds_read_b64_tr_b16 v[50:51], v8 offset:2048
    v_add_u32 v9, s35, v6
    ds_read_b64_tr_b16 v[52:53], v9 offset:0
    ds_read_b64_tr_b16 v[54:55], v9 offset:2048
    v_add_u32 v10, s35, v1
    ds_read_b64_tr_b16 v[56:57], v10 offset:0
    ds_read_b64_tr_b16 v[58:59], v10 offset:2048
    v_add_u32 v11, s35, v3
    ds_read_b64_tr_b16 v[60:61], v11 offset:0
    ds_read_b64_tr_b16 v[62:63], v11 offset:2048
    s_branch D_p3
D_t58:
    s_cmp_gt_u32 s70, 6
    s_cbranch_scc1 D_t78
    s_cmp_eq_u32 s70, 6
    s_cbranch_scc1 D_e6
D_e5:
    s_ff1_i32_b32 s64, s68
    s_bitset0_b32 s68, s64
    v_readlane_b32 s36, v7, s64
    s_add_u32 s69, s64, s74
    s_and_b32 s69, s69, 15
    s_lshl_b32 s69, s69, 11
    buffer_load_dwordx4 v[144:147], v4, s[16:19], s69 offen sc1
    buffer_load_dwordx4 v[148:151], v12, s[16:19], s69 offen sc1
    s_add_u32 s69, s69, 2048
    buffer_load_dwordx4 v[152:155], v4, s[16:19], s69 offen sc1
    buffer_load_dwordx4 v[156:159], v12, s[16:19], s69 offen sc1
    s_ff1_i32_b32 s64, s68
    s_bitset0_b32 s68, s64
    v_readlane_b32 s35, v7, s64
    s_add_u32 s69, s64, s74
    s_and_b32 s69, s69, 15
    s_lshl_b32 s69, s69, 11
    buffer_load_dwordx4 v[128:131], v4, s[16:19], s69 offen sc1
    buffer_load_dwordx4 v[132:135], v12, s[16:19], s69 offen sc1
    s_add_u32 s69, s69, 2048
    buffer_load_dwordx4 v[136:139], v4, s[16:19], s69 offen sc1
    buffer_load_dwordx4 v[140:143], v12, s[16:19], s69 offen sc1
    v_add_u32 v8, s36, v5
    ds_read_b64_tr_b16 v[48:49], v8 offset:0
    ds_read_b64_tr_b16 v[50:51], v8 offset:2048
    v_add_u32 v9, s36, v6
    ds_read_b64_tr_b16 v[52:53], v9 offset:0
    ds_read_b64_tr_b16 v[54:55], v9 offset:2048
    v_add_u32 v10, s36, v1
    ds_read_b64_tr_b16 v[56:57], v10 offset:0
    ds_read_b64_tr_b16 v[58:59], v10 offset:2048
    v_add_u32 v11, s36, v3
    ds_read_b64_tr_b16 v[60:61], v11 offset:0
    ds_read_b64_tr_b16 v[62:63], v11 offset:2048
    s_branch D_p4
D_e6:
    s_ff1_i32_b32 s64, s68
    s_bitset0_b32 s68, s64
    v_readlane_b32 s37, v7, s64
    s_add_u32 s69, s64, s74
    s_and_b32 s69, s69, 15
    s_lshl_b32 s69, s69, 11
    buffer_load_dwordx4 v[160:163], v4, s[16:19], s69 offen sc1
    buffer_load_dwordx4 v[164:167], v12, s[16:19], s69 offen sc1
    s_add_u32 s69, s69, 2048
    buffer_load_dwordx4 v[168:171], v4, s[16:19], s69 offen sc1
    buffer_load_dwordx4 v[172:175], v12, s[16:19], s69 offen sc1
    s_ff1_i32_b32 s64, s68
    s_bitset0_b32 s68, s64
    v_readlane_b32 s36, v7, s64
    s_add_u32 s69, s64, s74
    s_and_b32 s69, s69, 15
    s_lshl_b32 s69, s69, 11
    buffer_load_dwordx4 v[144:147], v4, s[16:19], s69 offen sc1
    buffer_load_dwordx4 v[148:151], v12, s[16:19], s69 offen sc1
    s_add_u32 s69, s69, 2048
    buffer_load_dwordx4 v[152:155], v4, s[16:19], s69 offen sc1
    buffer_load_dwordx4 v[156:159], v12, s[16:19], s69 offen sc1
    v_add_u32 v8, s37, v5
    ds_read_b64_tr_b16 v[48:49], v8 offset:0
    ds_read_b64_tr_b16 v[50:51], v8 offset:2048
    v_add_u32 v9, s37, v6
    ds_read_b64_tr_b16 v[52:53], v9 offset:0
    ds_read_b64_tr_b16 v[54:55], v9 offset:2048
    v_add_u32 v10, s37, v1
    ds_read_b64_tr_b16 v[56:57], v10 offset:0
    ds_read_b64_tr_b16 v[58:59], v10 offset:2048
    v_add_u32 v11, s37, v3
    ds_read_b64_tr_b16 v[60:61], v11 offset:0
    ds_read_b64_tr_b16 v[62:63], v11 offset:2048
    s_branch D_p5
D_t78:
    s_cmp_eq_u32 s70, 8
    s_cbranch_scc1 D_e8
D_e7:
    s_ff1_i32_b32 s64, s68
    s_bitset0_b32 s68, s64
    v_readlane_b32 s38, v7, s64
    s_add_u32 s69, s64, s74
    s_and_b32 s69, s69, 15
    s_lshl_b32 s69, s69, 11
    buffer_load_dwordx4 v[176:179], v4, s[16:19], s69 offen sc1
    buffer_load_dwordx4 v[180:183], v12, s[16:19], s69 offen sc1
    s_add_u32 s69, s69, 2048
    buffer_load_dwordx4 v[184:187], v4, s[16:19], s69 offen sc1
    buffer_load_dwordx4 v[188:191], v12, s[16:19], s69 offen sc1
    s_ff1_i32_b32 s64, s68
    s_bitset0_b32 s68, s64
    v_readlane_b32 s37, v7, s64
    s_add_u32 s69, s64, s74
    s_and_b32 s69, s69, 15
    s_lshl_b32 s69, s69, 11
    buffer_load_dwordx4 v[160:163], v4, s[16:19], s69 offen sc1
    buffer_load_dwordx4 v[164:167], v12, s[16:19], s69 offen sc1
    s_add_u32 s69, s69, 2048
    buffer_load_dwordx4 v[168:171], v4, s[16:19], s69 offen sc1
    buffer_load_dwordx4 v[172:175], v12, s[16:19], s69 offen sc1
    v_add_u32 v8, s38, v5
    ds_read_b64_tr_b16 v[48:49], v8 offset:0
    ds_read_b64_tr_b16 v[50:51], v8 offset:2048
    v_add_u32 v9, s38, v6
    ds_read_b64_tr_b16 v[52:53], v9 offset:0
    ds_read_b64_tr_b16 v[54:55], v9 offset:2048
    v_add_u32 v10, s38, v1
    ds_read_b64_tr_b16 v[56:57], v10 offset:0
    ds_read_b64_tr_b16 v[58:59], v10 offset:2048
    v_add_u32 v11, s38, v3
    ds_read_b64_tr_b16 v[60:61], v11 offset:0
    ds_read_b64_tr_b16 v[62:63], v11 offset:2048
    s_branch D_p6
D_e8:
    s_ff1_i32_b32 s64, s68
    s_bitset0_b32 s68, s64
    v_readlane_b32 s39, v7, s64
    s_add_u32 s69, s64, s74
    s_and_b32 s69, s69, 15
    s_lshl_b32 s69, s69, 11
    buffer_load_dwordx4 v[192:195], v4, s[16:19], s69 offen sc1
    buffer_load_dwordx4 v[196:199], v12, s[16:19], s69 offen sc1
    s_add_u32 s69, s69, 2048
    buffer_load_dwordx4 v[200:203], v4, s[16:19], s69 offen sc1
    buffer_load_dwordx4 v[204:207], v12, s[16:19], s69 offen sc1
    s_ff1_i32_b32 s64, s68
    s_bitset0_b32 s68, s64
    v_readlane_b32 s38, v7, s64
    s_add_u32 s69, s64, s74
    s_and_b32 s69, s69, 15
    s_lshl_b32 s69, s69, 11
    buffer_load_dwordx4 v[176:179], v4, s[16:19], s69 offen sc1
    buffer_load_dwordx4 v[180:183], v12, s[16:19], s69 offen sc1
    s_add_u32 s69, s69, 2048
    buffer_load_dwordx4 v[184:187], v4, s[16:19], s69 offen sc1
    buffer_load_dwordx4 v[188:191], v12, s[16:19], s69 offen sc1
    v_add_u32 v8, s39, v5
    ds_read_b64_tr_b16 v[48:49], v8 offset:0
    ds_read_b64_tr_b16 v[50:51], v8 offset:2048
    v_add_u32 v9, s39, v6
    ds_read_b64_tr_b16 v[52:53], v9 offset:0
    ds_read_b64_tr_b16 v[54:55], v9 offset:2048
    v_add_u32 v10, s39, v1
    ds_read_b64_tr_b16 v[56:57], v10 offset:0
    ds_read_b64_tr_b16 v[58:59], v10 offset:2048
    v_add_u32 v11, s39, v3
    ds_read_b64_tr_b16 v[60:61], v11 offset:0
    ds_read_b64_tr_b16 v[62:63], v11 offset:2048
D_p7:
    s_waitcnt vmcnt(4) lgkmcnt(0)
    v_mfma_f32_16x16x32_bf16 v[16:19], v[48:51], v[192:195], v[16:19]
    ds_read_b64_tr_b16 v[64:65], v8 offset:4096
    ds_read_b64_tr_b16 v[66:67], v8 offset:6144
    v_mfma_f32_16x16x32_bf16 v[32:35], v[48:51], v[196:199], v[32:35]
    ds_read_b64_tr_b16 v[68:69], v9 offset:4096
    ds_read_b64_tr_b16 v[70:71], v9 offset:6144
    v_mfma_f32_16x16x32_bf16 v[20:23], v[52:55], v[192:195], v[20:23]
    ds_read_b64_tr_b16 v[72:73], v10 offset:4096
    ds_read_b64_tr_b16 v[74:75], v10 offset:6144
    v_mfma_f32_16x16x32_bf16 v[36:39], v[52:55], v[196:199], v[36:39]
    ds_read_b64_tr_b16 v[76:77], v11 offset:4096
    ds_read_b64_tr_b16 v[78:79], v11 offset:6144
    s_ff1_i32_b32 s64, s68
    s_bitset0_b32 s68, s64
    v_readlane_b32 s37, v7, s64
    s_add_u32 s69, s64, s74
    s_and_b32 s69, s69, 15
    s_lshl_b32 s69, s69, 11
    buffer_load_dwordx4 v[160:163], v4, s[16:19], s69 offen sc1
    v_mfma_f32_16x16x32_bf16 v[24:27], v[56:59], v[192:195], v[24:27]
    v_mfma_f32_16x16x32_bf16 v[40:43], v[56:59], v[196:199], v[40:43]
    v_mfma_f32_16x16x32_bf16 v[28:31], v[60:63], v[192:195], v[28:31]
    buffer_load_dwordx4 v[164:167], v12, s[16:19], s69 offen sc1
    v_mfma_f32_16x16x32_bf16 v[44:47], v[60:63], v[196:199], v[44:47]
    s_waitcnt lgkmcnt(0)
    v_mfma_f32_16x16x32_bf16 v[16:19], v[64:67], v[200:203], v[16:19]
    v_add_u32 v8, s38, v5
    ds_read_b64_tr_b16 v[48:49], v8 offset:0
    v_mfma_f32_16x16x32_bf16 v[32:35], v[64:67], v[204:207], v[32:35]
    ds_read_b64_tr_b16 v[50:51], v8 offset:2048
    v_add_u32 v9, s38, v6
    v_mfma_f32_16x16x32_bf16 v[20:23], v[68:71], v[200:203], v[20:23]
    ds_read_b64_tr_b16 v[52:53], v9 offset:0
    ds_read_b64_tr_b16 v[54:55], v9 offset:2048
    v_mfma_f32_16x16x32_bf16 v[36:39], v[68:71], v[204:207], v[36:39]
    v_add_u32 v10, s38, v1
    ds_read_b64_tr_b16 v[56:57], v10 offset:0
    s_add_u32 s69, s69, 2048
    buffer_load_dwordx4 v[168:171], v4, s[16:19], s69 offen sc1
    v_mfma_f32_16x16x32_bf16 v[24:27], v[72:75], v[200:203], v[24:27]
    ds_read_b64_tr_b16 v[58:59], v10 offset:2048
    v_add_u32 v11, s38, v3
    v_mfma_f32_16x16x32_bf16 v[40:43], v[72:75], v[204:207], v[40:43]
    ds_read_b64_tr_b16 v[60:61], v11 offset:0
    ds_read_b64_tr_b16 v[62:63], v11 offset:2048
    v_mfma_f32_16x16x32_bf16 v[28:31], v[76:79], v[200:203], v[28:31]
    buffer_load_dwordx4 v[172:175], v12, s[16:19], s69 offen sc1
    v_mfma_f32_16x16x32_bf16 v[44:47], v[76:79], v[204:207], v[44:47]
D_p6:
    s_waitcnt vmcnt(4) lgkmcnt(0)
    v_mfma_f32_16x16x32_bf16 v[16:19], v[48:51], v[176:179], v[16:19]
    ds_read_b64_tr_b16 v[64:65], v8 offset:4096
    ds_read_b64_tr_b16 v[66:67], v8 offset:6144
    v_mfma_f32_16x16x32_bf16 v[32:35], v[48:51], v[180:183], v[32:35]
    ds_read_b64_tr_b16 v[68:69], v9 offset:4096
    ds_read_b64_tr_b16 v[70:71], v9 offset:6144
    v_mfma_f32_16x16x32_bf16 v[20:23], v[52:55], v[176:179], v[20:23]
    ds_read_b64_tr_b16 v[72:73], v10 offset:4096
    ds_read_b64_tr_b16 v[74:75], v10 offset:6144
    v_mfma_f32_16x16x32_bf16 v[36:39], v[52:55], v[180:183], v[36:39]
    ds_read_b64_tr_b16 v[76:77], v11 offset:4096
    ds_read_b64_tr_b16 v[78:79], v11 offset:6144
    s_ff1_i32_b32 s64, s68
    s_bitset0_b32 s68, s64
    v_readlane_b32 s36, v7, s64
    s_add_u32 s69, s64, s74
    s_and_b32 s69, s69, 15
    s_lshl_b32 s69, s69, 11
    buffer_load_dwordx4 v[144:147], v4, s[16:19], s69 offen sc1
    v_mfma_f32_16x16x32_bf16 v[24:27], v[56:59], v[176:179], v[24:27]
    v_mfma_f32_16x16x32_bf16 v[40:43], v[56:59], v[180:183], v[40:43]
    v_mfma_f32_16x16x32_bf16 v[28:31], v[60:63], v[176:179], v[28:31]
    buffer_load_dwordx4 v[148:151], v12, s[16:19], s69 offen sc1
    v_mfma_f32_16x16x32_bf16 v[44:47], v[60:63], v[180:183], v[44:47]
    s_waitcnt lgkmcnt(0)
    v_mfma_f32_16x16x32_bf16 v[16:19], v[64:67], v[184:187], v[16:19]
    v_add_u32 v8, s37, v5
    ds_read_b64_tr_b16 v[48:49], v8 offset:0
    v_mfma_f32_16x16x32_bf16 v[32:35], v[64:67], v[188:191], v[32:35]
    ds_read_b64_tr_b16 v[50:51], v8 offset:2048
    v_add_u32 v9, s37, v6
    v_mfma_f32_16x16x32_bf16 v[20:23], v[68:71], v[184:187], v[20:23]
    ds_read_b64_tr_b16 v[52:53], v9 offset:0
    ds_read_b64_tr_b16 v[54:55], v9 offset:2048
    v_mfma_f32_16x16x32_bf16 v[36:39], v[68:71], v[188:191], v[36:39]
    v_add_u32 v10, s37, v1
    ds_read_b64_tr_b16 v[56:57], v10 offset:0
    s_add_u32 s69, s69, 2048
    buffer_load_dwordx4 v[152:155], v4, s[16:19], s69 offen sc1
    v_mfma_f32_16x16x32_bf16 v[24:27], v[72:75], v[184:187], v[24:27]
    ds_read_b64_tr_b16 v[58:59], v10 offset:2048
    v_add_u32 v11, s37, v3
    v_mfma_f32_16x16x32_bf16 v[40:43], v[72:75], v[188:191], v[40:43]
    ds_read_b64_tr_b16 v[60:61], v11 offset:0
    ds_read_b64_tr_b16 v[62:63], v11 offset:2048
    v_mfma_f32_16x16x32_bf16 v[28:31], v[76:79], v[184:187], v[28:31]
    buffer_load_dwordx4 v[156:159], v12, s[16:19], s69 offen sc1
    v_mfma_f32_16x16x32_bf16 v[44:47], v[76:79], v[188:191], v[44:47]
D_p5:
    s_waitcnt vmcnt(4) lgkmcnt(0)
    v_mfma_f32_16x16x32_bf16 v[16:19], v[48:51], v[160:163], v[16:19]
    ds_read_b64_tr_b16 v[64:65], v8 offset:4096
    ds_read_b64_tr_b16 v[66:67], v8 offset:6144
    v_mfma_f32_16x16x32_bf16 v[32:35], v[48:51], v[164:167], v[32:35]
    ds_read_b64_tr_b16 v[68:69], v9 offset:4096
    ds_read_b64_tr_b16 v[70:71], v9 offset:6144
    v_mfma_f32_16x16x32_bf16 v[20:23], v[52:55], v[160:163], v[20:23]
    ds_read_b64_tr_b16 v[72:73], v10 offset:4096
    ds_read_b64_tr_b16 v[74:75], v10 offset:6144
    v_mfma_f32_16x16x32_bf16 v[36:39], v[52:55], v[164:167], v[36:39]
    ds_read_b64_tr_b16 v[76:77], v11 offset:4096
    ds_read_b64_tr_b16 v[78:79], v11 offset:6144
    s_ff1_i32_b32 s64, s68
    s_bitset0_b32 s68, s64
    v_readlane_b32 s35, v7, s64
    s_add_u32 s69, s64, s74
    s_and_b32 s69, s69, 15
    s_lshl_b32 s69, s69, 11
    buffer_load_dwordx4 v[128:131], v4, s[16:19], s69 offen sc1
    v_mfma_f32_16x16x32_bf16 v[24:27], v[56:59], v[160:163], v[24:27]
    v_mfma_f32_16x16x32_bf16 v[40:43], v[56:59], v[164:167], v[40:43]
    v_mfma_f32_16x16x32_bf16 v[28:31], v[60:63], v[160:163], v[28:31]
    buffer_load_dwordx4 v[132:135], v12, s[16:19], s69 offen sc1
    v_mfma_f32_16x16x32_bf16 v[44:47], v[60:63], v[164:167], v[44:47]
    s_waitcnt lgkmcnt(0)
    v_mfma_f32_16x16x32_bf16 v[16:19], v[64:67], v[168:171], v[16:19]
    v_add_u32 v8, s36, v5
    ds_read_b64_tr_b16 v[48:49], v8 offset:0
    v_mfma_f32_16x16x32_bf16 v[32:35], v[64:67], v[172:175], v[32:35]
    ds_read_b64_tr_b16 v[50:51], v8 offset:2048
    v_add_u32 v9, s36, v6
    v_mfma_f32_16x16x32_bf16 v[20:23], v[68:71], v[168:171], v[20:23]
    ds_read_b64_tr_b16 v[52:53], v9 offset:0
    ds_read_b64_tr_b16 v[54:55], v9 offset:2048
    v_mfma_f32_16x16x32_bf16 v[36:39], v[68:71], v[172:175], v[36:39]
    v_add_u32 v10, s36, v1
    ds_read_b64_tr_b16 v[56:57], v10 offset:0
    s_add_u32 s69, s69, 2048
    buffer_load_dwordx4 v[136:139], v4, s[16:19], s69 offen sc1
    v_mfma_f32_16x16x32_bf16 v[24:27], v[72:75], v[168:171], v[24:27]
    ds_read_b64_tr_b16 v[58:59], v10 offset:2048
    v_add_u32 v11, s36, v3
    v_mfma_f32_16x16x32_bf16 v[40:43], v[72:75], v[172:175], v[40:43]
    ds_read_b64_tr_b16 v[60:61], v11 offset:0
    ds_read_b64_tr_b16 v[62:63], v11 offset:2048
    v_mfma_f32_16x16x32_bf16 v[28:31], v[76:79], v[168:171], v[28:31]
    buffer_load_dwordx4 v[140:143], v12, s[16:19], s69 offen sc1
    v_mfma_f32_16x16x32_bf16 v[44:47], v[76:79], v[172:175], v[44:47]
D_p4:
    s_waitcnt vmcnt(4) lgkmcnt(0)
    v_mfma_f32_16x16x32_bf16 v[16:19], v[48:51], v[144:147], v[16:19]
    ds_read_b64_tr_b16 v[64:65], v8 offset:4096
    ds_read_b64_tr_b16 v[66:67], v8 offset:6144
    v_mfma_f32_16x16x32_bf16 v[32:35], v[48:51], v[148:151], v[32:35]
    ds_read_b64_tr_b16 v[68:69], v9 offset:4096
    ds_read_b64_tr_b16 v[70:71], v9 offset:6144
    v_mfma_f32_16x16x32_bf16 v[20:23], v[52:55], v[144:147], v[20:23]
    ds_read_b64_tr_b16 v[72:73], v10 offset:4096
    ds_read_b64_tr_b16 v[74:75], v10 offset:6144
    v_mfma_f32_16x16x32_bf16 v[36:39], v[52:55], v[148:151], v[36:39]
    ds_read_b64_tr_b16 v[76:77], v11 offset:4096
    ds_read_b64_tr_b16 v[78:79], v11 offset:6144
    s_ff1_i32_b32 s64, s68
    s_bitset0_b32 s68, s64
    v_readlane_b32 s34, v7, s64
    s_add_u32 s69, s64, s74
    s_and_b32 s69, s69, 15
    s_lshl_b32 s69, s69, 11
    buffer_load_dwordx4 v[112:115], v4, s[16:19], s69 offen sc1
    v_mfma_f32_16x16x32_bf16 v[24:27], v[56:59], v[144:147], v[24:27]
    v_mfma_f32_16x16x32_bf16 v[40:43], v[56:59], v[148:151], v[40:43]
    v_mfma_f32_16x16x32_bf16 v[28:31], v[60:63], v[144:147], v[28:31]
    buffer_load_dwordx4 v[116:119], v12, s[16:19], s69 offen sc1
    v_mfma_f32_16x16x32_bf16 v[44:47], v[60:63], v[148:151], v[44:47]
    s_waitcnt lgkmcnt(0)
    v_mfma_f32_16x16x32_bf16 v[16:19], v[64:67], v[152:155], v[16:19]
    v_add_u32 v8, s35, v5
    ds_read_b64_tr_b16 v[48:49], v8 offset:0
    v_mfma_f32_16x16x32_bf16 v[32:35], v[64:67], v[156:159], v[32:35]
    ds_read_b64_tr_b16 v[50:51], v8 offset:2048
    v_add_u32 v9, s35, v6
    v_mfma_f32_16x16x32_bf16 v[20:23], v[68:71], v[152:155], v[20:23]
    ds_read_b64_tr_b16 v[52:53], v9 offset:0
    ds_read_b64_tr_b16 v[54:55], v9 offset:2048
    v_mfma_f32_16x16x32_bf16 v[36:39], v[68:71], v[156:159], v[36:39]
    v_add_u32 v10, s35, v1
    ds_read_b64_tr_b16 v[56:57], v10 offset:0
    s_add_u32 s69, s69, 2048
    buffer_load_dwordx4 v[120:123], v4, s[16:19], s69 offen sc1
    v_mfma_f32_16x16x32_bf16 v[24:27], v[72:75], v[152:155], v[24:27]
    ds_read_b64_tr_b16 v[58:59], v10 offset:2048
    v_add_u32 v11, s35, v3
    v_mfma_f32_16x16x32_bf16 v[40:43], v[72:75], v[156:159], v[40:43]
    ds_read_b64_tr_b16 v[60:61], v11 offset:0
    ds_read_b64_tr_b16 v[62:63], v11 offset:2048
    v_mfma_f32_16x16x32_bf16 v[28:31], v[76:79], v[152:155], v[28:31]
    buffer_load_dwordx4 v[124:127], v12, s[16:19], s69 offen sc1
    v_mfma_f32_16x16x32_bf16 v[44:47], v[76:79], v[156:159], v[44:47]
D_p3:
    s_waitcnt vmcnt(4) lgkmcnt(0)
    v_mfma_f32_16x16x32_bf16 v[16:19], v[48:51], v[128:131], v[16:19]
    ds_read_b64_tr_b16 v[64:65], v8 offset:4096
    ds_read_b64_tr_b16 v[66:67], v8 offset:6144
    v_mfma_f32_16x16x32_bf16 v[32:35], v[48:51], v[132:135], v[32:35]
    ds_read_b64_tr_b16 v[68:69], v9 offset:4096
    ds_read_b64_tr_b16 v[70:71], v9 offset:6144
    v_mfma_f32_16x16x32_bf16 v[20:23], v[52:55], v[128:131], v[20:23]
    ds_read_b64_tr_b16 v[72:73], v10 offset:4096
    ds_read_b64_tr_b16 v[74:75], v10 offset:6144
    v_mfma_f32_16x16x32_bf16 v[36:39], v[52:55], v[132:135], v[36:39]
    ds_read_b64_tr_b16 v[76:77], v11 offset:4096
    ds_read_b64_tr_b16 v[78:79], v11 offset:6144
    s_ff1_i32_b32 s64, s68
    s_bitset0_b32 s68, s64
    v_readlane_b32 s33, v7, s64
    s_add_u32 s69, s64, s74
    s_and_b32 s69, s69, 15
    s_lshl_b32 s69, s69, 11
    buffer_load_dwordx4 v[96:99], v4, s[16:19], s69 offen sc1
    v_mfma_f32_16x16x32_bf16 v[24:27], v[56:59], v[128:131], v[24:27]
    v_mfma_f32_16x16x32_bf16 v[40:43], v[56:59], v[132:135], v[40:43]
    v_mfma_f32_16x16x32_bf16 v[28:31], v[60:63], v[128:131], v[28:31]
    buffer_load_dwordx4 v[100:103], v12, s[16:19], s69 offen sc1
    v_mfma_f32_16x16x32_bf16 v[44:47], v[60:63], v[132:135], v[44:47]
    s_waitcnt lgkmcnt(0)
    v_mfma_f32_16x16x32_bf16 v[16:19], v[64:67], v[136:139], v[16:19]
    v_add_u32 v8, s34, v5
    ds_read_b64_tr_b16 v[48:49], v8 offset:0
    v_mfma_f32_16x16x32_bf16 v[32:35], v[64:67], v[140:143], v[32:35]
    ds_read_b64_tr_b16 v[50:51], v8 offset:2048
    v_add_u32 v9, s34, v6
    v_mfma_f32_16x16x32_bf16 v[20:23], v[68:71], v[136:139], v[20:23]
    ds_read_b64_tr_b16 v[52:53], v9 offset:0
    ds_read_b64_tr_b16 v[54:55], v9 offset:2048
    v_mfma_f32_16x16x32_bf16 v[36:39], v[68:71], v[140:143], v[36:39]
    v_add_u32 v10, s34, v1
    ds_read_b64_tr_b16 v[56:57], v10 offset:0
    s_add_u32 s69, s69, 2048
    buffer_load_dwordx4 v[104:107], v4, s[16:19], s69 offen sc1
    v_mfma_f32_16x16x32_bf16 v[24:27], v[72:75], v[136:139], v[24:27]
    ds_read_b64_tr_b16 v[58:59], v10 offset:2048
    v_add_u32 v11, s34, v3
    v_mfma_f32_16x16x32_bf16 v[40:43], v[72:75], v[140:143], v[40:43]
    ds_read_b64_tr_b16 v[60:61], v11 offset:0
    ds_read_b64_tr_b16 v[62:63], v11 offset:2048
    v_mfma_f32_16x16x32_bf16 v[28:31], v[76:79], v[136:139], v[28:31]
    buffer_load_dwordx4 v[108:111], v12, s[16:19], s69 offen sc1
    v_mfma_f32_16x16x32_bf16 v[44:47], v[76:79], v[140:143], v[44:47]
D_p2:
    s_waitcnt vmcnt(4) lgkmcnt(0)
    v_mfma_f32_16x16x32_bf16 v[16:19], v[48:51], v[112:115], v[16:19]
    ds_read_b64_tr_b16 v[64:65], v8 offset:4096
    ds_read_b64_tr_b16 v[66:67], v8 offset:6144
    v_mfma_f32_16x16x32_bf16 v[32:35], v[48:51], v[116:119], v[32:35]
    ds_read_b64_tr_b16 v[68:69], v9 offset:4096
    ds_read_b64_tr_b16 v[70:71], v9 offset:6144
    v_mfma_f32_16x16x32_bf16 v[20:23], v[52:55], v[112:115], v[20:23]
    ds_read_b64_tr_b16 v[72:73], v10 offset:4096
    ds_read_b64_tr_b16 v[74:75], v10 offset:6144
    v_mfma_f32_16x16x32_bf16 v[36:39], v[52:55], v[116:119], v[36:39]
    ds_read_b64_tr_b16 v[76:77], v11 offset:4096
    ds_read_b64_tr_b16 v[78:79], v11 offset:6144
    s_ff1_i32_b32 s64, s68
    s_bitset0_b32 s68, s64
    v_readlane_b32 s32, v7, s64
    s_add_u32 s69, s64, s74
    s_and_b32 s69, s69, 15
    s_lshl_b32 s69, s69, 11
    buffer_load_dwordx4 v[80:83], v4, s[16:19], s69 offen sc1
    v_mfma_f32_16x16x32_bf16 v[24:27], v[56:59], v[112:115], v[24:27]
    v_mfma_f32_16x16x32_bf16 v[40:43], v[56:59], v[116:119], v[40:43]
    v_mfma_f32_16x16x32_bf16 v[28:31], v[60:63], v[112:115], v[28:31]
    buffer_load_dwordx4 v[84:87], v12, s[16:19], s69 offen sc1
    v_mfma_f32_16x16x32_bf16 v[44:47], v[60:63], v[116:119], v[44:47]
    s_waitcnt lgkmcnt(0)
    v_mfma_f32_16x16x32_bf16 v[16:19], v[64:67], v[120:123], v[16:19]
    v_add_u32 v8, s33, v5
    ds_read_b64_tr_b16 v[48:49], v8 offset:0
    v_mfma_f32_16x16x32_bf16 v[32:35], v[64:67], v[124:127], v[32:35]
    ds_read_b64_tr_b16 v[50:51], v8 offset:2048
    v_add_u32 v9, s33, v6
    v_mfma_f32_16x16x32_bf16 v[20:23], v[68:71], v[120:123], v[20:23]
    ds_read_b64_tr_b16 v[52:53], v9 offset:0
    ds_read_b64_tr_b16 v[54:55], v9 offset:2048
    v_mfma_f32_16x16x32_bf16 v[36:39], v[68:71], v[124:127], v[36:39]
    v_add_u32 v10, s33, v1
    ds_read_b64_tr_b16 v[56:57], v10 offset:0
    s_add_u32 s69, s69, 2048
    buffer_load_dwordx4 v[88:91], v4, s[16:19], s69 offen sc1
    v_mfma_f32_16x16x32_bf16 v[24:27], v[72:75], v[120:123], v[24:27]
    ds_read_b64_tr_b16 v[58:59], v10 offset:2048
    v_add_u32 v11, s33, v3
    v_mfma_f32_16x16x32_bf16 v[40:43], v[72:75], v[124:127], v[40:43]
    ds_read_b64_tr_b16 v[60:61], v11 offset:0
    ds_read_b64_tr_b16 v[62:63], v11 offset:2048
    v_mfma_f32_16x16x32_bf16 v[28:31], v[76:79], v[120:123], v[28:31]
    buffer_load_dwordx4 v[92:95], v12, s[16:19], s69 offen sc1
    s_mov_b64 exec, 1
    v_mov_b32 v15, 0
    buffer_atomic_or v15, v14, s[16:19], 0 offen sc0
    s_mov_b64 exec, -1
    v_mfma_f32_16x16x32_bf16 v[44:47], v[76:79], v[124:127], v[44:47]
D_p1:
    s_waitcnt vmcnt(5) lgkmcnt(0)
    v_mfma_f32_16x16x32_bf16 v[16:19], v[48:51], v[96:99], v[16:19]
    ds_read_b64_tr_b16 v[64:65], v8 offset:4096
    ds_read_b64_tr_b16 v[66:67], v8 offset:6144
    v_mfma_f32_16x16x32_bf16 v[32:35], v[48:51], v[100:103], v[32:35]
    ds_read_b64_tr_b16 v[68:69], v9 offset:4096
    ds_read_b64_tr_b16 v[70:71], v9 offset:6144
    v_mfma_f32_16x16x32_bf16 v[20:23], v[52:55], v[96:99], v[20:23]
    ds_read_b64_tr_b16 v[72:73], v10 offset:4096
    ds_read_b64_tr_b16 v[74:75], v10 offset:6144
    v_mfma_f32_16x16x32_bf16 v[36:39], v[52:55], v[100:103], v[36:39]
    ds_read_b64_tr_b16 v[76:77], v11 offset:4096
    ds_read_b64_tr_b16 v[78:79], v11 offset:6144
    v_mfma_f32_16x16x32_bf16 v[24:27], v[56:59], v[96:99], v[24:27]
    v_mfma_f32_16x16x32_bf16 v[40:43], v[56:59], v[100:103], v[40:43]
    v_mfma_f32_16x16x32_bf16 v[28:31], v[60:63], v[96:99], v[28:31]
    v_mfma_f32_16x16x32_bf16 v[44:47], v[60:63], v[100:103], v[44:47]
    s_waitcnt lgkmcnt(0)
    v_mfma_f32_16x16x32_bf16 v[16:19], v[64:67], v[104:107], v[16:19]
    v_add_u32 v8, s32, v5
    ds_read_b64_tr_b16 v[48:49], v8 offset:0
    v_mfma_f32_16x16x32_bf16 v[32:35], v[64:67], v[108:111], v[32:35]
    ds_read_b64_tr_b16 v[50:51], v8 offset:2048
    v_add_u32 v9, s32, v6
    v_mfma_f32_16x16x32_bf16 v[20:23], v[68:71], v[104:107], v[20:23]
    ds_read_b64_tr_b16 v[52:53], v9 offset:0
    ds_read_b64_tr_b16 v[54:55], v9 offset:2048
    v_mfma_f32_16x16x32_bf16 v[36:39], v[68:71], v[108:111], v[36:39]
    v_add_u32 v10, s32, v1
    ds_read_b64_tr_b16 v[56:57], v10 offset:0
    v_mfma_f32_16x16x32_bf16 v[24:27], v[72:75], v[104:107], v[24:27]
    ds_read_b64_tr_b16 v[58:59], v10 offset:2048
    v_add_u32 v11, s32, v3
    v_mfma_f32_16x16x32_bf16 v[40:43], v[72:75], v[108:111], v[40:43]
    ds_read_b64_tr_b16 v[60:61], v11 offset:0
    ds_read_b64_tr_b16 v[62:63], v11 offset:2048
    v_mfma_f32_16x16x32_bf16 v[28:31], v[76:79], v[104:107], v[28:31]
    v_mfma_f32_16x16x32_bf16 v[44:47], v[76:79], v[108:111], v[44:47]
D_p0:
    s_waitcnt vmcnt(1) lgkmcnt(0)
    v_mfma_f32_16x16x32_bf16 v[16:19], v[48:51], v[80:83], v[16:19]
    ds_read_b64_tr_b16 v[64:65], v8 offset:4096
    ds_read_b64_tr_b16 v[66:67], v8 offset:6144
    v_mfma_f32_16x16x32_bf16 v[32:35], v[48:51], v[84:87], v[32:35]
    ds_read_b64_tr_b16 v[68:69], v9 offset:4096
    ds_read_b64_tr_b16 v[70:71], v9 offset:6144
    v_mfma_f32_16x16x32_bf16 v[20:23], v[52:55], v[80:83], v[20:23]
    ds_read_b64_tr_b16 v[72:73], v10 offset:4096
    ds_read_b64_tr_b16 v[74:75], v10 offset:6144
    v_mfma_f32_16x16x32_bf16 v[36:39], v[52:55], v[84:87], v[36:39]
    ds_read_b64_tr_b16 v[76:77], v11 offset:4096
    ds_read_b64_tr_b16 v[78:79], v11 offset:6144
    v_mfma_f32_16x16x32_bf16 v[24:27], v[56:59], v[80:83], v[24:27]
    v_mfma_f32_16x16x32_bf16 v[40:43], v[56:59], v[84:87], v[40:43]
    v_mfma_f32_16x16x32_bf16 v[28:31], v[60:63], v[80:83], v[28:31]
    v_mfma_f32_16x16x32_bf16 v[44:47], v[60:63], v[84:87], v[44:47]
    s_waitcnt lgkmcnt(0)
    v_mfma_f32_16x16x32_bf16 v[16:19], v[64:67], v[88:91], v[16:19]
    v_mfma_f32_16x16x32_bf16 v[32:35], v[64:67], v[92:95], v[32:35]
    v_mfma_f32_16x16x32_bf16 v[20:23], v[68:71], v[88:91], v[20:23]
    v_mfma_f32_16x16x32_bf16 v[36:39], v[68:71], v[92:95], v[36:39]
    v_mfma_f32_16x16x32_bf16 v[24:27], v[72:75], v[88:91], v[24:27]
    v_mfma_f32_16x16x32_bf16 v[40:43], v[72:75], v[92:95], v[40:43]
    v_mfma_f32_16x16x32_bf16 v[28:31], v[76:79], v[88:91], v[28:31]
    v_mfma_f32_16x16x32_bf16 v[44:47], v[76:79], v[92:95], v[44:47]
    s_cmp_lg_u32 s66, 0
    s_cbranch_scc1 D_wait
D_end:
    s_lshl_b32 s64, s3, 12
    s_add_u32 s64, s64, 8192
    v_lshl_add_u32 v8, v2, 4, s64
    s_xor_b32 s65, s3, 4
    s_lshl_b32 s65, s65, 12
    s_add_u32 s65, s65, 8192
    v_lshl_add_u32 v5, v2, 4, s65
    v_lshlrev_b32 v9, 1, v229
    v_cmp_eq_u32 s[70:71], s67, v230
    s_cmp_eq_u32 s46, 0
    s_cbranch_scc1 P2_y
P2_ny:
    s_barrier
    ds_write_b128 v8, v[32:35] offset:0
    ds_write_b128 v8, v[36:39] offset:1024
    ds_write_b128 v8, v[40:43] offset:2048
    ds_write_b128 v8, v[44:47] offset:3072
    s_cmp_lg_u64 s[70:71], 0
    s_cbranch_scc1 P2_fix
P2_nr:
    s_waitcnt lgkmcnt(0)
    s_barrier
    ds_read_b128 v[64:67], v5 offset:0
    ds_read_b128 v[68:71], v5 offset:1024
    ds_read_b128 v[72:75], v5 offset:2048
    ds_read_b128 v[76:79], v5 offset:3072
    s_waitcnt lgkmcnt(2)
    v_pk_add_f32 v[16:17], v[16:17], v[64:65]
    v_pk_add_f32 v[18:19], v[18:19], v[66:67]
    v_pk_add_f32 v[20:21], v[20:21], v[68:69]
    v_pk_add_f32 v[22:23], v[22:23], v[70:71]
    v_cvt_pk_bf16_f32 v48, v16, v17
    v_cvt_pk_bf16_f32 v49, v18, v19
    v_cvt_pk_bf16_f32 v50, v20, v21
    v_cvt_pk_bf16_f32 v51, v22, v23
    s_nop 0
    v_permlane16_swap_b32 v48, v50
    v_permlane16_swap_b32 v49, v51
    v_lshlrev_b32 v16, 16, v48
    v_and_b32 v17, 0xffff0000, v48
    v_lshlrev_b32 v18, 16, v49
    v_and_b32 v19, 0xffff0000, v49
    v_lshlrev_b32 v20, 16, v50
    v_and_b32 v21, 0xffff0000, v50
    v_lshlrev_b32 v22, 16, v51
    v_and_b32 v23, 0xffff0000, v51
    v_pk_mul_f32 v[16:17], v[16:17], v[228:229] op_sel_hi:[1,0]
    v_pk_mul_f32 v[18:19], v[18:19], v[228:229] op_sel_hi:[1,0]
    v_pk_mul_f32 v[20:21], v[20:21], v[228:229] op_sel_hi:[1,0]
    v_pk_mul_f32 v[22:23], v[22:23], v[228:229] op_sel_hi:[1,0]
    v_cvt_pk_bf16_f32 v48, v16, v17
    v_cvt_pk_bf16_f32 v49, v18, v19
    v_cvt_pk_bf16_f32 v50, v20, v21
    v_cvt_pk_bf16_f32 v51, v22, v23
    v_lshlrev_b32 v16, 16, v48
    v_and_b32 v17, 0xffff0000, v48
    v_lshlrev_b32 v18, 16, v49
    v_and_b32 v19, 0xffff0000, v49
    v_lshlrev_b32 v20, 16, v50
    v_and_b32 v21, 0xffff0000, v50
    v_lshlrev_b32 v22, 16, v51
    v_and_b32 v23, 0xffff0000, v51
    v_pk_add_f32 v[16:17], v[16:17], v[232:233]
    v_pk_add_f32 v[18:19], v[18:19], v[234:235]
    v_pk_add_f32 v[20:21], v[20:21], v[236:237]
    v_pk_add_f32 v[22:23], v[22:23], v[238:239]
    v_cvt_pk_bf16_f32 v120, v16, v17
    v_cvt_pk_bf16_f32 v121, v18, v19
    v_cvt_pk_bf16_f32 v122, v20, v21
    v_cvt_pk_bf16_f32 v123, v22, v23
    v_and_b32 v6, 1, v2
    v_mul_u32_u24 v6, 1984, v6
    v_sub_u32 v231, v231, v6
    s_mov_b32 vcc_lo, 0x55555555
    s_mov_b32 vcc_hi, 0x55555555
    s_waitcnt lgkmcnt(0)
    v_pk_add_f32 v[24:25], v[24:25], v[72:73]
    v_pk_add_f32 v[26:27], v[26:27], v[74:75]
    v_pk_add_f32 v[28:29], v[28:29], v[76:77]
    v_pk_add_f32 v[30:31], v[30:31], v[78:79]
    v_cvt_pk_bf16_f32 v52, v24, v25
    v_cvt_pk_bf16_f32 v53, v26, v27
    v_cvt_pk_bf16_f32 v54, v28, v29
    v_cvt_pk_bf16_f32 v55, v30, v31
    s_nop 0
    v_permlane16_swap_b32 v52, v54
    v_permlane16_swap_b32 v53, v55
    v_lshlrev_b32 v24, 16, v52
    v_and_b32 v25, 0xffff0000, v52
    v_lshlrev_b32 v26, 16, v53
    v_and_b32 v27, 0xffff0000, v53
    v_lshlrev_b32 v28, 16, v54
    v_and_b32 v29, 0xffff0000, v54
    v_lshlrev_b32 v30, 16, v55
    v_and_b32 v31, 0xffff0000, v55
    v_pk_mul_f32 v[24:25], v[24:25], v[228:229] op_sel_hi:[1,0]
    v_pk_mul_f32 v[26:27], v[26:27], v[228:229] op_sel_hi:[1,0]
    v_pk_mul_f32 v[28:29], v[28:29], v[228:229] op_sel_hi:[1,0]
    v_pk_mul_f32 v[30:31], v[30:31], v[228:229] op_sel_hi:[1,0]
    v_cvt_pk_bf16_f32 v52, v24, v25
    v_cvt_pk_bf16_f32 v53, v26, v27
    v_cvt_pk_bf16_f32 v54, v28, v29
    v_cvt_pk_bf16_f32 v55, v30, v31
    v_lshlrev_b32 v24, 16, v52
    v_and_b32 v25, 0xffff0000, v52
    v_lshlrev_b32 v26, 16, v53
    v_and_b32 v27, 0xffff0000, v53
    v_lshlrev_b32 v28, 16, v54
    v_and_b32 v29, 0xffff0000, v54
    v_lshlrev_b32 v30, 16, v55
    v_and_b32 v31, 0xffff0000, v55
    v_pk_add_f32 v[24:25], v[24:25], v[240:241]
    v_pk_add_f32 v[26:27], v[26:27], v[242:243]
    v_pk_add_f32 v[28:29], v[28:29], v[244:245]
    v_pk_add_f32 v[30:31], v[30:31], v[246:247]
    v_cvt_pk_bf16_f32 v124, v24, v25
    v_cvt_pk_bf16_f32 v125, v26, v27
    v_cvt_pk_bf16_f32 v126, v28, v29
    v_cvt_pk_bf16_f32 v127, v30, v31
    s_nop 1
    v_cndmask_b32_dpp v56, v124, v120, vcc quad_perm:[1,0,3,2] row_mask:0xf bank_mask:0xf
    v_cndmask_b32_dpp v57, v125, v121, vcc quad_perm:[1,0,3,2] row_mask:0xf bank_mask:0xf
    v_cndmask_b32_dpp v58, v126, v122, vcc quad_perm:[1,0,3,2] row_mask:0xf bank_mask:0xf
    v_cndmask_b32_dpp v59, v127, v123, vcc quad_perm:[1,0,3,2] row_mask:0xf bank_mask:0xf
    buffer_store_dwordx4 v[56:59], v231, s[20:23], 0 offen nt
    s_not_b64 vcc, vcc
    v_cndmask_b32_dpp v60, v120, v124, vcc quad_perm:[1,0,3,2] row_mask:0xf bank_mask:0xf
    v_cndmask_b32_dpp v61, v121, v125, vcc quad_perm:[1,0,3,2] row_mask:0xf bank_mask:0xf
    v_cndmask_b32_dpp v62, v122, v126, vcc quad_perm:[1,0,3,2] row_mask:0xf bank_mask:0xf
    v_cndmask_b32_dpp v63, v123, v127, vcc quad_perm:[1,0,3,2] row_mask:0xf bank_mask:0xf
    buffer_store_dwordx4 v[60:63], v231, s[20:23], 0 offen offset:2048 nt
K_end:
    s_endpgm
H_nre:
    s_add_u32 s65, s65, 1
    s_cmp_ge_u32 s65, 200000
    s_cbranch_scc1 H_nok
    s_sleep 4
    buffer_load_dword v78, v79, s[20:23], 0 offen sc1
    s_waitcnt vmcnt(0)
    s_branch H_nspin
H_retry:
    s_add_u32 s65, s65, 1
    s_cmp_ge_u32 s65, 200000
    s_cbranch_scc1 H_nq
    s_sleep 8
    s_mov_b32 s64, 6717440
    buffer_load_dwordx4 v[24:27], v6, s[16:19], s64 offen offset:0 sc1
    buffer_load_dwordx4 v[28:31], v6, s[16:19], s64 offen offset:1024 sc1
    s_waitcnt vmcnt(0)
    s_branch H_spin
G_f15:
    s_bitset1_b32 s66, s55
    s_branch G_q15
G_f14:
    s_bitset1_b32 s66, s54
    s_branch G_q14
G_f13:
    s_bitset1_b32 s66, s53
    s_branch G_q13
G_f12:
    s_bitset1_b32 s66, s52
    s_branch G_q12
G_f11:
    s_bitset1_b32 s66, s51
    s_branch G_q11
G_f10:
    s_bitset1_b32 s66, s50
    s_branch G_q10
G_f9:
    s_bitset1_b32 s66, s49
    s_branch G_q9
G_f8:
    s_bitset1_b32 s66, s48
    s_branch G_q8
G_f7:
    s_bitset1_b32 s66, s47
    s_branch G_q7
G_f6:
    s_bitset1_b32 s66, s46
    s_branch G_q6
G_f5:
    s_bitset1_b32 s66, s45
    s_branch G_q5
G_f4:
    s_bitset1_b32 s66, s44
    s_branch G_q4
G_f3:
    s_bitset1_b32 s66, s43
    s_branch G_q3
G_f2:
    s_bitset1_b32 s66, s42
    s_branch G_q2
G_f1:
    s_bitset1_b32 s66, s41
    s_branch G_q1
G_f0:
    s_bitset1_b32 s66, s40
    s_branch G_q0
phi_16_fix:
    v_lshlrev_b32 v48, 16, v16
    v_and_b32 v49, 0xffff0000, v16
    v_add_f32 v48, s73, v48
    v_add_f32 v49, s73, v49
    v_cvt_pk_bf16_f32 v16, v48, v49
    v_lshlrev_b32 v48, 16, v17
    v_and_b32 v49, 0xffff0000, v17
    v_add_f32 v48, s73, v48
    v_add_f32 v49, s73, v49
    v_cvt_pk_bf16_f32 v17, v48, v49
    v_lshlrev_b32 v48, 16, v18
    v_and_b32 v49, 0xffff0000, v18
    v_add_f32 v48, s73, v48
    v_add_f32 v49, s73, v49
    v_cvt_pk_bf16_f32 v18, v48, v49
    v_lshlrev_b32 v48, 16, v19
    v_and_b32 v49, 0xffff0000, v19
    v_add_f32 v48, s73, v48
    v_add_f32 v49, s73, v49
    v_cvt_pk_bf16_f32 v19, v48, v49
    v_lshlrev_b32 v48, 16, v20
    v_and_b32 v49, 0xffff0000, v20
    v_add_f32 v48, s73, v48
    v_add_f32 v49, s73, v49
    v_cvt_pk_bf16_f32 v20, v48, v49
    v_lshlrev_b32 v48, 16, v21
    v_and_b32 v49, 0xffff0000, v21
    v_add_f32 v48, s73, v48
    v_add_f32 v49, s73, v49
    v_cvt_pk_bf16_f32 v21, v48, v49
    v_lshlrev_b32 v48, 16, v22
    v_and_b32 v49, 0xffff0000, v22
    v_add_f32 v48, s73, v48
    v_add_f32 v49, s73, v49
    v_cvt_pk_bf16_f32 v22, v48, v49
    v_lshlrev_b32 v48, 16, v23
    v_and_b32 v49, 0xffff0000, v23
    v_add_f32 v48, s73, v48
    v_add_f32 v49, s73, v49
    v_cvt_pk_bf16_f32 v23, v48, v49
    s_branch phi_16_done
phi_17_fix:
    v_lshlrev_b32 v48, 16, v24
    v_and_b32 v49, 0xffff0000, v24
    v_add_f32 v48, s73, v48
    v_add_f32 v49, s73, v49
    v_cvt_pk_bf16_f32 v24, v48, v49
    v_lshlrev_b32 v48, 16, v25
    v_and_b32 v49, 0xffff0000, v25
    v_add_f32 v48, s73, v48
    v_add_f32 v49, s73, v49
    v_cvt_pk_bf16_f32 v25, v48, v49
    v_lshlrev_b32 v48, 16, v26
    v_and_b32 v49, 0xffff0000, v26
    v_add_f32 v48, s73, v48
    v_add_f32 v49, s73, v49
    v_cvt_pk_bf16_f32 v26, v48, v49
    v_lshlrev_b32 v48, 16, v27
    v_and_b32 v49, 0xffff0000, v27
    v_add_f32 v48, s73, v48
    v_add_f32 v49, s73, v49
    v_cvt_pk_bf16_f32 v27, v48, v49
    v_lshlrev_b32 v48, 16, v28
    v_and_b32 v49, 0xffff0000, v28
    v_add_f32 v48, s73, v48
    v_add_f32 v49, s73, v49
    v_cvt_pk_bf16_f32 v28, v48, v49
    v_lshlrev_b32 v48, 16, v29
    v_and_b32 v49, 0xffff0000, v29
    v_add_f32 v48, s73, v48
    v_add_f32 v49, s73, v49
    v_cvt_pk_bf16_f32 v29, v48, v49
    v_lshlrev_b32 v48, 16, v30
    v_and_b32 v49, 0xffff0000, v30
    v_add_f32 v48, s73, v48
    v_add_f32 v49, s73, v49
    v_cvt_pk_bf16_f32 v30, v48, v49
    v_lshlrev_b32 v48, 16, v31
    v_and_b32 v49, 0xffff0000, v31
    v_add_f32 v48, s73, v48
    v_add_f32 v49, s73, v49
    v_cvt_pk_bf16_f32 v31, v48, v49
    s_branch phi_17_done
C_ex1:
    ds_write_b32 v227, v96 offset:4608
    ds_write_b128 v224, v[240:243] offset:32768
    ds_write_b128 v224, v[244:247] offset:33792
    s_nop 4
    v_mov_b32 v96, v60
    v_mov_b32 v240, v248
    v_mov_b32 v241, v249
    v_mov_b32 v242, v250
    v_mov_b32 v243, v251
    v_mov_b32 v244, v252
    v_mov_b32 v245, v253
    v_mov_b32 v246, v254
    v_mov_b32 v247, v255
    s_branch C_ex2
phi_18_fix:
    v_lshlrev_b32 v48, 16, v32
    v_and_b32 v49, 0xffff0000, v32
    v_add_f32 v48, s73, v48
    v_add_f32 v49, s73, v49
    v_cvt_pk_bf16_f32 v32, v48, v49
    v_lshlrev_b32 v48, 16, v33
    v_and_b32 v49, 0xffff0000, v33
    v_add_f32 v48, s73, v48
    v_add_f32 v49, s73, v49
    v_cvt_pk_bf16_f32 v33, v48, v49
    v_lshlrev_b32 v48, 16, v34
    v_and_b32 v49, 0xffff0000, v34
    v_add_f32 v48, s73, v48
    v_add_f32 v49, s73, v49
    v_cvt_pk_bf16_f32 v34, v48, v49
    v_lshlrev_b32 v48, 16, v35
    v_and_b32 v49, 0xffff0000, v35
    v_add_f32 v48, s73, v48
    v_add_f32 v49, s73, v49
    v_cvt_pk_bf16_f32 v35, v48, v49
    v_lshlrev_b32 v48, 16, v36
    v_and_b32 v49, 0xffff0000, v36
    v_add_f32 v48, s73, v48
    v_add_f32 v49, s73, v49
    v_cvt_pk_bf16_f32 v36, v48, v49
    v_lshlrev_b32 v48, 16, v37
    v_and_b32 v49, 0xffff0000, v37
    v_add_f32 v48, s73, v48
    v_add_f32 v49, s73, v49
    v_cvt_pk_bf16_f32 v37, v48, v49
    v_lshlrev_b32 v48, 16, v38
    v_and_b32 v49, 0xffff0000, v38
    v_add_f32 v48, s73, v48
    v_add_f32 v49, s73, v49
    v_cvt_pk_bf16_f32 v38, v48, v49
    v_lshlrev_b32 v48, 16, v39
    v_and_b32 v49, 0xffff0000, v39
    v_add_f32 v48, s73, v48
    v_add_f32 v49, s73, v49
    v_cvt_pk_bf16_f32 v39, v48, v49
    s_branch phi_18_done
phi_19_fix:
    v_lshlrev_b32 v48, 16, v40
    v_and_b32 v49, 0xffff0000, v40
    v_add_f32 v48, s73, v48
    v_add_f32 v49, s73, v49
    v_cvt_pk_bf16_f32 v40, v48, v49
    v_lshlrev_b32 v48, 16, v41
    v_and_b32 v49, 0xffff0000, v41
    v_add_f32 v48, s73, v48
    v_add_f32 v49, s73, v49
    v_cvt_pk_bf16_f32 v41, v48, v49
    v_lshlrev_b32 v48, 16, v42
    v_and_b32 v49, 0xffff0000, v42
    v_add_f32 v48, s73, v48
    v_add_f32 v49, s73, v49
    v_cvt_pk_bf16_f32 v42, v48, v49
    v_lshlrev_b32 v48, 16, v43
    v_and_b32 v49, 0xffff0000, v43
    v_add_f32 v48, s73, v48
    v_add_f32 v49, s73, v49
    v_cvt_pk_bf16_f32 v43, v48, v49
    v_lshlrev_b32 v48, 16, v44
    v_and_b32 v49, 0xffff0000, v44
    v_add_f32 v48, s73, v48
    v_add_f32 v49, s73, v49
    v_cvt_pk_bf16_f32 v44, v48, v49
    v_lshlrev_b32 v48, 16, v45
    v_and_b32 v49, 0xffff0000, v45
    v_add_f32 v48, s73, v48
    v_add_f32 v49, s73, v49
    v_cvt_pk_bf16_f32 v45, v48, v49
    v_lshlrev_b32 v48, 16, v46
    v_and_b32 v49, 0xffff0000, v46
    v_add_f32 v48, s73, v48
    v_add_f32 v49, s73, v49
    v_cvt_pk_bf16_f32 v46, v48, v49
    v_lshlrev_b32 v48, 16, v47
    v_and_b32 v49, 0xffff0000, v47
    v_add_f32 v48, s73, v48
    v_add_f32 v49, s73, v49
    v_cvt_pk_bf16_f32 v47, v48, v49
    s_branch phi_19_done
P2_ys:
    v_lshrrev_b32 v13, 4, v2
    v_lshlrev_b32 v13, 12, v13
    v_and_b32 v208, 15, v2
    v_lshl_add_u32 v13, v208, 4, v13
    s_lshl_b32 s64, s5, 8
    s_lshl_b32 s65, s3, 16
    s_add_u32 s64, s64, s65
    v_add_u32 v13, s64, v13
    s_lshl_b32 s64, s67, 11
    s_lshl_b32 s65, s5, 7
    s_add_u32 s64, s64, s65
    v_lshl_add_u32 v209, v2, 1, s64
    s_lshl_b32 s64, s67, 2
    s_add_u32 s64, s64, 6709248
    v_mov_b32 v215, s64
    s_branch P2_ysd
P2_yl:
    s_cmp_gt_u32 s70, 7
    s_cbranch_scc1 P2_nyl
    buffer_load_ushort v211, v209, s[8:11], 0 offen
    buffer_load_dword v212, v215, s[16:19], 0 offen sc1
    s_mov_b32 s69, 6447104
    buffer_load_dwordx4 v[192:195], v13, s[16:19], s69 offen sc1
    s_mov_b32 s69, 6463488
    buffer_load_dwordx4 v[196:199], v13, s[16:19], s69 offen sc1
    s_mov_b32 s69, 6479872
    buffer_load_dwordx4 v[200:203], v13, s[16:19], s69 offen sc1
    s_mov_b32 s69, 6496256
    buffer_load_dwordx4 v[204:207], v13, s[16:19], s69 offen sc1
    s_mov_b32 s47, 1
    s_branch P2_nyl
P2_y:
    s_mov_b32 s66, 0
    s_cmp_lg_u32 s47, 0
    s_cbranch_scc1 P2_ychk
P2_yre:
    buffer_load_ushort v211, v209, s[8:11], 0 offen
    buffer_load_dword v212, v215, s[16:19], 0 offen sc1
    s_mov_b32 s69, 6447104
    buffer_load_dwordx4 v[192:195], v13, s[16:19], s69 offen sc1
    s_mov_b32 s69, 6463488
    buffer_load_dwordx4 v[196:199], v13, s[16:19], s69 offen sc1
    s_mov_b32 s69, 6479872
    buffer_load_dwordx4 v[200:203], v13, s[16:19], s69 offen sc1
    s_mov_b32 s69, 6496256
    buffer_load_dwordx4 v[204:207], v13, s[16:19], s69 offen sc1
P2_ychk:
    s_waitcnt vmcnt(0)
    v_max3_u32 v10, v192, v193, v194
    v_max3_u32 v10, v195, v196, v10
    v_max3_u32 v10, v197, v198, v10
    v_max3_u32 v10, v199, v200, v10
    v_max3_u32 v10, v201, v202, v10
    v_max3_u32 v10, v203, v204, v10
    v_max3_u32 v10, v205, v206, v10
    v_max_u32 v10, v207, v10
    v_cmp_eq_u32 vcc, -1, v10
    s_cbranch_vccz P2_yok
    s_add_u32 s66, s66, 1
    s_cmp_ge_u32 s66, 40000
    s_cbranch_scc1 P2_yok
    s_sleep 4
    s_branch P2_yre
P2_yok:
    v_pk_add_f32 v[192:193], v[192:193], v[200:201]
    v_pk_add_f32 v[194:195], v[194:195], v[202:203]
    v_pk_add_f32 v[196:197], v[196:197], v[204:205]
    v_pk_add_f32 v[198:199], v[198:199], v[206:207]
    v_pk_add_f32 v[192:193], v[192:193], v[196:197]
    v_pk_add_f32 v[194:195], v[194:195], v[198:199]
    v_mov_b32 v196, v192
    v_mov_b32 v197, v193
    v_mov_b32 v198, v194
    v_mov_b32 v199, v195
    s_nop 0
    v_permlane16_swap_b32 v192, v196
    v_permlane16_swap_b32 v193, v197
    v_permlane16_swap_b32 v194, v198
    v_permlane16_swap_b32 v195, v199
    v_add_f32 v192, v192, v196
    v_add_f32 v193, v193, v197
    v_add_f32 v194, v194, v198
    v_add_f32 v195, v195, v199
    v_mov_b32 v196, v192
    v_mov_b32 v197, v193
    v_mov_b32 v198, v194
    v_mov_b32 v199, v195
    s_nop 0
    v_permlane32_swap_b32 v192, v196
    v_permlane32_swap_b32 v193, v197
    v_permlane32_swap_b32 v194, v198
    v_permlane32_swap_b32 v195, v199
    v_add_f32 v192, v192, v196
    v_add_f32 v193, v193, v197
    v_add_f32 v194, v194, v198
    v_add_f32 v195, v195, v199
    s_lshl_b32 s64, s3, 8
    v_lshl_add_u32 v208, v208, 4, s64
    ds_write_b128 v208, v[192:195] offset:5888
    v_mov_b32 v208, 0
    v_mov_b32 v214, 1
    s_mov_b64 exec, 1
    ds_add_rtn_u32 v210, v208, v214 offset:4304
    s_mov_b64 exec, -1
    s_and_b32 s64, s75, 0xffff0000
    s_xor_b32 s65, s64, 0x80000000
    s_not_b32 s69, s64
    s_and_b32 s69, s69, 0xffff0000
    s_cmp_ge_u32 s64, 0x80000000
    s_cselect_b32 s64, s65, s69
    v_mov_b32 v213, s64
    v_lshlrev_b32 v208, 2, v2
    s_waitcnt lgkmcnt(0)
    v_readfirstlane_b32 s64, v210
    s_cmp_lg_u32 s64, 3
    s_cbranch_scc1 P2_ny
    ds_read_b32 v192, v208 offset:5888
    ds_read_b32 v193, v208 offset:6144
    ds_read_b32 v194, v208 offset:6400
    ds_read_b32 v195, v208 offset:6656
    v_mul_f32 v213, s72, v213
    v_exp_f32 v213, -v213
    s_nop 0
    v_add_f32 v213, 1.0, v213
    v_rcp_f32 v213, v213
    s_nop 0
    v_cvt_pk_bf16_f32 v213, v213, v213
    v_lshlrev_b32 v213, 16, v213
    v_sub_f32 v214, 1.0, v212
    v_cvt_pk_bf16_f32 v214, v214, v214
    v_lshlrev_b32 v214, 16, v214
    v_lshlrev_b32 v211, 16, v211
    s_waitcnt lgkmcnt(0)
    v_add_f32 v192, v192, v193
    v_add_f32 v194, v194, v195
    v_add_f32 v210, v192, v194
    v_cvt_pk_bf16_f32 v210, v210, v210
    v_lshlrev_b32 v210, 16, v210
    v_mul_f32 v210, v210, v213
    v_cvt_pk_bf16_f32 v210, v210, v210
    v_lshlrev_b32 v210, 16, v210
    v_add_f32 v210, v211, v210
    v_cvt_pk_bf16_f32 v210, v210, v210
    v_lshlrev_b32 v210, 16, v210
    v_mul_f32 v210, v210, v214
    v_cvt_pk_bf16_f32 v210, v210, v210
    v_lshlrev_b32 v210, 16, v210
    ds_write_b32 v208, v210 offset:5632
    s_waitcnt lgkmcnt(0)
    s_branch P2_ny
P2_fix:
    s_mov_b64 exec, s[70:71]
    ds_read_b128 v[232:235], v9 offset:5632
    ds_read_b128 v[236:239], v9 offset:5648
    ds_read_b128 v[240:243], v9 offset:5760
    ds_read_b128 v[244:247], v9 offset:5776
    s_mov_b64 exec, -1
    s_branch P2_nr
CODE_END:
.section .rodata,"a"
.p2align 6
.amdhsa_kernel gated_mix__linear_attn_block__moe_arch_mod__prompt_kernel
  .amdhsa_next_free_vgpr 256
  .amdhsa_next_free_sgpr 102
  .amdhsa_accum_offset 256
  .amdhsa_group_segment_fixed_size 0
  .amdhsa_kernarg_size 96
  .amdhsa_user_sgpr_count 2
  .amdhsa_user_sgpr_kernarg_segment_ptr 1
  .amdhsa_system_sgpr_workgroup_id_x 1
.end_amdhsa_kernel
```

```asm
; @launch grid=(256,1,1) block=(512,1,1) lds=163840
.amdgcn_target "amdgcn-amd-amdhsa--gfx950"
.text
.globl gated_mix__linear_attn_block__moe_arch_mod__prompt_kernel
.p2align 8
.type gated_mix__linear_attn_block__moe_arch_mod__prompt_kernel,@function
gated_mix__linear_attn_block__moe_arch_mod__prompt_kernel:
    s_load_dwordx16 s[40:55], s[0:1], 0
    s_load_dwordx8 s[56:63], s[0:1], 64
    s_cmp_ge_u32 s2, 256
    s_cbranch_scc1 K_end
    v_lshrrev_b32 v1, 6, v0
    v_and_b32 v2, 63, v0
    s_and_b32 s6, s2, 7
    v_readfirstlane_b32 s3, v1
    s_lshr_b32 s7, s2, 3
    s_and_b32 s4, s6, 1
    s_lshl_b32 s4, s4, 3
    s_and_b32 s64, s7, 7
    s_add_u32 s4, s4, s64
    s_lshr_b32 s5, s6, 1
    s_lshl_b32 s5, s5, 2
    s_lshr_b32 s64, s7, 3
    s_add_u32 s5, s5, s64
    s_bitcmp1_b32 s6, 1
    s_mov_b32 s64, 0xfc74d850
    s_cselect_b32 s64, 0xfd75e860, s64
    s_and_b32 s65, s6, 1
    s_lshl_b32 s65, s65, 2
    s_and_b32 s74, s4, 3
    s_add_u32 s65, s65, s74
    s_lshl_b32 s65, s65, 2
    s_lshr_b32 s74, s64, s65
    s_and_b32 s74, s74, 15
    v_lshrrev_b32 v6, 3, v2
    s_lshl_b32 s65, s3, 3
    v_add_u32 v6, s65, v6
    s_lshl_b32 s64, s4, 7
    v_add_u32 v7, s64, v6
    v_lshlrev_b32 v7, 11, v7
    v_lshrrev_b32 v8, 4, v2
    s_and_b32 s64, s3, 1
    s_lshl_b32 s64, s64, 2
    v_add_u32 v9, s64, v8
    v_and_b32 v10, 7, v2
    v_xor_b32 v9, v9, v10
    v_lshl_add_u32 v7, v9, 4, v7
    v_mul_u32_u24 v6, 6144, v6
    v_and_b32 v9, 1, v8
    s_lshr_b32 s64, s64, 1
    v_lshl_add_u32 v9, v9, 2, s64
    v_xor_b32 v9, v9, v10
    v_lshl_add_u32 v6, v9, 4, v6
    s_lshl_b32 s64, s5, 7
    v_add_u32 v6, s64, v6
    s_lshl_b32 s66, s3, 10
    s_mov_b32 s10, 4194304
    s_mov_b32 s11, 0x00020000
    s_mov_b32 s14, 6291456
    s_mov_b32 s15, 0x00020000
    s_add_u32 s65, s74, 0
    s_and_b32 s65, s65, 15
    s_lshl_b32 s67, s65, 7
    s_mul_i32 s65, s65, 393216
    s_waitcnt lgkmcnt(0)
    s_mov_b32 s8, s40
    s_mov_b32 s9, s41
    s_mov_b32 s12, s42
    s_mov_b32 s13, s43
    s_add_u32 m0, s66, 8192
    s_add_u32 s64, s67, 0
    buffer_load_dwordx4 v7, s[8:11], s64 offen lds
    s_add_u32 m0, s66, 16384
    s_add_u32 s64, s67, 131072
    buffer_load_dwordx4 v7, s[8:11], s64 offen lds
    s_add_u32 m0, s66, 24576
    s_add_u32 s64, s65, 0
    buffer_load_dwordx4 v6, s[12:15], s64 offen lds
    s_add_u32 m0, s66, 32768
    s_add_u32 s64, s65, 2048
    buffer_load_dwordx4 v6, s[12:15], s64 offen lds
    s_add_u32 m0, s66, 40960
    s_add_u32 s64, s65, 4096
    buffer_load_dwordx4 v6, s[12:15], s64 offen lds
    s_cmp_lt_u32 s3, 4
    s_cbranch_scc1 K_nt
    s_lshl_b32 s64, s2, 2
    s_add_u32 s64, s64, s3
    s_sub_u32 s64, s64, 4
    s_mul_i32 s64, s64, 6144
    s_add_u32 s46, s12, s64
    s_addc_u32 s47, s13, 0
    s_load_dword s43, s[46:47], 384
    s_load_dword s43, s[46:47], 448
    s_load_dword s43, s[46:47], 1408
    s_load_dword s43, s[46:47], 1472
    s_load_dword s43, s[46:47], 2432
    s_load_dword s43, s[46:47], 2496
    s_load_dword s43, s[46:47], 3456
    s_load_dword s43, s[46:47], 3520
    s_load_dword s43, s[46:47], 4480
    s_load_dword s43, s[46:47], 4544
    s_load_dword s43, s[46:47], 5504
    s_load_dword s43, s[46:47], 5568
K_nt:
    s_barrier
    s_mov_b32 s72, 0x3fb8aa3b
    s_mov_b32 s73, 0x358637bd
    s_mov_b32 s16, s62
    s_mov_b32 s17, s63
    s_mov_b32 s18, 0x10000000
    s_mov_b32 s19, 0x00020000
    s_cmp_lt_u32 s3, 4
    s_cbranch_scc1 C_start
    s_sub_u32 s6, s3, 4
    s_lshl_b32 s7, s6, 10
    v_lshrrev_b32 v6, 3, v2
    s_lshl_b32 s64, s4, 7
    s_lshl_b32 s65, s6, 3
    s_add_u32 s64, s64, s65
    v_add_u32 v7, s64, v6
    v_lshlrev_b32 v7, 11, v7
    s_and_b32 s64, s6, 1
    s_lshl_b32 s64, s64, 2
    v_add_u32 v9, s64, v8
    v_xor_b32 v9, v9, v10
    v_lshl_add_u32 v4, v9, 4, v7
    v_add_u32 v7, s65, v6
    v_mul_u32_u24 v7, 6144, v7
    v_and_b32 v9, 1, v8
    s_lshr_b32 s64, s64, 1
    v_lshl_add_u32 v9, v9, 2, s64
    v_xor_b32 v9, v9, v10
    v_lshl_add_u32 v7, v9, 4, v7
    s_lshl_b32 s64, s5, 7
    v_add_u32 v5, s64, v7
    v_lshlrev_b32 v6, 4, v2
    s_and_b32 s64, s2, 1
    s_lshl_b32 s68, s64, 10
    s_bfe_u32 s64, s2, 0x20001
    s_lshl_b32 s64, s64, 8
    s_add_u32 s68, s68, s64
    s_and_b32 s64, s2, 0xf8
    s_add_u32 s68, s68, s64
    s_lshl_b32 s64, s6, 1
    s_add_u32 s68, s68, s64
    s_lshl_b32 s64, s68, 11
    v_add_u32 v13, s64, v6
    s_add_u32 s41, s74, 1
    s_and_b32 s41, s41, 15
    s_lshl_b32 s42, s41, 7
    s_mul_i32 s41, s41, 393216
    s_add_u32 m0, s7, 49152
    s_add_u32 s40, s42, 0
    buffer_load_dwordx4 v4, s[8:11], s40 offen lds
    s_add_u32 m0, s7, 53248
    s_add_u32 s40, s42, 65536
    buffer_load_dwordx4 v4, s[8:11], s40 offen lds
    s_add_u32 m0, s7, 57344
    s_add_u32 s40, s42, 131072
    buffer_load_dwordx4 v4, s[8:11], s40 offen lds
    s_add_u32 m0, s7, 61440
    s_add_u32 s40, s42, 196608
    buffer_load_dwordx4 v4, s[8:11], s40 offen lds
    s_add_u32 m0, s7, 65536
    s_add_u32 s40, s41, 0
    buffer_load_dwordx4 v5, s[12:15], s40 offen lds
    s_add_u32 m0, s7, 69632
    s_add_u32 s40, s41, 196608
    buffer_load_dwordx4 v5, s[12:15], s40 offen lds
    s_add_u32 m0, s7, 73728
    s_add_u32 s40, s41, 2048
    buffer_load_dwordx4 v5, s[12:15], s40 offen lds
    s_add_u32 m0, s7, 77824
    s_add_u32 s40, s41, 198656
    buffer_load_dwordx4 v5, s[12:15], s40 offen lds
    s_add_u32 m0, s7, 81920
    s_add_u32 s40, s41, 4096
    buffer_load_dwordx4 v5, s[12:15], s40 offen lds
    s_add_u32 m0, s7, 86016
    s_add_u32 s40, s41, 200704
    buffer_load_dwordx4 v5, s[12:15], s40 offen lds
    s_mov_b32 s32, s50
    s_mov_b32 s33, s51
    s_mov_b32 s34, 0x700000
    s_mov_b32 s35, 0x00020000
    s_mov_b32 s36, s52
    s_mov_b32 s37, s53
    s_mov_b32 s38, 0x700000
    s_mov_b32 s39, 0x00020000
    s_or_b32 s64, s2, s6
    s_cmp_lg_u32 s64, 0
    s_cbranch_scc1 H_nn
    s_mov_b32 s64, 6717440
    s_load_dwordx2 s[66:67], s[62:63], s64
    s_mov_b32 s20, s60
    s_mov_b32 s21, s61
    s_mov_b32 s22, 0x100
    s_mov_b32 s23, 0x00020000
    s_waitcnt lgkmcnt(0)
    s_xor_b32 s64, s66, s67
    s_add_u32 s64, s64, 1
    s_max_u32 s64, s64, 1
    v_mov_b32 v72, s64
    v_mov_b32 v73, 0
    s_mov_b64 exec, 1
    buffer_store_dword v72, v73, s[20:23], 0 offen sc0 sc1
    s_mov_b64 exec, -1
H_nn:
    s_mov_b32 s20, s60
    s_mov_b32 s21, s61
    s_mov_b32 s22, 0x100
    s_mov_b32 s23, 0x00020000
    s_mov_b32 s24, s48
    s_mov_b32 s25, s49
    s_mov_b32 s26, 0x800
    s_mov_b32 s27, 0x00020000
    s_mov_b32 s28, s56
    s_mov_b32 s29, s57
    s_mov_b32 s30, 0x800
    s_mov_b32 s31, 0x00020000
    s_lshr_b32 s69, s2, 3
    s_and_b32 s64, s2, 7
    v_and_b32 v9, 15, v2
    v_min_u32 v9, 13, v9
    s_lshl_b32 s65, s69, 5
    v_lshl_add_u32 v7, v8, 3, s65
    v_mul_u32_u24 v7, 7168, v7
    s_mul_i32 s65, s64, 896
    s_mul_i32 s66, s6, 224
    s_add_u32 s65, s65, s66
    v_lshl_add_u32 v7, v9, 4, v7
    v_add_u32 v11, s65, v7
    v_cmp_le_u32 vcc, 7, v9
    v_mov_b32 v15, 16160
    s_nop 0
    v_cndmask_b32 v7, 0, v15, vcc
    v_lshl_add_u32 v7, v9, 5, v7
    v_lshrrev_b32 v15, 1, v8
    v_lshl_add_u32 v7, v15, 13, v7
    v_and_b32 v15, 1, v8
    v_lshl_add_u32 v7, v15, 4, v7
    s_lshl_b32 s64, s64, 17
    s_lshl_b32 s65, s6, 15
    s_add_u32 s64, s64, s65
    s_lshl_b32 s65, s69, 8
    s_add_u32 s64, s64, s65
    s_add_u32 s64, s64, 5398528
    v_add_u32 v12, s64, v7
    s_lshl_b32 s70, s5, 2
    s_add_u32 s70, s70, s6
    s_mul_i32 s70, s70, 18432
    s_add_u32 s70, s70, 4194304
    s_mul_i32 s64, s4, 1152
    s_add_u32 s64, s64, s70
    s_mov_b32 s67, s64
    v_lshl_add_u32 v15, v2, 2, s64
    v_add_u32 v15, 960, v15
    s_lshl_b32 s64, s5, 2
    s_add_u32 s64, s64, s6
    s_lshl_b32 s64, s64, 7
    s_add_u32 s64, s64, 5373952
    v_mov_b32 v23, s64
    s_lshl_b32 s65, s4, 10
    s_add_u32 s65, s65, 5382016
    v_lshl_add_u32 v20, v2, 7, s65
    v_cmp_gt_u32 vcc, 16, v2
    s_nop 1
    v_cndmask_b32 v15, v15, v20, vcc
    v_writelane_b32 v15, s64, 0
    s_cmp_eq_u32 s4, 0
    s_cselect_b32 s75, 1, 0
    s_or_b32 s64, s5, s6
    s_cmp_eq_u32 s64, 0
    s_cselect_b32 s64, 0x1fe, 0
    s_or_b32 s75, s75, s64
    s_or_b32 s75, s75, 0xffff0000
    v_lshlrev_b32 v22, 4, v2
    v_add_u32 v22, s67, v22
    v_mov_b32 v16, -1
    v_mov_b32 v17, -1
    v_mov_b32 v18, -1
    v_mov_b32 v19, -1
    v_cndmask_b32 v20, -1, 0, vcc
    s_waitcnt vmcnt(10)
    s_barrier
    s_add_u32 s41, s74, 2
    s_and_b32 s41, s41, 15
    s_lshl_b32 s42, s41, 7
    s_mul_i32 s41, s41, 393216
    s_add_u32 m0, s7, 90112
    s_add_u32 s40, s42, 0
    buffer_load_dwordx4 v4, s[8:11], s40 offen lds
    s_add_u32 m0, s7, 94208
    s_add_u32 s40, s42, 65536
    buffer_load_dwordx4 v4, s[8:11], s40 offen lds
    s_add_u32 m0, s7, 98304
    s_add_u32 s40, s42, 131072
    buffer_load_dwordx4 v4, s[8:11], s40 offen lds
    s_add_u32 m0, s7, 102400
    s_add_u32 s40, s42, 196608
    buffer_load_dwordx4 v4, s[8:11], s40 offen lds
    s_add_u32 m0, s7, 106496
    s_add_u32 s40, s41, 0
    buffer_load_dwordx4 v5, s[12:15], s40 offen lds
    s_add_u32 m0, s7, 110592
    s_add_u32 s40, s41, 196608
    buffer_load_dwordx4 v5, s[12:15], s40 offen lds
    s_add_u32 m0, s7, 114688
    s_add_u32 s40, s41, 2048
    buffer_load_dwordx4 v5, s[12:15], s40 offen lds
    s_add_u32 m0, s7, 118784
    s_add_u32 s40, s41, 198656
    buffer_load_dwordx4 v5, s[12:15], s40 offen lds
    s_add_u32 m0, s7, 122880
    s_add_u32 s40, s41, 4096
    buffer_load_dwordx4 v5, s[12:15], s40 offen lds
    s_add_u32 m0, s7, 126976
    s_add_u32 s40, s41, 200704
    buffer_load_dwordx4 v5, s[12:15], s40 offen lds
    s_getpc_b64 s[66:67]
pc_1:
    s_sub_u32 s66, s66, pc_1-gated_mix__linear_attn_block__moe_arch_mod__prompt_kernel
    s_subb_u32 s67, s67, 0
    s_lshr_b32 s64, s2, 3
    s_lshl_b32 s64, s64, 2
    s_add_u32 s64, s64, s6
    s_mul_i32 s64, s64, 256
    s_min_u32 s65, s64, CODE_END-gated_mix__linear_attn_block__moe_arch_mod__prompt_kernel-4
    s_load_dword s43, s[66:67], s65
    s_add_u32 s64, s64, 64
    s_min_u32 s65, s64, CODE_END-gated_mix__linear_attn_block__moe_arch_mod__prompt_kernel-4
    s_load_dword s43, s[66:67], s65
    s_add_u32 s64, s64, 64
    s_min_u32 s65, s64, CODE_END-gated_mix__linear_attn_block__moe_arch_mod__prompt_kernel-4
    s_load_dword s43, s[66:67], s65
    s_add_u32 s64, s64, 64
    s_min_u32 s65, s64, CODE_END-gated_mix__linear_attn_block__moe_arch_mod__prompt_kernel-4
    s_load_dword s43, s[66:67], s65
    s_add_u32 s64, s64, 64
    buffer_load_dwordx4 v[24:27], v13, s[8:11], 0 offen offset:0
    buffer_load_dwordx4 v[28:31], v13, s[8:11], 0 offen offset:1024
    buffer_load_dwordx4 v[32:35], v13, s[8:11], 0 offen offset:2048
    buffer_load_dwordx4 v[36:39], v13, s[8:11], 0 offen offset:3072
    s_cmp_lt_u32 s6, 2
    s_cselect_b32 s24, s48, s56
    s_cselect_b32 s25, s49, s57
    s_and_b32 s64, s7, 1024
    s_add_u32 m0, s7, 0
    s_nop 0
    buffer_load_dwordx4 v6, s[24:27], s64 offen lds
    s_waitcnt vmcnt(15)
    s_barrier
    s_add_u32 s41, s74, 3
    s_and_b32 s41, s41, 15
    s_lshl_b32 s42, s41, 7
    s_mul_i32 s41, s41, 393216
    s_add_u32 m0, s7, 8192
    s_add_u32 s40, s42, 0
    buffer_load_dwordx4 v4, s[8:11], s40 offen lds
    s_add_u32 m0, s7, 12288
    s_add_u32 s40, s42, 65536
    buffer_load_dwordx4 v4, s[8:11], s40 offen lds
    s_add_u32 m0, s7, 16384
    s_add_u32 s40, s42, 131072
    buffer_load_dwordx4 v4, s[8:11], s40 offen lds
    s_add_u32 m0, s7, 20480
    s_add_u32 s40, s42, 196608
    buffer_load_dwordx4 v4, s[8:11], s40 offen lds
    s_add_u32 m0, s7, 24576
    s_add_u32 s40, s41, 0
    buffer_load_dwordx4 v5, s[12:15], s40 offen lds
    s_add_u32 m0, s7, 28672
    s_add_u32 s40, s41, 196608
    buffer_load_dwordx4 v5, s[12:15], s40 offen lds
    s_add_u32 m0, s7, 32768
    s_add_u32 s40, s41, 2048
    buffer_load_dwordx4 v5, s[12:15], s40 offen lds
    s_add_u32 m0, s7, 36864
    s_add_u32 s40, s41, 198656
    buffer_load_dwordx4 v5, s[12:15], s40 offen lds
    s_add_u32 m0, s7, 40960
    s_add_u32 s40, s41, 4096
    buffer_load_dwordx4 v5, s[12:15], s40 offen lds
    s_add_u32 m0, s7, 45056
    s_add_u32 s40, s41, 200704
    buffer_load_dwordx4 v5, s[12:15], s40 offen lds
    buffer_store_dwordx4 v[16:19], v22, s[16:19], 0 offen sc0 sc1
    s_mov_b32 exec_lo, s75
    s_mov_b32 exec_hi, 0
    buffer_store_dword v20, v15, s[16:19], 0 offen sc0 sc1
    s_mov_b32 exec_lo, 0x3fff3fff
    s_mov_b32 exec_hi, 0x3fff3fff
    buffer_store_dwordx4 v[16:19], v12, s[16:19], 0 offen sc0 sc1
    s_mov_b64 exec, 0xffff
    s_lshl_b32 s64, s2, 10
    s_lshl_b32 s65, s6, 8
    s_add_u32 s64, s64, s65
    s_add_u32 s64, s64, 6447104
    buffer_store_dwordx4 v[16:19], v6, s[16:19], s64 offen sc0 sc1
    s_mov_b64 exec, -1
    s_waitcnt vmcnt(19)
    s_barrier
    v_mov_b32 v79, 0
    s_cmp_lg_u32 s6, 0
    s_cbranch_scc1 H_nc
    buffer_load_dword v78, v79, s[20:23], 0 offen sc1
H_nc:
    s_add_u32 s41, s74, 4
    s_and_b32 s41, s41, 15
    s_lshl_b32 s42, s41, 7
    s_mul_i32 s41, s41, 393216
    s_add_u32 m0, s7, 49152
    s_add_u32 s40, s42, 0
    buffer_load_dwordx4 v4, s[8:11], s40 offen lds
    s_add_u32 m0, s7, 53248
    s_add_u32 s40, s42, 65536
    buffer_load_dwordx4 v4, s[8:11], s40 offen lds
    s_add_u32 m0, s7, 57344
    s_add_u32 s40, s42, 131072
    buffer_load_dwordx4 v4, s[8:11], s40 offen lds
    s_add_u32 m0, s7, 61440
    s_add_u32 s40, s42, 196608
    buffer_load_dwordx4 v4, s[8:11], s40 offen lds
    s_add_u32 m0, s7, 65536
    s_add_u32 s40, s41, 0
    buffer_load_dwordx4 v5, s[12:15], s40 offen lds
    s_add_u32 m0, s7, 69632
    s_add_u32 s40, s41, 196608
    buffer_load_dwordx4 v5, s[12:15], s40 offen lds
    s_add_u32 m0, s7, 73728
    s_add_u32 s40, s41, 2048
    buffer_load_dwordx4 v5, s[12:15], s40 offen lds
    s_add_u32 m0, s7, 77824
    s_add_u32 s40, s41, 198656
    buffer_load_dwordx4 v5, s[12:15], s40 offen lds
    s_add_u32 m0, s7, 81920
    s_add_u32 s40, s41, 4096
    buffer_load_dwordx4 v5, s[12:15], s40 offen lds
    s_add_u32 m0, s7, 86016
    s_add_u32 s40, s41, 200704
    buffer_load_dwordx4 v5, s[12:15], s40 offen lds
    s_waitcnt vmcnt(14)
    s_barrier
    ds_read_b128 v[40:43], v6 offset:0
    ds_read_b128 v[44:47], v6 offset:1024
    ds_read_b128 v[48:51], v6 offset:2048
    ds_read_b128 v[52:55], v6 offset:3072
    s_add_u32 s41, s74, 5
    s_and_b32 s41, s41, 15
    s_lshl_b32 s42, s41, 7
    s_mul_i32 s41, s41, 393216
    s_add_u32 m0, s7, 90112
    s_add_u32 s40, s42, 0
    buffer_load_dwordx4 v4, s[8:11], s40 offen lds
    s_waitcnt lgkmcnt(0)
    s_add_u32 m0, s7, 94208
    s_add_u32 s40, s42, 65536
    buffer_load_dwordx4 v4, s[8:11], s40 offen lds
    v_dot2_f32_bf16 v72, v24, v48, 0
    v_dot2_f32_bf16 v73, v32, v48, 0
    v_dot2_f32_bf16 v74, v24, v40, 0
    v_dot2_f32_bf16 v75, v32, v40, 0
    s_add_u32 m0, s7, 98304
    s_add_u32 s40, s42, 131072
    buffer_load_dwordx4 v4, s[8:11], s40 offen lds
    v_dot2_f32_bf16 v72, v25, v49, v72
    v_dot2_f32_bf16 v73, v33, v49, v73
    v_dot2_f32_bf16 v74, v25, v41, v74
    v_dot2_f32_bf16 v75, v33, v41, v75
    s_add_u32 m0, s7, 102400
    s_add_u32 s40, s42, 196608
    buffer_load_dwordx4 v4, s[8:11], s40 offen lds
    v_dot2_f32_bf16 v72, v26, v50, v72
    v_dot2_f32_bf16 v73, v34, v50, v73
    v_dot2_f32_bf16 v74, v26, v42, v74
    v_dot2_f32_bf16 v75, v34, v42, v75
    s_add_u32 m0, s7, 106496
    s_add_u32 s40, s41, 0
    buffer_load_dwordx4 v5, s[12:15], s40 offen lds
    v_dot2_f32_bf16 v72, v27, v51, v72
    v_dot2_f32_bf16 v73, v35, v51, v73
    v_dot2_f32_bf16 v74, v27, v43, v74
    v_dot2_f32_bf16 v75, v35, v43, v75
    s_add_u32 m0, s7, 110592
    s_add_u32 s40, s41, 196608
    buffer_load_dwordx4 v5, s[12:15], s40 offen lds
    v_dot2_f32_bf16 v72, v28, v52, v72
    v_dot2_f32_bf16 v73, v36, v52, v73
    v_dot2_f32_bf16 v74, v28, v44, v74
    v_dot2_f32_bf16 v75, v36, v44, v75
    s_add_u32 m0, s7, 114688
    s_add_u32 s40, s41, 2048
    buffer_load_dwordx4 v5, s[12:15], s40 offen lds
    v_dot2_f32_bf16 v72, v29, v53, v72
    v_dot2_f32_bf16 v73, v37, v53, v73
    v_dot2_f32_bf16 v74, v29, v45, v74
    v_dot2_f32_bf16 v75, v37, v45, v75
    s_add_u32 m0, s7, 118784
    s_add_u32 s40, s41, 198656
    buffer_load_dwordx4 v5, s[12:15], s40 offen lds
    v_dot2_f32_bf16 v72, v30, v54, v72
    v_dot2_f32_bf16 v73, v38, v54, v73
    v_dot2_f32_bf16 v74, v30, v46, v74
    v_dot2_f32_bf16 v75, v38, v46, v75
    s_add_u32 m0, s7, 122880
    s_add_u32 s40, s41, 4096
    buffer_load_dwordx4 v5, s[12:15], s40 offen lds
    v_dot2_f32_bf16 v72, v31, v55, v72
    v_dot2_f32_bf16 v73, v39, v55, v73
    v_dot2_f32_bf16 v74, v31, v47, v74
    v_dot2_f32_bf16 v75, v39, v47, v75
    s_add_u32 m0, s7, 126976
    s_add_u32 s40, s41, 200704
    buffer_load_dwordx4 v5, s[12:15], s40 offen lds
    s_waitcnt vmcnt(10)
    s_barrier
    s_add_u32 s41, s74, 6
    s_and_b32 s41, s41, 15
    s_lshl_b32 s42, s41, 7
    s_mul_i32 s41, s41, 393216
    s_add_u32 m0, s7, 8192
    s_add_u32 s40, s42, 0
    buffer_load_dwordx4 v4, s[8:11], s40 offen lds
    v_permlane32_swap_b32 v72, v74
    v_permlane32_swap_b32 v73, v75
    v_add_f32 v72, v72, v74
    v_add_f32 v73, v73, v75
    s_add_u32 m0, s7, 12288
    s_add_u32 s40, s42, 65536
    buffer_load_dwordx4 v4, s[8:11], s40 offen lds
    s_lshl_b32 s64, s68, 2
    s_add_u32 s64, s64, 6709248
    v_permlane16_swap_b32 v72, v73
    v_add_f32 v72, v72, v73
    s_add_u32 m0, s7, 16384
    s_add_u32 s40, s42, 131072
    buffer_load_dwordx4 v4, s[8:11], s40 offen lds
    v_and_b32 v75, 1, v8
    v_lshl_add_u32 v76, v75, 2, s64
    v_add_f32_dpp v72, v72, v72 quad_perm:[1,0,3,2] row_mask:0xf bank_mask:0xf
    s_nop 1
    s_add_u32 m0, s7, 20480
    s_add_u32 s40, s42, 196608
    buffer_load_dwordx4 v4, s[8:11], s40 offen lds
    v_add_f32_dpp v72, v72, v72 quad_perm:[2,3,0,1] row_mask:0xf bank_mask:0xf
    s_nop 1
    v_add_f32_dpp v72, v72, v72 row_half_mirror row_mask:0xf bank_mask:0xf
    s_nop 1
    s_add_u32 m0, s7, 24576
    s_add_u32 s40, s41, 0
    buffer_load_dwordx4 v5, s[12:15], s40 offen lds
    v_add_f32_dpp v72, v72, v72 row_mirror row_mask:0xf bank_mask:0xf
    s_nop 1
    v_cvt_pk_bf16_f32 v72, v72, v72
    s_sub_u32 s64, 34815, s68
    s_add_u32 m0, s7, 28672
    s_add_u32 s40, s41, 196608
    buffer_load_dwordx4 v5, s[12:15], s40 offen lds
    v_lshlrev_b32 v72, 16, v72
    v_ashrrev_i32 v73, 31, v72
    v_sub_u32 v77, s64, v75
    v_or_b32 v73, 0x80000000, v73
    s_add_u32 m0, s7, 32768
    s_add_u32 s40, s41, 2048
    buffer_load_dwordx4 v5, s[12:15], s40 offen lds
    s_lshl_b32 s64, s6, 3
    v_xor_b32 v73, v72, v73
    v_lshl_add_u32 v75, v75, 2, s64
    v_and_b32 v73, 0xffff0000, v73
    s_add_u32 m0, s7, 36864
    s_add_u32 s40, s41, 198656
    buffer_load_dwordx4 v5, s[12:15], s40 offen lds
    v_or_b32 v73, v77, v73
    v_mul_f32 v72, s72, v72
    v_exp_f32 v72, -v72
    s_nop 0
    s_add_u32 m0, s7, 40960
    s_add_u32 s40, s41, 4096
    buffer_load_dwordx4 v5, s[12:15], s40 offen lds
    v_add_f32 v72, 1.0, v72
    v_rcp_f32 v72, v72
    s_nop 0
    v_cvt_pk_bf16_f32 v72, v72, v72
    s_add_u32 m0, s7, 45056
    s_add_u32 s40, s41, 200704
    buffer_load_dwordx4 v5, s[12:15], s40 offen lds
    v_lshlrev_b32 v72, 16, v72
    s_mov_b32 exec_lo, 0
    s_mov_b32 exec_hi, 0x10001
    ds_write_b32 v75, v73 offset:4224
    s_mov_b32 exec_lo, 0x10001
    s_mov_b32 exec_hi, 0
    buffer_store_dword v72, v76, s[16:19], 0 offen sc0 sc1
    s_mov_b64 exec, -1
    s_mov_b32 exec_lo, 0x3fff3fff
    s_mov_b32 exec_hi, 0x3fff3fff
    s_mov_b32 s64, 0
    buffer_load_dwordx4 v[96:99], v11, s[32:35], s64 offen nt
    s_mov_b32 s64, 0
    buffer_load_dwordx4 v[128:131], v11, s[36:39], s64 offen nt
    s_mov_b32 s64, 7168
    buffer_load_dwordx4 v[100:103], v11, s[32:35], s64 offen nt
    s_mov_b32 s64, 7168
    buffer_load_dwordx4 v[132:135], v11, s[36:39], s64 offen nt
    s_mov_b32 s64, 14336
    buffer_load_dwordx4 v[104:107], v11, s[32:35], s64 offen nt
    s_mov_b64 exec, -1
    s_waitcnt vmcnt(16)
    s_waitcnt lgkmcnt(0)
    s_barrier
    s_add_u32 s41, s74, 7
    s_and_b32 s41, s41, 15
    s_lshl_b32 s42, s41, 7
    s_mul_i32 s41, s41, 393216
    s_add_u32 m0, s7, 49152
    s_add_u32 s40, s42, 0
    buffer_load_dwordx4 v4, s[8:11], s40 offen lds
    s_add_u32 m0, s7, 53248
    s_add_u32 s40, s42, 65536
    buffer_load_dwordx4 v4, s[8:11], s40 offen lds
    s_add_u32 m0, s7, 57344
    s_add_u32 s40, s42, 131072
    buffer_load_dwordx4 v4, s[8:11], s40 offen lds
    s_add_u32 m0, s7, 61440
    s_add_u32 s40, s42, 196608
    buffer_load_dwordx4 v4, s[8:11], s40 offen lds
    s_add_u32 m0, s7, 65536
    s_add_u32 s40, s41, 0
    buffer_load_dwordx4 v5, s[12:15], s40 offen lds
    s_add_u32 m0, s7, 69632
    s_add_u32 s40, s41, 196608
    buffer_load_dwordx4 v5, s[12:15], s40 offen lds
    s_add_u32 m0, s7, 73728
    s_add_u32 s40, s41, 2048
    buffer_load_dwordx4 v5, s[12:15], s40 offen lds
    s_add_u32 m0, s7, 77824
    s_add_u32 s40, s41, 198656
    buffer_load_dwordx4 v5, s[12:15], s40 offen lds
    s_add_u32 m0, s7, 81920
    s_add_u32 s40, s41, 4096
    buffer_load_dwordx4 v5, s[12:15], s40 offen lds
    s_add_u32 m0, s7, 86016
    s_add_u32 s40, s41, 200704
    buffer_load_dwordx4 v5, s[12:15], s40 offen lds
    s_waitcnt vmcnt(16)
    s_barrier
    s_add_u32 s41, s74, 8
    s_and_b32 s41, s41, 15
    s_lshl_b32 s42, s41, 7
    s_mul_i32 s41, s41, 393216
    s_add_u32 m0, s7, 90112
    s_add_u32 s40, s42, 0
    buffer_load_dwordx4 v4, s[8:11], s40 offen lds
    s_add_u32 m0, s7, 94208
    s_add_u32 s40, s42, 65536
    buffer_load_dwordx4 v4, s[8:11], s40 offen lds
    s_add_u32 m0, s7, 98304
    s_add_u32 s40, s42, 131072
    buffer_load_dwordx4 v4, s[8:11], s40 offen lds
    s_add_u32 m0, s7, 102400
    s_add_u32 s40, s42, 196608
    buffer_load_dwordx4 v4, s[8:11], s40 offen lds
    s_add_u32 m0, s7, 106496
    s_add_u32 s40, s41, 0
    buffer_load_dwordx4 v5, s[12:15], s40 offen lds
    s_add_u32 m0, s7, 110592
    s_add_u32 s40, s41, 196608
    buffer_load_dwordx4 v5, s[12:15], s40 offen lds
    s_add_u32 m0, s7, 114688
    s_add_u32 s40, s41, 2048
    buffer_load_dwordx4 v5, s[12:15], s40 offen lds
    s_add_u32 m0, s7, 118784
    s_add_u32 s40, s41, 198656
    buffer_load_dwordx4 v5, s[12:15], s40 offen lds
    s_add_u32 m0, s7, 122880
    s_add_u32 s40, s41, 4096
    buffer_load_dwordx4 v5, s[12:15], s40 offen lds
    s_add_u32 m0, s7, 126976
    s_add_u32 s40, s41, 200704
    buffer_load_dwordx4 v5, s[12:15], s40 offen lds
    s_waitcnt vmcnt(10)
    s_barrier
    s_add_u32 s41, s74, 9
    s_and_b32 s41, s41, 15
    s_lshl_b32 s42, s41, 7
    s_mul_i32 s41, s41, 393216
    s_add_u32 m0, s7, 8192
    s_add_u32 s40, s42, 0
    buffer_load_dwordx4 v4, s[8:11], s40 offen lds
    s_add_u32 m0, s7, 12288
    s_add_u32 s40, s42, 65536
    buffer_load_dwordx4 v4, s[8:11], s40 offen lds
    s_add_u32 m0, s7, 16384
    s_add_u32 s40, s42, 131072
    buffer_load_dwordx4 v4, s[8:11], s40 offen lds
    s_add_u32 m0, s7, 20480
    s_add_u32 s40, s42, 196608
    buffer_load_dwordx4 v4, s[8:11], s40 offen lds
    s_add_u32 m0, s7, 24576
    s_add_u32 s40, s41, 0
    buffer_load_dwordx4 v5, s[12:15], s40 offen lds
    s_add_u32 m0, s7, 28672
    s_add_u32 s40, s41, 196608
    buffer_load_dwordx4 v5, s[12:15], s40 offen lds
    s_add_u32 m0, s7, 32768
    s_add_u32 s40, s41, 2048
    buffer_load_dwordx4 v5, s[12:15], s40 offen lds
    s_add_u32 m0, s7, 36864
    s_add_u32 s40, s41, 198656
    buffer_load_dwordx4 v5, s[12:15], s40 offen lds
    s_add_u32 m0, s7, 40960
    s_add_u32 s40, s41, 4096
    buffer_load_dwordx4 v5, s[12:15], s40 offen lds
    s_add_u32 m0, s7, 45056
    s_add_u32 s40, s41, 200704
    buffer_load_dwordx4 v5, s[12:15], s40 offen lds
    s_cmp_lg_u32 s6, 0
    s_cbranch_scc1 H_nk
    v_mov_b32 v3, 4224
    ds_read_b128 v[72:75], v3
    ds_read_b128 v[24:27], v3 offset:16
    s_mov_b32 s65, 0
H_nspin:
    v_readfirstlane_b32 s71, v78
    s_cmp_eq_u32 s71, 0
    s_cbranch_scc1 H_nre
H_nok:
    s_lshl_b32 s64, s2, 3
    s_add_u32 s64, s64, 6717440
    v_mov_b32 v3, s64
    s_waitcnt lgkmcnt(0)
    v_max3_u32 v72, v72, v73, v74
    v_max3_u32 v24, v24, v25, v26
    v_max3_u32 v72, v72, v75, v27
    v_max_u32 v72, v72, v24
    v_xor_b32 v73, s71, v72
    s_mov_b64 exec, 1
    buffer_store_dwordx2 v[72:73], v3, s[16:19], 0 offen sc0 sc1
    s_mov_b64 exec, -1
H_nk:
    s_mov_b32 exec_lo, 0x3fff3fff
    s_mov_b32 exec_hi, 0x3fff3fff
    s_mov_b32 s64, 14336
    buffer_load_dwordx4 v[136:139], v11, s[36:39], s64 offen nt
    s_mov_b32 s64, 21504
    buffer_load_dwordx4 v[108:111], v11, s[32:35], s64 offen nt
    s_mov_b32 s64, 21504
    buffer_load_dwordx4 v[140:143], v11, s[36:39], s64 offen nt
    s_mov_b32 s64, 28672
    buffer_load_dwordx4 v[112:115], v11, s[32:35], s64 offen nt
    s_mov_b32 s64, 28672
    buffer_load_dwordx4 v[144:147], v11, s[36:39], s64 offen nt
    s_mov_b64 exec, -1
    s_waitcnt vmcnt(15)
    s_barrier
    s_add_u32 s41, s74, 10
    s_and_b32 s41, s41, 15
    s_lshl_b32 s42, s41, 7
    s_mul_i32 s41, s41, 393216
    s_add_u32 m0, s7, 49152
    s_add_u32 s40, s42, 0
    buffer_load_dwordx4 v4, s[8:11], s40 offen lds
    s_add_u32 m0, s7, 53248
    s_add_u32 s40, s42, 65536
    buffer_load_dwordx4 v4, s[8:11], s40 offen lds
    s_add_u32 m0, s7, 57344
    s_add_u32 s40, s42, 131072
    buffer_load_dwordx4 v4, s[8:11], s40 offen lds
    s_add_u32 m0, s7, 61440
    s_add_u32 s40, s42, 196608
    buffer_load_dwordx4 v4, s[8:11], s40 offen lds
    s_add_u32 m0, s7, 65536
    s_add_u32 s40, s41, 0
    buffer_load_dwordx4 v5, s[12:15], s40 offen lds
    s_add_u32 m0, s7, 69632
    s_add_u32 s40, s41, 196608
    buffer_load_dwordx4 v5, s[12:15], s40 offen lds
    s_add_u32 m0, s7, 73728
    s_add_u32 s40, s41, 2048
    buffer_load_dwordx4 v5, s[12:15], s40 offen lds
    s_add_u32 m0, s7, 77824
    s_add_u32 s40, s41, 198656
    buffer_load_dwordx4 v5, s[12:15], s40 offen lds
    s_add_u32 m0, s7, 81920
    s_add_u32 s40, s41, 4096
    buffer_load_dwordx4 v5, s[12:15], s40 offen lds
    s_add_u32 m0, s7, 86016
    s_add_u32 s40, s41, 200704
    buffer_load_dwordx4 v5, s[12:15], s40 offen lds
    s_lshl_b32 s64, s2, 2
    s_add_u32 s64, s64, s6
    s_mul_i32 s64, s64, 2048
    s_add_u32 s46, s44, s64
    s_addc_u32 s47, s45, 0
    s_load_dword s43, s[46:47], 384
    s_load_dword s43, s[46:47], 448
    s_load_dword s43, s[46:47], 1408
    s_load_dword s43, s[46:47], 1472
    s_waitcnt vmcnt(15)
    s_barrier
    s_add_u32 s41, s74, 11
    s_and_b32 s41, s41, 15
    s_lshl_b32 s42, s41, 7
    s_mul_i32 s41, s41, 393216
    s_add_u32 m0, s7, 90112
    s_add_u32 s40, s42, 0
    buffer_load_dwordx4 v4, s[8:11], s40 offen lds
    s_add_u32 m0, s7, 94208
    s_add_u32 s40, s42, 65536
    buffer_load_dwordx4 v4, s[8:11], s40 offen lds
    s_add_u32 m0, s7, 98304
    s_add_u32 s40, s42, 131072
    buffer_load_dwordx4 v4, s[8:11], s40 offen lds
    s_add_u32 m0, s7, 102400
    s_add_u32 s40, s42, 196608
    buffer_load_dwordx4 v4, s[8:11], s40 offen lds
    s_add_u32 m0, s7, 106496
    s_add_u32 s40, s41, 0
    buffer_load_dwordx4 v5, s[12:15], s40 offen lds
    s_add_u32 m0, s7, 110592
    s_add_u32 s40, s41, 196608
    buffer_load_dwordx4 v5, s[12:15], s40 offen lds
    s_add_u32 m0, s7, 114688
    s_add_u32 s40, s41, 2048
    buffer_load_dwordx4 v5, s[12:15], s40 offen lds
    s_add_u32 m0, s7, 118784
    s_add_u32 s40, s41, 198656
    buffer_load_dwordx4 v5, s[12:15], s40 offen lds
    s_add_u32 m0, s7, 122880
    s_add_u32 s40, s41, 4096
    buffer_load_dwordx4 v5, s[12:15], s40 offen lds
    s_add_u32 m0, s7, 126976
    s_add_u32 s40, s41, 200704
    buffer_load_dwordx4 v5, s[12:15], s40 offen lds
    s_waitcnt vmcnt(10)
    s_barrier
    s_add_u32 s41, s74, 12
    s_and_b32 s41, s41, 15
    s_lshl_b32 s42, s41, 7
    s_mul_i32 s41, s41, 393216
    s_add_u32 m0, s7, 8192
    s_add_u32 s40, s42, 0
    buffer_load_dwordx4 v4, s[8:11], s40 offen lds
    s_add_u32 m0, s7, 12288
    s_add_u32 s40, s42, 65536
    buffer_load_dwordx4 v4, s[8:11], s40 offen lds
    s_add_u32 m0, s7, 16384
    s_add_u32 s40, s42, 131072
    buffer_load_dwordx4 v4, s[8:11], s40 offen lds
    s_add_u32 m0, s7, 20480
    s_add_u32 s40, s42, 196608
    buffer_load_dwordx4 v4, s[8:11], s40 offen lds
    s_add_u32 m0, s7, 24576
    s_add_u32 s40, s41, 0
    buffer_load_dwordx4 v5, s[12:15], s40 offen lds
    s_add_u32 m0, s7, 28672
    s_add_u32 s40, s41, 196608
    buffer_load_dwordx4 v5, s[12:15], s40 offen lds
    s_add_u32 m0, s7, 32768
    s_add_u32 s40, s41, 2048
    buffer_load_dwordx4 v5, s[12:15], s40 offen lds
    s_add_u32 m0, s7, 36864
    s_add_u32 s40, s41, 198656
    buffer_load_dwordx4 v5, s[12:15], s40 offen lds
    s_add_u32 m0, s7, 40960
    s_add_u32 s40, s41, 4096
    buffer_load_dwordx4 v5, s[12:15], s40 offen lds
    s_add_u32 m0, s7, 45056
    s_add_u32 s40, s41, 200704
    buffer_load_dwordx4 v5, s[12:15], s40 offen lds
    s_mov_b32 exec_lo, 0x3fff3fff
    s_mov_b32 exec_hi, 0x3fff3fff
    s_mov_b32 s64, 35840
    buffer_load_dwordx4 v[116:119], v11, s[32:35], s64 offen nt
    s_mov_b32 s64, 35840
    buffer_load_dwordx4 v[148:151], v11, s[36:39], s64 offen nt
    s_mov_b32 s64, 43008
    buffer_load_dwordx4 v[120:123], v11, s[32:35], s64 offen nt
    s_mov_b32 s64, 43008
    buffer_load_dwordx4 v[152:155], v11, s[36:39], s64 offen nt
    s_mov_b32 s64, 50176
    buffer_load_dwordx4 v[124:127], v11, s[32:35], s64 offen nt
    s_mov_b32 s64, 50176
    buffer_load_dwordx4 v[156:159], v11, s[36:39], s64 offen nt
    s_mov_b64 exec, -1
    s_waitcnt vmcnt(16)
    s_barrier
    s_cmp_lg_u32 s6, 0
    s_cbranch_scc1 H_np
    s_mov_b32 s64, 6717440
    buffer_load_dwordx4 v[24:27], v6, s[16:19], s64 offen offset:0 sc1
    buffer_load_dwordx4 v[28:31], v6, s[16:19], s64 offen offset:1024 sc1
H_np:
    s_add_u32 s41, s74, 13
    s_and_b32 s41, s41, 15
    s_lshl_b32 s42, s41, 7
    s_mul_i32 s41, s41, 393216
    s_add_u32 m0, s7, 49152
    s_add_u32 s40, s42, 0
    buffer_load_dwordx4 v4, s[8:11], s40 offen lds
    s_add_u32 m0, s7, 53248
    s_add_u32 s40, s42, 65536
    buffer_load_dwordx4 v4, s[8:11], s40 offen lds
    s_add_u32 m0, s7, 57344
    s_add_u32 s40, s42, 131072
    buffer_load_dwordx4 v4, s[8:11], s40 offen lds
    s_add_u32 m0, s7, 61440
    s_add_u32 s40, s42, 196608
    buffer_load_dwordx4 v4, s[8:11], s40 offen lds
    s_add_u32 m0, s7, 65536
    s_add_u32 s40, s41, 0
    buffer_load_dwordx4 v5, s[12:15], s40 offen lds
    s_add_u32 m0, s7, 69632
    s_add_u32 s40, s41, 196608
    buffer_load_dwordx4 v5, s[12:15], s40 offen lds
    s_add_u32 m0, s7, 73728
    s_add_u32 s40, s41, 2048
    buffer_load_dwordx4 v5, s[12:15], s40 offen lds
    s_add_u32 m0, s7, 77824
    s_add_u32 s40, s41, 198656
    buffer_load_dwordx4 v5, s[12:15], s40 offen lds
    s_add_u32 m0, s7, 81920
    s_add_u32 s40, s41, 4096
    buffer_load_dwordx4 v5, s[12:15], s40 offen lds
    s_add_u32 m0, s7, 86016
    s_add_u32 s40, s41, 200704
    buffer_load_dwordx4 v5, s[12:15], s40 offen lds
    s_waitcnt vmcnt(16)
    s_barrier
    s_cmp_lg_u32 s6, 0
    s_cbranch_scc1 H_nq
    s_waitcnt vmcnt(10)
    s_mov_b32 s65, 0
H_spin:
    v_xor_b32 v25, v24, v25
    v_xor_b32 v27, v26, v27
    v_xor_b32 v29, v28, v29
    v_xor_b32 v31, v30, v31
    v_xor_b32 v3, s71, v25
    v_xor_b32 v7, s71, v27
    v_xor_b32 v25, s71, v29
    v_xor_b32 v27, s71, v31
    v_or3_b32 v3, v3, v7, v25
    v_or_b32 v3, v3, v27
    v_cmp_ne_u32 vcc, 0, v3
    s_cbranch_vccnz H_retry
H_nq:
    s_add_u32 s41, s74, 14
    s_and_b32 s41, s41, 15
    s_lshl_b32 s42, s41, 7
    s_mul_i32 s41, s41, 393216
    s_add_u32 m0, s7, 90112
    s_add_u32 s40, s42, 0
    buffer_load_dwordx4 v4, s[8:11], s40 offen lds
    v_max_u32 v3, v24, v26
    v_max3_u32 v3, v3, v28, v30
    s_nop 1
    v_max_u32_dpp v3, v3, v3 quad_perm:[1,0,3,2] row_mask:0xf bank_mask:0xf
    s_add_u32 m0, s7, 94208
    s_add_u32 s40, s42, 65536
    buffer_load_dwordx4 v4, s[8:11], s40 offen lds
    s_nop 1
    v_max_u32_dpp v3, v3, v3 quad_perm:[2,3,0,1] row_mask:0xf bank_mask:0xf
    s_nop 1
    v_max_u32_dpp v3, v3, v3 row_half_mirror row_mask:0xf bank_mask:0xf
    s_add_u32 m0, s7, 98304
    s_add_u32 s40, s42, 131072
    buffer_load_dwordx4 v4, s[8:11], s40 offen lds
    s_nop 1
    v_max_u32_dpp v3, v3, v3 row_mirror row_mask:0xf bank_mask:0xf
    s_nop 1
    v_mov_b32 v7, v3
    s_add_u32 m0, s7, 102400
    s_add_u32 s40, s42, 196608
    buffer_load_dwordx4 v4, s[8:11], s40 offen lds
    s_nop 1
    v_permlane16_swap_b32 v3, v7
    v_max_u32 v3, v3, v7
    v_mov_b32 v7, v3
    s_add_u32 m0, s7, 106496
    s_add_u32 s40, s41, 0
    buffer_load_dwordx4 v5, s[12:15], s40 offen lds
    s_nop 1
    v_permlane32_swap_b32 v3, v7
    v_max_u32 v3, v3, v7
    v_mov_b32 v7, 4256
    s_add_u32 m0, s7, 110592
    s_add_u32 s40, s41, 196608
    buffer_load_dwordx4 v5, s[12:15], s40 offen lds
    s_add_u32 m0, s7, 114688
    s_add_u32 s40, s41, 2048
    buffer_load_dwordx4 v5, s[12:15], s40 offen lds
    s_add_u32 m0, s7, 118784
    s_add_u32 s40, s41, 198656
    buffer_load_dwordx4 v5, s[12:15], s40 offen lds
    s_add_u32 m0, s7, 122880
    s_add_u32 s40, s41, 4096
    buffer_load_dwordx4 v5, s[12:15], s40 offen lds
    s_add_u32 m0, s7, 126976
    s_add_u32 s40, s41, 200704
    buffer_load_dwordx4 v5, s[12:15], s40 offen lds
    s_cmp_lg_u32 s6, 0
    s_cbranch_scc1 H_nw
    ds_write_b32 v7, v3
H_nw:
    s_waitcnt vmcnt(10)
    s_waitcnt lgkmcnt(0)
    s_barrier
    v_mov_b32 v7, 4256
    ds_read_b32 v3, v7
    s_lshl_b32 s65, s69, 6
    v_lshl_add_u32 v7, v8, 4, s65
    s_waitcnt lgkmcnt(0)
    v_readfirstlane_b32 s75, v3
    s_nop 3
    s_and_b32 s64, s75, 0x7ff
    s_sub_u32 s64, 2047, s64
    s_lshl_b32 s64, s64, 11
    buffer_load_dwordx4 v[88:91], v7, s[8:11], s64 offen
    s_add_u32 s41, s74, 15
    s_and_b32 s41, s41, 15
    s_lshl_b32 s42, s41, 7
    s_mul_i32 s41, s41, 393216
    s_add_u32 m0, s7, 8192
    s_add_u32 s40, s42, 0
    buffer_load_dwordx4 v4, s[8:11], s40 offen lds
    s_add_u32 m0, s7, 12288
    s_add_u32 s40, s42, 65536
    buffer_load_dwordx4 v4, s[8:11], s40 offen lds
    s_add_u32 m0, s7, 16384
    s_add_u32 s40, s42, 131072
    buffer_load_dwordx4 v4, s[8:11], s40 offen lds
    s_add_u32 m0, s7, 20480
    s_add_u32 s40, s42, 196608
    buffer_load_dwordx4 v4, s[8:11], s40 offen lds
    s_add_u32 m0, s7, 24576
    s_add_u32 s40, s41, 0
    buffer_load_dwordx4 v5, s[12:15], s40 offen lds
    s_add_u32 m0, s7, 28672
    s_add_u32 s40, s41, 196608
    buffer_load_dwordx4 v5, s[12:15], s40 offen lds
    s_add_u32 m0, s7, 32768
    s_add_u32 s40, s41, 2048
    buffer_load_dwordx4 v5, s[12:15], s40 offen lds
    s_add_u32 m0, s7, 36864
    s_add_u32 s40, s41, 198656
    buffer_load_dwordx4 v5, s[12:15], s40 offen lds
    s_add_u32 m0, s7, 40960
    s_add_u32 s40, s41, 4096
    buffer_load_dwordx4 v5, s[12:15], s40 offen lds
    s_add_u32 m0, s7, 45056
    s_add_u32 s40, s41, 200704
    buffer_load_dwordx4 v5, s[12:15], s40 offen lds
    s_mov_b32 s24, s54
    s_mov_b32 s25, s55
    s_mov_b32 s26, 0x700000
    s_mov_b32 s27, 0x00020000
    s_lshr_b32 s64, s2, 2
    s_mul_i32 s64, s64, 114688
    s_and_b32 s65, s2, 3
    s_lshl_b32 s65, s65, 9
    s_add_u32 s64, s64, s65
    s_lshl_b32 s65, s6, 7
    s_add_u32 s64, s64, s65
    v_lshrrev_b32 v7, 3, v2
    v_lshlrev_b32 v7, 11, v7
    v_and_b32 v9, 7, v2
    v_lshl_add_u32 v7, v9, 4, v7
    v_add_u32 v21, s64, v7
    s_mov_b32 s64, 0
    buffer_load_dwordx4 v[192:195], v21, s[24:27], s64 offen nt
    s_mov_b32 s64, 16384
    buffer_load_dwordx4 v[196:199], v21, s[24:27], s64 offen nt
    s_mov_b32 s64, 32768
    buffer_load_dwordx4 v[200:203], v21, s[24:27], s64 offen nt
    s_mov_b32 s64, 49152
    buffer_load_dwordx4 v[204:207], v21, s[24:27], s64 offen nt
    s_mov_b32 s64, 65536
    buffer_load_dwordx4 v[208:211], v21, s[24:27], s64 offen nt
    s_mov_b32 s64, 81920
    buffer_load_dwordx4 v[212:215], v21, s[24:27], s64 offen nt
    s_mov_b32 s64, 98304
    buffer_load_dwordx4 v[216:219], v21, s[24:27], s64 offen nt
    s_waitcnt vmcnt(18)
    s_barrier
    s_waitcnt vmcnt(17)
    s_and_b32 s64, s2, 7
    s_lshr_b32 s65, s2, 3
    s_and_b32 s4, s64, 3
    s_lshl_b32 s4, s4, 2
    s_and_b32 s66, s65, 3
    s_add_u32 s4, s4, s66
    s_lshr_b32 s5, s64, 2
    s_lshl_b32 s5, s5, 3
    s_lshr_b32 s66, s65, 2
    s_add_u32 s5, s5, s66
    s_mov_b32 s28, s44
    s_mov_b32 s29, s45
    s_mov_b32 s30, 0x200000
    s_mov_b32 s31, 0x00020000
    v_lshrrev_b32 v7, 3, v2
    s_lshl_b32 s64, s6, 3
    v_add_u32 v7, s64, v7
    v_lshlrev_b32 v7, 11, v7
    v_lshrrev_b32 v9, 4, v2
    v_lshlrev_b32 v9, 1, v9
    v_and_b32 v10, 7, v2
    v_xor_b32 v9, v9, v10
    v_lshl_add_u32 v7, v9, 4, v7
    s_lshl_b32 s64, s5, 7
    v_add_u32 v10, s64, v7
    s_add_u32 m0, s7, 131072
    s_mov_b32 s40, 0
    buffer_load_dwordx4 v10, s[28:31], s40 offen lds
    v_and_b32 v48, 15, v2
    v_and_b32 v49, 1, v2
    v_lshlrev_b32 v49, 4, v49
    v_mov_b32 v50, 0xffff
    v_lshlrev_b32 v49, v49, v50
    v_lshrrev_b32 v48, 1, v48
    v_cmp_eq_u32 vcc, 0, v48
    s_nop 1
    v_cndmask_b32 v40, 0, v49, vcc
    v_cmp_eq_u32 vcc, 1, v48
    s_nop 1
    v_cndmask_b32 v41, 0, v49, vcc
    v_cmp_eq_u32 vcc, 2, v48
    s_nop 1
    v_cndmask_b32 v42, 0, v49, vcc
    v_cmp_eq_u32 vcc, 3, v48
    s_nop 1
    v_cndmask_b32 v43, 0, v49, vcc
    s_mov_b32 s64, 0x01000100
    s_mov_b32 s65, 0x03020302
    v_perm_b32 v48, v88, v88, s64
    v_and_b32 v44, v48, v40
    v_and_b32 v45, v48, v41
    v_and_b32 v46, v48, v42
    s_add_u32 m0, s7, 135168
    s_mov_b32 s40, 65536
    buffer_load_dwordx4 v10, s[28:31], s40 offen lds
    v_and_b32 v47, v48, v43
    s_nop 1
    v_mfma_f32_16x16x32_bf16 v[32:35], v[44:47], v[96:99], 0
    v_mfma_f32_16x16x32_bf16 v[36:39], v[44:47], v[128:131], 0
    v_perm_b32 v48, v88, v88, s65
    v_and_b32 v52, v48, v40
    v_and_b32 v53, v48, v41
    v_and_b32 v54, v48, v42
    v_and_b32 v55, v48, v43
    s_nop 1
    v_mfma_f32_16x16x32_bf16 v[32:35], v[52:55], v[100:103], v[32:35]
    v_mfma_f32_16x16x32_bf16 v[36:39], v[52:55], v[132:135], v[36:39]
    v_perm_b32 v48, v89, v89, s64
    v_and_b32 v44, v48, v40
    v_and_b32 v45, v48, v41
    v_and_b32 v46, v48, v42
    v_and_b32 v47, v48, v43
    s_nop 1
    v_mfma_f32_16x16x32_bf16 v[32:35], v[44:47], v[104:107], v[32:35]
    v_mfma_f32_16x16x32_bf16 v[36:39], v[44:47], v[136:139], v[36:39]
    v_perm_b32 v48, v89, v89, s65
    v_and_b32 v52, v48, v40
    v_and_b32 v53, v48, v41
    v_and_b32 v54, v48, v42
    s_add_u32 m0, s7, 147456
    s_mov_b32 s40, 1048576
    buffer_load_dwordx4 v10, s[28:31], s40 offen lds
    v_and_b32 v55, v48, v43
    s_nop 1
    v_mfma_f32_16x16x32_bf16 v[32:35], v[52:55], v[108:111], v[32:35]
    v_mfma_f32_16x16x32_bf16 v[36:39], v[52:55], v[140:143], v[36:39]
    v_perm_b32 v48, v90, v90, s64
    v_and_b32 v44, v48, v40
    v_and_b32 v45, v48, v41
    v_and_b32 v46, v48, v42
    v_and_b32 v47, v48, v43
    s_nop 1
    v_mfma_f32_16x16x32_bf16 v[32:35], v[44:47], v[112:115], v[32:35]
    v_mfma_f32_16x16x32_bf16 v[36:39], v[44:47], v[144:147], v[36:39]
    v_perm_b32 v48, v90, v90, s65
    v_and_b32 v52, v48, v40
    v_and_b32 v53, v48, v41
    v_and_b32 v54, v48, v42
    v_and_b32 v55, v48, v43
    s_nop 1
    v_mfma_f32_16x16x32_bf16 v[32:35], v[52:55], v[116:119], v[32:35]
    v_mfma_f32_16x16x32_bf16 v[36:39], v[52:55], v[148:151], v[36:39]
    v_perm_b32 v48, v91, v91, s64
    v_and_b32 v44, v48, v40
    v_and_b32 v45, v48, v41
    v_and_b32 v46, v48, v42
    s_add_u32 m0, s7, 151552
    s_mov_b32 s40, 1114112
    buffer_load_dwordx4 v10, s[28:31], s40 offen lds
    v_and_b32 v47, v48, v43
    s_nop 1
    v_mfma_f32_16x16x32_bf16 v[32:35], v[44:47], v[120:123], v[32:35]
    v_mfma_f32_16x16x32_bf16 v[36:39], v[44:47], v[152:155], v[36:39]
    v_perm_b32 v48, v91, v91, s65
    v_and_b32 v52, v48, v40
    v_and_b32 v53, v48, v41
    v_and_b32 v54, v48, v42
    v_and_b32 v55, v48, v43
    s_nop 1
    v_mfma_f32_16x16x32_bf16 v[32:35], v[52:55], v[124:127], v[32:35]
    v_mfma_f32_16x16x32_bf16 v[36:39], v[52:55], v[156:159], v[36:39]
    s_nop 7
    v_permlane32_swap_b32 v32, v36
    v_permlane32_swap_b32 v33, v37
    v_permlane32_swap_b32 v34, v38
    v_permlane32_swap_b32 v35, v39
    s_mov_b32 exec_lo, 0x3fff3fff
    s_mov_b32 exec_hi, 0x3fff3fff
    buffer_store_dwordx4 v[32:35], v12, s[16:19], 0 offen sc0 sc1
    s_mov_b64 exec, -1
    s_waitcnt vmcnt(12)
    s_barrier
    s_add_u32 m0, s7, 139264
    s_mov_b32 s40, 131072
    buffer_load_dwordx4 v10, s[28:31], s40 offen lds
    s_add_u32 m0, s7, 143360
    s_mov_b32 s40, 196608
    buffer_load_dwordx4 v10, s[28:31], s40 offen lds
    s_add_u32 m0, s7, 155648
    s_mov_b32 s40, 1179648
    buffer_load_dwordx4 v10, s[28:31], s40 offen lds
    s_add_u32 m0, s7, 159744
    s_mov_b32 s40, 1245184
    buffer_load_dwordx4 v10, s[28:31], s40 offen lds
    s_add_u32 m0, s7, 73728
    s_mov_b32 s40, 262144
    buffer_load_dwordx4 v10, s[28:31], s40 offen lds
    s_add_u32 m0, s7, 77824
    s_mov_b32 s40, 327680
    buffer_load_dwordx4 v10, s[28:31], s40 offen lds
    s_add_u32 m0, s7, 81920
    s_mov_b32 s40, 1310720
    buffer_load_dwordx4 v10, s[28:31], s40 offen lds
    s_add_u32 m0, s7, 86016
    s_mov_b32 s40, 1376256
    buffer_load_dwordx4 v10, s[28:31], s40 offen lds
    s_barrier
    s_and_b32 s64, s3, 3
    s_lshl_b32 s64, s64, 1
    s_lshr_b32 s65, s3, 2
    s_add_u32 s64, s64, s65
    s_lshl_b32 s64, s64, 4
    s_lshl_b32 s65, s4, 7
    s_add_u32 s64, s64, s65
    v_and_b32 v230, 15, v2
    v_add_u32 v230, s64, v230
    v_bfe_u32 v3, v2, 4, 1
    v_lshlrev_b32 v229, 5, v3
    v_lshrrev_b32 v3, 5, v2
    v_lshl_add_u32 v229, v3, 4, v229
    v_lshl_add_u32 v231, v230, 11, v229
    s_lshl_b32 s64, s5, 7
    v_add_u32 v231, s64, v231
    v_lshlrev_b32 v3, 2, v230
    v_add_u32 v3, 6709248, v3
    buffer_load_dwordx4 v[220:223], v231, s[8:11], 0 offen
    buffer_load_dwordx4 v[224:227], v231, s[8:11], 0 offen offset:64
    buffer_load_dword v228, v3, s[16:19], 0 offen sc1
    s_add_u32 m0, s7, 114688
    s_mov_b32 s40, 393216
    buffer_load_dwordx4 v10, s[28:31], s40 offen lds
    s_add_u32 m0, s7, 118784
    s_mov_b32 s40, 458752
    buffer_load_dwordx4 v10, s[28:31], s40 offen lds
    s_add_u32 m0, s7, 122880
    s_mov_b32 s40, 1441792
    buffer_load_dwordx4 v10, s[28:31], s40 offen lds
    s_add_u32 m0, s7, 126976
    s_mov_b32 s40, 1507328
    buffer_load_dwordx4 v10, s[28:31], s40 offen lds
    s_add_u32 m0, s7, 40960
    s_mov_b32 s40, 524288
    buffer_load_dwordx4 v10, s[28:31], s40 offen lds
    s_add_u32 m0, s7, 45056
    s_mov_b32 s40, 589824
    buffer_load_dwordx4 v10, s[28:31], s40 offen lds
    s_add_u32 m0, s7, 49152
    s_mov_b32 s40, 1572864
    buffer_load_dwordx4 v10, s[28:31], s40 offen lds
    s_add_u32 m0, s7, 53248
    s_mov_b32 s40, 1638400
    buffer_load_dwordx4 v10, s[28:31], s40 offen lds
    s_add_u32 m0, s7, 8192
    s_mov_b32 s40, 655360
    buffer_load_dwordx4 v10, s[28:31], s40 offen lds
    s_add_u32 m0, s7, 12288
    s_mov_b32 s40, 720896
    buffer_load_dwordx4 v10, s[28:31], s40 offen lds
    s_add_u32 m0, s7, 57344
    s_mov_b32 s40, 1703936
    buffer_load_dwordx4 v10, s[28:31], s40 offen lds
    s_add_u32 m0, s7, 61440
    s_mov_b32 s40, 1769472
    buffer_load_dwordx4 v10, s[28:31], s40 offen lds
    s_add_u32 m0, s7, 16384
    s_mov_b32 s40, 786432
    buffer_load_dwordx4 v10, s[28:31], s40 offen lds
    s_add_u32 m0, s7, 20480
    s_mov_b32 s40, 851968
    buffer_load_dwordx4 v10, s[28:31], s40 offen lds
    s_add_u32 m0, s7, 65536
    s_mov_b32 s40, 1835008
    buffer_load_dwordx4 v10, s[28:31], s40 offen lds
    s_add_u32 m0, s7, 69632
    s_mov_b32 s40, 1900544
    buffer_load_dwordx4 v10, s[28:31], s40 offen lds
    s_add_u32 m0, s7, 98304
    s_mov_b32 s40, 917504
    buffer_load_dwordx4 v10, s[28:31], s40 offen lds
    s_add_u32 m0, s7, 102400
    s_mov_b32 s40, 983040
    buffer_load_dwordx4 v10, s[28:31], s40 offen lds
    s_add_u32 m0, s7, 90112
    s_mov_b32 s40, 1966080
    buffer_load_dwordx4 v10, s[28:31], s40 offen lds
    s_add_u32 m0, s7, 94208
    s_mov_b32 s40, 2031616
    buffer_load_dwordx4 v10, s[28:31], s40 offen lds
    s_mov_b64 exec, 1
    v_mov_b32 v20, 0
    buffer_atomic_or v20, v23, s[16:19], 0 offen sc0
    s_mov_b64 exec, -1
    v_lshlrev_b32 v17, 4, v2
    v_add_u32 v17, s70, v17
    v_lshrrev_b32 v18, 2, v2
    v_mul_u32_u24 v18, 1152, v18
    v_and_b32 v19, 3, v2
    v_lshl_add_u32 v18, v19, 4, v18
    s_add_u32 s64, s70, 1024
    v_add_u32 v18, s64, v18
    v_bfe_u32 v26, v2, 3, 1
    v_lshl_add_u32 v26, v26, 2, v19
    v_bfe_u32 v27, v2, 2, 1
    v_lshrrev_b32 v28, 5, v2
    v_cmp_eq_u32 vcc, v27, v28
    v_and_b32 v27, 16, v2
    v_cmp_eq_u32 s[64:65], 0, v27
    s_and_b64 vcc, vcc, s[64:65]
    v_and_b32 v27, 1, v26
    v_lshlrev_b32 v27, 4, v27
    v_mov_b32 v28, 0x3f80
    v_lshlrev_b32 v27, v27, v28
    v_cndmask_b32 v27, 0, v27, vcc
    v_lshrrev_b32 v26, 1, v26
    v_cmp_eq_u32 vcc, 0, v26
    s_nop 1
    v_cndmask_b32 v48, 0, v27, vcc
    v_cmp_eq_u32 vcc, 1, v26
    s_nop 1
    v_cndmask_b32 v49, 0, v27, vcc
    v_cmp_eq_u32 vcc, 2, v26
    s_nop 1
    v_cndmask_b32 v50, 0, v27, vcc
    v_cmp_eq_u32 vcc, 3, v26
    s_nop 1
    v_cndmask_b32 v51, 0, v27, vcc
    v_mov_b32 v128, 0
    v_mov_b32 v129, 0
    v_mov_b32 v130, 0
    v_mov_b32 v131, 0
    v_mov_b32 v132, 0
    v_mov_b32 v133, 0
    v_mov_b32 v134, 0
    v_mov_b32 v135, 0
    v_mov_b32 v136, 0
    v_mov_b32 v137, 0
    v_mov_b32 v138, 0
    v_mov_b32 v139, 0
    v_mov_b32 v140, 0
    v_mov_b32 v141, 0
    v_mov_b32 v142, 0
    v_mov_b32 v143, 0
    s_mov_b32 s66, 0xffff
    s_mov_b32 s65, 0
    s_waitcnt vmcnt(21)
    v_sub_f32 v248, 1.0, v228
    v_cvt_pk_bf16_f32 v248, v248, v248
    v_lshlrev_b32 v248, 16, v248
    v_lshlrev_b32 v232, 16, v220
    v_and_b32 v233, 0xffff0000, v220
    v_mul_f32 v232, v232, v248
    v_mul_f32 v233, v233, v248
    v_cvt_pk_bf16_f32 v3, v232, v233
    v_lshlrev_b32 v232, 16, v3
    v_and_b32 v233, 0xffff0000, v3
    v_lshlrev_b32 v234, 16, v221
    v_and_b32 v235, 0xffff0000, v221
    v_mul_f32 v234, v234, v248
    v_mul_f32 v235, v235, v248
    v_cvt_pk_bf16_f32 v3, v234, v235
    v_lshlrev_b32 v234, 16, v3
    v_and_b32 v235, 0xffff0000, v3
    v_lshlrev_b32 v236, 16, v222
    v_and_b32 v237, 0xffff0000, v222
    v_mul_f32 v236, v236, v248
    v_mul_f32 v237, v237, v248
    v_cvt_pk_bf16_f32 v3, v236, v237
    v_lshlrev_b32 v236, 16, v3
    v_and_b32 v237, 0xffff0000, v3
    v_lshlrev_b32 v238, 16, v223
    v_and_b32 v239, 0xffff0000, v223
    v_mul_f32 v238, v238, v248
    v_mul_f32 v239, v239, v248
    v_cvt_pk_bf16_f32 v3, v238, v239
    v_lshlrev_b32 v238, 16, v3
    v_and_b32 v239, 0xffff0000, v3
    v_lshlrev_b32 v240, 16, v224
    v_and_b32 v241, 0xffff0000, v224
    v_mul_f32 v240, v240, v248
    v_mul_f32 v241, v241, v248
    v_cvt_pk_bf16_f32 v3, v240, v241
    v_lshlrev_b32 v240, 16, v3
    v_and_b32 v241, 0xffff0000, v3
    v_lshlrev_b32 v242, 16, v225
    v_and_b32 v243, 0xffff0000, v225
    v_mul_f32 v242, v242, v248
    v_mul_f32 v243, v243, v248
    v_cvt_pk_bf16_f32 v3, v242, v243
    v_lshlrev_b32 v242, 16, v3
    v_and_b32 v243, 0xffff0000, v3
    v_lshlrev_b32 v244, 16, v226
    v_and_b32 v245, 0xffff0000, v226
    v_mul_f32 v244, v244, v248
    v_mul_f32 v245, v245, v248
    v_cvt_pk_bf16_f32 v3, v244, v245
    v_lshlrev_b32 v244, 16, v3
    v_and_b32 v245, 0xffff0000, v3
    v_lshlrev_b32 v246, 16, v227
    v_and_b32 v247, 0xffff0000, v227
    v_mul_f32 v246, v246, v248
    v_mul_f32 v247, v247, v248
    v_cvt_pk_bf16_f32 v3, v246, v247
    v_lshlrev_b32 v246, 16, v3
    v_and_b32 v247, 0xffff0000, v3
    s_waitcnt vmcnt(0)
G_loop:
    v_readfirstlane_b32 s68, v20
    s_and_b32 s68, s68, s66
G_new:
    s_andn2_b32 s66, s66, s68
    s_bcnt1_i32_b32 s67, s68
    s_cmp_eq_u32 s67, 0
    s_cbranch_scc1 G_l0
    s_cmp_gt_u32 s67, 8
    s_cbranch_scc1 G_lt_2
    s_cmp_gt_u32 s67, 4
    s_cbranch_scc1 G_lt_3
    s_cmp_gt_u32 s67, 2
    s_cbranch_scc1 G_lt_4
    s_cmp_eq_u32 s67, 1
    s_cbranch_scc1 G_l1
    s_branch G_l2
G_lt_4:
    s_cmp_eq_u32 s67, 3
    s_cbranch_scc1 G_l3
    s_branch G_l4
G_lt_3:
    s_cmp_gt_u32 s67, 6
    s_cbranch_scc1 G_lt_5
    s_cmp_eq_u32 s67, 5
    s_cbranch_scc1 G_l5
    s_branch G_l6
G_lt_5:
    s_cmp_eq_u32 s67, 7
    s_cbranch_scc1 G_l7
    s_branch G_l8
G_lt_2:
    s_cmp_gt_u32 s67, 12
    s_cbranch_scc1 G_lt_6
    s_cmp_gt_u32 s67, 10
    s_cbranch_scc1 G_lt_7
    s_cmp_eq_u32 s67, 9
    s_cbranch_scc1 G_l9
    s_branch G_l10
G_lt_7:
    s_cmp_eq_u32 s67, 11
    s_cbranch_scc1 G_l11
    s_branch G_l12
G_lt_6:
    s_cmp_gt_u32 s67, 14
    s_cbranch_scc1 G_lt_8
    s_cmp_eq_u32 s67, 13
    s_cbranch_scc1 G_l13
    s_branch G_l14
G_lt_8:
    s_cmp_eq_u32 s67, 15
    s_cbranch_scc1 G_l15
G_l16:
    s_ff1_i32_b32 s55, s68
    s_bitset0_b32 s68, s55
    s_mul_i32 s64, s55, 1152
    buffer_load_dwordx4 v[124:127], v17, s[16:19], s64 offen sc1
G_l15:
    s_ff1_i32_b32 s54, s68
    s_bitset0_b32 s68, s54
    s_mul_i32 s64, s54, 1152
    buffer_load_dwordx4 v[120:123], v17, s[16:19], s64 offen sc1
G_l14:
    s_ff1_i32_b32 s53, s68
    s_bitset0_b32 s68, s53
    s_mul_i32 s64, s53, 1152
    buffer_load_dwordx4 v[116:119], v17, s[16:19], s64 offen sc1
G_l13:
    s_ff1_i32_b32 s52, s68
    s_bitset0_b32 s68, s52
    s_mul_i32 s64, s52, 1152
    buffer_load_dwordx4 v[112:115], v17, s[16:19], s64 offen sc1
G_l12:
    s_ff1_i32_b32 s51, s68
    s_bitset0_b32 s68, s51
    s_mul_i32 s64, s51, 1152
    buffer_load_dwordx4 v[108:111], v17, s[16:19], s64 offen sc1
G_l11:
    s_ff1_i32_b32 s50, s68
    s_bitset0_b32 s68, s50
    s_mul_i32 s64, s50, 1152
    buffer_load_dwordx4 v[104:107], v17, s[16:19], s64 offen sc1
G_l10:
    s_ff1_i32_b32 s49, s68
    s_bitset0_b32 s68, s49
    s_mul_i32 s64, s49, 1152
    buffer_load_dwordx4 v[100:103], v17, s[16:19], s64 offen sc1
G_l9:
    s_ff1_i32_b32 s48, s68
    s_bitset0_b32 s68, s48
    s_mul_i32 s64, s48, 1152
    buffer_load_dwordx4 v[96:99], v17, s[16:19], s64 offen sc1
G_l8:
    s_ff1_i32_b32 s47, s68
    s_bitset0_b32 s68, s47
    s_mul_i32 s64, s47, 1152
    buffer_load_dwordx4 v[92:95], v17, s[16:19], s64 offen sc1
G_l7:
    s_ff1_i32_b32 s46, s68
    s_bitset0_b32 s68, s46
    s_mul_i32 s64, s46, 1152
    buffer_load_dwordx4 v[88:91], v17, s[16:19], s64 offen sc1
G_l6:
    s_ff1_i32_b32 s45, s68
    s_bitset0_b32 s68, s45
    s_mul_i32 s64, s45, 1152
    buffer_load_dwordx4 v[84:87], v17, s[16:19], s64 offen sc1
G_l5:
    s_ff1_i32_b32 s44, s68
    s_bitset0_b32 s68, s44
    s_mul_i32 s64, s44, 1152
    buffer_load_dwordx4 v[80:83], v17, s[16:19], s64 offen sc1
G_l4:
    s_ff1_i32_b32 s43, s68
    s_bitset0_b32 s68, s43
    s_mul_i32 s64, s43, 1152
    buffer_load_dwordx4 v[76:79], v17, s[16:19], s64 offen sc1
G_l3:
    s_ff1_i32_b32 s42, s68
    s_bitset0_b32 s68, s42
    s_mul_i32 s64, s42, 1152
    buffer_load_dwordx4 v[72:75], v17, s[16:19], s64 offen sc1
G_l2:
    s_ff1_i32_b32 s41, s68
    s_bitset0_b32 s68, s41
    s_mul_i32 s64, s41, 1152
    buffer_load_dwordx4 v[68:71], v17, s[16:19], s64 offen sc1
G_l1:
    s_ff1_i32_b32 s40, s68
    s_bitset0_b32 s68, s40
    s_mul_i32 s64, s40, 1152
    buffer_load_dwordx4 v[64:67], v17, s[16:19], s64 offen sc1
G_l0:
    s_mov_b32 s68, s66
    s_cmp_eq_u32 s66, 0
    s_cbranch_scc1 G_z
    s_cmp_lg_u32 s67, 0
    s_cbranch_scc1 G_p
    s_sleep 2
G_p:
    s_mov_b64 exec, 1
    v_mov_b32 v20, 0
    buffer_atomic_or v20, v23, s[16:19], 0 offen sc0
    s_mov_b64 exec, -1
    s_branch G_proc
G_z:
    buffer_load_dwordx4 v[56:59], v18, s[16:19], 0 offen sc1
G_proc:
    s_cmp_eq_u32 s67, 0
    s_cbranch_scc1 G_q0
    s_cmp_gt_u32 s67, 8
    s_cbranch_scc1 G_qt_9
    s_cmp_gt_u32 s67, 4
    s_cbranch_scc1 G_qt_10
    s_cmp_gt_u32 s67, 2
    s_cbranch_scc1 G_qt_11
    s_cmp_eq_u32 s67, 1
    s_cbranch_scc1 G_q1
    s_branch G_q2
G_qt_11:
    s_cmp_eq_u32 s67, 3
    s_cbranch_scc1 G_q3
    s_branch G_q4
G_qt_10:
    s_cmp_gt_u32 s67, 6
    s_cbranch_scc1 G_qt_12
    s_cmp_eq_u32 s67, 5
    s_cbranch_scc1 G_q5
    s_branch G_q6
G_qt_12:
    s_cmp_eq_u32 s67, 7
    s_cbranch_scc1 G_q7
    s_branch G_q8
G_qt_9:
    s_cmp_gt_u32 s67, 12
    s_cbranch_scc1 G_qt_13
    s_cmp_gt_u32 s67, 10
    s_cbranch_scc1 G_qt_14
    s_cmp_eq_u32 s67, 9
    s_cbranch_scc1 G_q9
    s_branch G_q10
G_qt_14:
    s_cmp_eq_u32 s67, 11
    s_cbranch_scc1 G_q11
    s_branch G_q12
G_qt_13:
    s_cmp_gt_u32 s67, 14
    s_cbranch_scc1 G_qt_15
    s_cmp_eq_u32 s67, 13
    s_cbranch_scc1 G_q13
    s_branch G_q14
G_qt_15:
    s_cmp_eq_u32 s67, 15
    s_cbranch_scc1 G_q15
G_q16:
    s_waitcnt vmcnt(16)
    v_max3_u32 v21, v124, v125, v126
    v_max_u32 v21, v21, v127
    v_cmp_eq_u32 vcc, -1, v21
    s_cbranch_vccnz G_f15
    v_mfma_f32_32x32x16_bf16 v[128:143], v[48:51], v[124:127], v[128:143]
G_q15:
    s_waitcnt vmcnt(15)
    v_max3_u32 v21, v120, v121, v122
    v_max_u32 v21, v21, v123
    v_cmp_eq_u32 vcc, -1, v21
    s_cbranch_vccnz G_f14
    v_mfma_f32_32x32x16_bf16 v[128:143], v[48:51], v[120:123], v[128:143]
G_q14:
    s_waitcnt vmcnt(14)
    v_max3_u32 v21, v116, v117, v118
    v_max_u32 v21, v21, v119
    v_cmp_eq_u32 vcc, -1, v21
    s_cbranch_vccnz G_f13
    v_mfma_f32_32x32x16_bf16 v[128:143], v[48:51], v[116:119], v[128:143]
G_q13:
    s_waitcnt vmcnt(13)
    v_max3_u32 v21, v112, v113, v114
    v_max_u32 v21, v21, v115
    v_cmp_eq_u32 vcc, -1, v21
    s_cbranch_vccnz G_f12
    v_mfma_f32_32x32x16_bf16 v[128:143], v[48:51], v[112:115], v[128:143]
G_q12:
    s_waitcnt vmcnt(12)
    v_max3_u32 v21, v108, v109, v110
    v_max_u32 v21, v21, v111
    v_cmp_eq_u32 vcc, -1, v21
    s_cbranch_vccnz G_f11
    v_mfma_f32_32x32x16_bf16 v[128:143], v[48:51], v[108:111], v[128:143]
G_q11:
    s_waitcnt vmcnt(11)
    v_max3_u32 v21, v104, v105, v106
    v_max_u32 v21, v21, v107
    v_cmp_eq_u32 vcc, -1, v21
    s_cbranch_vccnz G_f10
    v_mfma_f32_32x32x16_bf16 v[128:143], v[48:51], v[104:107], v[128:143]
G_q10:
    s_waitcnt vmcnt(10)
    v_max3_u32 v21, v100, v101, v102
    v_max_u32 v21, v21, v103
    v_cmp_eq_u32 vcc, -1, v21
    s_cbranch_vccnz G_f9
    v_mfma_f32_32x32x16_bf16 v[128:143], v[48:51], v[100:103], v[128:143]
G_q9:
    s_waitcnt vmcnt(9)
    v_max3_u32 v21, v96, v97, v98
    v_max_u32 v21, v21, v99
    v_cmp_eq_u32 vcc, -1, v21
    s_cbranch_vccnz G_f8
    v_mfma_f32_32x32x16_bf16 v[128:143], v[48:51], v[96:99], v[128:143]
G_q8:
    s_waitcnt vmcnt(8)
    v_max3_u32 v21, v92, v93, v94
    v_max_u32 v21, v21, v95
    v_cmp_eq_u32 vcc, -1, v21
    s_cbranch_vccnz G_f7
    v_mfma_f32_32x32x16_bf16 v[128:143], v[48:51], v[92:95], v[128:143]
G_q7:
    s_waitcnt vmcnt(7)
    v_max3_u32 v21, v88, v89, v90
    v_max_u32 v21, v21, v91
    v_cmp_eq_u32 vcc, -1, v21
    s_cbranch_vccnz G_f6
    v_mfma_f32_32x32x16_bf16 v[128:143], v[48:51], v[88:91], v[128:143]
G_q6:
    s_waitcnt vmcnt(6)
    v_max3_u32 v21, v84, v85, v86
    v_max_u32 v21, v21, v87
    v_cmp_eq_u32 vcc, -1, v21
    s_cbranch_vccnz G_f5
    v_mfma_f32_32x32x16_bf16 v[128:143], v[48:51], v[84:87], v[128:143]
G_q5:
    s_waitcnt vmcnt(5)
    v_max3_u32 v21, v80, v81, v82
    v_max_u32 v21, v21, v83
    v_cmp_eq_u32 vcc, -1, v21
    s_cbranch_vccnz G_f4
    v_mfma_f32_32x32x16_bf16 v[128:143], v[48:51], v[80:83], v[128:143]
G_q4:
    s_waitcnt vmcnt(4)
    v_max3_u32 v21, v76, v77, v78
    v_max_u32 v21, v21, v79
    v_cmp_eq_u32 vcc, -1, v21
    s_cbranch_vccnz G_f3
    v_mfma_f32_32x32x16_bf16 v[128:143], v[48:51], v[76:79], v[128:143]
G_q3:
    s_waitcnt vmcnt(3)
    v_max3_u32 v21, v72, v73, v74
    v_max_u32 v21, v21, v75
    v_cmp_eq_u32 vcc, -1, v21
    s_cbranch_vccnz G_f2
    v_mfma_f32_32x32x16_bf16 v[128:143], v[48:51], v[72:75], v[128:143]
G_q2:
    s_waitcnt vmcnt(2)
    v_max3_u32 v21, v68, v69, v70
    v_max_u32 v21, v21, v71
    v_cmp_eq_u32 vcc, -1, v21
    s_cbranch_vccnz G_f1
    v_mfma_f32_32x32x16_bf16 v[128:143], v[48:51], v[68:71], v[128:143]
G_q1:
    s_waitcnt vmcnt(1)
    v_max3_u32 v21, v64, v65, v66
    v_max_u32 v21, v21, v67
    v_cmp_eq_u32 vcc, -1, v21
    s_cbranch_vccnz G_f0
    v_mfma_f32_32x32x16_bf16 v[128:143], v[48:51], v[64:67], v[128:143]
G_q0:
    s_waitcnt vmcnt(0)
G_chk:
    s_add_u32 s65, s65, 1
    s_cmp_ge_u32 s65, 40000
    s_cbranch_scc1 G_done
    s_cmp_lg_u32 s68, 0
    s_cbranch_scc1 G_loop
    v_mov_b32 v20, -1
    s_cmp_lg_u32 s66, 0
    s_cbranch_scc1 G_loop
    v_max3_u32 v21, v56, v57, v58
    v_max_u32 v21, v21, v59
    v_cmp_eq_u32 vcc, -1, v21
    s_cbranch_vccnz G_loop
G_done:
    v_add_u32 v16, s7, v6
    v_add_f32_dpp v56, v56, v56 row_ror:4 row_mask:0xf bank_mask:0xf
    v_add_f32_dpp v57, v57, v57 row_ror:4 row_mask:0xf bank_mask:0xf
    v_add_f32_dpp v58, v58, v58 row_ror:4 row_mask:0xf bank_mask:0xf
    v_add_f32_dpp v59, v59, v59 row_ror:4 row_mask:0xf bank_mask:0xf
    v_add_f32_dpp v56, v56, v56 row_ror:8 row_mask:0xf bank_mask:0xf
    v_add_f32_dpp v57, v57, v57 row_ror:8 row_mask:0xf bank_mask:0xf
    v_add_f32_dpp v58, v58, v58 row_ror:8 row_mask:0xf bank_mask:0xf
    v_add_f32_dpp v59, v59, v59 row_ror:8 row_mask:0xf bank_mask:0xf
    v_mov_b32 v64, v56
    v_mov_b32 v65, v57
    v_mov_b32 v66, v58
    v_mov_b32 v67, v59
    s_nop 0
    v_permlane16_swap_b32 v56, v64
    v_permlane16_swap_b32 v57, v65
    v_permlane16_swap_b32 v58, v66
    v_permlane16_swap_b32 v59, v67
    v_add_f32 v56, v56, v64
    v_add_f32 v57, v57, v65
    v_add_f32 v58, v58, v66
    v_add_f32 v59, v59, v67
    v_mov_b32 v64, v56
    v_mov_b32 v65, v57
    v_mov_b32 v66, v58
    v_mov_b32 v67, v59
    s_nop 0
    v_permlane32_swap_b32 v56, v64
    v_permlane32_swap_b32 v57, v65
    v_permlane32_swap_b32 v58, v66
    v_permlane32_swap_b32 v59, v67
    v_add_f32 v56, v56, v64
    v_add_f32 v57, v57, v65
    v_add_f32 v58, v58, v66
    v_add_f32 v59, v59, v67
    v_cvt_pk_bf16_f32 v60, v128, v129
    v_cvt_pk_bf16_f32 v61, v130, v131
    v_cvt_pk_bf16_f32 v62, v132, v133
    v_cvt_pk_bf16_f32 v63, v134, v135
    ds_write_b128 v16, v[60:63] offset:0
    v_cvt_pk_bf16_f32 v56, v56, v57
    v_cvt_pk_bf16_f32 v57, v58, v59
    s_lshr_b32 s64, s6, 1
    s_lshl_b32 s64, s64, 6
    s_and_b32 s65, s6, 1
    s_lshl_b32 s65, s65, 3
    s_add_u32 s64, s64, s65
    v_lshl_add_u32 v16, v2, 4, s64
    s_mov_b64 exec, 15
    ds_write_b64 v16, v[56:57] offset:4096
    s_mov_b64 exec, -1
    s_waitcnt vmcnt(0) lgkmcnt(0)
    s_barrier
    v_lshrrev_b32 v18, 3, v2
    v_lshlrev_b32 v18, 2, v18
    ds_read_b32 v24, v18 offset:4352
    ds_read_b32 v25, v18 offset:4384
    ds_read_b32 v26, v18 offset:4416
    ds_read_b32 v27, v18 offset:4448
    ds_read_b32 v28, v18 offset:4480
    ds_read_b32 v29, v18 offset:4512
    ds_read_b32 v30, v18 offset:4544
    s_waitcnt lgkmcnt(0)
    s_mov_b32 s64, 0x05040100
    s_mov_b32 s65, 0x07060302
    v_cvt_pk_bf16_f32 v24, v24, v25
    v_cvt_pk_bf16_f32 v25, v26, v27
    v_cvt_pk_bf16_f32 v26, v28, v29
    v_cvt_pk_bf16_f32 v27, v30, 0
    v_perm_b32 v48, v196, v192, s64
    v_perm_b32 v49, v196, v192, s65
    v_dot2_f32_bf16 v32, v48, v24, 0
    v_dot2_f32_bf16 v33, v49, v24, 0
    v_perm_b32 v50, v197, v193, s64
    v_perm_b32 v51, v197, v193, s65
    v_dot2_f32_bf16 v34, v50, v24, 0
    v_dot2_f32_bf16 v35, v51, v24, 0
    v_perm_b32 v48, v198, v194, s64
    v_perm_b32 v49, v198, v194, s65
    v_dot2_f32_bf16 v36, v48, v24, 0
    v_dot2_f32_bf16 v37, v49, v24, 0
    v_perm_b32 v50, v199, v195, s64
    v_perm_b32 v51, v199, v195, s65
    v_dot2_f32_bf16 v38, v50, v24, 0
    v_dot2_f32_bf16 v39, v51, v24, 0
    v_perm_b32 v48, v204, v200, s64
    v_perm_b32 v49, v204, v200, s65
    v_dot2_f32_bf16 v32, v48, v25, v32
    v_dot2_f32_bf16 v33, v49, v25, v33
    v_perm_b32 v50, v205, v201, s64
    v_perm_b32 v51, v205, v201, s65
    v_dot2_f32_bf16 v34, v50, v25, v34
    v_dot2_f32_bf16 v35, v51, v25, v35
    v_perm_b32 v48, v206, v202, s64
    v_perm_b32 v49, v206, v202, s65
    v_dot2_f32_bf16 v36, v48, v25, v36
    v_dot2_f32_bf16 v37, v49, v25, v37
    v_perm_b32 v50, v207, v203, s64
    v_perm_b32 v51, v207, v203, s65
    v_dot2_f32_bf16 v38, v50, v25, v38
    v_dot2_f32_bf16 v39, v51, v25, v39
    v_perm_b32 v48, v212, v208, s64
    v_perm_b32 v49, v212, v208, s65
    v_dot2_f32_bf16 v32, v48, v26, v32
    v_dot2_f32_bf16 v33, v49, v26, v33
    v_perm_b32 v50, v213, v209, s64
    v_perm_b32 v51, v213, v209, s65
    v_dot2_f32_bf16 v34, v50, v26, v34
    v_dot2_f32_bf16 v35, v51, v26, v35
    v_perm_b32 v48, v214, v210, s64
    v_perm_b32 v49, v214, v210, s65
    v_dot2_f32_bf16 v36, v48, v26, v36
    v_dot2_f32_bf16 v37, v49, v26, v37
    v_perm_b32 v50, v215, v211, s64
    v_perm_b32 v51, v215, v211, s65
    v_dot2_f32_bf16 v38, v50, v26, v38
    v_dot2_f32_bf16 v39, v51, v26, v39
    v_perm_b32 v48, v216, v216, s64
    v_perm_b32 v49, v216, v216, s65
    v_dot2_f32_bf16 v32, v48, v27, v32
    v_dot2_f32_bf16 v33, v49, v27, v33
    v_perm_b32 v50, v217, v217, s64
    v_perm_b32 v51, v217, v217, s65
    v_dot2_f32_bf16 v34, v50, v27, v34
    v_dot2_f32_bf16 v35, v51, v27, v35
    v_perm_b32 v48, v218, v218, s64
    v_perm_b32 v49, v218, v218, s65
    v_dot2_f32_bf16 v36, v48, v27, v36
    v_dot2_f32_bf16 v37, v49, v27, v37
    v_perm_b32 v50, v219, v219, s64
    v_perm_b32 v51, v219, v219, s65
    v_dot2_f32_bf16 v38, v50, v27, v38
    v_dot2_f32_bf16 v39, v51, v27, v39
    s_nop 1
    s_nop 1
    v_permlane32_swap_b32 v32, v36
    v_permlane32_swap_b32 v33, v37
    v_permlane32_swap_b32 v34, v38
    v_permlane32_swap_b32 v35, v39
    v_add_f32 v32, v32, v36
    v_add_f32 v33, v33, v37
    v_add_f32 v34, v34, v38
    v_add_f32 v35, v35, v39
    s_nop 1
    v_permlane16_swap_b32 v32, v34
    v_permlane16_swap_b32 v33, v35
    v_add_f32 v32, v32, v34
    v_add_f32 v33, v33, v35
    s_nop 1
    v_add_f32_dpp v32, v32, v32 row_ror:8 row_mask:0xf bank_mask:0xf
    v_add_f32_dpp v33, v33, v33 row_ror:8 row_mask:0xf bank_mask:0xf
    v_and_b32 v16, 7, v2
    v_lshlrev_b32 v16, 5, v16
    v_lshl_add_u32 v16, v8, 3, v16
    s_lshl_b32 s64, s2, 10
    s_lshl_b32 s65, s6, 8
    s_add_u32 s64, s64, s65
    s_add_u32 s64, s64, 6447104
    s_mov_b32 exec_lo, 0x00ff00ff
    s_mov_b32 exec_hi, 0x00ff00ff
    buffer_store_dwordx2 v[32:33], v16, s[16:19], s64 offen sc0 sc1
    s_mov_b64 exec, -1
    s_lshl_b32 s64, s4, 3
    s_add_u32 s64, s64, s3
    s_lshl_b32 s64, s64, 7
    s_add_u32 s64, s64, 5382144
    v_mov_b32 v14, s64
    s_mov_b64 exec, 1
    v_mov_b32 v15, 0
    buffer_atomic_or v15, v14, s[16:19], 0 offen sc0
    s_mov_b64 exec, -1
    v_mov_b32 v254, v14
    s_branch P2_start
C_start:
    s_and_b32 s6, s3, 1
    s_lshr_b32 s7, s3, 1
    v_and_b32 v3, 15, v2
    s_lshl_b32 s64, s6, 6
    v_add_u32 v3, s64, v3
    v_lshlrev_b32 v3, 7, v3
    v_add_u32 v3, 8192, v3
    v_bfe_u32 v56, v2, 1, 3
    v_lshrrev_b32 v57, 4, v2
    v_xor_b32 v56, v56, v57
    v_lshl_add_u32 v4, v56, 4, v3
    v_xor_b32 v5, 64, v4
    v_bfe_u32 v56, v2, 2, 2
    v_lshl_add_u32 v58, v57, 3, v56
    v_lshlrev_b32 v58, 7, v58
    v_lshrrev_b32 v56, 1, v56
    v_xor_b32 v56, s7, v56
    v_lshl_add_u32 v58, v56, 6, v58
    v_and_b32 v57, 1, v57
    v_lshl_add_u32 v58, v57, 5, v58
    v_and_b32 v56, 3, v2
    v_lshl_add_u32 v58, v56, 3, v58
    v_add_u32 v6, 24576, v58
    v_xor_b32 v7, 32, v6
    v_mov_b32 v8, v4
    v_mov_b32 v10, v6
    v_mov_b32 v9, v5
    v_mov_b32 v11, v7
    v_mov_b32 v64, 0
    v_mov_b32 v65, 0
    v_mov_b32 v66, 0
    v_mov_b32 v67, 0
    v_mov_b32 v68, 0
    v_mov_b32 v69, 0
    v_mov_b32 v70, 0
    v_mov_b32 v71, 0
    v_mov_b32 v72, 0
    v_mov_b32 v73, 0
    v_mov_b32 v74, 0
    v_mov_b32 v75, 0
    v_mov_b32 v76, 0
    v_mov_b32 v77, 0
    v_mov_b32 v78, 0
    v_mov_b32 v79, 0
    v_mov_b32 v80, 0
    v_mov_b32 v81, 0
    v_mov_b32 v82, 0
    v_mov_b32 v83, 0
    v_mov_b32 v84, 0
    v_mov_b32 v85, 0
    v_mov_b32 v86, 0
    v_mov_b32 v87, 0
    v_mov_b32 v88, 0
    v_mov_b32 v89, 0
    v_mov_b32 v90, 0
    v_mov_b32 v91, 0
    v_mov_b32 v92, 0
    v_mov_b32 v93, 0
    v_mov_b32 v94, 0
    v_mov_b32 v95, 0
    v_mov_b32 v96, 0
    v_mov_b32 v97, 0
    v_mov_b32 v98, 0
    v_mov_b32 v99, 0
    v_mov_b32 v100, 0
    v_mov_b32 v101, 0
    v_mov_b32 v102, 0
    v_mov_b32 v103, 0
    v_mov_b32 v104, 0
    v_mov_b32 v105, 0
    v_mov_b32 v106, 0
    v_mov_b32 v107, 0
    v_mov_b32 v108, 0
    v_mov_b32 v109, 0
    v_mov_b32 v110, 0
    v_mov_b32 v111, 0
    v_mov_b32 v112, 0
    v_mov_b32 v113, 0
    v_mov_b32 v114, 0
    v_mov_b32 v115, 0
    v_mov_b32 v116, 0
    v_mov_b32 v117, 0
    v_mov_b32 v118, 0
    v_mov_b32 v119, 0
    v_mov_b32 v120, 0
    v_mov_b32 v121, 0
    v_mov_b32 v122, 0
    v_mov_b32 v123, 0
    v_mov_b32 v124, 0
    v_mov_b32 v125, 0
    v_mov_b32 v126, 0
    v_mov_b32 v127, 0
    v_mov_b32 v128, 0
    v_mov_b32 v129, 0
    v_mov_b32 v130, 0
    v_mov_b32 v131, 0
    v_mov_b32 v132, 0
    v_mov_b32 v133, 0
    v_mov_b32 v134, 0
    v_mov_b32 v135, 0
    v_mov_b32 v136, 0
    v_mov_b32 v137, 0
    v_mov_b32 v138, 0
    v_mov_b32 v139, 0
    v_mov_b32 v140, 0
    v_mov_b32 v141, 0
    v_mov_b32 v142, 0
    v_mov_b32 v143, 0
    v_mov_b32 v144, 0
    v_mov_b32 v145, 0
    v_mov_b32 v146, 0
    v_mov_b32 v147, 0
    v_mov_b32 v148, 0
    v_mov_b32 v149, 0
    v_mov_b32 v150, 0
    v_mov_b32 v151, 0
    v_mov_b32 v152, 0
    v_mov_b32 v153, 0
    v_mov_b32 v154, 0
    v_mov_b32 v155, 0
    v_mov_b32 v156, 0
    v_mov_b32 v157, 0
    v_mov_b32 v158, 0
    v_mov_b32 v159, 0
    s_lshl_b32 s64, s3, 2
    v_mov_b32 v229, s64
    ds_write_b32 v229, v64 offset:4288
    ds_write_b32 v229, v64 offset:4304
    v_lshlrev_b32 v3, 4, v2
    s_lshl_b32 s64, s3, 11
    v_add_u32 v224, s64, v3
    v_xor_b32 v225, 2048, v224
    s_lshl_b32 s64, s3, 8
    v_lshl_add_u32 v227, v2, 2, s64
    v_xor_b32 v228, 256, v227
    v_xor_b32 v230, 4, v229
    v_mov_b32 v231, 1
    v_lshlrev_b32 v232, 2, v2
    s_lshl_b32 s64, 1, s4
    v_mov_b32 v233, s64
    s_lshl_b32 s43, s5, 2
    s_add_u32 s43, s43, s3
    s_lshl_b32 s64, s43, 7
    s_add_u32 s64, s64, 5373952
    v_mov_b32 v234, s64
    s_lshl_b32 s43, s43, 4
    s_add_u32 s43, s43, s4
    s_mul_i32 s43, s43, 1152
    s_add_u32 s43, s43, 4194304
    s_lshl_b32 s42, s4, 2
    s_lshl_b32 s64, s6, 1
    s_add_u32 s42, s42, s64
    s_lshl_b32 s42, s42, 5
    s_lshl_b32 s64, s5, 1
    s_add_u32 s42, s42, s64
    s_add_u32 s42, s42, s7
    s_lshl_b32 s42, s42, 11
    s_and_b32 s64, s5, 7
    s_lshl_b32 s64, s64, 1
    s_add_u32 s64, s64, s7
    s_lshl_b32 s64, 1, s64
    v_mov_b32 v13, s64
    s_lshr_b32 s64, s5, 3
    s_lshl_b32 s64, s64, 1
    s_add_u32 s64, s64, s6
    s_lshl_b32 s64, s64, 8
    s_lshl_b32 s65, s4, 10
    s_add_u32 s64, s64, s65
    s_add_u32 s64, s64, 5382144
    v_lshl_add_u32 v15, v2, 7, s64
    v_lshlrev_b32 v1, 4, v2
    s_and_b32 s64, s2, 7
    s_lshr_b32 s65, s2, 3
    s_and_b32 s4, s64, 3
    s_lshl_b32 s4, s4, 2
    s_and_b32 s66, s65, 3
    s_add_u32 s4, s4, s66
    s_lshr_b32 s5, s64, 2
    s_lshl_b32 s5, s5, 3
    s_lshr_b32 s66, s65, 2
    s_add_u32 s5, s5, s66
    s_mov_b32 s65, 0
    s_mov_b32 s66, 0
    v_mov_b32 v236, 0x3f803f80
    v_mov_b32 v237, 0x3f803f80
    v_mov_b32 v238, 0x3f803f80
    v_mov_b32 v239, 0x3f803f80
    s_waitcnt vmcnt(0) lgkmcnt(0)
    s_barrier
    ds_read_b64_tr_b16 v[16:17], v10 offset:0
    ds_read_b64_tr_b16 v[18:19], v10 offset:512
    ds_read_b128 v[192:195], v8 offset:0
    ds_read_b128 v[196:199], v8 offset:2048
    ds_read_b128 v[200:203], v8 offset:4096
    ds_read_b128 v[204:207], v8 offset:6144
    ds_read_b64_tr_b16 v[20:21], v11 offset:0
    ds_read_b64_tr_b16 v[22:23], v11 offset:512
    ds_read_b64_tr_b16 v[24:25], v10 offset:8192
    ds_read_b64_tr_b16 v[26:27], v10 offset:8704
    ds_read_b64_tr_b16 v[28:29], v11 offset:8192
    ds_read_b64_tr_b16 v[30:31], v11 offset:8704
    ds_read_b64_tr_b16 v[32:33], v10 offset:16384
    ds_read_b64_tr_b16 v[34:35], v10 offset:16896
    ds_read_b64_tr_b16 v[36:37], v11 offset:16384
    ds_read_b64_tr_b16 v[38:39], v11 offset:16896
.p2align 3
C_loop:
    s_waitcnt lgkmcnt(0)
    v_mfma_f32_16x16x32_bf16 v[64:67], v[16:19], v[192:195], v[64:67]
    ds_read_b64_tr_b16 v[40:41], v10 offset:4096
    v_mfma_f32_16x16x32_bf16 v[72:75], v[16:19], v[196:199], v[72:75]
    ds_read_b64_tr_b16 v[42:43], v10 offset:4608
    v_mfma_f32_16x16x32_bf16 v[80:83], v[16:19], v[200:203], v[80:83]
    ds_read_b128 v[208:211], v9 offset:0
    v_mfma_f32_16x16x32_bf16 v[88:91], v[16:19], v[204:207], v[88:91]
    ds_read_b128 v[212:215], v9 offset:2048
    v_mfma_f32_16x16x32_bf16 v[68:71], v[20:23], v[192:195], v[68:71]
    ds_read_b128 v[216:219], v9 offset:4096
    v_mfma_f32_16x16x32_bf16 v[76:79], v[20:23], v[196:199], v[76:79]
    ds_read_b128 v[220:223], v9 offset:6144
    v_mfma_f32_16x16x32_bf16 v[84:87], v[20:23], v[200:203], v[84:87]
    ds_read_b64_tr_b16 v[44:45], v11 offset:4096
    v_mfma_f32_16x16x32_bf16 v[92:95], v[20:23], v[204:207], v[92:95]
    ds_read_b64_tr_b16 v[46:47], v11 offset:4608
    v_mfma_f32_16x16x32_bf16 v[96:99], v[192:195], v[24:27], v[96:99]
    ds_read_b64_tr_b16 v[48:49], v10 offset:12288
    v_mfma_f32_16x16x32_bf16 v[100:103], v[196:199], v[24:27], v[100:103]
    ds_read_b64_tr_b16 v[50:51], v10 offset:12800
    v_mfma_f32_16x16x32_bf16 v[112:115], v[200:203], v[24:27], v[112:115]
    ds_read_b64_tr_b16 v[52:53], v11 offset:12288
    v_mfma_f32_16x16x32_bf16 v[116:119], v[204:207], v[24:27], v[116:119]
    ds_read_b64_tr_b16 v[54:55], v11 offset:12800
    v_mfma_f32_16x16x32_bf16 v[104:107], v[192:195], v[28:31], v[104:107]
    ds_read_b64_tr_b16 v[56:57], v10 offset:20480
    v_mfma_f32_16x16x32_bf16 v[108:111], v[196:199], v[28:31], v[108:111]
    ds_read_b64_tr_b16 v[58:59], v10 offset:20992
    v_mfma_f32_16x16x32_bf16 v[120:123], v[200:203], v[28:31], v[120:123]
    ds_read_b64_tr_b16 v[60:61], v11 offset:20480
    v_mfma_f32_16x16x32_bf16 v[124:127], v[204:207], v[28:31], v[124:127]
    ds_read_b64_tr_b16 v[62:63], v11 offset:20992
    v_mfma_f32_16x16x32_bf16 v[128:131], v[192:195], v[32:35], v[128:131]
    v_mfma_f32_16x16x32_bf16 v[132:135], v[196:199], v[32:35], v[132:135]
    v_mfma_f32_16x16x32_bf16 v[144:147], v[200:203], v[32:35], v[144:147]
    v_mfma_f32_16x16x32_bf16 v[148:151], v[204:207], v[32:35], v[148:151]
    v_mfma_f32_16x16x32_bf16 v[136:139], v[192:195], v[36:39], v[136:139]
    v_mfma_f32_16x16x32_bf16 v[140:143], v[196:199], v[36:39], v[140:143]
    v_mfma_f32_16x16x32_bf16 v[152:155], v[200:203], v[36:39], v[152:155]
    v_mfma_f32_16x16x32_bf16 v[156:159], v[204:207], v[36:39], v[156:159]
    s_waitcnt lgkmcnt(0)
    s_barrier
    s_add_u32 s65, s65, 40960
    s_cmp_eq_u32 s65, 122880
    s_cselect_b32 s65, 0, s65
    v_mfma_f32_16x16x32_bf16 v[64:67], v[40:43], v[208:211], v[64:67]
    v_add_u32 v10, s65, v6
    v_add_u32 v8, s65, v4
    v_mfma_f32_16x16x32_bf16 v[72:75], v[40:43], v[212:215], v[72:75]
    ds_read_b64_tr_b16 v[16:17], v10 offset:0
    v_mfma_f32_16x16x32_bf16 v[80:83], v[40:43], v[216:219], v[80:83]
    ds_read_b64_tr_b16 v[18:19], v10 offset:512
    v_mfma_f32_16x16x32_bf16 v[88:91], v[40:43], v[220:223], v[88:91]
    ds_read_b128 v[192:195], v8 offset:0
    v_mfma_f32_16x16x32_bf16 v[68:71], v[44:47], v[208:211], v[68:71]
    ds_read_b128 v[196:199], v8 offset:2048
    v_mfma_f32_16x16x32_bf16 v[76:79], v[44:47], v[212:215], v[76:79]
    ds_read_b128 v[200:203], v8 offset:4096
    v_mfma_f32_16x16x32_bf16 v[84:87], v[44:47], v[216:219], v[84:87]
    ds_read_b128 v[204:207], v8 offset:6144
    v_mfma_f32_16x16x32_bf16 v[92:95], v[44:47], v[220:223], v[92:95]
    v_add_u32 v11, s65, v7
    v_mfma_f32_16x16x32_bf16 v[96:99], v[208:211], v[48:51], v[96:99]
    ds_read_b64_tr_b16 v[20:21], v11 offset:0
    v_mfma_f32_16x16x32_bf16 v[100:103], v[212:215], v[48:51], v[100:103]
    ds_read_b64_tr_b16 v[22:23], v11 offset:512
    v_mfma_f32_16x16x32_bf16 v[112:115], v[216:219], v[48:51], v[112:115]
    ds_read_b64_tr_b16 v[24:25], v10 offset:8192
    v_mfma_f32_16x16x32_bf16 v[116:119], v[220:223], v[48:51], v[116:119]
    ds_read_b64_tr_b16 v[26:27], v10 offset:8704
    v_mfma_f32_16x16x32_bf16 v[104:107], v[208:211], v[52:55], v[104:107]
    ds_read_b64_tr_b16 v[28:29], v11 offset:8192
    v_mfma_f32_16x16x32_bf16 v[108:111], v[212:215], v[52:55], v[108:111]
    ds_read_b64_tr_b16 v[30:31], v11 offset:8704
    v_mfma_f32_16x16x32_bf16 v[120:123], v[216:219], v[52:55], v[120:123]
    ds_read_b64_tr_b16 v[32:33], v10 offset:16384
    v_mfma_f32_16x16x32_bf16 v[124:127], v[220:223], v[52:55], v[124:127]
    ds_read_b64_tr_b16 v[34:35], v10 offset:16896
    v_mfma_f32_16x16x32_bf16 v[128:131], v[208:211], v[56:59], v[128:131]
    ds_read_b64_tr_b16 v[36:37], v11 offset:16384
    v_mfma_f32_16x16x32_bf16 v[132:135], v[212:215], v[56:59], v[132:135]
    ds_read_b64_tr_b16 v[38:39], v11 offset:16896
    v_mfma_f32_16x16x32_bf16 v[144:147], v[216:219], v[56:59], v[144:147]
    v_add_u32 v9, s65, v5
    v_mfma_f32_16x16x32_bf16 v[148:151], v[220:223], v[56:59], v[148:151]
    v_mfma_f32_16x16x32_bf16 v[136:139], v[208:211], v[60:63], v[136:139]
    v_mfma_f32_16x16x32_bf16 v[140:143], v[212:215], v[60:63], v[140:143]
    v_mfma_f32_16x16x32_bf16 v[152:155], v[216:219], v[60:63], v[152:155]
    v_mfma_f32_16x16x32_bf16 v[156:159], v[220:223], v[60:63], v[156:159]
    s_add_u32 s66, s66, 1
    s_cmp_lt_u32 s66, 14
    s_cbranch_scc1 C_loop
    s_waitcnt lgkmcnt(0)
    v_mfma_f32_16x16x32_bf16 v[96:99], v[192:195], v[24:27], v[96:99]
    ds_read_b64_tr_b16 v[48:49], v10 offset:12288
    v_mfma_f32_16x16x32_bf16 v[100:103], v[196:199], v[24:27], v[100:103]
    ds_read_b64_tr_b16 v[50:51], v10 offset:12800
    v_mfma_f32_16x16x32_bf16 v[112:115], v[200:203], v[24:27], v[112:115]
    ds_read_b128 v[160:163], v9 offset:0
    v_mfma_f32_16x16x32_bf16 v[116:119], v[204:207], v[24:27], v[116:119]
    ds_read_b128 v[164:167], v9 offset:2048
    v_mfma_f32_16x16x32_bf16 v[104:107], v[192:195], v[28:31], v[104:107]
    ds_read_b128 v[168:171], v9 offset:4096
    v_mfma_f32_16x16x32_bf16 v[108:111], v[196:199], v[28:31], v[108:111]
    ds_read_b128 v[172:175], v9 offset:6144
    v_mfma_f32_16x16x32_bf16 v[120:123], v[200:203], v[28:31], v[120:123]
    ds_read_b64_tr_b16 v[52:53], v11 offset:12288
    v_mfma_f32_16x16x32_bf16 v[124:127], v[204:207], v[28:31], v[124:127]
    ds_read_b64_tr_b16 v[54:55], v11 offset:12800
    v_mfma_f32_16x16x32_bf16 v[128:131], v[192:195], v[32:35], v[128:131]
    ds_read_b64_tr_b16 v[56:57], v10 offset:20480
    v_mfma_f32_16x16x32_bf16 v[132:135], v[196:199], v[32:35], v[132:135]
    ds_read_b64_tr_b16 v[58:59], v10 offset:20992
    v_mfma_f32_16x16x32_bf16 v[144:147], v[200:203], v[32:35], v[144:147]
    ds_read_b64_tr_b16 v[60:61], v11 offset:20480
    v_mfma_f32_16x16x32_bf16 v[148:151], v[204:207], v[32:35], v[148:151]
    ds_read_b64_tr_b16 v[62:63], v11 offset:20992
    v_mfma_f32_16x16x32_bf16 v[136:139], v[192:195], v[36:39], v[136:139]
    v_mfma_f32_16x16x32_bf16 v[140:143], v[196:199], v[36:39], v[140:143]
    v_mfma_f32_16x16x32_bf16 v[152:155], v[200:203], v[36:39], v[152:155]
    v_mfma_f32_16x16x32_bf16 v[156:159], v[204:207], v[36:39], v[156:159]
    s_waitcnt lgkmcnt(0)
    s_barrier
    s_add_u32 s66, s66, 1
    v_mfma_f32_16x16x32_bf16 v[96:99], v[160:163], v[48:51], v[96:99]
    v_mov_b32 v10, v6
    v_mov_b32 v8, v4
    v_mfma_f32_16x16x32_bf16 v[100:103], v[164:167], v[48:51], v[100:103]
    ds_read_b64_tr_b16 v[24:25], v10 offset:8192
    v_mfma_f32_16x16x32_bf16 v[112:115], v[168:171], v[48:51], v[112:115]
    ds_read_b64_tr_b16 v[26:27], v10 offset:8704
    v_mfma_f32_16x16x32_bf16 v[116:119], v[172:175], v[48:51], v[116:119]
    v_mov_b32 v11, v7
    v_mov_b32 v9, v5
    v_mfma_f32_16x16x32_bf16 v[104:107], v[160:163], v[52:55], v[104:107]
    ds_read_b128 v[176:179], v8 offset:0
    v_mfma_f32_16x16x32_bf16 v[108:111], v[164:167], v[52:55], v[108:111]
    ds_read_b128 v[180:183], v8 offset:2048
    v_mfma_f32_16x16x32_bf16 v[120:123], v[168:171], v[52:55], v[120:123]
    ds_read_b128 v[184:187], v8 offset:4096
    v_mfma_f32_16x16x32_bf16 v[124:127], v[172:175], v[52:55], v[124:127]
    ds_read_b128 v[188:191], v8 offset:6144
    v_mfma_f32_16x16x32_bf16 v[128:131], v[160:163], v[56:59], v[128:131]
    ds_read_b64_tr_b16 v[28:29], v11 offset:8192
    v_mfma_f32_16x16x32_bf16 v[132:135], v[164:167], v[56:59], v[132:135]
    ds_read_b64_tr_b16 v[30:31], v11 offset:8704
    v_mfma_f32_16x16x32_bf16 v[144:147], v[168:171], v[56:59], v[144:147]
    ds_read_b64_tr_b16 v[32:33], v10 offset:16384
    v_mfma_f32_16x16x32_bf16 v[148:151], v[172:175], v[56:59], v[148:151]
    ds_read_b64_tr_b16 v[34:35], v10 offset:16896
    v_mfma_f32_16x16x32_bf16 v[136:139], v[160:163], v[60:63], v[136:139]
    ds_read_b64_tr_b16 v[36:37], v11 offset:16384
    v_mfma_f32_16x16x32_bf16 v[140:143], v[164:167], v[60:63], v[140:143]
    ds_read_b64_tr_b16 v[38:39], v11 offset:16896
    v_mfma_f32_16x16x32_bf16 v[152:155], v[168:171], v[60:63], v[152:155]
    v_mfma_f32_16x16x32_bf16 v[156:159], v[172:175], v[60:63], v[156:159]
    s_waitcnt lgkmcnt(0)
    v_mfma_f32_16x16x32_bf16 v[96:99], v[176:179], v[24:27], v[96:99]
    ds_read_b64_tr_b16 v[48:49], v10 offset:12288
    v_mfma_f32_16x16x32_bf16 v[100:103], v[180:183], v[24:27], v[100:103]
    ds_read_b64_tr_b16 v[50:51], v10 offset:12800
    v_mfma_f32_16x16x32_bf16 v[112:115], v[184:187], v[24:27], v[112:115]
    ds_read_b128 v[208:211], v9 offset:0
    v_mfma_f32_16x16x32_bf16 v[116:119], v[188:191], v[24:27], v[116:119]
    ds_read_b128 v[212:215], v9 offset:2048
    v_mfma_f32_16x16x32_bf16 v[104:107], v[176:179], v[28:31], v[104:107]
    ds_read_b128 v[216:219], v9 offset:4096
    v_mfma_f32_16x16x32_bf16 v[108:111], v[180:183], v[28:31], v[108:111]
    ds_read_b128 v[220:223], v9 offset:6144
    v_mfma_f32_16x16x32_bf16 v[120:123], v[184:187], v[28:31], v[120:123]
    ds_read_b64_tr_b16 v[52:53], v11 offset:12288
    v_mfma_f32_16x16x32_bf16 v[124:127], v[188:191], v[28:31], v[124:127]
    ds_read_b64_tr_b16 v[54:55], v11 offset:12800
    v_mfma_f32_16x16x32_bf16 v[128:131], v[176:179], v[32:35], v[128:131]
    ds_read_b64_tr_b16 v[56:57], v10 offset:20480
    v_mfma_f32_16x16x32_bf16 v[132:135], v[180:183], v[32:35], v[132:135]
    ds_read_b64_tr_b16 v[58:59], v10 offset:20992
    v_mfma_f32_16x16x32_bf16 v[144:147], v[184:187], v[32:35], v[144:147]
    ds_read_b64_tr_b16 v[60:61], v11 offset:20480
    v_mfma_f32_16x16x32_bf16 v[148:151], v[188:191], v[32:35], v[148:151]
    ds_read_b64_tr_b16 v[62:63], v11 offset:20992
    v_mfma_f32_16x16x32_bf16 v[136:139], v[176:179], v[36:39], v[136:139]
    v_mfma_f32_16x16x32_bf16 v[140:143], v[180:183], v[36:39], v[140:143]
    v_mfma_f32_16x16x32_bf16 v[152:155], v[184:187], v[36:39], v[152:155]
    v_mfma_f32_16x16x32_bf16 v[156:159], v[188:191], v[36:39], v[156:159]
    s_waitcnt lgkmcnt(0)
    s_barrier
    v_mfma_f32_16x16x32_bf16 v[96:99], v[208:211], v[48:51], v[96:99]
    v_mfma_f32_16x16x32_bf16 v[100:103], v[212:215], v[48:51], v[100:103]
    v_mfma_f32_16x16x32_bf16 v[112:115], v[216:219], v[48:51], v[112:115]
    v_mfma_f32_16x16x32_bf16 v[116:119], v[220:223], v[48:51], v[116:119]
    v_mfma_f32_16x16x32_bf16 v[104:107], v[208:211], v[52:55], v[104:107]
    v_mfma_f32_16x16x32_bf16 v[108:111], v[212:215], v[52:55], v[108:111]
    v_mfma_f32_16x16x32_bf16 v[120:123], v[216:219], v[52:55], v[120:123]
    v_mfma_f32_16x16x32_bf16 v[124:127], v[220:223], v[52:55], v[124:127]
    v_mfma_f32_16x16x32_bf16 v[128:131], v[208:211], v[56:59], v[128:131]
    v_mfma_f32_16x16x32_bf16 v[132:135], v[212:215], v[56:59], v[132:135]
    v_mfma_f32_16x16x32_bf16 v[144:147], v[216:219], v[56:59], v[144:147]
    v_mfma_f32_16x16x32_bf16 v[148:151], v[220:223], v[56:59], v[148:151]
    v_mfma_f32_16x16x32_bf16 v[136:139], v[208:211], v[60:63], v[136:139]
    v_mfma_f32_16x16x32_bf16 v[140:143], v[212:215], v[60:63], v[140:143]
    v_mfma_f32_16x16x32_bf16 v[152:155], v[216:219], v[60:63], v[152:155]
    v_mfma_f32_16x16x32_bf16 v[156:159], v[220:223], v[60:63], v[156:159]
    v_add_u32 v10, 81920, v6
    v_add_u32 v11, 81920, v7
    v_cvt_pk_bf16_f32 v16, v96, v97
    v_lshlrev_b32 v48, 16, v16
    v_and_b32 v49, 0xffff0000, v16
    v_mul_f32 v50, s72, v48
    v_mul_f32 v51, s72, v49
    v_exp_f32 v50, v50 clamp
    v_exp_f32 v51, v51 clamp
    v_max_f32 v48, 0, v48
    v_max_f32 v49, 0, v49
    v_add_f32 v48, v48, v50
    v_add_f32 v49, v49, v51
    v_min_f32 v56, v48, v49
    v_cvt_pk_bf16_f32 v16, v48, v49
    v_cvt_pk_bf16_f32 v17, v98, v99
    v_lshlrev_b32 v48, 16, v17
    v_and_b32 v49, 0xffff0000, v17
    v_mul_f32 v50, s72, v48
    v_mul_f32 v51, s72, v49
    v_exp_f32 v50, v50 clamp
    v_exp_f32 v51, v51 clamp
    v_max_f32 v48, 0, v48
    v_max_f32 v49, 0, v49
    v_add_f32 v48, v48, v50
    v_add_f32 v49, v49, v51
    v_min3_f32 v56, v48, v49, v56
    v_cvt_pk_bf16_f32 v17, v48, v49
    v_cvt_pk_bf16_f32 v18, v100, v101
    v_lshlrev_b32 v48, 16, v18
    v_and_b32 v49, 0xffff0000, v18
    v_mul_f32 v50, s72, v48
    v_mul_f32 v51, s72, v49
    v_exp_f32 v50, v50 clamp
    v_exp_f32 v51, v51 clamp
    v_max_f32 v48, 0, v48
    v_max_f32 v49, 0, v49
    v_add_f32 v48, v48, v50
    v_add_f32 v49, v49, v51
    v_min3_f32 v56, v48, v49, v56
    v_cvt_pk_bf16_f32 v18, v48, v49
    v_cvt_pk_bf16_f32 v19, v102, v103
    v_lshlrev_b32 v48, 16, v19
    v_and_b32 v49, 0xffff0000, v19
    v_mul_f32 v50, s72, v48
    v_mul_f32 v51, s72, v49
    v_exp_f32 v50, v50 clamp
    v_exp_f32 v51, v51 clamp
    v_max_f32 v48, 0, v48
    v_max_f32 v49, 0, v49
    v_add_f32 v48, v48, v50
    v_add_f32 v49, v49, v51
    v_min3_f32 v56, v48, v49, v56
    v_cvt_pk_bf16_f32 v19, v48, v49
    v_cvt_pk_bf16_f32 v20, v104, v105
    v_lshlrev_b32 v48, 16, v20
    v_and_b32 v49, 0xffff0000, v20
    v_mul_f32 v50, s72, v48
    v_mul_f32 v51, s72, v49
    v_exp_f32 v50, v50 clamp
    v_exp_f32 v51, v51 clamp
    v_max_f32 v48, 0, v48
    v_max_f32 v49, 0, v49
    v_add_f32 v48, v48, v50
    v_add_f32 v49, v49, v51
    v_min3_f32 v56, v48, v49, v56
    v_cvt_pk_bf16_f32 v20, v48, v49
    v_cvt_pk_bf16_f32 v21, v106, v107
    v_lshlrev_b32 v48, 16, v21
    v_and_b32 v49, 0xffff0000, v21
    v_mul_f32 v50, s72, v48
    v_mul_f32 v51, s72, v49
    v_exp_f32 v50, v50 clamp
    v_exp_f32 v51, v51 clamp
    v_max_f32 v48, 0, v48
    v_max_f32 v49, 0, v49
    v_add_f32 v48, v48, v50
    v_add_f32 v49, v49, v51
    v_min3_f32 v56, v48, v49, v56
    v_cvt_pk_bf16_f32 v21, v48, v49
    v_cvt_pk_bf16_f32 v22, v108, v109
    v_lshlrev_b32 v48, 16, v22
    v_and_b32 v49, 0xffff0000, v22
    v_mul_f32 v50, s72, v48
    v_mul_f32 v51, s72, v49
    v_exp_f32 v50, v50 clamp
    v_exp_f32 v51, v51 clamp
    v_max_f32 v48, 0, v48
    v_max_f32 v49, 0, v49
    v_add_f32 v48, v48, v50
    v_add_f32 v49, v49, v51
    v_min3_f32 v56, v48, v49, v56
    v_cvt_pk_bf16_f32 v22, v48, v49
    v_cvt_pk_bf16_f32 v23, v110, v111
    v_lshlrev_b32 v48, 16, v23
    v_and_b32 v49, 0xffff0000, v23
    v_mul_f32 v50, s72, v48
    v_mul_f32 v51, s72, v49
    v_exp_f32 v50, v50 clamp
    v_exp_f32 v51, v51 clamp
    v_max_f32 v48, 0, v48
    v_max_f32 v49, 0, v49
    v_add_f32 v48, v48, v50
    v_add_f32 v49, v49, v51
    v_min3_f32 v56, v48, v49, v56
    v_cvt_pk_bf16_f32 v23, v48, v49
    v_cmp_gt_f32 vcc, 0x3a800000, v56
    s_cbranch_vccnz phi_16_fix
phi_16_done:
    v_cvt_pk_bf16_f32 v32, v128, v129
    v_cvt_pk_bf16_f32 v33, v130, v131
    v_mfma_f32_16x16x32_bf16 v[96:99], v[236:239], v[16:19], 0
    v_cvt_pk_bf16_f32 v34, v132, v133
    v_mfma_f32_16x16x32_bf16 v[60:63], v[236:239], v[20:23], 0
    v_cvt_pk_bf16_f32 v35, v134, v135
    v_cvt_pk_bf16_f32 v36, v136, v137
    v_cvt_pk_bf16_f32 v37, v138, v139
    v_mfma_f32_16x16x32_bf16 v[240:243], v[16:19], v[32:35], 0
    v_cvt_pk_bf16_f32 v38, v140, v141
    v_mfma_f32_16x16x32_bf16 v[244:247], v[20:23], v[32:35], 0
    v_cvt_pk_bf16_f32 v39, v142, v143
    s_nop 1
    v_mfma_f32_16x16x32_bf16 v[248:251], v[16:19], v[36:39], 0
    v_mfma_f32_16x16x32_bf16 v[252:255], v[20:23], v[36:39], 0
    v_cvt_pk_bf16_f32 v24, v112, v113
    v_lshlrev_b32 v48, 16, v24
    v_and_b32 v49, 0xffff0000, v24
    v_mul_f32 v50, s72, v48
    v_mul_f32 v51, s72, v49
    v_exp_f32 v50, v50 clamp
    v_exp_f32 v51, v51 clamp
    v_max_f32 v48, 0, v48
    v_max_f32 v49, 0, v49
    v_add_f32 v48, v48, v50
    v_add_f32 v49, v49, v51
    v_min_f32 v56, v48, v49
    v_cvt_pk_bf16_f32 v24, v48, v49
    v_cvt_pk_bf16_f32 v25, v114, v115
    v_lshlrev_b32 v48, 16, v25
    v_and_b32 v49, 0xffff0000, v25
    v_mul_f32 v50, s72, v48
    v_mul_f32 v51, s72, v49
    v_exp_f32 v50, v50 clamp
    v_exp_f32 v51, v51 clamp
    v_max_f32 v48, 0, v48
    v_max_f32 v49, 0, v49
    v_add_f32 v48, v48, v50
    v_add_f32 v49, v49, v51
    v_min3_f32 v56, v48, v49, v56
    v_cvt_pk_bf16_f32 v25, v48, v49
    v_cvt_pk_bf16_f32 v26, v116, v117
    v_lshlrev_b32 v48, 16, v26
    v_and_b32 v49, 0xffff0000, v26
    v_mul_f32 v50, s72, v48
    v_mul_f32 v51, s72, v49
    v_exp_f32 v50, v50 clamp
    v_exp_f32 v51, v51 clamp
    v_max_f32 v48, 0, v48
    v_max_f32 v49, 0, v49
    v_add_f32 v48, v48, v50
    v_add_f32 v49, v49, v51
    v_min3_f32 v56, v48, v49, v56
    v_cvt_pk_bf16_f32 v26, v48, v49
    v_cvt_pk_bf16_f32 v27, v118, v119
    v_lshlrev_b32 v48, 16, v27
    v_and_b32 v49, 0xffff0000, v27
    v_mul_f32 v50, s72, v48
    v_mul_f32 v51, s72, v49
    v_exp_f32 v50, v50 clamp
    v_exp_f32 v51, v51 clamp
    v_max_f32 v48, 0, v48
    v_max_f32 v49, 0, v49
    v_add_f32 v48, v48, v50
    v_add_f32 v49, v49, v51
    v_min3_f32 v56, v48, v49, v56
    v_cvt_pk_bf16_f32 v27, v48, v49
    v_cvt_pk_bf16_f32 v28, v120, v121
    v_lshlrev_b32 v48, 16, v28
    v_and_b32 v49, 0xffff0000, v28
    v_mul_f32 v50, s72, v48
    v_mul_f32 v51, s72, v49
    v_exp_f32 v50, v50 clamp
    v_exp_f32 v51, v51 clamp
    v_max_f32 v48, 0, v48
    v_max_f32 v49, 0, v49
    v_add_f32 v48, v48, v50
    v_add_f32 v49, v49, v51
    v_min3_f32 v56, v48, v49, v56
    v_cvt_pk_bf16_f32 v28, v48, v49
    v_cvt_pk_bf16_f32 v29, v122, v123
    v_lshlrev_b32 v48, 16, v29
    v_and_b32 v49, 0xffff0000, v29
    v_mul_f32 v50, s72, v48
    v_mul_f32 v51, s72, v49
    v_exp_f32 v50, v50 clamp
    v_exp_f32 v51, v51 clamp
    v_max_f32 v48, 0, v48
    v_max_f32 v49, 0, v49
    v_add_f32 v48, v48, v50
    v_add_f32 v49, v49, v51
    v_min3_f32 v56, v48, v49, v56
    v_cvt_pk_bf16_f32 v29, v48, v49
    v_cvt_pk_bf16_f32 v30, v124, v125
    v_lshlrev_b32 v48, 16, v30
    v_and_b32 v49, 0xffff0000, v30
    v_mul_f32 v50, s72, v48
    v_mul_f32 v51, s72, v49
    v_exp_f32 v50, v50 clamp
    v_exp_f32 v51, v51 clamp
    v_max_f32 v48, 0, v48
    v_max_f32 v49, 0, v49
    v_add_f32 v48, v48, v50
    v_add_f32 v49, v49, v51
    v_min3_f32 v56, v48, v49, v56
    v_cvt_pk_bf16_f32 v30, v48, v49
    v_cvt_pk_bf16_f32 v31, v126, v127
    v_lshlrev_b32 v48, 16, v31
    v_and_b32 v49, 0xffff0000, v31
    v_mul_f32 v50, s72, v48
    v_mul_f32 v51, s72, v49
    v_exp_f32 v50, v50 clamp
    v_exp_f32 v51, v51 clamp
    v_max_f32 v48, 0, v48
    v_max_f32 v49, 0, v49
    v_add_f32 v48, v48, v50
    v_add_f32 v49, v49, v51
    v_min3_f32 v56, v48, v49, v56
    v_cvt_pk_bf16_f32 v31, v48, v49
    v_cmp_gt_f32 vcc, 0x3a800000, v56
    s_cbranch_vccnz phi_17_fix
phi_17_done:
    v_cvt_pk_bf16_f32 v40, v144, v145
    v_cvt_pk_bf16_f32 v41, v146, v147
    v_mfma_f32_16x16x32_bf16 v[96:99], v[236:239], v[24:27], v[96:99]
    v_cvt_pk_bf16_f32 v42, v148, v149
    v_mfma_f32_16x16x32_bf16 v[60:63], v[236:239], v[28:31], v[60:63]
    v_cvt_pk_bf16_f32 v43, v150, v151
    v_cvt_pk_bf16_f32 v44, v152, v153
    v_cvt_pk_bf16_f32 v45, v154, v155
    v_mfma_f32_16x16x32_bf16 v[240:243], v[24:27], v[40:43], v[240:243]
    v_cvt_pk_bf16_f32 v46, v156, v157
    v_mfma_f32_16x16x32_bf16 v[244:247], v[28:31], v[40:43], v[244:247]
    v_cvt_pk_bf16_f32 v47, v158, v159
    s_nop 1
    v_mfma_f32_16x16x32_bf16 v[248:251], v[24:27], v[44:47], v[248:251]
    v_mfma_f32_16x16x32_bf16 v[252:255], v[28:31], v[44:47], v[252:255]
    s_cmp_eq_u32 s6, 0
    s_cbranch_scc0 C_ex1
    ds_write_b32 v227, v60 offset:4608
    s_nop 5
    ds_write_b128 v224, v[248:251] offset:32768
    ds_write_b128 v224, v[252:255] offset:33792
C_ex2:
    ds_write_b32 v229, v231 offset:4288
C_ps:
    ds_read_b32 v25, v230 offset:4288
    ds_read_b128 v[16:19], v225 offset:32768
    ds_read_b128 v[20:23], v225 offset:33792
    ds_read_b32 v24, v228 offset:4608
    s_waitcnt lgkmcnt(0)
    v_cmp_eq_u32 vcc, 0, v25
    s_cbranch_vccnz C_ps
    v_add_f32 v16, v16, v240
    v_add_f32 v17, v17, v241
    v_add_f32 v18, v18, v242
    v_add_f32 v19, v19, v243
    v_add_f32 v20, v20, v244
    v_add_f32 v21, v21, v245
    v_add_f32 v22, v22, v246
    v_add_f32 v23, v23, v247
    v_add_f32 v24, v24, v96
    v_cvt_pk_bf16_f32 v28, v16, v17
    v_cvt_pk_bf16_f32 v29, v18, v19
    v_cvt_pk_bf16_f32 v30, v20, v21
    v_cvt_pk_bf16_f32 v31, v22, v23
    buffer_store_dwordx4 v[28:31], v1, s[16:19], s43 offen sc0 sc1
    s_mov_b64 exec, 0xffff
    buffer_store_dword v24, v232, s[16:19], s43 offen offset:1024 sc0 sc1
    s_mov_b64 exec, 1
    buffer_atomic_or v233, v234, s[16:19], 0 offen
    s_mov_b64 exec, -1
    ds_read_b64_tr_b16 v[96:97], v10 offset:0
    ds_read_b64_tr_b16 v[98:99], v10 offset:512
    ds_read_b64_tr_b16 v[100:101], v11 offset:0
    ds_read_b64_tr_b16 v[102:103], v11 offset:512
    ds_read_b64_tr_b16 v[104:105], v10 offset:4096
    ds_read_b64_tr_b16 v[106:107], v10 offset:4608
    ds_read_b64_tr_b16 v[108:109], v11 offset:4096
    ds_read_b64_tr_b16 v[110:111], v11 offset:4608
    ds_read_b64_tr_b16 v[112:113], v6 offset:0
    ds_read_b64_tr_b16 v[114:115], v6 offset:512
    ds_read_b64_tr_b16 v[116:117], v7 offset:0
    ds_read_b64_tr_b16 v[118:119], v7 offset:512
    ds_read_b64_tr_b16 v[120:121], v6 offset:4096
    ds_read_b64_tr_b16 v[122:123], v6 offset:4608
    ds_read_b64_tr_b16 v[124:125], v7 offset:4096
    ds_read_b64_tr_b16 v[126:127], v7 offset:4608
    s_waitcnt lgkmcnt(12)
    v_mfma_f32_16x16x32_bf16 v[64:67], v[96:99], v[192:195], v[64:67]
    v_mfma_f32_16x16x32_bf16 v[72:75], v[96:99], v[196:199], v[72:75]
    v_mfma_f32_16x16x32_bf16 v[80:83], v[96:99], v[200:203], v[80:83]
    v_mfma_f32_16x16x32_bf16 v[88:91], v[96:99], v[204:207], v[88:91]
    v_mfma_f32_16x16x32_bf16 v[68:71], v[100:103], v[192:195], v[68:71]
    v_mfma_f32_16x16x32_bf16 v[76:79], v[100:103], v[196:199], v[76:79]
    v_mfma_f32_16x16x32_bf16 v[84:87], v[100:103], v[200:203], v[84:87]
    v_mfma_f32_16x16x32_bf16 v[92:95], v[100:103], v[204:207], v[92:95]
    s_waitcnt lgkmcnt(8)
    v_mfma_f32_16x16x32_bf16 v[64:67], v[104:107], v[160:163], v[64:67]
    v_mfma_f32_16x16x32_bf16 v[72:75], v[104:107], v[164:167], v[72:75]
    v_mfma_f32_16x16x32_bf16 v[80:83], v[104:107], v[168:171], v[80:83]
    v_mfma_f32_16x16x32_bf16 v[88:91], v[104:107], v[172:175], v[88:91]
    v_mfma_f32_16x16x32_bf16 v[68:71], v[108:111], v[160:163], v[68:71]
    v_mfma_f32_16x16x32_bf16 v[76:79], v[108:111], v[164:167], v[76:79]
    v_mfma_f32_16x16x32_bf16 v[84:87], v[108:111], v[168:171], v[84:87]
    v_mfma_f32_16x16x32_bf16 v[92:95], v[108:111], v[172:175], v[92:95]
    s_waitcnt lgkmcnt(4)
    v_mfma_f32_16x16x32_bf16 v[64:67], v[112:115], v[176:179], v[64:67]
    v_mfma_f32_16x16x32_bf16 v[72:75], v[112:115], v[180:183], v[72:75]
    v_mfma_f32_16x16x32_bf16 v[80:83], v[112:115], v[184:187], v[80:83]
    v_mfma_f32_16x16x32_bf16 v[88:91], v[112:115], v[188:191], v[88:91]
    v_mfma_f32_16x16x32_bf16 v[68:71], v[116:119], v[176:179], v[68:71]
    v_mfma_f32_16x16x32_bf16 v[76:79], v[116:119], v[180:183], v[76:79]
    v_mfma_f32_16x16x32_bf16 v[84:87], v[116:119], v[184:187], v[84:87]
    v_mfma_f32_16x16x32_bf16 v[92:95], v[116:119], v[188:191], v[92:95]
    s_waitcnt lgkmcnt(0)
    v_mfma_f32_16x16x32_bf16 v[64:67], v[120:123], v[208:211], v[64:67]
    v_mfma_f32_16x16x32_bf16 v[72:75], v[120:123], v[212:215], v[72:75]
    v_mfma_f32_16x16x32_bf16 v[80:83], v[120:123], v[216:219], v[80:83]
    v_mfma_f32_16x16x32_bf16 v[88:91], v[120:123], v[220:223], v[88:91]
    v_mfma_f32_16x16x32_bf16 v[68:71], v[124:127], v[208:211], v[68:71]
    v_mfma_f32_16x16x32_bf16 v[76:79], v[124:127], v[212:215], v[76:79]
    v_mfma_f32_16x16x32_bf16 v[84:87], v[124:127], v[216:219], v[84:87]
    v_mfma_f32_16x16x32_bf16 v[92:95], v[124:127], v[220:223], v[92:95]
    v_mov_b32 v254, v15
    v_mov_b32 v255, v13
    s_cmp_lg_u32 s3, 0
    s_cbranch_scc1 C_nh0
    s_lshr_b32 s64, s2, 2
    s_lshl_b32 s64, s64, 14
    s_add_u32 s64, s64, 5398528
    v_lshl_add_u32 v152, v2, 4, s64
    s_mov_b32 s64, 0
    buffer_load_dwordx4 v[156:159], v152, s[16:19], s64 offen offset:0 sc1
    s_mov_b32 s64, 0
    buffer_load_dwordx4 v[160:163], v152, s[16:19], s64 offen offset:1024 sc1
    s_mov_b32 s64, 0
    buffer_load_dwordx4 v[164:167], v152, s[16:19], s64 offen offset:2048 sc1
    s_mov_b32 s64, 0
    buffer_load_dwordx4 v[168:171], v152, s[16:19], s64 offen offset:3072 sc1
    s_mov_b32 s64, 4096
    buffer_load_dwordx4 v[172:175], v152, s[16:19], s64 offen offset:0 sc1
    s_mov_b32 s64, 4096
    buffer_load_dwordx4 v[176:179], v152, s[16:19], s64 offen offset:1024 sc1
    s_mov_b32 s64, 4096
    buffer_load_dwordx4 v[180:183], v152, s[16:19], s64 offen offset:2048 sc1
    s_mov_b32 s64, 4096
    buffer_load_dwordx4 v[184:187], v152, s[16:19], s64 offen offset:3072 sc1
    s_mov_b32 s64, 8192
    buffer_load_dwordx4 v[188:191], v152, s[16:19], s64 offen offset:0 sc1
    s_mov_b32 s64, 8192
    buffer_load_dwordx4 v[192:195], v152, s[16:19], s64 offen offset:1024 sc1
    s_mov_b32 s64, 8192
    buffer_load_dwordx4 v[196:199], v152, s[16:19], s64 offen offset:2048 sc1
    s_mov_b32 s64, 8192
    buffer_load_dwordx4 v[200:203], v152, s[16:19], s64 offen offset:3072 sc1
    s_mov_b32 s64, 12288
    buffer_load_dwordx4 v[204:207], v152, s[16:19], s64 offen offset:0 sc1
    s_mov_b32 s64, 12288
    buffer_load_dwordx4 v[208:211], v152, s[16:19], s64 offen offset:1024 sc1
    s_mov_b32 s64, 12288
    buffer_load_dwordx4 v[212:215], v152, s[16:19], s64 offen offset:2048 sc1
    s_mov_b32 s64, 12288
    buffer_load_dwordx4 v[216:219], v152, s[16:19], s64 offen offset:3072 sc1
C_nh0:
    s_and_b32 s64, s3, 3
    s_lshl_b32 s64, s64, 1
    s_lshr_b32 s65, s3, 2
    s_add_u32 s64, s64, s65
    s_lshl_b32 s64, s64, 4
    s_lshl_b32 s65, s4, 7
    s_add_u32 s64, s64, s65
    v_and_b32 v230, 15, v2
    v_add_u32 v230, s64, v230
    v_bfe_u32 v3, v2, 4, 1
    v_lshlrev_b32 v229, 5, v3
    v_lshrrev_b32 v3, 5, v2
    v_lshl_add_u32 v229, v3, 4, v229
    v_lshl_add_u32 v231, v230, 11, v229
    s_lshl_b32 s64, s5, 7
    v_add_u32 v231, s64, v231
    v_lshlrev_b32 v3, 2, v230
    v_add_u32 v3, 6709248, v3
    buffer_load_dwordx4 v[220:223], v231, s[8:11], 0 offen
    buffer_load_dwordx4 v[224:227], v231, s[8:11], 0 offen offset:64
    buffer_load_dword v228, v3, s[16:19], 0 offen sc1
    v_lshlrev_b32 v3, 4, v2
    s_lshl_b32 s64, s7, 11
    v_add_u32 v4, s64, v3
    v_lshrrev_b32 v5, 4, v2
    v_lshlrev_b32 v5, 4, v5
    s_lshl_b32 s64, s7, 6
    v_add_u32 v5, s64, v5
    v_mov_b32 v6, 4256
    ds_read_b32 v6, v6
    v_cvt_pk_bf16_f32 v32, v64, v65
    v_lshlrev_b32 v48, 16, v32
    v_and_b32 v49, 0xffff0000, v32
    v_mul_f32 v50, s72, v48
    v_mul_f32 v51, s72, v49
    v_exp_f32 v50, v50 clamp
    v_exp_f32 v51, v51 clamp
    v_max_f32 v48, 0, v48
    v_max_f32 v49, 0, v49
    v_add_f32 v48, v48, v50
    v_add_f32 v49, v49, v51
    v_min_f32 v56, v48, v49
    v_cvt_pk_bf16_f32 v32, v48, v49
    v_cvt_pk_bf16_f32 v33, v66, v67
    v_lshlrev_b32 v48, 16, v33
    v_and_b32 v49, 0xffff0000, v33
    v_mul_f32 v50, s72, v48
    v_mul_f32 v51, s72, v49
    v_exp_f32 v50, v50 clamp
    v_exp_f32 v51, v51 clamp
    v_max_f32 v48, 0, v48
    v_max_f32 v49, 0, v49
    v_add_f32 v48, v48, v50
    v_add_f32 v49, v49, v51
    v_min3_f32 v56, v48, v49, v56
    v_cvt_pk_bf16_f32 v33, v48, v49
    v_cvt_pk_bf16_f32 v34, v68, v69
    v_lshlrev_b32 v48, 16, v34
    v_and_b32 v49, 0xffff0000, v34
    v_mul_f32 v50, s72, v48
    v_mul_f32 v51, s72, v49
    v_exp_f32 v50, v50 clamp
    v_exp_f32 v51, v51 clamp
    v_max_f32 v48, 0, v48
    v_max_f32 v49, 0, v49
    v_add_f32 v48, v48, v50
    v_add_f32 v49, v49, v51
    v_min3_f32 v56, v48, v49, v56
    v_cvt_pk_bf16_f32 v34, v48, v49
    v_cvt_pk_bf16_f32 v35, v70, v71
    v_lshlrev_b32 v48, 16, v35
    v_and_b32 v49, 0xffff0000, v35
    v_mul_f32 v50, s72, v48
    v_mul_f32 v51, s72, v49
    v_exp_f32 v50, v50 clamp
    v_exp_f32 v51, v51 clamp
    v_max_f32 v48, 0, v48
    v_max_f32 v49, 0, v49
    v_add_f32 v48, v48, v50
    v_add_f32 v49, v49, v51
    v_min3_f32 v56, v48, v49, v56
    v_cvt_pk_bf16_f32 v35, v48, v49
    v_cvt_pk_bf16_f32 v36, v72, v73
    v_lshlrev_b32 v48, 16, v36
    v_and_b32 v49, 0xffff0000, v36
    v_mul_f32 v50, s72, v48
    v_mul_f32 v51, s72, v49
    v_exp_f32 v50, v50 clamp
    v_exp_f32 v51, v51 clamp
    v_max_f32 v48, 0, v48
    v_max_f32 v49, 0, v49
    v_add_f32 v48, v48, v50
    v_add_f32 v49, v49, v51
    v_min3_f32 v56, v48, v49, v56
    v_cvt_pk_bf16_f32 v36, v48, v49
    v_cvt_pk_bf16_f32 v37, v74, v75
    v_lshlrev_b32 v48, 16, v37
    v_and_b32 v49, 0xffff0000, v37
    v_mul_f32 v50, s72, v48
    v_mul_f32 v51, s72, v49
    v_exp_f32 v50, v50 clamp
    v_exp_f32 v51, v51 clamp
    v_max_f32 v48, 0, v48
    v_max_f32 v49, 0, v49
    v_add_f32 v48, v48, v50
    v_add_f32 v49, v49, v51
    v_min3_f32 v56, v48, v49, v56
    v_cvt_pk_bf16_f32 v37, v48, v49
    v_cvt_pk_bf16_f32 v38, v76, v77
    v_lshlrev_b32 v48, 16, v38
    v_and_b32 v49, 0xffff0000, v38
    v_mul_f32 v50, s72, v48
    v_mul_f32 v51, s72, v49
    v_exp_f32 v50, v50 clamp
    v_exp_f32 v51, v51 clamp
    v_max_f32 v48, 0, v48
    v_max_f32 v49, 0, v49
    v_add_f32 v48, v48, v50
    v_add_f32 v49, v49, v51
    v_min3_f32 v56, v48, v49, v56
    v_cvt_pk_bf16_f32 v38, v48, v49
    v_cvt_pk_bf16_f32 v39, v78, v79
    v_lshlrev_b32 v48, 16, v39
    v_and_b32 v49, 0xffff0000, v39
    v_mul_f32 v50, s72, v48
    v_mul_f32 v51, s72, v49
    v_exp_f32 v50, v50 clamp
    v_exp_f32 v51, v51 clamp
    v_max_f32 v48, 0, v48
    v_max_f32 v49, 0, v49
    v_add_f32 v48, v48, v50
    v_add_f32 v49, v49, v51
    v_min3_f32 v56, v48, v49, v56
    v_cvt_pk_bf16_f32 v39, v48, v49
    v_cmp_gt_f32 vcc, 0x3a800000, v56
    s_cbranch_vccnz phi_18_fix
phi_18_done:
    v_cvt_pk_bf16_f32 v40, v80, v81
    v_lshlrev_b32 v48, 16, v40
    v_and_b32 v49, 0xffff0000, v40
    v_mul_f32 v50, s72, v48
    v_mul_f32 v51, s72, v49
    v_exp_f32 v50, v50 clamp
    v_exp_f32 v51, v51 clamp
    v_max_f32 v48, 0, v48
    v_max_f32 v49, 0, v49
    v_add_f32 v48, v48, v50
    v_add_f32 v49, v49, v51
    v_min_f32 v56, v48, v49
    v_cvt_pk_bf16_f32 v40, v48, v49
    v_cvt_pk_bf16_f32 v41, v82, v83
    v_lshlrev_b32 v48, 16, v41
    v_and_b32 v49, 0xffff0000, v41
    v_mul_f32 v50, s72, v48
    v_mul_f32 v51, s72, v49
    v_exp_f32 v50, v50 clamp
    v_exp_f32 v51, v51 clamp
    v_max_f32 v48, 0, v48
    v_max_f32 v49, 0, v49
    v_add_f32 v48, v48, v50
    v_add_f32 v49, v49, v51
    v_min3_f32 v56, v48, v49, v56
    v_cvt_pk_bf16_f32 v41, v48, v49
    v_cvt_pk_bf16_f32 v42, v84, v85
    v_lshlrev_b32 v48, 16, v42
    v_and_b32 v49, 0xffff0000, v42
    v_mul_f32 v50, s72, v48
    v_mul_f32 v51, s72, v49
    v_exp_f32 v50, v50 clamp
    v_exp_f32 v51, v51 clamp
    v_max_f32 v48, 0, v48
    v_max_f32 v49, 0, v49
    v_add_f32 v48, v48, v50
    v_add_f32 v49, v49, v51
    v_min3_f32 v56, v48, v49, v56
    v_cvt_pk_bf16_f32 v42, v48, v49
    v_cvt_pk_bf16_f32 v43, v86, v87
    v_lshlrev_b32 v48, 16, v43
    v_and_b32 v49, 0xffff0000, v43
    v_mul_f32 v50, s72, v48
    v_mul_f32 v51, s72, v49
    v_exp_f32 v50, v50 clamp
    v_exp_f32 v51, v51 clamp
    v_max_f32 v48, 0, v48
    v_max_f32 v49, 0, v49
    v_add_f32 v48, v48, v50
    v_add_f32 v49, v49, v51
    v_min3_f32 v56, v48, v49, v56
    v_cvt_pk_bf16_f32 v43, v48, v49
    v_cvt_pk_bf16_f32 v44, v88, v89
    v_lshlrev_b32 v48, 16, v44
    v_and_b32 v49, 0xffff0000, v44
    v_mul_f32 v50, s72, v48
    v_mul_f32 v51, s72, v49
    v_exp_f32 v50, v50 clamp
    v_exp_f32 v51, v51 clamp
    v_max_f32 v48, 0, v48
    v_max_f32 v49, 0, v49
    v_add_f32 v48, v48, v50
    v_add_f32 v49, v49, v51
    v_min3_f32 v56, v48, v49, v56
    v_cvt_pk_bf16_f32 v44, v48, v49
    v_cvt_pk_bf16_f32 v45, v90, v91
    v_lshlrev_b32 v48, 16, v45
    v_and_b32 v49, 0xffff0000, v45
    v_mul_f32 v50, s72, v48
    v_mul_f32 v51, s72, v49
    v_exp_f32 v50, v50 clamp
    v_exp_f32 v51, v51 clamp
    v_max_f32 v48, 0, v48
    v_max_f32 v49, 0, v49
    v_add_f32 v48, v48, v50
    v_add_f32 v49, v49, v51
    v_min3_f32 v56, v48, v49, v56
    v_cvt_pk_bf16_f32 v45, v48, v49
    v_cvt_pk_bf16_f32 v46, v92, v93
    v_lshlrev_b32 v48, 16, v46
    v_and_b32 v49, 0xffff0000, v46
    v_mul_f32 v50, s72, v48
    v_mul_f32 v51, s72, v49
    v_exp_f32 v50, v50 clamp
    v_exp_f32 v51, v51 clamp
    v_max_f32 v48, 0, v48
    v_max_f32 v49, 0, v49
    v_add_f32 v48, v48, v50
    v_add_f32 v49, v49, v51
    v_min3_f32 v56, v48, v49, v56
    v_cvt_pk_bf16_f32 v46, v48, v49
    v_cvt_pk_bf16_f32 v47, v94, v95
    v_lshlrev_b32 v48, 16, v47
    v_and_b32 v49, 0xffff0000, v47
    v_mul_f32 v50, s72, v48
    v_mul_f32 v51, s72, v49
    v_exp_f32 v50, v50 clamp
    v_exp_f32 v51, v51 clamp
    v_max_f32 v48, 0, v48
    v_max_f32 v49, 0, v49
    v_add_f32 v48, v48, v50
    v_add_f32 v49, v49, v51
    v_min3_f32 v56, v48, v49, v56
    v_cvt_pk_bf16_f32 v47, v48, v49
    v_cmp_gt_f32 vcc, 0x3a800000, v56
    s_cbranch_vccnz phi_19_fix
phi_19_done:
    s_waitcnt lgkmcnt(0)
    v_readfirstlane_b32 s75, v6
    s_waitcnt vmcnt(0)
    v_sub_f32 v248, 1.0, v228
    v_cvt_pk_bf16_f32 v248, v248, v248
    v_lshlrev_b32 v248, 16, v248
    v_lshlrev_b32 v232, 16, v220
    v_and_b32 v233, 0xffff0000, v220
    v_mul_f32 v232, v232, v248
    v_mul_f32 v233, v233, v248
    v_cvt_pk_bf16_f32 v3, v232, v233
    v_lshlrev_b32 v232, 16, v3
    v_and_b32 v233, 0xffff0000, v3
    v_lshlrev_b32 v234, 16, v221
    v_and_b32 v235, 0xffff0000, v221
    v_mul_f32 v234, v234, v248
    v_mul_f32 v235, v235, v248
    v_cvt_pk_bf16_f32 v3, v234, v235
    v_lshlrev_b32 v234, 16, v3
    v_and_b32 v235, 0xffff0000, v3
    v_lshlrev_b32 v236, 16, v222
    v_and_b32 v237, 0xffff0000, v222
    v_mul_f32 v236, v236, v248
    v_mul_f32 v237, v237, v248
    v_cvt_pk_bf16_f32 v3, v236, v237
    v_lshlrev_b32 v236, 16, v3
    v_and_b32 v237, 0xffff0000, v3
    v_lshlrev_b32 v238, 16, v223
    v_and_b32 v239, 0xffff0000, v223
    v_mul_f32 v238, v238, v248
    v_mul_f32 v239, v239, v248
    v_cvt_pk_bf16_f32 v3, v238, v239
    v_lshlrev_b32 v238, 16, v3
    v_and_b32 v239, 0xffff0000, v3
    v_lshlrev_b32 v240, 16, v224
    v_and_b32 v241, 0xffff0000, v224
    v_mul_f32 v240, v240, v248
    v_mul_f32 v241, v241, v248
    v_cvt_pk_bf16_f32 v3, v240, v241
    v_lshlrev_b32 v240, 16, v3
    v_and_b32 v241, 0xffff0000, v3
    v_lshlrev_b32 v242, 16, v225
    v_and_b32 v243, 0xffff0000, v225
    v_mul_f32 v242, v242, v248
    v_mul_f32 v243, v243, v248
    v_cvt_pk_bf16_f32 v3, v242, v243
    v_lshlrev_b32 v242, 16, v3
    v_and_b32 v243, 0xffff0000, v3
    v_lshlrev_b32 v244, 16, v226
    v_and_b32 v245, 0xffff0000, v226
    v_mul_f32 v244, v244, v248
    v_mul_f32 v245, v245, v248
    v_cvt_pk_bf16_f32 v3, v244, v245
    v_lshlrev_b32 v244, 16, v3
    v_and_b32 v245, 0xffff0000, v3
    v_lshlrev_b32 v246, 16, v227
    v_and_b32 v247, 0xffff0000, v227
    v_mul_f32 v246, v246, v248
    v_mul_f32 v247, v247, v248
    v_cvt_pk_bf16_f32 v3, v246, v247
    v_lshlrev_b32 v246, 16, v3
    v_and_b32 v247, 0xffff0000, v3
    s_cmp_lg_u32 s3, 0
    s_cbranch_scc1 C_nh
    s_mov_b32 s65, 0
    v_lshrrev_b32 v155, 4, v2
H_hl:
    v_max3_u32 v153, v156, v157, v158
    v_max3_u32 v153, v159, v160, v153
    v_max3_u32 v153, v161, v162, v153
    v_max3_u32 v153, v163, v164, v153
    v_max3_u32 v153, v165, v166, v153
    v_max3_u32 v153, v167, v168, v153
    v_max3_u32 v153, v169, v170, v153
    v_max3_u32 v153, v171, v172, v153
    v_max3_u32 v153, v173, v174, v153
    v_max3_u32 v153, v175, v176, v153
    v_max3_u32 v153, v177, v178, v153
    v_max3_u32 v153, v179, v180, v153
    v_max3_u32 v153, v181, v182, v153
    v_max3_u32 v153, v183, v184, v153
    v_max3_u32 v153, v185, v186, v153
    v_max3_u32 v153, v187, v188, v153
    v_max3_u32 v153, v189, v190, v153
    v_max3_u32 v153, v191, v192, v153
    v_max3_u32 v153, v193, v194, v153
    v_max3_u32 v153, v195, v196, v153
    v_max3_u32 v153, v197, v198, v153
    v_max3_u32 v153, v199, v200, v153
    v_max3_u32 v153, v201, v202, v153
    v_max3_u32 v153, v203, v204, v153
    v_max3_u32 v153, v205, v206, v153
    v_max3_u32 v153, v207, v208, v153
    v_max3_u32 v153, v209, v210, v153
    v_max3_u32 v153, v211, v212, v153
    v_max3_u32 v153, v213, v214, v153
    v_max3_u32 v153, v215, v216, v153
    v_max3_u32 v153, v217, v218, v153
    v_max_u32 v153, v219, v153
    s_mov_b32 exec_lo, 0x3fff3fff
    s_mov_b32 exec_hi, 0x3fff3fff
    v_cmp_eq_u32 vcc, -1, v153
    s_mov_b64 exec, -1
    s_cbranch_vccz H_hok
    s_add_u32 s65, s65, 1
    s_cmp_ge_u32 s65, 100000
    s_cbranch_scc1 H_hok
    s_sleep 8
    s_lshr_b32 s64, s2, 2
    s_lshl_b32 s64, s64, 14
    s_add_u32 s64, s64, 5398528
    v_lshl_add_u32 v152, v2, 4, s64
    s_mov_b32 s64, 0
    buffer_load_dwordx4 v[156:159], v152, s[16:19], s64 offen offset:0 sc1
    s_mov_b32 s64, 0
    buffer_load_dwordx4 v[160:163], v152, s[16:19], s64 offen offset:1024 sc1
    s_mov_b32 s64, 0
    buffer_load_dwordx4 v[164:167], v152, s[16:19], s64 offen offset:2048 sc1
    s_mov_b32 s64, 0
    buffer_load_dwordx4 v[168:171], v152, s[16:19], s64 offen offset:3072 sc1
    s_mov_b32 s64, 4096
    buffer_load_dwordx4 v[172:175], v152, s[16:19], s64 offen offset:0 sc1
    s_mov_b32 s64, 4096
    buffer_load_dwordx4 v[176:179], v152, s[16:19], s64 offen offset:1024 sc1
    s_mov_b32 s64, 4096
    buffer_load_dwordx4 v[180:183], v152, s[16:19], s64 offen offset:2048 sc1
    s_mov_b32 s64, 4096
    buffer_load_dwordx4 v[184:187], v152, s[16:19], s64 offen offset:3072 sc1
    s_mov_b32 s64, 8192
    buffer_load_dwordx4 v[188:191], v152, s[16:19], s64 offen offset:0 sc1
    s_mov_b32 s64, 8192
    buffer_load_dwordx4 v[192:195], v152, s[16:19], s64 offen offset:1024 sc1
    s_mov_b32 s64, 8192
    buffer_load_dwordx4 v[196:199], v152, s[16:19], s64 offen offset:2048 sc1
    s_mov_b32 s64, 8192
    buffer_load_dwordx4 v[200:203], v152, s[16:19], s64 offen offset:3072 sc1
    s_mov_b32 s64, 12288
    buffer_load_dwordx4 v[204:207], v152, s[16:19], s64 offen offset:0 sc1
    s_mov_b32 s64, 12288
    buffer_load_dwordx4 v[208:211], v152, s[16:19], s64 offen offset:1024 sc1
    s_mov_b32 s64, 12288
    buffer_load_dwordx4 v[212:215], v152, s[16:19], s64 offen offset:2048 sc1
    s_mov_b32 s64, 12288
    buffer_load_dwordx4 v[216:219], v152, s[16:19], s64 offen offset:3072 sc1
    s_waitcnt vmcnt(0)
    s_branch H_hl
H_hok:
    v_add_f32 v156, v156, v160
    v_add_f32 v157, v157, v161
    v_add_f32 v158, v158, v162
    v_add_f32 v159, v159, v163
    v_add_f32 v156, v156, v164
    v_add_f32 v157, v157, v165
    v_add_f32 v158, v158, v166
    v_add_f32 v159, v159, v167
    v_add_f32 v156, v156, v168
    v_add_f32 v157, v157, v169
    v_add_f32 v158, v158, v170
    v_add_f32 v159, v159, v171
    v_add_f32 v156, v156, v172
    v_add_f32 v157, v157, v173
    v_add_f32 v158, v158, v174
    v_add_f32 v159, v159, v175
    v_add_f32 v156, v156, v176
    v_add_f32 v157, v157, v177
    v_add_f32 v158, v158, v178
    v_add_f32 v159, v159, v179
    v_add_f32 v156, v156, v180
    v_add_f32 v157, v157, v181
    v_add_f32 v158, v158, v182
    v_add_f32 v159, v159, v183
    v_add_f32 v156, v156, v184
    v_add_f32 v157, v157, v185
    v_add_f32 v158, v158, v186
    v_add_f32 v159, v159, v187
    v_add_f32 v188, v188, v192
    v_add_f32 v189, v189, v193
    v_add_f32 v190, v190, v194
    v_add_f32 v191, v191, v195
    v_add_f32 v188, v188, v196
    v_add_f32 v189, v189, v197
    v_add_f32 v190, v190, v198
    v_add_f32 v191, v191, v199
    v_add_f32 v188, v188, v200
    v_add_f32 v189, v189, v201
    v_add_f32 v190, v190, v202
    v_add_f32 v191, v191, v203
    v_add_f32 v188, v188, v204
    v_add_f32 v189, v189, v205
    v_add_f32 v190, v190, v206
    v_add_f32 v191, v191, v207
    v_add_f32 v188, v188, v208
    v_add_f32 v189, v189, v209
    v_add_f32 v190, v190, v210
    v_add_f32 v191, v191, v211
    v_add_f32 v188, v188, v212
    v_add_f32 v189, v189, v213
    v_add_f32 v190, v190, v214
    v_add_f32 v191, v191, v215
    v_add_f32 v188, v188, v216
    v_add_f32 v189, v189, v217
    v_add_f32 v190, v190, v218
    v_add_f32 v191, v191, v219
    s_nop 1
    v_permlane16_swap_b32 v156, v188
    v_permlane16_swap_b32 v157, v189
    v_permlane16_swap_b32 v158, v190
    v_permlane16_swap_b32 v159, v191
    v_add_f32 v156, v156, v188
    v_add_f32 v157, v157, v189
    v_add_f32 v158, v158, v190
    v_add_f32 v159, v159, v191
    s_nop 1
    v_permlane32_swap_b32 v156, v158
    v_permlane32_swap_b32 v157, v159
    v_add_f32 v156, v156, v158
    v_add_f32 v157, v157, v159
    s_nop 1
    v_permlane16_swap_b32 v156, v157
    v_cvt_pk_bf16_f32 v158, v156, v157
    v_lshlrev_b32 v156, 16, v158
    v_and_b32 v157, 0xffff0000, v158
    v_mul_f32 v158, s72, v156
    v_exp_f32 v158, -v158
    v_and_b32 v154, 15, v2
    v_add_f32 v158, 1.0, v158
    v_rcp_f32 v158, v158
    v_lshl_add_u32 v154, v154, 2, v155
    v_mul_f32 v158, v158, v156
    v_cvt_pk_bf16_f32 v158, v158, v158
    v_lshlrev_b32 v158, 16, v158
    v_mul_f32 v158, v158, v157
    v_cvt_pk_bf16_f32 v158, v158, v158
    v_lshlrev_b32 v158, 16, v158
    v_lshlrev_b32 v154, 2, v154
    ds_write_b32 v154, v158 offset:4352
    s_waitcnt lgkmcnt(0)
C_nh:
    v_lshlrev_b32 v3, 4, v2
    s_barrier
    ds_read_b128 v[24:27], v5 offset:4096
    ds_read_b128 v[16:19], v4 offset:0
    ds_read_b128 v[20:23], v4 offset:1024
    s_waitcnt lgkmcnt(2)
    v_mfma_f32_16x16x32_bf16 v[96:99], v[24:27], v[32:35], 0
    v_mfma_f32_16x16x32_bf16 v[100:103], v[24:27], v[36:39], 0
    v_mfma_f32_16x16x32_bf16 v[104:107], v[24:27], v[40:43], 0
    v_mfma_f32_16x16x32_bf16 v[108:111], v[24:27], v[44:47], 0
    s_waitcnt lgkmcnt(0)
    v_mfma_f32_16x16x32_bf16 v[64:67], v[16:19], v[32:35], 0
    v_mfma_f32_16x16x32_bf16 v[68:71], v[20:23], v[32:35], 0
    v_mfma_f32_16x16x32_bf16 v[72:75], v[16:19], v[36:39], 0
    v_mfma_f32_16x16x32_bf16 v[76:79], v[20:23], v[36:39], 0
    v_mfma_f32_16x16x32_bf16 v[80:83], v[16:19], v[40:43], 0
    v_mfma_f32_16x16x32_bf16 v[84:87], v[20:23], v[40:43], 0
    v_mfma_f32_16x16x32_bf16 v[88:91], v[16:19], v[44:47], 0
    v_mfma_f32_16x16x32_bf16 v[92:95], v[20:23], v[44:47], 0
    v_cvt_pk_bf16_f32 v48, v96, v96
    v_cvt_pk_bf16_f32 v49, v100, v100
    v_cvt_pk_bf16_f32 v50, v104, v104
    v_cvt_pk_bf16_f32 v51, v108, v108
    v_lshlrev_b32 v48, 16, v48
    v_lshlrev_b32 v49, 16, v49
    v_lshlrev_b32 v50, 16, v50
    v_lshlrev_b32 v51, 16, v51
    v_add_f32 v48, s73, v48
    v_add_f32 v49, s73, v49
    v_add_f32 v50, s73, v50
    v_add_f32 v51, s73, v51
    v_cvt_pk_bf16_f32 v48, v48, v48
    v_cvt_pk_bf16_f32 v49, v49, v49
    v_cvt_pk_bf16_f32 v50, v50, v50
    v_cvt_pk_bf16_f32 v51, v51, v51
    v_lshlrev_b32 v48, 16, v48
    v_lshlrev_b32 v49, 16, v49
    v_lshlrev_b32 v50, 16, v50
    v_lshlrev_b32 v51, 16, v51
    v_rcp_f32 v48, v48
    v_rcp_f32 v49, v49
    v_rcp_f32 v50, v50
    v_rcp_f32 v51, v51
    s_nop 0
    v_mul_f32 v64, v64, v48
    v_mul_f32 v65, v65, v48
    v_cvt_pk_bf16_f32 v128, v64, v65
    v_mul_f32 v66, v66, v48
    v_mul_f32 v67, v67, v48
    v_cvt_pk_bf16_f32 v129, v66, v67
    v_mul_f32 v68, v68, v48
    v_mul_f32 v69, v69, v48
    v_cvt_pk_bf16_f32 v130, v68, v69
    v_mul_f32 v70, v70, v48
    v_mul_f32 v71, v71, v48
    v_cvt_pk_bf16_f32 v131, v70, v71
    buffer_store_dwordx4 v[128:131], v1, s[16:19], s42 offen offset:0 sc0 sc1
    v_mul_f32 v72, v72, v49
    v_mul_f32 v73, v73, v49
    v_cvt_pk_bf16_f32 v132, v72, v73
    v_mul_f32 v74, v74, v49
    v_mul_f32 v75, v75, v49
    v_cvt_pk_bf16_f32 v133, v74, v75
    v_mul_f32 v76, v76, v49
    v_mul_f32 v77, v77, v49
    v_cvt_pk_bf16_f32 v134, v76, v77
    v_mul_f32 v78, v78, v49
    v_mul_f32 v79, v79, v49
    v_cvt_pk_bf16_f32 v135, v78, v79
    buffer_store_dwordx4 v[132:135], v1, s[16:19], s42 offen offset:1024 sc0 sc1
    s_add_u32 s42, s42, 65536
    v_mul_f32 v80, v80, v50
    v_mul_f32 v81, v81, v50
    v_cvt_pk_bf16_f32 v136, v80, v81
    v_mul_f32 v82, v82, v50
    v_mul_f32 v83, v83, v50
    v_cvt_pk_bf16_f32 v137, v82, v83
    v_mul_f32 v84, v84, v50
    v_mul_f32 v85, v85, v50
    v_cvt_pk_bf16_f32 v138, v84, v85
    v_mul_f32 v86, v86, v50
    v_mul_f32 v87, v87, v50
    v_cvt_pk_bf16_f32 v139, v86, v87
    buffer_store_dwordx4 v[136:139], v1, s[16:19], s42 offen offset:0 sc0 sc1
    v_mul_f32 v88, v88, v51
    v_mul_f32 v89, v89, v51
    v_cvt_pk_bf16_f32 v140, v88, v89
    v_mul_f32 v90, v90, v51
    v_mul_f32 v91, v91, v51
    v_cvt_pk_bf16_f32 v141, v90, v91
    v_mul_f32 v92, v92, v51
    v_mul_f32 v93, v93, v51
    v_cvt_pk_bf16_f32 v142, v92, v93
    v_mul_f32 v94, v94, v51
    v_mul_f32 v95, v95, v51
    v_cvt_pk_bf16_f32 v143, v94, v95
    buffer_store_dwordx4 v[140:143], v1, s[16:19], s42 offen offset:1024 sc0 sc1
    s_lshl_b32 s64, s4, 3
    s_add_u32 s64, s64, s3
    s_lshl_b32 s64, s64, 7
    s_add_u32 s64, s64, 5382144
    v_mov_b32 v14, s64
    s_mov_b64 exec, 1
    v_mov_b32 v15, 0
    buffer_atomic_or v15, v14, s[16:19], 0 offen sc0
    s_mov_b64 exec, -1
P2_start:
    s_and_b32 s6, s3, 3
    s_lshr_b32 s7, s3, 2
    s_mov_b32 s20, s58
    s_mov_b32 s21, s59
    s_mov_b32 s22, 0x400000
    s_mov_b32 s23, 0x00020000
    s_and_b32 s67, s75, 0x7ff
    s_sub_u32 s67, 2047, s67
    s_lshl_b32 s64, s4, 2
    s_add_u32 s64, s64, s6
    s_lshl_b32 s64, s64, 16
    s_lshl_b32 s65, s7, 15
    s_add_u32 s64, s64, s65
    s_lshl_b32 s65, s7, 10
    s_add_u32 s66, s64, s65
    s_xor_b32 s64, s66, 1024
    v_lshlrev_b32 v12, 4, v2
    v_add_u32 v4, s66, v12
    v_add_u32 v12, s64, v12
    v_lshrrev_b32 v10, 4, v2
    v_bfe_u32 v11, v2, 2, 2
    v_lshl_add_u32 v10, v10, 2, v11
    v_bfe_u32 v13, v10, 1, 2
    v_lshlrev_b32 v10, 7, v10
    v_lshl_add_u32 v10, v13, 5, v10
    v_and_b32 v13, 3, v2
    v_lshl_add_u32 v5, v13, 3, v10
    v_xor_b32 v6, 32, v5
    v_xor_b32 v1, 64, v5
    v_xor_b32 v3, 96, v5
    s_and_b32 s74, s5, 7
    s_lshl_b32 s74, s74, 1
    s_cmp_eq_u32 s7, 0
    s_mov_b32 s64, 147456
    s_cselect_b32 s64, 131072, s64
    s_sub_u32 m0, 16, s74
    s_and_b32 m0, m0, 15
    v_writelane_b32 v7, s64, m0
    s_cmp_eq_u32 s7, 0
    s_mov_b32 s64, 155648
    s_cselect_b32 s64, 139264, s64
    s_sub_u32 m0, 18, s74
    s_and_b32 m0, m0, 15
    v_writelane_b32 v7, s64, m0
    s_cmp_eq_u32 s7, 0
    s_mov_b32 s64, 81920
    s_cselect_b32 s64, 73728, s64
    s_sub_u32 m0, 20, s74
    s_and_b32 m0, m0, 15
    v_writelane_b32 v7, s64, m0
    s_cmp_eq_u32 s7, 0
    s_mov_b32 s64, 122880
    s_cselect_b32 s64, 114688, s64
    s_sub_u32 m0, 22, s74
    s_and_b32 m0, m0, 15
    v_writelane_b32 v7, s64, m0
    s_cmp_eq_u32 s7, 0
    s_mov_b32 s64, 49152
    s_cselect_b32 s64, 40960, s64
    s_sub_u32 m0, 24, s74
    s_and_b32 m0, m0, 15
    v_writelane_b32 v7, s64, m0
    s_cmp_eq_u32 s7, 0
    s_mov_b32 s64, 57344
    s_cselect_b32 s64, 8192, s64
    s_sub_u32 m0, 26, s74
    s_and_b32 m0, m0, 15
    v_writelane_b32 v7, s64, m0
    s_cmp_eq_u32 s7, 0
    s_mov_b32 s64, 65536
    s_cselect_b32 s64, 16384, s64
    s_sub_u32 m0, 28, s74
    s_and_b32 m0, m0, 15
    v_writelane_b32 v7, s64, m0
    s_cmp_eq_u32 s7, 0
    s_mov_b32 s64, 90112
    s_cselect_b32 s64, 98304, s64
    s_sub_u32 m0, 30, s74
    s_and_b32 m0, m0, 15
    v_writelane_b32 v7, s64, m0
    s_cmp_eq_u32 s7, 0
    v_mov_b32 v16, 0
    v_mov_b32 v17, 0
    v_mov_b32 v18, 0
    v_mov_b32 v19, 0
    v_mov_b32 v20, 0
    v_mov_b32 v21, 0
    v_mov_b32 v22, 0
    v_mov_b32 v23, 0
    v_mov_b32 v24, 0
    v_mov_b32 v25, 0
    v_mov_b32 v26, 0
    v_mov_b32 v27, 0
    v_mov_b32 v28, 0
    v_mov_b32 v29, 0
    v_mov_b32 v30, 0
    v_mov_b32 v31, 0
    v_mov_b32 v32, 0
    v_mov_b32 v33, 0
    v_mov_b32 v34, 0
    v_mov_b32 v35, 0
    v_mov_b32 v36, 0
    v_mov_b32 v37, 0
    v_mov_b32 v38, 0
    v_mov_b32 v39, 0
    v_mov_b32 v40, 0
    v_mov_b32 v41, 0
    v_mov_b32 v42, 0
    v_mov_b32 v43, 0
    v_mov_b32 v44, 0
    v_mov_b32 v45, 0
    v_mov_b32 v46, 0
    v_mov_b32 v47, 0
    v_mov_b32 v209, 0
    v_mov_b32 v215, 0
    s_lshr_b32 s46, s67, 7
    s_xor_b32 s46, s46, s4
    s_or_b32 s46, s46, s7
    s_mov_b32 s47, 0
    s_cbranch_scc0 P2_ys
P2_ysd:
    s_mov_b32 s66, 0x5555
    s_mov_b32 s65, 0
    s_cmp_lt_u32 s3, 4
    s_cbranch_scc0 D_wait
    s_waitcnt vmcnt(1)
    s_mov_b64 exec, 3
    buffer_atomic_or v255, v254, s[16:19], 0 offen
    s_mov_b64 exec, -1
    s_waitcnt vmcnt(1)
    s_branch D_got
D_wait:
    s_waitcnt vmcnt(0)
D_got:
    v_readfirstlane_b32 s68, v15
    s_mul_i32 s68, s68, 0x10001
    s_lshr_b32 s68, s68, s74
    s_lshr_b32 s64, s68, 1
    s_and_b32 s68, s68, s64
    s_and_b32 s68, s68, s66
    s_cbranch_scc1 D_go
    s_add_u32 s65, s65, 1
    s_cmp_ge_u32 s65, 40000
    s_cbranch_scc1 D_end
    s_sleep 1
    s_mov_b64 exec, 1
    v_mov_b32 v15, 0
    buffer_atomic_or v15, v14, s[16:19], 0 offen sc0
    s_mov_b64 exec, -1
    s_branch D_wait
D_go:
    s_andn2_b32 s66, s66, s68
    s_bcnt1_i32_b32 s70, s68
    s_or_b32 s64, s46, s66
    s_cbranch_scc0 P2_yl
P2_nyl:
    s_cmp_gt_u32 s70, 4
    s_cbranch_scc1 D_t58
    s_cmp_gt_u32 s70, 2
    s_cbranch_scc1 D_t34
    s_cmp_eq_u32 s70, 2
    s_cbranch_scc1 D_e2
D_e1:
    s_ff1_i32_b32 s64, s68
    s_bitset0_b32 s68, s64
    v_readlane_b32 s32, v7, s64
    s_add_u32 s69, s64, s74
    s_and_b32 s69, s69, 15
    s_lshl_b32 s69, s69, 11
    buffer_load_dwordx4 v[80:83], v4, s[16:19], s69 offen sc1
    buffer_load_dwordx4 v[84:87], v12, s[16:19], s69 offen sc1
    s_add_u32 s69, s69, 2048
    buffer_load_dwordx4 v[88:91], v4, s[16:19], s69 offen sc1
    buffer_load_dwordx4 v[92:95], v12, s[16:19], s69 offen sc1
    s_mov_b64 exec, 1
    v_mov_b32 v15, 0
    buffer_atomic_or v15, v14, s[16:19], 0 offen sc0
    s_mov_b64 exec, -1
    v_add_u32 v8, s32, v5
    ds_read_b64_tr_b16 v[48:49], v8 offset:0
    ds_read_b64_tr_b16 v[50:51], v8 offset:2048
    v_add_u32 v9, s32, v6
    ds_read_b64_tr_b16 v[52:53], v9 offset:0
    ds_read_b64_tr_b16 v[54:55], v9 offset:2048
    v_add_u32 v10, s32, v1
    ds_read_b64_tr_b16 v[56:57], v10 offset:0
    ds_read_b64_tr_b16 v[58:59], v10 offset:2048
    v_add_u32 v11, s32, v3
    ds_read_b64_tr_b16 v[60:61], v11 offset:0
    ds_read_b64_tr_b16 v[62:63], v11 offset:2048
    s_branch D_p0
D_e2:
    s_ff1_i32_b32 s64, s68
    s_bitset0_b32 s68, s64
    v_readlane_b32 s33, v7, s64
    s_add_u32 s69, s64, s74
    s_and_b32 s69, s69, 15
    s_lshl_b32 s69, s69, 11
    buffer_load_dwordx4 v[96:99], v4, s[16:19], s69 offen sc1
    buffer_load_dwordx4 v[100:103], v12, s[16:19], s69 offen sc1
    s_add_u32 s69, s69, 2048
    buffer_load_dwordx4 v[104:107], v4, s[16:19], s69 offen sc1
    buffer_load_dwordx4 v[108:111], v12, s[16:19], s69 offen sc1
    s_ff1_i32_b32 s64, s68
    s_bitset0_b32 s68, s64
    v_readlane_b32 s32, v7, s64
    s_add_u32 s69, s64, s74
    s_and_b32 s69, s69, 15
    s_lshl_b32 s69, s69, 11
    buffer_load_dwordx4 v[80:83], v4, s[16:19], s69 offen sc1
    buffer_load_dwordx4 v[84:87], v12, s[16:19], s69 offen sc1
    s_add_u32 s69, s69, 2048
    buffer_load_dwordx4 v[88:91], v4, s[16:19], s69 offen sc1
    buffer_load_dwordx4 v[92:95], v12, s[16:19], s69 offen sc1
    s_mov_b64 exec, 1
    v_mov_b32 v15, 0
    buffer_atomic_or v15, v14, s[16:19], 0 offen sc0
    s_mov_b64 exec, -1
    v_add_u32 v8, s33, v5
    ds_read_b64_tr_b16 v[48:49], v8 offset:0
    ds_read_b64_tr_b16 v[50:51], v8 offset:2048
    v_add_u32 v9, s33, v6
    ds_read_b64_tr_b16 v[52:53], v9 offset:0
    ds_read_b64_tr_b16 v[54:55], v9 offset:2048
    v_add_u32 v10, s33, v1
    ds_read_b64_tr_b16 v[56:57], v10 offset:0
    ds_read_b64_tr_b16 v[58:59], v10 offset:2048
    v_add_u32 v11, s33, v3
    ds_read_b64_tr_b16 v[60:61], v11 offset:0
    ds_read_b64_tr_b16 v[62:63], v11 offset:2048
    s_branch D_p1
D_t34:
    s_cmp_eq_u32 s70, 4
    s_cbranch_scc1 D_e4
D_e3:
    s_ff1_i32_b32 s64, s68
    s_bitset0_b32 s68, s64
    v_readlane_b32 s34, v7, s64
    s_add_u32 s69, s64, s74
    s_and_b32 s69, s69, 15
    s_lshl_b32 s69, s69, 11
    buffer_load_dwordx4 v[112:115], v4, s[16:19], s69 offen sc1
    buffer_load_dwordx4 v[116:119], v12, s[16:19], s69 offen sc1
    s_add_u32 s69, s69, 2048
    buffer_load_dwordx4 v[120:123], v4, s[16:19], s69 offen sc1
    buffer_load_dwordx4 v[124:127], v12, s[16:19], s69 offen sc1
    s_ff1_i32_b32 s64, s68
    s_bitset0_b32 s68, s64
    v_readlane_b32 s33, v7, s64
    s_add_u32 s69, s64, s74
    s_and_b32 s69, s69, 15
    s_lshl_b32 s69, s69, 11
    buffer_load_dwordx4 v[96:99], v4, s[16:19], s69 offen sc1
    buffer_load_dwordx4 v[100:103], v12, s[16:19], s69 offen sc1
    s_add_u32 s69, s69, 2048
    buffer_load_dwordx4 v[104:107], v4, s[16:19], s69 offen sc1
    buffer_load_dwordx4 v[108:111], v12, s[16:19], s69 offen sc1
    v_add_u32 v8, s34, v5
    ds_read_b64_tr_b16 v[48:49], v8 offset:0
    ds_read_b64_tr_b16 v[50:51], v8 offset:2048
    v_add_u32 v9, s34, v6
    ds_read_b64_tr_b16 v[52:53], v9 offset:0
    ds_read_b64_tr_b16 v[54:55], v9 offset:2048
    v_add_u32 v10, s34, v1
    ds_read_b64_tr_b16 v[56:57], v10 offset:0
    ds_read_b64_tr_b16 v[58:59], v10 offset:2048
    v_add_u32 v11, s34, v3
    ds_read_b64_tr_b16 v[60:61], v11 offset:0
    ds_read_b64_tr_b16 v[62:63], v11 offset:2048
    s_branch D_p2
D_e4:
    s_ff1_i32_b32 s64, s68
    s_bitset0_b32 s68, s64
    v_readlane_b32 s35, v7, s64
    s_add_u32 s69, s64, s74
    s_and_b32 s69, s69, 15
    s_lshl_b32 s69, s69, 11
    buffer_load_dwordx4 v[128:131], v4, s[16:19], s69 offen sc1
    buffer_load_dwordx4 v[132:135], v12, s[16:19], s69 offen sc1
    s_add_u32 s69, s69, 2048
    buffer_load_dwordx4 v[136:139], v4, s[16:19], s69 offen sc1
    buffer_load_dwordx4 v[140:143], v12, s[16:19], s69 offen sc1
    s_ff1_i32_b32 s64, s68
    s_bitset0_b32 s68, s64
    v_readlane_b32 s34, v7, s64
    s_add_u32 s69, s64, s74
    s_and_b32 s69, s69, 15
    s_lshl_b32 s69, s69, 11
    buffer_load_dwordx4 v[112:115], v4, s[16:19], s69 offen sc1
    buffer_load_dwordx4 v[116:119], v12, s[16:19], s69 offen sc1
    s_add_u32 s69, s69, 2048
    buffer_load_dwordx4 v[120:123], v4, s[16:19], s69 offen sc1
    buffer_load_dwordx4 v[124:127], v12, s[16:19], s69 offen sc1
    v_add_u32 v8, s35, v5
    ds_read_b64_tr_b16 v[48:49], v8 offset:0
    ds_read_b64_tr_b16 v[50:51], v8 offset:2048
    v_add_u32 v9, s35, v6
    ds_read_b64_tr_b16 v[52:53], v9 offset:0
    ds_read_b64_tr_b16 v[54:55], v9 offset:2048
    v_add_u32 v10, s35, v1
    ds_read_b64_tr_b16 v[56:57], v10 offset:0
    ds_read_b64_tr_b16 v[58:59], v10 offset:2048
    v_add_u32 v11, s35, v3
    ds_read_b64_tr_b16 v[60:61], v11 offset:0
    ds_read_b64_tr_b16 v[62:63], v11 offset:2048
    s_branch D_p3
D_t58:
    s_cmp_gt_u32 s70, 6
    s_cbranch_scc1 D_t78
    s_cmp_eq_u32 s70, 6
    s_cbranch_scc1 D_e6
D_e5:
    s_ff1_i32_b32 s64, s68
    s_bitset0_b32 s68, s64
    v_readlane_b32 s36, v7, s64
    s_add_u32 s69, s64, s74
    s_and_b32 s69, s69, 15
    s_lshl_b32 s69, s69, 11
    buffer_load_dwordx4 v[144:147], v4, s[16:19], s69 offen sc1
    buffer_load_dwordx4 v[148:151], v12, s[16:19], s69 offen sc1
    s_add_u32 s69, s69, 2048
    buffer_load_dwordx4 v[152:155], v4, s[16:19], s69 offen sc1
    buffer_load_dwordx4 v[156:159], v12, s[16:19], s69 offen sc1
    s_ff1_i32_b32 s64, s68
    s_bitset0_b32 s68, s64
    v_readlane_b32 s35, v7, s64
    s_add_u32 s69, s64, s74
    s_and_b32 s69, s69, 15
    s_lshl_b32 s69, s69, 11
    buffer_load_dwordx4 v[128:131], v4, s[16:19], s69 offen sc1
    buffer_load_dwordx4 v[132:135], v12, s[16:19], s69 offen sc1
    s_add_u32 s69, s69, 2048
    buffer_load_dwordx4 v[136:139], v4, s[16:19], s69 offen sc1
    buffer_load_dwordx4 v[140:143], v12, s[16:19], s69 offen sc1
    v_add_u32 v8, s36, v5
    ds_read_b64_tr_b16 v[48:49], v8 offset:0
    ds_read_b64_tr_b16 v[50:51], v8 offset:2048
    v_add_u32 v9, s36, v6
    ds_read_b64_tr_b16 v[52:53], v9 offset:0
    ds_read_b64_tr_b16 v[54:55], v9 offset:2048
    v_add_u32 v10, s36, v1
    ds_read_b64_tr_b16 v[56:57], v10 offset:0
    ds_read_b64_tr_b16 v[58:59], v10 offset:2048
    v_add_u32 v11, s36, v3
    ds_read_b64_tr_b16 v[60:61], v11 offset:0
    ds_read_b64_tr_b16 v[62:63], v11 offset:2048
    s_branch D_p4
D_e6:
    s_ff1_i32_b32 s64, s68
    s_bitset0_b32 s68, s64
    v_readlane_b32 s37, v7, s64
    s_add_u32 s69, s64, s74
    s_and_b32 s69, s69, 15
    s_lshl_b32 s69, s69, 11
    buffer_load_dwordx4 v[160:163], v4, s[16:19], s69 offen sc1
    buffer_load_dwordx4 v[164:167], v12, s[16:19], s69 offen sc1
    s_add_u32 s69, s69, 2048
    buffer_load_dwordx4 v[168:171], v4, s[16:19], s69 offen sc1
    buffer_load_dwordx4 v[172:175], v12, s[16:19], s69 offen sc1
    s_ff1_i32_b32 s64, s68
    s_bitset0_b32 s68, s64
    v_readlane_b32 s36, v7, s64
    s_add_u32 s69, s64, s74
    s_and_b32 s69, s69, 15
    s_lshl_b32 s69, s69, 11
    buffer_load_dwordx4 v[144:147], v4, s[16:19], s69 offen sc1
    buffer_load_dwordx4 v[148:151], v12, s[16:19], s69 offen sc1
    s_add_u32 s69, s69, 2048
    buffer_load_dwordx4 v[152:155], v4, s[16:19], s69 offen sc1
    buffer_load_dwordx4 v[156:159], v12, s[16:19], s69 offen sc1
    v_add_u32 v8, s37, v5
    ds_read_b64_tr_b16 v[48:49], v8 offset:0
    ds_read_b64_tr_b16 v[50:51], v8 offset:2048
    v_add_u32 v9, s37, v6
    ds_read_b64_tr_b16 v[52:53], v9 offset:0
    ds_read_b64_tr_b16 v[54:55], v9 offset:2048
    v_add_u32 v10, s37, v1
    ds_read_b64_tr_b16 v[56:57], v10 offset:0
    ds_read_b64_tr_b16 v[58:59], v10 offset:2048
    v_add_u32 v11, s37, v3
    ds_read_b64_tr_b16 v[60:61], v11 offset:0
    ds_read_b64_tr_b16 v[62:63], v11 offset:2048
    s_branch D_p5
D_t78:
    s_cmp_eq_u32 s70, 8
    s_cbranch_scc1 D_e8
D_e7:
    s_ff1_i32_b32 s64, s68
    s_bitset0_b32 s68, s64
    v_readlane_b32 s38, v7, s64
    s_add_u32 s69, s64, s74
    s_and_b32 s69, s69, 15
    s_lshl_b32 s69, s69, 11
    buffer_load_dwordx4 v[176:179], v4, s[16:19], s69 offen sc1
    buffer_load_dwordx4 v[180:183], v12, s[16:19], s69 offen sc1
    s_add_u32 s69, s69, 2048
    buffer_load_dwordx4 v[184:187], v4, s[16:19], s69 offen sc1
    buffer_load_dwordx4 v[188:191], v12, s[16:19], s69 offen sc1
    s_ff1_i32_b32 s64, s68
    s_bitset0_b32 s68, s64
    v_readlane_b32 s37, v7, s64
    s_add_u32 s69, s64, s74
    s_and_b32 s69, s69, 15
    s_lshl_b32 s69, s69, 11
    buffer_load_dwordx4 v[160:163], v4, s[16:19], s69 offen sc1
    buffer_load_dwordx4 v[164:167], v12, s[16:19], s69 offen sc1
    s_add_u32 s69, s69, 2048
    buffer_load_dwordx4 v[168:171], v4, s[16:19], s69 offen sc1
    buffer_load_dwordx4 v[172:175], v12, s[16:19], s69 offen sc1
    v_add_u32 v8, s38, v5
    ds_read_b64_tr_b16 v[48:49], v8 offset:0
    ds_read_b64_tr_b16 v[50:51], v8 offset:2048
    v_add_u32 v9, s38, v6
    ds_read_b64_tr_b16 v[52:53], v9 offset:0
    ds_read_b64_tr_b16 v[54:55], v9 offset:2048
    v_add_u32 v10, s38, v1
    ds_read_b64_tr_b16 v[56:57], v10 offset:0
    ds_read_b64_tr_b16 v[58:59], v10 offset:2048
    v_add_u32 v11, s38, v3
    ds_read_b64_tr_b16 v[60:61], v11 offset:0
    ds_read_b64_tr_b16 v[62:63], v11 offset:2048
    s_branch D_p6
D_e8:
    s_ff1_i32_b32 s64, s68
    s_bitset0_b32 s68, s64
    v_readlane_b32 s39, v7, s64
    s_add_u32 s69, s64, s74
    s_and_b32 s69, s69, 15
    s_lshl_b32 s69, s69, 11
    buffer_load_dwordx4 v[192:195], v4, s[16:19], s69 offen sc1
    buffer_load_dwordx4 v[196:199], v12, s[16:19], s69 offen sc1
    s_add_u32 s69, s69, 2048
    buffer_load_dwordx4 v[200:203], v4, s[16:19], s69 offen sc1
    buffer_load_dwordx4 v[204:207], v12, s[16:19], s69 offen sc1
    s_ff1_i32_b32 s64, s68
    s_bitset0_b32 s68, s64
    v_readlane_b32 s38, v7, s64
    s_add_u32 s69, s64, s74
    s_and_b32 s69, s69, 15
    s_lshl_b32 s69, s69, 11
    buffer_load_dwordx4 v[176:179], v4, s[16:19], s69 offen sc1
    buffer_load_dwordx4 v[180:183], v12, s[16:19], s69 offen sc1
    s_add_u32 s69, s69, 2048
    buffer_load_dwordx4 v[184:187], v4, s[16:19], s69 offen sc1
    buffer_load_dwordx4 v[188:191], v12, s[16:19], s69 offen sc1
    v_add_u32 v8, s39, v5
    ds_read_b64_tr_b16 v[48:49], v8 offset:0
    ds_read_b64_tr_b16 v[50:51], v8 offset:2048
    v_add_u32 v9, s39, v6
    ds_read_b64_tr_b16 v[52:53], v9 offset:0
    ds_read_b64_tr_b16 v[54:55], v9 offset:2048
    v_add_u32 v10, s39, v1
    ds_read_b64_tr_b16 v[56:57], v10 offset:0
    ds_read_b64_tr_b16 v[58:59], v10 offset:2048
    v_add_u32 v11, s39, v3
    ds_read_b64_tr_b16 v[60:61], v11 offset:0
    ds_read_b64_tr_b16 v[62:63], v11 offset:2048
D_p7:
    s_waitcnt vmcnt(4) lgkmcnt(0)
    v_mfma_f32_16x16x32_bf16 v[16:19], v[48:51], v[192:195], v[16:19]
    ds_read_b64_tr_b16 v[64:65], v8 offset:4096
    ds_read_b64_tr_b16 v[66:67], v8 offset:6144
    v_mfma_f32_16x16x32_bf16 v[32:35], v[48:51], v[196:199], v[32:35]
    ds_read_b64_tr_b16 v[68:69], v9 offset:4096
    ds_read_b64_tr_b16 v[70:71], v9 offset:6144
    v_mfma_f32_16x16x32_bf16 v[20:23], v[52:55], v[192:195], v[20:23]
    ds_read_b64_tr_b16 v[72:73], v10 offset:4096
    ds_read_b64_tr_b16 v[74:75], v10 offset:6144
    v_mfma_f32_16x16x32_bf16 v[36:39], v[52:55], v[196:199], v[36:39]
    ds_read_b64_tr_b16 v[76:77], v11 offset:4096
    ds_read_b64_tr_b16 v[78:79], v11 offset:6144
    s_ff1_i32_b32 s64, s68
    s_bitset0_b32 s68, s64
    v_readlane_b32 s37, v7, s64
    s_add_u32 s69, s64, s74
    s_and_b32 s69, s69, 15
    s_lshl_b32 s69, s69, 11
    buffer_load_dwordx4 v[160:163], v4, s[16:19], s69 offen sc1
    v_mfma_f32_16x16x32_bf16 v[24:27], v[56:59], v[192:195], v[24:27]
    v_mfma_f32_16x16x32_bf16 v[40:43], v[56:59], v[196:199], v[40:43]
    v_mfma_f32_16x16x32_bf16 v[28:31], v[60:63], v[192:195], v[28:31]
    buffer_load_dwordx4 v[164:167], v12, s[16:19], s69 offen sc1
    v_mfma_f32_16x16x32_bf16 v[44:47], v[60:63], v[196:199], v[44:47]
    s_waitcnt lgkmcnt(0)
    v_mfma_f32_16x16x32_bf16 v[16:19], v[64:67], v[200:203], v[16:19]
    v_add_u32 v8, s38, v5
    ds_read_b64_tr_b16 v[48:49], v8 offset:0
    v_mfma_f32_16x16x32_bf16 v[32:35], v[64:67], v[204:207], v[32:35]
    ds_read_b64_tr_b16 v[50:51], v8 offset:2048
    v_add_u32 v9, s38, v6
    v_mfma_f32_16x16x32_bf16 v[20:23], v[68:71], v[200:203], v[20:23]
    ds_read_b64_tr_b16 v[52:53], v9 offset:0
    ds_read_b64_tr_b16 v[54:55], v9 offset:2048
    v_mfma_f32_16x16x32_bf16 v[36:39], v[68:71], v[204:207], v[36:39]
    v_add_u32 v10, s38, v1
    ds_read_b64_tr_b16 v[56:57], v10 offset:0
    s_add_u32 s69, s69, 2048
    buffer_load_dwordx4 v[168:171], v4, s[16:19], s69 offen sc1
    v_mfma_f32_16x16x32_bf16 v[24:27], v[72:75], v[200:203], v[24:27]
    ds_read_b64_tr_b16 v[58:59], v10 offset:2048
    v_add_u32 v11, s38, v3
    v_mfma_f32_16x16x32_bf16 v[40:43], v[72:75], v[204:207], v[40:43]
    ds_read_b64_tr_b16 v[60:61], v11 offset:0
    ds_read_b64_tr_b16 v[62:63], v11 offset:2048
    v_mfma_f32_16x16x32_bf16 v[28:31], v[76:79], v[200:203], v[28:31]
    buffer_load_dwordx4 v[172:175], v12, s[16:19], s69 offen sc1
    v_mfma_f32_16x16x32_bf16 v[44:47], v[76:79], v[204:207], v[44:47]
D_p6:
    s_waitcnt vmcnt(4) lgkmcnt(0)
    v_mfma_f32_16x16x32_bf16 v[16:19], v[48:51], v[176:179], v[16:19]
    ds_read_b64_tr_b16 v[64:65], v8 offset:4096
    ds_read_b64_tr_b16 v[66:67], v8 offset:6144
    v_mfma_f32_16x16x32_bf16 v[32:35], v[48:51], v[180:183], v[32:35]
    ds_read_b64_tr_b16 v[68:69], v9 offset:4096
    ds_read_b64_tr_b16 v[70:71], v9 offset:6144
    v_mfma_f32_16x16x32_bf16 v[20:23], v[52:55], v[176:179], v[20:23]
    ds_read_b64_tr_b16 v[72:73], v10 offset:4096
    ds_read_b64_tr_b16 v[74:75], v10 offset:6144
    v_mfma_f32_16x16x32_bf16 v[36:39], v[52:55], v[180:183], v[36:39]
    ds_read_b64_tr_b16 v[76:77], v11 offset:4096
    ds_read_b64_tr_b16 v[78:79], v11 offset:6144
    s_ff1_i32_b32 s64, s68
    s_bitset0_b32 s68, s64
    v_readlane_b32 s36, v7, s64
    s_add_u32 s69, s64, s74
    s_and_b32 s69, s69, 15
    s_lshl_b32 s69, s69, 11
    buffer_load_dwordx4 v[144:147], v4, s[16:19], s69 offen sc1
    v_mfma_f32_16x16x32_bf16 v[24:27], v[56:59], v[176:179], v[24:27]
    v_mfma_f32_16x16x32_bf16 v[40:43], v[56:59], v[180:183], v[40:43]
    v_mfma_f32_16x16x32_bf16 v[28:31], v[60:63], v[176:179], v[28:31]
    buffer_load_dwordx4 v[148:151], v12, s[16:19], s69 offen sc1
    v_mfma_f32_16x16x32_bf16 v[44:47], v[60:63], v[180:183], v[44:47]
    s_waitcnt lgkmcnt(0)
    v_mfma_f32_16x16x32_bf16 v[16:19], v[64:67], v[184:187], v[16:19]
    v_add_u32 v8, s37, v5
    ds_read_b64_tr_b16 v[48:49], v8 offset:0
    v_mfma_f32_16x16x32_bf16 v[32:35], v[64:67], v[188:191], v[32:35]
    ds_read_b64_tr_b16 v[50:51], v8 offset:2048
    v_add_u32 v9, s37, v6
    v_mfma_f32_16x16x32_bf16 v[20:23], v[68:71], v[184:187], v[20:23]
    ds_read_b64_tr_b16 v[52:53], v9 offset:0
    ds_read_b64_tr_b16 v[54:55], v9 offset:2048
    v_mfma_f32_16x16x32_bf16 v[36:39], v[68:71], v[188:191], v[36:39]
    v_add_u32 v10, s37, v1
    ds_read_b64_tr_b16 v[56:57], v10 offset:0
    s_add_u32 s69, s69, 2048
    buffer_load_dwordx4 v[152:155], v4, s[16:19], s69 offen sc1
    v_mfma_f32_16x16x32_bf16 v[24:27], v[72:75], v[184:187], v[24:27]
    ds_read_b64_tr_b16 v[58:59], v10 offset:2048
    v_add_u32 v11, s37, v3
    v_mfma_f32_16x16x32_bf16 v[40:43], v[72:75], v[188:191], v[40:43]
    ds_read_b64_tr_b16 v[60:61], v11 offset:0
    ds_read_b64_tr_b16 v[62:63], v11 offset:2048
    v_mfma_f32_16x16x32_bf16 v[28:31], v[76:79], v[184:187], v[28:31]
    buffer_load_dwordx4 v[156:159], v12, s[16:19], s69 offen sc1
    v_mfma_f32_16x16x32_bf16 v[44:47], v[76:79], v[188:191], v[44:47]
D_p5:
    s_waitcnt vmcnt(4) lgkmcnt(0)
    v_mfma_f32_16x16x32_bf16 v[16:19], v[48:51], v[160:163], v[16:19]
    ds_read_b64_tr_b16 v[64:65], v8 offset:4096
    ds_read_b64_tr_b16 v[66:67], v8 offset:6144
    v_mfma_f32_16x16x32_bf16 v[32:35], v[48:51], v[164:167], v[32:35]
    ds_read_b64_tr_b16 v[68:69], v9 offset:4096
    ds_read_b64_tr_b16 v[70:71], v9 offset:6144
    v_mfma_f32_16x16x32_bf16 v[20:23], v[52:55], v[160:163], v[20:23]
    ds_read_b64_tr_b16 v[72:73], v10 offset:4096
    ds_read_b64_tr_b16 v[74:75], v10 offset:6144
    v_mfma_f32_16x16x32_bf16 v[36:39], v[52:55], v[164:167], v[36:39]
    ds_read_b64_tr_b16 v[76:77], v11 offset:4096
    ds_read_b64_tr_b16 v[78:79], v11 offset:6144
    s_ff1_i32_b32 s64, s68
    s_bitset0_b32 s68, s64
    v_readlane_b32 s35, v7, s64
    s_add_u32 s69, s64, s74
    s_and_b32 s69, s69, 15
    s_lshl_b32 s69, s69, 11
    buffer_load_dwordx4 v[128:131], v4, s[16:19], s69 offen sc1
    v_mfma_f32_16x16x32_bf16 v[24:27], v[56:59], v[160:163], v[24:27]
    v_mfma_f32_16x16x32_bf16 v[40:43], v[56:59], v[164:167], v[40:43]
    v_mfma_f32_16x16x32_bf16 v[28:31], v[60:63], v[160:163], v[28:31]
    buffer_load_dwordx4 v[132:135], v12, s[16:19], s69 offen sc1
    v_mfma_f32_16x16x32_bf16 v[44:47], v[60:63], v[164:167], v[44:47]
    s_waitcnt lgkmcnt(0)
    v_mfma_f32_16x16x32_bf16 v[16:19], v[64:67], v[168:171], v[16:19]
    v_add_u32 v8, s36, v5
    ds_read_b64_tr_b16 v[48:49], v8 offset:0
    v_mfma_f32_16x16x32_bf16 v[32:35], v[64:67], v[172:175], v[32:35]
    ds_read_b64_tr_b16 v[50:51], v8 offset:2048
    v_add_u32 v9, s36, v6
    v_mfma_f32_16x16x32_bf16 v[20:23], v[68:71], v[168:171], v[20:23]
    ds_read_b64_tr_b16 v[52:53], v9 offset:0
    ds_read_b64_tr_b16 v[54:55], v9 offset:2048
    v_mfma_f32_16x16x32_bf16 v[36:39], v[68:71], v[172:175], v[36:39]
    v_add_u32 v10, s36, v1
    ds_read_b64_tr_b16 v[56:57], v10 offset:0
    s_add_u32 s69, s69, 2048
    buffer_load_dwordx4 v[136:139], v4, s[16:19], s69 offen sc1
    v_mfma_f32_16x16x32_bf16 v[24:27], v[72:75], v[168:171], v[24:27]
    ds_read_b64_tr_b16 v[58:59], v10 offset:2048
    v_add_u32 v11, s36, v3
    v_mfma_f32_16x16x32_bf16 v[40:43], v[72:75], v[172:175], v[40:43]
    ds_read_b64_tr_b16 v[60:61], v11 offset:0
    ds_read_b64_tr_b16 v[62:63], v11 offset:2048
    v_mfma_f32_16x16x32_bf16 v[28:31], v[76:79], v[168:171], v[28:31]
    buffer_load_dwordx4 v[140:143], v12, s[16:19], s69 offen sc1
    v_mfma_f32_16x16x32_bf16 v[44:47], v[76:79], v[172:175], v[44:47]
D_p4:
    s_waitcnt vmcnt(4) lgkmcnt(0)
    v_mfma_f32_16x16x32_bf16 v[16:19], v[48:51], v[144:147], v[16:19]
    ds_read_b64_tr_b16 v[64:65], v8 offset:4096
    ds_read_b64_tr_b16 v[66:67], v8 offset:6144
    v_mfma_f32_16x16x32_bf16 v[32:35], v[48:51], v[148:151], v[32:35]
    ds_read_b64_tr_b16 v[68:69], v9 offset:4096
    ds_read_b64_tr_b16 v[70:71], v9 offset:6144
    v_mfma_f32_16x16x32_bf16 v[20:23], v[52:55], v[144:147], v[20:23]
    ds_read_b64_tr_b16 v[72:73], v10 offset:4096
    ds_read_b64_tr_b16 v[74:75], v10 offset:6144
    v_mfma_f32_16x16x32_bf16 v[36:39], v[52:55], v[148:151], v[36:39]
    ds_read_b64_tr_b16 v[76:77], v11 offset:4096
    ds_read_b64_tr_b16 v[78:79], v11 offset:6144
    s_ff1_i32_b32 s64, s68
    s_bitset0_b32 s68, s64
    v_readlane_b32 s34, v7, s64
    s_add_u32 s69, s64, s74
    s_and_b32 s69, s69, 15
    s_lshl_b32 s69, s69, 11
    buffer_load_dwordx4 v[112:115], v4, s[16:19], s69 offen sc1
    v_mfma_f32_16x16x32_bf16 v[24:27], v[56:59], v[144:147], v[24:27]
    v_mfma_f32_16x16x32_bf16 v[40:43], v[56:59], v[148:151], v[40:43]
    v_mfma_f32_16x16x32_bf16 v[28:31], v[60:63], v[144:147], v[28:31]
    buffer_load_dwordx4 v[116:119], v12, s[16:19], s69 offen sc1
    v_mfma_f32_16x16x32_bf16 v[44:47], v[60:63], v[148:151], v[44:47]
    s_waitcnt lgkmcnt(0)
    v_mfma_f32_16x16x32_bf16 v[16:19], v[64:67], v[152:155], v[16:19]
    v_add_u32 v8, s35, v5
    ds_read_b64_tr_b16 v[48:49], v8 offset:0
    v_mfma_f32_16x16x32_bf16 v[32:35], v[64:67], v[156:159], v[32:35]
    ds_read_b64_tr_b16 v[50:51], v8 offset:2048
    v_add_u32 v9, s35, v6
    v_mfma_f32_16x16x32_bf16 v[20:23], v[68:71], v[152:155], v[20:23]
    ds_read_b64_tr_b16 v[52:53], v9 offset:0
    ds_read_b64_tr_b16 v[54:55], v9 offset:2048
    v_mfma_f32_16x16x32_bf16 v[36:39], v[68:71], v[156:159], v[36:39]
    v_add_u32 v10, s35, v1
    ds_read_b64_tr_b16 v[56:57], v10 offset:0
    s_add_u32 s69, s69, 2048
    buffer_load_dwordx4 v[120:123], v4, s[16:19], s69 offen sc1
    v_mfma_f32_16x16x32_bf16 v[24:27], v[72:75], v[152:155], v[24:27]
    ds_read_b64_tr_b16 v[58:59], v10 offset:2048
    v_add_u32 v11, s35, v3
    v_mfma_f32_16x16x32_bf16 v[40:43], v[72:75], v[156:159], v[40:43]
    ds_read_b64_tr_b16 v[60:61], v11 offset:0
    ds_read_b64_tr_b16 v[62:63], v11 offset:2048
    v_mfma_f32_16x16x32_bf16 v[28:31], v[76:79], v[152:155], v[28:31]
    buffer_load_dwordx4 v[124:127], v12, s[16:19], s69 offen sc1
    v_mfma_f32_16x16x32_bf16 v[44:47], v[76:79], v[156:159], v[44:47]
D_p3:
    s_waitcnt vmcnt(4) lgkmcnt(0)
    v_mfma_f32_16x16x32_bf16 v[16:19], v[48:51], v[128:131], v[16:19]
    ds_read_b64_tr_b16 v[64:65], v8 offset:4096
    ds_read_b64_tr_b16 v[66:67], v8 offset:6144
    v_mfma_f32_16x16x32_bf16 v[32:35], v[48:51], v[132:135], v[32:35]
    ds_read_b64_tr_b16 v[68:69], v9 offset:4096
    ds_read_b64_tr_b16 v[70:71], v9 offset:6144
    v_mfma_f32_16x16x32_bf16 v[20:23], v[52:55], v[128:131], v[20:23]
    ds_read_b64_tr_b16 v[72:73], v10 offset:4096
    ds_read_b64_tr_b16 v[74:75], v10 offset:6144
    v_mfma_f32_16x16x32_bf16 v[36:39], v[52:55], v[132:135], v[36:39]
    ds_read_b64_tr_b16 v[76:77], v11 offset:4096
    ds_read_b64_tr_b16 v[78:79], v11 offset:6144
    s_ff1_i32_b32 s64, s68
    s_bitset0_b32 s68, s64
    v_readlane_b32 s33, v7, s64
    s_add_u32 s69, s64, s74
    s_and_b32 s69, s69, 15
    s_lshl_b32 s69, s69, 11
    buffer_load_dwordx4 v[96:99], v4, s[16:19], s69 offen sc1
    v_mfma_f32_16x16x32_bf16 v[24:27], v[56:59], v[128:131], v[24:27]
    v_mfma_f32_16x16x32_bf16 v[40:43], v[56:59], v[132:135], v[40:43]
    v_mfma_f32_16x16x32_bf16 v[28:31], v[60:63], v[128:131], v[28:31]
    buffer_load_dwordx4 v[100:103], v12, s[16:19], s69 offen sc1
    v_mfma_f32_16x16x32_bf16 v[44:47], v[60:63], v[132:135], v[44:47]
    s_waitcnt lgkmcnt(0)
    v_mfma_f32_16x16x32_bf16 v[16:19], v[64:67], v[136:139], v[16:19]
    v_add_u32 v8, s34, v5
    ds_read_b64_tr_b16 v[48:49], v8 offset:0
    v_mfma_f32_16x16x32_bf16 v[32:35], v[64:67], v[140:143], v[32:35]
    ds_read_b64_tr_b16 v[50:51], v8 offset:2048
    v_add_u32 v9, s34, v6
    v_mfma_f32_16x16x32_bf16 v[20:23], v[68:71], v[136:139], v[20:23]
    ds_read_b64_tr_b16 v[52:53], v9 offset:0
    ds_read_b64_tr_b16 v[54:55], v9 offset:2048
    v_mfma_f32_16x16x32_bf16 v[36:39], v[68:71], v[140:143], v[36:39]
    v_add_u32 v10, s34, v1
    ds_read_b64_tr_b16 v[56:57], v10 offset:0
    s_add_u32 s69, s69, 2048
    buffer_load_dwordx4 v[104:107], v4, s[16:19], s69 offen sc1
    v_mfma_f32_16x16x32_bf16 v[24:27], v[72:75], v[136:139], v[24:27]
    ds_read_b64_tr_b16 v[58:59], v10 offset:2048
    v_add_u32 v11, s34, v3
    v_mfma_f32_16x16x32_bf16 v[40:43], v[72:75], v[140:143], v[40:43]
    ds_read_b64_tr_b16 v[60:61], v11 offset:0
    ds_read_b64_tr_b16 v[62:63], v11 offset:2048
    v_mfma_f32_16x16x32_bf16 v[28:31], v[76:79], v[136:139], v[28:31]
    buffer_load_dwordx4 v[108:111], v12, s[16:19], s69 offen sc1
    v_mfma_f32_16x16x32_bf16 v[44:47], v[76:79], v[140:143], v[44:47]
D_p2:
    s_waitcnt vmcnt(4) lgkmcnt(0)
    v_mfma_f32_16x16x32_bf16 v[16:19], v[48:51], v[112:115], v[16:19]
    ds_read_b64_tr_b16 v[64:65], v8 offset:4096
    ds_read_b64_tr_b16 v[66:67], v8 offset:6144
    v_mfma_f32_16x16x32_bf16 v[32:35], v[48:51], v[116:119], v[32:35]
    ds_read_b64_tr_b16 v[68:69], v9 offset:4096
    ds_read_b64_tr_b16 v[70:71], v9 offset:6144
    v_mfma_f32_16x16x32_bf16 v[20:23], v[52:55], v[112:115], v[20:23]
    ds_read_b64_tr_b16 v[72:73], v10 offset:4096
    ds_read_b64_tr_b16 v[74:75], v10 offset:6144
    v_mfma_f32_16x16x32_bf16 v[36:39], v[52:55], v[116:119], v[36:39]
    ds_read_b64_tr_b16 v[76:77], v11 offset:4096
    ds_read_b64_tr_b16 v[78:79], v11 offset:6144
    s_ff1_i32_b32 s64, s68
    s_bitset0_b32 s68, s64
    v_readlane_b32 s32, v7, s64
    s_add_u32 s69, s64, s74
    s_and_b32 s69, s69, 15
    s_lshl_b32 s69, s69, 11
    buffer_load_dwordx4 v[80:83], v4, s[16:19], s69 offen sc1
    v_mfma_f32_16x16x32_bf16 v[24:27], v[56:59], v[112:115], v[24:27]
    v_mfma_f32_16x16x32_bf16 v[40:43], v[56:59], v[116:119], v[40:43]
    v_mfma_f32_16x16x32_bf16 v[28:31], v[60:63], v[112:115], v[28:31]
    buffer_load_dwordx4 v[84:87], v12, s[16:19], s69 offen sc1
    v_mfma_f32_16x16x32_bf16 v[44:47], v[60:63], v[116:119], v[44:47]
    s_waitcnt lgkmcnt(0)
    v_mfma_f32_16x16x32_bf16 v[16:19], v[64:67], v[120:123], v[16:19]
    v_add_u32 v8, s33, v5
    ds_read_b64_tr_b16 v[48:49], v8 offset:0
    v_mfma_f32_16x16x32_bf16 v[32:35], v[64:67], v[124:127], v[32:35]
    ds_read_b64_tr_b16 v[50:51], v8 offset:2048
    v_add_u32 v9, s33, v6
    v_mfma_f32_16x16x32_bf16 v[20:23], v[68:71], v[120:123], v[20:23]
    ds_read_b64_tr_b16 v[52:53], v9 offset:0
    ds_read_b64_tr_b16 v[54:55], v9 offset:2048
    v_mfma_f32_16x16x32_bf16 v[36:39], v[68:71], v[124:127], v[36:39]
    v_add_u32 v10, s33, v1
    ds_read_b64_tr_b16 v[56:57], v10 offset:0
    s_add_u32 s69, s69, 2048
    buffer_load_dwordx4 v[88:91], v4, s[16:19], s69 offen sc1
    v_mfma_f32_16x16x32_bf16 v[24:27], v[72:75], v[120:123], v[24:27]
    ds_read_b64_tr_b16 v[58:59], v10 offset:2048
    v_add_u32 v11, s33, v3
    v_mfma_f32_16x16x32_bf16 v[40:43], v[72:75], v[124:127], v[40:43]
    ds_read_b64_tr_b16 v[60:61], v11 offset:0
    ds_read_b64_tr_b16 v[62:63], v11 offset:2048
    v_mfma_f32_16x16x32_bf16 v[28:31], v[76:79], v[120:123], v[28:31]
    buffer_load_dwordx4 v[92:95], v12, s[16:19], s69 offen sc1
    s_mov_b64 exec, 1
    v_mov_b32 v15, 0
    buffer_atomic_or v15, v14, s[16:19], 0 offen sc0
    s_mov_b64 exec, -1
    v_mfma_f32_16x16x32_bf16 v[44:47], v[76:79], v[124:127], v[44:47]
D_p1:
    s_waitcnt vmcnt(5) lgkmcnt(0)
    v_mfma_f32_16x16x32_bf16 v[16:19], v[48:51], v[96:99], v[16:19]
    ds_read_b64_tr_b16 v[64:65], v8 offset:4096
    ds_read_b64_tr_b16 v[66:67], v8 offset:6144
    v_mfma_f32_16x16x32_bf16 v[32:35], v[48:51], v[100:103], v[32:35]
    ds_read_b64_tr_b16 v[68:69], v9 offset:4096
    ds_read_b64_tr_b16 v[70:71], v9 offset:6144
    v_mfma_f32_16x16x32_bf16 v[20:23], v[52:55], v[96:99], v[20:23]
    ds_read_b64_tr_b16 v[72:73], v10 offset:4096
    ds_read_b64_tr_b16 v[74:75], v10 offset:6144
    v_mfma_f32_16x16x32_bf16 v[36:39], v[52:55], v[100:103], v[36:39]
    ds_read_b64_tr_b16 v[76:77], v11 offset:4096
    ds_read_b64_tr_b16 v[78:79], v11 offset:6144
    v_mfma_f32_16x16x32_bf16 v[24:27], v[56:59], v[96:99], v[24:27]
    v_mfma_f32_16x16x32_bf16 v[40:43], v[56:59], v[100:103], v[40:43]
    v_mfma_f32_16x16x32_bf16 v[28:31], v[60:63], v[96:99], v[28:31]
    v_mfma_f32_16x16x32_bf16 v[44:47], v[60:63], v[100:103], v[44:47]
    s_waitcnt lgkmcnt(0)
    v_mfma_f32_16x16x32_bf16 v[16:19], v[64:67], v[104:107], v[16:19]
    v_add_u32 v8, s32, v5
    ds_read_b64_tr_b16 v[48:49], v8 offset:0
    v_mfma_f32_16x16x32_bf16 v[32:35], v[64:67], v[108:111], v[32:35]
    ds_read_b64_tr_b16 v[50:51], v8 offset:2048
    v_add_u32 v9, s32, v6
    v_mfma_f32_16x16x32_bf16 v[20:23], v[68:71], v[104:107], v[20:23]
    ds_read_b64_tr_b16 v[52:53], v9 offset:0
    ds_read_b64_tr_b16 v[54:55], v9 offset:2048
    v_mfma_f32_16x16x32_bf16 v[36:39], v[68:71], v[108:111], v[36:39]
    v_add_u32 v10, s32, v1
    ds_read_b64_tr_b16 v[56:57], v10 offset:0
    v_mfma_f32_16x16x32_bf16 v[24:27], v[72:75], v[104:107], v[24:27]
    ds_read_b64_tr_b16 v[58:59], v10 offset:2048
    v_add_u32 v11, s32, v3
    v_mfma_f32_16x16x32_bf16 v[40:43], v[72:75], v[108:111], v[40:43]
    ds_read_b64_tr_b16 v[60:61], v11 offset:0
    ds_read_b64_tr_b16 v[62:63], v11 offset:2048
    v_mfma_f32_16x16x32_bf16 v[28:31], v[76:79], v[104:107], v[28:31]
    v_mfma_f32_16x16x32_bf16 v[44:47], v[76:79], v[108:111], v[44:47]
D_p0:
    s_waitcnt vmcnt(1) lgkmcnt(0)
    v_mfma_f32_16x16x32_bf16 v[16:19], v[48:51], v[80:83], v[16:19]
    ds_read_b64_tr_b16 v[64:65], v8 offset:4096
    ds_read_b64_tr_b16 v[66:67], v8 offset:6144
    v_mfma_f32_16x16x32_bf16 v[32:35], v[48:51], v[84:87], v[32:35]
    ds_read_b64_tr_b16 v[68:69], v9 offset:4096
    ds_read_b64_tr_b16 v[70:71], v9 offset:6144
    v_mfma_f32_16x16x32_bf16 v[20:23], v[52:55], v[80:83], v[20:23]
    ds_read_b64_tr_b16 v[72:73], v10 offset:4096
    ds_read_b64_tr_b16 v[74:75], v10 offset:6144
    v_mfma_f32_16x16x32_bf16 v[36:39], v[52:55], v[84:87], v[36:39]
    ds_read_b64_tr_b16 v[76:77], v11 offset:4096
    ds_read_b64_tr_b16 v[78:79], v11 offset:6144
    v_mfma_f32_16x16x32_bf16 v[24:27], v[56:59], v[80:83], v[24:27]
    v_mfma_f32_16x16x32_bf16 v[40:43], v[56:59], v[84:87], v[40:43]
    v_mfma_f32_16x16x32_bf16 v[28:31], v[60:63], v[80:83], v[28:31]
    v_mfma_f32_16x16x32_bf16 v[44:47], v[60:63], v[84:87], v[44:47]
    s_waitcnt lgkmcnt(0)
    v_mfma_f32_16x16x32_bf16 v[16:19], v[64:67], v[88:91], v[16:19]
    v_mfma_f32_16x16x32_bf16 v[32:35], v[64:67], v[92:95], v[32:35]
    v_mfma_f32_16x16x32_bf16 v[20:23], v[68:71], v[88:91], v[20:23]
    v_mfma_f32_16x16x32_bf16 v[36:39], v[68:71], v[92:95], v[36:39]
    v_mfma_f32_16x16x32_bf16 v[24:27], v[72:75], v[88:91], v[24:27]
    v_mfma_f32_16x16x32_bf16 v[40:43], v[72:75], v[92:95], v[40:43]
    v_mfma_f32_16x16x32_bf16 v[28:31], v[76:79], v[88:91], v[28:31]
    v_mfma_f32_16x16x32_bf16 v[44:47], v[76:79], v[92:95], v[44:47]
    s_cmp_lg_u32 s66, 0
    s_cbranch_scc1 D_wait
D_end:
    s_lshl_b32 s64, s3, 12
    s_add_u32 s64, s64, 8192
    v_lshl_add_u32 v8, v2, 4, s64
    s_xor_b32 s65, s3, 4
    s_lshl_b32 s65, s65, 12
    s_add_u32 s65, s65, 8192
    v_lshl_add_u32 v5, v2, 4, s65
    v_lshlrev_b32 v9, 1, v229
    v_cmp_eq_u32 s[70:71], s67, v230
    s_cmp_eq_u32 s46, 0
    s_cbranch_scc1 P2_y
P2_ny:
    s_barrier
    ds_write_b128 v8, v[32:35] offset:0
    ds_write_b128 v8, v[36:39] offset:1024
    ds_write_b128 v8, v[40:43] offset:2048
    ds_write_b128 v8, v[44:47] offset:3072
    s_cmp_lg_u64 s[70:71], 0
    s_cbranch_scc1 P2_fix
P2_nr:
    s_waitcnt lgkmcnt(0)
    s_barrier
    ds_read_b128 v[64:67], v5 offset:0
    ds_read_b128 v[68:71], v5 offset:1024
    ds_read_b128 v[72:75], v5 offset:2048
    ds_read_b128 v[76:79], v5 offset:3072
    s_waitcnt lgkmcnt(2)
    v_pk_add_f32 v[16:17], v[16:17], v[64:65]
    v_pk_add_f32 v[18:19], v[18:19], v[66:67]
    v_pk_add_f32 v[20:21], v[20:21], v[68:69]
    v_pk_add_f32 v[22:23], v[22:23], v[70:71]
    v_cvt_pk_bf16_f32 v48, v16, v17
    v_cvt_pk_bf16_f32 v49, v18, v19
    v_cvt_pk_bf16_f32 v50, v20, v21
    v_cvt_pk_bf16_f32 v51, v22, v23
    s_nop 0
    v_permlane16_swap_b32 v48, v50
    v_permlane16_swap_b32 v49, v51
    v_lshlrev_b32 v16, 16, v48
    v_and_b32 v17, 0xffff0000, v48
    v_lshlrev_b32 v18, 16, v49
    v_and_b32 v19, 0xffff0000, v49
    v_lshlrev_b32 v20, 16, v50
    v_and_b32 v21, 0xffff0000, v50
    v_lshlrev_b32 v22, 16, v51
    v_and_b32 v23, 0xffff0000, v51
    v_pk_mul_f32 v[16:17], v[16:17], v[228:229] op_sel_hi:[1,0]
    v_pk_mul_f32 v[18:19], v[18:19], v[228:229] op_sel_hi:[1,0]
    v_pk_mul_f32 v[20:21], v[20:21], v[228:229] op_sel_hi:[1,0]
    v_pk_mul_f32 v[22:23], v[22:23], v[228:229] op_sel_hi:[1,0]
    v_cvt_pk_bf16_f32 v48, v16, v17
    v_cvt_pk_bf16_f32 v49, v18, v19
    v_cvt_pk_bf16_f32 v50, v20, v21
    v_cvt_pk_bf16_f32 v51, v22, v23
    v_lshlrev_b32 v16, 16, v48
    v_and_b32 v17, 0xffff0000, v48
    v_lshlrev_b32 v18, 16, v49
    v_and_b32 v19, 0xffff0000, v49
    v_lshlrev_b32 v20, 16, v50
    v_and_b32 v21, 0xffff0000, v50
    v_lshlrev_b32 v22, 16, v51
    v_and_b32 v23, 0xffff0000, v51
    v_pk_add_f32 v[16:17], v[16:17], v[232:233]
    v_pk_add_f32 v[18:19], v[18:19], v[234:235]
    v_pk_add_f32 v[20:21], v[20:21], v[236:237]
    v_pk_add_f32 v[22:23], v[22:23], v[238:239]
    v_cvt_pk_bf16_f32 v120, v16, v17
    v_cvt_pk_bf16_f32 v121, v18, v19
    v_cvt_pk_bf16_f32 v122, v20, v21
    v_cvt_pk_bf16_f32 v123, v22, v23
    v_and_b32 v6, 1, v2
    v_mul_u32_u24 v6, 1984, v6
    v_sub_u32 v231, v231, v6
    s_mov_b32 vcc_lo, 0x55555555
    s_mov_b32 vcc_hi, 0x55555555
    s_waitcnt lgkmcnt(0)
    v_pk_add_f32 v[24:25], v[24:25], v[72:73]
    v_pk_add_f32 v[26:27], v[26:27], v[74:75]
    v_pk_add_f32 v[28:29], v[28:29], v[76:77]
    v_pk_add_f32 v[30:31], v[30:31], v[78:79]
    v_cvt_pk_bf16_f32 v52, v24, v25
    v_cvt_pk_bf16_f32 v53, v26, v27
    v_cvt_pk_bf16_f32 v54, v28, v29
    v_cvt_pk_bf16_f32 v55, v30, v31
    s_nop 0
    v_permlane16_swap_b32 v52, v54
    v_permlane16_swap_b32 v53, v55
    v_lshlrev_b32 v24, 16, v52
    v_and_b32 v25, 0xffff0000, v52
    v_lshlrev_b32 v26, 16, v53
    v_and_b32 v27, 0xffff0000, v53
    v_lshlrev_b32 v28, 16, v54
    v_and_b32 v29, 0xffff0000, v54
    v_lshlrev_b32 v30, 16, v55
    v_and_b32 v31, 0xffff0000, v55
    v_pk_mul_f32 v[24:25], v[24:25], v[228:229] op_sel_hi:[1,0]
    v_pk_mul_f32 v[26:27], v[26:27], v[228:229] op_sel_hi:[1,0]
    v_pk_mul_f32 v[28:29], v[28:29], v[228:229] op_sel_hi:[1,0]
    v_pk_mul_f32 v[30:31], v[30:31], v[228:229] op_sel_hi:[1,0]
    v_cvt_pk_bf16_f32 v52, v24, v25
    v_cvt_pk_bf16_f32 v53, v26, v27
    v_cvt_pk_bf16_f32 v54, v28, v29
    v_cvt_pk_bf16_f32 v55, v30, v31
    v_lshlrev_b32 v24, 16, v52
    v_and_b32 v25, 0xffff0000, v52
    v_lshlrev_b32 v26, 16, v53
    v_and_b32 v27, 0xffff0000, v53
    v_lshlrev_b32 v28, 16, v54
    v_and_b32 v29, 0xffff0000, v54
    v_lshlrev_b32 v30, 16, v55
    v_and_b32 v31, 0xffff0000, v55
    v_pk_add_f32 v[24:25], v[24:25], v[240:241]
    v_pk_add_f32 v[26:27], v[26:27], v[242:243]
    v_pk_add_f32 v[28:29], v[28:29], v[244:245]
    v_pk_add_f32 v[30:31], v[30:31], v[246:247]
    v_cvt_pk_bf16_f32 v124, v24, v25
    v_cvt_pk_bf16_f32 v125, v26, v27
    v_cvt_pk_bf16_f32 v126, v28, v29
    v_cvt_pk_bf16_f32 v127, v30, v31
    s_nop 1
    v_cndmask_b32_dpp v56, v124, v120, vcc quad_perm:[1,0,3,2] row_mask:0xf bank_mask:0xf
    v_cndmask_b32_dpp v57, v125, v121, vcc quad_perm:[1,0,3,2] row_mask:0xf bank_mask:0xf
    v_cndmask_b32_dpp v58, v126, v122, vcc quad_perm:[1,0,3,2] row_mask:0xf bank_mask:0xf
    v_cndmask_b32_dpp v59, v127, v123, vcc quad_perm:[1,0,3,2] row_mask:0xf bank_mask:0xf
    buffer_store_dwordx4 v[56:59], v231, s[20:23], 0 offen nt
    s_not_b64 vcc, vcc
    v_cndmask_b32_dpp v60, v120, v124, vcc quad_perm:[1,0,3,2] row_mask:0xf bank_mask:0xf
    v_cndmask_b32_dpp v61, v121, v125, vcc quad_perm:[1,0,3,2] row_mask:0xf bank_mask:0xf
    v_cndmask_b32_dpp v62, v122, v126, vcc quad_perm:[1,0,3,2] row_mask:0xf bank_mask:0xf
    v_cndmask_b32_dpp v63, v123, v127, vcc quad_perm:[1,0,3,2] row_mask:0xf bank_mask:0xf
    buffer_store_dwordx4 v[60:63], v231, s[20:23], 0 offen offset:2048 nt
K_end:
    s_endpgm
H_nre:
    s_add_u32 s65, s65, 1
    s_cmp_ge_u32 s65, 200000
    s_cbranch_scc1 H_nok
    s_sleep 4
    buffer_load_dword v78, v79, s[20:23], 0 offen sc1
    s_waitcnt vmcnt(0)
    s_branch H_nspin
H_retry:
    s_add_u32 s65, s65, 1
    s_cmp_ge_u32 s65, 200000
    s_cbranch_scc1 H_nq
    s_sleep 8
    s_mov_b32 s64, 6717440
    buffer_load_dwordx4 v[24:27], v6, s[16:19], s64 offen offset:0 sc1
    buffer_load_dwordx4 v[28:31], v6, s[16:19], s64 offen offset:1024 sc1
    s_waitcnt vmcnt(0)
    s_branch H_spin
G_f15:
    s_bitset1_b32 s66, s55
    s_branch G_q15
G_f14:
    s_bitset1_b32 s66, s54
    s_branch G_q14
G_f13:
    s_bitset1_b32 s66, s53
    s_branch G_q13
G_f12:
    s_bitset1_b32 s66, s52
    s_branch G_q12
G_f11:
    s_bitset1_b32 s66, s51
    s_branch G_q11
G_f10:
    s_bitset1_b32 s66, s50
    s_branch G_q10
G_f9:
    s_bitset1_b32 s66, s49
    s_branch G_q9
G_f8:
    s_bitset1_b32 s66, s48
    s_branch G_q8
G_f7:
    s_bitset1_b32 s66, s47
    s_branch G_q7
G_f6:
    s_bitset1_b32 s66, s46
    s_branch G_q6
G_f5:
    s_bitset1_b32 s66, s45
    s_branch G_q5
G_f4:
    s_bitset1_b32 s66, s44
    s_branch G_q4
G_f3:
    s_bitset1_b32 s66, s43
    s_branch G_q3
G_f2:
    s_bitset1_b32 s66, s42
    s_branch G_q2
G_f1:
    s_bitset1_b32 s66, s41
    s_branch G_q1
G_f0:
    s_bitset1_b32 s66, s40
    s_branch G_q0
phi_16_fix:
    v_lshlrev_b32 v48, 16, v16
    v_and_b32 v49, 0xffff0000, v16
    v_add_f32 v48, s73, v48
    v_add_f32 v49, s73, v49
    v_cvt_pk_bf16_f32 v16, v48, v49
    v_lshlrev_b32 v48, 16, v17
    v_and_b32 v49, 0xffff0000, v17
    v_add_f32 v48, s73, v48
    v_add_f32 v49, s73, v49
    v_cvt_pk_bf16_f32 v17, v48, v49
    v_lshlrev_b32 v48, 16, v18
    v_and_b32 v49, 0xffff0000, v18
    v_add_f32 v48, s73, v48
    v_add_f32 v49, s73, v49
    v_cvt_pk_bf16_f32 v18, v48, v49
    v_lshlrev_b32 v48, 16, v19
    v_and_b32 v49, 0xffff0000, v19
    v_add_f32 v48, s73, v48
    v_add_f32 v49, s73, v49
    v_cvt_pk_bf16_f32 v19, v48, v49
    v_lshlrev_b32 v48, 16, v20
    v_and_b32 v49, 0xffff0000, v20
    v_add_f32 v48, s73, v48
    v_add_f32 v49, s73, v49
    v_cvt_pk_bf16_f32 v20, v48, v49
    v_lshlrev_b32 v48, 16, v21
    v_and_b32 v49, 0xffff0000, v21
    v_add_f32 v48, s73, v48
    v_add_f32 v49, s73, v49
    v_cvt_pk_bf16_f32 v21, v48, v49
    v_lshlrev_b32 v48, 16, v22
    v_and_b32 v49, 0xffff0000, v22
    v_add_f32 v48, s73, v48
    v_add_f32 v49, s73, v49
    v_cvt_pk_bf16_f32 v22, v48, v49
    v_lshlrev_b32 v48, 16, v23
    v_and_b32 v49, 0xffff0000, v23
    v_add_f32 v48, s73, v48
    v_add_f32 v49, s73, v49
    v_cvt_pk_bf16_f32 v23, v48, v49
    s_branch phi_16_done
phi_17_fix:
    v_lshlrev_b32 v48, 16, v24
    v_and_b32 v49, 0xffff0000, v24
    v_add_f32 v48, s73, v48
    v_add_f32 v49, s73, v49
    v_cvt_pk_bf16_f32 v24, v48, v49
    v_lshlrev_b32 v48, 16, v25
    v_and_b32 v49, 0xffff0000, v25
    v_add_f32 v48, s73, v48
    v_add_f32 v49, s73, v49
    v_cvt_pk_bf16_f32 v25, v48, v49
    v_lshlrev_b32 v48, 16, v26
    v_and_b32 v49, 0xffff0000, v26
    v_add_f32 v48, s73, v48
    v_add_f32 v49, s73, v49
    v_cvt_pk_bf16_f32 v26, v48, v49
    v_lshlrev_b32 v48, 16, v27
    v_and_b32 v49, 0xffff0000, v27
    v_add_f32 v48, s73, v48
    v_add_f32 v49, s73, v49
    v_cvt_pk_bf16_f32 v27, v48, v49
    v_lshlrev_b32 v48, 16, v28
    v_and_b32 v49, 0xffff0000, v28
    v_add_f32 v48, s73, v48
    v_add_f32 v49, s73, v49
    v_cvt_pk_bf16_f32 v28, v48, v49
    v_lshlrev_b32 v48, 16, v29
    v_and_b32 v49, 0xffff0000, v29
    v_add_f32 v48, s73, v48
    v_add_f32 v49, s73, v49
    v_cvt_pk_bf16_f32 v29, v48, v49
    v_lshlrev_b32 v48, 16, v30
    v_and_b32 v49, 0xffff0000, v30
    v_add_f32 v48, s73, v48
    v_add_f32 v49, s73, v49
    v_cvt_pk_bf16_f32 v30, v48, v49
    v_lshlrev_b32 v48, 16, v31
    v_and_b32 v49, 0xffff0000, v31
    v_add_f32 v48, s73, v48
    v_add_f32 v49, s73, v49
    v_cvt_pk_bf16_f32 v31, v48, v49
    s_branch phi_17_done
C_ex1:
    ds_write_b32 v227, v96 offset:4608
    ds_write_b128 v224, v[240:243] offset:32768
    ds_write_b128 v224, v[244:247] offset:33792
    s_nop 4
    v_mov_b32 v96, v60
    v_mov_b32 v240, v248
    v_mov_b32 v241, v249
    v_mov_b32 v242, v250
    v_mov_b32 v243, v251
    v_mov_b32 v244, v252
    v_mov_b32 v245, v253
    v_mov_b32 v246, v254
    v_mov_b32 v247, v255
    s_branch C_ex2
phi_18_fix:
    v_lshlrev_b32 v48, 16, v32
    v_and_b32 v49, 0xffff0000, v32
    v_add_f32 v48, s73, v48
    v_add_f32 v49, s73, v49
    v_cvt_pk_bf16_f32 v32, v48, v49
    v_lshlrev_b32 v48, 16, v33
    v_and_b32 v49, 0xffff0000, v33
    v_add_f32 v48, s73, v48
    v_add_f32 v49, s73, v49
    v_cvt_pk_bf16_f32 v33, v48, v49
    v_lshlrev_b32 v48, 16, v34
    v_and_b32 v49, 0xffff0000, v34
    v_add_f32 v48, s73, v48
    v_add_f32 v49, s73, v49
    v_cvt_pk_bf16_f32 v34, v48, v49
    v_lshlrev_b32 v48, 16, v35
    v_and_b32 v49, 0xffff0000, v35
    v_add_f32 v48, s73, v48
    v_add_f32 v49, s73, v49
    v_cvt_pk_bf16_f32 v35, v48, v49
    v_lshlrev_b32 v48, 16, v36
    v_and_b32 v49, 0xffff0000, v36
    v_add_f32 v48, s73, v48
    v_add_f32 v49, s73, v49
    v_cvt_pk_bf16_f32 v36, v48, v49
    v_lshlrev_b32 v48, 16, v37
    v_and_b32 v49, 0xffff0000, v37
    v_add_f32 v48, s73, v48
    v_add_f32 v49, s73, v49
    v_cvt_pk_bf16_f32 v37, v48, v49
    v_lshlrev_b32 v48, 16, v38
    v_and_b32 v49, 0xffff0000, v38
    v_add_f32 v48, s73, v48
    v_add_f32 v49, s73, v49
    v_cvt_pk_bf16_f32 v38, v48, v49
    v_lshlrev_b32 v48, 16, v39
    v_and_b32 v49, 0xffff0000, v39
    v_add_f32 v48, s73, v48
    v_add_f32 v49, s73, v49
    v_cvt_pk_bf16_f32 v39, v48, v49
    s_branch phi_18_done
phi_19_fix:
    v_lshlrev_b32 v48, 16, v40
    v_and_b32 v49, 0xffff0000, v40
    v_add_f32 v48, s73, v48
    v_add_f32 v49, s73, v49
    v_cvt_pk_bf16_f32 v40, v48, v49
    v_lshlrev_b32 v48, 16, v41
    v_and_b32 v49, 0xffff0000, v41
    v_add_f32 v48, s73, v48
    v_add_f32 v49, s73, v49
    v_cvt_pk_bf16_f32 v41, v48, v49
    v_lshlrev_b32 v48, 16, v42
    v_and_b32 v49, 0xffff0000, v42
    v_add_f32 v48, s73, v48
    v_add_f32 v49, s73, v49
    v_cvt_pk_bf16_f32 v42, v48, v49
    v_lshlrev_b32 v48, 16, v43
    v_and_b32 v49, 0xffff0000, v43
    v_add_f32 v48, s73, v48
    v_add_f32 v49, s73, v49
    v_cvt_pk_bf16_f32 v43, v48, v49
    v_lshlrev_b32 v48, 16, v44
    v_and_b32 v49, 0xffff0000, v44
    v_add_f32 v48, s73, v48
    v_add_f32 v49, s73, v49
    v_cvt_pk_bf16_f32 v44, v48, v49
    v_lshlrev_b32 v48, 16, v45
    v_and_b32 v49, 0xffff0000, v45
    v_add_f32 v48, s73, v48
    v_add_f32 v49, s73, v49
    v_cvt_pk_bf16_f32 v45, v48, v49
    v_lshlrev_b32 v48, 16, v46
    v_and_b32 v49, 0xffff0000, v46
    v_add_f32 v48, s73, v48
    v_add_f32 v49, s73, v49
    v_cvt_pk_bf16_f32 v46, v48, v49
    v_lshlrev_b32 v48, 16, v47
    v_and_b32 v49, 0xffff0000, v47
    v_add_f32 v48, s73, v48
    v_add_f32 v49, s73, v49
    v_cvt_pk_bf16_f32 v47, v48, v49
    s_branch phi_19_done
P2_ys:
    v_lshrrev_b32 v13, 4, v2
    v_lshlrev_b32 v13, 12, v13
    v_and_b32 v208, 15, v2
    v_lshl_add_u32 v13, v208, 4, v13
    s_lshl_b32 s64, s5, 8
    s_lshl_b32 s65, s3, 16
    s_add_u32 s64, s64, s65
    v_add_u32 v13, s64, v13
    s_lshl_b32 s64, s67, 11
    s_lshl_b32 s65, s5, 7
    s_add_u32 s64, s64, s65
    v_lshl_add_u32 v209, v2, 1, s64
    s_lshl_b32 s64, s67, 2
    s_add_u32 s64, s64, 6709248
    v_mov_b32 v215, s64
    s_branch P2_ysd
P2_yl:
    s_cmp_gt_u32 s70, 7
    s_cbranch_scc1 P2_nyl
    buffer_load_ushort v211, v209, s[8:11], 0 offen
    buffer_load_dword v212, v215, s[16:19], 0 offen sc1
    s_mov_b32 s69, 6447104
    buffer_load_dwordx4 v[192:195], v13, s[16:19], s69 offen sc1
    s_mov_b32 s69, 6463488
    buffer_load_dwordx4 v[196:199], v13, s[16:19], s69 offen sc1
    s_mov_b32 s69, 6479872
    buffer_load_dwordx4 v[200:203], v13, s[16:19], s69 offen sc1
    s_mov_b32 s69, 6496256
    buffer_load_dwordx4 v[204:207], v13, s[16:19], s69 offen sc1
    s_mov_b32 s47, 1
    s_branch P2_nyl
P2_y:
    s_mov_b32 s66, 0
    s_cmp_lg_u32 s47, 0
    s_cbranch_scc1 P2_ychk
P2_yre:
    buffer_load_ushort v211, v209, s[8:11], 0 offen
    buffer_load_dword v212, v215, s[16:19], 0 offen sc1
    s_mov_b32 s69, 6447104
    buffer_load_dwordx4 v[192:195], v13, s[16:19], s69 offen sc1
    s_mov_b32 s69, 6463488
    buffer_load_dwordx4 v[196:199], v13, s[16:19], s69 offen sc1
    s_mov_b32 s69, 6479872
    buffer_load_dwordx4 v[200:203], v13, s[16:19], s69 offen sc1
    s_mov_b32 s69, 6496256
    buffer_load_dwordx4 v[204:207], v13, s[16:19], s69 offen sc1
P2_ychk:
    s_waitcnt vmcnt(0)
    v_max3_u32 v10, v192, v193, v194
    v_max3_u32 v10, v195, v196, v10
    v_max3_u32 v10, v197, v198, v10
    v_max3_u32 v10, v199, v200, v10
    v_max3_u32 v10, v201, v202, v10
    v_max3_u32 v10, v203, v204, v10
    v_max3_u32 v10, v205, v206, v10
    v_max_u32 v10, v207, v10
    v_cmp_eq_u32 vcc, -1, v10
    s_cbranch_vccz P2_yok
    s_add_u32 s66, s66, 1
    s_cmp_ge_u32 s66, 40000
    s_cbranch_scc1 P2_yok
    s_sleep 4
    s_branch P2_yre
P2_yok:
    v_pk_add_f32 v[192:193], v[192:193], v[200:201]
    v_pk_add_f32 v[194:195], v[194:195], v[202:203]
    v_pk_add_f32 v[196:197], v[196:197], v[204:205]
    v_pk_add_f32 v[198:199], v[198:199], v[206:207]
    v_pk_add_f32 v[192:193], v[192:193], v[196:197]
    v_pk_add_f32 v[194:195], v[194:195], v[198:199]
    v_mov_b32 v196, v192
    v_mov_b32 v197, v193
    v_mov_b32 v198, v194
    v_mov_b32 v199, v195
    s_nop 0
    v_permlane16_swap_b32 v192, v196
    v_permlane16_swap_b32 v193, v197
    v_permlane16_swap_b32 v194, v198
    v_permlane16_swap_b32 v195, v199
    v_add_f32 v192, v192, v196
    v_add_f32 v193, v193, v197
    v_add_f32 v194, v194, v198
    v_add_f32 v195, v195, v199
    v_mov_b32 v196, v192
    v_mov_b32 v197, v193
    v_mov_b32 v198, v194
    v_mov_b32 v199, v195
    s_nop 0
    v_permlane32_swap_b32 v192, v196
    v_permlane32_swap_b32 v193, v197
    v_permlane32_swap_b32 v194, v198
    v_permlane32_swap_b32 v195, v199
    v_add_f32 v192, v192, v196
    v_add_f32 v193, v193, v197
    v_add_f32 v194, v194, v198
    v_add_f32 v195, v195, v199
    s_lshl_b32 s64, s3, 8
    v_lshl_add_u32 v208, v208, 4, s64
    ds_write_b128 v208, v[192:195] offset:5888
    v_mov_b32 v208, 0
    v_mov_b32 v214, 1
    s_mov_b64 exec, 1
    ds_add_rtn_u32 v210, v208, v214 offset:4304
    s_mov_b64 exec, -1
    s_and_b32 s64, s75, 0xffff0000
    s_xor_b32 s65, s64, 0x80000000
    s_not_b32 s69, s64
    s_and_b32 s69, s69, 0xffff0000
    s_cmp_ge_u32 s64, 0x80000000
    s_cselect_b32 s64, s65, s69
    v_mov_b32 v213, s64
    v_lshlrev_b32 v208, 2, v2
    s_waitcnt lgkmcnt(0)
    v_readfirstlane_b32 s64, v210
    s_cmp_lg_u32 s64, 3
    s_cbranch_scc1 P2_ny
    ds_read_b32 v192, v208 offset:5888
    ds_read_b32 v193, v208 offset:6144
    ds_read_b32 v194, v208 offset:6400
    ds_read_b32 v195, v208 offset:6656
    v_mul_f32 v213, s72, v213
    v_exp_f32 v213, -v213
    s_nop 0
    v_add_f32 v213, 1.0, v213
    v_rcp_f32 v213, v213
    s_nop 0
    v_cvt_pk_bf16_f32 v213, v213, v213
    v_lshlrev_b32 v213, 16, v213
    v_sub_f32 v214, 1.0, v212
    v_cvt_pk_bf16_f32 v214, v214, v214
    v_lshlrev_b32 v214, 16, v214
    v_lshlrev_b32 v211, 16, v211
    s_waitcnt lgkmcnt(0)
    v_add_f32 v192, v192, v193
    v_add_f32 v194, v194, v195
    v_add_f32 v210, v192, v194
    v_cvt_pk_bf16_f32 v210, v210, v210
    v_lshlrev_b32 v210, 16, v210
    v_mul_f32 v210, v210, v213
    v_cvt_pk_bf16_f32 v210, v210, v210
    v_lshlrev_b32 v210, 16, v210
    v_add_f32 v210, v211, v210
    v_cvt_pk_bf16_f32 v210, v210, v210
    v_lshlrev_b32 v210, 16, v210
    v_mul_f32 v210, v210, v214
    v_cvt_pk_bf16_f32 v210, v210, v210
    v_lshlrev_b32 v210, 16, v210
    ds_write_b32 v208, v210 offset:5632
    s_waitcnt lgkmcnt(0)
    s_branch P2_ny
P2_fix:
    s_mov_b64 exec, s[70:71]
    ds_read_b128 v[232:235], v9 offset:5632
    ds_read_b128 v[236:239], v9 offset:5648
    ds_read_b128 v[240:243], v9 offset:5760
    ds_read_b128 v[244:247], v9 offset:5776
    s_mov_b64 exec, -1
    s_branch P2_nr
CODE_END:
.section .rodata,"a"
.p2align 6
.amdhsa_kernel gated_mix__linear_attn_block__moe_arch_mod__prompt_kernel
  .amdhsa_next_free_vgpr 256
  .amdhsa_next_free_sgpr 102
  .amdhsa_accum_offset 256
  .amdhsa_group_segment_fixed_size 0
  .amdhsa_kernarg_size 96
  .amdhsa_user_sgpr_count 2
  .amdhsa_user_sgpr_kernarg_segment_ptr 1
  .amdhsa_system_sgpr_workgroup_id_x 1
.end_amdhsa_kernel
```

```asm
; @launch grid=(256,1,1) block=(512,1,1) lds=163840
.amdgcn_target "amdgcn-amd-amdhsa--gfx950"
.text
.globl gated_mix__linear_attn_block__moe_arch_mod__prompt_kernel
.p2align 8
.type gated_mix__linear_attn_block__moe_arch_mod__prompt_kernel,@function
gated_mix__linear_attn_block__moe_arch_mod__prompt_kernel:
    s_load_dwordx16 s[40:55], s[0:1], 0
    s_load_dwordx8 s[56:63], s[0:1], 64
    s_cmp_ge_u32 s2, 256
    s_cbranch_scc1 K_end
    v_lshrrev_b32 v1, 6, v0
    v_and_b32 v2, 63, v0
    s_and_b32 s6, s2, 7
    v_readfirstlane_b32 s3, v1
    s_lshr_b32 s7, s2, 3
    s_and_b32 s4, s6, 1
    s_lshl_b32 s4, s4, 3
    s_and_b32 s64, s7, 7
    s_add_u32 s4, s4, s64
    s_lshr_b32 s5, s6, 1
    s_lshl_b32 s5, s5, 2
    s_lshr_b32 s64, s7, 3
    s_add_u32 s5, s5, s64
    s_bitcmp1_b32 s6, 1
    s_mov_b32 s64, 0xfc74d850
    s_cselect_b32 s64, 0xfd75e860, s64
    s_and_b32 s65, s6, 1
    s_lshl_b32 s65, s65, 2
    s_and_b32 s74, s4, 3
    s_add_u32 s65, s65, s74
    s_lshl_b32 s65, s65, 2
    s_lshr_b32 s74, s64, s65
    s_and_b32 s74, s74, 15
    v_lshrrev_b32 v6, 3, v2
    s_lshl_b32 s65, s3, 3
    v_add_u32 v6, s65, v6
    s_lshl_b32 s64, s4, 7
    v_add_u32 v7, s64, v6
    v_lshlrev_b32 v7, 11, v7
    v_lshrrev_b32 v8, 4, v2
    s_and_b32 s64, s3, 1
    s_lshl_b32 s64, s64, 2
    v_add_u32 v9, s64, v8
    v_and_b32 v10, 7, v2
    v_xor_b32 v9, v9, v10
    v_lshl_add_u32 v7, v9, 4, v7
    v_mul_u32_u24 v6, 6144, v6
    v_and_b32 v9, 1, v8
    s_lshr_b32 s64, s64, 1
    v_lshl_add_u32 v9, v9, 2, s64
    v_xor_b32 v9, v9, v10
    v_lshl_add_u32 v6, v9, 4, v6
    s_lshl_b32 s64, s5, 7
    v_add_u32 v6, s64, v6
    s_lshl_b32 s66, s3, 10
    s_mov_b32 s10, 4194304
    s_mov_b32 s11, 0x00020000
    s_mov_b32 s14, 6291456
    s_mov_b32 s15, 0x00020000
    s_add_u32 s65, s74, 0
    s_and_b32 s65, s65, 15
    s_lshl_b32 s67, s65, 7
    s_mul_i32 s65, s65, 393216
    s_waitcnt lgkmcnt(0)
    s_mov_b32 s8, s40
    s_mov_b32 s9, s41
    s_mov_b32 s12, s42
    s_mov_b32 s13, s43
    s_add_u32 m0, s66, 8192
    s_add_u32 s64, s67, 0
    buffer_load_dwordx4 v7, s[8:11], s64 offen lds
    s_add_u32 m0, s66, 16384
    s_add_u32 s64, s67, 131072
    buffer_load_dwordx4 v7, s[8:11], s64 offen lds
    s_add_u32 m0, s66, 24576
    s_add_u32 s64, s65, 0
    buffer_load_dwordx4 v6, s[12:15], s64 offen lds
    s_add_u32 m0, s66, 32768
    s_add_u32 s64, s65, 2048
    buffer_load_dwordx4 v6, s[12:15], s64 offen lds
    s_add_u32 m0, s66, 40960
    s_add_u32 s64, s65, 4096
    buffer_load_dwordx4 v6, s[12:15], s64 offen lds
    s_cmp_lt_u32 s3, 4
    s_cbranch_scc1 K_nt
    s_lshl_b32 s64, s2, 2
    s_add_u32 s64, s64, s3
    s_sub_u32 s64, s64, 4
    s_mul_i32 s64, s64, 6144
    s_add_u32 s46, s12, s64
    s_addc_u32 s47, s13, 0
    s_load_dword s43, s[46:47], 384
    s_load_dword s43, s[46:47], 448
    s_load_dword s43, s[46:47], 1408
    s_load_dword s43, s[46:47], 1472
    s_load_dword s43, s[46:47], 2432
    s_load_dword s43, s[46:47], 2496
    s_load_dword s43, s[46:47], 3456
    s_load_dword s43, s[46:47], 3520
    s_load_dword s43, s[46:47], 4480
    s_load_dword s43, s[46:47], 4544
    s_load_dword s43, s[46:47], 5504
    s_load_dword s43, s[46:47], 5568
K_nt:
    s_barrier
    s_mov_b32 s72, 0x3fb8aa3b
    s_mov_b32 s73, 0x358637bd
    s_mov_b32 s16, s62
    s_mov_b32 s17, s63
    s_mov_b32 s18, 0x10000000
    s_mov_b32 s19, 0x00020000
    s_cmp_lt_u32 s3, 4
    s_cbranch_scc1 C_start
    s_sub_u32 s6, s3, 4
    s_lshl_b32 s7, s6, 10
    v_lshrrev_b32 v6, 3, v2
    s_lshl_b32 s64, s4, 7
    s_lshl_b32 s65, s6, 3
    s_add_u32 s64, s64, s65
    v_add_u32 v7, s64, v6
    v_lshlrev_b32 v7, 11, v7
    s_and_b32 s64, s6, 1
    s_lshl_b32 s64, s64, 2
    v_add_u32 v9, s64, v8
    v_xor_b32 v9, v9, v10
    v_lshl_add_u32 v4, v9, 4, v7
    v_add_u32 v7, s65, v6
    v_mul_u32_u24 v7, 6144, v7
    v_and_b32 v9, 1, v8
    s_lshr_b32 s64, s64, 1
    v_lshl_add_u32 v9, v9, 2, s64
    v_xor_b32 v9, v9, v10
    v_lshl_add_u32 v7, v9, 4, v7
    s_lshl_b32 s64, s5, 7
    v_add_u32 v5, s64, v7
    v_lshlrev_b32 v6, 4, v2
    s_and_b32 s64, s2, 1
    s_lshl_b32 s68, s64, 10
    s_bfe_u32 s64, s2, 0x20001
    s_lshl_b32 s64, s64, 8
    s_add_u32 s68, s68, s64
    s_and_b32 s64, s2, 0xf8
    s_add_u32 s68, s68, s64
    s_lshl_b32 s64, s6, 1
    s_add_u32 s68, s68, s64
    s_lshl_b32 s64, s68, 11
    v_add_u32 v13, s64, v6
    s_mov_b32 s24, s48
    s_mov_b32 s25, s49
    s_mov_b32 s26, 0x800
    s_mov_b32 s27, 0x00020000
    buffer_load_dwordx4 v[24:27], v13, s[8:11], 0 offen offset:0
    buffer_load_dwordx4 v[28:31], v13, s[8:11], 0 offen offset:1024
    buffer_load_dwordx4 v[32:35], v13, s[8:11], 0 offen offset:2048
    buffer_load_dwordx4 v[36:39], v13, s[8:11], 0 offen offset:3072
    s_cmp_lt_u32 s6, 2
    s_cselect_b32 s24, s48, s56
    s_cselect_b32 s25, s49, s57
    s_and_b32 s64, s7, 1024
    s_add_u32 m0, s7, 0
    s_nop 0
    buffer_load_dwordx4 v6, s[24:27], s64 offen lds
    s_add_u32 s41, s74, 1
    s_and_b32 s41, s41, 15
    s_lshl_b32 s42, s41, 7
    s_mul_i32 s41, s41, 393216
    s_add_u32 m0, s7, 49152
    s_add_u32 s40, s42, 0
    buffer_load_dwordx4 v4, s[8:11], s40 offen lds
    s_add_u32 m0, s7, 53248
    s_add_u32 s40, s42, 65536
    buffer_load_dwordx4 v4, s[8:11], s40 offen lds
    s_add_u32 m0, s7, 57344
    s_add_u32 s40, s42, 131072
    buffer_load_dwordx4 v4, s[8:11], s40 offen lds
    s_add_u32 m0, s7, 61440
    s_add_u32 s40, s42, 196608
    buffer_load_dwordx4 v4, s[8:11], s40 offen lds
    s_add_u32 m0, s7, 65536
    s_add_u32 s40, s41, 0
    buffer_load_dwordx4 v5, s[12:15], s40 offen lds
    s_add_u32 m0, s7, 69632
    s_add_u32 s40, s41, 196608
    buffer_load_dwordx4 v5, s[12:15], s40 offen lds
    s_add_u32 m0, s7, 73728
    s_add_u32 s40, s41, 2048
    buffer_load_dwordx4 v5, s[12:15], s40 offen lds
    s_add_u32 m0, s7, 77824
    s_add_u32 s40, s41, 198656
    buffer_load_dwordx4 v5, s[12:15], s40 offen lds
    s_add_u32 m0, s7, 81920
    s_add_u32 s40, s41, 4096
    buffer_load_dwordx4 v5, s[12:15], s40 offen lds
    s_add_u32 m0, s7, 86016
    s_add_u32 s40, s41, 200704
    buffer_load_dwordx4 v5, s[12:15], s40 offen lds
    s_mov_b32 s32, s50
    s_mov_b32 s33, s51
    s_mov_b32 s34, 0x700000
    s_mov_b32 s35, 0x00020000
    s_mov_b32 s36, s52
    s_mov_b32 s37, s53
    s_mov_b32 s38, 0x700000
    s_mov_b32 s39, 0x00020000
    s_or_b32 s64, s2, s6
    s_cmp_lg_u32 s64, 0
    s_cbranch_scc1 H_nn
    s_mov_b32 s64, 6717440
    s_load_dwordx2 s[66:67], s[62:63], s64
    s_mov_b32 s20, s60
    s_mov_b32 s21, s61
    s_mov_b32 s22, 0x100
    s_mov_b32 s23, 0x00020000
    s_waitcnt lgkmcnt(0)
    s_xor_b32 s64, s66, s67
    s_add_u32 s64, s64, 1
    s_max_u32 s64, s64, 1
    v_mov_b32 v72, s64
    v_mov_b32 v73, 0
    s_mov_b64 exec, 1
    buffer_store_dword v72, v73, s[20:23], 0 offen sc0 sc1
    s_mov_b64 exec, -1
H_nn:
    s_mov_b32 s20, s60
    s_mov_b32 s21, s61
    s_mov_b32 s22, 0x100
    s_mov_b32 s23, 0x00020000
    s_mov_b32 s28, s56
    s_mov_b32 s29, s57
    s_mov_b32 s30, 0x800
    s_mov_b32 s31, 0x00020000
    s_lshr_b32 s69, s2, 3
    s_and_b32 s64, s2, 7
    v_and_b32 v9, 15, v2
    v_min_u32 v9, 13, v9
    s_lshl_b32 s65, s69, 5
    v_lshl_add_u32 v7, v8, 3, s65
    v_mul_u32_u24 v7, 7168, v7
    s_mul_i32 s65, s64, 896
    s_mul_i32 s66, s6, 224
    s_add_u32 s65, s65, s66
    v_lshl_add_u32 v7, v9, 4, v7
    v_add_u32 v11, s65, v7
    v_cmp_le_u32 vcc, 7, v9
    v_mov_b32 v15, 16160
    s_nop 0
    v_cndmask_b32 v7, 0, v15, vcc
    v_lshl_add_u32 v7, v9, 5, v7
    v_lshrrev_b32 v15, 1, v8
    v_lshl_add_u32 v7, v15, 13, v7
    v_and_b32 v15, 1, v8
    v_lshl_add_u32 v7, v15, 4, v7
    s_lshl_b32 s64, s64, 17
    s_lshl_b32 s65, s6, 15
    s_add_u32 s64, s64, s65
    s_lshl_b32 s65, s69, 8
    s_add_u32 s64, s64, s65
    s_add_u32 s64, s64, 5398528
    v_add_u32 v12, s64, v7
    s_lshl_b32 s70, s5, 2
    s_add_u32 s70, s70, s6
    s_mul_i32 s70, s70, 18432
    s_add_u32 s70, s70, 4194304
    s_mul_i32 s64, s4, 1152
    s_add_u32 s64, s64, s70
    s_mov_b32 s67, s64
    v_lshl_add_u32 v15, v2, 2, s64
    v_add_u32 v15, 960, v15
    s_lshl_b32 s64, s5, 2
    s_add_u32 s64, s64, s6
    s_lshl_b32 s64, s64, 7
    s_add_u32 s64, s64, 5373952
    v_mov_b32 v23, s64
    s_lshl_b32 s65, s4, 10
    s_add_u32 s65, s65, 5382016
    v_lshl_add_u32 v20, v2, 7, s65
    v_cmp_gt_u32 vcc, 16, v2
    s_nop 1
    v_cndmask_b32 v15, v15, v20, vcc
    v_writelane_b32 v15, s64, 0
    s_cmp_eq_u32 s4, 0
    s_cselect_b32 s75, 1, 0
    s_or_b32 s64, s5, s6
    s_cmp_eq_u32 s64, 0
    s_cselect_b32 s64, 0x1fe, 0
    s_or_b32 s75, s75, s64
    s_or_b32 s75, s75, 0xffff0000
    v_lshlrev_b32 v22, 4, v2
    v_add_u32 v22, s67, v22
    v_mov_b32 v16, -1
    v_mov_b32 v17, -1
    v_mov_b32 v18, -1
    v_mov_b32 v19, -1
    v_cndmask_b32 v20, -1, 0, vcc
    s_waitcnt vmcnt(15)
    s_barrier
    s_add_u32 s41, s74, 2
    s_and_b32 s41, s41, 15
    s_lshl_b32 s42, s41, 7
    s_mul_i32 s41, s41, 393216
    s_add_u32 m0, s7, 90112
    s_add_u32 s40, s42, 0
    buffer_load_dwordx4 v4, s[8:11], s40 offen lds
    s_add_u32 m0, s7, 94208
    s_add_u32 s40, s42, 65536
    buffer_load_dwordx4 v4, s[8:11], s40 offen lds
    s_add_u32 m0, s7, 98304
    s_add_u32 s40, s42, 131072
    buffer_load_dwordx4 v4, s[8:11], s40 offen lds
    s_add_u32 m0, s7, 102400
    s_add_u32 s40, s42, 196608
    buffer_load_dwordx4 v4, s[8:11], s40 offen lds
    s_add_u32 m0, s7, 106496
    s_add_u32 s40, s41, 0
    buffer_load_dwordx4 v5, s[12:15], s40 offen lds
    s_add_u32 m0, s7, 110592
    s_add_u32 s40, s41, 196608
    buffer_load_dwordx4 v5, s[12:15], s40 offen lds
    s_add_u32 m0, s7, 114688
    s_add_u32 s40, s41, 2048
    buffer_load_dwordx4 v5, s[12:15], s40 offen lds
    s_add_u32 m0, s7, 118784
    s_add_u32 s40, s41, 198656
    buffer_load_dwordx4 v5, s[12:15], s40 offen lds
    s_add_u32 m0, s7, 122880
    s_add_u32 s40, s41, 4096
    buffer_load_dwordx4 v5, s[12:15], s40 offen lds
    s_add_u32 m0, s7, 126976
    s_add_u32 s40, s41, 200704
    buffer_load_dwordx4 v5, s[12:15], s40 offen lds
    s_getpc_b64 s[66:67]
pc_1:
    s_sub_u32 s66, s66, pc_1-gated_mix__linear_attn_block__moe_arch_mod__prompt_kernel
    s_subb_u32 s67, s67, 0
    s_lshr_b32 s64, s2, 3
    s_lshl_b32 s64, s64, 2
    s_add_u32 s64, s64, s6
    s_mul_i32 s64, s64, 256
    s_min_u32 s65, s64, CODE_END-gated_mix__linear_attn_block__moe_arch_mod__prompt_kernel-4
    s_load_dword s43, s[66:67], s65
    s_add_u32 s64, s64, 64
    s_min_u32 s65, s64, CODE_END-gated_mix__linear_attn_block__moe_arch_mod__prompt_kernel-4
    s_load_dword s43, s[66:67], s65
    s_add_u32 s64, s64, 64
    s_min_u32 s65, s64, CODE_END-gated_mix__linear_attn_block__moe_arch_mod__prompt_kernel-4
    s_load_dword s43, s[66:67], s65
    s_add_u32 s64, s64, 64
    s_min_u32 s65, s64, CODE_END-gated_mix__linear_attn_block__moe_arch_mod__prompt_kernel-4
    s_load_dword s43, s[66:67], s65
    s_add_u32 s64, s64, 64
    s_waitcnt vmcnt(10)
    s_barrier
    v_mov_b32 v79, 0
    s_cmp_lg_u32 s6, 0
    s_cbranch_scc1 H_nc
    buffer_load_dword v78, v79, s[20:23], 0 offen sc1
H_nc:
    s_add_u32 s41, s74, 3
    s_and_b32 s41, s41, 15
    s_lshl_b32 s42, s41, 7
    s_mul_i32 s41, s41, 393216
    s_add_u32 m0, s7, 8192
    s_add_u32 s40, s42, 0
    buffer_load_dwordx4 v4, s[8:11], s40 offen lds
    s_add_u32 m0, s7, 12288
    s_add_u32 s40, s42, 65536
    buffer_load_dwordx4 v4, s[8:11], s40 offen lds
    s_add_u32 m0, s7, 16384
    s_add_u32 s40, s42, 131072
    buffer_load_dwordx4 v4, s[8:11], s40 offen lds
    s_add_u32 m0, s7, 20480
    s_add_u32 s40, s42, 196608
    buffer_load_dwordx4 v4, s[8:11], s40 offen lds
    s_add_u32 m0, s7, 24576
    s_add_u32 s40, s41, 0
    buffer_load_dwordx4 v5, s[12:15], s40 offen lds
    s_add_u32 m0, s7, 28672
    s_add_u32 s40, s41, 196608
    buffer_load_dwordx4 v5, s[12:15], s40 offen lds
    s_add_u32 m0, s7, 32768
    s_add_u32 s40, s41, 2048
    buffer_load_dwordx4 v5, s[12:15], s40 offen lds
    s_add_u32 m0, s7, 36864
    s_add_u32 s40, s41, 198656
    buffer_load_dwordx4 v5, s[12:15], s40 offen lds
    s_add_u32 m0, s7, 40960
    s_add_u32 s40, s41, 4096
    buffer_load_dwordx4 v5, s[12:15], s40 offen lds
    s_add_u32 m0, s7, 45056
    s_add_u32 s40, s41, 200704
    buffer_load_dwordx4 v5, s[12:15], s40 offen lds
    buffer_store_dwordx4 v[16:19], v22, s[16:19], 0 offen sc0 sc1
    s_mov_b32 exec_lo, s75
    s_mov_b32 exec_hi, 0
    buffer_store_dword v20, v15, s[16:19], 0 offen sc0 sc1
    s_mov_b32 exec_lo, 0x3fff3fff
    s_mov_b32 exec_hi, 0x3fff3fff
    buffer_store_dwordx4 v[16:19], v12, s[16:19], 0 offen sc0 sc1
    s_mov_b64 exec, 0xffff
    s_lshl_b32 s64, s2, 10
    s_lshl_b32 s65, s6, 8
    s_add_u32 s64, s64, s65
    s_add_u32 s64, s64, 6447104
    buffer_store_dwordx4 v[16:19], v6, s[16:19], s64 offen sc0 sc1
    s_mov_b64 exec, -1
    s_waitcnt vmcnt(14)
    s_barrier
    ds_read_b128 v[40:43], v6 offset:0
    ds_read_b128 v[44:47], v6 offset:1024
    ds_read_b128 v[48:51], v6 offset:2048
    ds_read_b128 v[52:55], v6 offset:3072
    s_add_u32 s41, s74, 4
    s_and_b32 s41, s41, 15
    s_lshl_b32 s42, s41, 7
    s_mul_i32 s41, s41, 393216
    s_add_u32 m0, s7, 49152
    s_add_u32 s40, s42, 0
    buffer_load_dwordx4 v4, s[8:11], s40 offen lds
    s_waitcnt lgkmcnt(0)
    v_mov_b32 v84, 0x3f803f80
    v_lshlrev_b32 v56, 16, v48
    v_and_b32 v57, 0xffff0000, v48
    v_lshlrev_b32 v80, 16, v24
    s_add_u32 m0, s7, 53248
    s_add_u32 s40, s42, 65536
    buffer_load_dwordx4 v4, s[8:11], s40 offen lds
    v_and_b32 v81, 0xffff0000, v24
    v_mul_f32 v80, v80, v56
    v_mul_f32 v81, v81, v57
    v_dot2_f32_bf16 v74, v24, v40, 0
    v_cvt_pk_bf16_f32 v80, v80, v81
    v_lshlrev_b32 v82, 16, v32
    v_and_b32 v83, 0xffff0000, v32
    v_mul_f32 v82, v82, v56
    s_add_u32 m0, s7, 57344
    s_add_u32 s40, s42, 131072
    buffer_load_dwordx4 v4, s[8:11], s40 offen lds
    v_mul_f32 v83, v83, v57
    v_dot2_f32_bf16 v75, v32, v40, 0
    v_cvt_pk_bf16_f32 v82, v82, v83
    v_dot2_f32_bf16 v72, v80, v84, 0
    v_dot2_f32_bf16 v73, v82, v84, 0
    v_lshlrev_b32 v56, 16, v49
    v_and_b32 v57, 0xffff0000, v49
    v_lshlrev_b32 v80, 16, v25
    s_add_u32 m0, s7, 61440
    s_add_u32 s40, s42, 196608
    buffer_load_dwordx4 v4, s[8:11], s40 offen lds
    v_and_b32 v81, 0xffff0000, v25
    v_mul_f32 v80, v80, v56
    v_mul_f32 v81, v81, v57
    v_dot2_f32_bf16 v74, v25, v41, v74
    v_cvt_pk_bf16_f32 v80, v80, v81
    v_lshlrev_b32 v82, 16, v33
    v_and_b32 v83, 0xffff0000, v33
    v_mul_f32 v82, v82, v56
    s_add_u32 m0, s7, 65536
    s_add_u32 s40, s41, 0
    buffer_load_dwordx4 v5, s[12:15], s40 offen lds
    v_mul_f32 v83, v83, v57
    v_dot2_f32_bf16 v75, v33, v41, v75
    v_cvt_pk_bf16_f32 v82, v82, v83
    v_dot2_f32_bf16 v72, v80, v84, v72
    v_dot2_f32_bf16 v73, v82, v84, v73
    v_lshlrev_b32 v56, 16, v50
    v_and_b32 v57, 0xffff0000, v50
    v_lshlrev_b32 v80, 16, v26
    s_add_u32 m0, s7, 69632
    s_add_u32 s40, s41, 196608
    buffer_load_dwordx4 v5, s[12:15], s40 offen lds
    v_and_b32 v81, 0xffff0000, v26
    v_mul_f32 v80, v80, v56
    v_mul_f32 v81, v81, v57
    v_dot2_f32_bf16 v74, v26, v42, v74
    v_cvt_pk_bf16_f32 v80, v80, v81
    v_lshlrev_b32 v82, 16, v34
    v_and_b32 v83, 0xffff0000, v34
    v_mul_f32 v82, v82, v56
    s_add_u32 m0, s7, 73728
    s_add_u32 s40, s41, 2048
    buffer_load_dwordx4 v5, s[12:15], s40 offen lds
    v_mul_f32 v83, v83, v57
    v_dot2_f32_bf16 v75, v34, v42, v75
    v_cvt_pk_bf16_f32 v82, v82, v83
    v_dot2_f32_bf16 v72, v80, v84, v72
    v_dot2_f32_bf16 v73, v82, v84, v73
    v_lshlrev_b32 v56, 16, v51
    v_and_b32 v57, 0xffff0000, v51
    v_lshlrev_b32 v80, 16, v27
    s_add_u32 m0, s7, 77824
    s_add_u32 s40, s41, 198656
    buffer_load_dwordx4 v5, s[12:15], s40 offen lds
    v_and_b32 v81, 0xffff0000, v27
    v_mul_f32 v80, v80, v56
    v_mul_f32 v81, v81, v57
    v_dot2_f32_bf16 v74, v27, v43, v74
    v_cvt_pk_bf16_f32 v80, v80, v81
    v_lshlrev_b32 v82, 16, v35
    v_and_b32 v83, 0xffff0000, v35
    v_mul_f32 v82, v82, v56
    s_add_u32 m0, s7, 81920
    s_add_u32 s40, s41, 4096
    buffer_load_dwordx4 v5, s[12:15], s40 offen lds
    v_mul_f32 v83, v83, v57
    v_dot2_f32_bf16 v75, v35, v43, v75
    v_cvt_pk_bf16_f32 v82, v82, v83
    v_dot2_f32_bf16 v72, v80, v84, v72
    v_dot2_f32_bf16 v73, v82, v84, v73
    s_add_u32 m0, s7, 86016
    s_add_u32 s40, s41, 200704
    buffer_load_dwordx4 v5, s[12:15], s40 offen lds
    s_waitcnt vmcnt(14)
    s_barrier
    s_add_u32 s41, s74, 5
    s_and_b32 s41, s41, 15
    s_lshl_b32 s42, s41, 7
    s_mul_i32 s41, s41, 393216
    s_add_u32 m0, s7, 90112
    s_add_u32 s40, s42, 0
    buffer_load_dwordx4 v4, s[8:11], s40 offen lds
    v_lshlrev_b32 v56, 16, v52
    v_and_b32 v57, 0xffff0000, v52
    v_lshlrev_b32 v80, 16, v28
    v_and_b32 v81, 0xffff0000, v28
    v_mul_f32 v80, v80, v56
    v_mul_f32 v81, v81, v57
    v_dot2_f32_bf16 v74, v28, v44, v74
    v_cvt_pk_bf16_f32 v80, v80, v81
    s_add_u32 m0, s7, 94208
    s_add_u32 s40, s42, 65536
    buffer_load_dwordx4 v4, s[8:11], s40 offen lds
    v_lshlrev_b32 v82, 16, v36
    v_and_b32 v83, 0xffff0000, v36
    v_mul_f32 v82, v82, v56
    v_mul_f32 v83, v83, v57
    v_dot2_f32_bf16 v75, v36, v44, v75
    v_cvt_pk_bf16_f32 v82, v82, v83
    v_dot2_f32_bf16 v72, v80, v84, v72
    v_dot2_f32_bf16 v73, v82, v84, v73
    s_add_u32 m0, s7, 98304
    s_add_u32 s40, s42, 131072
    buffer_load_dwordx4 v4, s[8:11], s40 offen lds
    v_lshlrev_b32 v56, 16, v53
    v_and_b32 v57, 0xffff0000, v53
    v_lshlrev_b32 v80, 16, v29
    v_and_b32 v81, 0xffff0000, v29
    v_mul_f32 v80, v80, v56
    v_mul_f32 v81, v81, v57
    v_dot2_f32_bf16 v74, v29, v45, v74
    v_cvt_pk_bf16_f32 v80, v80, v81
    s_add_u32 m0, s7, 102400
    s_add_u32 s40, s42, 196608
    buffer_load_dwordx4 v4, s[8:11], s40 offen lds
    v_lshlrev_b32 v82, 16, v37
    v_and_b32 v83, 0xffff0000, v37
    v_mul_f32 v82, v82, v56
    v_mul_f32 v83, v83, v57
    v_dot2_f32_bf16 v75, v37, v45, v75
    v_cvt_pk_bf16_f32 v82, v82, v83
    v_dot2_f32_bf16 v72, v80, v84, v72
    v_dot2_f32_bf16 v73, v82, v84, v73
    s_add_u32 m0, s7, 106496
    s_add_u32 s40, s41, 0
    buffer_load_dwordx4 v5, s[12:15], s40 offen lds
    v_lshlrev_b32 v56, 16, v54
    v_and_b32 v57, 0xffff0000, v54
    v_lshlrev_b32 v80, 16, v30
    v_and_b32 v81, 0xffff0000, v30
    v_mul_f32 v80, v80, v56
    v_mul_f32 v81, v81, v57
    v_dot2_f32_bf16 v74, v30, v46, v74
    v_cvt_pk_bf16_f32 v80, v80, v81
    s_add_u32 m0, s7, 110592
    s_add_u32 s40, s41, 196608
    buffer_load_dwordx4 v5, s[12:15], s40 offen lds
    v_lshlrev_b32 v82, 16, v38
    v_and_b32 v83, 0xffff0000, v38
    v_mul_f32 v82, v82, v56
    v_mul_f32 v83, v83, v57
    v_dot2_f32_bf16 v75, v38, v46, v75
    v_cvt_pk_bf16_f32 v82, v82, v83
    v_dot2_f32_bf16 v72, v80, v84, v72
    v_dot2_f32_bf16 v73, v82, v84, v73
    s_add_u32 m0, s7, 114688
    s_add_u32 s40, s41, 2048
    buffer_load_dwordx4 v5, s[12:15], s40 offen lds
    v_lshlrev_b32 v56, 16, v55
    v_and_b32 v57, 0xffff0000, v55
    v_lshlrev_b32 v80, 16, v31
    v_and_b32 v81, 0xffff0000, v31
    v_mul_f32 v80, v80, v56
    v_mul_f32 v81, v81, v57
    v_dot2_f32_bf16 v74, v31, v47, v74
    v_cvt_pk_bf16_f32 v80, v80, v81
    s_add_u32 m0, s7, 118784
    s_add_u32 s40, s41, 198656
    buffer_load_dwordx4 v5, s[12:15], s40 offen lds
    v_lshlrev_b32 v82, 16, v39
    v_and_b32 v83, 0xffff0000, v39
    v_mul_f32 v82, v82, v56
    v_mul_f32 v83, v83, v57
    v_dot2_f32_bf16 v75, v39, v47, v75
    v_cvt_pk_bf16_f32 v82, v82, v83
    v_dot2_f32_bf16 v72, v80, v84, v72
    v_dot2_f32_bf16 v73, v82, v84, v73
    s_add_u32 m0, s7, 122880
    s_add_u32 s40, s41, 4096
    buffer_load_dwordx4 v5, s[12:15], s40 offen lds
    s_add_u32 m0, s7, 126976
    s_add_u32 s40, s41, 200704
    buffer_load_dwordx4 v5, s[12:15], s40 offen lds
    s_waitcnt vmcnt(10)
    s_barrier
    s_add_u32 s41, s74, 6
    s_and_b32 s41, s41, 15
    s_lshl_b32 s42, s41, 7
    s_mul_i32 s41, s41, 393216
    s_add_u32 m0, s7, 8192
    s_add_u32 s40, s42, 0
    buffer_load_dwordx4 v4, s[8:11], s40 offen lds
    v_permlane32_swap_b32 v72, v74
    v_permlane32_swap_b32 v73, v75
    v_add_f32 v72, v72, v74
    v_add_f32 v73, v73, v75
    s_add_u32 m0, s7, 12288
    s_add_u32 s40, s42, 65536
    buffer_load_dwordx4 v4, s[8:11], s40 offen lds
    s_lshl_b32 s64, s68, 2
    s_add_u32 s64, s64, 6709248
    v_permlane16_swap_b32 v72, v73
    v_add_f32 v72, v72, v73
    s_add_u32 m0, s7, 16384
    s_add_u32 s40, s42, 131072
    buffer_load_dwordx4 v4, s[8:11], s40 offen lds
    v_and_b32 v75, 1, v8
    v_lshl_add_u32 v76, v75, 2, s64
    v_add_f32_dpp v72, v72, v72 quad_perm:[1,0,3,2] row_mask:0xf bank_mask:0xf
    s_nop 1
    s_add_u32 m0, s7, 20480
    s_add_u32 s40, s42, 196608
    buffer_load_dwordx4 v4, s[8:11], s40 offen lds
    v_add_f32_dpp v72, v72, v72 quad_perm:[2,3,0,1] row_mask:0xf bank_mask:0xf
    s_nop 1
    v_add_f32_dpp v72, v72, v72 row_half_mirror row_mask:0xf bank_mask:0xf
    s_nop 1
    s_add_u32 m0, s7, 24576
    s_add_u32 s40, s41, 0
    buffer_load_dwordx4 v5, s[12:15], s40 offen lds
    v_add_f32_dpp v72, v72, v72 row_mirror row_mask:0xf bank_mask:0xf
    s_nop 1
    v_cvt_pk_bf16_f32 v72, v72, v72
    s_sub_u32 s64, 34815, s68
    s_add_u32 m0, s7, 28672
    s_add_u32 s40, s41, 196608
    buffer_load_dwordx4 v5, s[12:15], s40 offen lds
    v_lshlrev_b32 v72, 16, v72
    v_ashrrev_i32 v73, 31, v72
    v_sub_u32 v77, s64, v75
    v_or_b32 v73, 0x80000000, v73
    s_add_u32 m0, s7, 32768
    s_add_u32 s40, s41, 2048
    buffer_load_dwordx4 v5, s[12:15], s40 offen lds
    s_lshl_b32 s64, s6, 3
    v_xor_b32 v73, v72, v73
    v_lshl_add_u32 v75, v75, 2, s64
    v_and_b32 v73, 0xffff0000, v73
    s_add_u32 m0, s7, 36864
    s_add_u32 s40, s41, 198656
    buffer_load_dwordx4 v5, s[12:15], s40 offen lds
    v_or_b32 v73, v77, v73
    v_mul_f32 v72, s72, v72
    v_exp_f32 v72, -v72
    s_nop 0
    s_add_u32 m0, s7, 40960
    s_add_u32 s40, s41, 4096
    buffer_load_dwordx4 v5, s[12:15], s40 offen lds
    v_add_f32 v72, 1.0, v72
    v_rcp_f32 v72, v72
    s_nop 0
    v_cvt_pk_bf16_f32 v72, v72, v72
    s_add_u32 m0, s7, 45056
    s_add_u32 s40, s41, 200704
    buffer_load_dwordx4 v5, s[12:15], s40 offen lds
    v_lshlrev_b32 v72, 16, v72
    s_mov_b32 exec_lo, 0
    s_mov_b32 exec_hi, 0x10001
    ds_write_b32 v75, v73 offset:4224
    s_mov_b32 exec_lo, 0x10001
    s_mov_b32 exec_hi, 0
    buffer_store_dword v72, v76, s[16:19], 0 offen sc0 sc1
    s_mov_b64 exec, -1
    s_mov_b32 exec_lo, 0x3fff3fff
    s_mov_b32 exec_hi, 0x3fff3fff
    s_mov_b32 s64, 0
    buffer_load_dwordx4 v[96:99], v11, s[32:35], s64 offen nt
    s_mov_b32 s64, 0
    buffer_load_dwordx4 v[128:131], v11, s[36:39], s64 offen nt
    s_mov_b32 s64, 7168
    buffer_load_dwordx4 v[100:103], v11, s[32:35], s64 offen nt
    s_mov_b32 s64, 7168
    buffer_load_dwordx4 v[132:135], v11, s[36:39], s64 offen nt
    s_mov_b32 s64, 14336
    buffer_load_dwordx4 v[104:107], v11, s[32:35], s64 offen nt
    s_mov_b64 exec, -1
    s_waitcnt vmcnt(16)
    s_waitcnt lgkmcnt(0)
    s_barrier
    s_add_u32 s41, s74, 7
    s_and_b32 s41, s41, 15
    s_lshl_b32 s42, s41, 7
    s_mul_i32 s41, s41, 393216
    s_add_u32 m0, s7, 49152
    s_add_u32 s40, s42, 0
    buffer_load_dwordx4 v4, s[8:11], s40 offen lds
    s_add_u32 m0, s7, 53248
    s_add_u32 s40, s42, 65536
    buffer_load_dwordx4 v4, s[8:11], s40 offen lds
    s_add_u32 m0, s7, 57344
    s_add_u32 s40, s42, 131072
    buffer_load_dwordx4 v4, s[8:11], s40 offen lds
    s_add_u32 m0, s7, 61440
    s_add_u32 s40, s42, 196608
    buffer_load_dwordx4 v4, s[8:11], s40 offen lds
    s_add_u32 m0, s7, 65536
    s_add_u32 s40, s41, 0
    buffer_load_dwordx4 v5, s[12:15], s40 offen lds
    s_add_u32 m0, s7, 69632
    s_add_u32 s40, s41, 196608
    buffer_load_dwordx4 v5, s[12:15], s40 offen lds
    s_add_u32 m0, s7, 73728
    s_add_u32 s40, s41, 2048
    buffer_load_dwordx4 v5, s[12:15], s40 offen lds
    s_add_u32 m0, s7, 77824
    s_add_u32 s40, s41, 198656
    buffer_load_dwordx4 v5, s[12:15], s40 offen lds
    s_add_u32 m0, s7, 81920
    s_add_u32 s40, s41, 4096
    buffer_load_dwordx4 v5, s[12:15], s40 offen lds
    s_add_u32 m0, s7, 86016
    s_add_u32 s40, s41, 200704
    buffer_load_dwordx4 v5, s[12:15], s40 offen lds
    s_waitcnt vmcnt(16)
    s_barrier
    s_add_u32 s41, s74, 8
    s_and_b32 s41, s41, 15
    s_lshl_b32 s42, s41, 7
    s_mul_i32 s41, s41, 393216
    s_add_u32 m0, s7, 90112
    s_add_u32 s40, s42, 0
    buffer_load_dwordx4 v4, s[8:11], s40 offen lds
    s_add_u32 m0, s7, 94208
    s_add_u32 s40, s42, 65536
    buffer_load_dwordx4 v4, s[8:11], s40 offen lds
    s_add_u32 m0, s7, 98304
    s_add_u32 s40, s42, 131072
    buffer_load_dwordx4 v4, s[8:11], s40 offen lds
    s_add_u32 m0, s7, 102400
    s_add_u32 s40, s42, 196608
    buffer_load_dwordx4 v4, s[8:11], s40 offen lds
    s_add_u32 m0, s7, 106496
    s_add_u32 s40, s41, 0
    buffer_load_dwordx4 v5, s[12:15], s40 offen lds
    s_add_u32 m0, s7, 110592
    s_add_u32 s40, s41, 196608
    buffer_load_dwordx4 v5, s[12:15], s40 offen lds
    s_add_u32 m0, s7, 114688
    s_add_u32 s40, s41, 2048
    buffer_load_dwordx4 v5, s[12:15], s40 offen lds
    s_add_u32 m0, s7, 118784
    s_add_u32 s40, s41, 198656
    buffer_load_dwordx4 v5, s[12:15], s40 offen lds
    s_add_u32 m0, s7, 122880
    s_add_u32 s40, s41, 4096
    buffer_load_dwordx4 v5, s[12:15], s40 offen lds
    s_add_u32 m0, s7, 126976
    s_add_u32 s40, s41, 200704
    buffer_load_dwordx4 v5, s[12:15], s40 offen lds
    s_waitcnt vmcnt(10)
    s_barrier
    s_add_u32 s41, s74, 9
    s_and_b32 s41, s41, 15
    s_lshl_b32 s42, s41, 7
    s_mul_i32 s41, s41, 393216
    s_add_u32 m0, s7, 8192
    s_add_u32 s40, s42, 0
    buffer_load_dwordx4 v4, s[8:11], s40 offen lds
    s_add_u32 m0, s7, 12288
    s_add_u32 s40, s42, 65536
    buffer_load_dwordx4 v4, s[8:11], s40 offen lds
    s_add_u32 m0, s7, 16384
    s_add_u32 s40, s42, 131072
    buffer_load_dwordx4 v4, s[8:11], s40 offen lds
    s_add_u32 m0, s7, 20480
    s_add_u32 s40, s42, 196608
    buffer_load_dwordx4 v4, s[8:11], s40 offen lds
    s_add_u32 m0, s7, 24576
    s_add_u32 s40, s41, 0
    buffer_load_dwordx4 v5, s[12:15], s40 offen lds
    s_add_u32 m0, s7, 28672
    s_add_u32 s40, s41, 196608
    buffer_load_dwordx4 v5, s[12:15], s40 offen lds
    s_add_u32 m0, s7, 32768
    s_add_u32 s40, s41, 2048
    buffer_load_dwordx4 v5, s[12:15], s40 offen lds
    s_add_u32 m0, s7, 36864
    s_add_u32 s40, s41, 198656
    buffer_load_dwordx4 v5, s[12:15], s40 offen lds
    s_add_u32 m0, s7, 40960
    s_add_u32 s40, s41, 4096
    buffer_load_dwordx4 v5, s[12:15], s40 offen lds
    s_add_u32 m0, s7, 45056
    s_add_u32 s40, s41, 200704
    buffer_load_dwordx4 v5, s[12:15], s40 offen lds
    s_cmp_lg_u32 s6, 0
    s_cbranch_scc1 H_nk
    v_mov_b32 v3, 4224
    ds_read_b128 v[72:75], v3
    ds_read_b128 v[60:63], v3 offset:16
    s_mov_b32 s65, 0
H_nspin:
    v_readfirstlane_b32 s71, v78
    s_cmp_eq_u32 s71, 0
    s_cbranch_scc1 H_nre
H_nok:
    s_lshl_b32 s64, s2, 3
    s_add_u32 s64, s64, 6717440
    v_mov_b32 v3, s64
    s_waitcnt lgkmcnt(0)
    v_max3_u32 v72, v72, v73, v74
    v_max3_u32 v60, v60, v61, v62
    v_max3_u32 v72, v72, v75, v63
    v_max_u32 v72, v72, v60
    v_xor_b32 v73, s71, v72
    s_mov_b64 exec, 1
    buffer_store_dwordx2 v[72:73], v3, s[16:19], 0 offen sc0 sc1
    s_mov_b64 exec, -1
H_nk:
    s_mov_b32 exec_lo, 0x3fff3fff
    s_mov_b32 exec_hi, 0x3fff3fff
    s_mov_b32 s64, 14336
    buffer_load_dwordx4 v[136:139], v11, s[36:39], s64 offen nt
    s_mov_b32 s64, 21504
    buffer_load_dwordx4 v[108:111], v11, s[32:35], s64 offen nt
    s_mov_b32 s64, 21504
    buffer_load_dwordx4 v[140:143], v11, s[36:39], s64 offen nt
    s_mov_b32 s64, 28672
    buffer_load_dwordx4 v[112:115], v11, s[32:35], s64 offen nt
    s_mov_b32 s64, 28672
    buffer_load_dwordx4 v[144:147], v11, s[36:39], s64 offen nt
    s_mov_b64 exec, -1
    s_waitcnt vmcnt(15)
    s_barrier
    s_add_u32 s41, s74, 10
    s_and_b32 s41, s41, 15
    s_lshl_b32 s42, s41, 7
    s_mul_i32 s41, s41, 393216
    s_add_u32 m0, s7, 49152
    s_add_u32 s40, s42, 0
    buffer_load_dwordx4 v4, s[8:11], s40 offen lds
    s_add_u32 m0, s7, 53248
    s_add_u32 s40, s42, 65536
    buffer_load_dwordx4 v4, s[8:11], s40 offen lds
    s_add_u32 m0, s7, 57344
    s_add_u32 s40, s42, 131072
    buffer_load_dwordx4 v4, s[8:11], s40 offen lds
    s_add_u32 m0, s7, 61440
    s_add_u32 s40, s42, 196608
    buffer_load_dwordx4 v4, s[8:11], s40 offen lds
    s_add_u32 m0, s7, 65536
    s_add_u32 s40, s41, 0
    buffer_load_dwordx4 v5, s[12:15], s40 offen lds
    s_add_u32 m0, s7, 69632
    s_add_u32 s40, s41, 196608
    buffer_load_dwordx4 v5, s[12:15], s40 offen lds
    s_add_u32 m0, s7, 73728
    s_add_u32 s40, s41, 2048
    buffer_load_dwordx4 v5, s[12:15], s40 offen lds
    s_add_u32 m0, s7, 77824
    s_add_u32 s40, s41, 198656
    buffer_load_dwordx4 v5, s[12:15], s40 offen lds
    s_add_u32 m0, s7, 81920
    s_add_u32 s40, s41, 4096
    buffer_load_dwordx4 v5, s[12:15], s40 offen lds
    s_add_u32 m0, s7, 86016
    s_add_u32 s40, s41, 200704
    buffer_load_dwordx4 v5, s[12:15], s40 offen lds
    s_lshl_b32 s64, s2, 2
    s_add_u32 s64, s64, s6
    s_mul_i32 s64, s64, 2048
    s_add_u32 s46, s44, s64
    s_addc_u32 s47, s45, 0
    s_load_dword s43, s[46:47], 384
    s_load_dword s43, s[46:47], 448
    s_load_dword s43, s[46:47], 1408
    s_load_dword s43, s[46:47], 1472
    s_waitcnt vmcnt(15)
    s_barrier
    s_add_u32 s41, s74, 11
    s_and_b32 s41, s41, 15
    s_lshl_b32 s42, s41, 7
    s_mul_i32 s41, s41, 393216
    s_add_u32 m0, s7, 90112
    s_add_u32 s40, s42, 0
    buffer_load_dwordx4 v4, s[8:11], s40 offen lds
    s_add_u32 m0, s7, 94208
    s_add_u32 s40, s42, 65536
    buffer_load_dwordx4 v4, s[8:11], s40 offen lds
    s_add_u32 m0, s7, 98304
    s_add_u32 s40, s42, 131072
    buffer_load_dwordx4 v4, s[8:11], s40 offen lds
    s_add_u32 m0, s7, 102400
    s_add_u32 s40, s42, 196608
    buffer_load_dwordx4 v4, s[8:11], s40 offen lds
    s_add_u32 m0, s7, 106496
    s_add_u32 s40, s41, 0
    buffer_load_dwordx4 v5, s[12:15], s40 offen lds
    s_add_u32 m0, s7, 110592
    s_add_u32 s40, s41, 196608
    buffer_load_dwordx4 v5, s[12:15], s40 offen lds
    s_add_u32 m0, s7, 114688
    s_add_u32 s40, s41, 2048
    buffer_load_dwordx4 v5, s[12:15], s40 offen lds
    s_add_u32 m0, s7, 118784
    s_add_u32 s40, s41, 198656
    buffer_load_dwordx4 v5, s[12:15], s40 offen lds
    s_add_u32 m0, s7, 122880
    s_add_u32 s40, s41, 4096
    buffer_load_dwordx4 v5, s[12:15], s40 offen lds
    s_add_u32 m0, s7, 126976
    s_add_u32 s40, s41, 200704
    buffer_load_dwordx4 v5, s[12:15], s40 offen lds
    s_waitcnt vmcnt(10)
    s_barrier
    s_add_u32 s41, s74, 12
    s_and_b32 s41, s41, 15
    s_lshl_b32 s42, s41, 7
    s_mul_i32 s41, s41, 393216
    s_add_u32 m0, s7, 8192
    s_add_u32 s40, s42, 0
    buffer_load_dwordx4 v4, s[8:11], s40 offen lds
    s_add_u32 m0, s7, 12288
    s_add_u32 s40, s42, 65536
    buffer_load_dwordx4 v4, s[8:11], s40 offen lds
    s_add_u32 m0, s7, 16384
    s_add_u32 s40, s42, 131072
    buffer_load_dwordx4 v4, s[8:11], s40 offen lds
    s_add_u32 m0, s7, 20480
    s_add_u32 s40, s42, 196608
    buffer_load_dwordx4 v4, s[8:11], s40 offen lds
    s_add_u32 m0, s7, 24576
    s_add_u32 s40, s41, 0
    buffer_load_dwordx4 v5, s[12:15], s40 offen lds
    s_add_u32 m0, s7, 28672
    s_add_u32 s40, s41, 196608
    buffer_load_dwordx4 v5, s[12:15], s40 offen lds
    s_add_u32 m0, s7, 32768
    s_add_u32 s40, s41, 2048
    buffer_load_dwordx4 v5, s[12:15], s40 offen lds
    s_add_u32 m0, s7, 36864
    s_add_u32 s40, s41, 198656
    buffer_load_dwordx4 v5, s[12:15], s40 offen lds
    s_add_u32 m0, s7, 40960
    s_add_u32 s40, s41, 4096
    buffer_load_dwordx4 v5, s[12:15], s40 offen lds
    s_add_u32 m0, s7, 45056
    s_add_u32 s40, s41, 200704
    buffer_load_dwordx4 v5, s[12:15], s40 offen lds
    s_mov_b32 exec_lo, 0x3fff3fff
    s_mov_b32 exec_hi, 0x3fff3fff
    s_mov_b32 s64, 35840
    buffer_load_dwordx4 v[116:119], v11, s[32:35], s64 offen nt
    s_mov_b32 s64, 35840
    buffer_load_dwordx4 v[148:151], v11, s[36:39], s64 offen nt
    s_mov_b32 s64, 43008
    buffer_load_dwordx4 v[120:123], v11, s[32:35], s64 offen nt
    s_mov_b32 s64, 43008
    buffer_load_dwordx4 v[152:155], v11, s[36:39], s64 offen nt
    s_mov_b32 s64, 50176
    buffer_load_dwordx4 v[124:127], v11, s[32:35], s64 offen nt
    s_mov_b32 s64, 50176
    buffer_load_dwordx4 v[156:159], v11, s[36:39], s64 offen nt
    s_mov_b64 exec, -1
    s_waitcnt vmcnt(16)
    s_barrier
    s_cmp_lg_u32 s6, 0
    s_cbranch_scc1 H_np
    s_mov_b32 s64, 6717440
    buffer_load_dwordx4 v[24:27], v6, s[16:19], s64 offen offset:0 sc1
    buffer_load_dwordx4 v[28:31], v6, s[16:19], s64 offen offset:1024 sc1
H_np:
    s_add_u32 s41, s74, 13
    s_and_b32 s41, s41, 15
    s_lshl_b32 s42, s41, 7
    s_mul_i32 s41, s41, 393216
    s_add_u32 m0, s7, 49152
    s_add_u32 s40, s42, 0
    buffer_load_dwordx4 v4, s[8:11], s40 offen lds
    s_add_u32 m0, s7, 53248
    s_add_u32 s40, s42, 65536
    buffer_load_dwordx4 v4, s[8:11], s40 offen lds
    s_add_u32 m0, s7, 57344
    s_add_u32 s40, s42, 131072
    buffer_load_dwordx4 v4, s[8:11], s40 offen lds
    s_add_u32 m0, s7, 61440
    s_add_u32 s40, s42, 196608
    buffer_load_dwordx4 v4, s[8:11], s40 offen lds
    s_add_u32 m0, s7, 65536
    s_add_u32 s40, s41, 0
    buffer_load_dwordx4 v5, s[12:15], s40 offen lds
    s_add_u32 m0, s7, 69632
    s_add_u32 s40, s41, 196608
    buffer_load_dwordx4 v5, s[12:15], s40 offen lds
    s_add_u32 m0, s7, 73728
    s_add_u32 s40, s41, 2048
    buffer_load_dwordx4 v5, s[12:15], s40 offen lds
    s_add_u32 m0, s7, 77824
    s_add_u32 s40, s41, 198656
    buffer_load_dwordx4 v5, s[12:15], s40 offen lds
    s_add_u32 m0, s7, 81920
    s_add_u32 s40, s41, 4096
    buffer_load_dwordx4 v5, s[12:15], s40 offen lds
    s_add_u32 m0, s7, 86016
    s_add_u32 s40, s41, 200704
    buffer_load_dwordx4 v5, s[12:15], s40 offen lds
    s_waitcnt vmcnt(16)
    s_barrier
    s_cmp_lg_u32 s6, 0
    s_cbranch_scc1 H_nq
    s_waitcnt vmcnt(10)
    s_mov_b32 s65, 0
H_spin:
    v_xor_b32 v25, v24, v25
    v_xor_b32 v27, v26, v27
    v_xor_b32 v29, v28, v29
    v_xor_b32 v31, v30, v31
    v_xor_b32 v3, s71, v25
    v_xor_b32 v7, s71, v27
    v_xor_b32 v25, s71, v29
    v_xor_b32 v27, s71, v31
    v_or3_b32 v3, v3, v7, v25
    v_or_b32 v3, v3, v27
    v_cmp_ne_u32 vcc, 0, v3
    s_cbranch_vccnz H_retry
H_nq:
    s_add_u32 s41, s74, 14
    s_and_b32 s41, s41, 15
    s_lshl_b32 s42, s41, 7
    s_mul_i32 s41, s41, 393216
    s_add_u32 m0, s7, 90112
    s_add_u32 s40, s42, 0
    buffer_load_dwordx4 v4, s[8:11], s40 offen lds
    v_max_u32 v3, v24, v26
    v_max3_u32 v3, v3, v28, v30
    s_nop 1
    v_max_u32_dpp v3, v3, v3 quad_perm:[1,0,3,2] row_mask:0xf bank_mask:0xf
    s_add_u32 m0, s7, 94208
    s_add_u32 s40, s42, 65536
    buffer_load_dwordx4 v4, s[8:11], s40 offen lds
    s_nop 1
    v_max_u32_dpp v3, v3, v3 quad_perm:[2,3,0,1] row_mask:0xf bank_mask:0xf
    s_nop 1
    v_max_u32_dpp v3, v3, v3 row_half_mirror row_mask:0xf bank_mask:0xf
    s_add_u32 m0, s7, 98304
    s_add_u32 s40, s42, 131072
    buffer_load_dwordx4 v4, s[8:11], s40 offen lds
    s_nop 1
    v_max_u32_dpp v3, v3, v3 row_mirror row_mask:0xf bank_mask:0xf
    s_nop 1
    v_mov_b32 v7, v3
    s_add_u32 m0, s7, 102400
    s_add_u32 s40, s42, 196608
    buffer_load_dwordx4 v4, s[8:11], s40 offen lds
    s_nop 1
    v_permlane16_swap_b32 v3, v7
    v_max_u32 v3, v3, v7
    v_mov_b32 v7, v3
    s_add_u32 m0, s7, 106496
    s_add_u32 s40, s41, 0
    buffer_load_dwordx4 v5, s[12:15], s40 offen lds
    s_nop 1
    v_permlane32_swap_b32 v3, v7
    v_max_u32 v3, v3, v7
    v_mov_b32 v7, 4256
    s_add_u32 m0, s7, 110592
    s_add_u32 s40, s41, 196608
    buffer_load_dwordx4 v5, s[12:15], s40 offen lds
    s_add_u32 m0, s7, 114688
    s_add_u32 s40, s41, 2048
    buffer_load_dwordx4 v5, s[12:15], s40 offen lds
    s_add_u32 m0, s7, 118784
    s_add_u32 s40, s41, 198656
    buffer_load_dwordx4 v5, s[12:15], s40 offen lds
    s_add_u32 m0, s7, 122880
    s_add_u32 s40, s41, 4096
    buffer_load_dwordx4 v5, s[12:15], s40 offen lds
    s_add_u32 m0, s7, 126976
    s_add_u32 s40, s41, 200704
    buffer_load_dwordx4 v5, s[12:15], s40 offen lds
    s_cmp_lg_u32 s6, 0
    s_cbranch_scc1 H_nw
    ds_write_b32 v7, v3
H_nw:
    s_waitcnt vmcnt(10)
    s_waitcnt lgkmcnt(0)
    s_barrier
    v_mov_b32 v7, 4256
    ds_read_b32 v3, v7
    s_lshl_b32 s65, s69, 6
    v_lshl_add_u32 v7, v8, 4, s65
    s_waitcnt lgkmcnt(0)
    v_readfirstlane_b32 s75, v3
    s_nop 3
    s_and_b32 s64, s75, 0x7ff
    s_sub_u32 s64, 2047, s64
    s_lshl_b32 s64, s64, 11
    buffer_load_dwordx4 v[88:91], v7, s[8:11], s64 offen
    s_add_u32 s41, s74, 15
    s_and_b32 s41, s41, 15
    s_lshl_b32 s42, s41, 7
    s_mul_i32 s41, s41, 393216
    s_add_u32 m0, s7, 8192
    s_add_u32 s40, s42, 0
    buffer_load_dwordx4 v4, s[8:11], s40 offen lds
    s_add_u32 m0, s7, 12288
    s_add_u32 s40, s42, 65536
    buffer_load_dwordx4 v4, s[8:11], s40 offen lds
    s_add_u32 m0, s7, 16384
    s_add_u32 s40, s42, 131072
    buffer_load_dwordx4 v4, s[8:11], s40 offen lds
    s_add_u32 m0, s7, 20480
    s_add_u32 s40, s42, 196608
    buffer_load_dwordx4 v4, s[8:11], s40 offen lds
    s_add_u32 m0, s7, 24576
    s_add_u32 s40, s41, 0
    buffer_load_dwordx4 v5, s[12:15], s40 offen lds
    s_add_u32 m0, s7, 28672
    s_add_u32 s40, s41, 196608
    buffer_load_dwordx4 v5, s[12:15], s40 offen lds
    s_add_u32 m0, s7, 32768
    s_add_u32 s40, s41, 2048
    buffer_load_dwordx4 v5, s[12:15], s40 offen lds
    s_add_u32 m0, s7, 36864
    s_add_u32 s40, s41, 198656
    buffer_load_dwordx4 v5, s[12:15], s40 offen lds
    s_add_u32 m0, s7, 40960
    s_add_u32 s40, s41, 4096
    buffer_load_dwordx4 v5, s[12:15], s40 offen lds
    s_add_u32 m0, s7, 45056
    s_add_u32 s40, s41, 200704
    buffer_load_dwordx4 v5, s[12:15], s40 offen lds
    s_mov_b32 s24, s54
    s_mov_b32 s25, s55
    s_mov_b32 s26, 0x700000
    s_mov_b32 s27, 0x00020000
    s_lshr_b32 s64, s2, 2
    s_mul_i32 s64, s64, 114688
    s_and_b32 s65, s2, 3
    s_lshl_b32 s65, s65, 9
    s_add_u32 s64, s64, s65
    s_lshl_b32 s65, s6, 7
    s_add_u32 s64, s64, s65
    v_lshrrev_b32 v7, 3, v2
    v_lshlrev_b32 v7, 11, v7
    v_and_b32 v9, 7, v2
    v_lshl_add_u32 v7, v9, 4, v7
    v_add_u32 v21, s64, v7
    s_mov_b32 s64, 0
    buffer_load_dwordx4 v[192:195], v21, s[24:27], s64 offen nt
    s_mov_b32 s64, 16384
    buffer_load_dwordx4 v[196:199], v21, s[24:27], s64 offen nt
    s_mov_b32 s64, 32768
    buffer_load_dwordx4 v[200:203], v21, s[24:27], s64 offen nt
    s_mov_b32 s64, 49152
    buffer_load_dwordx4 v[204:207], v21, s[24:27], s64 offen nt
    s_mov_b32 s64, 65536
    buffer_load_dwordx4 v[208:211], v21, s[24:27], s64 offen nt
    s_mov_b32 s64, 81920
    buffer_load_dwordx4 v[212:215], v21, s[24:27], s64 offen nt
    s_mov_b32 s64, 98304
    buffer_load_dwordx4 v[216:219], v21, s[24:27], s64 offen nt
    s_waitcnt vmcnt(18)
    s_barrier
    s_waitcnt vmcnt(17)
    s_and_b32 s64, s2, 7
    s_lshr_b32 s65, s2, 3
    s_and_b32 s4, s64, 3
    s_lshl_b32 s4, s4, 2
    s_and_b32 s66, s65, 3
    s_add_u32 s4, s4, s66
    s_lshr_b32 s5, s64, 2
    s_lshl_b32 s5, s5, 3
    s_lshr_b32 s66, s65, 2
    s_add_u32 s5, s5, s66
    s_mov_b32 s28, s44
    s_mov_b32 s29, s45
    s_mov_b32 s30, 0x200000
    s_mov_b32 s31, 0x00020000
    v_lshrrev_b32 v7, 3, v2
    s_lshl_b32 s64, s6, 3
    v_add_u32 v7, s64, v7
    v_lshlrev_b32 v7, 11, v7
    v_lshrrev_b32 v9, 4, v2
    v_lshlrev_b32 v9, 1, v9
    v_and_b32 v10, 7, v2
    v_xor_b32 v9, v9, v10
    v_lshl_add_u32 v7, v9, 4, v7
    s_lshl_b32 s64, s5, 7
    v_add_u32 v10, s64, v7
    s_add_u32 m0, s7, 131072
    s_mov_b32 s40, 0
    buffer_load_dwordx4 v10, s[28:31], s40 offen lds
    v_and_b32 v48, 15, v2
    v_and_b32 v49, 1, v2
    v_lshlrev_b32 v49, 4, v49
    v_mov_b32 v50, 0xffff
    v_lshlrev_b32 v49, v49, v50
    v_lshrrev_b32 v48, 1, v48
    v_cmp_eq_u32 vcc, 0, v48
    s_nop 1
    v_cndmask_b32 v40, 0, v49, vcc
    v_cmp_eq_u32 vcc, 1, v48
    s_nop 1
    v_cndmask_b32 v41, 0, v49, vcc
    v_cmp_eq_u32 vcc, 2, v48
    s_nop 1
    v_cndmask_b32 v42, 0, v49, vcc
    v_cmp_eq_u32 vcc, 3, v48
    s_nop 1
    v_cndmask_b32 v43, 0, v49, vcc
    s_mov_b32 s64, 0x01000100
    s_mov_b32 s65, 0x03020302
    v_perm_b32 v48, v88, v88, s64
    v_and_b32 v44, v48, v40
    v_and_b32 v45, v48, v41
    v_and_b32 v46, v48, v42
    s_add_u32 m0, s7, 135168
    s_mov_b32 s40, 65536
    buffer_load_dwordx4 v10, s[28:31], s40 offen lds
    v_and_b32 v47, v48, v43
    s_nop 1
    v_mfma_f32_16x16x32_bf16 v[32:35], v[44:47], v[96:99], 0
    v_mfma_f32_16x16x32_bf16 v[36:39], v[44:47], v[128:131], 0
    v_perm_b32 v48, v88, v88, s65
    v_and_b32 v52, v48, v40
    v_and_b32 v53, v48, v41
    v_and_b32 v54, v48, v42
    v_and_b32 v55, v48, v43
    s_nop 1
    v_mfma_f32_16x16x32_bf16 v[32:35], v[52:55], v[100:103], v[32:35]
    v_mfma_f32_16x16x32_bf16 v[36:39], v[52:55], v[132:135], v[36:39]
    v_perm_b32 v48, v89, v89, s64
    v_and_b32 v44, v48, v40
    v_and_b32 v45, v48, v41
    v_and_b32 v46, v48, v42
    v_and_b32 v47, v48, v43
    s_nop 1
    v_mfma_f32_16x16x32_bf16 v[32:35], v[44:47], v[104:107], v[32:35]
    v_mfma_f32_16x16x32_bf16 v[36:39], v[44:47], v[136:139], v[36:39]
    v_perm_b32 v48, v89, v89, s65
    v_and_b32 v52, v48, v40
    v_and_b32 v53, v48, v41
    v_and_b32 v54, v48, v42
    s_add_u32 m0, s7, 147456
    s_mov_b32 s40, 1048576
    buffer_load_dwordx4 v10, s[28:31], s40 offen lds
    v_and_b32 v55, v48, v43
    s_nop 1
    v_mfma_f32_16x16x32_bf16 v[32:35], v[52:55], v[108:111], v[32:35]
    v_mfma_f32_16x16x32_bf16 v[36:39], v[52:55], v[140:143], v[36:39]
    v_perm_b32 v48, v90, v90, s64
    v_and_b32 v44, v48, v40
    v_and_b32 v45, v48, v41
    v_and_b32 v46, v48, v42
    v_and_b32 v47, v48, v43
    s_nop 1
    v_mfma_f32_16x16x32_bf16 v[32:35], v[44:47], v[112:115], v[32:35]
    v_mfma_f32_16x16x32_bf16 v[36:39], v[44:47], v[144:147], v[36:39]
    v_perm_b32 v48, v90, v90, s65
    v_and_b32 v52, v48, v40
    v_and_b32 v53, v48, v41
    v_and_b32 v54, v48, v42
    v_and_b32 v55, v48, v43
    s_nop 1
    v_mfma_f32_16x16x32_bf16 v[32:35], v[52:55], v[116:119], v[32:35]
    v_mfma_f32_16x16x32_bf16 v[36:39], v[52:55], v[148:151], v[36:39]
    v_perm_b32 v48, v91, v91, s64
    v_and_b32 v44, v48, v40
    v_and_b32 v45, v48, v41
    v_and_b32 v46, v48, v42
    s_add_u32 m0, s7, 151552
    s_mov_b32 s40, 1114112
    buffer_load_dwordx4 v10, s[28:31], s40 offen lds
    v_and_b32 v47, v48, v43
    s_nop 1
    v_mfma_f32_16x16x32_bf16 v[32:35], v[44:47], v[120:123], v[32:35]
    v_mfma_f32_16x16x32_bf16 v[36:39], v[44:47], v[152:155], v[36:39]
    v_perm_b32 v48, v91, v91, s65
    v_and_b32 v52, v48, v40
    v_and_b32 v53, v48, v41
    v_and_b32 v54, v48, v42
    v_and_b32 v55, v48, v43
    s_nop 1
    v_mfma_f32_16x16x32_bf16 v[32:35], v[52:55], v[124:127], v[32:35]
    v_mfma_f32_16x16x32_bf16 v[36:39], v[52:55], v[156:159], v[36:39]
    s_nop 7
    v_permlane32_swap_b32 v32, v36
    v_permlane32_swap_b32 v33, v37
    v_permlane32_swap_b32 v34, v38
    v_permlane32_swap_b32 v35, v39
    s_mov_b32 exec_lo, 0x3fff3fff
    s_mov_b32 exec_hi, 0x3fff3fff
    buffer_store_dwordx4 v[32:35], v12, s[16:19], 0 offen sc0 sc1
    s_mov_b64 exec, -1
    s_waitcnt vmcnt(12)
    s_barrier
    s_add_u32 m0, s7, 139264
    s_mov_b32 s40, 131072
    buffer_load_dwordx4 v10, s[28:31], s40 offen lds
    s_add_u32 m0, s7, 143360
    s_mov_b32 s40, 196608
    buffer_load_dwordx4 v10, s[28:31], s40 offen lds
    s_add_u32 m0, s7, 155648
    s_mov_b32 s40, 1179648
    buffer_load_dwordx4 v10, s[28:31], s40 offen lds
    s_add_u32 m0, s7, 159744
    s_mov_b32 s40, 1245184
    buffer_load_dwordx4 v10, s[28:31], s40 offen lds
    s_add_u32 m0, s7, 73728
    s_mov_b32 s40, 262144
    buffer_load_dwordx4 v10, s[28:31], s40 offen lds
    s_add_u32 m0, s7, 77824
    s_mov_b32 s40, 327680
    buffer_load_dwordx4 v10, s[28:31], s40 offen lds
    s_add_u32 m0, s7, 81920
    s_mov_b32 s40, 1310720
    buffer_load_dwordx4 v10, s[28:31], s40 offen lds
    s_add_u32 m0, s7, 86016
    s_mov_b32 s40, 1376256
    buffer_load_dwordx4 v10, s[28:31], s40 offen lds
    s_barrier
    s_and_b32 s64, s3, 3
    s_lshl_b32 s64, s64, 1
    s_lshr_b32 s65, s3, 2
    s_add_u32 s64, s64, s65
    s_lshl_b32 s64, s64, 4
    s_lshl_b32 s65, s4, 7
    s_add_u32 s64, s64, s65
    v_and_b32 v230, 15, v2
    v_add_u32 v230, s64, v230
    v_bfe_u32 v3, v2, 4, 1
    v_lshlrev_b32 v229, 5, v3
    v_lshrrev_b32 v3, 5, v2
    v_lshl_add_u32 v229, v3, 4, v229
    v_lshl_add_u32 v231, v230, 11, v229
    s_lshl_b32 s64, s5, 7
    v_add_u32 v231, s64, v231
    v_lshlrev_b32 v3, 2, v230
    v_add_u32 v3, 6709248, v3
    buffer_load_dwordx4 v[220:223], v231, s[8:11], 0 offen
    buffer_load_dwordx4 v[224:227], v231, s[8:11], 0 offen offset:64
    buffer_load_dword v228, v3, s[16:19], 0 offen sc1
    s_add_u32 m0, s7, 114688
    s_mov_b32 s40, 393216
    buffer_load_dwordx4 v10, s[28:31], s40 offen lds
    s_add_u32 m0, s7, 118784
    s_mov_b32 s40, 458752
    buffer_load_dwordx4 v10, s[28:31], s40 offen lds
    s_add_u32 m0, s7, 122880
    s_mov_b32 s40, 1441792
    buffer_load_dwordx4 v10, s[28:31], s40 offen lds
    s_add_u32 m0, s7, 126976
    s_mov_b32 s40, 1507328
    buffer_load_dwordx4 v10, s[28:31], s40 offen lds
    s_add_u32 m0, s7, 40960
    s_mov_b32 s40, 524288
    buffer_load_dwordx4 v10, s[28:31], s40 offen lds
    s_add_u32 m0, s7, 45056
    s_mov_b32 s40, 589824
    buffer_load_dwordx4 v10, s[28:31], s40 offen lds
    s_add_u32 m0, s7, 49152
    s_mov_b32 s40, 1572864
    buffer_load_dwordx4 v10, s[28:31], s40 offen lds
    s_add_u32 m0, s7, 53248
    s_mov_b32 s40, 1638400
    buffer_load_dwordx4 v10, s[28:31], s40 offen lds
    s_add_u32 m0, s7, 8192
    s_mov_b32 s40, 655360
    buffer_load_dwordx4 v10, s[28:31], s40 offen lds
    s_add_u32 m0, s7, 12288
    s_mov_b32 s40, 720896
    buffer_load_dwordx4 v10, s[28:31], s40 offen lds
    s_add_u32 m0, s7, 57344
    s_mov_b32 s40, 1703936
    buffer_load_dwordx4 v10, s[28:31], s40 offen lds
    s_add_u32 m0, s7, 61440
    s_mov_b32 s40, 1769472
    buffer_load_dwordx4 v10, s[28:31], s40 offen lds
    s_add_u32 m0, s7, 16384
    s_mov_b32 s40, 786432
    buffer_load_dwordx4 v10, s[28:31], s40 offen lds
    s_add_u32 m0, s7, 20480
    s_mov_b32 s40, 851968
    buffer_load_dwordx4 v10, s[28:31], s40 offen lds
    s_add_u32 m0, s7, 65536
    s_mov_b32 s40, 1835008
    buffer_load_dwordx4 v10, s[28:31], s40 offen lds
    s_add_u32 m0, s7, 69632
    s_mov_b32 s40, 1900544
    buffer_load_dwordx4 v10, s[28:31], s40 offen lds
    s_add_u32 m0, s7, 98304
    s_mov_b32 s40, 917504
    buffer_load_dwordx4 v10, s[28:31], s40 offen lds
    s_add_u32 m0, s7, 102400
    s_mov_b32 s40, 983040
    buffer_load_dwordx4 v10, s[28:31], s40 offen lds
    s_add_u32 m0, s7, 90112
    s_mov_b32 s40, 1966080
    buffer_load_dwordx4 v10, s[28:31], s40 offen lds
    s_add_u32 m0, s7, 94208
    s_mov_b32 s40, 2031616
    buffer_load_dwordx4 v10, s[28:31], s40 offen lds
    s_mov_b64 exec, 1
    v_mov_b32 v20, 0
    buffer_atomic_or v20, v23, s[16:19], 0 offen sc0
    s_mov_b64 exec, -1
    v_lshlrev_b32 v17, 4, v2
    v_add_u32 v17, s70, v17
    v_lshrrev_b32 v18, 2, v2
    v_mul_u32_u24 v18, 1152, v18
    v_and_b32 v19, 3, v2
    v_lshl_add_u32 v18, v19, 4, v18
    s_add_u32 s64, s70, 1024
    v_add_u32 v18, s64, v18
    v_bfe_u32 v26, v2, 3, 1
    v_lshl_add_u32 v26, v26, 2, v19
    v_bfe_u32 v27, v2, 2, 1
    v_lshrrev_b32 v28, 5, v2
    v_cmp_eq_u32 vcc, v27, v28
    v_and_b32 v27, 16, v2
    v_cmp_eq_u32 s[64:65], 0, v27
    s_and_b64 vcc, vcc, s[64:65]
    v_and_b32 v27, 1, v26
    v_lshlrev_b32 v27, 4, v27
    v_mov_b32 v28, 0x3f80
    v_lshlrev_b32 v27, v27, v28
    v_cndmask_b32 v27, 0, v27, vcc
    v_lshrrev_b32 v26, 1, v26
    v_cmp_eq_u32 vcc, 0, v26
    s_nop 1
    v_cndmask_b32 v48, 0, v27, vcc
    v_cmp_eq_u32 vcc, 1, v26
    s_nop 1
    v_cndmask_b32 v49, 0, v27, vcc
    v_cmp_eq_u32 vcc, 2, v26
    s_nop 1
    v_cndmask_b32 v50, 0, v27, vcc
    v_cmp_eq_u32 vcc, 3, v26
    s_nop 1
    v_cndmask_b32 v51, 0, v27, vcc
    v_mov_b32 v128, 0
    v_mov_b32 v129, 0
    v_mov_b32 v130, 0
    v_mov_b32 v131, 0
    v_mov_b32 v132, 0
    v_mov_b32 v133, 0
    v_mov_b32 v134, 0
    v_mov_b32 v135, 0
    v_mov_b32 v136, 0
    v_mov_b32 v137, 0
    v_mov_b32 v138, 0
    v_mov_b32 v139, 0
    v_mov_b32 v140, 0
    v_mov_b32 v141, 0
    v_mov_b32 v142, 0
    v_mov_b32 v143, 0
    s_mov_b32 s66, 0xffff
    s_mov_b32 s65, 0
    s_waitcnt vmcnt(21)
    v_sub_f32 v248, 1.0, v228
    v_cvt_pk_bf16_f32 v248, v248, v248
    v_lshlrev_b32 v248, 16, v248
    v_lshlrev_b32 v232, 16, v220
    v_and_b32 v233, 0xffff0000, v220
    v_mul_f32 v232, v232, v248
    v_mul_f32 v233, v233, v248
    v_cvt_pk_bf16_f32 v3, v232, v233
    v_lshlrev_b32 v232, 16, v3
    v_and_b32 v233, 0xffff0000, v3
    v_lshlrev_b32 v234, 16, v221
    v_and_b32 v235, 0xffff0000, v221
    v_mul_f32 v234, v234, v248
    v_mul_f32 v235, v235, v248
    v_cvt_pk_bf16_f32 v3, v234, v235
    v_lshlrev_b32 v234, 16, v3
    v_and_b32 v235, 0xffff0000, v3
    v_lshlrev_b32 v236, 16, v222
    v_and_b32 v237, 0xffff0000, v222
    v_mul_f32 v236, v236, v248
    v_mul_f32 v237, v237, v248
    v_cvt_pk_bf16_f32 v3, v236, v237
    v_lshlrev_b32 v236, 16, v3
    v_and_b32 v237, 0xffff0000, v3
    v_lshlrev_b32 v238, 16, v223
    v_and_b32 v239, 0xffff0000, v223
    v_mul_f32 v238, v238, v248
    v_mul_f32 v239, v239, v248
    v_cvt_pk_bf16_f32 v3, v238, v239
    v_lshlrev_b32 v238, 16, v3
    v_and_b32 v239, 0xffff0000, v3
    v_lshlrev_b32 v240, 16, v224
    v_and_b32 v241, 0xffff0000, v224
    v_mul_f32 v240, v240, v248
    v_mul_f32 v241, v241, v248
    v_cvt_pk_bf16_f32 v3, v240, v241
    v_lshlrev_b32 v240, 16, v3
    v_and_b32 v241, 0xffff0000, v3
    v_lshlrev_b32 v242, 16, v225
    v_and_b32 v243, 0xffff0000, v225
    v_mul_f32 v242, v242, v248
    v_mul_f32 v243, v243, v248
    v_cvt_pk_bf16_f32 v3, v242, v243
    v_lshlrev_b32 v242, 16, v3
    v_and_b32 v243, 0xffff0000, v3
    v_lshlrev_b32 v244, 16, v226
    v_and_b32 v245, 0xffff0000, v226
    v_mul_f32 v244, v244, v248
    v_mul_f32 v245, v245, v248
    v_cvt_pk_bf16_f32 v3, v244, v245
    v_lshlrev_b32 v244, 16, v3
    v_and_b32 v245, 0xffff0000, v3
    v_lshlrev_b32 v246, 16, v227
    v_and_b32 v247, 0xffff0000, v227
    v_mul_f32 v246, v246, v248
    v_mul_f32 v247, v247, v248
    v_cvt_pk_bf16_f32 v3, v246, v247
    v_lshlrev_b32 v246, 16, v3
    v_and_b32 v247, 0xffff0000, v3
    s_waitcnt vmcnt(0)
G_loop:
    v_readfirstlane_b32 s68, v20
    s_and_b32 s68, s68, s66
G_new:
    s_andn2_b32 s66, s66, s68
    s_bcnt1_i32_b32 s67, s68
    s_cmp_eq_u32 s67, 0
    s_cbranch_scc1 G_l0
    s_cmp_gt_u32 s67, 8
    s_cbranch_scc1 G_lt_2
    s_cmp_gt_u32 s67, 4
    s_cbranch_scc1 G_lt_3
    s_cmp_gt_u32 s67, 2
    s_cbranch_scc1 G_lt_4
    s_cmp_eq_u32 s67, 1
    s_cbranch_scc1 G_l1
    s_branch G_l2
G_lt_4:
    s_cmp_eq_u32 s67, 3
    s_cbranch_scc1 G_l3
    s_branch G_l4
G_lt_3:
    s_cmp_gt_u32 s67, 6
    s_cbranch_scc1 G_lt_5
    s_cmp_eq_u32 s67, 5
    s_cbranch_scc1 G_l5
    s_branch G_l6
G_lt_5:
    s_cmp_eq_u32 s67, 7
    s_cbranch_scc1 G_l7
    s_branch G_l8
G_lt_2:
    s_cmp_gt_u32 s67, 12
    s_cbranch_scc1 G_lt_6
    s_cmp_gt_u32 s67, 10
    s_cbranch_scc1 G_lt_7
    s_cmp_eq_u32 s67, 9
    s_cbranch_scc1 G_l9
    s_branch G_l10
G_lt_7:
    s_cmp_eq_u32 s67, 11
    s_cbranch_scc1 G_l11
    s_branch G_l12
G_lt_6:
    s_cmp_gt_u32 s67, 14
    s_cbranch_scc1 G_lt_8
    s_cmp_eq_u32 s67, 13
    s_cbranch_scc1 G_l13
    s_branch G_l14
G_lt_8:
    s_cmp_eq_u32 s67, 15
    s_cbranch_scc1 G_l15
G_l16:
    s_ff1_i32_b32 s55, s68
    s_bitset0_b32 s68, s55
    s_mul_i32 s64, s55, 1152
    buffer_load_dwordx4 v[124:127], v17, s[16:19], s64 offen sc1
G_l15:
    s_ff1_i32_b32 s54, s68
    s_bitset0_b32 s68, s54
    s_mul_i32 s64, s54, 1152
    buffer_load_dwordx4 v[120:123], v17, s[16:19], s64 offen sc1
G_l14:
    s_ff1_i32_b32 s53, s68
    s_bitset0_b32 s68, s53
    s_mul_i32 s64, s53, 1152
    buffer_load_dwordx4 v[116:119], v17, s[16:19], s64 offen sc1
G_l13:
    s_ff1_i32_b32 s52, s68
    s_bitset0_b32 s68, s52
    s_mul_i32 s64, s52, 1152
    buffer_load_dwordx4 v[112:115], v17, s[16:19], s64 offen sc1
G_l12:
    s_ff1_i32_b32 s51, s68
    s_bitset0_b32 s68, s51
    s_mul_i32 s64, s51, 1152
    buffer_load_dwordx4 v[108:111], v17, s[16:19], s64 offen sc1
G_l11:
    s_ff1_i32_b32 s50, s68
    s_bitset0_b32 s68, s50
    s_mul_i32 s64, s50, 1152
    buffer_load_dwordx4 v[104:107], v17, s[16:19], s64 offen sc1
G_l10:
    s_ff1_i32_b32 s49, s68
    s_bitset0_b32 s68, s49
    s_mul_i32 s64, s49, 1152
    buffer_load_dwordx4 v[100:103], v17, s[16:19], s64 offen sc1
G_l9:
    s_ff1_i32_b32 s48, s68
    s_bitset0_b32 s68, s48
    s_mul_i32 s64, s48, 1152
    buffer_load_dwordx4 v[96:99], v17, s[16:19], s64 offen sc1
G_l8:
    s_ff1_i32_b32 s47, s68
    s_bitset0_b32 s68, s47
    s_mul_i32 s64, s47, 1152
    buffer_load_dwordx4 v[92:95], v17, s[16:19], s64 offen sc1
G_l7:
    s_ff1_i32_b32 s46, s68
    s_bitset0_b32 s68, s46
    s_mul_i32 s64, s46, 1152
    buffer_load_dwordx4 v[88:91], v17, s[16:19], s64 offen sc1
G_l6:
    s_ff1_i32_b32 s45, s68
    s_bitset0_b32 s68, s45
    s_mul_i32 s64, s45, 1152
    buffer_load_dwordx4 v[84:87], v17, s[16:19], s64 offen sc1
G_l5:
    s_ff1_i32_b32 s44, s68
    s_bitset0_b32 s68, s44
    s_mul_i32 s64, s44, 1152
    buffer_load_dwordx4 v[80:83], v17, s[16:19], s64 offen sc1
G_l4:
    s_ff1_i32_b32 s43, s68
    s_bitset0_b32 s68, s43
    s_mul_i32 s64, s43, 1152
    buffer_load_dwordx4 v[76:79], v17, s[16:19], s64 offen sc1
G_l3:
    s_ff1_i32_b32 s42, s68
    s_bitset0_b32 s68, s42
    s_mul_i32 s64, s42, 1152
    buffer_load_dwordx4 v[72:75], v17, s[16:19], s64 offen sc1
G_l2:
    s_ff1_i32_b32 s41, s68
    s_bitset0_b32 s68, s41
    s_mul_i32 s64, s41, 1152
    buffer_load_dwordx4 v[68:71], v17, s[16:19], s64 offen sc1
G_l1:
    s_ff1_i32_b32 s40, s68
    s_bitset0_b32 s68, s40
    s_mul_i32 s64, s40, 1152
    buffer_load_dwordx4 v[64:67], v17, s[16:19], s64 offen sc1
G_l0:
    s_mov_b32 s68, s66
    s_cmp_eq_u32 s66, 0
    s_cbranch_scc1 G_z
    s_cmp_lg_u32 s67, 0
    s_cbranch_scc1 G_p
    s_sleep 2
G_p:
    s_mov_b64 exec, 1
    v_mov_b32 v20, 0
    buffer_atomic_or v20, v23, s[16:19], 0 offen sc0
    s_mov_b64 exec, -1
    s_branch G_proc
G_z:
    buffer_load_dwordx4 v[56:59], v18, s[16:19], 0 offen sc1
G_proc:
    s_cmp_eq_u32 s67, 0
    s_cbranch_scc1 G_q0
    s_cmp_gt_u32 s67, 8
    s_cbranch_scc1 G_qt_9
    s_cmp_gt_u32 s67, 4
    s_cbranch_scc1 G_qt_10
    s_cmp_gt_u32 s67, 2
    s_cbranch_scc1 G_qt_11
    s_cmp_eq_u32 s67, 1
    s_cbranch_scc1 G_q1
    s_branch G_q2
G_qt_11:
    s_cmp_eq_u32 s67, 3
    s_cbranch_scc1 G_q3
    s_branch G_q4
G_qt_10:
    s_cmp_gt_u32 s67, 6
    s_cbranch_scc1 G_qt_12
    s_cmp_eq_u32 s67, 5
    s_cbranch_scc1 G_q5
    s_branch G_q6
G_qt_12:
    s_cmp_eq_u32 s67, 7
    s_cbranch_scc1 G_q7
    s_branch G_q8
G_qt_9:
    s_cmp_gt_u32 s67, 12
    s_cbranch_scc1 G_qt_13
    s_cmp_gt_u32 s67, 10
    s_cbranch_scc1 G_qt_14
    s_cmp_eq_u32 s67, 9
    s_cbranch_scc1 G_q9
    s_branch G_q10
G_qt_14:
    s_cmp_eq_u32 s67, 11
    s_cbranch_scc1 G_q11
    s_branch G_q12
G_qt_13:
    s_cmp_gt_u32 s67, 14
    s_cbranch_scc1 G_qt_15
    s_cmp_eq_u32 s67, 13
    s_cbranch_scc1 G_q13
    s_branch G_q14
G_qt_15:
    s_cmp_eq_u32 s67, 15
    s_cbranch_scc1 G_q15
G_q16:
    s_waitcnt vmcnt(16)
    v_max3_u32 v21, v124, v125, v126
    v_max_u32 v21, v21, v127
    v_cmp_eq_u32 vcc, -1, v21
    s_cbranch_vccnz G_f15
    v_mfma_f32_32x32x16_bf16 v[128:143], v[48:51], v[124:127], v[128:143]
G_q15:
    s_waitcnt vmcnt(15)
    v_max3_u32 v21, v120, v121, v122
    v_max_u32 v21, v21, v123
    v_cmp_eq_u32 vcc, -1, v21
    s_cbranch_vccnz G_f14
    v_mfma_f32_32x32x16_bf16 v[128:143], v[48:51], v[120:123], v[128:143]
G_q14:
    s_waitcnt vmcnt(14)
    v_max3_u32 v21, v116, v117, v118
    v_max_u32 v21, v21, v119
    v_cmp_eq_u32 vcc, -1, v21
    s_cbranch_vccnz G_f13
    v_mfma_f32_32x32x16_bf16 v[128:143], v[48:51], v[116:119], v[128:143]
G_q13:
    s_waitcnt vmcnt(13)
    v_max3_u32 v21, v112, v113, v114
    v_max_u32 v21, v21, v115
    v_cmp_eq_u32 vcc, -1, v21
    s_cbranch_vccnz G_f12
    v_mfma_f32_32x32x16_bf16 v[128:143], v[48:51], v[112:115], v[128:143]
G_q12:
    s_waitcnt vmcnt(12)
    v_max3_u32 v21, v108, v109, v110
    v_max_u32 v21, v21, v111
    v_cmp_eq_u32 vcc, -1, v21
    s_cbranch_vccnz G_f11
    v_mfma_f32_32x32x16_bf16 v[128:143], v[48:51], v[108:111], v[128:143]
G_q11:
    s_waitcnt vmcnt(11)
    v_max3_u32 v21, v104, v105, v106
    v_max_u32 v21, v21, v107
    v_cmp_eq_u32 vcc, -1, v21
    s_cbranch_vccnz G_f10
    v_mfma_f32_32x32x16_bf16 v[128:143], v[48:51], v[104:107], v[128:143]
G_q10:
    s_waitcnt vmcnt(10)
    v_max3_u32 v21, v100, v101, v102
    v_max_u32 v21, v21, v103
    v_cmp_eq_u32 vcc, -1, v21
    s_cbranch_vccnz G_f9
    v_mfma_f32_32x32x16_bf16 v[128:143], v[48:51], v[100:103], v[128:143]
G_q9:
    s_waitcnt vmcnt(9)
    v_max3_u32 v21, v96, v97, v98
    v_max_u32 v21, v21, v99
    v_cmp_eq_u32 vcc, -1, v21
    s_cbranch_vccnz G_f8
    v_mfma_f32_32x32x16_bf16 v[128:143], v[48:51], v[96:99], v[128:143]
G_q8:
    s_waitcnt vmcnt(8)
    v_max3_u32 v21, v92, v93, v94
    v_max_u32 v21, v21, v95
    v_cmp_eq_u32 vcc, -1, v21
    s_cbranch_vccnz G_f7
    v_mfma_f32_32x32x16_bf16 v[128:143], v[48:51], v[92:95], v[128:143]
G_q7:
    s_waitcnt vmcnt(7)
    v_max3_u32 v21, v88, v89, v90
    v_max_u32 v21, v21, v91
    v_cmp_eq_u32 vcc, -1, v21
    s_cbranch_vccnz G_f6
    v_mfma_f32_32x32x16_bf16 v[128:143], v[48:51], v[88:91], v[128:143]
G_q6:
    s_waitcnt vmcnt(6)
    v_max3_u32 v21, v84, v85, v86
    v_max_u32 v21, v21, v87
    v_cmp_eq_u32 vcc, -1, v21
    s_cbranch_vccnz G_f5
    v_mfma_f32_32x32x16_bf16 v[128:143], v[48:51], v[84:87], v[128:143]
G_q5:
    s_waitcnt vmcnt(5)
    v_max3_u32 v21, v80, v81, v82
    v_max_u32 v21, v21, v83
    v_cmp_eq_u32 vcc, -1, v21
    s_cbranch_vccnz G_f4
    v_mfma_f32_32x32x16_bf16 v[128:143], v[48:51], v[80:83], v[128:143]
G_q4:
    s_waitcnt vmcnt(4)
    v_max3_u32 v21, v76, v77, v78
    v_max_u32 v21, v21, v79
    v_cmp_eq_u32 vcc, -1, v21
    s_cbranch_vccnz G_f3
    v_mfma_f32_32x32x16_bf16 v[128:143], v[48:51], v[76:79], v[128:143]
G_q3:
    s_waitcnt vmcnt(3)
    v_max3_u32 v21, v72, v73, v74
    v_max_u32 v21, v21, v75
    v_cmp_eq_u32 vcc, -1, v21
    s_cbranch_vccnz G_f2
    v_mfma_f32_32x32x16_bf16 v[128:143], v[48:51], v[72:75], v[128:143]
G_q2:
    s_waitcnt vmcnt(2)
    v_max3_u32 v21, v68, v69, v70
    v_max_u32 v21, v21, v71
    v_cmp_eq_u32 vcc, -1, v21
    s_cbranch_vccnz G_f1
    v_mfma_f32_32x32x16_bf16 v[128:143], v[48:51], v[68:71], v[128:143]
G_q1:
    s_waitcnt vmcnt(1)
    v_max3_u32 v21, v64, v65, v66
    v_max_u32 v21, v21, v67
    v_cmp_eq_u32 vcc, -1, v21
    s_cbranch_vccnz G_f0
    v_mfma_f32_32x32x16_bf16 v[128:143], v[48:51], v[64:67], v[128:143]
G_q0:
    s_waitcnt vmcnt(0)
G_chk:
    s_add_u32 s65, s65, 1
    s_cmp_ge_u32 s65, 40000
    s_cbranch_scc1 G_done
    s_cmp_lg_u32 s68, 0
    s_cbranch_scc1 G_loop
    v_mov_b32 v20, -1
    s_cmp_lg_u32 s66, 0
    s_cbranch_scc1 G_loop
    v_max3_u32 v21, v56, v57, v58
    v_max_u32 v21, v21, v59
    v_cmp_eq_u32 vcc, -1, v21
    s_cbranch_vccnz G_loop
G_done:
    v_add_u32 v16, s7, v6
    v_add_f32_dpp v56, v56, v56 row_ror:4 row_mask:0xf bank_mask:0xf
    v_add_f32_dpp v57, v57, v57 row_ror:4 row_mask:0xf bank_mask:0xf
    v_add_f32_dpp v58, v58, v58 row_ror:4 row_mask:0xf bank_mask:0xf
    v_add_f32_dpp v59, v59, v59 row_ror:4 row_mask:0xf bank_mask:0xf
    v_add_f32_dpp v56, v56, v56 row_ror:8 row_mask:0xf bank_mask:0xf
    v_add_f32_dpp v57, v57, v57 row_ror:8 row_mask:0xf bank_mask:0xf
    v_add_f32_dpp v58, v58, v58 row_ror:8 row_mask:0xf bank_mask:0xf
    v_add_f32_dpp v59, v59, v59 row_ror:8 row_mask:0xf bank_mask:0xf
    v_mov_b32 v64, v56
    v_mov_b32 v65, v57
    v_mov_b32 v66, v58
    v_mov_b32 v67, v59
    s_nop 0
    v_permlane16_swap_b32 v56, v64
    v_permlane16_swap_b32 v57, v65
    v_permlane16_swap_b32 v58, v66
    v_permlane16_swap_b32 v59, v67
    v_add_f32 v56, v56, v64
    v_add_f32 v57, v57, v65
    v_add_f32 v58, v58, v66
    v_add_f32 v59, v59, v67
    v_mov_b32 v64, v56
    v_mov_b32 v65, v57
    v_mov_b32 v66, v58
    v_mov_b32 v67, v59
    s_nop 0
    v_permlane32_swap_b32 v56, v64
    v_permlane32_swap_b32 v57, v65
    v_permlane32_swap_b32 v58, v66
    v_permlane32_swap_b32 v59, v67
    v_add_f32 v56, v56, v64
    v_add_f32 v57, v57, v65
    v_add_f32 v58, v58, v66
    v_add_f32 v59, v59, v67
    v_cvt_pk_bf16_f32 v60, v128, v129
    v_cvt_pk_bf16_f32 v61, v130, v131
    v_cvt_pk_bf16_f32 v62, v132, v133
    v_cvt_pk_bf16_f32 v63, v134, v135
    ds_write_b128 v16, v[60:63] offset:0
    v_cvt_pk_bf16_f32 v56, v56, v57
    v_cvt_pk_bf16_f32 v57, v58, v59
    s_lshr_b32 s64, s6, 1
    s_lshl_b32 s64, s64, 6
    s_and_b32 s65, s6, 1
    s_lshl_b32 s65, s65, 3
    s_add_u32 s64, s64, s65
    v_lshl_add_u32 v16, v2, 4, s64
    s_mov_b64 exec, 15
    ds_write_b64 v16, v[56:57] offset:4096
    s_mov_b64 exec, -1
    s_waitcnt vmcnt(0) lgkmcnt(0)
    s_barrier
    v_lshrrev_b32 v18, 3, v2
    v_lshlrev_b32 v18, 2, v18
    ds_read_b32 v24, v18 offset:4352
    ds_read_b32 v25, v18 offset:4384
    ds_read_b32 v26, v18 offset:4416
    ds_read_b32 v27, v18 offset:4448
    ds_read_b32 v28, v18 offset:4480
    ds_read_b32 v29, v18 offset:4512
    ds_read_b32 v30, v18 offset:4544
    s_waitcnt lgkmcnt(0)
    s_mov_b32 s64, 0x05040100
    s_mov_b32 s65, 0x07060302
    v_cvt_pk_bf16_f32 v24, v24, v25
    v_cvt_pk_bf16_f32 v25, v26, v27
    v_cvt_pk_bf16_f32 v26, v28, v29
    v_cvt_pk_bf16_f32 v27, v30, 0
    v_perm_b32 v48, v196, v192, s64
    v_perm_b32 v49, v196, v192, s65
    v_dot2_f32_bf16 v32, v48, v24, 0
    v_dot2_f32_bf16 v33, v49, v24, 0
    v_perm_b32 v50, v197, v193, s64
    v_perm_b32 v51, v197, v193, s65
    v_dot2_f32_bf16 v34, v50, v24, 0
    v_dot2_f32_bf16 v35, v51, v24, 0
    v_perm_b32 v48, v198, v194, s64
    v_perm_b32 v49, v198, v194, s65
    v_dot2_f32_bf16 v36, v48, v24, 0
    v_dot2_f32_bf16 v37, v49, v24, 0
    v_perm_b32 v50, v199, v195, s64
    v_perm_b32 v51, v199, v195, s65
    v_dot2_f32_bf16 v38, v50, v24, 0
    v_dot2_f32_bf16 v39, v51, v24, 0
    v_perm_b32 v48, v204, v200, s64
    v_perm_b32 v49, v204, v200, s65
    v_dot2_f32_bf16 v32, v48, v25, v32
    v_dot2_f32_bf16 v33, v49, v25, v33
    v_perm_b32 v50, v205, v201, s64
    v_perm_b32 v51, v205, v201, s65
    v_dot2_f32_bf16 v34, v50, v25, v34
    v_dot2_f32_bf16 v35, v51, v25, v35
    v_perm_b32 v48, v206, v202, s64
    v_perm_b32 v49, v206, v202, s65
    v_dot2_f32_bf16 v36, v48, v25, v36
    v_dot2_f32_bf16 v37, v49, v25, v37
    v_perm_b32 v50, v207, v203, s64
    v_perm_b32 v51, v207, v203, s65
    v_dot2_f32_bf16 v38, v50, v25, v38
    v_dot2_f32_bf16 v39, v51, v25, v39
    v_perm_b32 v48, v212, v208, s64
    v_perm_b32 v49, v212, v208, s65
    v_dot2_f32_bf16 v32, v48, v26, v32
    v_dot2_f32_bf16 v33, v49, v26, v33
    v_perm_b32 v50, v213, v209, s64
    v_perm_b32 v51, v213, v209, s65
    v_dot2_f32_bf16 v34, v50, v26, v34
    v_dot2_f32_bf16 v35, v51, v26, v35
    v_perm_b32 v48, v214, v210, s64
    v_perm_b32 v49, v214, v210, s65
    v_dot2_f32_bf16 v36, v48, v26, v36
    v_dot2_f32_bf16 v37, v49, v26, v37
    v_perm_b32 v50, v215, v211, s64
    v_perm_b32 v51, v215, v211, s65
    v_dot2_f32_bf16 v38, v50, v26, v38
    v_dot2_f32_bf16 v39, v51, v26, v39
    v_perm_b32 v48, v216, v216, s64
    v_perm_b32 v49, v216, v216, s65
    v_dot2_f32_bf16 v32, v48, v27, v32
    v_dot2_f32_bf16 v33, v49, v27, v33
    v_perm_b32 v50, v217, v217, s64
    v_perm_b32 v51, v217, v217, s65
    v_dot2_f32_bf16 v34, v50, v27, v34
    v_dot2_f32_bf16 v35, v51, v27, v35
    v_perm_b32 v48, v218, v218, s64
    v_perm_b32 v49, v218, v218, s65
    v_dot2_f32_bf16 v36, v48, v27, v36
    v_dot2_f32_bf16 v37, v49, v27, v37
    v_perm_b32 v50, v219, v219, s64
    v_perm_b32 v51, v219, v219, s65
    v_dot2_f32_bf16 v38, v50, v27, v38
    v_dot2_f32_bf16 v39, v51, v27, v39
    s_nop 1
    s_nop 1
    v_permlane32_swap_b32 v32, v36
    v_permlane32_swap_b32 v33, v37
    v_permlane32_swap_b32 v34, v38
    v_permlane32_swap_b32 v35, v39
    v_add_f32 v32, v32, v36
    v_add_f32 v33, v33, v37
    v_add_f32 v34, v34, v38
    v_add_f32 v35, v35, v39
    s_nop 1
    v_permlane16_swap_b32 v32, v34
    v_permlane16_swap_b32 v33, v35
    v_add_f32 v32, v32, v34
    v_add_f32 v33, v33, v35
    s_nop 1
    v_add_f32_dpp v32, v32, v32 row_ror:8 row_mask:0xf bank_mask:0xf
    v_add_f32_dpp v33, v33, v33 row_ror:8 row_mask:0xf bank_mask:0xf
    v_and_b32 v16, 7, v2
    v_lshlrev_b32 v16, 5, v16
    v_lshl_add_u32 v16, v8, 3, v16
    s_lshl_b32 s64, s2, 10
    s_lshl_b32 s65, s6, 8
    s_add_u32 s64, s64, s65
    s_add_u32 s64, s64, 6447104
    s_mov_b32 exec_lo, 0x00ff00ff
    s_mov_b32 exec_hi, 0x00ff00ff
    buffer_store_dwordx2 v[32:33], v16, s[16:19], s64 offen sc0 sc1
    s_mov_b64 exec, -1
    s_lshl_b32 s64, s4, 3
    s_add_u32 s64, s64, s3
    s_lshl_b32 s64, s64, 7
    s_add_u32 s64, s64, 5382144
    v_mov_b32 v14, s64
    s_mov_b64 exec, 1
    v_mov_b32 v15, 0
    buffer_atomic_or v15, v14, s[16:19], 0 offen sc0
    s_mov_b64 exec, -1
    v_mov_b32 v254, v14
    s_branch P2_start
C_start:
    s_and_b32 s6, s3, 1
    s_lshr_b32 s7, s3, 1
    v_and_b32 v3, 15, v2
    s_lshl_b32 s64, s6, 6
    v_add_u32 v3, s64, v3
    v_lshlrev_b32 v3, 7, v3
    v_add_u32 v3, 8192, v3
    v_bfe_u32 v56, v2, 1, 3
    v_lshrrev_b32 v57, 4, v2
    v_xor_b32 v56, v56, v57
    v_lshl_add_u32 v4, v56, 4, v3
    v_xor_b32 v5, 64, v4
    v_bfe_u32 v56, v2, 2, 2
    v_lshl_add_u32 v58, v57, 3, v56
    v_lshlrev_b32 v58, 7, v58
    v_lshrrev_b32 v56, 1, v56
    v_xor_b32 v56, s7, v56
    v_lshl_add_u32 v58, v56, 6, v58
    v_and_b32 v57, 1, v57
    v_lshl_add_u32 v58, v57, 5, v58
    v_and_b32 v56, 3, v2
    v_lshl_add_u32 v58, v56, 3, v58
    v_add_u32 v6, 24576, v58
    v_xor_b32 v7, 32, v6
    v_mov_b32 v8, v4
    v_mov_b32 v10, v6
    v_mov_b32 v9, v5
    v_mov_b32 v11, v7
    v_mov_b32 v64, 0
    v_mov_b32 v65, 0
    v_mov_b32 v66, 0
    v_mov_b32 v67, 0
    v_mov_b32 v68, 0
    v_mov_b32 v69, 0
    v_mov_b32 v70, 0
    v_mov_b32 v71, 0
    v_mov_b32 v72, 0
    v_mov_b32 v73, 0
    v_mov_b32 v74, 0
    v_mov_b32 v75, 0
    v_mov_b32 v76, 0
    v_mov_b32 v77, 0
    v_mov_b32 v78, 0
    v_mov_b32 v79, 0
    v_mov_b32 v80, 0
    v_mov_b32 v81, 0
    v_mov_b32 v82, 0
    v_mov_b32 v83, 0
    v_mov_b32 v84, 0
    v_mov_b32 v85, 0
    v_mov_b32 v86, 0
    v_mov_b32 v87, 0
    v_mov_b32 v88, 0
    v_mov_b32 v89, 0
    v_mov_b32 v90, 0
    v_mov_b32 v91, 0
    v_mov_b32 v92, 0
    v_mov_b32 v93, 0
    v_mov_b32 v94, 0
    v_mov_b32 v95, 0
    v_mov_b32 v96, 0
    v_mov_b32 v97, 0
    v_mov_b32 v98, 0
    v_mov_b32 v99, 0
    v_mov_b32 v100, 0
    v_mov_b32 v101, 0
    v_mov_b32 v102, 0
    v_mov_b32 v103, 0
    v_mov_b32 v104, 0
    v_mov_b32 v105, 0
    v_mov_b32 v106, 0
    v_mov_b32 v107, 0
    v_mov_b32 v108, 0
    v_mov_b32 v109, 0
    v_mov_b32 v110, 0
    v_mov_b32 v111, 0
    v_mov_b32 v112, 0
    v_mov_b32 v113, 0
    v_mov_b32 v114, 0
    v_mov_b32 v115, 0
    v_mov_b32 v116, 0
    v_mov_b32 v117, 0
    v_mov_b32 v118, 0
    v_mov_b32 v119, 0
    v_mov_b32 v120, 0
    v_mov_b32 v121, 0
    v_mov_b32 v122, 0
    v_mov_b32 v123, 0
    v_mov_b32 v124, 0
    v_mov_b32 v125, 0
    v_mov_b32 v126, 0
    v_mov_b32 v127, 0
    v_mov_b32 v128, 0
    v_mov_b32 v129, 0
    v_mov_b32 v130, 0
    v_mov_b32 v131, 0
    v_mov_b32 v132, 0
    v_mov_b32 v133, 0
    v_mov_b32 v134, 0
    v_mov_b32 v135, 0
    v_mov_b32 v136, 0
    v_mov_b32 v137, 0
    v_mov_b32 v138, 0
    v_mov_b32 v139, 0
    v_mov_b32 v140, 0
    v_mov_b32 v141, 0
    v_mov_b32 v142, 0
    v_mov_b32 v143, 0
    v_mov_b32 v144, 0
    v_mov_b32 v145, 0
    v_mov_b32 v146, 0
    v_mov_b32 v147, 0
    v_mov_b32 v148, 0
    v_mov_b32 v149, 0
    v_mov_b32 v150, 0
    v_mov_b32 v151, 0
    v_mov_b32 v152, 0
    v_mov_b32 v153, 0
    v_mov_b32 v154, 0
    v_mov_b32 v155, 0
    v_mov_b32 v156, 0
    v_mov_b32 v157, 0
    v_mov_b32 v158, 0
    v_mov_b32 v159, 0
    s_lshl_b32 s64, s3, 2
    v_mov_b32 v229, s64
    ds_write_b32 v229, v64 offset:4288
    ds_write_b32 v229, v64 offset:4304
    v_lshlrev_b32 v3, 4, v2
    s_lshl_b32 s64, s3, 11
    v_add_u32 v224, s64, v3
    v_xor_b32 v225, 2048, v224
    s_lshl_b32 s64, s3, 8
    v_lshl_add_u32 v227, v2, 2, s64
    v_xor_b32 v228, 256, v227
    v_xor_b32 v230, 4, v229
    v_mov_b32 v231, 1
    v_mov_b32 v226, 0
    v_lshlrev_b32 v232, 2, v2
    s_lshl_b32 s64, 1, s4
    v_mov_b32 v233, s64
    s_lshl_b32 s43, s5, 2
    s_add_u32 s43, s43, s3
    s_lshl_b32 s64, s43, 7
    s_add_u32 s64, s64, 5373952
    v_mov_b32 v234, s64
    s_lshl_b32 s43, s43, 4
    s_add_u32 s43, s43, s4
    s_mul_i32 s43, s43, 1152
    s_add_u32 s43, s43, 4194304
    s_lshl_b32 s42, s4, 2
    s_lshl_b32 s64, s6, 1
    s_add_u32 s42, s42, s64
    s_lshl_b32 s42, s42, 5
    s_lshl_b32 s64, s5, 1
    s_add_u32 s42, s42, s64
    s_add_u32 s42, s42, s7
    s_lshl_b32 s42, s42, 11
    s_and_b32 s64, s5, 7
    s_lshl_b32 s64, s64, 1
    s_add_u32 s64, s64, s7
    s_lshl_b32 s64, 1, s64
    v_mov_b32 v13, s64
    s_lshr_b32 s64, s5, 3
    s_lshl_b32 s64, s64, 1
    s_add_u32 s64, s64, s6
    s_lshl_b32 s64, s64, 8
    s_lshl_b32 s65, s4, 10
    s_add_u32 s64, s64, s65
    s_add_u32 s64, s64, 5382144
    v_lshl_add_u32 v15, v2, 7, s64
    v_lshlrev_b32 v1, 4, v2
    s_and_b32 s64, s2, 7
    s_lshr_b32 s65, s2, 3
    s_and_b32 s4, s64, 3
    s_lshl_b32 s4, s4, 2
    s_and_b32 s66, s65, 3
    s_add_u32 s4, s4, s66
    s_lshr_b32 s5, s64, 2
    s_lshl_b32 s5, s5, 3
    s_lshr_b32 s66, s65, 2
    s_add_u32 s5, s5, s66
    s_mov_b32 s65, 0
    s_mov_b32 s66, 0
    v_mov_b32 v236, 0x3f803f80
    v_mov_b32 v237, 0x3f803f80
    v_mov_b32 v238, 0x3f803f80
    v_mov_b32 v239, 0x3f803f80
    s_waitcnt vmcnt(0) lgkmcnt(0)
    s_barrier
    ds_read_b64_tr_b16 v[16:17], v10 offset:0
    ds_read_b64_tr_b16 v[18:19], v10 offset:512
    ds_read_b128 v[192:195], v8 offset:0
    ds_read_b128 v[196:199], v8 offset:2048
    ds_read_b128 v[200:203], v8 offset:4096
    ds_read_b128 v[204:207], v8 offset:6144
    ds_read_b64_tr_b16 v[20:21], v11 offset:0
    ds_read_b64_tr_b16 v[22:23], v11 offset:512
    ds_read_b64_tr_b16 v[24:25], v10 offset:8192
    ds_read_b64_tr_b16 v[26:27], v10 offset:8704
    ds_read_b64_tr_b16 v[28:29], v11 offset:8192
    ds_read_b64_tr_b16 v[30:31], v11 offset:8704
    ds_read_b64_tr_b16 v[32:33], v10 offset:16384
    ds_read_b64_tr_b16 v[34:35], v10 offset:16896
    ds_read_b64_tr_b16 v[36:37], v11 offset:16384
    ds_read_b64_tr_b16 v[38:39], v11 offset:16896
.p2align 3
C_loop:
    s_waitcnt lgkmcnt(0)
    v_mfma_f32_16x16x32_bf16 v[64:67], v[16:19], v[192:195], v[64:67]
    ds_read_b64_tr_b16 v[40:41], v10 offset:4096
    v_mfma_f32_16x16x32_bf16 v[72:75], v[16:19], v[196:199], v[72:75]
    ds_read_b64_tr_b16 v[42:43], v10 offset:4608
    v_mfma_f32_16x16x32_bf16 v[80:83], v[16:19], v[200:203], v[80:83]
    ds_read_b128 v[208:211], v9 offset:0
    v_mfma_f32_16x16x32_bf16 v[88:91], v[16:19], v[204:207], v[88:91]
    ds_read_b128 v[212:215], v9 offset:2048
    v_mfma_f32_16x16x32_bf16 v[68:71], v[20:23], v[192:195], v[68:71]
    ds_read_b128 v[216:219], v9 offset:4096
    v_mfma_f32_16x16x32_bf16 v[76:79], v[20:23], v[196:199], v[76:79]
    ds_read_b128 v[220:223], v9 offset:6144
    v_mfma_f32_16x16x32_bf16 v[84:87], v[20:23], v[200:203], v[84:87]
    ds_read_b64_tr_b16 v[44:45], v11 offset:4096
    v_mfma_f32_16x16x32_bf16 v[92:95], v[20:23], v[204:207], v[92:95]
    ds_read_b64_tr_b16 v[46:47], v11 offset:4608
    v_mfma_f32_16x16x32_bf16 v[96:99], v[192:195], v[24:27], v[96:99]
    ds_read_b64_tr_b16 v[48:49], v10 offset:12288
    v_mfma_f32_16x16x32_bf16 v[100:103], v[196:199], v[24:27], v[100:103]
    ds_read_b64_tr_b16 v[50:51], v10 offset:12800
    v_mfma_f32_16x16x32_bf16 v[112:115], v[200:203], v[24:27], v[112:115]
    ds_read_b64_tr_b16 v[52:53], v11 offset:12288
    v_mfma_f32_16x16x32_bf16 v[116:119], v[204:207], v[24:27], v[116:119]
    ds_read_b64_tr_b16 v[54:55], v11 offset:12800
    v_mfma_f32_16x16x32_bf16 v[104:107], v[192:195], v[28:31], v[104:107]
    ds_read_b64_tr_b16 v[56:57], v10 offset:20480
    v_mfma_f32_16x16x32_bf16 v[108:111], v[196:199], v[28:31], v[108:111]
    ds_read_b64_tr_b16 v[58:59], v10 offset:20992
    v_mfma_f32_16x16x32_bf16 v[120:123], v[200:203], v[28:31], v[120:123]
    ds_read_b64_tr_b16 v[60:61], v11 offset:20480
    v_mfma_f32_16x16x32_bf16 v[124:127], v[204:207], v[28:31], v[124:127]
    ds_read_b64_tr_b16 v[62:63], v11 offset:20992
    v_mfma_f32_16x16x32_bf16 v[128:131], v[192:195], v[32:35], v[128:131]
    v_mfma_f32_16x16x32_bf16 v[132:135], v[196:199], v[32:35], v[132:135]
    v_mfma_f32_16x16x32_bf16 v[144:147], v[200:203], v[32:35], v[144:147]
    v_mfma_f32_16x16x32_bf16 v[148:151], v[204:207], v[32:35], v[148:151]
    v_mfma_f32_16x16x32_bf16 v[136:139], v[192:195], v[36:39], v[136:139]
    v_mfma_f32_16x16x32_bf16 v[140:143], v[196:199], v[36:39], v[140:143]
    v_mfma_f32_16x16x32_bf16 v[152:155], v[200:203], v[36:39], v[152:155]
    v_mfma_f32_16x16x32_bf16 v[156:159], v[204:207], v[36:39], v[156:159]
    s_waitcnt lgkmcnt(0)
    s_barrier
    s_add_u32 s65, s65, 40960
    s_cmp_eq_u32 s65, 122880
    s_cselect_b32 s65, 0, s65
    v_mfma_f32_16x16x32_bf16 v[64:67], v[40:43], v[208:211], v[64:67]
    v_add_u32 v10, s65, v6
    v_add_u32 v8, s65, v4
    v_mfma_f32_16x16x32_bf16 v[72:75], v[40:43], v[212:215], v[72:75]
    ds_read_b64_tr_b16 v[16:17], v10 offset:0
    v_mfma_f32_16x16x32_bf16 v[80:83], v[40:43], v[216:219], v[80:83]
    ds_read_b64_tr_b16 v[18:19], v10 offset:512
    v_mfma_f32_16x16x32_bf16 v[88:91], v[40:43], v[220:223], v[88:91]
    ds_read_b128 v[192:195], v8 offset:0
    v_mfma_f32_16x16x32_bf16 v[68:71], v[44:47], v[208:211], v[68:71]
    ds_read_b128 v[196:199], v8 offset:2048
    v_mfma_f32_16x16x32_bf16 v[76:79], v[44:47], v[212:215], v[76:79]
    ds_read_b128 v[200:203], v8 offset:4096
    v_mfma_f32_16x16x32_bf16 v[84:87], v[44:47], v[216:219], v[84:87]
    ds_read_b128 v[204:207], v8 offset:6144
    v_mfma_f32_16x16x32_bf16 v[92:95], v[44:47], v[220:223], v[92:95]
    v_add_u32 v11, s65, v7
    v_mfma_f32_16x16x32_bf16 v[96:99], v[208:211], v[48:51], v[96:99]
    ds_read_b64_tr_b16 v[20:21], v11 offset:0
    v_mfma_f32_16x16x32_bf16 v[100:103], v[212:215], v[48:51], v[100:103]
    ds_read_b64_tr_b16 v[22:23], v11 offset:512
    v_mfma_f32_16x16x32_bf16 v[112:115], v[216:219], v[48:51], v[112:115]
    ds_read_b64_tr_b16 v[24:25], v10 offset:8192
    v_mfma_f32_16x16x32_bf16 v[116:119], v[220:223], v[48:51], v[116:119]
    ds_read_b64_tr_b16 v[26:27], v10 offset:8704
    v_mfma_f32_16x16x32_bf16 v[104:107], v[208:211], v[52:55], v[104:107]
    ds_read_b64_tr_b16 v[28:29], v11 offset:8192
    v_mfma_f32_16x16x32_bf16 v[108:111], v[212:215], v[52:55], v[108:111]
    ds_read_b64_tr_b16 v[30:31], v11 offset:8704
    v_mfma_f32_16x16x32_bf16 v[120:123], v[216:219], v[52:55], v[120:123]
    ds_read_b64_tr_b16 v[32:33], v10 offset:16384
    v_mfma_f32_16x16x32_bf16 v[124:127], v[220:223], v[52:55], v[124:127]
    ds_read_b64_tr_b16 v[34:35], v10 offset:16896
    v_mfma_f32_16x16x32_bf16 v[128:131], v[208:211], v[56:59], v[128:131]
    ds_read_b64_tr_b16 v[36:37], v11 offset:16384
    v_mfma_f32_16x16x32_bf16 v[132:135], v[212:215], v[56:59], v[132:135]
    ds_read_b64_tr_b16 v[38:39], v11 offset:16896
    v_mfma_f32_16x16x32_bf16 v[144:147], v[216:219], v[56:59], v[144:147]
    v_add_u32 v9, s65, v5
    v_mfma_f32_16x16x32_bf16 v[148:151], v[220:223], v[56:59], v[148:151]
    v_mfma_f32_16x16x32_bf16 v[136:139], v[208:211], v[60:63], v[136:139]
    v_mfma_f32_16x16x32_bf16 v[140:143], v[212:215], v[60:63], v[140:143]
    v_mfma_f32_16x16x32_bf16 v[152:155], v[216:219], v[60:63], v[152:155]
    v_mfma_f32_16x16x32_bf16 v[156:159], v[220:223], v[60:63], v[156:159]
    s_add_u32 s66, s66, 1
    s_cmp_lt_u32 s66, 14
    s_cbranch_scc1 C_loop
    s_waitcnt lgkmcnt(0)
    v_mfma_f32_16x16x32_bf16 v[96:99], v[192:195], v[24:27], v[96:99]
    ds_read_b64_tr_b16 v[48:49], v10 offset:12288
    v_mfma_f32_16x16x32_bf16 v[100:103], v[196:199], v[24:27], v[100:103]
    ds_read_b64_tr_b16 v[50:51], v10 offset:12800
    v_mfma_f32_16x16x32_bf16 v[112:115], v[200:203], v[24:27], v[112:115]
    ds_read_b128 v[160:163], v9 offset:0
    v_mfma_f32_16x16x32_bf16 v[116:119], v[204:207], v[24:27], v[116:119]
    ds_read_b128 v[164:167], v9 offset:2048
    v_mfma_f32_16x16x32_bf16 v[104:107], v[192:195], v[28:31], v[104:107]
    ds_read_b128 v[168:171], v9 offset:4096
    v_mfma_f32_16x16x32_bf16 v[108:111], v[196:199], v[28:31], v[108:111]
    ds_read_b128 v[172:175], v9 offset:6144
    v_mfma_f32_16x16x32_bf16 v[120:123], v[200:203], v[28:31], v[120:123]
    ds_read_b64_tr_b16 v[52:53], v11 offset:12288
    v_mfma_f32_16x16x32_bf16 v[124:127], v[204:207], v[28:31], v[124:127]
    ds_read_b64_tr_b16 v[54:55], v11 offset:12800
    v_mfma_f32_16x16x32_bf16 v[128:131], v[192:195], v[32:35], v[128:131]
    ds_read_b64_tr_b16 v[56:57], v10 offset:20480
    v_mfma_f32_16x16x32_bf16 v[132:135], v[196:199], v[32:35], v[132:135]
    ds_read_b64_tr_b16 v[58:59], v10 offset:20992
    v_mfma_f32_16x16x32_bf16 v[144:147], v[200:203], v[32:35], v[144:147]
    ds_read_b64_tr_b16 v[60:61], v11 offset:20480
    v_mfma_f32_16x16x32_bf16 v[148:151], v[204:207], v[32:35], v[148:151]
    ds_read_b64_tr_b16 v[62:63], v11 offset:20992
    v_mfma_f32_16x16x32_bf16 v[136:139], v[192:195], v[36:39], v[136:139]
    v_mfma_f32_16x16x32_bf16 v[140:143], v[196:199], v[36:39], v[140:143]
    v_mfma_f32_16x16x32_bf16 v[152:155], v[200:203], v[36:39], v[152:155]
    v_mfma_f32_16x16x32_bf16 v[156:159], v[204:207], v[36:39], v[156:159]
    s_waitcnt lgkmcnt(0)
    s_barrier
    s_add_u32 s66, s66, 1
    v_mfma_f32_16x16x32_bf16 v[96:99], v[160:163], v[48:51], v[96:99]
    v_mov_b32 v10, v6
    v_mov_b32 v8, v4
    v_mfma_f32_16x16x32_bf16 v[100:103], v[164:167], v[48:51], v[100:103]
    ds_read_b64_tr_b16 v[24:25], v10 offset:8192
    v_mfma_f32_16x16x32_bf16 v[112:115], v[168:171], v[48:51], v[112:115]
    ds_read_b64_tr_b16 v[26:27], v10 offset:8704
    v_mfma_f32_16x16x32_bf16 v[116:119], v[172:175], v[48:51], v[116:119]
    v_mov_b32 v11, v7
    v_mov_b32 v9, v5
    v_mfma_f32_16x16x32_bf16 v[104:107], v[160:163], v[52:55], v[104:107]
    ds_read_b128 v[176:179], v8 offset:0
    v_mfma_f32_16x16x32_bf16 v[108:111], v[164:167], v[52:55], v[108:111]
    ds_read_b128 v[180:183], v8 offset:2048
    v_mfma_f32_16x16x32_bf16 v[120:123], v[168:171], v[52:55], v[120:123]
    ds_read_b128 v[184:187], v8 offset:4096
    v_mfma_f32_16x16x32_bf16 v[124:127], v[172:175], v[52:55], v[124:127]
    ds_read_b128 v[188:191], v8 offset:6144
    v_mfma_f32_16x16x32_bf16 v[128:131], v[160:163], v[56:59], v[128:131]
    ds_read_b64_tr_b16 v[28:29], v11 offset:8192
    v_mfma_f32_16x16x32_bf16 v[132:135], v[164:167], v[56:59], v[132:135]
    ds_read_b64_tr_b16 v[30:31], v11 offset:8704
    v_mfma_f32_16x16x32_bf16 v[144:147], v[168:171], v[56:59], v[144:147]
    ds_read_b64_tr_b16 v[32:33], v10 offset:16384
    v_mfma_f32_16x16x32_bf16 v[148:151], v[172:175], v[56:59], v[148:151]
    ds_read_b64_tr_b16 v[34:35], v10 offset:16896
    v_mfma_f32_16x16x32_bf16 v[136:139], v[160:163], v[60:63], v[136:139]
    ds_read_b64_tr_b16 v[36:37], v11 offset:16384
    v_mfma_f32_16x16x32_bf16 v[140:143], v[164:167], v[60:63], v[140:143]
    ds_read_b64_tr_b16 v[38:39], v11 offset:16896
    v_mfma_f32_16x16x32_bf16 v[152:155], v[168:171], v[60:63], v[152:155]
    v_mfma_f32_16x16x32_bf16 v[156:159], v[172:175], v[60:63], v[156:159]
    s_waitcnt lgkmcnt(0)
    v_mfma_f32_16x16x32_bf16 v[96:99], v[176:179], v[24:27], v[96:99]
    ds_read_b64_tr_b16 v[48:49], v10 offset:12288
    v_mfma_f32_16x16x32_bf16 v[100:103], v[180:183], v[24:27], v[100:103]
    ds_read_b64_tr_b16 v[50:51], v10 offset:12800
    v_mfma_f32_16x16x32_bf16 v[112:115], v[184:187], v[24:27], v[112:115]
    ds_read_b128 v[208:211], v9 offset:0
    v_mfma_f32_16x16x32_bf16 v[116:119], v[188:191], v[24:27], v[116:119]
    ds_read_b128 v[212:215], v9 offset:2048
    v_mfma_f32_16x16x32_bf16 v[104:107], v[176:179], v[28:31], v[104:107]
    ds_read_b128 v[216:219], v9 offset:4096
    v_mfma_f32_16x16x32_bf16 v[108:111], v[180:183], v[28:31], v[108:111]
    ds_read_b128 v[220:223], v9 offset:6144
    v_mfma_f32_16x16x32_bf16 v[120:123], v[184:187], v[28:31], v[120:123]
    ds_read_b64_tr_b16 v[52:53], v11 offset:12288
    v_mfma_f32_16x16x32_bf16 v[124:127], v[188:191], v[28:31], v[124:127]
    ds_read_b64_tr_b16 v[54:55], v11 offset:12800
    v_mfma_f32_16x16x32_bf16 v[128:131], v[176:179], v[32:35], v[128:131]
    ds_read_b64_tr_b16 v[56:57], v10 offset:20480
    v_mfma_f32_16x16x32_bf16 v[132:135], v[180:183], v[32:35], v[132:135]
    ds_read_b64_tr_b16 v[58:59], v10 offset:20992
    v_mfma_f32_16x16x32_bf16 v[144:147], v[184:187], v[32:35], v[144:147]
    ds_read_b64_tr_b16 v[60:61], v11 offset:20480
    v_mfma_f32_16x16x32_bf16 v[148:151], v[188:191], v[32:35], v[148:151]
    ds_read_b64_tr_b16 v[62:63], v11 offset:20992
    v_mfma_f32_16x16x32_bf16 v[136:139], v[176:179], v[36:39], v[136:139]
    v_mfma_f32_16x16x32_bf16 v[140:143], v[180:183], v[36:39], v[140:143]
    v_mfma_f32_16x16x32_bf16 v[152:155], v[184:187], v[36:39], v[152:155]
    v_mfma_f32_16x16x32_bf16 v[156:159], v[188:191], v[36:39], v[156:159]
    s_waitcnt lgkmcnt(0)
    s_barrier
    v_mfma_f32_16x16x32_bf16 v[96:99], v[208:211], v[48:51], v[96:99]
    v_mfma_f32_16x16x32_bf16 v[100:103], v[212:215], v[48:51], v[100:103]
    v_mfma_f32_16x16x32_bf16 v[104:107], v[208:211], v[52:55], v[104:107]
    v_mfma_f32_16x16x32_bf16 v[108:111], v[212:215], v[52:55], v[108:111]
    v_mfma_f32_16x16x32_bf16 v[128:131], v[208:211], v[56:59], v[128:131]
    v_mfma_f32_16x16x32_bf16 v[132:135], v[212:215], v[56:59], v[132:135]
    v_mfma_f32_16x16x32_bf16 v[136:139], v[208:211], v[60:63], v[136:139]
    v_add_u32 v10, 81920, v6
    v_add_u32 v11, 81920, v7
    s_nop 2
    v_cvt_pk_bf16_f32 v16, v96, v97
    v_lshlrev_b32 v32, 16, v16
    v_and_b32 v33, 0xffff0000, v16
    v_mul_f32 v34, s72, v32
    v_mul_f32 v35, s72, v33
    v_exp_f32 v34, v34 clamp
    v_exp_f32 v35, v35 clamp
    v_max_f32 v32, 0, v32
    v_mfma_f32_16x16x32_bf16 v[140:143], v[212:215], v[60:63], v[140:143]
    v_max_f32 v33, 0, v33
    v_add_f32 v32, v32, v34
    v_add_f32 v33, v33, v35
    v_min_f32 v36, v32, v33
    v_cvt_pk_bf16_f32 v16, v32, v33
    v_cvt_pk_bf16_f32 v17, v98, v99
    v_lshlrev_b32 v32, 16, v17
    v_and_b32 v33, 0xffff0000, v17
    v_mfma_f32_16x16x32_bf16 v[112:115], v[216:219], v[48:51], v[112:115]
    v_mul_f32 v34, s72, v32
    v_mul_f32 v35, s72, v33
    v_exp_f32 v34, v34 clamp
    v_exp_f32 v35, v35 clamp
    v_max_f32 v32, 0, v32
    v_max_f32 v33, 0, v33
    v_add_f32 v32, v32, v34
    v_add_f32 v33, v33, v35
    v_mfma_f32_16x16x32_bf16 v[116:119], v[220:223], v[48:51], v[116:119]
    v_min3_f32 v36, v32, v33, v36
    v_cvt_pk_bf16_f32 v17, v32, v33
    v_cvt_pk_bf16_f32 v18, v100, v101
    v_lshlrev_b32 v32, 16, v18
    v_and_b32 v33, 0xffff0000, v18
    v_mul_f32 v34, s72, v32
    v_mul_f32 v35, s72, v33
    v_exp_f32 v34, v34 clamp
    v_mfma_f32_16x16x32_bf16 v[120:123], v[216:219], v[52:55], v[120:123]
    v_exp_f32 v35, v35 clamp
    v_max_f32 v32, 0, v32
    v_max_f32 v33, 0, v33
    v_add_f32 v32, v32, v34
    v_add_f32 v33, v33, v35
    v_min3_f32 v36, v32, v33, v36
    v_cvt_pk_bf16_f32 v18, v32, v33
    v_cvt_pk_bf16_f32 v19, v102, v103
    v_mfma_f32_16x16x32_bf16 v[124:127], v[220:223], v[52:55], v[124:127]
    v_lshlrev_b32 v32, 16, v19
    v_and_b32 v33, 0xffff0000, v19
    v_mul_f32 v34, s72, v32
    v_mul_f32 v35, s72, v33
    v_exp_f32 v34, v34 clamp
    v_exp_f32 v35, v35 clamp
    v_max_f32 v32, 0, v32
    v_max_f32 v33, 0, v33
    v_mfma_f32_16x16x32_bf16 v[144:147], v[216:219], v[56:59], v[144:147]
    v_add_f32 v32, v32, v34
    v_add_f32 v33, v33, v35
    v_min3_f32 v36, v32, v33, v36
    v_cvt_pk_bf16_f32 v19, v32, v33
    v_cvt_pk_bf16_f32 v20, v104, v105
    v_lshlrev_b32 v32, 16, v20
    v_and_b32 v33, 0xffff0000, v20
    v_mul_f32 v34, s72, v32
    v_mfma_f32_16x16x32_bf16 v[148:151], v[220:223], v[56:59], v[148:151]
    v_mul_f32 v35, s72, v33
    v_exp_f32 v34, v34 clamp
    v_exp_f32 v35, v35 clamp
    v_max_f32 v32, 0, v32
    v_max_f32 v33, 0, v33
    v_add_f32 v32, v32, v34
    v_add_f32 v33, v33, v35
    v_min3_f32 v36, v32, v33, v36
    v_mfma_f32_16x16x32_bf16 v[152:155], v[216:219], v[60:63], v[152:155]
    v_cvt_pk_bf16_f32 v20, v32, v33
    v_cvt_pk_bf16_f32 v21, v106, v107
    v_lshlrev_b32 v32, 16, v21
    v_and_b32 v33, 0xffff0000, v21
    v_mul_f32 v34, s72, v32
    v_mul_f32 v35, s72, v33
    v_exp_f32 v34, v34 clamp
    v_exp_f32 v35, v35 clamp
    v_mfma_f32_16x16x32_bf16 v[156:159], v[220:223], v[60:63], v[156:159]
    v_max_f32 v32, 0, v32
    v_max_f32 v33, 0, v33
    v_add_f32 v32, v32, v34
    v_add_f32 v33, v33, v35
    v_min3_f32 v36, v32, v33, v36
    v_cvt_pk_bf16_f32 v21, v32, v33
    v_cvt_pk_bf16_f32 v22, v108, v109
    v_lshlrev_b32 v32, 16, v22
    v_and_b32 v33, 0xffff0000, v22
    v_mul_f32 v34, s72, v32
    v_mul_f32 v35, s72, v33
    v_exp_f32 v34, v34 clamp
    v_exp_f32 v35, v35 clamp
    v_max_f32 v32, 0, v32
    v_max_f32 v33, 0, v33
    v_add_f32 v32, v32, v34
    v_add_f32 v33, v33, v35
    v_min3_f32 v36, v32, v33, v36
    v_cvt_pk_bf16_f32 v22, v32, v33
    v_cvt_pk_bf16_f32 v23, v110, v111
    v_lshlrev_b32 v32, 16, v23
    v_and_b32 v33, 0xffff0000, v23
    v_mul_f32 v34, s72, v32
    v_mul_f32 v35, s72, v33
    v_exp_f32 v34, v34 clamp
    v_exp_f32 v35, v35 clamp
    v_max_f32 v32, 0, v32
    v_max_f32 v33, 0, v33
    v_add_f32 v32, v32, v34
    v_add_f32 v33, v33, v35
    v_min3_f32 v36, v32, v33, v36
    v_cvt_pk_bf16_f32 v23, v32, v33
    v_cmp_gt_f32 vcc, 0x3a800000, v36
    s_cbranch_vccnz phi_16_fix
phi_16_done:
    v_cvt_pk_bf16_f32 v32, v128, v129
    v_cvt_pk_bf16_f32 v33, v130, v131
    v_mfma_f32_16x16x32_bf16 v[96:99], v[236:239], v[16:19], 0
    v_cvt_pk_bf16_f32 v34, v132, v133
    v_mfma_f32_16x16x32_bf16 v[60:63], v[236:239], v[20:23], 0
    v_cvt_pk_bf16_f32 v35, v134, v135
    v_cvt_pk_bf16_f32 v36, v136, v137
    v_cvt_pk_bf16_f32 v37, v138, v139
    v_mfma_f32_16x16x32_bf16 v[240:243], v[16:19], v[32:35], 0
    v_cvt_pk_bf16_f32 v38, v140, v141
    v_mfma_f32_16x16x32_bf16 v[244:247], v[20:23], v[32:35], 0
    v_cvt_pk_bf16_f32 v39, v142, v143
    s_nop 1
    v_mfma_f32_16x16x32_bf16 v[248:251], v[16:19], v[36:39], 0
    v_mfma_f32_16x16x32_bf16 v[252:255], v[20:23], v[36:39], 0
    v_cvt_pk_bf16_f32 v24, v112, v113
    v_lshlrev_b32 v48, 16, v24
    v_and_b32 v49, 0xffff0000, v24
    v_mul_f32 v50, s72, v48
    v_mul_f32 v51, s72, v49
    v_exp_f32 v50, v50 clamp
    v_exp_f32 v51, v51 clamp
    v_max_f32 v48, 0, v48
    v_max_f32 v49, 0, v49
    v_add_f32 v48, v48, v50
    v_add_f32 v49, v49, v51
    v_min_f32 v56, v48, v49
    v_cvt_pk_bf16_f32 v24, v48, v49
    v_cvt_pk_bf16_f32 v25, v114, v115
    v_lshlrev_b32 v48, 16, v25
    v_and_b32 v49, 0xffff0000, v25
    v_mul_f32 v50, s72, v48
    v_mul_f32 v51, s72, v49
    v_exp_f32 v50, v50 clamp
    v_exp_f32 v51, v51 clamp
    v_max_f32 v48, 0, v48
    v_max_f32 v49, 0, v49
    v_add_f32 v48, v48, v50
    v_add_f32 v49, v49, v51
    v_min3_f32 v56, v48, v49, v56
    v_cvt_pk_bf16_f32 v25, v48, v49
    v_cvt_pk_bf16_f32 v26, v116, v117
    v_lshlrev_b32 v48, 16, v26
    v_and_b32 v49, 0xffff0000, v26
    v_mul_f32 v50, s72, v48
    v_mul_f32 v51, s72, v49
    v_exp_f32 v50, v50 clamp
    v_exp_f32 v51, v51 clamp
    v_max_f32 v48, 0, v48
    v_max_f32 v49, 0, v49
    v_add_f32 v48, v48, v50
    v_add_f32 v49, v49, v51
    v_min3_f32 v56, v48, v49, v56
    v_cvt_pk_bf16_f32 v26, v48, v49
    v_cvt_pk_bf16_f32 v27, v118, v119
    v_lshlrev_b32 v48, 16, v27
    v_and_b32 v49, 0xffff0000, v27
    v_mul_f32 v50, s72, v48
    v_mul_f32 v51, s72, v49
    v_exp_f32 v50, v50 clamp
    v_exp_f32 v51, v51 clamp
    v_max_f32 v48, 0, v48
    v_max_f32 v49, 0, v49
    v_add_f32 v48, v48, v50
    v_add_f32 v49, v49, v51
    v_min3_f32 v56, v48, v49, v56
    v_cvt_pk_bf16_f32 v27, v48, v49
    v_cvt_pk_bf16_f32 v28, v120, v121
    v_lshlrev_b32 v48, 16, v28
    v_and_b32 v49, 0xffff0000, v28
    v_mul_f32 v50, s72, v48
    v_mul_f32 v51, s72, v49
    v_exp_f32 v50, v50 clamp
    v_exp_f32 v51, v51 clamp
    v_max_f32 v48, 0, v48
    v_max_f32 v49, 0, v49
    v_add_f32 v48, v48, v50
    v_add_f32 v49, v49, v51
    v_min3_f32 v56, v48, v49, v56
    v_cvt_pk_bf16_f32 v28, v48, v49
    v_cvt_pk_bf16_f32 v29, v122, v123
    v_lshlrev_b32 v48, 16, v29
    v_and_b32 v49, 0xffff0000, v29
    v_mul_f32 v50, s72, v48
    v_mul_f32 v51, s72, v49
    v_exp_f32 v50, v50 clamp
    v_exp_f32 v51, v51 clamp
    v_max_f32 v48, 0, v48
    v_max_f32 v49, 0, v49
    v_add_f32 v48, v48, v50
    v_add_f32 v49, v49, v51
    v_min3_f32 v56, v48, v49, v56
    v_cvt_pk_bf16_f32 v29, v48, v49
    v_cvt_pk_bf16_f32 v30, v124, v125
    v_lshlrev_b32 v48, 16, v30
    v_and_b32 v49, 0xffff0000, v30
    v_mul_f32 v50, s72, v48
    v_mul_f32 v51, s72, v49
    v_exp_f32 v50, v50 clamp
    v_exp_f32 v51, v51 clamp
    v_max_f32 v48, 0, v48
    v_max_f32 v49, 0, v49
    v_add_f32 v48, v48, v50
    v_add_f32 v49, v49, v51
    v_min3_f32 v56, v48, v49, v56
    v_cvt_pk_bf16_f32 v30, v48, v49
    v_cvt_pk_bf16_f32 v31, v126, v127
    v_lshlrev_b32 v48, 16, v31
    v_and_b32 v49, 0xffff0000, v31
    v_mul_f32 v50, s72, v48
    v_mul_f32 v51, s72, v49
    v_exp_f32 v50, v50 clamp
    v_exp_f32 v51, v51 clamp
    v_max_f32 v48, 0, v48
    v_max_f32 v49, 0, v49
    v_add_f32 v48, v48, v50
    v_add_f32 v49, v49, v51
    v_min3_f32 v56, v48, v49, v56
    v_cvt_pk_bf16_f32 v31, v48, v49
    v_cmp_gt_f32 vcc, 0x3a800000, v56
    s_cbranch_vccnz phi_17_fix
phi_17_done:
    v_cvt_pk_bf16_f32 v40, v144, v145
    v_cvt_pk_bf16_f32 v41, v146, v147
    v_mfma_f32_16x16x32_bf16 v[96:99], v[236:239], v[24:27], v[96:99]
    v_cvt_pk_bf16_f32 v42, v148, v149
    v_mfma_f32_16x16x32_bf16 v[60:63], v[236:239], v[28:31], v[60:63]
    v_cvt_pk_bf16_f32 v43, v150, v151
    v_cvt_pk_bf16_f32 v44, v152, v153
    v_cvt_pk_bf16_f32 v45, v154, v155
    v_mfma_f32_16x16x32_bf16 v[240:243], v[24:27], v[40:43], v[240:243]
    v_cvt_pk_bf16_f32 v46, v156, v157
    v_mfma_f32_16x16x32_bf16 v[244:247], v[28:31], v[40:43], v[244:247]
    v_cvt_pk_bf16_f32 v47, v158, v159
    s_nop 1
    v_mfma_f32_16x16x32_bf16 v[248:251], v[24:27], v[44:47], v[248:251]
    v_mfma_f32_16x16x32_bf16 v[252:255], v[28:31], v[44:47], v[252:255]
    s_cmp_eq_u32 s6, 0
    s_cbranch_scc0 C_ex1
    ds_write_b32 v227, v60 offset:4608
    s_nop 5
    ds_write_b128 v224, v[248:251] offset:32768
    ds_write_b128 v224, v[252:255] offset:33792
C_ex2:
    ds_write_b32 v229, v231 offset:4288
C_ps:
    ds_read_b32 v25, v230 offset:4288
    ds_read_b128 v[16:19], v225 offset:32768
    ds_read_b128 v[20:23], v225 offset:33792
    ds_read_b32 v24, v228 offset:4608
    s_waitcnt lgkmcnt(0)
    v_cmp_eq_u32 vcc, 0, v25
    s_cbranch_vccnz C_ps
    v_add_f32 v16, v16, v240
    v_add_f32 v17, v17, v241
    v_add_f32 v18, v18, v242
    v_add_f32 v19, v19, v243
    v_add_f32 v20, v20, v244
    v_add_f32 v21, v21, v245
    v_add_f32 v22, v22, v246
    v_add_f32 v23, v23, v247
    v_add_f32 v24, v24, v96
    v_cvt_pk_bf16_f32 v28, v16, v17
    v_cvt_pk_bf16_f32 v29, v18, v19
    v_cvt_pk_bf16_f32 v30, v20, v21
    v_cvt_pk_bf16_f32 v31, v22, v23
    buffer_store_dwordx4 v[28:31], v1, s[16:19], s43 offen sc0 sc1
    s_mov_b64 exec, 0xffff
    buffer_store_dword v24, v232, s[16:19], s43 offen offset:1024 sc0 sc1
    s_mov_b64 exec, 1
    buffer_atomic_or v233, v234, s[16:19], 0 offen
    s_mov_b64 exec, -1
    ds_read_b64_tr_b16 v[96:97], v10 offset:0
    ds_read_b64_tr_b16 v[98:99], v10 offset:512
    ds_read_b64_tr_b16 v[100:101], v11 offset:0
    ds_read_b64_tr_b16 v[102:103], v11 offset:512
    ds_read_b64_tr_b16 v[104:105], v10 offset:4096
    ds_read_b64_tr_b16 v[106:107], v10 offset:4608
    ds_read_b64_tr_b16 v[108:109], v11 offset:4096
    ds_read_b64_tr_b16 v[110:111], v11 offset:4608
    ds_read_b64_tr_b16 v[112:113], v6 offset:0
    ds_read_b64_tr_b16 v[114:115], v6 offset:512
    ds_read_b64_tr_b16 v[116:117], v7 offset:0
    ds_read_b64_tr_b16 v[118:119], v7 offset:512
    ds_read_b64_tr_b16 v[120:121], v6 offset:4096
    ds_read_b64_tr_b16 v[122:123], v6 offset:4608
    ds_read_b64_tr_b16 v[124:125], v7 offset:4096
    ds_read_b64_tr_b16 v[126:127], v7 offset:4608
    s_waitcnt lgkmcnt(12)
    v_mfma_f32_16x16x32_bf16 v[64:67], v[96:99], v[192:195], v[64:67]
    v_mfma_f32_16x16x32_bf16 v[72:75], v[96:99], v[196:199], v[72:75]
    v_mfma_f32_16x16x32_bf16 v[80:83], v[96:99], v[200:203], v[80:83]
    v_mfma_f32_16x16x32_bf16 v[88:91], v[96:99], v[204:207], v[88:91]
    v_mfma_f32_16x16x32_bf16 v[68:71], v[100:103], v[192:195], v[68:71]
    v_mfma_f32_16x16x32_bf16 v[76:79], v[100:103], v[196:199], v[76:79]
    v_mfma_f32_16x16x32_bf16 v[84:87], v[100:103], v[200:203], v[84:87]
    v_mfma_f32_16x16x32_bf16 v[92:95], v[100:103], v[204:207], v[92:95]
    s_waitcnt lgkmcnt(8)
    v_mfma_f32_16x16x32_bf16 v[64:67], v[104:107], v[160:163], v[64:67]
    v_mfma_f32_16x16x32_bf16 v[72:75], v[104:107], v[164:167], v[72:75]
    v_mfma_f32_16x16x32_bf16 v[80:83], v[104:107], v[168:171], v[80:83]
    v_mfma_f32_16x16x32_bf16 v[88:91], v[104:107], v[172:175], v[88:91]
    v_mfma_f32_16x16x32_bf16 v[68:71], v[108:111], v[160:163], v[68:71]
    v_mfma_f32_16x16x32_bf16 v[76:79], v[108:111], v[164:167], v[76:79]
    v_mfma_f32_16x16x32_bf16 v[84:87], v[108:111], v[168:171], v[84:87]
    v_mfma_f32_16x16x32_bf16 v[92:95], v[108:111], v[172:175], v[92:95]
    s_waitcnt lgkmcnt(4)
    v_mfma_f32_16x16x32_bf16 v[64:67], v[112:115], v[176:179], v[64:67]
    v_mfma_f32_16x16x32_bf16 v[72:75], v[112:115], v[180:183], v[72:75]
    v_mfma_f32_16x16x32_bf16 v[80:83], v[112:115], v[184:187], v[80:83]
    v_mfma_f32_16x16x32_bf16 v[88:91], v[112:115], v[188:191], v[88:91]
    v_mfma_f32_16x16x32_bf16 v[68:71], v[116:119], v[176:179], v[68:71]
    v_mfma_f32_16x16x32_bf16 v[76:79], v[116:119], v[180:183], v[76:79]
    v_mfma_f32_16x16x32_bf16 v[84:87], v[116:119], v[184:187], v[84:87]
    v_mfma_f32_16x16x32_bf16 v[92:95], v[116:119], v[188:191], v[92:95]
    s_waitcnt lgkmcnt(0)
    v_mfma_f32_16x16x32_bf16 v[64:67], v[120:123], v[208:211], v[64:67]
    v_mfma_f32_16x16x32_bf16 v[72:75], v[120:123], v[212:215], v[72:75]
    v_mfma_f32_16x16x32_bf16 v[80:83], v[120:123], v[216:219], v[80:83]
    v_mfma_f32_16x16x32_bf16 v[88:91], v[120:123], v[220:223], v[88:91]
    v_mfma_f32_16x16x32_bf16 v[68:71], v[124:127], v[208:211], v[68:71]
    v_mfma_f32_16x16x32_bf16 v[76:79], v[124:127], v[212:215], v[76:79]
    v_mfma_f32_16x16x32_bf16 v[84:87], v[124:127], v[216:219], v[84:87]
    v_mfma_f32_16x16x32_bf16 v[92:95], v[124:127], v[220:223], v[92:95]
    v_mov_b32 v254, v15
    v_mov_b32 v255, v13
    s_cmp_lg_u32 s3, 0
    s_cbranch_scc1 C_nh0
    s_lshr_b32 s64, s2, 2
    s_lshl_b32 s64, s64, 14
    s_add_u32 s64, s64, 5398528
    v_lshl_add_u32 v152, v2, 4, s64
    s_mov_b32 s64, 0
    buffer_load_dwordx4 v[156:159], v152, s[16:19], s64 offen offset:0 sc1
    s_mov_b32 s64, 0
    buffer_load_dwordx4 v[160:163], v152, s[16:19], s64 offen offset:1024 sc1
    s_mov_b32 s64, 0
    buffer_load_dwordx4 v[164:167], v152, s[16:19], s64 offen offset:2048 sc1
    s_mov_b32 s64, 0
    buffer_load_dwordx4 v[168:171], v152, s[16:19], s64 offen offset:3072 sc1
    s_mov_b32 s64, 4096
    buffer_load_dwordx4 v[172:175], v152, s[16:19], s64 offen offset:0 sc1
    s_mov_b32 s64, 4096
    buffer_load_dwordx4 v[176:179], v152, s[16:19], s64 offen offset:1024 sc1
    s_mov_b32 s64, 4096
    buffer_load_dwordx4 v[180:183], v152, s[16:19], s64 offen offset:2048 sc1
    s_mov_b32 s64, 4096
    buffer_load_dwordx4 v[184:187], v152, s[16:19], s64 offen offset:3072 sc1
    s_mov_b32 s64, 8192
    buffer_load_dwordx4 v[188:191], v152, s[16:19], s64 offen offset:0 sc1
    s_mov_b32 s64, 8192
    buffer_load_dwordx4 v[192:195], v152, s[16:19], s64 offen offset:1024 sc1
    s_mov_b32 s64, 8192
    buffer_load_dwordx4 v[196:199], v152, s[16:19], s64 offen offset:2048 sc1
    s_mov_b32 s64, 8192
    buffer_load_dwordx4 v[200:203], v152, s[16:19], s64 offen offset:3072 sc1
    s_mov_b32 s64, 12288
    buffer_load_dwordx4 v[204:207], v152, s[16:19], s64 offen offset:0 sc1
    s_mov_b32 s64, 12288
    buffer_load_dwordx4 v[208:211], v152, s[16:19], s64 offen offset:1024 sc1
    s_mov_b32 s64, 12288
    buffer_load_dwordx4 v[212:215], v152, s[16:19], s64 offen offset:2048 sc1
    s_mov_b32 s64, 12288
    buffer_load_dwordx4 v[216:219], v152, s[16:19], s64 offen offset:3072 sc1
C_nh0:
    s_and_b32 s64, s3, 3
    s_lshl_b32 s64, s64, 1
    s_lshr_b32 s65, s3, 2
    s_add_u32 s64, s64, s65
    s_lshl_b32 s64, s64, 4
    s_lshl_b32 s65, s4, 7
    s_add_u32 s64, s64, s65
    v_and_b32 v230, 15, v2
    v_add_u32 v230, s64, v230
    v_bfe_u32 v3, v2, 4, 1
    v_lshlrev_b32 v229, 5, v3
    v_lshrrev_b32 v3, 5, v2
    v_lshl_add_u32 v229, v3, 4, v229
    v_lshl_add_u32 v231, v230, 11, v229
    s_lshl_b32 s64, s5, 7
    v_add_u32 v231, s64, v231
    v_lshlrev_b32 v3, 2, v230
    v_add_u32 v3, 6709248, v3
    buffer_load_dwordx4 v[220:223], v231, s[8:11], 0 offen
    buffer_load_dwordx4 v[224:227], v231, s[8:11], 0 offen offset:64
    buffer_load_dword v228, v3, s[16:19], 0 offen sc1
    v_lshlrev_b32 v3, 4, v2
    s_lshl_b32 s64, s7, 11
    v_add_u32 v4, s64, v3
    v_lshrrev_b32 v5, 4, v2
    v_lshlrev_b32 v5, 4, v5
    s_lshl_b32 s64, s7, 6
    v_add_u32 v5, s64, v5
    v_mov_b32 v6, 4256
    ds_read_b32 v6, v6
    v_cvt_pk_bf16_f32 v32, v64, v65
    v_lshlrev_b32 v48, 16, v32
    v_and_b32 v49, 0xffff0000, v32
    v_mul_f32 v50, s72, v48
    v_mul_f32 v51, s72, v49
    v_exp_f32 v50, v50 clamp
    v_exp_f32 v51, v51 clamp
    v_max_f32 v48, 0, v48
    v_max_f32 v49, 0, v49
    v_add_f32 v48, v48, v50
    v_add_f32 v49, v49, v51
    v_min_f32 v56, v48, v49
    v_cvt_pk_bf16_f32 v32, v48, v49
    v_cvt_pk_bf16_f32 v33, v66, v67
    v_lshlrev_b32 v48, 16, v33
    v_and_b32 v49, 0xffff0000, v33
    v_mul_f32 v50, s72, v48
    v_mul_f32 v51, s72, v49
    v_exp_f32 v50, v50 clamp
    v_exp_f32 v51, v51 clamp
    v_max_f32 v48, 0, v48
    v_max_f32 v49, 0, v49
    v_add_f32 v48, v48, v50
    v_add_f32 v49, v49, v51
    v_min3_f32 v56, v48, v49, v56
    v_cvt_pk_bf16_f32 v33, v48, v49
    v_cvt_pk_bf16_f32 v34, v68, v69
    v_lshlrev_b32 v48, 16, v34
    v_and_b32 v49, 0xffff0000, v34
    v_mul_f32 v50, s72, v48
    v_mul_f32 v51, s72, v49
    v_exp_f32 v50, v50 clamp
    v_exp_f32 v51, v51 clamp
    v_max_f32 v48, 0, v48
    v_max_f32 v49, 0, v49
    v_add_f32 v48, v48, v50
    v_add_f32 v49, v49, v51
    v_min3_f32 v56, v48, v49, v56
    v_cvt_pk_bf16_f32 v34, v48, v49
    v_cvt_pk_bf16_f32 v35, v70, v71
    v_lshlrev_b32 v48, 16, v35
    v_and_b32 v49, 0xffff0000, v35
    v_mul_f32 v50, s72, v48
    v_mul_f32 v51, s72, v49
    v_exp_f32 v50, v50 clamp
    v_exp_f32 v51, v51 clamp
    v_max_f32 v48, 0, v48
    v_max_f32 v49, 0, v49
    v_add_f32 v48, v48, v50
    v_add_f32 v49, v49, v51
    v_min3_f32 v56, v48, v49, v56
    v_cvt_pk_bf16_f32 v35, v48, v49
    v_cvt_pk_bf16_f32 v36, v72, v73
    v_lshlrev_b32 v48, 16, v36
    v_and_b32 v49, 0xffff0000, v36
    v_mul_f32 v50, s72, v48
    v_mul_f32 v51, s72, v49
    v_exp_f32 v50, v50 clamp
    v_exp_f32 v51, v51 clamp
    v_max_f32 v48, 0, v48
    v_max_f32 v49, 0, v49
    v_add_f32 v48, v48, v50
    v_add_f32 v49, v49, v51
    v_min3_f32 v56, v48, v49, v56
    v_cvt_pk_bf16_f32 v36, v48, v49
    v_cvt_pk_bf16_f32 v37, v74, v75
    v_lshlrev_b32 v48, 16, v37
    v_and_b32 v49, 0xffff0000, v37
    v_mul_f32 v50, s72, v48
    v_mul_f32 v51, s72, v49
    v_exp_f32 v50, v50 clamp
    v_exp_f32 v51, v51 clamp
    v_max_f32 v48, 0, v48
    v_max_f32 v49, 0, v49
    v_add_f32 v48, v48, v50
    v_add_f32 v49, v49, v51
    v_min3_f32 v56, v48, v49, v56
    v_cvt_pk_bf16_f32 v37, v48, v49
    v_cvt_pk_bf16_f32 v38, v76, v77
    v_lshlrev_b32 v48, 16, v38
    v_and_b32 v49, 0xffff0000, v38
    v_mul_f32 v50, s72, v48
    v_mul_f32 v51, s72, v49
    v_exp_f32 v50, v50 clamp
    v_exp_f32 v51, v51 clamp
    v_max_f32 v48, 0, v48
    v_max_f32 v49, 0, v49
    v_add_f32 v48, v48, v50
    v_add_f32 v49, v49, v51
    v_min3_f32 v56, v48, v49, v56
    v_cvt_pk_bf16_f32 v38, v48, v49
    v_cvt_pk_bf16_f32 v39, v78, v79
    v_lshlrev_b32 v48, 16, v39
    v_and_b32 v49, 0xffff0000, v39
    v_mul_f32 v50, s72, v48
    v_mul_f32 v51, s72, v49
    v_exp_f32 v50, v50 clamp
    v_exp_f32 v51, v51 clamp
    v_max_f32 v48, 0, v48
    v_max_f32 v49, 0, v49
    v_add_f32 v48, v48, v50
    v_add_f32 v49, v49, v51
    v_min3_f32 v56, v48, v49, v56
    v_cvt_pk_bf16_f32 v39, v48, v49
    v_cmp_gt_f32 vcc, 0x3a800000, v56
    s_cbranch_vccnz phi_18_fix
phi_18_done:
    v_cvt_pk_bf16_f32 v40, v80, v81
    v_lshlrev_b32 v48, 16, v40
    v_and_b32 v49, 0xffff0000, v40
    v_mul_f32 v50, s72, v48
    v_mul_f32 v51, s72, v49
    v_exp_f32 v50, v50 clamp
    v_exp_f32 v51, v51 clamp
    v_max_f32 v48, 0, v48
    v_max_f32 v49, 0, v49
    v_add_f32 v48, v48, v50
    v_add_f32 v49, v49, v51
    v_min_f32 v56, v48, v49
    v_cvt_pk_bf16_f32 v40, v48, v49
    v_cvt_pk_bf16_f32 v41, v82, v83
    v_lshlrev_b32 v48, 16, v41
    v_and_b32 v49, 0xffff0000, v41
    v_mul_f32 v50, s72, v48
    v_mul_f32 v51, s72, v49
    v_exp_f32 v50, v50 clamp
    v_exp_f32 v51, v51 clamp
    v_max_f32 v48, 0, v48
    v_max_f32 v49, 0, v49
    v_add_f32 v48, v48, v50
    v_add_f32 v49, v49, v51
    v_min3_f32 v56, v48, v49, v56
    v_cvt_pk_bf16_f32 v41, v48, v49
    v_cvt_pk_bf16_f32 v42, v84, v85
    v_lshlrev_b32 v48, 16, v42
    v_and_b32 v49, 0xffff0000, v42
    v_mul_f32 v50, s72, v48
    v_mul_f32 v51, s72, v49
    v_exp_f32 v50, v50 clamp
    v_exp_f32 v51, v51 clamp
    v_max_f32 v48, 0, v48
    v_max_f32 v49, 0, v49
    v_add_f32 v48, v48, v50
    v_add_f32 v49, v49, v51
    v_min3_f32 v56, v48, v49, v56
    v_cvt_pk_bf16_f32 v42, v48, v49
    v_cvt_pk_bf16_f32 v43, v86, v87
    v_lshlrev_b32 v48, 16, v43
    v_and_b32 v49, 0xffff0000, v43
    v_mul_f32 v50, s72, v48
    v_mul_f32 v51, s72, v49
    v_exp_f32 v50, v50 clamp
    v_exp_f32 v51, v51 clamp
    v_max_f32 v48, 0, v48
    v_max_f32 v49, 0, v49
    v_add_f32 v48, v48, v50
    v_add_f32 v49, v49, v51
    v_min3_f32 v56, v48, v49, v56
    v_cvt_pk_bf16_f32 v43, v48, v49
    v_cvt_pk_bf16_f32 v44, v88, v89
    v_lshlrev_b32 v48, 16, v44
    v_and_b32 v49, 0xffff0000, v44
    v_mul_f32 v50, s72, v48
    v_mul_f32 v51, s72, v49
    v_exp_f32 v50, v50 clamp
    v_exp_f32 v51, v51 clamp
    v_max_f32 v48, 0, v48
    v_max_f32 v49, 0, v49
    v_add_f32 v48, v48, v50
    v_add_f32 v49, v49, v51
    v_min3_f32 v56, v48, v49, v56
    v_cvt_pk_bf16_f32 v44, v48, v49
    v_cvt_pk_bf16_f32 v45, v90, v91
    v_lshlrev_b32 v48, 16, v45
    v_and_b32 v49, 0xffff0000, v45
    v_mul_f32 v50, s72, v48
    v_mul_f32 v51, s72, v49
    v_exp_f32 v50, v50 clamp
    v_exp_f32 v51, v51 clamp
    v_max_f32 v48, 0, v48
    v_max_f32 v49, 0, v49
    v_add_f32 v48, v48, v50
    v_add_f32 v49, v49, v51
    v_min3_f32 v56, v48, v49, v56
    v_cvt_pk_bf16_f32 v45, v48, v49
    v_cvt_pk_bf16_f32 v46, v92, v93
    v_lshlrev_b32 v48, 16, v46
    v_and_b32 v49, 0xffff0000, v46
    v_mul_f32 v50, s72, v48
    v_mul_f32 v51, s72, v49
    v_exp_f32 v50, v50 clamp
    v_exp_f32 v51, v51 clamp
    v_max_f32 v48, 0, v48
    v_max_f32 v49, 0, v49
    v_add_f32 v48, v48, v50
    v_add_f32 v49, v49, v51
    v_min3_f32 v56, v48, v49, v56
    v_cvt_pk_bf16_f32 v46, v48, v49
    v_cvt_pk_bf16_f32 v47, v94, v95
    v_lshlrev_b32 v48, 16, v47
    v_and_b32 v49, 0xffff0000, v47
    v_mul_f32 v50, s72, v48
    v_mul_f32 v51, s72, v49
    v_exp_f32 v50, v50 clamp
    v_exp_f32 v51, v51 clamp
    v_max_f32 v48, 0, v48
    v_max_f32 v49, 0, v49
    v_add_f32 v48, v48, v50
    v_add_f32 v49, v49, v51
    v_min3_f32 v56, v48, v49, v56
    v_cvt_pk_bf16_f32 v47, v48, v49
    v_cmp_gt_f32 vcc, 0x3a800000, v56
    s_cbranch_vccnz phi_19_fix
phi_19_done:
    s_waitcnt lgkmcnt(0)
    v_readfirstlane_b32 s75, v6
    s_waitcnt vmcnt(0)
    v_sub_f32 v248, 1.0, v228
    v_cvt_pk_bf16_f32 v248, v248, v248
    v_lshlrev_b32 v248, 16, v248
    v_lshlrev_b32 v232, 16, v220
    v_and_b32 v233, 0xffff0000, v220
    v_mul_f32 v232, v232, v248
    v_mul_f32 v233, v233, v248
    v_cvt_pk_bf16_f32 v3, v232, v233
    v_lshlrev_b32 v232, 16, v3
    v_and_b32 v233, 0xffff0000, v3
    v_lshlrev_b32 v234, 16, v221
    v_and_b32 v235, 0xffff0000, v221
    v_mul_f32 v234, v234, v248
    v_mul_f32 v235, v235, v248
    v_cvt_pk_bf16_f32 v3, v234, v235
    v_lshlrev_b32 v234, 16, v3
    v_and_b32 v235, 0xffff0000, v3
    v_lshlrev_b32 v236, 16, v222
    v_and_b32 v237, 0xffff0000, v222
    v_mul_f32 v236, v236, v248
    v_mul_f32 v237, v237, v248
    v_cvt_pk_bf16_f32 v3, v236, v237
    v_lshlrev_b32 v236, 16, v3
    v_and_b32 v237, 0xffff0000, v3
    v_lshlrev_b32 v238, 16, v223
    v_and_b32 v239, 0xffff0000, v223
    v_mul_f32 v238, v238, v248
    v_mul_f32 v239, v239, v248
    v_cvt_pk_bf16_f32 v3, v238, v239
    v_lshlrev_b32 v238, 16, v3
    v_and_b32 v239, 0xffff0000, v3
    v_lshlrev_b32 v240, 16, v224
    v_and_b32 v241, 0xffff0000, v224
    v_mul_f32 v240, v240, v248
    v_mul_f32 v241, v241, v248
    v_cvt_pk_bf16_f32 v3, v240, v241
    v_lshlrev_b32 v240, 16, v3
    v_and_b32 v241, 0xffff0000, v3
    v_lshlrev_b32 v242, 16, v225
    v_and_b32 v243, 0xffff0000, v225
    v_mul_f32 v242, v242, v248
    v_mul_f32 v243, v243, v248
    v_cvt_pk_bf16_f32 v3, v242, v243
    v_lshlrev_b32 v242, 16, v3
    v_and_b32 v243, 0xffff0000, v3
    v_lshlrev_b32 v244, 16, v226
    v_and_b32 v245, 0xffff0000, v226
    v_mul_f32 v244, v244, v248
    v_mul_f32 v245, v245, v248
    v_cvt_pk_bf16_f32 v3, v244, v245
    v_lshlrev_b32 v244, 16, v3
    v_and_b32 v245, 0xffff0000, v3
    v_lshlrev_b32 v246, 16, v227
    v_and_b32 v247, 0xffff0000, v227
    v_mul_f32 v246, v246, v248
    v_mul_f32 v247, v247, v248
    v_cvt_pk_bf16_f32 v3, v246, v247
    v_lshlrev_b32 v246, 16, v3
    v_and_b32 v247, 0xffff0000, v3
    s_cmp_lg_u32 s3, 0
    s_cbranch_scc1 C_nh
    s_mov_b32 s65, 0
    v_lshrrev_b32 v155, 4, v2
H_hl:
    v_max3_u32 v153, v156, v157, v158
    v_max3_u32 v153, v159, v160, v153
    v_max3_u32 v153, v161, v162, v153
    v_max3_u32 v153, v163, v164, v153
    v_max3_u32 v153, v165, v166, v153
    v_max3_u32 v153, v167, v168, v153
    v_max3_u32 v153, v169, v170, v153
    v_max3_u32 v153, v171, v172, v153
    v_max3_u32 v153, v173, v174, v153
    v_max3_u32 v153, v175, v176, v153
    v_max3_u32 v153, v177, v178, v153
    v_max3_u32 v153, v179, v180, v153
    v_max3_u32 v153, v181, v182, v153
    v_max3_u32 v153, v183, v184, v153
    v_max3_u32 v153, v185, v186, v153
    v_max3_u32 v153, v187, v188, v153
    v_max3_u32 v153, v189, v190, v153
    v_max3_u32 v153, v191, v192, v153
    v_max3_u32 v153, v193, v194, v153
    v_max3_u32 v153, v195, v196, v153
    v_max3_u32 v153, v197, v198, v153
    v_max3_u32 v153, v199, v200, v153
    v_max3_u32 v153, v201, v202, v153
    v_max3_u32 v153, v203, v204, v153
    v_max3_u32 v153, v205, v206, v153
    v_max3_u32 v153, v207, v208, v153
    v_max3_u32 v153, v209, v210, v153
    v_max3_u32 v153, v211, v212, v153
    v_max3_u32 v153, v213, v214, v153
    v_max3_u32 v153, v215, v216, v153
    v_max3_u32 v153, v217, v218, v153
    v_max_u32 v153, v219, v153
    s_mov_b32 exec_lo, 0x3fff3fff
    s_mov_b32 exec_hi, 0x3fff3fff
    v_cmp_eq_u32 vcc, -1, v153
    s_mov_b64 exec, -1
    s_cbranch_vccz H_hok
    s_add_u32 s65, s65, 1
    s_cmp_ge_u32 s65, 100000
    s_cbranch_scc1 H_hok
    s_sleep 8
    s_lshr_b32 s64, s2, 2
    s_lshl_b32 s64, s64, 14
    s_add_u32 s64, s64, 5398528
    v_lshl_add_u32 v152, v2, 4, s64
    s_mov_b32 s64, 0
    buffer_load_dwordx4 v[156:159], v152, s[16:19], s64 offen offset:0 sc1
    s_mov_b32 s64, 0
    buffer_load_dwordx4 v[160:163], v152, s[16:19], s64 offen offset:1024 sc1
    s_mov_b32 s64, 0
    buffer_load_dwordx4 v[164:167], v152, s[16:19], s64 offen offset:2048 sc1
    s_mov_b32 s64, 0
    buffer_load_dwordx4 v[168:171], v152, s[16:19], s64 offen offset:3072 sc1
    s_mov_b32 s64, 4096
    buffer_load_dwordx4 v[172:175], v152, s[16:19], s64 offen offset:0 sc1
    s_mov_b32 s64, 4096
    buffer_load_dwordx4 v[176:179], v152, s[16:19], s64 offen offset:1024 sc1
    s_mov_b32 s64, 4096
    buffer_load_dwordx4 v[180:183], v152, s[16:19], s64 offen offset:2048 sc1
    s_mov_b32 s64, 4096
    buffer_load_dwordx4 v[184:187], v152, s[16:19], s64 offen offset:3072 sc1
    s_mov_b32 s64, 8192
    buffer_load_dwordx4 v[188:191], v152, s[16:19], s64 offen offset:0 sc1
    s_mov_b32 s64, 8192
    buffer_load_dwordx4 v[192:195], v152, s[16:19], s64 offen offset:1024 sc1
    s_mov_b32 s64, 8192
    buffer_load_dwordx4 v[196:199], v152, s[16:19], s64 offen offset:2048 sc1
    s_mov_b32 s64, 8192
    buffer_load_dwordx4 v[200:203], v152, s[16:19], s64 offen offset:3072 sc1
    s_mov_b32 s64, 12288
    buffer_load_dwordx4 v[204:207], v152, s[16:19], s64 offen offset:0 sc1
    s_mov_b32 s64, 12288
    buffer_load_dwordx4 v[208:211], v152, s[16:19], s64 offen offset:1024 sc1
    s_mov_b32 s64, 12288
    buffer_load_dwordx4 v[212:215], v152, s[16:19], s64 offen offset:2048 sc1
    s_mov_b32 s64, 12288
    buffer_load_dwordx4 v[216:219], v152, s[16:19], s64 offen offset:3072 sc1
    s_waitcnt vmcnt(0)
    s_branch H_hl
H_hok:
    v_add_f32 v156, v156, v160
    v_add_f32 v157, v157, v161
    v_add_f32 v158, v158, v162
    v_add_f32 v159, v159, v163
    v_add_f32 v156, v156, v164
    v_add_f32 v157, v157, v165
    v_add_f32 v158, v158, v166
    v_add_f32 v159, v159, v167
    v_add_f32 v156, v156, v168
    v_add_f32 v157, v157, v169
    v_add_f32 v158, v158, v170
    v_add_f32 v159, v159, v171
    v_add_f32 v156, v156, v172
    v_add_f32 v157, v157, v173
    v_add_f32 v158, v158, v174
    v_add_f32 v159, v159, v175
    v_add_f32 v156, v156, v176
    v_add_f32 v157, v157, v177
    v_add_f32 v158, v158, v178
    v_add_f32 v159, v159, v179
    v_add_f32 v156, v156, v180
    v_add_f32 v157, v157, v181
    v_add_f32 v158, v158, v182
    v_add_f32 v159, v159, v183
    v_add_f32 v156, v156, v184
    v_add_f32 v157, v157, v185
    v_add_f32 v158, v158, v186
    v_add_f32 v159, v159, v187
    v_add_f32 v188, v188, v192
    v_add_f32 v189, v189, v193
    v_add_f32 v190, v190, v194
    v_add_f32 v191, v191, v195
    v_add_f32 v188, v188, v196
    v_add_f32 v189, v189, v197
    v_add_f32 v190, v190, v198
    v_add_f32 v191, v191, v199
    v_add_f32 v188, v188, v200
    v_add_f32 v189, v189, v201
    v_add_f32 v190, v190, v202
    v_add_f32 v191, v191, v203
    v_add_f32 v188, v188, v204
    v_add_f32 v189, v189, v205
    v_add_f32 v190, v190, v206
    v_add_f32 v191, v191, v207
    v_add_f32 v188, v188, v208
    v_add_f32 v189, v189, v209
    v_add_f32 v190, v190, v210
    v_add_f32 v191, v191, v211
    v_add_f32 v188, v188, v212
    v_add_f32 v189, v189, v213
    v_add_f32 v190, v190, v214
    v_add_f32 v191, v191, v215
    v_add_f32 v188, v188, v216
    v_add_f32 v189, v189, v217
    v_add_f32 v190, v190, v218
    v_add_f32 v191, v191, v219
    s_nop 1
    v_permlane16_swap_b32 v156, v188
    v_permlane16_swap_b32 v157, v189
    v_permlane16_swap_b32 v158, v190
    v_permlane16_swap_b32 v159, v191
    v_add_f32 v156, v156, v188
    v_add_f32 v157, v157, v189
    v_add_f32 v158, v158, v190
    v_add_f32 v159, v159, v191
    s_nop 1
    v_permlane32_swap_b32 v156, v158
    v_permlane32_swap_b32 v157, v159
    v_add_f32 v156, v156, v158
    v_add_f32 v157, v157, v159
    s_nop 1
    v_permlane16_swap_b32 v156, v157
    v_cvt_pk_bf16_f32 v158, v156, v157
    v_lshlrev_b32 v156, 16, v158
    v_and_b32 v157, 0xffff0000, v158
    v_mul_f32 v158, s72, v156
    v_exp_f32 v158, -v158
    v_and_b32 v154, 15, v2
    v_add_f32 v158, 1.0, v158
    v_rcp_f32 v158, v158
    v_lshl_add_u32 v154, v154, 2, v155
    v_mul_f32 v158, v158, v156
    v_cvt_pk_bf16_f32 v158, v158, v158
    v_lshlrev_b32 v158, 16, v158
    v_mul_f32 v158, v158, v157
    v_cvt_pk_bf16_f32 v158, v158, v158
    v_lshlrev_b32 v158, 16, v158
    v_lshlrev_b32 v154, 2, v154
    ds_write_b32 v154, v158 offset:4352
    s_waitcnt lgkmcnt(0)
C_nh:
    v_lshlrev_b32 v3, 4, v2
    s_barrier
    ds_read_b128 v[24:27], v5 offset:4096
    ds_read_b128 v[16:19], v4 offset:0
    ds_read_b128 v[20:23], v4 offset:1024
    s_waitcnt lgkmcnt(2)
    v_mfma_f32_16x16x32_bf16 v[96:99], v[24:27], v[32:35], 0
    v_mfma_f32_16x16x32_bf16 v[100:103], v[24:27], v[36:39], 0
    v_mfma_f32_16x16x32_bf16 v[104:107], v[24:27], v[40:43], 0
    v_mfma_f32_16x16x32_bf16 v[108:111], v[24:27], v[44:47], 0
    s_waitcnt lgkmcnt(0)
    v_mfma_f32_16x16x32_bf16 v[64:67], v[16:19], v[32:35], 0
    v_mfma_f32_16x16x32_bf16 v[68:71], v[20:23], v[32:35], 0
    v_mfma_f32_16x16x32_bf16 v[72:75], v[16:19], v[36:39], 0
    v_mfma_f32_16x16x32_bf16 v[76:79], v[20:23], v[36:39], 0
    v_mfma_f32_16x16x32_bf16 v[80:83], v[16:19], v[40:43], 0
    v_mfma_f32_16x16x32_bf16 v[84:87], v[20:23], v[40:43], 0
    v_mfma_f32_16x16x32_bf16 v[88:91], v[16:19], v[44:47], 0
    v_mfma_f32_16x16x32_bf16 v[92:95], v[20:23], v[44:47], 0
    v_cvt_pk_bf16_f32 v48, v96, v96
    v_cvt_pk_bf16_f32 v49, v100, v100
    v_cvt_pk_bf16_f32 v50, v104, v104
    v_cvt_pk_bf16_f32 v51, v108, v108
    v_lshlrev_b32 v48, 16, v48
    v_lshlrev_b32 v49, 16, v49
    v_lshlrev_b32 v50, 16, v50
    v_lshlrev_b32 v51, 16, v51
    v_add_f32 v48, s73, v48
    v_add_f32 v49, s73, v49
    v_add_f32 v50, s73, v50
    v_add_f32 v51, s73, v51
    v_cvt_pk_bf16_f32 v48, v48, v48
    v_cvt_pk_bf16_f32 v49, v49, v49
    v_cvt_pk_bf16_f32 v50, v50, v50
    v_cvt_pk_bf16_f32 v51, v51, v51
    v_lshlrev_b32 v48, 16, v48
    v_lshlrev_b32 v49, 16, v49
    v_lshlrev_b32 v50, 16, v50
    v_lshlrev_b32 v51, 16, v51
    v_rcp_f32 v48, v48
    v_rcp_f32 v49, v49
    v_rcp_f32 v50, v50
    v_rcp_f32 v51, v51
    s_nop 0
    v_mul_f32 v64, v64, v48
    v_mul_f32 v65, v65, v48
    v_cvt_pk_bf16_f32 v128, v64, v65
    v_mul_f32 v66, v66, v48
    v_mul_f32 v67, v67, v48
    v_cvt_pk_bf16_f32 v129, v66, v67
    v_mul_f32 v68, v68, v48
    v_mul_f32 v69, v69, v48
    v_cvt_pk_bf16_f32 v130, v68, v69
    v_mul_f32 v70, v70, v48
    v_mul_f32 v71, v71, v48
    v_cvt_pk_bf16_f32 v131, v70, v71
    buffer_store_dwordx4 v[128:131], v1, s[16:19], s42 offen offset:0 sc0 sc1
    v_mul_f32 v72, v72, v49
    v_mul_f32 v73, v73, v49
    v_cvt_pk_bf16_f32 v132, v72, v73
    v_mul_f32 v74, v74, v49
    v_mul_f32 v75, v75, v49
    v_cvt_pk_bf16_f32 v133, v74, v75
    v_mul_f32 v76, v76, v49
    v_mul_f32 v77, v77, v49
    v_cvt_pk_bf16_f32 v134, v76, v77
    v_mul_f32 v78, v78, v49
    v_mul_f32 v79, v79, v49
    v_cvt_pk_bf16_f32 v135, v78, v79
    buffer_store_dwordx4 v[132:135], v1, s[16:19], s42 offen offset:1024 sc0 sc1
    s_add_u32 s42, s42, 65536
    v_mul_f32 v80, v80, v50
    v_mul_f32 v81, v81, v50
    v_cvt_pk_bf16_f32 v136, v80, v81
    v_mul_f32 v82, v82, v50
    v_mul_f32 v83, v83, v50
    v_cvt_pk_bf16_f32 v137, v82, v83
    v_mul_f32 v84, v84, v50
    v_mul_f32 v85, v85, v50
    v_cvt_pk_bf16_f32 v138, v84, v85
    v_mul_f32 v86, v86, v50
    v_mul_f32 v87, v87, v50
    v_cvt_pk_bf16_f32 v139, v86, v87
    buffer_store_dwordx4 v[136:139], v1, s[16:19], s42 offen offset:0 sc0 sc1
    v_mul_f32 v88, v88, v51
    v_mul_f32 v89, v89, v51
    v_cvt_pk_bf16_f32 v140, v88, v89
    v_mul_f32 v90, v90, v51
    v_mul_f32 v91, v91, v51
    v_cvt_pk_bf16_f32 v141, v90, v91
    v_mul_f32 v92, v92, v51
    v_mul_f32 v93, v93, v51
    v_cvt_pk_bf16_f32 v142, v92, v93
    v_mul_f32 v94, v94, v51
    v_mul_f32 v95, v95, v51
    v_cvt_pk_bf16_f32 v143, v94, v95
    buffer_store_dwordx4 v[140:143], v1, s[16:19], s42 offen offset:1024 sc0 sc1
    s_lshl_b32 s64, s4, 3
    s_add_u32 s64, s64, s3
    s_lshl_b32 s64, s64, 7
    s_add_u32 s64, s64, 5382144
    v_mov_b32 v14, s64
    s_mov_b64 exec, 1
    v_mov_b32 v15, 0
    buffer_atomic_or v15, v14, s[16:19], 0 offen sc0
    s_mov_b64 exec, -1
P2_start:
    s_and_b32 s6, s3, 3
    s_lshr_b32 s7, s3, 2
    s_mov_b32 s20, s58
    s_mov_b32 s21, s59
    s_mov_b32 s22, 0x400000
    s_mov_b32 s23, 0x00020000
    s_and_b32 s67, s75, 0x7ff
    s_sub_u32 s67, 2047, s67
    s_lshl_b32 s64, s4, 2
    s_add_u32 s64, s64, s6
    s_lshl_b32 s64, s64, 16
    s_lshl_b32 s65, s7, 15
    s_add_u32 s64, s64, s65
    s_lshl_b32 s65, s7, 10
    s_add_u32 s66, s64, s65
    s_xor_b32 s64, s66, 1024
    v_lshlrev_b32 v12, 4, v2
    v_add_u32 v4, s66, v12
    v_add_u32 v12, s64, v12
    v_lshrrev_b32 v10, 4, v2
    v_bfe_u32 v11, v2, 2, 2
    v_lshl_add_u32 v10, v10, 2, v11
    v_bfe_u32 v13, v10, 1, 2
    v_lshlrev_b32 v10, 7, v10
    v_lshl_add_u32 v10, v13, 5, v10
    v_and_b32 v13, 3, v2
    v_lshl_add_u32 v5, v13, 3, v10
    v_xor_b32 v6, 32, v5
    v_xor_b32 v1, 64, v5
    v_xor_b32 v3, 96, v5
    s_and_b32 s74, s5, 7
    s_lshl_b32 s74, s74, 1
    s_cmp_eq_u32 s7, 0
    s_mov_b32 s64, 147456
    s_cselect_b32 s64, 131072, s64
    s_sub_u32 m0, 16, s74
    s_and_b32 m0, m0, 15
    v_writelane_b32 v7, s64, m0
    s_cmp_eq_u32 s7, 0
    s_mov_b32 s64, 155648
    s_cselect_b32 s64, 139264, s64
    s_sub_u32 m0, 18, s74
    s_and_b32 m0, m0, 15
    v_writelane_b32 v7, s64, m0
    s_cmp_eq_u32 s7, 0
    s_mov_b32 s64, 81920
    s_cselect_b32 s64, 73728, s64
    s_sub_u32 m0, 20, s74
    s_and_b32 m0, m0, 15
    v_writelane_b32 v7, s64, m0
    s_cmp_eq_u32 s7, 0
    s_mov_b32 s64, 122880
    s_cselect_b32 s64, 114688, s64
    s_sub_u32 m0, 22, s74
    s_and_b32 m0, m0, 15
    v_writelane_b32 v7, s64, m0
    s_cmp_eq_u32 s7, 0
    s_mov_b32 s64, 49152
    s_cselect_b32 s64, 40960, s64
    s_sub_u32 m0, 24, s74
    s_and_b32 m0, m0, 15
    v_writelane_b32 v7, s64, m0
    s_cmp_eq_u32 s7, 0
    s_mov_b32 s64, 57344
    s_cselect_b32 s64, 8192, s64
    s_sub_u32 m0, 26, s74
    s_and_b32 m0, m0, 15
    v_writelane_b32 v7, s64, m0
    s_cmp_eq_u32 s7, 0
    s_mov_b32 s64, 65536
    s_cselect_b32 s64, 16384, s64
    s_sub_u32 m0, 28, s74
    s_and_b32 m0, m0, 15
    v_writelane_b32 v7, s64, m0
    s_cmp_eq_u32 s7, 0
    s_mov_b32 s64, 90112
    s_cselect_b32 s64, 98304, s64
    s_sub_u32 m0, 30, s74
    s_and_b32 m0, m0, 15
    v_writelane_b32 v7, s64, m0
    s_cmp_eq_u32 s7, 0
    v_mov_b32 v16, 0
    v_mov_b32 v17, 0
    v_mov_b32 v18, 0
    v_mov_b32 v19, 0
    v_mov_b32 v20, 0
    v_mov_b32 v21, 0
    v_mov_b32 v22, 0
    v_mov_b32 v23, 0
    v_mov_b32 v24, 0
    v_mov_b32 v25, 0
    v_mov_b32 v26, 0
    v_mov_b32 v27, 0
    v_mov_b32 v28, 0
    v_mov_b32 v29, 0
    v_mov_b32 v30, 0
    v_mov_b32 v31, 0
    v_mov_b32 v32, 0
    v_mov_b32 v33, 0
    v_mov_b32 v34, 0
    v_mov_b32 v35, 0
    v_mov_b32 v36, 0
    v_mov_b32 v37, 0
    v_mov_b32 v38, 0
    v_mov_b32 v39, 0
    v_mov_b32 v40, 0
    v_mov_b32 v41, 0
    v_mov_b32 v42, 0
    v_mov_b32 v43, 0
    v_mov_b32 v44, 0
    v_mov_b32 v45, 0
    v_mov_b32 v46, 0
    v_mov_b32 v47, 0
    v_mov_b32 v209, 0
    v_mov_b32 v215, 0
    s_lshr_b32 s46, s67, 7
    s_xor_b32 s46, s46, s4
    s_or_b32 s46, s46, s7
    s_mov_b32 s47, 0
    s_cbranch_scc0 P2_ys
P2_ysd:
    s_mov_b32 s66, 0x5555
    s_mov_b32 s65, 0
    s_cmp_lt_u32 s3, 4
    s_cbranch_scc0 D_wait
    s_waitcnt vmcnt(1)
    s_mov_b64 exec, 3
    buffer_atomic_or v255, v254, s[16:19], 0 offen
    s_mov_b64 exec, -1
    s_waitcnt vmcnt(1)
    s_branch D_got
D_wait:
    s_waitcnt vmcnt(0)
D_got:
    v_readfirstlane_b32 s68, v15
    s_mul_i32 s68, s68, 0x10001
    s_lshr_b32 s68, s68, s74
    s_lshr_b32 s64, s68, 1
    s_and_b32 s68, s68, s64
    s_and_b32 s68, s68, s66
    s_cbranch_scc1 D_go
    s_add_u32 s65, s65, 1
    s_cmp_ge_u32 s65, 40000
    s_cbranch_scc1 D_end
    s_sleep 1
    s_mov_b64 exec, 1
    v_mov_b32 v15, 0
    buffer_atomic_or v15, v14, s[16:19], 0 offen sc0
    s_mov_b64 exec, -1
    s_branch D_wait
D_go:
    s_andn2_b32 s66, s66, s68
    s_bcnt1_i32_b32 s70, s68
    s_or_b32 s64, s46, s66
    s_cbranch_scc0 P2_yl
P2_nyl:
    s_cmp_gt_u32 s70, 4
    s_cbranch_scc1 D_t58
    s_cmp_gt_u32 s70, 2
    s_cbranch_scc1 D_t34
    s_cmp_eq_u32 s70, 2
    s_cbranch_scc1 D_e2
D_e1:
    s_ff1_i32_b32 s64, s68
    s_bitset0_b32 s68, s64
    v_readlane_b32 s32, v7, s64
    s_add_u32 s69, s64, s74
    s_and_b32 s69, s69, 15
    s_lshl_b32 s69, s69, 11
    buffer_load_dwordx4 v[80:83], v4, s[16:19], s69 offen sc1
    buffer_load_dwordx4 v[84:87], v12, s[16:19], s69 offen sc1
    s_add_u32 s69, s69, 2048
    buffer_load_dwordx4 v[88:91], v4, s[16:19], s69 offen sc1
    buffer_load_dwordx4 v[92:95], v12, s[16:19], s69 offen sc1
    s_mov_b64 exec, 1
    v_mov_b32 v15, 0
    buffer_atomic_or v15, v14, s[16:19], 0 offen sc0
    s_mov_b64 exec, -1
    v_add_u32 v8, s32, v5
    ds_read_b64_tr_b16 v[48:49], v8 offset:0
    ds_read_b64_tr_b16 v[50:51], v8 offset:2048
    v_add_u32 v9, s32, v6
    ds_read_b64_tr_b16 v[52:53], v9 offset:0
    ds_read_b64_tr_b16 v[54:55], v9 offset:2048
    v_add_u32 v10, s32, v1
    ds_read_b64_tr_b16 v[56:57], v10 offset:0
    ds_read_b64_tr_b16 v[58:59], v10 offset:2048
    v_add_u32 v11, s32, v3
    ds_read_b64_tr_b16 v[60:61], v11 offset:0
    ds_read_b64_tr_b16 v[62:63], v11 offset:2048
    s_branch D_p0
D_e2:
    s_ff1_i32_b32 s64, s68
    s_bitset0_b32 s68, s64
    v_readlane_b32 s33, v7, s64
    s_add_u32 s69, s64, s74
    s_and_b32 s69, s69, 15
    s_lshl_b32 s69, s69, 11
    buffer_load_dwordx4 v[96:99], v4, s[16:19], s69 offen sc1
    buffer_load_dwordx4 v[100:103], v12, s[16:19], s69 offen sc1
    s_add_u32 s69, s69, 2048
    buffer_load_dwordx4 v[104:107], v4, s[16:19], s69 offen sc1
    buffer_load_dwordx4 v[108:111], v12, s[16:19], s69 offen sc1
    s_ff1_i32_b32 s64, s68
    s_bitset0_b32 s68, s64
    v_readlane_b32 s32, v7, s64
    s_add_u32 s69, s64, s74
    s_and_b32 s69, s69, 15
    s_lshl_b32 s69, s69, 11
    buffer_load_dwordx4 v[80:83], v4, s[16:19], s69 offen sc1
    buffer_load_dwordx4 v[84:87], v12, s[16:19], s69 offen sc1
    s_add_u32 s69, s69, 2048
    buffer_load_dwordx4 v[88:91], v4, s[16:19], s69 offen sc1
    buffer_load_dwordx4 v[92:95], v12, s[16:19], s69 offen sc1
    s_mov_b64 exec, 1
    v_mov_b32 v15, 0
    buffer_atomic_or v15, v14, s[16:19], 0 offen sc0
    s_mov_b64 exec, -1
    v_add_u32 v8, s33, v5
    ds_read_b64_tr_b16 v[48:49], v8 offset:0
    ds_read_b64_tr_b16 v[50:51], v8 offset:2048
    v_add_u32 v9, s33, v6
    ds_read_b64_tr_b16 v[52:53], v9 offset:0
    ds_read_b64_tr_b16 v[54:55], v9 offset:2048
    v_add_u32 v10, s33, v1
    ds_read_b64_tr_b16 v[56:57], v10 offset:0
    ds_read_b64_tr_b16 v[58:59], v10 offset:2048
    v_add_u32 v11, s33, v3
    ds_read_b64_tr_b16 v[60:61], v11 offset:0
    ds_read_b64_tr_b16 v[62:63], v11 offset:2048
    s_branch D_p1
D_t34:
    s_cmp_eq_u32 s70, 4
    s_cbranch_scc1 D_e4
D_e3:
    s_ff1_i32_b32 s64, s68
    s_bitset0_b32 s68, s64
    v_readlane_b32 s34, v7, s64
    s_add_u32 s69, s64, s74
    s_and_b32 s69, s69, 15
    s_lshl_b32 s69, s69, 11
    buffer_load_dwordx4 v[112:115], v4, s[16:19], s69 offen sc1
    buffer_load_dwordx4 v[116:119], v12, s[16:19], s69 offen sc1
    s_add_u32 s69, s69, 2048
    buffer_load_dwordx4 v[120:123], v4, s[16:19], s69 offen sc1
    buffer_load_dwordx4 v[124:127], v12, s[16:19], s69 offen sc1
    s_ff1_i32_b32 s64, s68
    s_bitset0_b32 s68, s64
    v_readlane_b32 s33, v7, s64
    s_add_u32 s69, s64, s74
    s_and_b32 s69, s69, 15
    s_lshl_b32 s69, s69, 11
    buffer_load_dwordx4 v[96:99], v4, s[16:19], s69 offen sc1
    buffer_load_dwordx4 v[100:103], v12, s[16:19], s69 offen sc1
    s_add_u32 s69, s69, 2048
    buffer_load_dwordx4 v[104:107], v4, s[16:19], s69 offen sc1
    buffer_load_dwordx4 v[108:111], v12, s[16:19], s69 offen sc1
    v_add_u32 v8, s34, v5
    ds_read_b64_tr_b16 v[48:49], v8 offset:0
    ds_read_b64_tr_b16 v[50:51], v8 offset:2048
    v_add_u32 v9, s34, v6
    ds_read_b64_tr_b16 v[52:53], v9 offset:0
    ds_read_b64_tr_b16 v[54:55], v9 offset:2048
    v_add_u32 v10, s34, v1
    ds_read_b64_tr_b16 v[56:57], v10 offset:0
    ds_read_b64_tr_b16 v[58:59], v10 offset:2048
    v_add_u32 v11, s34, v3
    ds_read_b64_tr_b16 v[60:61], v11 offset:0
    ds_read_b64_tr_b16 v[62:63], v11 offset:2048
    s_branch D_p2
D_e4:
    s_ff1_i32_b32 s64, s68
    s_bitset0_b32 s68, s64
    v_readlane_b32 s35, v7, s64
    s_add_u32 s69, s64, s74
    s_and_b32 s69, s69, 15
    s_lshl_b32 s69, s69, 11
    buffer_load_dwordx4 v[128:131], v4, s[16:19], s69 offen sc1
    buffer_load_dwordx4 v[132:135], v12, s[16:19], s69 offen sc1
    s_add_u32 s69, s69, 2048
    buffer_load_dwordx4 v[136:139], v4, s[16:19], s69 offen sc1
    buffer_load_dwordx4 v[140:143], v12, s[16:19], s69 offen sc1
    s_ff1_i32_b32 s64, s68
    s_bitset0_b32 s68, s64
    v_readlane_b32 s34, v7, s64
    s_add_u32 s69, s64, s74
    s_and_b32 s69, s69, 15
    s_lshl_b32 s69, s69, 11
    buffer_load_dwordx4 v[112:115], v4, s[16:19], s69 offen sc1
    buffer_load_dwordx4 v[116:119], v12, s[16:19], s69 offen sc1
    s_add_u32 s69, s69, 2048
    buffer_load_dwordx4 v[120:123], v4, s[16:19], s69 offen sc1
    buffer_load_dwordx4 v[124:127], v12, s[16:19], s69 offen sc1
    v_add_u32 v8, s35, v5
    ds_read_b64_tr_b16 v[48:49], v8 offset:0
    ds_read_b64_tr_b16 v[50:51], v8 offset:2048
    v_add_u32 v9, s35, v6
    ds_read_b64_tr_b16 v[52:53], v9 offset:0
    ds_read_b64_tr_b16 v[54:55], v9 offset:2048
    v_add_u32 v10, s35, v1
    ds_read_b64_tr_b16 v[56:57], v10 offset:0
    ds_read_b64_tr_b16 v[58:59], v10 offset:2048
    v_add_u32 v11, s35, v3
    ds_read_b64_tr_b16 v[60:61], v11 offset:0
    ds_read_b64_tr_b16 v[62:63], v11 offset:2048
    s_branch D_p3
D_t58:
    s_cmp_gt_u32 s70, 6
    s_cbranch_scc1 D_t78
    s_cmp_eq_u32 s70, 6
    s_cbranch_scc1 D_e6
D_e5:
    s_ff1_i32_b32 s64, s68
    s_bitset0_b32 s68, s64
    v_readlane_b32 s36, v7, s64
    s_add_u32 s69, s64, s74
    s_and_b32 s69, s69, 15
    s_lshl_b32 s69, s69, 11
    buffer_load_dwordx4 v[144:147], v4, s[16:19], s69 offen sc1
    buffer_load_dwordx4 v[148:151], v12, s[16:19], s69 offen sc1
    s_add_u32 s69, s69, 2048
    buffer_load_dwordx4 v[152:155], v4, s[16:19], s69 offen sc1
    buffer_load_dwordx4 v[156:159], v12, s[16:19], s69 offen sc1
    s_ff1_i32_b32 s64, s68
    s_bitset0_b32 s68, s64
    v_readlane_b32 s35, v7, s64
    s_add_u32 s69, s64, s74
    s_and_b32 s69, s69, 15
    s_lshl_b32 s69, s69, 11
    buffer_load_dwordx4 v[128:131], v4, s[16:19], s69 offen sc1
    buffer_load_dwordx4 v[132:135], v12, s[16:19], s69 offen sc1
    s_add_u32 s69, s69, 2048
    buffer_load_dwordx4 v[136:139], v4, s[16:19], s69 offen sc1
    buffer_load_dwordx4 v[140:143], v12, s[16:19], s69 offen sc1
    v_add_u32 v8, s36, v5
    ds_read_b64_tr_b16 v[48:49], v8 offset:0
    ds_read_b64_tr_b16 v[50:51], v8 offset:2048
    v_add_u32 v9, s36, v6
    ds_read_b64_tr_b16 v[52:53], v9 offset:0
    ds_read_b64_tr_b16 v[54:55], v9 offset:2048
    v_add_u32 v10, s36, v1
    ds_read_b64_tr_b16 v[56:57], v10 offset:0
    ds_read_b64_tr_b16 v[58:59], v10 offset:2048
    v_add_u32 v11, s36, v3
    ds_read_b64_tr_b16 v[60:61], v11 offset:0
    ds_read_b64_tr_b16 v[62:63], v11 offset:2048
    s_branch D_p4
D_e6:
    s_ff1_i32_b32 s64, s68
    s_bitset0_b32 s68, s64
    v_readlane_b32 s37, v7, s64
    s_add_u32 s69, s64, s74
    s_and_b32 s69, s69, 15
    s_lshl_b32 s69, s69, 11
    buffer_load_dwordx4 v[160:163], v4, s[16:19], s69 offen sc1
    buffer_load_dwordx4 v[164:167], v12, s[16:19], s69 offen sc1
    s_add_u32 s69, s69, 2048
    buffer_load_dwordx4 v[168:171], v4, s[16:19], s69 offen sc1
    buffer_load_dwordx4 v[172:175], v12, s[16:19], s69 offen sc1
    s_ff1_i32_b32 s64, s68
    s_bitset0_b32 s68, s64
    v_readlane_b32 s36, v7, s64
    s_add_u32 s69, s64, s74
    s_and_b32 s69, s69, 15
    s_lshl_b32 s69, s69, 11
    buffer_load_dwordx4 v[144:147], v4, s[16:19], s69 offen sc1
    buffer_load_dwordx4 v[148:151], v12, s[16:19], s69 offen sc1
    s_add_u32 s69, s69, 2048
    buffer_load_dwordx4 v[152:155], v4, s[16:19], s69 offen sc1
    buffer_load_dwordx4 v[156:159], v12, s[16:19], s69 offen sc1
    v_add_u32 v8, s37, v5
    ds_read_b64_tr_b16 v[48:49], v8 offset:0
    ds_read_b64_tr_b16 v[50:51], v8 offset:2048
    v_add_u32 v9, s37, v6
    ds_read_b64_tr_b16 v[52:53], v9 offset:0
    ds_read_b64_tr_b16 v[54:55], v9 offset:2048
    v_add_u32 v10, s37, v1
    ds_read_b64_tr_b16 v[56:57], v10 offset:0
    ds_read_b64_tr_b16 v[58:59], v10 offset:2048
    v_add_u32 v11, s37, v3
    ds_read_b64_tr_b16 v[60:61], v11 offset:0
    ds_read_b64_tr_b16 v[62:63], v11 offset:2048
    s_branch D_p5
D_t78:
    s_cmp_eq_u32 s70, 8
    s_cbranch_scc1 D_e8
D_e7:
    s_ff1_i32_b32 s64, s68
    s_bitset0_b32 s68, s64
    v_readlane_b32 s38, v7, s64
    s_add_u32 s69, s64, s74
    s_and_b32 s69, s69, 15
    s_lshl_b32 s69, s69, 11
    buffer_load_dwordx4 v[176:179], v4, s[16:19], s69 offen sc1
    buffer_load_dwordx4 v[180:183], v12, s[16:19], s69 offen sc1
    s_add_u32 s69, s69, 2048
    buffer_load_dwordx4 v[184:187], v4, s[16:19], s69 offen sc1
    buffer_load_dwordx4 v[188:191], v12, s[16:19], s69 offen sc1
    s_ff1_i32_b32 s64, s68
    s_bitset0_b32 s68, s64
    v_readlane_b32 s37, v7, s64
    s_add_u32 s69, s64, s74
    s_and_b32 s69, s69, 15
    s_lshl_b32 s69, s69, 11
    buffer_load_dwordx4 v[160:163], v4, s[16:19], s69 offen sc1
    buffer_load_dwordx4 v[164:167], v12, s[16:19], s69 offen sc1
    s_add_u32 s69, s69, 2048
    buffer_load_dwordx4 v[168:171], v4, s[16:19], s69 offen sc1
    buffer_load_dwordx4 v[172:175], v12, s[16:19], s69 offen sc1
    v_add_u32 v8, s38, v5
    ds_read_b64_tr_b16 v[48:49], v8 offset:0
    ds_read_b64_tr_b16 v[50:51], v8 offset:2048
    v_add_u32 v9, s38, v6
    ds_read_b64_tr_b16 v[52:53], v9 offset:0
    ds_read_b64_tr_b16 v[54:55], v9 offset:2048
    v_add_u32 v10, s38, v1
    ds_read_b64_tr_b16 v[56:57], v10 offset:0
    ds_read_b64_tr_b16 v[58:59], v10 offset:2048
    v_add_u32 v11, s38, v3
    ds_read_b64_tr_b16 v[60:61], v11 offset:0
    ds_read_b64_tr_b16 v[62:63], v11 offset:2048
    s_branch D_p6
D_e8:
    s_ff1_i32_b32 s64, s68
    s_bitset0_b32 s68, s64
    v_readlane_b32 s39, v7, s64
    s_add_u32 s69, s64, s74
    s_and_b32 s69, s69, 15
    s_lshl_b32 s69, s69, 11
    buffer_load_dwordx4 v[192:195], v4, s[16:19], s69 offen sc1
    buffer_load_dwordx4 v[196:199], v12, s[16:19], s69 offen sc1
    s_add_u32 s69, s69, 2048
    buffer_load_dwordx4 v[200:203], v4, s[16:19], s69 offen sc1
    buffer_load_dwordx4 v[204:207], v12, s[16:19], s69 offen sc1
    s_ff1_i32_b32 s64, s68
    s_bitset0_b32 s68, s64
    v_readlane_b32 s38, v7, s64
    s_add_u32 s69, s64, s74
    s_and_b32 s69, s69, 15
    s_lshl_b32 s69, s69, 11
    buffer_load_dwordx4 v[176:179], v4, s[16:19], s69 offen sc1
    buffer_load_dwordx4 v[180:183], v12, s[16:19], s69 offen sc1
    s_add_u32 s69, s69, 2048
    buffer_load_dwordx4 v[184:187], v4, s[16:19], s69 offen sc1
    buffer_load_dwordx4 v[188:191], v12, s[16:19], s69 offen sc1
    v_add_u32 v8, s39, v5
    ds_read_b64_tr_b16 v[48:49], v8 offset:0
    ds_read_b64_tr_b16 v[50:51], v8 offset:2048
    v_add_u32 v9, s39, v6
    ds_read_b64_tr_b16 v[52:53], v9 offset:0
    ds_read_b64_tr_b16 v[54:55], v9 offset:2048
    v_add_u32 v10, s39, v1
    ds_read_b64_tr_b16 v[56:57], v10 offset:0
    ds_read_b64_tr_b16 v[58:59], v10 offset:2048
    v_add_u32 v11, s39, v3
    ds_read_b64_tr_b16 v[60:61], v11 offset:0
    ds_read_b64_tr_b16 v[62:63], v11 offset:2048
D_p7:
    s_waitcnt vmcnt(4) lgkmcnt(0)
    v_mfma_f32_16x16x32_bf16 v[16:19], v[48:51], v[192:195], v[16:19]
    ds_read_b64_tr_b16 v[64:65], v8 offset:4096
    ds_read_b64_tr_b16 v[66:67], v8 offset:6144
    v_mfma_f32_16x16x32_bf16 v[32:35], v[48:51], v[196:199], v[32:35]
    ds_read_b64_tr_b16 v[68:69], v9 offset:4096
    ds_read_b64_tr_b16 v[70:71], v9 offset:6144
    v_mfma_f32_16x16x32_bf16 v[20:23], v[52:55], v[192:195], v[20:23]
    ds_read_b64_tr_b16 v[72:73], v10 offset:4096
    ds_read_b64_tr_b16 v[74:75], v10 offset:6144
    v_mfma_f32_16x16x32_bf16 v[36:39], v[52:55], v[196:199], v[36:39]
    ds_read_b64_tr_b16 v[76:77], v11 offset:4096
    ds_read_b64_tr_b16 v[78:79], v11 offset:6144
    s_ff1_i32_b32 s64, s68
    s_bitset0_b32 s68, s64
    v_readlane_b32 s37, v7, s64
    s_add_u32 s69, s64, s74
    s_and_b32 s69, s69, 15
    s_lshl_b32 s69, s69, 11
    buffer_load_dwordx4 v[160:163], v4, s[16:19], s69 offen sc1
    v_mfma_f32_16x16x32_bf16 v[24:27], v[56:59], v[192:195], v[24:27]
    v_mfma_f32_16x16x32_bf16 v[40:43], v[56:59], v[196:199], v[40:43]
    v_mfma_f32_16x16x32_bf16 v[28:31], v[60:63], v[192:195], v[28:31]
    buffer_load_dwordx4 v[164:167], v12, s[16:19], s69 offen sc1
    v_mfma_f32_16x16x32_bf16 v[44:47], v[60:63], v[196:199], v[44:47]
    s_waitcnt lgkmcnt(0)
    v_mfma_f32_16x16x32_bf16 v[16:19], v[64:67], v[200:203], v[16:19]
    v_add_u32 v8, s38, v5
    ds_read_b64_tr_b16 v[48:49], v8 offset:0
    v_mfma_f32_16x16x32_bf16 v[32:35], v[64:67], v[204:207], v[32:35]
    ds_read_b64_tr_b16 v[50:51], v8 offset:2048
    v_add_u32 v9, s38, v6
    v_mfma_f32_16x16x32_bf16 v[20:23], v[68:71], v[200:203], v[20:23]
    ds_read_b64_tr_b16 v[52:53], v9 offset:0
    ds_read_b64_tr_b16 v[54:55], v9 offset:2048
    v_mfma_f32_16x16x32_bf16 v[36:39], v[68:71], v[204:207], v[36:39]
    v_add_u32 v10, s38, v1
    ds_read_b64_tr_b16 v[56:57], v10 offset:0
    s_add_u32 s69, s69, 2048
    buffer_load_dwordx4 v[168:171], v4, s[16:19], s69 offen sc1
    v_mfma_f32_16x16x32_bf16 v[24:27], v[72:75], v[200:203], v[24:27]
    ds_read_b64_tr_b16 v[58:59], v10 offset:2048
    v_add_u32 v11, s38, v3
    v_mfma_f32_16x16x32_bf16 v[40:43], v[72:75], v[204:207], v[40:43]
    ds_read_b64_tr_b16 v[60:61], v11 offset:0
    ds_read_b64_tr_b16 v[62:63], v11 offset:2048
    v_mfma_f32_16x16x32_bf16 v[28:31], v[76:79], v[200:203], v[28:31]
    buffer_load_dwordx4 v[172:175], v12, s[16:19], s69 offen sc1
    v_mfma_f32_16x16x32_bf16 v[44:47], v[76:79], v[204:207], v[44:47]
D_p6:
    s_waitcnt vmcnt(4) lgkmcnt(0)
    v_mfma_f32_16x16x32_bf16 v[16:19], v[48:51], v[176:179], v[16:19]
    ds_read_b64_tr_b16 v[64:65], v8 offset:4096
    ds_read_b64_tr_b16 v[66:67], v8 offset:6144
    v_mfma_f32_16x16x32_bf16 v[32:35], v[48:51], v[180:183], v[32:35]
    ds_read_b64_tr_b16 v[68:69], v9 offset:4096
    ds_read_b64_tr_b16 v[70:71], v9 offset:6144
    v_mfma_f32_16x16x32_bf16 v[20:23], v[52:55], v[176:179], v[20:23]
    ds_read_b64_tr_b16 v[72:73], v10 offset:4096
    ds_read_b64_tr_b16 v[74:75], v10 offset:6144
    v_mfma_f32_16x16x32_bf16 v[36:39], v[52:55], v[180:183], v[36:39]
    ds_read_b64_tr_b16 v[76:77], v11 offset:4096
    ds_read_b64_tr_b16 v[78:79], v11 offset:6144
    s_ff1_i32_b32 s64, s68
    s_bitset0_b32 s68, s64
    v_readlane_b32 s36, v7, s64
    s_add_u32 s69, s64, s74
    s_and_b32 s69, s69, 15
    s_lshl_b32 s69, s69, 11
    buffer_load_dwordx4 v[144:147], v4, s[16:19], s69 offen sc1
    v_mfma_f32_16x16x32_bf16 v[24:27], v[56:59], v[176:179], v[24:27]
    v_mfma_f32_16x16x32_bf16 v[40:43], v[56:59], v[180:183], v[40:43]
    v_mfma_f32_16x16x32_bf16 v[28:31], v[60:63], v[176:179], v[28:31]
    buffer_load_dwordx4 v[148:151], v12, s[16:19], s69 offen sc1
    v_mfma_f32_16x16x32_bf16 v[44:47], v[60:63], v[180:183], v[44:47]
    s_waitcnt lgkmcnt(0)
    v_mfma_f32_16x16x32_bf16 v[16:19], v[64:67], v[184:187], v[16:19]
    v_add_u32 v8, s37, v5
    ds_read_b64_tr_b16 v[48:49], v8 offset:0
    v_mfma_f32_16x16x32_bf16 v[32:35], v[64:67], v[188:191], v[32:35]
    ds_read_b64_tr_b16 v[50:51], v8 offset:2048
    v_add_u32 v9, s37, v6
    v_mfma_f32_16x16x32_bf16 v[20:23], v[68:71], v[184:187], v[20:23]
    ds_read_b64_tr_b16 v[52:53], v9 offset:0
    ds_read_b64_tr_b16 v[54:55], v9 offset:2048
    v_mfma_f32_16x16x32_bf16 v[36:39], v[68:71], v[188:191], v[36:39]
    v_add_u32 v10, s37, v1
    ds_read_b64_tr_b16 v[56:57], v10 offset:0
    s_add_u32 s69, s69, 2048
    buffer_load_dwordx4 v[152:155], v4, s[16:19], s69 offen sc1
    v_mfma_f32_16x16x32_bf16 v[24:27], v[72:75], v[184:187], v[24:27]
    ds_read_b64_tr_b16 v[58:59], v10 offset:2048
    v_add_u32 v11, s37, v3
    v_mfma_f32_16x16x32_bf16 v[40:43], v[72:75], v[188:191], v[40:43]
    ds_read_b64_tr_b16 v[60:61], v11 offset:0
    ds_read_b64_tr_b16 v[62:63], v11 offset:2048
    v_mfma_f32_16x16x32_bf16 v[28:31], v[76:79], v[184:187], v[28:31]
    buffer_load_dwordx4 v[156:159], v12, s[16:19], s69 offen sc1
    v_mfma_f32_16x16x32_bf16 v[44:47], v[76:79], v[188:191], v[44:47]
D_p5:
    s_waitcnt vmcnt(4) lgkmcnt(0)
    v_mfma_f32_16x16x32_bf16 v[16:19], v[48:51], v[160:163], v[16:19]
    ds_read_b64_tr_b16 v[64:65], v8 offset:4096
    ds_read_b64_tr_b16 v[66:67], v8 offset:6144
    v_mfma_f32_16x16x32_bf16 v[32:35], v[48:51], v[164:167], v[32:35]
    ds_read_b64_tr_b16 v[68:69], v9 offset:4096
    ds_read_b64_tr_b16 v[70:71], v9 offset:6144
    v_mfma_f32_16x16x32_bf16 v[20:23], v[52:55], v[160:163], v[20:23]
    ds_read_b64_tr_b16 v[72:73], v10 offset:4096
    ds_read_b64_tr_b16 v[74:75], v10 offset:6144
    v_mfma_f32_16x16x32_bf16 v[36:39], v[52:55], v[164:167], v[36:39]
    ds_read_b64_tr_b16 v[76:77], v11 offset:4096
    ds_read_b64_tr_b16 v[78:79], v11 offset:6144
    s_ff1_i32_b32 s64, s68
    s_bitset0_b32 s68, s64
    v_readlane_b32 s35, v7, s64
    s_add_u32 s69, s64, s74
    s_and_b32 s69, s69, 15
    s_lshl_b32 s69, s69, 11
    buffer_load_dwordx4 v[128:131], v4, s[16:19], s69 offen sc1
    v_mfma_f32_16x16x32_bf16 v[24:27], v[56:59], v[160:163], v[24:27]
    v_mfma_f32_16x16x32_bf16 v[40:43], v[56:59], v[164:167], v[40:43]
    v_mfma_f32_16x16x32_bf16 v[28:31], v[60:63], v[160:163], v[28:31]
    buffer_load_dwordx4 v[132:135], v12, s[16:19], s69 offen sc1
    v_mfma_f32_16x16x32_bf16 v[44:47], v[60:63], v[164:167], v[44:47]
    s_waitcnt lgkmcnt(0)
    v_mfma_f32_16x16x32_bf16 v[16:19], v[64:67], v[168:171], v[16:19]
    v_add_u32 v8, s36, v5
    ds_read_b64_tr_b16 v[48:49], v8 offset:0
    v_mfma_f32_16x16x32_bf16 v[32:35], v[64:67], v[172:175], v[32:35]
    ds_read_b64_tr_b16 v[50:51], v8 offset:2048
    v_add_u32 v9, s36, v6
    v_mfma_f32_16x16x32_bf16 v[20:23], v[68:71], v[168:171], v[20:23]
    ds_read_b64_tr_b16 v[52:53], v9 offset:0
    ds_read_b64_tr_b16 v[54:55], v9 offset:2048
    v_mfma_f32_16x16x32_bf16 v[36:39], v[68:71], v[172:175], v[36:39]
    v_add_u32 v10, s36, v1
    ds_read_b64_tr_b16 v[56:57], v10 offset:0
    s_add_u32 s69, s69, 2048
    buffer_load_dwordx4 v[136:139], v4, s[16:19], s69 offen sc1
    v_mfma_f32_16x16x32_bf16 v[24:27], v[72:75], v[168:171], v[24:27]
    ds_read_b64_tr_b16 v[58:59], v10 offset:2048
    v_add_u32 v11, s36, v3
    v_mfma_f32_16x16x32_bf16 v[40:43], v[72:75], v[172:175], v[40:43]
    ds_read_b64_tr_b16 v[60:61], v11 offset:0
    ds_read_b64_tr_b16 v[62:63], v11 offset:2048
    v_mfma_f32_16x16x32_bf16 v[28:31], v[76:79], v[168:171], v[28:31]
    buffer_load_dwordx4 v[140:143], v12, s[16:19], s69 offen sc1
    v_mfma_f32_16x16x32_bf16 v[44:47], v[76:79], v[172:175], v[44:47]
D_p4:
    s_waitcnt vmcnt(4) lgkmcnt(0)
    v_mfma_f32_16x16x32_bf16 v[16:19], v[48:51], v[144:147], v[16:19]
    ds_read_b64_tr_b16 v[64:65], v8 offset:4096
    ds_read_b64_tr_b16 v[66:67], v8 offset:6144
    v_mfma_f32_16x16x32_bf16 v[32:35], v[48:51], v[148:151], v[32:35]
    ds_read_b64_tr_b16 v[68:69], v9 offset:4096
    ds_read_b64_tr_b16 v[70:71], v9 offset:6144
    v_mfma_f32_16x16x32_bf16 v[20:23], v[52:55], v[144:147], v[20:23]
    ds_read_b64_tr_b16 v[72:73], v10 offset:4096
    ds_read_b64_tr_b16 v[74:75], v10 offset:6144
    v_mfma_f32_16x16x32_bf16 v[36:39], v[52:55], v[148:151], v[36:39]
    ds_read_b64_tr_b16 v[76:77], v11 offset:4096
    ds_read_b64_tr_b16 v[78:79], v11 offset:6144
    s_ff1_i32_b32 s64, s68
    s_bitset0_b32 s68, s64
    v_readlane_b32 s34, v7, s64
    s_add_u32 s69, s64, s74
    s_and_b32 s69, s69, 15
    s_lshl_b32 s69, s69, 11
    buffer_load_dwordx4 v[112:115], v4, s[16:19], s69 offen sc1
    v_mfma_f32_16x16x32_bf16 v[24:27], v[56:59], v[144:147], v[24:27]
    v_mfma_f32_16x16x32_bf16 v[40:43], v[56:59], v[148:151], v[40:43]
    v_mfma_f32_16x16x32_bf16 v[28:31], v[60:63], v[144:147], v[28:31]
    buffer_load_dwordx4 v[116:119], v12, s[16:19], s69 offen sc1
    v_mfma_f32_16x16x32_bf16 v[44:47], v[60:63], v[148:151], v[44:47]
    s_waitcnt lgkmcnt(0)
    v_mfma_f32_16x16x32_bf16 v[16:19], v[64:67], v[152:155], v[16:19]
    v_add_u32 v8, s35, v5
    ds_read_b64_tr_b16 v[48:49], v8 offset:0
    v_mfma_f32_16x16x32_bf16 v[32:35], v[64:67], v[156:159], v[32:35]
    ds_read_b64_tr_b16 v[50:51], v8 offset:2048
    v_add_u32 v9, s35, v6
    v_mfma_f32_16x16x32_bf16 v[20:23], v[68:71], v[152:155], v[20:23]
    ds_read_b64_tr_b16 v[52:53], v9 offset:0
    ds_read_b64_tr_b16 v[54:55], v9 offset:2048
    v_mfma_f32_16x16x32_bf16 v[36:39], v[68:71], v[156:159], v[36:39]
    v_add_u32 v10, s35, v1
    ds_read_b64_tr_b16 v[56:57], v10 offset:0
    s_add_u32 s69, s69, 2048
    buffer_load_dwordx4 v[120:123], v4, s[16:19], s69 offen sc1
    v_mfma_f32_16x16x32_bf16 v[24:27], v[72:75], v[152:155], v[24:27]
    ds_read_b64_tr_b16 v[58:59], v10 offset:2048
    v_add_u32 v11, s35, v3
    v_mfma_f32_16x16x32_bf16 v[40:43], v[72:75], v[156:159], v[40:43]
    ds_read_b64_tr_b16 v[60:61], v11 offset:0
    ds_read_b64_tr_b16 v[62:63], v11 offset:2048
    v_mfma_f32_16x16x32_bf16 v[28:31], v[76:79], v[152:155], v[28:31]
    buffer_load_dwordx4 v[124:127], v12, s[16:19], s69 offen sc1
    v_mfma_f32_16x16x32_bf16 v[44:47], v[76:79], v[156:159], v[44:47]
D_p3:
    s_waitcnt vmcnt(4) lgkmcnt(0)
    v_mfma_f32_16x16x32_bf16 v[16:19], v[48:51], v[128:131], v[16:19]
    ds_read_b64_tr_b16 v[64:65], v8 offset:4096
    ds_read_b64_tr_b16 v[66:67], v8 offset:6144
    v_mfma_f32_16x16x32_bf16 v[32:35], v[48:51], v[132:135], v[32:35]
    ds_read_b64_tr_b16 v[68:69], v9 offset:4096
    ds_read_b64_tr_b16 v[70:71], v9 offset:6144
    v_mfma_f32_16x16x32_bf16 v[20:23], v[52:55], v[128:131], v[20:23]
    ds_read_b64_tr_b16 v[72:73], v10 offset:4096
    ds_read_b64_tr_b16 v[74:75], v10 offset:6144
    v_mfma_f32_16x16x32_bf16 v[36:39], v[52:55], v[132:135], v[36:39]
    ds_read_b64_tr_b16 v[76:77], v11 offset:4096
    ds_read_b64_tr_b16 v[78:79], v11 offset:6144
    s_ff1_i32_b32 s64, s68
    s_bitset0_b32 s68, s64
    v_readlane_b32 s33, v7, s64
    s_add_u32 s69, s64, s74
    s_and_b32 s69, s69, 15
    s_lshl_b32 s69, s69, 11
    buffer_load_dwordx4 v[96:99], v4, s[16:19], s69 offen sc1
    v_mfma_f32_16x16x32_bf16 v[24:27], v[56:59], v[128:131], v[24:27]
    v_mfma_f32_16x16x32_bf16 v[40:43], v[56:59], v[132:135], v[40:43]
    v_mfma_f32_16x16x32_bf16 v[28:31], v[60:63], v[128:131], v[28:31]
    buffer_load_dwordx4 v[100:103], v12, s[16:19], s69 offen sc1
    v_mfma_f32_16x16x32_bf16 v[44:47], v[60:63], v[132:135], v[44:47]
    s_waitcnt lgkmcnt(0)
    v_mfma_f32_16x16x32_bf16 v[16:19], v[64:67], v[136:139], v[16:19]
    v_add_u32 v8, s34, v5
    ds_read_b64_tr_b16 v[48:49], v8 offset:0
    v_mfma_f32_16x16x32_bf16 v[32:35], v[64:67], v[140:143], v[32:35]
    ds_read_b64_tr_b16 v[50:51], v8 offset:2048
    v_add_u32 v9, s34, v6
    v_mfma_f32_16x16x32_bf16 v[20:23], v[68:71], v[136:139], v[20:23]
    ds_read_b64_tr_b16 v[52:53], v9 offset:0
    ds_read_b64_tr_b16 v[54:55], v9 offset:2048
    v_mfma_f32_16x16x32_bf16 v[36:39], v[68:71], v[140:143], v[36:39]
    v_add_u32 v10, s34, v1
    ds_read_b64_tr_b16 v[56:57], v10 offset:0
    s_add_u32 s69, s69, 2048
    buffer_load_dwordx4 v[104:107], v4, s[16:19], s69 offen sc1
    v_mfma_f32_16x16x32_bf16 v[24:27], v[72:75], v[136:139], v[24:27]
    ds_read_b64_tr_b16 v[58:59], v10 offset:2048
    v_add_u32 v11, s34, v3
    v_mfma_f32_16x16x32_bf16 v[40:43], v[72:75], v[140:143], v[40:43]
    ds_read_b64_tr_b16 v[60:61], v11 offset:0
    ds_read_b64_tr_b16 v[62:63], v11 offset:2048
    v_mfma_f32_16x16x32_bf16 v[28:31], v[76:79], v[136:139], v[28:31]
    buffer_load_dwordx4 v[108:111], v12, s[16:19], s69 offen sc1
    v_mfma_f32_16x16x32_bf16 v[44:47], v[76:79], v[140:143], v[44:47]
D_p2:
    s_waitcnt vmcnt(4) lgkmcnt(0)
    v_mfma_f32_16x16x32_bf16 v[16:19], v[48:51], v[112:115], v[16:19]
    ds_read_b64_tr_b16 v[64:65], v8 offset:4096
    ds_read_b64_tr_b16 v[66:67], v8 offset:6144
    v_mfma_f32_16x16x32_bf16 v[32:35], v[48:51], v[116:119], v[32:35]
    ds_read_b64_tr_b16 v[68:69], v9 offset:4096
    ds_read_b64_tr_b16 v[70:71], v9 offset:6144
    v_mfma_f32_16x16x32_bf16 v[20:23], v[52:55], v[112:115], v[20:23]
    ds_read_b64_tr_b16 v[72:73], v10 offset:4096
    ds_read_b64_tr_b16 v[74:75], v10 offset:6144
    v_mfma_f32_16x16x32_bf16 v[36:39], v[52:55], v[116:119], v[36:39]
    ds_read_b64_tr_b16 v[76:77], v11 offset:4096
    ds_read_b64_tr_b16 v[78:79], v11 offset:6144
    s_ff1_i32_b32 s64, s68
    s_bitset0_b32 s68, s64
    v_readlane_b32 s32, v7, s64
    s_add_u32 s69, s64, s74
    s_and_b32 s69, s69, 15
    s_lshl_b32 s69, s69, 11
    buffer_load_dwordx4 v[80:83], v4, s[16:19], s69 offen sc1
    v_mfma_f32_16x16x32_bf16 v[24:27], v[56:59], v[112:115], v[24:27]
    v_mfma_f32_16x16x32_bf16 v[40:43], v[56:59], v[116:119], v[40:43]
    v_mfma_f32_16x16x32_bf16 v[28:31], v[60:63], v[112:115], v[28:31]
    buffer_load_dwordx4 v[84:87], v12, s[16:19], s69 offen sc1
    v_mfma_f32_16x16x32_bf16 v[44:47], v[60:63], v[116:119], v[44:47]
    s_waitcnt lgkmcnt(0)
    v_mfma_f32_16x16x32_bf16 v[16:19], v[64:67], v[120:123], v[16:19]
    v_add_u32 v8, s33, v5
    ds_read_b64_tr_b16 v[48:49], v8 offset:0
    v_mfma_f32_16x16x32_bf16 v[32:35], v[64:67], v[124:127], v[32:35]
    ds_read_b64_tr_b16 v[50:51], v8 offset:2048
    v_add_u32 v9, s33, v6
    v_mfma_f32_16x16x32_bf16 v[20:23], v[68:71], v[120:123], v[20:23]
    ds_read_b64_tr_b16 v[52:53], v9 offset:0
    ds_read_b64_tr_b16 v[54:55], v9 offset:2048
    v_mfma_f32_16x16x32_bf16 v[36:39], v[68:71], v[124:127], v[36:39]
    v_add_u32 v10, s33, v1
    ds_read_b64_tr_b16 v[56:57], v10 offset:0
    s_add_u32 s69, s69, 2048
    buffer_load_dwordx4 v[88:91], v4, s[16:19], s69 offen sc1
    v_mfma_f32_16x16x32_bf16 v[24:27], v[72:75], v[120:123], v[24:27]
    ds_read_b64_tr_b16 v[58:59], v10 offset:2048
    v_add_u32 v11, s33, v3
    v_mfma_f32_16x16x32_bf16 v[40:43], v[72:75], v[124:127], v[40:43]
    ds_read_b64_tr_b16 v[60:61], v11 offset:0
    ds_read_b64_tr_b16 v[62:63], v11 offset:2048
    v_mfma_f32_16x16x32_bf16 v[28:31], v[76:79], v[120:123], v[28:31]
    buffer_load_dwordx4 v[92:95], v12, s[16:19], s69 offen sc1
    s_mov_b64 exec, 1
    v_mov_b32 v15, 0
    buffer_atomic_or v15, v14, s[16:19], 0 offen sc0
    s_mov_b64 exec, -1
    v_mfma_f32_16x16x32_bf16 v[44:47], v[76:79], v[124:127], v[44:47]
D_p1:
    s_waitcnt vmcnt(5) lgkmcnt(0)
    v_mfma_f32_16x16x32_bf16 v[16:19], v[48:51], v[96:99], v[16:19]
    ds_read_b64_tr_b16 v[64:65], v8 offset:4096
    ds_read_b64_tr_b16 v[66:67], v8 offset:6144
    v_mfma_f32_16x16x32_bf16 v[32:35], v[48:51], v[100:103], v[32:35]
    ds_read_b64_tr_b16 v[68:69], v9 offset:4096
    ds_read_b64_tr_b16 v[70:71], v9 offset:6144
    v_mfma_f32_16x16x32_bf16 v[20:23], v[52:55], v[96:99], v[20:23]
    ds_read_b64_tr_b16 v[72:73], v10 offset:4096
    ds_read_b64_tr_b16 v[74:75], v10 offset:6144
    v_mfma_f32_16x16x32_bf16 v[36:39], v[52:55], v[100:103], v[36:39]
    ds_read_b64_tr_b16 v[76:77], v11 offset:4096
    ds_read_b64_tr_b16 v[78:79], v11 offset:6144
    v_mfma_f32_16x16x32_bf16 v[24:27], v[56:59], v[96:99], v[24:27]
    v_mfma_f32_16x16x32_bf16 v[40:43], v[56:59], v[100:103], v[40:43]
    v_mfma_f32_16x16x32_bf16 v[28:31], v[60:63], v[96:99], v[28:31]
    v_mfma_f32_16x16x32_bf16 v[44:47], v[60:63], v[100:103], v[44:47]
    s_waitcnt lgkmcnt(0)
    v_mfma_f32_16x16x32_bf16 v[16:19], v[64:67], v[104:107], v[16:19]
    v_add_u32 v8, s32, v5
    ds_read_b64_tr_b16 v[48:49], v8 offset:0
    v_mfma_f32_16x16x32_bf16 v[32:35], v[64:67], v[108:111], v[32:35]
    ds_read_b64_tr_b16 v[50:51], v8 offset:2048
    v_add_u32 v9, s32, v6
    v_mfma_f32_16x16x32_bf16 v[20:23], v[68:71], v[104:107], v[20:23]
    ds_read_b64_tr_b16 v[52:53], v9 offset:0
    ds_read_b64_tr_b16 v[54:55], v9 offset:2048
    v_mfma_f32_16x16x32_bf16 v[36:39], v[68:71], v[108:111], v[36:39]
    v_add_u32 v10, s32, v1
    ds_read_b64_tr_b16 v[56:57], v10 offset:0
    v_mfma_f32_16x16x32_bf16 v[24:27], v[72:75], v[104:107], v[24:27]
    ds_read_b64_tr_b16 v[58:59], v10 offset:2048
    v_add_u32 v11, s32, v3
    v_mfma_f32_16x16x32_bf16 v[40:43], v[72:75], v[108:111], v[40:43]
    ds_read_b64_tr_b16 v[60:61], v11 offset:0
    ds_read_b64_tr_b16 v[62:63], v11 offset:2048
    v_mfma_f32_16x16x32_bf16 v[28:31], v[76:79], v[104:107], v[28:31]
    v_mfma_f32_16x16x32_bf16 v[44:47], v[76:79], v[108:111], v[44:47]
D_p0:
    s_waitcnt vmcnt(1) lgkmcnt(0)
    v_mfma_f32_16x16x32_bf16 v[16:19], v[48:51], v[80:83], v[16:19]
    ds_read_b64_tr_b16 v[64:65], v8 offset:4096
    ds_read_b64_tr_b16 v[66:67], v8 offset:6144
    v_mfma_f32_16x16x32_bf16 v[32:35], v[48:51], v[84:87], v[32:35]
    ds_read_b64_tr_b16 v[68:69], v9 offset:4096
    ds_read_b64_tr_b16 v[70:71], v9 offset:6144
    v_mfma_f32_16x16x32_bf16 v[20:23], v[52:55], v[80:83], v[20:23]
    ds_read_b64_tr_b16 v[72:73], v10 offset:4096
    ds_read_b64_tr_b16 v[74:75], v10 offset:6144
    v_mfma_f32_16x16x32_bf16 v[36:39], v[52:55], v[84:87], v[36:39]
    ds_read_b64_tr_b16 v[76:77], v11 offset:4096
    ds_read_b64_tr_b16 v[78:79], v11 offset:6144
    v_mfma_f32_16x16x32_bf16 v[24:27], v[56:59], v[80:83], v[24:27]
    v_mfma_f32_16x16x32_bf16 v[40:43], v[56:59], v[84:87], v[40:43]
    v_mfma_f32_16x16x32_bf16 v[28:31], v[60:63], v[80:83], v[28:31]
    v_mfma_f32_16x16x32_bf16 v[44:47], v[60:63], v[84:87], v[44:47]
    s_waitcnt lgkmcnt(0)
    v_mfma_f32_16x16x32_bf16 v[16:19], v[64:67], v[88:91], v[16:19]
    v_mfma_f32_16x16x32_bf16 v[32:35], v[64:67], v[92:95], v[32:35]
    v_mfma_f32_16x16x32_bf16 v[20:23], v[68:71], v[88:91], v[20:23]
    v_mfma_f32_16x16x32_bf16 v[36:39], v[68:71], v[92:95], v[36:39]
    v_mfma_f32_16x16x32_bf16 v[24:27], v[72:75], v[88:91], v[24:27]
    v_mfma_f32_16x16x32_bf16 v[40:43], v[72:75], v[92:95], v[40:43]
    v_mfma_f32_16x16x32_bf16 v[28:31], v[76:79], v[88:91], v[28:31]
    v_mfma_f32_16x16x32_bf16 v[44:47], v[76:79], v[92:95], v[44:47]
    s_cmp_lg_u32 s66, 0
    s_cbranch_scc1 D_wait
D_end:
    s_lshl_b32 s64, s3, 12
    s_add_u32 s64, s64, 8192
    v_lshl_add_u32 v8, v2, 4, s64
    s_xor_b32 s65, s3, 4
    s_lshl_b32 s65, s65, 12
    s_add_u32 s65, s65, 8192
    v_lshl_add_u32 v5, v2, 4, s65
    v_lshlrev_b32 v9, 1, v229
    v_cmp_eq_u32 s[70:71], s67, v230
    s_cmp_eq_u32 s46, 0
    s_cbranch_scc1 P2_y
P2_ny:
    s_barrier
    ds_write_b128 v8, v[32:35] offset:0
    ds_write_b128 v8, v[36:39] offset:1024
    ds_write_b128 v8, v[40:43] offset:2048
    ds_write_b128 v8, v[44:47] offset:3072
    s_cmp_lg_u64 s[70:71], 0
    s_cbranch_scc1 P2_fix
P2_nr:
    s_waitcnt lgkmcnt(0)
    s_barrier
    ds_read_b128 v[64:67], v5 offset:0
    ds_read_b128 v[68:71], v5 offset:1024
    ds_read_b128 v[72:75], v5 offset:2048
    ds_read_b128 v[76:79], v5 offset:3072
    s_waitcnt lgkmcnt(2)
    v_pk_add_f32 v[16:17], v[16:17], v[64:65]
    v_pk_add_f32 v[18:19], v[18:19], v[66:67]
    v_pk_add_f32 v[20:21], v[20:21], v[68:69]
    v_pk_add_f32 v[22:23], v[22:23], v[70:71]
    v_cvt_pk_bf16_f32 v48, v16, v17
    v_cvt_pk_bf16_f32 v49, v18, v19
    v_cvt_pk_bf16_f32 v50, v20, v21
    v_cvt_pk_bf16_f32 v51, v22, v23
    s_nop 0
    v_permlane16_swap_b32 v48, v50
    v_permlane16_swap_b32 v49, v51
    v_lshlrev_b32 v16, 16, v48
    v_and_b32 v17, 0xffff0000, v48
    v_lshlrev_b32 v18, 16, v49
    v_and_b32 v19, 0xffff0000, v49
    v_lshlrev_b32 v20, 16, v50
    v_and_b32 v21, 0xffff0000, v50
    v_lshlrev_b32 v22, 16, v51
    v_and_b32 v23, 0xffff0000, v51
    v_pk_mul_f32 v[16:17], v[16:17], v[228:229] op_sel_hi:[1,0]
    v_pk_mul_f32 v[18:19], v[18:19], v[228:229] op_sel_hi:[1,0]
    v_pk_mul_f32 v[20:21], v[20:21], v[228:229] op_sel_hi:[1,0]
    v_pk_mul_f32 v[22:23], v[22:23], v[228:229] op_sel_hi:[1,0]
    v_cvt_pk_bf16_f32 v48, v16, v17
    v_cvt_pk_bf16_f32 v49, v18, v19
    v_cvt_pk_bf16_f32 v50, v20, v21
    v_cvt_pk_bf16_f32 v51, v22, v23
    v_lshlrev_b32 v16, 16, v48
    v_and_b32 v17, 0xffff0000, v48
    v_lshlrev_b32 v18, 16, v49
    v_and_b32 v19, 0xffff0000, v49
    v_lshlrev_b32 v20, 16, v50
    v_and_b32 v21, 0xffff0000, v50
    v_lshlrev_b32 v22, 16, v51
    v_and_b32 v23, 0xffff0000, v51
    v_pk_add_f32 v[16:17], v[16:17], v[232:233]
    v_pk_add_f32 v[18:19], v[18:19], v[234:235]
    v_pk_add_f32 v[20:21], v[20:21], v[236:237]
    v_pk_add_f32 v[22:23], v[22:23], v[238:239]
    v_cvt_pk_bf16_f32 v120, v16, v17
    v_cvt_pk_bf16_f32 v121, v18, v19
    v_cvt_pk_bf16_f32 v122, v20, v21
    v_cvt_pk_bf16_f32 v123, v22, v23
    v_and_b32 v6, 1, v2
    v_mul_u32_u24 v6, 1984, v6
    v_sub_u32 v231, v231, v6
    s_mov_b32 vcc_lo, 0x55555555
    s_mov_b32 vcc_hi, 0x55555555
    s_waitcnt lgkmcnt(0)
    v_pk_add_f32 v[24:25], v[24:25], v[72:73]
    v_pk_add_f32 v[26:27], v[26:27], v[74:75]
    v_pk_add_f32 v[28:29], v[28:29], v[76:77]
    v_pk_add_f32 v[30:31], v[30:31], v[78:79]
    v_cvt_pk_bf16_f32 v52, v24, v25
    v_cvt_pk_bf16_f32 v53, v26, v27
    v_cvt_pk_bf16_f32 v54, v28, v29
    v_cvt_pk_bf16_f32 v55, v30, v31
    s_nop 0
    v_permlane16_swap_b32 v52, v54
    v_permlane16_swap_b32 v53, v55
    v_lshlrev_b32 v24, 16, v52
    v_and_b32 v25, 0xffff0000, v52
    v_lshlrev_b32 v26, 16, v53
    v_and_b32 v27, 0xffff0000, v53
    v_lshlrev_b32 v28, 16, v54
    v_and_b32 v29, 0xffff0000, v54
    v_lshlrev_b32 v30, 16, v55
    v_and_b32 v31, 0xffff0000, v55
    v_pk_mul_f32 v[24:25], v[24:25], v[228:229] op_sel_hi:[1,0]
    v_pk_mul_f32 v[26:27], v[26:27], v[228:229] op_sel_hi:[1,0]
    v_pk_mul_f32 v[28:29], v[28:29], v[228:229] op_sel_hi:[1,0]
    v_pk_mul_f32 v[30:31], v[30:31], v[228:229] op_sel_hi:[1,0]
    v_cvt_pk_bf16_f32 v52, v24, v25
    v_cvt_pk_bf16_f32 v53, v26, v27
    v_cvt_pk_bf16_f32 v54, v28, v29
    v_cvt_pk_bf16_f32 v55, v30, v31
    v_lshlrev_b32 v24, 16, v52
    v_and_b32 v25, 0xffff0000, v52
    v_lshlrev_b32 v26, 16, v53
    v_and_b32 v27, 0xffff0000, v53
    v_lshlrev_b32 v28, 16, v54
    v_and_b32 v29, 0xffff0000, v54
    v_lshlrev_b32 v30, 16, v55
    v_and_b32 v31, 0xffff0000, v55
    v_pk_add_f32 v[24:25], v[24:25], v[240:241]
    v_pk_add_f32 v[26:27], v[26:27], v[242:243]
    v_pk_add_f32 v[28:29], v[28:29], v[244:245]
    v_pk_add_f32 v[30:31], v[30:31], v[246:247]
    v_cvt_pk_bf16_f32 v124, v24, v25
    v_cvt_pk_bf16_f32 v125, v26, v27
    v_cvt_pk_bf16_f32 v126, v28, v29
    v_cvt_pk_bf16_f32 v127, v30, v31
    s_nop 1
    v_cndmask_b32_dpp v56, v124, v120, vcc quad_perm:[1,0,3,2] row_mask:0xf bank_mask:0xf
    v_cndmask_b32_dpp v57, v125, v121, vcc quad_perm:[1,0,3,2] row_mask:0xf bank_mask:0xf
    v_cndmask_b32_dpp v58, v126, v122, vcc quad_perm:[1,0,3,2] row_mask:0xf bank_mask:0xf
    v_cndmask_b32_dpp v59, v127, v123, vcc quad_perm:[1,0,3,2] row_mask:0xf bank_mask:0xf
    buffer_store_dwordx4 v[56:59], v231, s[20:23], 0 offen nt
    s_not_b64 vcc, vcc
    v_cndmask_b32_dpp v60, v120, v124, vcc quad_perm:[1,0,3,2] row_mask:0xf bank_mask:0xf
    v_cndmask_b32_dpp v61, v121, v125, vcc quad_perm:[1,0,3,2] row_mask:0xf bank_mask:0xf
    v_cndmask_b32_dpp v62, v122, v126, vcc quad_perm:[1,0,3,2] row_mask:0xf bank_mask:0xf
    v_cndmask_b32_dpp v63, v123, v127, vcc quad_perm:[1,0,3,2] row_mask:0xf bank_mask:0xf
    buffer_store_dwordx4 v[60:63], v231, s[20:23], 0 offen offset:2048 nt
K_end:
    s_endpgm
H_nre:
    s_add_u32 s65, s65, 1
    s_cmp_ge_u32 s65, 200000
    s_cbranch_scc1 H_nok
    s_sleep 4
    buffer_load_dword v78, v79, s[20:23], 0 offen sc1
    s_waitcnt vmcnt(0)
    s_branch H_nspin
H_retry:
    s_add_u32 s65, s65, 1
    s_cmp_ge_u32 s65, 200000
    s_cbranch_scc1 H_nq
    s_sleep 8
    s_mov_b32 s64, 6717440
    buffer_load_dwordx4 v[24:27], v6, s[16:19], s64 offen offset:0 sc1
    buffer_load_dwordx4 v[28:31], v6, s[16:19], s64 offen offset:1024 sc1
    s_waitcnt vmcnt(0)
    s_branch H_spin
G_f15:
    s_bitset1_b32 s66, s55
    s_branch G_q15
G_f14:
    s_bitset1_b32 s66, s54
    s_branch G_q14
G_f13:
    s_bitset1_b32 s66, s53
    s_branch G_q13
G_f12:
    s_bitset1_b32 s66, s52
    s_branch G_q12
G_f11:
    s_bitset1_b32 s66, s51
    s_branch G_q11
G_f10:
    s_bitset1_b32 s66, s50
    s_branch G_q10
G_f9:
    s_bitset1_b32 s66, s49
    s_branch G_q9
G_f8:
    s_bitset1_b32 s66, s48
    s_branch G_q8
G_f7:
    s_bitset1_b32 s66, s47
    s_branch G_q7
G_f6:
    s_bitset1_b32 s66, s46
    s_branch G_q6
G_f5:
    s_bitset1_b32 s66, s45
    s_branch G_q5
G_f4:
    s_bitset1_b32 s66, s44
    s_branch G_q4
G_f3:
    s_bitset1_b32 s66, s43
    s_branch G_q3
G_f2:
    s_bitset1_b32 s66, s42
    s_branch G_q2
G_f1:
    s_bitset1_b32 s66, s41
    s_branch G_q1
G_f0:
    s_bitset1_b32 s66, s40
    s_branch G_q0
phi_16_fix:
    v_lshlrev_b32 v32, 16, v16
    v_and_b32 v33, 0xffff0000, v16
    v_add_f32 v32, s73, v32
    v_add_f32 v33, s73, v33
    v_cvt_pk_bf16_f32 v16, v32, v33
    v_lshlrev_b32 v32, 16, v17
    v_and_b32 v33, 0xffff0000, v17
    v_add_f32 v32, s73, v32
    v_add_f32 v33, s73, v33
    v_cvt_pk_bf16_f32 v17, v32, v33
    v_lshlrev_b32 v32, 16, v18
    v_and_b32 v33, 0xffff0000, v18
    v_add_f32 v32, s73, v32
    v_add_f32 v33, s73, v33
    v_cvt_pk_bf16_f32 v18, v32, v33
    v_lshlrev_b32 v32, 16, v19
    v_and_b32 v33, 0xffff0000, v19
    v_add_f32 v32, s73, v32
    v_add_f32 v33, s73, v33
    v_cvt_pk_bf16_f32 v19, v32, v33
    v_lshlrev_b32 v32, 16, v20
    v_and_b32 v33, 0xffff0000, v20
    v_add_f32 v32, s73, v32
    v_add_f32 v33, s73, v33
    v_cvt_pk_bf16_f32 v20, v32, v33
    v_lshlrev_b32 v32, 16, v21
    v_and_b32 v33, 0xffff0000, v21
    v_add_f32 v32, s73, v32
    v_add_f32 v33, s73, v33
    v_cvt_pk_bf16_f32 v21, v32, v33
    v_lshlrev_b32 v32, 16, v22
    v_and_b32 v33, 0xffff0000, v22
    v_add_f32 v32, s73, v32
    v_add_f32 v33, s73, v33
    v_cvt_pk_bf16_f32 v22, v32, v33
    v_lshlrev_b32 v32, 16, v23
    v_and_b32 v33, 0xffff0000, v23
    v_add_f32 v32, s73, v32
    v_add_f32 v33, s73, v33
    v_cvt_pk_bf16_f32 v23, v32, v33
    s_branch phi_16_done
phi_17_fix:
    v_lshlrev_b32 v48, 16, v24
    v_and_b32 v49, 0xffff0000, v24
    v_add_f32 v48, s73, v48
    v_add_f32 v49, s73, v49
    v_cvt_pk_bf16_f32 v24, v48, v49
    v_lshlrev_b32 v48, 16, v25
    v_and_b32 v49, 0xffff0000, v25
    v_add_f32 v48, s73, v48
    v_add_f32 v49, s73, v49
    v_cvt_pk_bf16_f32 v25, v48, v49
    v_lshlrev_b32 v48, 16, v26
    v_and_b32 v49, 0xffff0000, v26
    v_add_f32 v48, s73, v48
    v_add_f32 v49, s73, v49
    v_cvt_pk_bf16_f32 v26, v48, v49
    v_lshlrev_b32 v48, 16, v27
    v_and_b32 v49, 0xffff0000, v27
    v_add_f32 v48, s73, v48
    v_add_f32 v49, s73, v49
    v_cvt_pk_bf16_f32 v27, v48, v49
    v_lshlrev_b32 v48, 16, v28
    v_and_b32 v49, 0xffff0000, v28
    v_add_f32 v48, s73, v48
    v_add_f32 v49, s73, v49
    v_cvt_pk_bf16_f32 v28, v48, v49
    v_lshlrev_b32 v48, 16, v29
    v_and_b32 v49, 0xffff0000, v29
    v_add_f32 v48, s73, v48
    v_add_f32 v49, s73, v49
    v_cvt_pk_bf16_f32 v29, v48, v49
    v_lshlrev_b32 v48, 16, v30
    v_and_b32 v49, 0xffff0000, v30
    v_add_f32 v48, s73, v48
    v_add_f32 v49, s73, v49
    v_cvt_pk_bf16_f32 v30, v48, v49
    v_lshlrev_b32 v48, 16, v31
    v_and_b32 v49, 0xffff0000, v31
    v_add_f32 v48, s73, v48
    v_add_f32 v49, s73, v49
    v_cvt_pk_bf16_f32 v31, v48, v49
    s_branch phi_17_done
C_ex1:
    ds_write_b32 v227, v96 offset:4608
    ds_write_b128 v224, v[240:243] offset:32768
    ds_write_b128 v224, v[244:247] offset:33792
    s_nop 4
    v_mov_b32 v96, v60
    v_mov_b32 v240, v248
    v_mov_b32 v241, v249
    v_mov_b32 v242, v250
    v_mov_b32 v243, v251
    v_mov_b32 v244, v252
    v_mov_b32 v245, v253
    v_mov_b32 v246, v254
    v_mov_b32 v247, v255
    s_branch C_ex2
phi_18_fix:
    v_lshlrev_b32 v48, 16, v32
    v_and_b32 v49, 0xffff0000, v32
    v_add_f32 v48, s73, v48
    v_add_f32 v49, s73, v49
    v_cvt_pk_bf16_f32 v32, v48, v49
    v_lshlrev_b32 v48, 16, v33
    v_and_b32 v49, 0xffff0000, v33
    v_add_f32 v48, s73, v48
    v_add_f32 v49, s73, v49
    v_cvt_pk_bf16_f32 v33, v48, v49
    v_lshlrev_b32 v48, 16, v34
    v_and_b32 v49, 0xffff0000, v34
    v_add_f32 v48, s73, v48
    v_add_f32 v49, s73, v49
    v_cvt_pk_bf16_f32 v34, v48, v49
    v_lshlrev_b32 v48, 16, v35
    v_and_b32 v49, 0xffff0000, v35
    v_add_f32 v48, s73, v48
    v_add_f32 v49, s73, v49
    v_cvt_pk_bf16_f32 v35, v48, v49
    v_lshlrev_b32 v48, 16, v36
    v_and_b32 v49, 0xffff0000, v36
    v_add_f32 v48, s73, v48
    v_add_f32 v49, s73, v49
    v_cvt_pk_bf16_f32 v36, v48, v49
    v_lshlrev_b32 v48, 16, v37
    v_and_b32 v49, 0xffff0000, v37
    v_add_f32 v48, s73, v48
    v_add_f32 v49, s73, v49
    v_cvt_pk_bf16_f32 v37, v48, v49
    v_lshlrev_b32 v48, 16, v38
    v_and_b32 v49, 0xffff0000, v38
    v_add_f32 v48, s73, v48
    v_add_f32 v49, s73, v49
    v_cvt_pk_bf16_f32 v38, v48, v49
    v_lshlrev_b32 v48, 16, v39
    v_and_b32 v49, 0xffff0000, v39
    v_add_f32 v48, s73, v48
    v_add_f32 v49, s73, v49
    v_cvt_pk_bf16_f32 v39, v48, v49
    s_branch phi_18_done
phi_19_fix:
    v_lshlrev_b32 v48, 16, v40
    v_and_b32 v49, 0xffff0000, v40
    v_add_f32 v48, s73, v48
    v_add_f32 v49, s73, v49
    v_cvt_pk_bf16_f32 v40, v48, v49
    v_lshlrev_b32 v48, 16, v41
    v_and_b32 v49, 0xffff0000, v41
    v_add_f32 v48, s73, v48
    v_add_f32 v49, s73, v49
    v_cvt_pk_bf16_f32 v41, v48, v49
    v_lshlrev_b32 v48, 16, v42
    v_and_b32 v49, 0xffff0000, v42
    v_add_f32 v48, s73, v48
    v_add_f32 v49, s73, v49
    v_cvt_pk_bf16_f32 v42, v48, v49
    v_lshlrev_b32 v48, 16, v43
    v_and_b32 v49, 0xffff0000, v43
    v_add_f32 v48, s73, v48
    v_add_f32 v49, s73, v49
    v_cvt_pk_bf16_f32 v43, v48, v49
    v_lshlrev_b32 v48, 16, v44
    v_and_b32 v49, 0xffff0000, v44
    v_add_f32 v48, s73, v48
    v_add_f32 v49, s73, v49
    v_cvt_pk_bf16_f32 v44, v48, v49
    v_lshlrev_b32 v48, 16, v45
    v_and_b32 v49, 0xffff0000, v45
    v_add_f32 v48, s73, v48
    v_add_f32 v49, s73, v49
    v_cvt_pk_bf16_f32 v45, v48, v49
    v_lshlrev_b32 v48, 16, v46
    v_and_b32 v49, 0xffff0000, v46
    v_add_f32 v48, s73, v48
    v_add_f32 v49, s73, v49
    v_cvt_pk_bf16_f32 v46, v48, v49
    v_lshlrev_b32 v48, 16, v47
    v_and_b32 v49, 0xffff0000, v47
    v_add_f32 v48, s73, v48
    v_add_f32 v49, s73, v49
    v_cvt_pk_bf16_f32 v47, v48, v49
    s_branch phi_19_done
P2_ys:
    v_lshrrev_b32 v13, 4, v2
    v_lshlrev_b32 v13, 12, v13
    v_and_b32 v208, 15, v2
    v_lshl_add_u32 v13, v208, 4, v13
    s_lshl_b32 s64, s5, 8
    s_lshl_b32 s65, s3, 16
    s_add_u32 s64, s64, s65
    v_add_u32 v13, s64, v13
    s_lshl_b32 s64, s67, 11
    s_lshl_b32 s65, s5, 7
    s_add_u32 s64, s64, s65
    v_lshl_add_u32 v209, v2, 1, s64
    s_lshl_b32 s64, s67, 2
    s_add_u32 s64, s64, 6709248
    v_mov_b32 v215, s64
    s_branch P2_ysd
P2_yl:
    s_cmp_gt_u32 s70, 7
    s_cbranch_scc1 P2_nyl
    buffer_load_ushort v211, v209, s[8:11], 0 offen
    buffer_load_dword v212, v215, s[16:19], 0 offen sc1
    s_mov_b32 s69, 6447104
    buffer_load_dwordx4 v[192:195], v13, s[16:19], s69 offen sc1
    s_mov_b32 s69, 6463488
    buffer_load_dwordx4 v[196:199], v13, s[16:19], s69 offen sc1
    s_mov_b32 s69, 6479872
    buffer_load_dwordx4 v[200:203], v13, s[16:19], s69 offen sc1
    s_mov_b32 s69, 6496256
    buffer_load_dwordx4 v[204:207], v13, s[16:19], s69 offen sc1
    s_mov_b32 s47, 1
    s_branch P2_nyl
P2_y:
    s_mov_b32 s66, 0
    s_cmp_lg_u32 s47, 0
    s_cbranch_scc1 P2_ychk
P2_yre:
    buffer_load_ushort v211, v209, s[8:11], 0 offen
    buffer_load_dword v212, v215, s[16:19], 0 offen sc1
    s_mov_b32 s69, 6447104
    buffer_load_dwordx4 v[192:195], v13, s[16:19], s69 offen sc1
    s_mov_b32 s69, 6463488
    buffer_load_dwordx4 v[196:199], v13, s[16:19], s69 offen sc1
    s_mov_b32 s69, 6479872
    buffer_load_dwordx4 v[200:203], v13, s[16:19], s69 offen sc1
    s_mov_b32 s69, 6496256
    buffer_load_dwordx4 v[204:207], v13, s[16:19], s69 offen sc1
P2_ychk:
    s_waitcnt vmcnt(0)
    v_max3_u32 v10, v192, v193, v194
    v_max3_u32 v10, v195, v196, v10
    v_max3_u32 v10, v197, v198, v10
    v_max3_u32 v10, v199, v200, v10
    v_max3_u32 v10, v201, v202, v10
    v_max3_u32 v10, v203, v204, v10
    v_max3_u32 v10, v205, v206, v10
    v_max_u32 v10, v207, v10
    v_cmp_eq_u32 vcc, -1, v10
    s_cbranch_vccz P2_yok
    s_add_u32 s66, s66, 1
    s_cmp_ge_u32 s66, 40000
    s_cbranch_scc1 P2_yok
    s_sleep 4
    s_branch P2_yre
P2_yok:
    v_pk_add_f32 v[192:193], v[192:193], v[200:201]
    v_pk_add_f32 v[194:195], v[194:195], v[202:203]
    v_pk_add_f32 v[196:197], v[196:197], v[204:205]
    v_pk_add_f32 v[198:199], v[198:199], v[206:207]
    v_pk_add_f32 v[192:193], v[192:193], v[196:197]
    v_pk_add_f32 v[194:195], v[194:195], v[198:199]
    v_mov_b32 v196, v192
    v_mov_b32 v197, v193
    v_mov_b32 v198, v194
    v_mov_b32 v199, v195
    s_nop 0
    v_permlane16_swap_b32 v192, v196
    v_permlane16_swap_b32 v193, v197
    v_permlane16_swap_b32 v194, v198
    v_permlane16_swap_b32 v195, v199
    v_add_f32 v192, v192, v196
    v_add_f32 v193, v193, v197
    v_add_f32 v194, v194, v198
    v_add_f32 v195, v195, v199
    v_mov_b32 v196, v192
    v_mov_b32 v197, v193
    v_mov_b32 v198, v194
    v_mov_b32 v199, v195
    s_nop 0
    v_permlane32_swap_b32 v192, v196
    v_permlane32_swap_b32 v193, v197
    v_permlane32_swap_b32 v194, v198
    v_permlane32_swap_b32 v195, v199
    v_add_f32 v192, v192, v196
    v_add_f32 v193, v193, v197
    v_add_f32 v194, v194, v198
    v_add_f32 v195, v195, v199
    s_lshl_b32 s64, s3, 8
    v_lshl_add_u32 v208, v208, 4, s64
    ds_write_b128 v208, v[192:195] offset:5888
    v_mov_b32 v208, 0
    v_mov_b32 v214, 1
    s_mov_b64 exec, 1
    ds_add_rtn_u32 v210, v208, v214 offset:4304
    s_mov_b64 exec, -1
    s_and_b32 s64, s75, 0xffff0000
    s_xor_b32 s65, s64, 0x80000000
    s_not_b32 s69, s64
    s_and_b32 s69, s69, 0xffff0000
    s_cmp_ge_u32 s64, 0x80000000
    s_cselect_b32 s64, s65, s69
    v_mov_b32 v213, s64
    v_lshlrev_b32 v208, 2, v2
    s_waitcnt lgkmcnt(0)
    v_readfirstlane_b32 s64, v210
    s_cmp_lg_u32 s64, 3
    s_cbranch_scc1 P2_ny
    ds_read_b32 v192, v208 offset:5888
    ds_read_b32 v193, v208 offset:6144
    ds_read_b32 v194, v208 offset:6400
    ds_read_b32 v195, v208 offset:6656
    v_mul_f32 v213, s72, v213
    v_exp_f32 v213, -v213
    s_nop 0
    v_add_f32 v213, 1.0, v213
    v_rcp_f32 v213, v213
    s_nop 0
    v_cvt_pk_bf16_f32 v213, v213, v213
    v_lshlrev_b32 v213, 16, v213
    v_sub_f32 v214, 1.0, v212
    v_cvt_pk_bf16_f32 v214, v214, v214
    v_lshlrev_b32 v214, 16, v214
    v_lshlrev_b32 v211, 16, v211
    s_waitcnt lgkmcnt(0)
    v_add_f32 v192, v192, v193
    v_add_f32 v194, v194, v195
    v_add_f32 v210, v192, v194
    v_cvt_pk_bf16_f32 v210, v210, v210
    v_lshlrev_b32 v210, 16, v210
    v_mul_f32 v210, v210, v213
    v_cvt_pk_bf16_f32 v210, v210, v210
    v_lshlrev_b32 v210, 16, v210
    v_add_f32 v210, v211, v210
    v_cvt_pk_bf16_f32 v210, v210, v210
    v_lshlrev_b32 v210, 16, v210
    v_mul_f32 v210, v210, v214
    v_cvt_pk_bf16_f32 v210, v210, v210
    v_lshlrev_b32 v210, 16, v210
    ds_write_b32 v208, v210 offset:5632
    s_waitcnt lgkmcnt(0)
    s_branch P2_ny
P2_fix:
    s_mov_b64 exec, s[70:71]
    ds_read_b128 v[232:235], v9 offset:5632
    ds_read_b128 v[236:239], v9 offset:5648
    ds_read_b128 v[240:243], v9 offset:5760
    ds_read_b128 v[244:247], v9 offset:5776
    s_mov_b64 exec, -1
    s_branch P2_nr
CODE_END:
.section .rodata,"a"
.p2align 6
.amdhsa_kernel gated_mix__linear_attn_block__moe_arch_mod__prompt_kernel
  .amdhsa_next_free_vgpr 256
  .amdhsa_next_free_sgpr 102
  .amdhsa_accum_offset 256
  .amdhsa_group_segment_fixed_size 0
  .amdhsa_kernarg_size 96
  .amdhsa_user_sgpr_count 2
  .amdhsa_user_sgpr_kernarg_segment_ptr 1
  .amdhsa_system_sgpr_workgroup_id_x 1
.end_amdhsa_kernel
```

```asm
; @launch grid=(256,1,1) block=(512,1,1) lds=163840
.amdgcn_target "amdgcn-amd-amdhsa--gfx950"
.text
.globl gated_mix__linear_attn_block__moe_arch_mod__prompt_kernel
.p2align 8
.type gated_mix__linear_attn_block__moe_arch_mod__prompt_kernel,@function
gated_mix__linear_attn_block__moe_arch_mod__prompt_kernel:
    s_load_dwordx16 s[40:55], s[0:1], 0
    s_load_dwordx8 s[56:63], s[0:1], 64
    s_cmp_ge_u32 s2, 256
    s_cbranch_scc1 K_end
    v_lshrrev_b32 v1, 6, v0
    v_and_b32 v2, 63, v0
    s_and_b32 s6, s2, 7
    v_readfirstlane_b32 s3, v1
    s_lshr_b32 s7, s2, 3
    s_and_b32 s4, s6, 1
    s_lshl_b32 s4, s4, 3
    s_and_b32 s64, s7, 7
    s_add_u32 s4, s4, s64
    s_lshr_b32 s5, s6, 1
    s_lshl_b32 s5, s5, 2
    s_lshr_b32 s64, s7, 3
    s_add_u32 s5, s5, s64
    s_bitcmp1_b32 s6, 1
    s_mov_b32 s64, 0xfc74d850
    s_cselect_b32 s64, 0xfd75e860, s64
    s_and_b32 s65, s6, 1
    s_lshl_b32 s65, s65, 2
    s_and_b32 s74, s4, 3
    s_add_u32 s65, s65, s74
    s_lshl_b32 s65, s65, 2
    s_lshr_b32 s74, s64, s65
    s_and_b32 s74, s74, 15
    v_lshrrev_b32 v6, 3, v2
    s_lshl_b32 s65, s3, 3
    v_add_u32 v6, s65, v6
    s_lshl_b32 s64, s4, 7
    v_add_u32 v7, s64, v6
    v_lshlrev_b32 v7, 11, v7
    v_lshrrev_b32 v8, 4, v2
    s_and_b32 s64, s3, 1
    s_lshl_b32 s64, s64, 2
    v_add_u32 v9, s64, v8
    v_and_b32 v10, 7, v2
    v_xor_b32 v9, v9, v10
    v_lshl_add_u32 v7, v9, 4, v7
    v_mul_u32_u24 v6, 6144, v6
    v_and_b32 v9, 1, v8
    s_lshr_b32 s64, s64, 1
    v_lshl_add_u32 v9, v9, 2, s64
    v_xor_b32 v9, v9, v10
    v_lshl_add_u32 v6, v9, 4, v6
    s_lshl_b32 s64, s5, 7
    v_add_u32 v6, s64, v6
    s_lshl_b32 s66, s3, 10
    s_mov_b32 s10, 4194304
    s_mov_b32 s11, 0x00020000
    s_mov_b32 s14, 6291456
    s_mov_b32 s15, 0x00020000
    s_add_u32 s65, s74, 0
    s_and_b32 s65, s65, 15
    s_lshl_b32 s67, s65, 7
    s_mul_i32 s65, s65, 393216
    s_waitcnt lgkmcnt(0)
    s_mov_b32 s8, s40
    s_mov_b32 s9, s41
    s_mov_b32 s12, s42
    s_mov_b32 s13, s43
    s_add_u32 m0, s66, 8192
    s_add_u32 s64, s67, 0
    buffer_load_dwordx4 v7, s[8:11], s64 offen lds
    s_add_u32 m0, s66, 16384
    s_add_u32 s64, s67, 131072
    buffer_load_dwordx4 v7, s[8:11], s64 offen lds
    s_add_u32 m0, s66, 24576
    s_add_u32 s64, s65, 0
    buffer_load_dwordx4 v6, s[12:15], s64 offen lds
    s_add_u32 m0, s66, 32768
    s_add_u32 s64, s65, 2048
    buffer_load_dwordx4 v6, s[12:15], s64 offen lds
    s_add_u32 m0, s66, 40960
    s_add_u32 s64, s65, 4096
    buffer_load_dwordx4 v6, s[12:15], s64 offen lds
    s_cmp_lt_u32 s3, 4
    s_cbranch_scc1 K_nt
    s_lshl_b32 s64, s2, 2
    s_add_u32 s64, s64, s3
    s_sub_u32 s64, s64, 4
    s_mul_i32 s64, s64, 6144
    s_add_u32 s46, s12, s64
    s_addc_u32 s47, s13, 0
    s_load_dword s43, s[46:47], 384
    s_load_dword s43, s[46:47], 448
    s_load_dword s43, s[46:47], 1408
    s_load_dword s43, s[46:47], 1472
    s_load_dword s43, s[46:47], 2432
    s_load_dword s43, s[46:47], 2496
    s_load_dword s43, s[46:47], 3456
    s_load_dword s43, s[46:47], 3520
    s_load_dword s43, s[46:47], 4480
    s_load_dword s43, s[46:47], 4544
    s_load_dword s43, s[46:47], 5504
    s_load_dword s43, s[46:47], 5568
K_nt:
    s_barrier
    s_mov_b32 s72, 0x3fb8aa3b
    s_mov_b32 s73, 0x358637bd
    s_mov_b32 s16, s62
    s_mov_b32 s17, s63
    s_mov_b32 s18, 0x10000000
    s_mov_b32 s19, 0x00020000
    s_cmp_lt_u32 s3, 4
    s_cbranch_scc1 C_start
    s_sub_u32 s6, s3, 4
    s_lshl_b32 s7, s6, 10
    v_lshrrev_b32 v6, 3, v2
    s_lshl_b32 s64, s4, 7
    s_lshl_b32 s65, s6, 3
    s_add_u32 s64, s64, s65
    v_add_u32 v7, s64, v6
    v_lshlrev_b32 v7, 11, v7
    s_and_b32 s64, s6, 1
    s_lshl_b32 s64, s64, 2
    v_add_u32 v9, s64, v8
    v_xor_b32 v9, v9, v10
    v_lshl_add_u32 v4, v9, 4, v7
    v_add_u32 v7, s65, v6
    v_mul_u32_u24 v7, 6144, v7
    v_and_b32 v9, 1, v8
    s_lshr_b32 s64, s64, 1
    v_lshl_add_u32 v9, v9, 2, s64
    v_xor_b32 v9, v9, v10
    v_lshl_add_u32 v7, v9, 4, v7
    s_lshl_b32 s64, s5, 7
    v_add_u32 v5, s64, v7
    v_lshlrev_b32 v6, 4, v2
    s_and_b32 s64, s2, 1
    s_lshl_b32 s68, s64, 10
    s_bfe_u32 s64, s2, 0x20001
    s_lshl_b32 s64, s64, 8
    s_add_u32 s68, s68, s64
    s_and_b32 s64, s2, 0xf8
    s_add_u32 s68, s68, s64
    s_lshl_b32 s64, s6, 1
    s_add_u32 s68, s68, s64
    s_lshl_b32 s64, s68, 11
    v_add_u32 v13, s64, v6
    s_mov_b32 s24, s48
    s_mov_b32 s25, s49
    s_mov_b32 s26, 0x800
    s_mov_b32 s27, 0x00020000
    buffer_load_dwordx4 v[24:27], v13, s[8:11], 0 offen offset:0
    buffer_load_dwordx4 v[28:31], v13, s[8:11], 0 offen offset:1024
    buffer_load_dwordx4 v[32:35], v13, s[8:11], 0 offen offset:2048
    buffer_load_dwordx4 v[36:39], v13, s[8:11], 0 offen offset:3072
    s_cmp_lt_u32 s6, 2
    s_cselect_b32 s24, s48, s56
    s_cselect_b32 s25, s49, s57
    s_and_b32 s64, s7, 1024
    s_add_u32 m0, s7, 0
    s_nop 0
    buffer_load_dwordx4 v6, s[24:27], s64 offen lds
    s_add_u32 s41, s74, 1
    s_and_b32 s41, s41, 15
    s_lshl_b32 s42, s41, 7
    s_mul_i32 s41, s41, 393216
    s_add_u32 m0, s7, 49152
    s_add_u32 s40, s42, 0
    buffer_load_dwordx4 v4, s[8:11], s40 offen lds
    s_add_u32 m0, s7, 53248
    s_add_u32 s40, s42, 65536
    buffer_load_dwordx4 v4, s[8:11], s40 offen lds
    s_add_u32 m0, s7, 57344
    s_add_u32 s40, s42, 131072
    buffer_load_dwordx4 v4, s[8:11], s40 offen lds
    s_add_u32 m0, s7, 61440
    s_add_u32 s40, s42, 196608
    buffer_load_dwordx4 v4, s[8:11], s40 offen lds
    s_add_u32 m0, s7, 65536
    s_add_u32 s40, s41, 0
    buffer_load_dwordx4 v5, s[12:15], s40 offen lds
    s_add_u32 m0, s7, 69632
    s_add_u32 s40, s41, 196608
    buffer_load_dwordx4 v5, s[12:15], s40 offen lds
    s_add_u32 m0, s7, 73728
    s_add_u32 s40, s41, 2048
    buffer_load_dwordx4 v5, s[12:15], s40 offen lds
    s_add_u32 m0, s7, 77824
    s_add_u32 s40, s41, 198656
    buffer_load_dwordx4 v5, s[12:15], s40 offen lds
    s_add_u32 m0, s7, 81920
    s_add_u32 s40, s41, 4096
    buffer_load_dwordx4 v5, s[12:15], s40 offen lds
    s_add_u32 m0, s7, 86016
    s_add_u32 s40, s41, 200704
    buffer_load_dwordx4 v5, s[12:15], s40 offen lds
    s_mov_b32 s32, s50
    s_mov_b32 s33, s51
    s_mov_b32 s34, 0x700000
    s_mov_b32 s35, 0x00020000
    s_mov_b32 s36, s52
    s_mov_b32 s37, s53
    s_mov_b32 s38, 0x700000
    s_mov_b32 s39, 0x00020000
    s_mov_b32 s20, s60
    s_mov_b32 s21, s61
    s_mov_b32 s22, 0x100
    s_mov_b32 s23, 0x00020000
    s_mov_b32 s28, s56
    s_mov_b32 s29, s57
    s_mov_b32 s30, 0x800
    s_mov_b32 s31, 0x00020000
    s_lshr_b32 s69, s2, 3
    s_and_b32 s64, s2, 7
    v_and_b32 v9, 15, v2
    v_min_u32 v9, 13, v9
    s_lshl_b32 s65, s69, 5
    v_lshl_add_u32 v7, v8, 3, s65
    v_mul_u32_u24 v7, 7168, v7
    s_mul_i32 s65, s64, 896
    s_mul_i32 s66, s6, 224
    s_add_u32 s65, s65, s66
    v_lshl_add_u32 v7, v9, 4, v7
    v_add_u32 v11, s65, v7
    v_cmp_le_u32 vcc, 7, v9
    v_mov_b32 v15, 16160
    s_nop 0
    v_cndmask_b32 v7, 0, v15, vcc
    v_lshl_add_u32 v7, v9, 5, v7
    v_lshrrev_b32 v15, 1, v8
    v_lshl_add_u32 v7, v15, 13, v7
    v_and_b32 v15, 1, v8
    v_lshl_add_u32 v7, v15, 4, v7
    s_lshl_b32 s64, s64, 17
    s_lshl_b32 s65, s6, 15
    s_add_u32 s64, s64, s65
    s_lshl_b32 s65, s69, 8
    s_add_u32 s64, s64, s65
    s_add_u32 s64, s64, 5398528
    v_add_u32 v12, s64, v7
    s_lshl_b32 s70, s5, 2
    s_add_u32 s70, s70, s6
    s_mul_i32 s70, s70, 18432
    s_add_u32 s70, s70, 4194304
    s_mul_i32 s64, s4, 1152
    s_add_u32 s64, s64, s70
    s_mov_b32 s67, s64
    v_lshl_add_u32 v15, v2, 2, s64
    v_add_u32 v15, 960, v15
    s_lshl_b32 s64, s5, 2
    s_add_u32 s64, s64, s6
    s_lshl_b32 s64, s64, 7
    s_add_u32 s64, s64, 5373952
    v_mov_b32 v23, s64
    s_lshl_b32 s65, s4, 10
    s_add_u32 s65, s65, 5382016
    v_lshl_add_u32 v20, v2, 7, s65
    v_cmp_gt_u32 vcc, 16, v2
    s_nop 1
    v_cndmask_b32 v15, v15, v20, vcc
    v_writelane_b32 v15, s64, 0
    s_cmp_eq_u32 s4, 0
    s_cselect_b32 s75, 1, 0
    s_or_b32 s64, s5, s6
    s_cmp_eq_u32 s64, 0
    s_cselect_b32 s64, 0x1fe, 0
    s_or_b32 s75, s75, s64
    s_or_b32 s75, s75, 0xffff0000
    v_lshlrev_b32 v22, 4, v2
    v_add_u32 v22, s67, v22
    v_mov_b32 v16, -1
    v_mov_b32 v17, -1
    v_mov_b32 v18, -1
    v_mov_b32 v19, -1
    v_cndmask_b32 v20, -1, 0, vcc
    s_waitcnt vmcnt(15)
    s_barrier
    s_add_u32 s41, s74, 2
    s_and_b32 s41, s41, 15
    s_lshl_b32 s42, s41, 7
    s_mul_i32 s41, s41, 393216
    s_add_u32 m0, s7, 90112
    s_add_u32 s40, s42, 0
    buffer_load_dwordx4 v4, s[8:11], s40 offen lds
    s_add_u32 m0, s7, 94208
    s_add_u32 s40, s42, 65536
    buffer_load_dwordx4 v4, s[8:11], s40 offen lds
    s_add_u32 m0, s7, 98304
    s_add_u32 s40, s42, 131072
    buffer_load_dwordx4 v4, s[8:11], s40 offen lds
    s_add_u32 m0, s7, 102400
    s_add_u32 s40, s42, 196608
    buffer_load_dwordx4 v4, s[8:11], s40 offen lds
    s_add_u32 m0, s7, 106496
    s_add_u32 s40, s41, 0
    buffer_load_dwordx4 v5, s[12:15], s40 offen lds
    s_add_u32 m0, s7, 110592
    s_add_u32 s40, s41, 196608
    buffer_load_dwordx4 v5, s[12:15], s40 offen lds
    s_add_u32 m0, s7, 114688
    s_add_u32 s40, s41, 2048
    buffer_load_dwordx4 v5, s[12:15], s40 offen lds
    s_add_u32 m0, s7, 118784
    s_add_u32 s40, s41, 198656
    buffer_load_dwordx4 v5, s[12:15], s40 offen lds
    s_add_u32 m0, s7, 122880
    s_add_u32 s40, s41, 4096
    buffer_load_dwordx4 v5, s[12:15], s40 offen lds
    s_add_u32 m0, s7, 126976
    s_add_u32 s40, s41, 200704
    buffer_load_dwordx4 v5, s[12:15], s40 offen lds
    s_getpc_b64 s[66:67]
pc_1:
    s_sub_u32 s66, s66, pc_1-gated_mix__linear_attn_block__moe_arch_mod__prompt_kernel
    s_subb_u32 s67, s67, 0
    s_lshr_b32 s64, s2, 3
    s_lshl_b32 s64, s64, 2
    s_add_u32 s64, s64, s6
    s_mul_i32 s64, s64, 256
    s_min_u32 s65, s64, CODE_END-gated_mix__linear_attn_block__moe_arch_mod__prompt_kernel-4
    s_load_dword s43, s[66:67], s65
    s_add_u32 s64, s64, 64
    s_min_u32 s65, s64, CODE_END-gated_mix__linear_attn_block__moe_arch_mod__prompt_kernel-4
    s_load_dword s43, s[66:67], s65
    s_add_u32 s64, s64, 64
    s_min_u32 s65, s64, CODE_END-gated_mix__linear_attn_block__moe_arch_mod__prompt_kernel-4
    s_load_dword s43, s[66:67], s65
    s_add_u32 s64, s64, 64
    s_min_u32 s65, s64, CODE_END-gated_mix__linear_attn_block__moe_arch_mod__prompt_kernel-4
    s_load_dword s43, s[66:67], s65
    s_add_u32 s64, s64, 64
    s_waitcnt vmcnt(10)
    s_barrier
    s_add_u32 s41, s74, 3
    s_and_b32 s41, s41, 15
    s_lshl_b32 s42, s41, 7
    s_mul_i32 s41, s41, 393216
    s_add_u32 m0, s7, 8192
    s_add_u32 s40, s42, 0
    buffer_load_dwordx4 v4, s[8:11], s40 offen lds
    s_add_u32 m0, s7, 12288
    s_add_u32 s40, s42, 65536
    buffer_load_dwordx4 v4, s[8:11], s40 offen lds
    s_add_u32 m0, s7, 16384
    s_add_u32 s40, s42, 131072
    buffer_load_dwordx4 v4, s[8:11], s40 offen lds
    s_add_u32 m0, s7, 20480
    s_add_u32 s40, s42, 196608
    buffer_load_dwordx4 v4, s[8:11], s40 offen lds
    s_add_u32 m0, s7, 24576
    s_add_u32 s40, s41, 0
    buffer_load_dwordx4 v5, s[12:15], s40 offen lds
    s_add_u32 m0, s7, 28672
    s_add_u32 s40, s41, 196608
    buffer_load_dwordx4 v5, s[12:15], s40 offen lds
    s_add_u32 m0, s7, 32768
    s_add_u32 s40, s41, 2048
    buffer_load_dwordx4 v5, s[12:15], s40 offen lds
    s_add_u32 m0, s7, 36864
    s_add_u32 s40, s41, 198656
    buffer_load_dwordx4 v5, s[12:15], s40 offen lds
    s_add_u32 m0, s7, 40960
    s_add_u32 s40, s41, 4096
    buffer_load_dwordx4 v5, s[12:15], s40 offen lds
    s_add_u32 m0, s7, 45056
    s_add_u32 s40, s41, 200704
    buffer_load_dwordx4 v5, s[12:15], s40 offen lds
    buffer_store_dwordx4 v[16:19], v22, s[16:19], 0 offen sc0 sc1
    s_mov_b32 exec_lo, s75
    s_mov_b32 exec_hi, 0
    buffer_store_dword v20, v15, s[16:19], 0 offen sc0 sc1
    s_mov_b32 exec_lo, 0x3fff3fff
    s_mov_b32 exec_hi, 0x3fff3fff
    buffer_store_dwordx4 v[16:19], v12, s[16:19], 0 offen sc0 sc1
    s_mov_b64 exec, 0xffff
    s_lshl_b32 s64, s2, 10
    s_lshl_b32 s65, s6, 8
    s_add_u32 s64, s64, s65
    s_add_u32 s64, s64, 6447104
    buffer_store_dwordx4 v[16:19], v6, s[16:19], s64 offen sc0 sc1
    s_mov_b64 exec, -1
    s_waitcnt vmcnt(14)
    s_barrier
    ds_read_b128 v[40:43], v6 offset:0
    ds_read_b128 v[44:47], v6 offset:1024
    ds_read_b128 v[48:51], v6 offset:2048
    ds_read_b128 v[52:55], v6 offset:3072
    s_add_u32 s41, s74, 4
    s_and_b32 s41, s41, 15
    s_lshl_b32 s42, s41, 7
    s_mul_i32 s41, s41, 393216
    s_add_u32 m0, s7, 49152
    s_add_u32 s40, s42, 0
    buffer_load_dwordx4 v4, s[8:11], s40 offen lds
    s_waitcnt lgkmcnt(0)
    v_mov_b32 v84, 0x3f803f80
    v_lshlrev_b32 v56, 16, v48
    v_and_b32 v57, 0xffff0000, v48
    v_lshlrev_b32 v80, 16, v24
    s_add_u32 m0, s7, 53248
    s_add_u32 s40, s42, 65536
    buffer_load_dwordx4 v4, s[8:11], s40 offen lds
    v_and_b32 v81, 0xffff0000, v24
    v_mul_f32 v80, v80, v56
    v_mul_f32 v81, v81, v57
    v_dot2_f32_bf16 v74, v24, v40, 0
    v_cvt_pk_bf16_f32 v80, v80, v81
    v_lshlrev_b32 v82, 16, v32
    v_and_b32 v83, 0xffff0000, v32
    v_mul_f32 v82, v82, v56
    s_add_u32 m0, s7, 57344
    s_add_u32 s40, s42, 131072
    buffer_load_dwordx4 v4, s[8:11], s40 offen lds
    v_mul_f32 v83, v83, v57
    v_dot2_f32_bf16 v75, v32, v40, 0
    v_cvt_pk_bf16_f32 v82, v82, v83
    v_dot2_f32_bf16 v72, v80, v84, 0
    v_dot2_f32_bf16 v73, v82, v84, 0
    v_lshlrev_b32 v56, 16, v49
    v_and_b32 v57, 0xffff0000, v49
    v_lshlrev_b32 v80, 16, v25
    s_add_u32 m0, s7, 61440
    s_add_u32 s40, s42, 196608
    buffer_load_dwordx4 v4, s[8:11], s40 offen lds
    v_and_b32 v81, 0xffff0000, v25
    v_mul_f32 v80, v80, v56
    v_mul_f32 v81, v81, v57
    v_dot2_f32_bf16 v74, v25, v41, v74
    v_cvt_pk_bf16_f32 v80, v80, v81
    v_lshlrev_b32 v82, 16, v33
    v_and_b32 v83, 0xffff0000, v33
    v_mul_f32 v82, v82, v56
    s_add_u32 m0, s7, 65536
    s_add_u32 s40, s41, 0
    buffer_load_dwordx4 v5, s[12:15], s40 offen lds
    v_mul_f32 v83, v83, v57
    v_dot2_f32_bf16 v75, v33, v41, v75
    v_cvt_pk_bf16_f32 v82, v82, v83
    v_dot2_f32_bf16 v72, v80, v84, v72
    v_dot2_f32_bf16 v73, v82, v84, v73
    v_lshlrev_b32 v56, 16, v50
    v_and_b32 v57, 0xffff0000, v50
    v_lshlrev_b32 v80, 16, v26
    s_add_u32 m0, s7, 69632
    s_add_u32 s40, s41, 196608
    buffer_load_dwordx4 v5, s[12:15], s40 offen lds
    v_and_b32 v81, 0xffff0000, v26
    v_mul_f32 v80, v80, v56
    v_mul_f32 v81, v81, v57
    v_dot2_f32_bf16 v74, v26, v42, v74
    v_cvt_pk_bf16_f32 v80, v80, v81
    v_lshlrev_b32 v82, 16, v34
    v_and_b32 v83, 0xffff0000, v34
    v_mul_f32 v82, v82, v56
    s_add_u32 m0, s7, 73728
    s_add_u32 s40, s41, 2048
    buffer_load_dwordx4 v5, s[12:15], s40 offen lds
    v_mul_f32 v83, v83, v57
    v_dot2_f32_bf16 v75, v34, v42, v75
    v_cvt_pk_bf16_f32 v82, v82, v83
    v_dot2_f32_bf16 v72, v80, v84, v72
    v_dot2_f32_bf16 v73, v82, v84, v73
    v_lshlrev_b32 v56, 16, v51
    v_and_b32 v57, 0xffff0000, v51
    v_lshlrev_b32 v80, 16, v27
    s_add_u32 m0, s7, 77824
    s_add_u32 s40, s41, 198656
    buffer_load_dwordx4 v5, s[12:15], s40 offen lds
    v_and_b32 v81, 0xffff0000, v27
    v_mul_f32 v80, v80, v56
    v_mul_f32 v81, v81, v57
    v_dot2_f32_bf16 v74, v27, v43, v74
    v_cvt_pk_bf16_f32 v80, v80, v81
    v_lshlrev_b32 v82, 16, v35
    v_and_b32 v83, 0xffff0000, v35
    v_mul_f32 v82, v82, v56
    s_add_u32 m0, s7, 81920
    s_add_u32 s40, s41, 4096
    buffer_load_dwordx4 v5, s[12:15], s40 offen lds
    v_mul_f32 v83, v83, v57
    v_dot2_f32_bf16 v75, v35, v43, v75
    v_cvt_pk_bf16_f32 v82, v82, v83
    v_dot2_f32_bf16 v72, v80, v84, v72
    v_dot2_f32_bf16 v73, v82, v84, v73
    s_add_u32 m0, s7, 86016
    s_add_u32 s40, s41, 200704
    buffer_load_dwordx4 v5, s[12:15], s40 offen lds
    s_waitcnt vmcnt(14)
    s_barrier
    s_add_u32 s41, s74, 5
    s_and_b32 s41, s41, 15
    s_lshl_b32 s42, s41, 7
    s_mul_i32 s41, s41, 393216
    s_add_u32 m0, s7, 90112
    s_add_u32 s40, s42, 0
    buffer_load_dwordx4 v4, s[8:11], s40 offen lds
    v_lshlrev_b32 v56, 16, v52
    v_and_b32 v57, 0xffff0000, v52
    v_lshlrev_b32 v80, 16, v28
    v_and_b32 v81, 0xffff0000, v28
    v_mul_f32 v80, v80, v56
    v_mul_f32 v81, v81, v57
    v_dot2_f32_bf16 v74, v28, v44, v74
    v_cvt_pk_bf16_f32 v80, v80, v81
    s_add_u32 m0, s7, 94208
    s_add_u32 s40, s42, 65536
    buffer_load_dwordx4 v4, s[8:11], s40 offen lds
    v_lshlrev_b32 v82, 16, v36
    v_and_b32 v83, 0xffff0000, v36
    v_mul_f32 v82, v82, v56
    v_mul_f32 v83, v83, v57
    v_dot2_f32_bf16 v75, v36, v44, v75
    v_cvt_pk_bf16_f32 v82, v82, v83
    v_dot2_f32_bf16 v72, v80, v84, v72
    v_dot2_f32_bf16 v73, v82, v84, v73
    s_add_u32 m0, s7, 98304
    s_add_u32 s40, s42, 131072
    buffer_load_dwordx4 v4, s[8:11], s40 offen lds
    v_lshlrev_b32 v56, 16, v53
    v_and_b32 v57, 0xffff0000, v53
    v_lshlrev_b32 v80, 16, v29
    v_and_b32 v81, 0xffff0000, v29
    v_mul_f32 v80, v80, v56
    v_mul_f32 v81, v81, v57
    v_dot2_f32_bf16 v74, v29, v45, v74
    v_cvt_pk_bf16_f32 v80, v80, v81
    s_add_u32 m0, s7, 102400
    s_add_u32 s40, s42, 196608
    buffer_load_dwordx4 v4, s[8:11], s40 offen lds
    v_lshlrev_b32 v82, 16, v37
    v_and_b32 v83, 0xffff0000, v37
    v_mul_f32 v82, v82, v56
    v_mul_f32 v83, v83, v57
    v_dot2_f32_bf16 v75, v37, v45, v75
    v_cvt_pk_bf16_f32 v82, v82, v83
    v_dot2_f32_bf16 v72, v80, v84, v72
    v_dot2_f32_bf16 v73, v82, v84, v73
    s_add_u32 m0, s7, 106496
    s_add_u32 s40, s41, 0
    buffer_load_dwordx4 v5, s[12:15], s40 offen lds
    v_lshlrev_b32 v56, 16, v54
    v_and_b32 v57, 0xffff0000, v54
    v_lshlrev_b32 v80, 16, v30
    v_and_b32 v81, 0xffff0000, v30
    v_mul_f32 v80, v80, v56
    v_mul_f32 v81, v81, v57
    v_dot2_f32_bf16 v74, v30, v46, v74
    v_cvt_pk_bf16_f32 v80, v80, v81
    s_add_u32 m0, s7, 110592
    s_add_u32 s40, s41, 196608
    buffer_load_dwordx4 v5, s[12:15], s40 offen lds
    v_lshlrev_b32 v82, 16, v38
    v_and_b32 v83, 0xffff0000, v38
    v_mul_f32 v82, v82, v56
    v_mul_f32 v83, v83, v57
    v_dot2_f32_bf16 v75, v38, v46, v75
    v_cvt_pk_bf16_f32 v82, v82, v83
    v_dot2_f32_bf16 v72, v80, v84, v72
    v_dot2_f32_bf16 v73, v82, v84, v73
    s_add_u32 m0, s7, 114688
    s_add_u32 s40, s41, 2048
    buffer_load_dwordx4 v5, s[12:15], s40 offen lds
    v_lshlrev_b32 v56, 16, v55
    v_and_b32 v57, 0xffff0000, v55
    v_lshlrev_b32 v80, 16, v31
    v_and_b32 v81, 0xffff0000, v31
    v_mul_f32 v80, v80, v56
    v_mul_f32 v81, v81, v57
    v_dot2_f32_bf16 v74, v31, v47, v74
    v_cvt_pk_bf16_f32 v80, v80, v81
    s_add_u32 m0, s7, 118784
    s_add_u32 s40, s41, 198656
    buffer_load_dwordx4 v5, s[12:15], s40 offen lds
    v_lshlrev_b32 v82, 16, v39
    v_and_b32 v83, 0xffff0000, v39
    v_mul_f32 v82, v82, v56
    v_mul_f32 v83, v83, v57
    v_dot2_f32_bf16 v75, v39, v47, v75
    v_cvt_pk_bf16_f32 v82, v82, v83
    v_dot2_f32_bf16 v72, v80, v84, v72
    v_dot2_f32_bf16 v73, v82, v84, v73
    s_add_u32 m0, s7, 122880
    s_add_u32 s40, s41, 4096
    buffer_load_dwordx4 v5, s[12:15], s40 offen lds
    s_add_u32 m0, s7, 126976
    s_add_u32 s40, s41, 200704
    buffer_load_dwordx4 v5, s[12:15], s40 offen lds
    s_waitcnt vmcnt(10)
    s_barrier
    s_add_u32 s41, s74, 6
    s_and_b32 s41, s41, 15
    s_lshl_b32 s42, s41, 7
    s_mul_i32 s41, s41, 393216
    s_add_u32 m0, s7, 8192
    s_add_u32 s40, s42, 0
    buffer_load_dwordx4 v4, s[8:11], s40 offen lds
    v_permlane32_swap_b32 v72, v74
    v_permlane32_swap_b32 v73, v75
    v_add_f32 v72, v72, v74
    v_add_f32 v73, v73, v75
    s_add_u32 m0, s7, 12288
    s_add_u32 s40, s42, 65536
    buffer_load_dwordx4 v4, s[8:11], s40 offen lds
    s_lshl_b32 s64, s68, 2
    s_add_u32 s64, s64, 6709248
    v_permlane16_swap_b32 v72, v73
    v_add_f32 v72, v72, v73
    s_add_u32 m0, s7, 16384
    s_add_u32 s40, s42, 131072
    buffer_load_dwordx4 v4, s[8:11], s40 offen lds
    v_and_b32 v75, 1, v8
    v_lshl_add_u32 v76, v75, 2, s64
    v_add_f32_dpp v72, v72, v72 quad_perm:[1,0,3,2] row_mask:0xf bank_mask:0xf
    s_nop 1
    s_add_u32 m0, s7, 20480
    s_add_u32 s40, s42, 196608
    buffer_load_dwordx4 v4, s[8:11], s40 offen lds
    v_add_f32_dpp v72, v72, v72 quad_perm:[2,3,0,1] row_mask:0xf bank_mask:0xf
    s_nop 1
    v_add_f32_dpp v72, v72, v72 row_half_mirror row_mask:0xf bank_mask:0xf
    s_nop 1
    s_add_u32 m0, s7, 24576
    s_add_u32 s40, s41, 0
    buffer_load_dwordx4 v5, s[12:15], s40 offen lds
    v_add_f32_dpp v72, v72, v72 row_mirror row_mask:0xf bank_mask:0xf
    s_nop 1
    v_cvt_pk_bf16_f32 v72, v72, v72
    s_sub_u32 s64, 34815, s68
    s_add_u32 m0, s7, 28672
    s_add_u32 s40, s41, 196608
    buffer_load_dwordx4 v5, s[12:15], s40 offen lds
    v_lshlrev_b32 v72, 16, v72
    v_ashrrev_i32 v73, 31, v72
    v_sub_u32 v77, s64, v75
    v_or_b32 v73, 0x80000000, v73
    s_add_u32 m0, s7, 32768
    s_add_u32 s40, s41, 2048
    buffer_load_dwordx4 v5, s[12:15], s40 offen lds
    s_lshl_b32 s64, s6, 3
    v_xor_b32 v73, v72, v73
    v_lshl_add_u32 v75, v75, 2, s64
    v_and_b32 v73, 0xffff0000, v73
    s_add_u32 m0, s7, 36864
    s_add_u32 s40, s41, 198656
    buffer_load_dwordx4 v5, s[12:15], s40 offen lds
    v_or_b32 v73, v77, v73
    v_mul_f32 v72, s72, v72
    v_exp_f32 v72, -v72
    s_nop 0
    s_add_u32 m0, s7, 40960
    s_add_u32 s40, s41, 4096
    buffer_load_dwordx4 v5, s[12:15], s40 offen lds
    v_add_f32 v72, 1.0, v72
    v_rcp_f32 v72, v72
    s_nop 0
    v_cvt_pk_bf16_f32 v72, v72, v72
    s_add_u32 m0, s7, 45056
    s_add_u32 s40, s41, 200704
    buffer_load_dwordx4 v5, s[12:15], s40 offen lds
    v_lshlrev_b32 v72, 16, v72
    s_mov_b32 exec_lo, 0
    s_mov_b32 exec_hi, 0x10001
    ds_write_b32 v75, v73 offset:4224
    s_mov_b32 exec_lo, 0x10001
    s_mov_b32 exec_hi, 0
    buffer_store_dword v72, v76, s[16:19], 0 offen sc0 sc1
    s_mov_b64 exec, -1
    s_mov_b32 exec_lo, 0x3fff3fff
    s_mov_b32 exec_hi, 0x3fff3fff
    s_mov_b32 s64, 0
    buffer_load_dwordx4 v[96:99], v11, s[32:35], s64 offen nt
    s_mov_b32 s64, 0
    buffer_load_dwordx4 v[128:131], v11, s[36:39], s64 offen nt
    s_mov_b32 s64, 7168
    buffer_load_dwordx4 v[100:103], v11, s[32:35], s64 offen nt
    s_mov_b32 s64, 7168
    buffer_load_dwordx4 v[132:135], v11, s[36:39], s64 offen nt
    s_mov_b32 s64, 14336
    buffer_load_dwordx4 v[104:107], v11, s[32:35], s64 offen nt
    s_mov_b64 exec, -1
    s_waitcnt vmcnt(16)
    s_waitcnt lgkmcnt(0)
    s_barrier
    v_mov_b32 v79, 0
    s_cmp_lg_u32 s6, 0
    s_cbranch_scc1 H_nc
    buffer_load_dword v78, v79, s[20:23], 0 offen sc1
H_nc:
    s_add_u32 s41, s74, 7
    s_and_b32 s41, s41, 15
    s_lshl_b32 s42, s41, 7
    s_mul_i32 s41, s41, 393216
    s_add_u32 m0, s7, 49152
    s_add_u32 s40, s42, 0
    buffer_load_dwordx4 v4, s[8:11], s40 offen lds
    s_add_u32 m0, s7, 53248
    s_add_u32 s40, s42, 65536
    buffer_load_dwordx4 v4, s[8:11], s40 offen lds
    s_add_u32 m0, s7, 57344
    s_add_u32 s40, s42, 131072
    buffer_load_dwordx4 v4, s[8:11], s40 offen lds
    s_add_u32 m0, s7, 61440
    s_add_u32 s40, s42, 196608
    buffer_load_dwordx4 v4, s[8:11], s40 offen lds
    s_add_u32 m0, s7, 65536
    s_add_u32 s40, s41, 0
    buffer_load_dwordx4 v5, s[12:15], s40 offen lds
    s_add_u32 m0, s7, 69632
    s_add_u32 s40, s41, 196608
    buffer_load_dwordx4 v5, s[12:15], s40 offen lds
    s_add_u32 m0, s7, 73728
    s_add_u32 s40, s41, 2048
    buffer_load_dwordx4 v5, s[12:15], s40 offen lds
    s_add_u32 m0, s7, 77824
    s_add_u32 s40, s41, 198656
    buffer_load_dwordx4 v5, s[12:15], s40 offen lds
    s_add_u32 m0, s7, 81920
    s_add_u32 s40, s41, 4096
    buffer_load_dwordx4 v5, s[12:15], s40 offen lds
    s_add_u32 m0, s7, 86016
    s_add_u32 s40, s41, 200704
    buffer_load_dwordx4 v5, s[12:15], s40 offen lds
    s_waitcnt vmcnt(16)
    s_barrier
    s_add_u32 s41, s74, 8
    s_and_b32 s41, s41, 15
    s_lshl_b32 s42, s41, 7
    s_mul_i32 s41, s41, 393216
    s_add_u32 m0, s7, 90112
    s_add_u32 s40, s42, 0
    buffer_load_dwordx4 v4, s[8:11], s40 offen lds
    s_add_u32 m0, s7, 94208
    s_add_u32 s40, s42, 65536
    buffer_load_dwordx4 v4, s[8:11], s40 offen lds
    s_add_u32 m0, s7, 98304
    s_add_u32 s40, s42, 131072
    buffer_load_dwordx4 v4, s[8:11], s40 offen lds
    s_add_u32 m0, s7, 102400
    s_add_u32 s40, s42, 196608
    buffer_load_dwordx4 v4, s[8:11], s40 offen lds
    s_add_u32 m0, s7, 106496
    s_add_u32 s40, s41, 0
    buffer_load_dwordx4 v5, s[12:15], s40 offen lds
    s_add_u32 m0, s7, 110592
    s_add_u32 s40, s41, 196608
    buffer_load_dwordx4 v5, s[12:15], s40 offen lds
    s_add_u32 m0, s7, 114688
    s_add_u32 s40, s41, 2048
    buffer_load_dwordx4 v5, s[12:15], s40 offen lds
    s_add_u32 m0, s7, 118784
    s_add_u32 s40, s41, 198656
    buffer_load_dwordx4 v5, s[12:15], s40 offen lds
    s_add_u32 m0, s7, 122880
    s_add_u32 s40, s41, 4096
    buffer_load_dwordx4 v5, s[12:15], s40 offen lds
    s_add_u32 m0, s7, 126976
    s_add_u32 s40, s41, 200704
    buffer_load_dwordx4 v5, s[12:15], s40 offen lds
    s_waitcnt vmcnt(10)
    s_barrier
    s_add_u32 s41, s74, 9
    s_and_b32 s41, s41, 15
    s_lshl_b32 s42, s41, 7
    s_mul_i32 s41, s41, 393216
    s_add_u32 m0, s7, 8192
    s_add_u32 s40, s42, 0
    buffer_load_dwordx4 v4, s[8:11], s40 offen lds
    s_add_u32 m0, s7, 12288
    s_add_u32 s40, s42, 65536
    buffer_load_dwordx4 v4, s[8:11], s40 offen lds
    s_add_u32 m0, s7, 16384
    s_add_u32 s40, s42, 131072
    buffer_load_dwordx4 v4, s[8:11], s40 offen lds
    s_add_u32 m0, s7, 20480
    s_add_u32 s40, s42, 196608
    buffer_load_dwordx4 v4, s[8:11], s40 offen lds
    s_add_u32 m0, s7, 24576
    s_add_u32 s40, s41, 0
    buffer_load_dwordx4 v5, s[12:15], s40 offen lds
    s_add_u32 m0, s7, 28672
    s_add_u32 s40, s41, 196608
    buffer_load_dwordx4 v5, s[12:15], s40 offen lds
    s_add_u32 m0, s7, 32768
    s_add_u32 s40, s41, 2048
    buffer_load_dwordx4 v5, s[12:15], s40 offen lds
    s_add_u32 m0, s7, 36864
    s_add_u32 s40, s41, 198656
    buffer_load_dwordx4 v5, s[12:15], s40 offen lds
    s_add_u32 m0, s7, 40960
    s_add_u32 s40, s41, 4096
    buffer_load_dwordx4 v5, s[12:15], s40 offen lds
    s_add_u32 m0, s7, 45056
    s_add_u32 s40, s41, 200704
    buffer_load_dwordx4 v5, s[12:15], s40 offen lds
    s_cmp_lg_u32 s6, 0
    s_cbranch_scc1 H_nk
    v_mov_b32 v3, 4224
    ds_read_b128 v[72:75], v3
    ds_read_b128 v[60:63], v3 offset:16
    s_mov_b32 s65, 0
H_nspin:
    v_readfirstlane_b32 s71, v78
    s_cmp_eq_u32 s71, 0
    s_cbranch_scc1 H_nre
H_nok:
    s_lshl_b32 s64, s2, 3
    s_add_u32 s64, s64, 6717440
    v_mov_b32 v3, s64
    s_waitcnt lgkmcnt(0)
    v_max3_u32 v72, v72, v73, v74
    v_max3_u32 v60, v60, v61, v62
    v_max3_u32 v72, v72, v75, v63
    v_max_u32 v72, v72, v60
    v_xor_b32 v73, s71, v72
    s_mov_b64 exec, 1
    buffer_store_dwordx2 v[72:73], v3, s[16:19], 0 offen sc0 sc1
    s_mov_b64 exec, -1
H_nk:
    s_mov_b32 exec_lo, 0x3fff3fff
    s_mov_b32 exec_hi, 0x3fff3fff
    s_mov_b32 s64, 14336
    buffer_load_dwordx4 v[136:139], v11, s[36:39], s64 offen nt
    s_mov_b32 s64, 21504
    buffer_load_dwordx4 v[108:111], v11, s[32:35], s64 offen nt
    s_mov_b32 s64, 21504
    buffer_load_dwordx4 v[140:143], v11, s[36:39], s64 offen nt
    s_mov_b32 s64, 28672
    buffer_load_dwordx4 v[112:115], v11, s[32:35], s64 offen nt
    s_mov_b32 s64, 28672
    buffer_load_dwordx4 v[144:147], v11, s[36:39], s64 offen nt
    s_mov_b64 exec, -1
    s_waitcnt vmcnt(15)
    s_barrier
    s_add_u32 s41, s74, 10
    s_and_b32 s41, s41, 15
    s_lshl_b32 s42, s41, 7
    s_mul_i32 s41, s41, 393216
    s_add_u32 m0, s7, 49152
    s_add_u32 s40, s42, 0
    buffer_load_dwordx4 v4, s[8:11], s40 offen lds
    s_add_u32 m0, s7, 53248
    s_add_u32 s40, s42, 65536
    buffer_load_dwordx4 v4, s[8:11], s40 offen lds
    s_add_u32 m0, s7, 57344
    s_add_u32 s40, s42, 131072
    buffer_load_dwordx4 v4, s[8:11], s40 offen lds
    s_add_u32 m0, s7, 61440
    s_add_u32 s40, s42, 196608
    buffer_load_dwordx4 v4, s[8:11], s40 offen lds
    s_add_u32 m0, s7, 65536
    s_add_u32 s40, s41, 0
    buffer_load_dwordx4 v5, s[12:15], s40 offen lds
    s_add_u32 m0, s7, 69632
    s_add_u32 s40, s41, 196608
    buffer_load_dwordx4 v5, s[12:15], s40 offen lds
    s_add_u32 m0, s7, 73728
    s_add_u32 s40, s41, 2048
    buffer_load_dwordx4 v5, s[12:15], s40 offen lds
    s_add_u32 m0, s7, 77824
    s_add_u32 s40, s41, 198656
    buffer_load_dwordx4 v5, s[12:15], s40 offen lds
    s_add_u32 m0, s7, 81920
    s_add_u32 s40, s41, 4096
    buffer_load_dwordx4 v5, s[12:15], s40 offen lds
    s_add_u32 m0, s7, 86016
    s_add_u32 s40, s41, 200704
    buffer_load_dwordx4 v5, s[12:15], s40 offen lds
    s_lshl_b32 s64, s2, 2
    s_add_u32 s64, s64, s6
    s_mul_i32 s64, s64, 2048
    s_add_u32 s46, s44, s64
    s_addc_u32 s47, s45, 0
    s_load_dword s43, s[46:47], 384
    s_load_dword s43, s[46:47], 448
    s_load_dword s43, s[46:47], 1408
    s_load_dword s43, s[46:47], 1472
    s_waitcnt vmcnt(15)
    s_barrier
    s_add_u32 s41, s74, 11
    s_and_b32 s41, s41, 15
    s_lshl_b32 s42, s41, 7
    s_mul_i32 s41, s41, 393216
    s_add_u32 m0, s7, 90112
    s_add_u32 s40, s42, 0
    buffer_load_dwordx4 v4, s[8:11], s40 offen lds
    s_add_u32 m0, s7, 94208
    s_add_u32 s40, s42, 65536
    buffer_load_dwordx4 v4, s[8:11], s40 offen lds
    s_add_u32 m0, s7, 98304
    s_add_u32 s40, s42, 131072
    buffer_load_dwordx4 v4, s[8:11], s40 offen lds
    s_add_u32 m0, s7, 102400
    s_add_u32 s40, s42, 196608
    buffer_load_dwordx4 v4, s[8:11], s40 offen lds
    s_add_u32 m0, s7, 106496
    s_add_u32 s40, s41, 0
    buffer_load_dwordx4 v5, s[12:15], s40 offen lds
    s_add_u32 m0, s7, 110592
    s_add_u32 s40, s41, 196608
    buffer_load_dwordx4 v5, s[12:15], s40 offen lds
    s_add_u32 m0, s7, 114688
    s_add_u32 s40, s41, 2048
    buffer_load_dwordx4 v5, s[12:15], s40 offen lds
    s_add_u32 m0, s7, 118784
    s_add_u32 s40, s41, 198656
    buffer_load_dwordx4 v5, s[12:15], s40 offen lds
    s_add_u32 m0, s7, 122880
    s_add_u32 s40, s41, 4096
    buffer_load_dwordx4 v5, s[12:15], s40 offen lds
    s_add_u32 m0, s7, 126976
    s_add_u32 s40, s41, 200704
    buffer_load_dwordx4 v5, s[12:15], s40 offen lds
    s_waitcnt vmcnt(10)
    s_barrier
    s_add_u32 s41, s74, 12
    s_and_b32 s41, s41, 15
    s_lshl_b32 s42, s41, 7
    s_mul_i32 s41, s41, 393216
    s_add_u32 m0, s7, 8192
    s_add_u32 s40, s42, 0
    buffer_load_dwordx4 v4, s[8:11], s40 offen lds
    s_add_u32 m0, s7, 12288
    s_add_u32 s40, s42, 65536
    buffer_load_dwordx4 v4, s[8:11], s40 offen lds
    s_add_u32 m0, s7, 16384
    s_add_u32 s40, s42, 131072
    buffer_load_dwordx4 v4, s[8:11], s40 offen lds
    s_add_u32 m0, s7, 20480
    s_add_u32 s40, s42, 196608
    buffer_load_dwordx4 v4, s[8:11], s40 offen lds
    s_add_u32 m0, s7, 24576
    s_add_u32 s40, s41, 0
    buffer_load_dwordx4 v5, s[12:15], s40 offen lds
    s_add_u32 m0, s7, 28672
    s_add_u32 s40, s41, 196608
    buffer_load_dwordx4 v5, s[12:15], s40 offen lds
    s_add_u32 m0, s7, 32768
    s_add_u32 s40, s41, 2048
    buffer_load_dwordx4 v5, s[12:15], s40 offen lds
    s_add_u32 m0, s7, 36864
    s_add_u32 s40, s41, 198656
    buffer_load_dwordx4 v5, s[12:15], s40 offen lds
    s_add_u32 m0, s7, 40960
    s_add_u32 s40, s41, 4096
    buffer_load_dwordx4 v5, s[12:15], s40 offen lds
    s_add_u32 m0, s7, 45056
    s_add_u32 s40, s41, 200704
    buffer_load_dwordx4 v5, s[12:15], s40 offen lds
    s_mov_b32 exec_lo, 0x3fff3fff
    s_mov_b32 exec_hi, 0x3fff3fff
    s_mov_b32 s64, 35840
    buffer_load_dwordx4 v[116:119], v11, s[32:35], s64 offen nt
    s_mov_b32 s64, 35840
    buffer_load_dwordx4 v[148:151], v11, s[36:39], s64 offen nt
    s_mov_b32 s64, 43008
    buffer_load_dwordx4 v[120:123], v11, s[32:35], s64 offen nt
    s_mov_b32 s64, 43008
    buffer_load_dwordx4 v[152:155], v11, s[36:39], s64 offen nt
    s_mov_b32 s64, 50176
    buffer_load_dwordx4 v[124:127], v11, s[32:35], s64 offen nt
    s_mov_b32 s64, 50176
    buffer_load_dwordx4 v[156:159], v11, s[36:39], s64 offen nt
    s_mov_b64 exec, -1
    s_waitcnt vmcnt(16)
    s_barrier
    s_cmp_lg_u32 s6, 0
    s_cbranch_scc1 H_np
    s_mov_b32 s64, 6717440
    buffer_load_dwordx4 v[24:27], v6, s[16:19], s64 offen offset:0 sc1
    buffer_load_dwordx4 v[28:31], v6, s[16:19], s64 offen offset:1024 sc1
H_np:
    s_add_u32 s41, s74, 13
    s_and_b32 s41, s41, 15
    s_lshl_b32 s42, s41, 7
    s_mul_i32 s41, s41, 393216
    s_add_u32 m0, s7, 49152
    s_add_u32 s40, s42, 0
    buffer_load_dwordx4 v4, s[8:11], s40 offen lds
    s_add_u32 m0, s7, 53248
    s_add_u32 s40, s42, 65536
    buffer_load_dwordx4 v4, s[8:11], s40 offen lds
    s_add_u32 m0, s7, 57344
    s_add_u32 s40, s42, 131072
    buffer_load_dwordx4 v4, s[8:11], s40 offen lds
    s_add_u32 m0, s7, 61440
    s_add_u32 s40, s42, 196608
    buffer_load_dwordx4 v4, s[8:11], s40 offen lds
    s_add_u32 m0, s7, 65536
    s_add_u32 s40, s41, 0
    buffer_load_dwordx4 v5, s[12:15], s40 offen lds
    s_add_u32 m0, s7, 69632
    s_add_u32 s40, s41, 196608
    buffer_load_dwordx4 v5, s[12:15], s40 offen lds
    s_add_u32 m0, s7, 73728
    s_add_u32 s40, s41, 2048
    buffer_load_dwordx4 v5, s[12:15], s40 offen lds
    s_add_u32 m0, s7, 77824
    s_add_u32 s40, s41, 198656
    buffer_load_dwordx4 v5, s[12:15], s40 offen lds
    s_add_u32 m0, s7, 81920
    s_add_u32 s40, s41, 4096
    buffer_load_dwordx4 v5, s[12:15], s40 offen lds
    s_add_u32 m0, s7, 86016
    s_add_u32 s40, s41, 200704
    buffer_load_dwordx4 v5, s[12:15], s40 offen lds
    s_waitcnt vmcnt(16)
    s_barrier
    s_cmp_lg_u32 s6, 0
    s_cbranch_scc1 H_nq
    s_waitcnt vmcnt(10)
    s_mov_b32 s65, 0
H_spin:
    v_xor_b32 v25, v24, v25
    v_xor_b32 v27, v26, v27
    v_xor_b32 v29, v28, v29
    v_xor_b32 v31, v30, v31
    v_xor_b32 v3, s71, v25
    v_xor_b32 v7, s71, v27
    v_xor_b32 v25, s71, v29
    v_xor_b32 v27, s71, v31
    v_or3_b32 v3, v3, v7, v25
    v_or_b32 v3, v3, v27
    v_cmp_ne_u32 vcc, 0, v3
    s_cbranch_vccnz H_retry
H_nq:
    s_add_u32 s41, s74, 14
    s_and_b32 s41, s41, 15
    s_lshl_b32 s42, s41, 7
    s_mul_i32 s41, s41, 393216
    s_add_u32 m0, s7, 90112
    s_add_u32 s40, s42, 0
    buffer_load_dwordx4 v4, s[8:11], s40 offen lds
    v_max_u32 v3, v24, v26
    v_max3_u32 v3, v3, v28, v30
    s_nop 1
    v_max_u32_dpp v3, v3, v3 quad_perm:[1,0,3,2] row_mask:0xf bank_mask:0xf
    s_add_u32 m0, s7, 94208
    s_add_u32 s40, s42, 65536
    buffer_load_dwordx4 v4, s[8:11], s40 offen lds
    s_nop 1
    v_max_u32_dpp v3, v3, v3 quad_perm:[2,3,0,1] row_mask:0xf bank_mask:0xf
    s_nop 1
    v_max_u32_dpp v3, v3, v3 row_half_mirror row_mask:0xf bank_mask:0xf
    s_add_u32 m0, s7, 98304
    s_add_u32 s40, s42, 131072
    buffer_load_dwordx4 v4, s[8:11], s40 offen lds
    s_nop 1
    v_max_u32_dpp v3, v3, v3 row_mirror row_mask:0xf bank_mask:0xf
    s_nop 1
    v_mov_b32 v7, v3
    s_add_u32 m0, s7, 102400
    s_add_u32 s40, s42, 196608
    buffer_load_dwordx4 v4, s[8:11], s40 offen lds
    s_nop 1
    v_permlane16_swap_b32 v3, v7
    v_max_u32 v3, v3, v7
    v_mov_b32 v7, v3
    s_add_u32 m0, s7, 106496
    s_add_u32 s40, s41, 0
    buffer_load_dwordx4 v5, s[12:15], s40 offen lds
    s_nop 1
    v_permlane32_swap_b32 v3, v7
    v_max_u32 v3, v3, v7
    v_mov_b32 v7, 4256
    s_add_u32 m0, s7, 110592
    s_add_u32 s40, s41, 196608
    buffer_load_dwordx4 v5, s[12:15], s40 offen lds
    s_add_u32 m0, s7, 114688
    s_add_u32 s40, s41, 2048
    buffer_load_dwordx4 v5, s[12:15], s40 offen lds
    s_add_u32 m0, s7, 118784
    s_add_u32 s40, s41, 198656
    buffer_load_dwordx4 v5, s[12:15], s40 offen lds
    s_add_u32 m0, s7, 122880
    s_add_u32 s40, s41, 4096
    buffer_load_dwordx4 v5, s[12:15], s40 offen lds
    s_add_u32 m0, s7, 126976
    s_add_u32 s40, s41, 200704
    buffer_load_dwordx4 v5, s[12:15], s40 offen lds
    s_cmp_lg_u32 s6, 0
    s_cbranch_scc1 H_nw
    ds_write_b32 v7, v3
H_nw:
    s_waitcnt vmcnt(10)
    s_waitcnt lgkmcnt(0)
    s_barrier
    v_mov_b32 v7, 4256
    ds_read_b32 v3, v7
    s_lshl_b32 s65, s69, 6
    v_lshl_add_u32 v7, v8, 4, s65
    s_waitcnt lgkmcnt(0)
    v_readfirstlane_b32 s75, v3
    s_nop 3
    s_and_b32 s64, s75, 0x7ff
    s_sub_u32 s64, 2047, s64
    s_lshl_b32 s64, s64, 11
    buffer_load_dwordx4 v[88:91], v7, s[8:11], s64 offen
    s_add_u32 s41, s74, 15
    s_and_b32 s41, s41, 15
    s_lshl_b32 s42, s41, 7
    s_mul_i32 s41, s41, 393216
    s_add_u32 m0, s7, 8192
    s_add_u32 s40, s42, 0
    buffer_load_dwordx4 v4, s[8:11], s40 offen lds
    s_add_u32 m0, s7, 12288
    s_add_u32 s40, s42, 65536
    buffer_load_dwordx4 v4, s[8:11], s40 offen lds
    s_add_u32 m0, s7, 16384
    s_add_u32 s40, s42, 131072
    buffer_load_dwordx4 v4, s[8:11], s40 offen lds
    s_add_u32 m0, s7, 20480
    s_add_u32 s40, s42, 196608
    buffer_load_dwordx4 v4, s[8:11], s40 offen lds
    s_add_u32 m0, s7, 24576
    s_add_u32 s40, s41, 0
    buffer_load_dwordx4 v5, s[12:15], s40 offen lds
    s_add_u32 m0, s7, 28672
    s_add_u32 s40, s41, 196608
    buffer_load_dwordx4 v5, s[12:15], s40 offen lds
    s_add_u32 m0, s7, 32768
    s_add_u32 s40, s41, 2048
    buffer_load_dwordx4 v5, s[12:15], s40 offen lds
    s_add_u32 m0, s7, 36864
    s_add_u32 s40, s41, 198656
    buffer_load_dwordx4 v5, s[12:15], s40 offen lds
    s_add_u32 m0, s7, 40960
    s_add_u32 s40, s41, 4096
    buffer_load_dwordx4 v5, s[12:15], s40 offen lds
    s_add_u32 m0, s7, 45056
    s_add_u32 s40, s41, 200704
    buffer_load_dwordx4 v5, s[12:15], s40 offen lds
    s_mov_b32 s24, s54
    s_mov_b32 s25, s55
    s_mov_b32 s26, 0x700000
    s_mov_b32 s27, 0x00020000
    s_lshr_b32 s64, s2, 2
    s_mul_i32 s64, s64, 114688
    s_and_b32 s65, s2, 3
    s_lshl_b32 s65, s65, 9
    s_add_u32 s64, s64, s65
    s_lshl_b32 s65, s6, 7
    s_add_u32 s64, s64, s65
    v_lshrrev_b32 v7, 3, v2
    v_lshlrev_b32 v7, 11, v7
    v_and_b32 v9, 7, v2
    v_lshl_add_u32 v7, v9, 4, v7
    v_add_u32 v21, s64, v7
    s_mov_b32 s64, 0
    buffer_load_dwordx4 v[192:195], v21, s[24:27], s64 offen nt
    s_mov_b32 s64, 16384
    buffer_load_dwordx4 v[196:199], v21, s[24:27], s64 offen nt
    s_mov_b32 s64, 32768
    buffer_load_dwordx4 v[200:203], v21, s[24:27], s64 offen nt
    s_mov_b32 s64, 49152
    buffer_load_dwordx4 v[204:207], v21, s[24:27], s64 offen nt
    s_mov_b32 s64, 65536
    buffer_load_dwordx4 v[208:211], v21, s[24:27], s64 offen nt
    s_mov_b32 s64, 81920
    buffer_load_dwordx4 v[212:215], v21, s[24:27], s64 offen nt
    s_mov_b32 s64, 98304
    buffer_load_dwordx4 v[216:219], v21, s[24:27], s64 offen nt
    s_waitcnt vmcnt(18)
    s_barrier
    s_waitcnt vmcnt(17)
    s_and_b32 s64, s2, 7
    s_lshr_b32 s65, s2, 3
    s_and_b32 s4, s64, 3
    s_lshl_b32 s4, s4, 2
    s_and_b32 s66, s65, 3
    s_add_u32 s4, s4, s66
    s_lshr_b32 s5, s64, 2
    s_lshl_b32 s5, s5, 3
    s_lshr_b32 s66, s65, 2
    s_add_u32 s5, s5, s66
    s_mov_b32 s28, s44
    s_mov_b32 s29, s45
    s_mov_b32 s30, 0x200000
    s_mov_b32 s31, 0x00020000
    v_lshrrev_b32 v7, 3, v2
    s_lshl_b32 s64, s6, 3
    v_add_u32 v7, s64, v7
    v_lshlrev_b32 v7, 11, v7
    v_lshrrev_b32 v9, 4, v2
    v_lshlrev_b32 v9, 1, v9
    v_and_b32 v10, 7, v2
    v_xor_b32 v9, v9, v10
    v_lshl_add_u32 v7, v9, 4, v7
    s_lshl_b32 s64, s5, 7
    v_add_u32 v10, s64, v7
    s_add_u32 m0, s7, 131072
    s_mov_b32 s40, 0
    buffer_load_dwordx4 v10, s[28:31], s40 offen lds
    v_and_b32 v48, 15, v2
    v_and_b32 v49, 1, v2
    v_lshlrev_b32 v49, 4, v49
    v_mov_b32 v50, 0xffff
    v_lshlrev_b32 v49, v49, v50
    v_lshrrev_b32 v48, 1, v48
    v_cmp_eq_u32 vcc, 0, v48
    s_nop 1
    v_cndmask_b32 v40, 0, v49, vcc
    v_cmp_eq_u32 vcc, 1, v48
    s_nop 1
    v_cndmask_b32 v41, 0, v49, vcc
    v_cmp_eq_u32 vcc, 2, v48
    s_nop 1
    v_cndmask_b32 v42, 0, v49, vcc
    v_cmp_eq_u32 vcc, 3, v48
    s_nop 1
    v_cndmask_b32 v43, 0, v49, vcc
    s_mov_b32 s64, 0x01000100
    s_mov_b32 s65, 0x03020302
    v_perm_b32 v48, v88, v88, s64
    v_and_b32 v44, v48, v40
    v_and_b32 v45, v48, v41
    v_and_b32 v46, v48, v42
    s_add_u32 m0, s7, 135168
    s_mov_b32 s40, 65536
    buffer_load_dwordx4 v10, s[28:31], s40 offen lds
    v_and_b32 v47, v48, v43
    s_nop 1
    v_mfma_f32_16x16x32_bf16 v[32:35], v[44:47], v[96:99], 0
    v_mfma_f32_16x16x32_bf16 v[36:39], v[44:47], v[128:131], 0
    v_perm_b32 v48, v88, v88, s65
    v_and_b32 v52, v48, v40
    v_and_b32 v53, v48, v41
    v_and_b32 v54, v48, v42
    v_and_b32 v55, v48, v43
    s_nop 1
    v_mfma_f32_16x16x32_bf16 v[32:35], v[52:55], v[100:103], v[32:35]
    v_mfma_f32_16x16x32_bf16 v[36:39], v[52:55], v[132:135], v[36:39]
    v_perm_b32 v48, v89, v89, s64
    v_and_b32 v44, v48, v40
    v_and_b32 v45, v48, v41
    v_and_b32 v46, v48, v42
    v_and_b32 v47, v48, v43
    s_nop 1
    v_mfma_f32_16x16x32_bf16 v[32:35], v[44:47], v[104:107], v[32:35]
    v_mfma_f32_16x16x32_bf16 v[36:39], v[44:47], v[136:139], v[36:39]
    v_perm_b32 v48, v89, v89, s65
    v_and_b32 v52, v48, v40
    v_and_b32 v53, v48, v41
    v_and_b32 v54, v48, v42
    s_add_u32 m0, s7, 147456
    s_mov_b32 s40, 1048576
    buffer_load_dwordx4 v10, s[28:31], s40 offen lds
    v_and_b32 v55, v48, v43
    s_nop 1
    v_mfma_f32_16x16x32_bf16 v[32:35], v[52:55], v[108:111], v[32:35]
    v_mfma_f32_16x16x32_bf16 v[36:39], v[52:55], v[140:143], v[36:39]
    v_perm_b32 v48, v90, v90, s64
    v_and_b32 v44, v48, v40
    v_and_b32 v45, v48, v41
    v_and_b32 v46, v48, v42
    v_and_b32 v47, v48, v43
    s_nop 1
    v_mfma_f32_16x16x32_bf16 v[32:35], v[44:47], v[112:115], v[32:35]
    v_mfma_f32_16x16x32_bf16 v[36:39], v[44:47], v[144:147], v[36:39]
    v_perm_b32 v48, v90, v90, s65
    v_and_b32 v52, v48, v40
    v_and_b32 v53, v48, v41
    v_and_b32 v54, v48, v42
    v_and_b32 v55, v48, v43
    s_nop 1
    v_mfma_f32_16x16x32_bf16 v[32:35], v[52:55], v[116:119], v[32:35]
    v_mfma_f32_16x16x32_bf16 v[36:39], v[52:55], v[148:151], v[36:39]
    v_perm_b32 v48, v91, v91, s64
    v_and_b32 v44, v48, v40
    v_and_b32 v45, v48, v41
    v_and_b32 v46, v48, v42
    s_add_u32 m0, s7, 151552
    s_mov_b32 s40, 1114112
    buffer_load_dwordx4 v10, s[28:31], s40 offen lds
    v_and_b32 v47, v48, v43
    s_nop 1
    v_mfma_f32_16x16x32_bf16 v[32:35], v[44:47], v[120:123], v[32:35]
    v_mfma_f32_16x16x32_bf16 v[36:39], v[44:47], v[152:155], v[36:39]
    v_perm_b32 v48, v91, v91, s65
    v_and_b32 v52, v48, v40
    v_and_b32 v53, v48, v41
    v_and_b32 v54, v48, v42
    v_and_b32 v55, v48, v43
    s_nop 1
    v_mfma_f32_16x16x32_bf16 v[32:35], v[52:55], v[124:127], v[32:35]
    v_mfma_f32_16x16x32_bf16 v[36:39], v[52:55], v[156:159], v[36:39]
    s_nop 7
    v_permlane32_swap_b32 v32, v36
    v_permlane32_swap_b32 v33, v37
    v_permlane32_swap_b32 v34, v38
    v_permlane32_swap_b32 v35, v39
    s_mov_b32 exec_lo, 0x3fff3fff
    s_mov_b32 exec_hi, 0x3fff3fff
    buffer_store_dwordx4 v[32:35], v12, s[16:19], 0 offen sc0 sc1
    s_mov_b64 exec, -1
    s_waitcnt vmcnt(12)
    s_barrier
    s_add_u32 m0, s7, 139264
    s_mov_b32 s40, 131072
    buffer_load_dwordx4 v10, s[28:31], s40 offen lds
    s_add_u32 m0, s7, 143360
    s_mov_b32 s40, 196608
    buffer_load_dwordx4 v10, s[28:31], s40 offen lds
    s_add_u32 m0, s7, 155648
    s_mov_b32 s40, 1179648
    buffer_load_dwordx4 v10, s[28:31], s40 offen lds
    s_add_u32 m0, s7, 159744
    s_mov_b32 s40, 1245184
    buffer_load_dwordx4 v10, s[28:31], s40 offen lds
    s_add_u32 m0, s7, 73728
    s_mov_b32 s40, 262144
    buffer_load_dwordx4 v10, s[28:31], s40 offen lds
    s_add_u32 m0, s7, 77824
    s_mov_b32 s40, 327680
    buffer_load_dwordx4 v10, s[28:31], s40 offen lds
    s_add_u32 m0, s7, 81920
    s_mov_b32 s40, 1310720
    buffer_load_dwordx4 v10, s[28:31], s40 offen lds
    s_add_u32 m0, s7, 86016
    s_mov_b32 s40, 1376256
    buffer_load_dwordx4 v10, s[28:31], s40 offen lds
    s_barrier
    s_and_b32 s64, s3, 3
    s_lshl_b32 s64, s64, 1
    s_lshr_b32 s65, s3, 2
    s_add_u32 s64, s64, s65
    s_lshl_b32 s64, s64, 4
    s_lshl_b32 s65, s4, 7
    s_add_u32 s64, s64, s65
    v_and_b32 v230, 15, v2
    v_add_u32 v230, s64, v230
    v_bfe_u32 v3, v2, 4, 1
    v_lshlrev_b32 v229, 5, v3
    v_lshrrev_b32 v3, 5, v2
    v_lshl_add_u32 v229, v3, 4, v229
    v_lshl_add_u32 v231, v230, 11, v229
    s_lshl_b32 s64, s5, 7
    v_add_u32 v231, s64, v231
    v_lshlrev_b32 v3, 2, v230
    v_add_u32 v3, 6709248, v3
    buffer_load_dwordx4 v[220:223], v231, s[8:11], 0 offen
    buffer_load_dwordx4 v[224:227], v231, s[8:11], 0 offen offset:64
    buffer_load_dword v228, v3, s[16:19], 0 offen sc1
    s_add_u32 m0, s7, 114688
    s_mov_b32 s40, 393216
    buffer_load_dwordx4 v10, s[28:31], s40 offen lds
    s_add_u32 m0, s7, 118784
    s_mov_b32 s40, 458752
    buffer_load_dwordx4 v10, s[28:31], s40 offen lds
    s_add_u32 m0, s7, 122880
    s_mov_b32 s40, 1441792
    buffer_load_dwordx4 v10, s[28:31], s40 offen lds
    s_add_u32 m0, s7, 126976
    s_mov_b32 s40, 1507328
    buffer_load_dwordx4 v10, s[28:31], s40 offen lds
    s_add_u32 m0, s7, 40960
    s_mov_b32 s40, 524288
    buffer_load_dwordx4 v10, s[28:31], s40 offen lds
    s_add_u32 m0, s7, 45056
    s_mov_b32 s40, 589824
    buffer_load_dwordx4 v10, s[28:31], s40 offen lds
    s_add_u32 m0, s7, 49152
    s_mov_b32 s40, 1572864
    buffer_load_dwordx4 v10, s[28:31], s40 offen lds
    s_add_u32 m0, s7, 53248
    s_mov_b32 s40, 1638400
    buffer_load_dwordx4 v10, s[28:31], s40 offen lds
    s_add_u32 m0, s7, 8192
    s_mov_b32 s40, 655360
    buffer_load_dwordx4 v10, s[28:31], s40 offen lds
    s_add_u32 m0, s7, 12288
    s_mov_b32 s40, 720896
    buffer_load_dwordx4 v10, s[28:31], s40 offen lds
    s_add_u32 m0, s7, 57344
    s_mov_b32 s40, 1703936
    buffer_load_dwordx4 v10, s[28:31], s40 offen lds
    s_add_u32 m0, s7, 61440
    s_mov_b32 s40, 1769472
    buffer_load_dwordx4 v10, s[28:31], s40 offen lds
    s_add_u32 m0, s7, 16384
    s_mov_b32 s40, 786432
    buffer_load_dwordx4 v10, s[28:31], s40 offen lds
    s_add_u32 m0, s7, 20480
    s_mov_b32 s40, 851968
    buffer_load_dwordx4 v10, s[28:31], s40 offen lds
    s_add_u32 m0, s7, 65536
    s_mov_b32 s40, 1835008
    buffer_load_dwordx4 v10, s[28:31], s40 offen lds
    s_add_u32 m0, s7, 69632
    s_mov_b32 s40, 1900544
    buffer_load_dwordx4 v10, s[28:31], s40 offen lds
    s_add_u32 m0, s7, 98304
    s_mov_b32 s40, 917504
    buffer_load_dwordx4 v10, s[28:31], s40 offen lds
    s_add_u32 m0, s7, 102400
    s_mov_b32 s40, 983040
    buffer_load_dwordx4 v10, s[28:31], s40 offen lds
    s_add_u32 m0, s7, 90112
    s_mov_b32 s40, 1966080
    buffer_load_dwordx4 v10, s[28:31], s40 offen lds
    s_add_u32 m0, s7, 94208
    s_mov_b32 s40, 2031616
    buffer_load_dwordx4 v10, s[28:31], s40 offen lds
    s_mov_b64 exec, 1
    v_mov_b32 v20, 0
    buffer_atomic_or v20, v23, s[16:19], 0 offen sc0
    s_mov_b64 exec, -1
    v_lshlrev_b32 v17, 4, v2
    v_add_u32 v17, s70, v17
    v_lshrrev_b32 v18, 2, v2
    v_mul_u32_u24 v18, 1152, v18
    v_and_b32 v19, 3, v2
    v_lshl_add_u32 v18, v19, 4, v18
    s_add_u32 s64, s70, 1024
    v_add_u32 v18, s64, v18
    v_bfe_u32 v26, v2, 3, 1
    v_lshl_add_u32 v26, v26, 2, v19
    v_bfe_u32 v27, v2, 2, 1
    v_lshrrev_b32 v28, 5, v2
    v_cmp_eq_u32 vcc, v27, v28
    v_and_b32 v27, 16, v2
    v_cmp_eq_u32 s[64:65], 0, v27
    s_and_b64 vcc, vcc, s[64:65]
    v_and_b32 v27, 1, v26
    v_lshlrev_b32 v27, 4, v27
    v_mov_b32 v28, 0x3f80
    v_lshlrev_b32 v27, v27, v28
    v_cndmask_b32 v27, 0, v27, vcc
    v_lshrrev_b32 v26, 1, v26
    v_cmp_eq_u32 vcc, 0, v26
    s_nop 1
    v_cndmask_b32 v48, 0, v27, vcc
    v_cmp_eq_u32 vcc, 1, v26
    s_nop 1
    v_cndmask_b32 v49, 0, v27, vcc
    v_cmp_eq_u32 vcc, 2, v26
    s_nop 1
    v_cndmask_b32 v50, 0, v27, vcc
    v_cmp_eq_u32 vcc, 3, v26
    s_nop 1
    v_cndmask_b32 v51, 0, v27, vcc
    v_mov_b32 v128, 0
    v_mov_b32 v129, 0
    v_mov_b32 v130, 0
    v_mov_b32 v131, 0
    v_mov_b32 v132, 0
    v_mov_b32 v133, 0
    v_mov_b32 v134, 0
    v_mov_b32 v135, 0
    v_mov_b32 v136, 0
    v_mov_b32 v137, 0
    v_mov_b32 v138, 0
    v_mov_b32 v139, 0
    v_mov_b32 v140, 0
    v_mov_b32 v141, 0
    v_mov_b32 v142, 0
    v_mov_b32 v143, 0
    s_mov_b32 s66, 0xffff
    s_mov_b32 s65, 0
    s_waitcnt vmcnt(21)
    v_sub_f32 v248, 1.0, v228
    v_cvt_pk_bf16_f32 v248, v248, v248
    v_lshlrev_b32 v248, 16, v248
    v_lshlrev_b32 v232, 16, v220
    v_and_b32 v233, 0xffff0000, v220
    v_mul_f32 v232, v232, v248
    v_mul_f32 v233, v233, v248
    v_cvt_pk_bf16_f32 v3, v232, v233
    v_lshlrev_b32 v232, 16, v3
    v_and_b32 v233, 0xffff0000, v3
    v_lshlrev_b32 v234, 16, v221
    v_and_b32 v235, 0xffff0000, v221
    v_mul_f32 v234, v234, v248
    v_mul_f32 v235, v235, v248
    v_cvt_pk_bf16_f32 v3, v234, v235
    v_lshlrev_b32 v234, 16, v3
    v_and_b32 v235, 0xffff0000, v3
    v_lshlrev_b32 v236, 16, v222
    v_and_b32 v237, 0xffff0000, v222
    v_mul_f32 v236, v236, v248
    v_mul_f32 v237, v237, v248
    v_cvt_pk_bf16_f32 v3, v236, v237
    v_lshlrev_b32 v236, 16, v3
    v_and_b32 v237, 0xffff0000, v3
    v_lshlrev_b32 v238, 16, v223
    v_and_b32 v239, 0xffff0000, v223
    v_mul_f32 v238, v238, v248
    v_mul_f32 v239, v239, v248
    v_cvt_pk_bf16_f32 v3, v238, v239
    v_lshlrev_b32 v238, 16, v3
    v_and_b32 v239, 0xffff0000, v3
    v_lshlrev_b32 v240, 16, v224
    v_and_b32 v241, 0xffff0000, v224
    v_mul_f32 v240, v240, v248
    v_mul_f32 v241, v241, v248
    v_cvt_pk_bf16_f32 v3, v240, v241
    v_lshlrev_b32 v240, 16, v3
    v_and_b32 v241, 0xffff0000, v3
    v_lshlrev_b32 v242, 16, v225
    v_and_b32 v243, 0xffff0000, v225
    v_mul_f32 v242, v242, v248
    v_mul_f32 v243, v243, v248
    v_cvt_pk_bf16_f32 v3, v242, v243
    v_lshlrev_b32 v242, 16, v3
    v_and_b32 v243, 0xffff0000, v3
    v_lshlrev_b32 v244, 16, v226
    v_and_b32 v245, 0xffff0000, v226
    v_mul_f32 v244, v244, v248
    v_mul_f32 v245, v245, v248
    v_cvt_pk_bf16_f32 v3, v244, v245
    v_lshlrev_b32 v244, 16, v3
    v_and_b32 v245, 0xffff0000, v3
    v_lshlrev_b32 v246, 16, v227
    v_and_b32 v247, 0xffff0000, v227
    v_mul_f32 v246, v246, v248
    v_mul_f32 v247, v247, v248
    v_cvt_pk_bf16_f32 v3, v246, v247
    v_lshlrev_b32 v246, 16, v3
    v_and_b32 v247, 0xffff0000, v3
    s_waitcnt vmcnt(0)
G_loop:
    v_readfirstlane_b32 s68, v20
    s_and_b32 s68, s68, s66
G_new:
    s_andn2_b32 s66, s66, s68
    s_bcnt1_i32_b32 s67, s68
    s_cmp_eq_u32 s67, 0
    s_cbranch_scc1 G_l0
    s_cmp_gt_u32 s67, 8
    s_cbranch_scc1 G_lt_2
    s_cmp_gt_u32 s67, 4
    s_cbranch_scc1 G_lt_3
    s_cmp_gt_u32 s67, 2
    s_cbranch_scc1 G_lt_4
    s_cmp_eq_u32 s67, 1
    s_cbranch_scc1 G_l1
    s_branch G_l2
G_lt_4:
    s_cmp_eq_u32 s67, 3
    s_cbranch_scc1 G_l3
    s_branch G_l4
G_lt_3:
    s_cmp_gt_u32 s67, 6
    s_cbranch_scc1 G_lt_5
    s_cmp_eq_u32 s67, 5
    s_cbranch_scc1 G_l5
    s_branch G_l6
G_lt_5:
    s_cmp_eq_u32 s67, 7
    s_cbranch_scc1 G_l7
    s_branch G_l8
G_lt_2:
    s_cmp_gt_u32 s67, 12
    s_cbranch_scc1 G_lt_6
    s_cmp_gt_u32 s67, 10
    s_cbranch_scc1 G_lt_7
    s_cmp_eq_u32 s67, 9
    s_cbranch_scc1 G_l9
    s_branch G_l10
G_lt_7:
    s_cmp_eq_u32 s67, 11
    s_cbranch_scc1 G_l11
    s_branch G_l12
G_lt_6:
    s_cmp_gt_u32 s67, 14
    s_cbranch_scc1 G_lt_8
    s_cmp_eq_u32 s67, 13
    s_cbranch_scc1 G_l13
    s_branch G_l14
G_lt_8:
    s_cmp_eq_u32 s67, 15
    s_cbranch_scc1 G_l15
G_l16:
    s_ff1_i32_b32 s55, s68
    s_bitset0_b32 s68, s55
    s_mul_i32 s64, s55, 1152
    buffer_load_dwordx4 v[124:127], v17, s[16:19], s64 offen sc1
G_l15:
    s_ff1_i32_b32 s54, s68
    s_bitset0_b32 s68, s54
    s_mul_i32 s64, s54, 1152
    buffer_load_dwordx4 v[120:123], v17, s[16:19], s64 offen sc1
G_l14:
    s_ff1_i32_b32 s53, s68
    s_bitset0_b32 s68, s53
    s_mul_i32 s64, s53, 1152
    buffer_load_dwordx4 v[116:119], v17, s[16:19], s64 offen sc1
G_l13:
    s_ff1_i32_b32 s52, s68
    s_bitset0_b32 s68, s52
    s_mul_i32 s64, s52, 1152
    buffer_load_dwordx4 v[112:115], v17, s[16:19], s64 offen sc1
G_l12:
    s_ff1_i32_b32 s51, s68
    s_bitset0_b32 s68, s51
    s_mul_i32 s64, s51, 1152
    buffer_load_dwordx4 v[108:111], v17, s[16:19], s64 offen sc1
G_l11:
    s_ff1_i32_b32 s50, s68
    s_bitset0_b32 s68, s50
    s_mul_i32 s64, s50, 1152
    buffer_load_dwordx4 v[104:107], v17, s[16:19], s64 offen sc1
G_l10:
    s_ff1_i32_b32 s49, s68
    s_bitset0_b32 s68, s49
    s_mul_i32 s64, s49, 1152
    buffer_load_dwordx4 v[100:103], v17, s[16:19], s64 offen sc1
G_l9:
    s_ff1_i32_b32 s48, s68
    s_bitset0_b32 s68, s48
    s_mul_i32 s64, s48, 1152
    buffer_load_dwordx4 v[96:99], v17, s[16:19], s64 offen sc1
G_l8:
    s_ff1_i32_b32 s47, s68
    s_bitset0_b32 s68, s47
    s_mul_i32 s64, s47, 1152
    buffer_load_dwordx4 v[92:95], v17, s[16:19], s64 offen sc1
G_l7:
    s_ff1_i32_b32 s46, s68
    s_bitset0_b32 s68, s46
    s_mul_i32 s64, s46, 1152
    buffer_load_dwordx4 v[88:91], v17, s[16:19], s64 offen sc1
G_l6:
    s_ff1_i32_b32 s45, s68
    s_bitset0_b32 s68, s45
    s_mul_i32 s64, s45, 1152
    buffer_load_dwordx4 v[84:87], v17, s[16:19], s64 offen sc1
G_l5:
    s_ff1_i32_b32 s44, s68
    s_bitset0_b32 s68, s44
    s_mul_i32 s64, s44, 1152
    buffer_load_dwordx4 v[80:83], v17, s[16:19], s64 offen sc1
G_l4:
    s_ff1_i32_b32 s43, s68
    s_bitset0_b32 s68, s43
    s_mul_i32 s64, s43, 1152
    buffer_load_dwordx4 v[76:79], v17, s[16:19], s64 offen sc1
G_l3:
    s_ff1_i32_b32 s42, s68
    s_bitset0_b32 s68, s42
    s_mul_i32 s64, s42, 1152
    buffer_load_dwordx4 v[72:75], v17, s[16:19], s64 offen sc1
G_l2:
    s_ff1_i32_b32 s41, s68
    s_bitset0_b32 s68, s41
    s_mul_i32 s64, s41, 1152
    buffer_load_dwordx4 v[68:71], v17, s[16:19], s64 offen sc1
G_l1:
    s_ff1_i32_b32 s40, s68
    s_bitset0_b32 s68, s40
    s_mul_i32 s64, s40, 1152
    buffer_load_dwordx4 v[64:67], v17, s[16:19], s64 offen sc1
G_l0:
    s_mov_b32 s68, s66
    s_cmp_eq_u32 s66, 0
    s_cbranch_scc1 G_z
    s_cmp_lg_u32 s67, 0
    s_cbranch_scc1 G_p
    s_sleep 2
G_p:
    s_mov_b64 exec, 1
    v_mov_b32 v20, 0
    buffer_atomic_or v20, v23, s[16:19], 0 offen sc0
    s_mov_b64 exec, -1
    s_branch G_proc
G_z:
    buffer_load_dwordx4 v[56:59], v18, s[16:19], 0 offen sc1
G_proc:
    s_cmp_eq_u32 s67, 0
    s_cbranch_scc1 G_q0
    s_cmp_gt_u32 s67, 8
    s_cbranch_scc1 G_qt_9
    s_cmp_gt_u32 s67, 4
    s_cbranch_scc1 G_qt_10
    s_cmp_gt_u32 s67, 2
    s_cbranch_scc1 G_qt_11
    s_cmp_eq_u32 s67, 1
    s_cbranch_scc1 G_q1
    s_branch G_q2
G_qt_11:
    s_cmp_eq_u32 s67, 3
    s_cbranch_scc1 G_q3
    s_branch G_q4
G_qt_10:
    s_cmp_gt_u32 s67, 6
    s_cbranch_scc1 G_qt_12
    s_cmp_eq_u32 s67, 5
    s_cbranch_scc1 G_q5
    s_branch G_q6
G_qt_12:
    s_cmp_eq_u32 s67, 7
    s_cbranch_scc1 G_q7
    s_branch G_q8
G_qt_9:
    s_cmp_gt_u32 s67, 12
    s_cbranch_scc1 G_qt_13
    s_cmp_gt_u32 s67, 10
    s_cbranch_scc1 G_qt_14
    s_cmp_eq_u32 s67, 9
    s_cbranch_scc1 G_q9
    s_branch G_q10
G_qt_14:
    s_cmp_eq_u32 s67, 11
    s_cbranch_scc1 G_q11
    s_branch G_q12
G_qt_13:
    s_cmp_gt_u32 s67, 14
    s_cbranch_scc1 G_qt_15
    s_cmp_eq_u32 s67, 13
    s_cbranch_scc1 G_q13
    s_branch G_q14
G_qt_15:
    s_cmp_eq_u32 s67, 15
    s_cbranch_scc1 G_q15
G_q16:
    s_waitcnt vmcnt(16)
    v_max3_u32 v21, v124, v125, v126
    v_max_u32 v21, v21, v127
    v_cmp_eq_u32 vcc, -1, v21
    s_cbranch_vccnz G_f15
    v_mfma_f32_32x32x16_bf16 v[128:143], v[48:51], v[124:127], v[128:143]
G_q15:
    s_waitcnt vmcnt(15)
    v_max3_u32 v21, v120, v121, v122
    v_max_u32 v21, v21, v123
    v_cmp_eq_u32 vcc, -1, v21
    s_cbranch_vccnz G_f14
    v_mfma_f32_32x32x16_bf16 v[128:143], v[48:51], v[120:123], v[128:143]
G_q14:
    s_waitcnt vmcnt(14)
    v_max3_u32 v21, v116, v117, v118
    v_max_u32 v21, v21, v119
    v_cmp_eq_u32 vcc, -1, v21
    s_cbranch_vccnz G_f13
    v_mfma_f32_32x32x16_bf16 v[128:143], v[48:51], v[116:119], v[128:143]
G_q13:
    s_waitcnt vmcnt(13)
    v_max3_u32 v21, v112, v113, v114
    v_max_u32 v21, v21, v115
    v_cmp_eq_u32 vcc, -1, v21
    s_cbranch_vccnz G_f12
    v_mfma_f32_32x32x16_bf16 v[128:143], v[48:51], v[112:115], v[128:143]
G_q12:
    s_waitcnt vmcnt(12)
    v_max3_u32 v21, v108, v109, v110
    v_max_u32 v21, v21, v111
    v_cmp_eq_u32 vcc, -1, v21
    s_cbranch_vccnz G_f11
    v_mfma_f32_32x32x16_bf16 v[128:143], v[48:51], v[108:111], v[128:143]
G_q11:
    s_waitcnt vmcnt(11)
    v_max3_u32 v21, v104, v105, v106
    v_max_u32 v21, v21, v107
    v_cmp_eq_u32 vcc, -1, v21
    s_cbranch_vccnz G_f10
    v_mfma_f32_32x32x16_bf16 v[128:143], v[48:51], v[104:107], v[128:143]
G_q10:
    s_waitcnt vmcnt(10)
    v_max3_u32 v21, v100, v101, v102
    v_max_u32 v21, v21, v103
    v_cmp_eq_u32 vcc, -1, v21
    s_cbranch_vccnz G_f9
    v_mfma_f32_32x32x16_bf16 v[128:143], v[48:51], v[100:103], v[128:143]
G_q9:
    s_waitcnt vmcnt(9)
    v_max3_u32 v21, v96, v97, v98
    v_max_u32 v21, v21, v99
    v_cmp_eq_u32 vcc, -1, v21
    s_cbranch_vccnz G_f8
    v_mfma_f32_32x32x16_bf16 v[128:143], v[48:51], v[96:99], v[128:143]
G_q8:
    s_waitcnt vmcnt(8)
    v_max3_u32 v21, v92, v93, v94
    v_max_u32 v21, v21, v95
    v_cmp_eq_u32 vcc, -1, v21
    s_cbranch_vccnz G_f7
    v_mfma_f32_32x32x16_bf16 v[128:143], v[48:51], v[92:95], v[128:143]
G_q7:
    s_waitcnt vmcnt(7)
    v_max3_u32 v21, v88, v89, v90
    v_max_u32 v21, v21, v91
    v_cmp_eq_u32 vcc, -1, v21
    s_cbranch_vccnz G_f6
    v_mfma_f32_32x32x16_bf16 v[128:143], v[48:51], v[88:91], v[128:143]
G_q6:
    s_waitcnt vmcnt(6)
    v_max3_u32 v21, v84, v85, v86
    v_max_u32 v21, v21, v87
    v_cmp_eq_u32 vcc, -1, v21
    s_cbranch_vccnz G_f5
    v_mfma_f32_32x32x16_bf16 v[128:143], v[48:51], v[84:87], v[128:143]
G_q5:
    s_waitcnt vmcnt(5)
    v_max3_u32 v21, v80, v81, v82
    v_max_u32 v21, v21, v83
    v_cmp_eq_u32 vcc, -1, v21
    s_cbranch_vccnz G_f4
    v_mfma_f32_32x32x16_bf16 v[128:143], v[48:51], v[80:83], v[128:143]
G_q4:
    s_waitcnt vmcnt(4)
    v_max3_u32 v21, v76, v77, v78
    v_max_u32 v21, v21, v79
    v_cmp_eq_u32 vcc, -1, v21
    s_cbranch_vccnz G_f3
    v_mfma_f32_32x32x16_bf16 v[128:143], v[48:51], v[76:79], v[128:143]
G_q3:
    s_waitcnt vmcnt(3)
    v_max3_u32 v21, v72, v73, v74
    v_max_u32 v21, v21, v75
    v_cmp_eq_u32 vcc, -1, v21
    s_cbranch_vccnz G_f2
    v_mfma_f32_32x32x16_bf16 v[128:143], v[48:51], v[72:75], v[128:143]
G_q2:
    s_waitcnt vmcnt(2)
    v_max3_u32 v21, v68, v69, v70
    v_max_u32 v21, v21, v71
    v_cmp_eq_u32 vcc, -1, v21
    s_cbranch_vccnz G_f1
    v_mfma_f32_32x32x16_bf16 v[128:143], v[48:51], v[68:71], v[128:143]
G_q1:
    s_waitcnt vmcnt(1)
    v_max3_u32 v21, v64, v65, v66
    v_max_u32 v21, v21, v67
    v_cmp_eq_u32 vcc, -1, v21
    s_cbranch_vccnz G_f0
    v_mfma_f32_32x32x16_bf16 v[128:143], v[48:51], v[64:67], v[128:143]
G_q0:
    s_waitcnt vmcnt(0)
G_chk:
    s_add_u32 s65, s65, 1
    s_cmp_ge_u32 s65, 40000
    s_cbranch_scc1 G_done
    s_cmp_lg_u32 s68, 0
    s_cbranch_scc1 G_loop
    v_mov_b32 v20, -1
    s_cmp_lg_u32 s66, 0
    s_cbranch_scc1 G_loop
    v_max3_u32 v21, v56, v57, v58
    v_max_u32 v21, v21, v59
    v_cmp_eq_u32 vcc, -1, v21
    s_cbranch_vccnz G_loop
G_done:
    v_add_u32 v16, s7, v6
    v_add_f32_dpp v56, v56, v56 row_ror:4 row_mask:0xf bank_mask:0xf
    v_add_f32_dpp v57, v57, v57 row_ror:4 row_mask:0xf bank_mask:0xf
    v_add_f32_dpp v58, v58, v58 row_ror:4 row_mask:0xf bank_mask:0xf
    v_add_f32_dpp v59, v59, v59 row_ror:4 row_mask:0xf bank_mask:0xf
    v_add_f32_dpp v56, v56, v56 row_ror:8 row_mask:0xf bank_mask:0xf
    v_add_f32_dpp v57, v57, v57 row_ror:8 row_mask:0xf bank_mask:0xf
    v_add_f32_dpp v58, v58, v58 row_ror:8 row_mask:0xf bank_mask:0xf
    v_add_f32_dpp v59, v59, v59 row_ror:8 row_mask:0xf bank_mask:0xf
    v_mov_b32 v64, v56
    v_mov_b32 v65, v57
    v_mov_b32 v66, v58
    v_mov_b32 v67, v59
    s_nop 0
    v_permlane16_swap_b32 v56, v64
    v_permlane16_swap_b32 v57, v65
    v_permlane16_swap_b32 v58, v66
    v_permlane16_swap_b32 v59, v67
    v_add_f32 v56, v56, v64
    v_add_f32 v57, v57, v65
    v_add_f32 v58, v58, v66
    v_add_f32 v59, v59, v67
    v_mov_b32 v64, v56
    v_mov_b32 v65, v57
    v_mov_b32 v66, v58
    v_mov_b32 v67, v59
    s_nop 0
    v_permlane32_swap_b32 v56, v64
    v_permlane32_swap_b32 v57, v65
    v_permlane32_swap_b32 v58, v66
    v_permlane32_swap_b32 v59, v67
    v_add_f32 v56, v56, v64
    v_add_f32 v57, v57, v65
    v_add_f32 v58, v58, v66
    v_add_f32 v59, v59, v67
    v_cvt_pk_bf16_f32 v60, v128, v129
    v_cvt_pk_bf16_f32 v61, v130, v131
    v_cvt_pk_bf16_f32 v62, v132, v133
    v_cvt_pk_bf16_f32 v63, v134, v135
    ds_write_b128 v16, v[60:63] offset:0
    v_cvt_pk_bf16_f32 v56, v56, v57
    v_cvt_pk_bf16_f32 v57, v58, v59
    s_lshr_b32 s64, s6, 1
    s_lshl_b32 s64, s64, 6
    s_and_b32 s65, s6, 1
    s_lshl_b32 s65, s65, 3
    s_add_u32 s64, s64, s65
    v_lshl_add_u32 v16, v2, 4, s64
    s_mov_b64 exec, 15
    ds_write_b64 v16, v[56:57] offset:4096
    s_mov_b64 exec, -1
    s_waitcnt vmcnt(0) lgkmcnt(0)
    s_barrier
    v_lshrrev_b32 v18, 3, v2
    v_lshlrev_b32 v18, 2, v18
    ds_read_b32 v24, v18 offset:4352
    ds_read_b32 v25, v18 offset:4384
    ds_read_b32 v26, v18 offset:4416
    ds_read_b32 v27, v18 offset:4448
    ds_read_b32 v28, v18 offset:4480
    ds_read_b32 v29, v18 offset:4512
    ds_read_b32 v30, v18 offset:4544
    s_waitcnt lgkmcnt(0)
    s_mov_b32 s64, 0x05040100
    s_mov_b32 s65, 0x07060302
    v_cvt_pk_bf16_f32 v24, v24, v25
    v_cvt_pk_bf16_f32 v25, v26, v27
    v_cvt_pk_bf16_f32 v26, v28, v29
    v_cvt_pk_bf16_f32 v27, v30, 0
    v_perm_b32 v48, v196, v192, s64
    v_perm_b32 v49, v196, v192, s65
    v_dot2_f32_bf16 v32, v48, v24, 0
    v_dot2_f32_bf16 v33, v49, v24, 0
    v_perm_b32 v50, v197, v193, s64
    v_perm_b32 v51, v197, v193, s65
    v_dot2_f32_bf16 v34, v50, v24, 0
    v_dot2_f32_bf16 v35, v51, v24, 0
    v_perm_b32 v48, v198, v194, s64
    v_perm_b32 v49, v198, v194, s65
    v_dot2_f32_bf16 v36, v48, v24, 0
    v_dot2_f32_bf16 v37, v49, v24, 0
    v_perm_b32 v50, v199, v195, s64
    v_perm_b32 v51, v199, v195, s65
    v_dot2_f32_bf16 v38, v50, v24, 0
    v_dot2_f32_bf16 v39, v51, v24, 0
    v_perm_b32 v48, v204, v200, s64
    v_perm_b32 v49, v204, v200, s65
    v_dot2_f32_bf16 v32, v48, v25, v32
    v_dot2_f32_bf16 v33, v49, v25, v33
    v_perm_b32 v50, v205, v201, s64
    v_perm_b32 v51, v205, v201, s65
    v_dot2_f32_bf16 v34, v50, v25, v34
    v_dot2_f32_bf16 v35, v51, v25, v35
    v_perm_b32 v48, v206, v202, s64
    v_perm_b32 v49, v206, v202, s65
    v_dot2_f32_bf16 v36, v48, v25, v36
    v_dot2_f32_bf16 v37, v49, v25, v37
    v_perm_b32 v50, v207, v203, s64
    v_perm_b32 v51, v207, v203, s65
    v_dot2_f32_bf16 v38, v50, v25, v38
    v_dot2_f32_bf16 v39, v51, v25, v39
    v_perm_b32 v48, v212, v208, s64
    v_perm_b32 v49, v212, v208, s65
    v_dot2_f32_bf16 v32, v48, v26, v32
    v_dot2_f32_bf16 v33, v49, v26, v33
    v_perm_b32 v50, v213, v209, s64
    v_perm_b32 v51, v213, v209, s65
    v_dot2_f32_bf16 v34, v50, v26, v34
    v_dot2_f32_bf16 v35, v51, v26, v35
    v_perm_b32 v48, v214, v210, s64
    v_perm_b32 v49, v214, v210, s65
    v_dot2_f32_bf16 v36, v48, v26, v36
    v_dot2_f32_bf16 v37, v49, v26, v37
    v_perm_b32 v50, v215, v211, s64
    v_perm_b32 v51, v215, v211, s65
    v_dot2_f32_bf16 v38, v50, v26, v38
    v_dot2_f32_bf16 v39, v51, v26, v39
    v_perm_b32 v48, v216, v216, s64
    v_perm_b32 v49, v216, v216, s65
    v_dot2_f32_bf16 v32, v48, v27, v32
    v_dot2_f32_bf16 v33, v49, v27, v33
    v_perm_b32 v50, v217, v217, s64
    v_perm_b32 v51, v217, v217, s65
    v_dot2_f32_bf16 v34, v50, v27, v34
    v_dot2_f32_bf16 v35, v51, v27, v35
    v_perm_b32 v48, v218, v218, s64
    v_perm_b32 v49, v218, v218, s65
    v_dot2_f32_bf16 v36, v48, v27, v36
    v_dot2_f32_bf16 v37, v49, v27, v37
    v_perm_b32 v50, v219, v219, s64
    v_perm_b32 v51, v219, v219, s65
    v_dot2_f32_bf16 v38, v50, v27, v38
    v_dot2_f32_bf16 v39, v51, v27, v39
    s_nop 1
    s_nop 1
    v_permlane32_swap_b32 v32, v36
    v_permlane32_swap_b32 v33, v37
    v_permlane32_swap_b32 v34, v38
    v_permlane32_swap_b32 v35, v39
    v_add_f32 v32, v32, v36
    v_add_f32 v33, v33, v37
    v_add_f32 v34, v34, v38
    v_add_f32 v35, v35, v39
    s_nop 1
    v_permlane16_swap_b32 v32, v34
    v_permlane16_swap_b32 v33, v35
    v_add_f32 v32, v32, v34
    v_add_f32 v33, v33, v35
    s_nop 1
    v_add_f32_dpp v32, v32, v32 row_ror:8 row_mask:0xf bank_mask:0xf
    v_add_f32_dpp v33, v33, v33 row_ror:8 row_mask:0xf bank_mask:0xf
    v_and_b32 v16, 7, v2
    v_lshlrev_b32 v16, 5, v16
    v_lshl_add_u32 v16, v8, 3, v16
    s_lshl_b32 s64, s2, 10
    s_lshl_b32 s65, s6, 8
    s_add_u32 s64, s64, s65
    s_add_u32 s64, s64, 6447104
    s_mov_b32 exec_lo, 0x00ff00ff
    s_mov_b32 exec_hi, 0x00ff00ff
    buffer_store_dwordx2 v[32:33], v16, s[16:19], s64 offen sc0 sc1
    s_mov_b64 exec, -1
    s_lshl_b32 s64, s4, 3
    s_add_u32 s64, s64, s3
    s_lshl_b32 s64, s64, 7
    s_add_u32 s64, s64, 5382144
    v_mov_b32 v14, s64
    s_mov_b64 exec, 1
    v_mov_b32 v15, 0
    buffer_atomic_or v15, v14, s[16:19], 0 offen sc0
    s_mov_b64 exec, -1
    v_mov_b32 v254, v14
    s_branch P2_start
C_start:
    s_or_b32 s64, s2, s3
    s_cbranch_scc1 C_nn
    s_mov_b32 s64, 6717440
    s_load_dwordx2 s[66:67], s[62:63], s64
    s_mov_b32 s20, s60
    s_mov_b32 s21, s61
    s_mov_b32 s22, 0x100
    s_mov_b32 s23, 0x00020000
    v_mov_b32 v57, 0
    s_waitcnt lgkmcnt(0)
    s_xor_b32 s64, s66, s67
    s_add_u32 s64, s64, 1
    s_max_u32 s64, s64, 1
    v_mov_b32 v56, s64
    s_mov_b64 exec, 1
    buffer_store_dword v56, v57, s[20:23], 0 offen sc0 sc1
    s_mov_b64 exec, -1
C_nn:
    s_and_b32 s6, s3, 1
    s_lshr_b32 s7, s3, 1
    v_and_b32 v3, 15, v2
    s_lshl_b32 s64, s6, 6
    v_add_u32 v3, s64, v3
    v_lshlrev_b32 v3, 7, v3
    v_add_u32 v3, 8192, v3
    v_bfe_u32 v56, v2, 1, 3
    v_lshrrev_b32 v57, 4, v2
    v_xor_b32 v56, v56, v57
    v_lshl_add_u32 v4, v56, 4, v3
    v_xor_b32 v5, 64, v4
    v_bfe_u32 v56, v2, 2, 2
    v_lshl_add_u32 v58, v57, 3, v56
    v_lshlrev_b32 v58, 7, v58
    v_lshrrev_b32 v56, 1, v56
    v_xor_b32 v56, s7, v56
    v_lshl_add_u32 v58, v56, 6, v58
    v_and_b32 v57, 1, v57
    v_lshl_add_u32 v58, v57, 5, v58
    v_and_b32 v56, 3, v2
    v_lshl_add_u32 v58, v56, 3, v58
    v_add_u32 v6, 24576, v58
    v_xor_b32 v7, 32, v6
    v_mov_b32 v8, v4
    v_mov_b32 v10, v6
    v_mov_b32 v9, v5
    v_mov_b32 v11, v7
    v_mov_b32 v64, 0
    v_mov_b32 v65, 0
    v_mov_b32 v66, 0
    v_mov_b32 v67, 0
    v_mov_b32 v68, 0
    v_mov_b32 v69, 0
    v_mov_b32 v70, 0
    v_mov_b32 v71, 0
    v_mov_b32 v72, 0
    v_mov_b32 v73, 0
    v_mov_b32 v74, 0
    v_mov_b32 v75, 0
    v_mov_b32 v76, 0
    v_mov_b32 v77, 0
    v_mov_b32 v78, 0
    v_mov_b32 v79, 0
    v_mov_b32 v80, 0
    v_mov_b32 v81, 0
    v_mov_b32 v82, 0
    v_mov_b32 v83, 0
    v_mov_b32 v84, 0
    v_mov_b32 v85, 0
    v_mov_b32 v86, 0
    v_mov_b32 v87, 0
    v_mov_b32 v88, 0
    v_mov_b32 v89, 0
    v_mov_b32 v90, 0
    v_mov_b32 v91, 0
    v_mov_b32 v92, 0
    v_mov_b32 v93, 0
    v_mov_b32 v94, 0
    v_mov_b32 v95, 0
    v_mov_b32 v96, 0
    v_mov_b32 v97, 0
    v_mov_b32 v98, 0
    v_mov_b32 v99, 0
    v_mov_b32 v100, 0
    v_mov_b32 v101, 0
    v_mov_b32 v102, 0
    v_mov_b32 v103, 0
    v_mov_b32 v104, 0
    v_mov_b32 v105, 0
    v_mov_b32 v106, 0
    v_mov_b32 v107, 0
    v_mov_b32 v108, 0
    v_mov_b32 v109, 0
    v_mov_b32 v110, 0
    v_mov_b32 v111, 0
    v_mov_b32 v112, 0
    v_mov_b32 v113, 0
    v_mov_b32 v114, 0
    v_mov_b32 v115, 0
    v_mov_b32 v116, 0
    v_mov_b32 v117, 0
    v_mov_b32 v118, 0
    v_mov_b32 v119, 0
    v_mov_b32 v120, 0
    v_mov_b32 v121, 0
    v_mov_b32 v122, 0
    v_mov_b32 v123, 0
    v_mov_b32 v124, 0
    v_mov_b32 v125, 0
    v_mov_b32 v126, 0
    v_mov_b32 v127, 0
    v_mov_b32 v128, 0
    v_mov_b32 v129, 0
    v_mov_b32 v130, 0
    v_mov_b32 v131, 0
    v_mov_b32 v132, 0
    v_mov_b32 v133, 0
    v_mov_b32 v134, 0
    v_mov_b32 v135, 0
    v_mov_b32 v136, 0
    v_mov_b32 v137, 0
    v_mov_b32 v138, 0
    v_mov_b32 v139, 0
    v_mov_b32 v140, 0
    v_mov_b32 v141, 0
    v_mov_b32 v142, 0
    v_mov_b32 v143, 0
    v_mov_b32 v144, 0
    v_mov_b32 v145, 0
    v_mov_b32 v146, 0
    v_mov_b32 v147, 0
    v_mov_b32 v148, 0
    v_mov_b32 v149, 0
    v_mov_b32 v150, 0
    v_mov_b32 v151, 0
    v_mov_b32 v152, 0
    v_mov_b32 v153, 0
    v_mov_b32 v154, 0
    v_mov_b32 v155, 0
    v_mov_b32 v156, 0
    v_mov_b32 v157, 0
    v_mov_b32 v158, 0
    v_mov_b32 v159, 0
    s_lshl_b32 s64, s3, 2
    v_mov_b32 v229, s64
    ds_write_b32 v229, v64 offset:4288
    ds_write_b32 v229, v64 offset:4304
    v_lshlrev_b32 v3, 4, v2
    s_lshl_b32 s64, s3, 11
    v_add_u32 v224, s64, v3
    v_xor_b32 v225, 2048, v224
    s_lshl_b32 s64, s3, 8
    v_lshl_add_u32 v227, v2, 2, s64
    v_xor_b32 v228, 256, v227
    v_xor_b32 v230, 4, v229
    v_mov_b32 v231, 1
    v_mov_b32 v226, 0
    v_lshlrev_b32 v232, 2, v2
    s_lshl_b32 s64, 1, s4
    v_mov_b32 v233, s64
    s_lshl_b32 s43, s5, 2
    s_add_u32 s43, s43, s3
    s_lshl_b32 s64, s43, 7
    s_add_u32 s64, s64, 5373952
    v_mov_b32 v234, s64
    s_lshl_b32 s43, s43, 4
    s_add_u32 s43, s43, s4
    s_mul_i32 s43, s43, 1152
    s_add_u32 s43, s43, 4194304
    s_lshl_b32 s42, s4, 2
    s_lshl_b32 s64, s6, 1
    s_add_u32 s42, s42, s64
    s_lshl_b32 s42, s42, 5
    s_lshl_b32 s64, s5, 1
    s_add_u32 s42, s42, s64
    s_add_u32 s42, s42, s7
    s_lshl_b32 s42, s42, 11
    s_and_b32 s64, s5, 7
    s_lshl_b32 s64, s64, 1
    s_add_u32 s64, s64, s7
    s_lshl_b32 s64, 1, s64
    v_mov_b32 v13, s64
    s_lshr_b32 s64, s5, 3
    s_lshl_b32 s64, s64, 1
    s_add_u32 s64, s64, s6
    s_lshl_b32 s64, s64, 8
    s_lshl_b32 s65, s4, 10
    s_add_u32 s64, s64, s65
    s_add_u32 s64, s64, 5382144
    v_lshl_add_u32 v15, v2, 7, s64
    v_lshlrev_b32 v1, 4, v2
    s_and_b32 s64, s2, 7
    s_lshr_b32 s65, s2, 3
    s_and_b32 s4, s64, 3
    s_lshl_b32 s4, s4, 2
    s_and_b32 s66, s65, 3
    s_add_u32 s4, s4, s66
    s_lshr_b32 s5, s64, 2
    s_lshl_b32 s5, s5, 3
    s_lshr_b32 s66, s65, 2
    s_add_u32 s5, s5, s66
    s_mov_b32 s65, 0
    s_mov_b32 s66, 0
    v_mov_b32 v236, 0x3f803f80
    v_mov_b32 v237, 0x3f803f80
    v_mov_b32 v238, 0x3f803f80
    v_mov_b32 v239, 0x3f803f80
    s_waitcnt vmcnt(0) lgkmcnt(0)
    s_barrier
    ds_read_b64_tr_b16 v[16:17], v10 offset:0
    ds_read_b64_tr_b16 v[18:19], v10 offset:512
    ds_read_b128 v[192:195], v8 offset:0
    ds_read_b128 v[196:199], v8 offset:2048
    ds_read_b128 v[200:203], v8 offset:4096
    ds_read_b128 v[204:207], v8 offset:6144
    ds_read_b64_tr_b16 v[20:21], v11 offset:0
    ds_read_b64_tr_b16 v[22:23], v11 offset:512
    ds_read_b64_tr_b16 v[24:25], v10 offset:8192
    ds_read_b64_tr_b16 v[26:27], v10 offset:8704
    ds_read_b64_tr_b16 v[28:29], v11 offset:8192
    ds_read_b64_tr_b16 v[30:31], v11 offset:8704
    ds_read_b64_tr_b16 v[32:33], v10 offset:16384
    ds_read_b64_tr_b16 v[34:35], v10 offset:16896
    ds_read_b64_tr_b16 v[36:37], v11 offset:16384
    ds_read_b64_tr_b16 v[38:39], v11 offset:16896
.p2align 3
C_loop:
    s_waitcnt lgkmcnt(0)
    v_mfma_f32_16x16x32_bf16 v[64:67], v[16:19], v[192:195], v[64:67]
    ds_read_b64_tr_b16 v[40:41], v10 offset:4096
    v_mfma_f32_16x16x32_bf16 v[72:75], v[16:19], v[196:199], v[72:75]
    ds_read_b64_tr_b16 v[42:43], v10 offset:4608
    v_mfma_f32_16x16x32_bf16 v[80:83], v[16:19], v[200:203], v[80:83]
    ds_read_b128 v[208:211], v9 offset:0
    v_mfma_f32_16x16x32_bf16 v[88:91], v[16:19], v[204:207], v[88:91]
    ds_read_b128 v[212:215], v9 offset:2048
    v_mfma_f32_16x16x32_bf16 v[68:71], v[20:23], v[192:195], v[68:71]
    ds_read_b128 v[216:219], v9 offset:4096
    v_mfma_f32_16x16x32_bf16 v[76:79], v[20:23], v[196:199], v[76:79]
    ds_read_b128 v[220:223], v9 offset:6144
    v_mfma_f32_16x16x32_bf16 v[84:87], v[20:23], v[200:203], v[84:87]
    ds_read_b64_tr_b16 v[44:45], v11 offset:4096
    v_mfma_f32_16x16x32_bf16 v[92:95], v[20:23], v[204:207], v[92:95]
    ds_read_b64_tr_b16 v[46:47], v11 offset:4608
    v_mfma_f32_16x16x32_bf16 v[96:99], v[192:195], v[24:27], v[96:99]
    ds_read_b64_tr_b16 v[48:49], v10 offset:12288
    v_mfma_f32_16x16x32_bf16 v[100:103], v[196:199], v[24:27], v[100:103]
    ds_read_b64_tr_b16 v[50:51], v10 offset:12800
    v_mfma_f32_16x16x32_bf16 v[112:115], v[200:203], v[24:27], v[112:115]
    ds_read_b64_tr_b16 v[52:53], v11 offset:12288
    v_mfma_f32_16x16x32_bf16 v[116:119], v[204:207], v[24:27], v[116:119]
    ds_read_b64_tr_b16 v[54:55], v11 offset:12800
    v_mfma_f32_16x16x32_bf16 v[104:107], v[192:195], v[28:31], v[104:107]
    ds_read_b64_tr_b16 v[56:57], v10 offset:20480
    v_mfma_f32_16x16x32_bf16 v[108:111], v[196:199], v[28:31], v[108:111]
    ds_read_b64_tr_b16 v[58:59], v10 offset:20992
    v_mfma_f32_16x16x32_bf16 v[120:123], v[200:203], v[28:31], v[120:123]
    ds_read_b64_tr_b16 v[60:61], v11 offset:20480
    v_mfma_f32_16x16x32_bf16 v[124:127], v[204:207], v[28:31], v[124:127]
    ds_read_b64_tr_b16 v[62:63], v11 offset:20992
    v_mfma_f32_16x16x32_bf16 v[128:131], v[192:195], v[32:35], v[128:131]
    v_mfma_f32_16x16x32_bf16 v[132:135], v[196:199], v[32:35], v[132:135]
    v_mfma_f32_16x16x32_bf16 v[144:147], v[200:203], v[32:35], v[144:147]
    v_mfma_f32_16x16x32_bf16 v[148:151], v[204:207], v[32:35], v[148:151]
    v_mfma_f32_16x16x32_bf16 v[136:139], v[192:195], v[36:39], v[136:139]
    v_mfma_f32_16x16x32_bf16 v[140:143], v[196:199], v[36:39], v[140:143]
    v_mfma_f32_16x16x32_bf16 v[152:155], v[200:203], v[36:39], v[152:155]
    v_mfma_f32_16x16x32_bf16 v[156:159], v[204:207], v[36:39], v[156:159]
    s_waitcnt lgkmcnt(0)
    s_barrier
    s_add_u32 s65, s65, 40960
    s_cmp_eq_u32 s65, 122880
    s_cselect_b32 s65, 0, s65
    v_mfma_f32_16x16x32_bf16 v[64:67], v[40:43], v[208:211], v[64:67]
    v_add_u32 v10, s65, v6
    v_add_u32 v8, s65, v4
    v_mfma_f32_16x16x32_bf16 v[72:75], v[40:43], v[212:215], v[72:75]
    ds_read_b64_tr_b16 v[16:17], v10 offset:0
    v_mfma_f32_16x16x32_bf16 v[80:83], v[40:43], v[216:219], v[80:83]
    ds_read_b64_tr_b16 v[18:19], v10 offset:512
    v_mfma_f32_16x16x32_bf16 v[88:91], v[40:43], v[220:223], v[88:91]
    ds_read_b128 v[192:195], v8 offset:0
    v_mfma_f32_16x16x32_bf16 v[68:71], v[44:47], v[208:211], v[68:71]
    ds_read_b128 v[196:199], v8 offset:2048
    v_mfma_f32_16x16x32_bf16 v[76:79], v[44:47], v[212:215], v[76:79]
    ds_read_b128 v[200:203], v8 offset:4096
    v_mfma_f32_16x16x32_bf16 v[84:87], v[44:47], v[216:219], v[84:87]
    ds_read_b128 v[204:207], v8 offset:6144
    v_mfma_f32_16x16x32_bf16 v[92:95], v[44:47], v[220:223], v[92:95]
    v_add_u32 v11, s65, v7
    v_mfma_f32_16x16x32_bf16 v[96:99], v[208:211], v[48:51], v[96:99]
    ds_read_b64_tr_b16 v[20:21], v11 offset:0
    v_mfma_f32_16x16x32_bf16 v[100:103], v[212:215], v[48:51], v[100:103]
    ds_read_b64_tr_b16 v[22:23], v11 offset:512
    v_mfma_f32_16x16x32_bf16 v[112:115], v[216:219], v[48:51], v[112:115]
    ds_read_b64_tr_b16 v[24:25], v10 offset:8192
    v_mfma_f32_16x16x32_bf16 v[116:119], v[220:223], v[48:51], v[116:119]
    ds_read_b64_tr_b16 v[26:27], v10 offset:8704
    v_mfma_f32_16x16x32_bf16 v[104:107], v[208:211], v[52:55], v[104:107]
    ds_read_b64_tr_b16 v[28:29], v11 offset:8192
    v_mfma_f32_16x16x32_bf16 v[108:111], v[212:215], v[52:55], v[108:111]
    ds_read_b64_tr_b16 v[30:31], v11 offset:8704
    v_mfma_f32_16x16x32_bf16 v[120:123], v[216:219], v[52:55], v[120:123]
    ds_read_b64_tr_b16 v[32:33], v10 offset:16384
    v_mfma_f32_16x16x32_bf16 v[124:127], v[220:223], v[52:55], v[124:127]
    ds_read_b64_tr_b16 v[34:35], v10 offset:16896
    v_mfma_f32_16x16x32_bf16 v[128:131], v[208:211], v[56:59], v[128:131]
    ds_read_b64_tr_b16 v[36:37], v11 offset:16384
    v_mfma_f32_16x16x32_bf16 v[132:135], v[212:215], v[56:59], v[132:135]
    ds_read_b64_tr_b16 v[38:39], v11 offset:16896
    v_mfma_f32_16x16x32_bf16 v[144:147], v[216:219], v[56:59], v[144:147]
    v_add_u32 v9, s65, v5
    v_mfma_f32_16x16x32_bf16 v[148:151], v[220:223], v[56:59], v[148:151]
    v_mfma_f32_16x16x32_bf16 v[136:139], v[208:211], v[60:63], v[136:139]
    v_mfma_f32_16x16x32_bf16 v[140:143], v[212:215], v[60:63], v[140:143]
    v_mfma_f32_16x16x32_bf16 v[152:155], v[216:219], v[60:63], v[152:155]
    v_mfma_f32_16x16x32_bf16 v[156:159], v[220:223], v[60:63], v[156:159]
    s_add_u32 s66, s66, 1
    s_cmp_lt_u32 s66, 14
    s_cbranch_scc1 C_loop
    s_waitcnt lgkmcnt(0)
    v_mfma_f32_16x16x32_bf16 v[96:99], v[192:195], v[24:27], v[96:99]
    ds_read_b64_tr_b16 v[48:49], v10 offset:12288
    v_mfma_f32_16x16x32_bf16 v[100:103], v[196:199], v[24:27], v[100:103]
    ds_read_b64_tr_b16 v[50:51], v10 offset:12800
    v_mfma_f32_16x16x32_bf16 v[112:115], v[200:203], v[24:27], v[112:115]
    ds_read_b128 v[160:163], v9 offset:0
    v_mfma_f32_16x16x32_bf16 v[116:119], v[204:207], v[24:27], v[116:119]
    ds_read_b128 v[164:167], v9 offset:2048
    v_mfma_f32_16x16x32_bf16 v[104:107], v[192:195], v[28:31], v[104:107]
    ds_read_b128 v[168:171], v9 offset:4096
    v_mfma_f32_16x16x32_bf16 v[108:111], v[196:199], v[28:31], v[108:111]
    ds_read_b128 v[172:175], v9 offset:6144
    v_mfma_f32_16x16x32_bf16 v[120:123], v[200:203], v[28:31], v[120:123]
    ds_read_b64_tr_b16 v[52:53], v11 offset:12288
    v_mfma_f32_16x16x32_bf16 v[124:127], v[204:207], v[28:31], v[124:127]
    ds_read_b64_tr_b16 v[54:55], v11 offset:12800
    v_mfma_f32_16x16x32_bf16 v[128:131], v[192:195], v[32:35], v[128:131]
    ds_read_b64_tr_b16 v[56:57], v10 offset:20480
    v_mfma_f32_16x16x32_bf16 v[132:135], v[196:199], v[32:35], v[132:135]
    ds_read_b64_tr_b16 v[58:59], v10 offset:20992
    v_mfma_f32_16x16x32_bf16 v[144:147], v[200:203], v[32:35], v[144:147]
    ds_read_b64_tr_b16 v[60:61], v11 offset:20480
    v_mfma_f32_16x16x32_bf16 v[148:151], v[204:207], v[32:35], v[148:151]
    ds_read_b64_tr_b16 v[62:63], v11 offset:20992
    v_mfma_f32_16x16x32_bf16 v[136:139], v[192:195], v[36:39], v[136:139]
    v_mfma_f32_16x16x32_bf16 v[140:143], v[196:199], v[36:39], v[140:143]
    v_mfma_f32_16x16x32_bf16 v[152:155], v[200:203], v[36:39], v[152:155]
    v_mfma_f32_16x16x32_bf16 v[156:159], v[204:207], v[36:39], v[156:159]
    s_waitcnt lgkmcnt(0)
    s_barrier
    s_add_u32 s66, s66, 1
    v_mfma_f32_16x16x32_bf16 v[96:99], v[160:163], v[48:51], v[96:99]
    v_mov_b32 v10, v6
    v_mov_b32 v8, v4
    v_mfma_f32_16x16x32_bf16 v[100:103], v[164:167], v[48:51], v[100:103]
    ds_read_b64_tr_b16 v[24:25], v10 offset:8192
    v_mfma_f32_16x16x32_bf16 v[112:115], v[168:171], v[48:51], v[112:115]
    ds_read_b64_tr_b16 v[26:27], v10 offset:8704
    v_mfma_f32_16x16x32_bf16 v[116:119], v[172:175], v[48:51], v[116:119]
    v_mov_b32 v11, v7
    v_mov_b32 v9, v5
    v_mfma_f32_16x16x32_bf16 v[104:107], v[160:163], v[52:55], v[104:107]
    ds_read_b128 v[176:179], v8 offset:0
    v_mfma_f32_16x16x32_bf16 v[108:111], v[164:167], v[52:55], v[108:111]
    ds_read_b128 v[180:183], v8 offset:2048
    v_mfma_f32_16x16x32_bf16 v[120:123], v[168:171], v[52:55], v[120:123]
    ds_read_b128 v[184:187], v8 offset:4096
    v_mfma_f32_16x16x32_bf16 v[124:127], v[172:175], v[52:55], v[124:127]
    ds_read_b128 v[188:191], v8 offset:6144
    v_mfma_f32_16x16x32_bf16 v[128:131], v[160:163], v[56:59], v[128:131]
    ds_read_b64_tr_b16 v[28:29], v11 offset:8192
    v_mfma_f32_16x16x32_bf16 v[132:135], v[164:167], v[56:59], v[132:135]
    ds_read_b64_tr_b16 v[30:31], v11 offset:8704
    v_mfma_f32_16x16x32_bf16 v[144:147], v[168:171], v[56:59], v[144:147]
    ds_read_b64_tr_b16 v[32:33], v10 offset:16384
    v_mfma_f32_16x16x32_bf16 v[148:151], v[172:175], v[56:59], v[148:151]
    ds_read_b64_tr_b16 v[34:35], v10 offset:16896
    v_mfma_f32_16x16x32_bf16 v[136:139], v[160:163], v[60:63], v[136:139]
    ds_read_b64_tr_b16 v[36:37], v11 offset:16384
    v_mfma_f32_16x16x32_bf16 v[140:143], v[164:167], v[60:63], v[140:143]
    ds_read_b64_tr_b16 v[38:39], v11 offset:16896
    v_mfma_f32_16x16x32_bf16 v[152:155], v[168:171], v[60:63], v[152:155]
    v_mfma_f32_16x16x32_bf16 v[156:159], v[172:175], v[60:63], v[156:159]
    s_waitcnt lgkmcnt(0)
    v_mfma_f32_16x16x32_bf16 v[96:99], v[176:179], v[24:27], v[96:99]
    ds_read_b64_tr_b16 v[48:49], v10 offset:12288
    v_mfma_f32_16x16x32_bf16 v[100:103], v[180:183], v[24:27], v[100:103]
    ds_read_b64_tr_b16 v[50:51], v10 offset:12800
    v_mfma_f32_16x16x32_bf16 v[112:115], v[184:187], v[24:27], v[112:115]
    ds_read_b128 v[208:211], v9 offset:0
    v_mfma_f32_16x16x32_bf16 v[116:119], v[188:191], v[24:27], v[116:119]
    ds_read_b128 v[212:215], v9 offset:2048
    v_mfma_f32_16x16x32_bf16 v[104:107], v[176:179], v[28:31], v[104:107]
    ds_read_b128 v[216:219], v9 offset:4096
    v_mfma_f32_16x16x32_bf16 v[108:111], v[180:183], v[28:31], v[108:111]
    ds_read_b128 v[220:223], v9 offset:6144
    v_mfma_f32_16x16x32_bf16 v[120:123], v[184:187], v[28:31], v[120:123]
    ds_read_b64_tr_b16 v[52:53], v11 offset:12288
    v_mfma_f32_16x16x32_bf16 v[124:127], v[188:191], v[28:31], v[124:127]
    ds_read_b64_tr_b16 v[54:55], v11 offset:12800
    v_mfma_f32_16x16x32_bf16 v[128:131], v[176:179], v[32:35], v[128:131]
    ds_read_b64_tr_b16 v[56:57], v10 offset:20480
    v_mfma_f32_16x16x32_bf16 v[132:135], v[180:183], v[32:35], v[132:135]
    ds_read_b64_tr_b16 v[58:59], v10 offset:20992
    v_mfma_f32_16x16x32_bf16 v[144:147], v[184:187], v[32:35], v[144:147]
    ds_read_b64_tr_b16 v[60:61], v11 offset:20480
    v_mfma_f32_16x16x32_bf16 v[148:151], v[188:191], v[32:35], v[148:151]
    ds_read_b64_tr_b16 v[62:63], v11 offset:20992
    v_mfma_f32_16x16x32_bf16 v[136:139], v[176:179], v[36:39], v[136:139]
    v_mfma_f32_16x16x32_bf16 v[140:143], v[180:183], v[36:39], v[140:143]
    v_mfma_f32_16x16x32_bf16 v[152:155], v[184:187], v[36:39], v[152:155]
    v_mfma_f32_16x16x32_bf16 v[156:159], v[188:191], v[36:39], v[156:159]
    s_waitcnt lgkmcnt(0)
    s_barrier
    v_mfma_f32_16x16x32_bf16 v[96:99], v[208:211], v[48:51], v[96:99]
    v_mfma_f32_16x16x32_bf16 v[100:103], v[212:215], v[48:51], v[100:103]
    v_mfma_f32_16x16x32_bf16 v[104:107], v[208:211], v[52:55], v[104:107]
    v_mfma_f32_16x16x32_bf16 v[108:111], v[212:215], v[52:55], v[108:111]
    v_mfma_f32_16x16x32_bf16 v[128:131], v[208:211], v[56:59], v[128:131]
    v_mfma_f32_16x16x32_bf16 v[132:135], v[212:215], v[56:59], v[132:135]
    v_mfma_f32_16x16x32_bf16 v[136:139], v[208:211], v[60:63], v[136:139]
    v_add_u32 v10, 81920, v6
    v_add_u32 v11, 81920, v7
    s_nop 2
    v_cvt_pk_bf16_f32 v16, v96, v97
    v_lshlrev_b32 v32, 16, v16
    v_and_b32 v33, 0xffff0000, v16
    v_mul_f32 v34, s72, v32
    v_mul_f32 v35, s72, v33
    v_exp_f32 v34, v34 clamp
    v_exp_f32 v35, v35 clamp
    v_max_f32 v32, 0, v32
    v_mfma_f32_16x16x32_bf16 v[140:143], v[212:215], v[60:63], v[140:143]
    v_max_f32 v33, 0, v33
    v_add_f32 v32, v32, v34
    v_add_f32 v33, v33, v35
    v_min_f32 v36, v32, v33
    v_cvt_pk_bf16_f32 v16, v32, v33
    v_cvt_pk_bf16_f32 v17, v98, v99
    v_lshlrev_b32 v32, 16, v17
    v_and_b32 v33, 0xffff0000, v17
    v_mfma_f32_16x16x32_bf16 v[112:115], v[216:219], v[48:51], v[112:115]
    v_mul_f32 v34, s72, v32
    v_mul_f32 v35, s72, v33
    v_exp_f32 v34, v34 clamp
    v_exp_f32 v35, v35 clamp
    v_max_f32 v32, 0, v32
    v_max_f32 v33, 0, v33
    v_add_f32 v32, v32, v34
    v_add_f32 v33, v33, v35
    v_mfma_f32_16x16x32_bf16 v[116:119], v[220:223], v[48:51], v[116:119]
    v_min3_f32 v36, v32, v33, v36
    v_cvt_pk_bf16_f32 v17, v32, v33
    v_cvt_pk_bf16_f32 v18, v100, v101
    v_lshlrev_b32 v32, 16, v18
    v_and_b32 v33, 0xffff0000, v18
    v_mul_f32 v34, s72, v32
    v_mul_f32 v35, s72, v33
    v_exp_f32 v34, v34 clamp
    v_mfma_f32_16x16x32_bf16 v[120:123], v[216:219], v[52:55], v[120:123]
    v_exp_f32 v35, v35 clamp
    v_max_f32 v32, 0, v32
    v_max_f32 v33, 0, v33
    v_add_f32 v32, v32, v34
    v_add_f32 v33, v33, v35
    v_min3_f32 v36, v32, v33, v36
    v_cvt_pk_bf16_f32 v18, v32, v33
    v_cvt_pk_bf16_f32 v19, v102, v103
    v_mfma_f32_16x16x32_bf16 v[124:127], v[220:223], v[52:55], v[124:127]
    v_lshlrev_b32 v32, 16, v19
    v_and_b32 v33, 0xffff0000, v19
    v_mul_f32 v34, s72, v32
    v_mul_f32 v35, s72, v33
    v_exp_f32 v34, v34 clamp
    v_exp_f32 v35, v35 clamp
    v_max_f32 v32, 0, v32
    v_max_f32 v33, 0, v33
    v_mfma_f32_16x16x32_bf16 v[144:147], v[216:219], v[56:59], v[144:147]
    v_add_f32 v32, v32, v34
    v_add_f32 v33, v33, v35
    v_min3_f32 v36, v32, v33, v36
    v_cvt_pk_bf16_f32 v19, v32, v33
    v_cvt_pk_bf16_f32 v20, v104, v105
    v_lshlrev_b32 v32, 16, v20
    v_and_b32 v33, 0xffff0000, v20
    v_mul_f32 v34, s72, v32
    v_mfma_f32_16x16x32_bf16 v[148:151], v[220:223], v[56:59], v[148:151]
    v_mul_f32 v35, s72, v33
    v_exp_f32 v34, v34 clamp
    v_exp_f32 v35, v35 clamp
    v_max_f32 v32, 0, v32
    v_max_f32 v33, 0, v33
    v_add_f32 v32, v32, v34
    v_add_f32 v33, v33, v35
    v_min3_f32 v36, v32, v33, v36
    v_mfma_f32_16x16x32_bf16 v[152:155], v[216:219], v[60:63], v[152:155]
    v_cvt_pk_bf16_f32 v20, v32, v33
    v_cvt_pk_bf16_f32 v21, v106, v107
    v_lshlrev_b32 v32, 16, v21
    v_and_b32 v33, 0xffff0000, v21
    v_mul_f32 v34, s72, v32
    v_mul_f32 v35, s72, v33
    v_exp_f32 v34, v34 clamp
    v_exp_f32 v35, v35 clamp
    v_mfma_f32_16x16x32_bf16 v[156:159], v[220:223], v[60:63], v[156:159]
    v_max_f32 v32, 0, v32
    v_max_f32 v33, 0, v33
    v_add_f32 v32, v32, v34
    v_add_f32 v33, v33, v35
    v_min3_f32 v36, v32, v33, v36
    v_cvt_pk_bf16_f32 v21, v32, v33
    v_cvt_pk_bf16_f32 v22, v108, v109
    v_lshlrev_b32 v32, 16, v22
    v_and_b32 v33, 0xffff0000, v22
    v_mul_f32 v34, s72, v32
    v_mul_f32 v35, s72, v33
    v_exp_f32 v34, v34 clamp
    v_exp_f32 v35, v35 clamp
    v_max_f32 v32, 0, v32
    v_max_f32 v33, 0, v33
    v_add_f32 v32, v32, v34
    v_add_f32 v33, v33, v35
    v_min3_f32 v36, v32, v33, v36
    v_cvt_pk_bf16_f32 v22, v32, v33
    v_cvt_pk_bf16_f32 v23, v110, v111
    v_lshlrev_b32 v32, 16, v23
    v_and_b32 v33, 0xffff0000, v23
    v_mul_f32 v34, s72, v32
    v_mul_f32 v35, s72, v33
    v_exp_f32 v34, v34 clamp
    v_exp_f32 v35, v35 clamp
    v_max_f32 v32, 0, v32
    v_max_f32 v33, 0, v33
    v_add_f32 v32, v32, v34
    v_add_f32 v33, v33, v35
    v_min3_f32 v36, v32, v33, v36
    v_cvt_pk_bf16_f32 v23, v32, v33
    v_cmp_gt_f32 vcc, 0x3a800000, v36
    s_cbranch_vccnz phi_16_fix
phi_16_done:
    v_cvt_pk_bf16_f32 v32, v128, v129
    v_cvt_pk_bf16_f32 v33, v130, v131
    v_mfma_f32_16x16x32_bf16 v[96:99], v[236:239], v[16:19], 0
    v_cvt_pk_bf16_f32 v34, v132, v133
    v_mfma_f32_16x16x32_bf16 v[60:63], v[236:239], v[20:23], 0
    v_cvt_pk_bf16_f32 v35, v134, v135
    v_cvt_pk_bf16_f32 v36, v136, v137
    v_cvt_pk_bf16_f32 v37, v138, v139
    v_mfma_f32_16x16x32_bf16 v[240:243], v[16:19], v[32:35], 0
    v_cvt_pk_bf16_f32 v38, v140, v141
    v_mfma_f32_16x16x32_bf16 v[244:247], v[20:23], v[32:35], 0
    v_cvt_pk_bf16_f32 v39, v142, v143
    s_nop 1
    v_mfma_f32_16x16x32_bf16 v[248:251], v[16:19], v[36:39], 0
    v_mfma_f32_16x16x32_bf16 v[252:255], v[20:23], v[36:39], 0
    v_cvt_pk_bf16_f32 v24, v112, v113
    v_lshlrev_b32 v48, 16, v24
    v_and_b32 v49, 0xffff0000, v24
    v_mul_f32 v50, s72, v48
    v_mul_f32 v51, s72, v49
    v_exp_f32 v50, v50 clamp
    v_exp_f32 v51, v51 clamp
    v_max_f32 v48, 0, v48
    v_max_f32 v49, 0, v49
    v_add_f32 v48, v48, v50
    v_add_f32 v49, v49, v51
    v_min_f32 v56, v48, v49
    v_cvt_pk_bf16_f32 v24, v48, v49
    v_cvt_pk_bf16_f32 v25, v114, v115
    v_lshlrev_b32 v48, 16, v25
    v_and_b32 v49, 0xffff0000, v25
    v_mul_f32 v50, s72, v48
    v_mul_f32 v51, s72, v49
    v_exp_f32 v50, v50 clamp
    v_exp_f32 v51, v51 clamp
    v_max_f32 v48, 0, v48
    v_max_f32 v49, 0, v49
    v_add_f32 v48, v48, v50
    v_add_f32 v49, v49, v51
    v_min3_f32 v56, v48, v49, v56
    v_cvt_pk_bf16_f32 v25, v48, v49
    v_cvt_pk_bf16_f32 v26, v116, v117
    v_lshlrev_b32 v48, 16, v26
    v_and_b32 v49, 0xffff0000, v26
    v_mul_f32 v50, s72, v48
    v_mul_f32 v51, s72, v49
    v_exp_f32 v50, v50 clamp
    v_exp_f32 v51, v51 clamp
    v_max_f32 v48, 0, v48
    v_max_f32 v49, 0, v49
    v_add_f32 v48, v48, v50
    v_add_f32 v49, v49, v51
    v_min3_f32 v56, v48, v49, v56
    v_cvt_pk_bf16_f32 v26, v48, v49
    v_cvt_pk_bf16_f32 v27, v118, v119
    v_lshlrev_b32 v48, 16, v27
    v_and_b32 v49, 0xffff0000, v27
    v_mul_f32 v50, s72, v48
    v_mul_f32 v51, s72, v49
    v_exp_f32 v50, v50 clamp
    v_exp_f32 v51, v51 clamp
    v_max_f32 v48, 0, v48
    v_max_f32 v49, 0, v49
    v_add_f32 v48, v48, v50
    v_add_f32 v49, v49, v51
    v_min3_f32 v56, v48, v49, v56
    v_cvt_pk_bf16_f32 v27, v48, v49
    v_cvt_pk_bf16_f32 v28, v120, v121
    v_lshlrev_b32 v48, 16, v28
    v_and_b32 v49, 0xffff0000, v28
    v_mul_f32 v50, s72, v48
    v_mul_f32 v51, s72, v49
    v_exp_f32 v50, v50 clamp
    v_exp_f32 v51, v51 clamp
    v_max_f32 v48, 0, v48
    v_max_f32 v49, 0, v49
    v_add_f32 v48, v48, v50
    v_add_f32 v49, v49, v51
    v_min3_f32 v56, v48, v49, v56
    v_cvt_pk_bf16_f32 v28, v48, v49
    v_cvt_pk_bf16_f32 v29, v122, v123
    v_lshlrev_b32 v48, 16, v29
    v_and_b32 v49, 0xffff0000, v29
    v_mul_f32 v50, s72, v48
    v_mul_f32 v51, s72, v49
    v_exp_f32 v50, v50 clamp
    v_exp_f32 v51, v51 clamp
    v_max_f32 v48, 0, v48
    v_max_f32 v49, 0, v49
    v_add_f32 v48, v48, v50
    v_add_f32 v49, v49, v51
    v_min3_f32 v56, v48, v49, v56
    v_cvt_pk_bf16_f32 v29, v48, v49
    v_cvt_pk_bf16_f32 v30, v124, v125
    v_lshlrev_b32 v48, 16, v30
    v_and_b32 v49, 0xffff0000, v30
    v_mul_f32 v50, s72, v48
    v_mul_f32 v51, s72, v49
    v_exp_f32 v50, v50 clamp
    v_exp_f32 v51, v51 clamp
    v_max_f32 v48, 0, v48
    v_max_f32 v49, 0, v49
    v_add_f32 v48, v48, v50
    v_add_f32 v49, v49, v51
    v_min3_f32 v56, v48, v49, v56
    v_cvt_pk_bf16_f32 v30, v48, v49
    v_cvt_pk_bf16_f32 v31, v126, v127
    v_lshlrev_b32 v48, 16, v31
    v_and_b32 v49, 0xffff0000, v31
    v_mul_f32 v50, s72, v48
    v_mul_f32 v51, s72, v49
    v_exp_f32 v50, v50 clamp
    v_exp_f32 v51, v51 clamp
    v_max_f32 v48, 0, v48
    v_max_f32 v49, 0, v49
    v_add_f32 v48, v48, v50
    v_add_f32 v49, v49, v51
    v_min3_f32 v56, v48, v49, v56
    v_cvt_pk_bf16_f32 v31, v48, v49
    v_cmp_gt_f32 vcc, 0x3a800000, v56
    s_cbranch_vccnz phi_17_fix
phi_17_done:
    v_cvt_pk_bf16_f32 v40, v144, v145
    v_cvt_pk_bf16_f32 v41, v146, v147
    v_mfma_f32_16x16x32_bf16 v[96:99], v[236:239], v[24:27], v[96:99]
    v_cvt_pk_bf16_f32 v42, v148, v149
    v_mfma_f32_16x16x32_bf16 v[60:63], v[236:239], v[28:31], v[60:63]
    v_cvt_pk_bf16_f32 v43, v150, v151
    v_cvt_pk_bf16_f32 v44, v152, v153
    v_cvt_pk_bf16_f32 v45, v154, v155
    v_mfma_f32_16x16x32_bf16 v[240:243], v[24:27], v[40:43], v[240:243]
    v_cvt_pk_bf16_f32 v46, v156, v157
    v_mfma_f32_16x16x32_bf16 v[244:247], v[28:31], v[40:43], v[244:247]
    v_cvt_pk_bf16_f32 v47, v158, v159
    s_nop 1
    v_mfma_f32_16x16x32_bf16 v[248:251], v[24:27], v[44:47], v[248:251]
    v_mfma_f32_16x16x32_bf16 v[252:255], v[28:31], v[44:47], v[252:255]
    s_cmp_eq_u32 s6, 0
    s_cbranch_scc0 C_ex1
    ds_write_b32 v227, v60 offset:4608
    s_nop 5
    ds_write_b128 v224, v[248:251] offset:32768
    ds_write_b128 v224, v[252:255] offset:33792
C_ex2:
    ds_write_b32 v229, v231 offset:4288
C_ps:
    ds_read_b32 v25, v230 offset:4288
    ds_read_b128 v[16:19], v225 offset:32768
    ds_read_b128 v[20:23], v225 offset:33792
    ds_read_b32 v24, v228 offset:4608
    s_waitcnt lgkmcnt(0)
    v_cmp_eq_u32 vcc, 0, v25
    s_cbranch_vccnz C_ps
    v_add_f32 v16, v16, v240
    v_add_f32 v17, v17, v241
    v_add_f32 v18, v18, v242
    v_add_f32 v19, v19, v243
    v_add_f32 v20, v20, v244
    v_add_f32 v21, v21, v245
    v_add_f32 v22, v22, v246
    v_add_f32 v23, v23, v247
    v_add_f32 v24, v24, v96
    v_cvt_pk_bf16_f32 v28, v16, v17
    v_cvt_pk_bf16_f32 v29, v18, v19
    v_cvt_pk_bf16_f32 v30, v20, v21
    v_cvt_pk_bf16_f32 v31, v22, v23
    buffer_store_dwordx4 v[28:31], v1, s[16:19], s43 offen sc0 sc1
    s_mov_b64 exec, 0xffff
    buffer_store_dword v24, v232, s[16:19], s43 offen offset:1024 sc0 sc1
    s_mov_b64 exec, 1
    buffer_atomic_or v233, v234, s[16:19], 0 offen
    s_mov_b64 exec, -1
    ds_read_b64_tr_b16 v[96:97], v10 offset:0
    ds_read_b64_tr_b16 v[98:99], v10 offset:512
    ds_read_b64_tr_b16 v[100:101], v11 offset:0
    ds_read_b64_tr_b16 v[102:103], v11 offset:512
    ds_read_b64_tr_b16 v[104:105], v10 offset:4096
    ds_read_b64_tr_b16 v[106:107], v10 offset:4608
    ds_read_b64_tr_b16 v[108:109], v11 offset:4096
    ds_read_b64_tr_b16 v[110:111], v11 offset:4608
    ds_read_b64_tr_b16 v[112:113], v6 offset:0
    ds_read_b64_tr_b16 v[114:115], v6 offset:512
    ds_read_b64_tr_b16 v[116:117], v7 offset:0
    ds_read_b64_tr_b16 v[118:119], v7 offset:512
    ds_read_b64_tr_b16 v[120:121], v6 offset:4096
    ds_read_b64_tr_b16 v[122:123], v6 offset:4608
    ds_read_b64_tr_b16 v[124:125], v7 offset:4096
    ds_read_b64_tr_b16 v[126:127], v7 offset:4608
    s_waitcnt lgkmcnt(12)
    v_mfma_f32_16x16x32_bf16 v[64:67], v[96:99], v[192:195], v[64:67]
    v_mfma_f32_16x16x32_bf16 v[72:75], v[96:99], v[196:199], v[72:75]
    v_mfma_f32_16x16x32_bf16 v[80:83], v[96:99], v[200:203], v[80:83]
    v_mfma_f32_16x16x32_bf16 v[88:91], v[96:99], v[204:207], v[88:91]
    v_mfma_f32_16x16x32_bf16 v[68:71], v[100:103], v[192:195], v[68:71]
    v_mfma_f32_16x16x32_bf16 v[76:79], v[100:103], v[196:199], v[76:79]
    v_mfma_f32_16x16x32_bf16 v[84:87], v[100:103], v[200:203], v[84:87]
    v_mfma_f32_16x16x32_bf16 v[92:95], v[100:103], v[204:207], v[92:95]
    s_waitcnt lgkmcnt(8)
    v_mfma_f32_16x16x32_bf16 v[64:67], v[104:107], v[160:163], v[64:67]
    v_mfma_f32_16x16x32_bf16 v[72:75], v[104:107], v[164:167], v[72:75]
    v_mfma_f32_16x16x32_bf16 v[80:83], v[104:107], v[168:171], v[80:83]
    v_mfma_f32_16x16x32_bf16 v[88:91], v[104:107], v[172:175], v[88:91]
    v_mfma_f32_16x16x32_bf16 v[68:71], v[108:111], v[160:163], v[68:71]
    v_mfma_f32_16x16x32_bf16 v[76:79], v[108:111], v[164:167], v[76:79]
    v_mfma_f32_16x16x32_bf16 v[84:87], v[108:111], v[168:171], v[84:87]
    v_mfma_f32_16x16x32_bf16 v[92:95], v[108:111], v[172:175], v[92:95]
    s_waitcnt lgkmcnt(4)
    v_mfma_f32_16x16x32_bf16 v[64:67], v[112:115], v[176:179], v[64:67]
    v_mfma_f32_16x16x32_bf16 v[72:75], v[112:115], v[180:183], v[72:75]
    v_mfma_f32_16x16x32_bf16 v[80:83], v[112:115], v[184:187], v[80:83]
    v_mfma_f32_16x16x32_bf16 v[88:91], v[112:115], v[188:191], v[88:91]
    v_mfma_f32_16x16x32_bf16 v[68:71], v[116:119], v[176:179], v[68:71]
    v_mfma_f32_16x16x32_bf16 v[76:79], v[116:119], v[180:183], v[76:79]
    v_mfma_f32_16x16x32_bf16 v[84:87], v[116:119], v[184:187], v[84:87]
    v_mfma_f32_16x16x32_bf16 v[92:95], v[116:119], v[188:191], v[92:95]
    s_waitcnt lgkmcnt(0)
    v_mfma_f32_16x16x32_bf16 v[64:67], v[120:123], v[208:211], v[64:67]
    v_mfma_f32_16x16x32_bf16 v[72:75], v[120:123], v[212:215], v[72:75]
    v_mfma_f32_16x16x32_bf16 v[80:83], v[120:123], v[216:219], v[80:83]
    v_mfma_f32_16x16x32_bf16 v[88:91], v[120:123], v[220:223], v[88:91]
    v_mfma_f32_16x16x32_bf16 v[68:71], v[124:127], v[208:211], v[68:71]
    v_mfma_f32_16x16x32_bf16 v[76:79], v[124:127], v[212:215], v[76:79]
    v_mfma_f32_16x16x32_bf16 v[84:87], v[124:127], v[216:219], v[84:87]
    v_mfma_f32_16x16x32_bf16 v[92:95], v[124:127], v[220:223], v[92:95]
    v_mov_b32 v254, v15
    v_mov_b32 v255, v13
    s_cmp_lg_u32 s3, 0
    s_cbranch_scc1 C_nh0
    s_lshr_b32 s64, s2, 2
    s_lshl_b32 s64, s64, 14
    s_add_u32 s64, s64, 5398528
    v_lshl_add_u32 v152, v2, 4, s64
    s_mov_b32 s64, 0
    buffer_load_dwordx4 v[156:159], v152, s[16:19], s64 offen offset:0 sc1
    s_mov_b32 s64, 0
    buffer_load_dwordx4 v[160:163], v152, s[16:19], s64 offen offset:1024 sc1
    s_mov_b32 s64, 0
    buffer_load_dwordx4 v[164:167], v152, s[16:19], s64 offen offset:2048 sc1
    s_mov_b32 s64, 0
    buffer_load_dwordx4 v[168:171], v152, s[16:19], s64 offen offset:3072 sc1
    s_mov_b32 s64, 4096
    buffer_load_dwordx4 v[172:175], v152, s[16:19], s64 offen offset:0 sc1
    s_mov_b32 s64, 4096
    buffer_load_dwordx4 v[176:179], v152, s[16:19], s64 offen offset:1024 sc1
    s_mov_b32 s64, 4096
    buffer_load_dwordx4 v[180:183], v152, s[16:19], s64 offen offset:2048 sc1
    s_mov_b32 s64, 4096
    buffer_load_dwordx4 v[184:187], v152, s[16:19], s64 offen offset:3072 sc1
    s_mov_b32 s64, 8192
    buffer_load_dwordx4 v[188:191], v152, s[16:19], s64 offen offset:0 sc1
    s_mov_b32 s64, 8192
    buffer_load_dwordx4 v[192:195], v152, s[16:19], s64 offen offset:1024 sc1
    s_mov_b32 s64, 8192
    buffer_load_dwordx4 v[196:199], v152, s[16:19], s64 offen offset:2048 sc1
    s_mov_b32 s64, 8192
    buffer_load_dwordx4 v[200:203], v152, s[16:19], s64 offen offset:3072 sc1
    s_mov_b32 s64, 12288
    buffer_load_dwordx4 v[204:207], v152, s[16:19], s64 offen offset:0 sc1
    s_mov_b32 s64, 12288
    buffer_load_dwordx4 v[208:211], v152, s[16:19], s64 offen offset:1024 sc1
    s_mov_b32 s64, 12288
    buffer_load_dwordx4 v[212:215], v152, s[16:19], s64 offen offset:2048 sc1
    s_mov_b32 s64, 12288
    buffer_load_dwordx4 v[216:219], v152, s[16:19], s64 offen offset:3072 sc1
C_nh0:
    s_and_b32 s64, s3, 3
    s_lshl_b32 s64, s64, 1
    s_lshr_b32 s65, s3, 2
    s_add_u32 s64, s64, s65
    s_lshl_b32 s64, s64, 4
    s_lshl_b32 s65, s4, 7
    s_add_u32 s64, s64, s65
    v_and_b32 v230, 15, v2
    v_add_u32 v230, s64, v230
    v_bfe_u32 v3, v2, 4, 1
    v_lshlrev_b32 v229, 5, v3
    v_lshrrev_b32 v3, 5, v2
    v_lshl_add_u32 v229, v3, 4, v229
    v_lshl_add_u32 v231, v230, 11, v229
    s_lshl_b32 s64, s5, 7
    v_add_u32 v231, s64, v231
    v_lshlrev_b32 v3, 2, v230
    v_add_u32 v3, 6709248, v3
    buffer_load_dwordx4 v[220:223], v231, s[8:11], 0 offen
    buffer_load_dwordx4 v[224:227], v231, s[8:11], 0 offen offset:64
    buffer_load_dword v228, v3, s[16:19], 0 offen sc1
    v_lshlrev_b32 v3, 4, v2
    s_lshl_b32 s64, s7, 11
    v_add_u32 v4, s64, v3
    v_lshrrev_b32 v5, 4, v2
    v_lshlrev_b32 v5, 4, v5
    s_lshl_b32 s64, s7, 6
    v_add_u32 v5, s64, v5
    v_mov_b32 v6, 4256
    ds_read_b32 v6, v6
    v_cvt_pk_bf16_f32 v32, v64, v65
    v_lshlrev_b32 v48, 16, v32
    v_and_b32 v49, 0xffff0000, v32
    v_mul_f32 v50, s72, v48
    v_mul_f32 v51, s72, v49
    v_exp_f32 v50, v50 clamp
    v_exp_f32 v51, v51 clamp
    v_max_f32 v48, 0, v48
    v_max_f32 v49, 0, v49
    v_add_f32 v48, v48, v50
    v_add_f32 v49, v49, v51
    v_min_f32 v56, v48, v49
    v_cvt_pk_bf16_f32 v32, v48, v49
    v_cvt_pk_bf16_f32 v33, v66, v67
    v_lshlrev_b32 v48, 16, v33
    v_and_b32 v49, 0xffff0000, v33
    v_mul_f32 v50, s72, v48
    v_mul_f32 v51, s72, v49
    v_exp_f32 v50, v50 clamp
    v_exp_f32 v51, v51 clamp
    v_max_f32 v48, 0, v48
    v_max_f32 v49, 0, v49
    v_add_f32 v48, v48, v50
    v_add_f32 v49, v49, v51
    v_min3_f32 v56, v48, v49, v56
    v_cvt_pk_bf16_f32 v33, v48, v49
    v_cvt_pk_bf16_f32 v34, v68, v69
    v_lshlrev_b32 v48, 16, v34
    v_and_b32 v49, 0xffff0000, v34
    v_mul_f32 v50, s72, v48
    v_mul_f32 v51, s72, v49
    v_exp_f32 v50, v50 clamp
    v_exp_f32 v51, v51 clamp
    v_max_f32 v48, 0, v48
    v_max_f32 v49, 0, v49
    v_add_f32 v48, v48, v50
    v_add_f32 v49, v49, v51
    v_min3_f32 v56, v48, v49, v56
    v_cvt_pk_bf16_f32 v34, v48, v49
    v_cvt_pk_bf16_f32 v35, v70, v71
    v_lshlrev_b32 v48, 16, v35
    v_and_b32 v49, 0xffff0000, v35
    v_mul_f32 v50, s72, v48
    v_mul_f32 v51, s72, v49
    v_exp_f32 v50, v50 clamp
    v_exp_f32 v51, v51 clamp
    v_max_f32 v48, 0, v48
    v_max_f32 v49, 0, v49
    v_add_f32 v48, v48, v50
    v_add_f32 v49, v49, v51
    v_min3_f32 v56, v48, v49, v56
    v_cvt_pk_bf16_f32 v35, v48, v49
    v_cvt_pk_bf16_f32 v36, v72, v73
    v_lshlrev_b32 v48, 16, v36
    v_and_b32 v49, 0xffff0000, v36
    v_mul_f32 v50, s72, v48
    v_mul_f32 v51, s72, v49
    v_exp_f32 v50, v50 clamp
    v_exp_f32 v51, v51 clamp
    v_max_f32 v48, 0, v48
    v_max_f32 v49, 0, v49
    v_add_f32 v48, v48, v50
    v_add_f32 v49, v49, v51
    v_min3_f32 v56, v48, v49, v56
    v_cvt_pk_bf16_f32 v36, v48, v49
    v_cvt_pk_bf16_f32 v37, v74, v75
    v_lshlrev_b32 v48, 16, v37
    v_and_b32 v49, 0xffff0000, v37
    v_mul_f32 v50, s72, v48
    v_mul_f32 v51, s72, v49
    v_exp_f32 v50, v50 clamp
    v_exp_f32 v51, v51 clamp
    v_max_f32 v48, 0, v48
    v_max_f32 v49, 0, v49
    v_add_f32 v48, v48, v50
    v_add_f32 v49, v49, v51
    v_min3_f32 v56, v48, v49, v56
    v_cvt_pk_bf16_f32 v37, v48, v49
    v_cvt_pk_bf16_f32 v38, v76, v77
    v_lshlrev_b32 v48, 16, v38
    v_and_b32 v49, 0xffff0000, v38
    v_mul_f32 v50, s72, v48
    v_mul_f32 v51, s72, v49
    v_exp_f32 v50, v50 clamp
    v_exp_f32 v51, v51 clamp
    v_max_f32 v48, 0, v48
    v_max_f32 v49, 0, v49
    v_add_f32 v48, v48, v50
    v_add_f32 v49, v49, v51
    v_min3_f32 v56, v48, v49, v56
    v_cvt_pk_bf16_f32 v38, v48, v49
    v_cvt_pk_bf16_f32 v39, v78, v79
    v_lshlrev_b32 v48, 16, v39
    v_and_b32 v49, 0xffff0000, v39
    v_mul_f32 v50, s72, v48
    v_mul_f32 v51, s72, v49
    v_exp_f32 v50, v50 clamp
    v_exp_f32 v51, v51 clamp
    v_max_f32 v48, 0, v48
    v_max_f32 v49, 0, v49
    v_add_f32 v48, v48, v50
    v_add_f32 v49, v49, v51
    v_min3_f32 v56, v48, v49, v56
    v_cvt_pk_bf16_f32 v39, v48, v49
    v_cmp_gt_f32 vcc, 0x3a800000, v56
    s_cbranch_vccnz phi_18_fix
phi_18_done:
    v_cvt_pk_bf16_f32 v40, v80, v81
    v_lshlrev_b32 v48, 16, v40
    v_and_b32 v49, 0xffff0000, v40
    v_mul_f32 v50, s72, v48
    v_mul_f32 v51, s72, v49
    v_exp_f32 v50, v50 clamp
    v_exp_f32 v51, v51 clamp
    v_max_f32 v48, 0, v48
    v_max_f32 v49, 0, v49
    v_add_f32 v48, v48, v50
    v_add_f32 v49, v49, v51
    v_min_f32 v56, v48, v49
    v_cvt_pk_bf16_f32 v40, v48, v49
    v_cvt_pk_bf16_f32 v41, v82, v83
    v_lshlrev_b32 v48, 16, v41
    v_and_b32 v49, 0xffff0000, v41
    v_mul_f32 v50, s72, v48
    v_mul_f32 v51, s72, v49
    v_exp_f32 v50, v50 clamp
    v_exp_f32 v51, v51 clamp
    v_max_f32 v48, 0, v48
    v_max_f32 v49, 0, v49
    v_add_f32 v48, v48, v50
    v_add_f32 v49, v49, v51
    v_min3_f32 v56, v48, v49, v56
    v_cvt_pk_bf16_f32 v41, v48, v49
    v_cvt_pk_bf16_f32 v42, v84, v85
    v_lshlrev_b32 v48, 16, v42
    v_and_b32 v49, 0xffff0000, v42
    v_mul_f32 v50, s72, v48
    v_mul_f32 v51, s72, v49
    v_exp_f32 v50, v50 clamp
    v_exp_f32 v51, v51 clamp
    v_max_f32 v48, 0, v48
    v_max_f32 v49, 0, v49
    v_add_f32 v48, v48, v50
    v_add_f32 v49, v49, v51
    v_min3_f32 v56, v48, v49, v56
    v_cvt_pk_bf16_f32 v42, v48, v49
    v_cvt_pk_bf16_f32 v43, v86, v87
    v_lshlrev_b32 v48, 16, v43
    v_and_b32 v49, 0xffff0000, v43
    v_mul_f32 v50, s72, v48
    v_mul_f32 v51, s72, v49
    v_exp_f32 v50, v50 clamp
    v_exp_f32 v51, v51 clamp
    v_max_f32 v48, 0, v48
    v_max_f32 v49, 0, v49
    v_add_f32 v48, v48, v50
    v_add_f32 v49, v49, v51
    v_min3_f32 v56, v48, v49, v56
    v_cvt_pk_bf16_f32 v43, v48, v49
    v_cvt_pk_bf16_f32 v44, v88, v89
    v_lshlrev_b32 v48, 16, v44
    v_and_b32 v49, 0xffff0000, v44
    v_mul_f32 v50, s72, v48
    v_mul_f32 v51, s72, v49
    v_exp_f32 v50, v50 clamp
    v_exp_f32 v51, v51 clamp
    v_max_f32 v48, 0, v48
    v_max_f32 v49, 0, v49
    v_add_f32 v48, v48, v50
    v_add_f32 v49, v49, v51
    v_min3_f32 v56, v48, v49, v56
    v_cvt_pk_bf16_f32 v44, v48, v49
    v_cvt_pk_bf16_f32 v45, v90, v91
    v_lshlrev_b32 v48, 16, v45
    v_and_b32 v49, 0xffff0000, v45
    v_mul_f32 v50, s72, v48
    v_mul_f32 v51, s72, v49
    v_exp_f32 v50, v50 clamp
    v_exp_f32 v51, v51 clamp
    v_max_f32 v48, 0, v48
    v_max_f32 v49, 0, v49
    v_add_f32 v48, v48, v50
    v_add_f32 v49, v49, v51
    v_min3_f32 v56, v48, v49, v56
    v_cvt_pk_bf16_f32 v45, v48, v49
    v_cvt_pk_bf16_f32 v46, v92, v93
    v_lshlrev_b32 v48, 16, v46
    v_and_b32 v49, 0xffff0000, v46
    v_mul_f32 v50, s72, v48
    v_mul_f32 v51, s72, v49
    v_exp_f32 v50, v50 clamp
    v_exp_f32 v51, v51 clamp
    v_max_f32 v48, 0, v48
    v_max_f32 v49, 0, v49
    v_add_f32 v48, v48, v50
    v_add_f32 v49, v49, v51
    v_min3_f32 v56, v48, v49, v56
    v_cvt_pk_bf16_f32 v46, v48, v49
    v_cvt_pk_bf16_f32 v47, v94, v95
    v_lshlrev_b32 v48, 16, v47
    v_and_b32 v49, 0xffff0000, v47
    v_mul_f32 v50, s72, v48
    v_mul_f32 v51, s72, v49
    v_exp_f32 v50, v50 clamp
    v_exp_f32 v51, v51 clamp
    v_max_f32 v48, 0, v48
    v_max_f32 v49, 0, v49
    v_add_f32 v48, v48, v50
    v_add_f32 v49, v49, v51
    v_min3_f32 v56, v48, v49, v56
    v_cvt_pk_bf16_f32 v47, v48, v49
    v_cmp_gt_f32 vcc, 0x3a800000, v56
    s_cbranch_vccnz phi_19_fix
phi_19_done:
    s_waitcnt lgkmcnt(0)
    v_readfirstlane_b32 s75, v6
    s_waitcnt vmcnt(0)
    v_sub_f32 v248, 1.0, v228
    v_cvt_pk_bf16_f32 v248, v248, v248
    v_lshlrev_b32 v248, 16, v248
    v_lshlrev_b32 v232, 16, v220
    v_and_b32 v233, 0xffff0000, v220
    v_mul_f32 v232, v232, v248
    v_mul_f32 v233, v233, v248
    v_cvt_pk_bf16_f32 v3, v232, v233
    v_lshlrev_b32 v232, 16, v3
    v_and_b32 v233, 0xffff0000, v3
    v_lshlrev_b32 v234, 16, v221
    v_and_b32 v235, 0xffff0000, v221
    v_mul_f32 v234, v234, v248
    v_mul_f32 v235, v235, v248
    v_cvt_pk_bf16_f32 v3, v234, v235
    v_lshlrev_b32 v234, 16, v3
    v_and_b32 v235, 0xffff0000, v3
    v_lshlrev_b32 v236, 16, v222
    v_and_b32 v237, 0xffff0000, v222
    v_mul_f32 v236, v236, v248
    v_mul_f32 v237, v237, v248
    v_cvt_pk_bf16_f32 v3, v236, v237
    v_lshlrev_b32 v236, 16, v3
    v_and_b32 v237, 0xffff0000, v3
    v_lshlrev_b32 v238, 16, v223
    v_and_b32 v239, 0xffff0000, v223
    v_mul_f32 v238, v238, v248
    v_mul_f32 v239, v239, v248
    v_cvt_pk_bf16_f32 v3, v238, v239
    v_lshlrev_b32 v238, 16, v3
    v_and_b32 v239, 0xffff0000, v3
    v_lshlrev_b32 v240, 16, v224
    v_and_b32 v241, 0xffff0000, v224
    v_mul_f32 v240, v240, v248
    v_mul_f32 v241, v241, v248
    v_cvt_pk_bf16_f32 v3, v240, v241
    v_lshlrev_b32 v240, 16, v3
    v_and_b32 v241, 0xffff0000, v3
    v_lshlrev_b32 v242, 16, v225
    v_and_b32 v243, 0xffff0000, v225
    v_mul_f32 v242, v242, v248
    v_mul_f32 v243, v243, v248
    v_cvt_pk_bf16_f32 v3, v242, v243
    v_lshlrev_b32 v242, 16, v3
    v_and_b32 v243, 0xffff0000, v3
    v_lshlrev_b32 v244, 16, v226
    v_and_b32 v245, 0xffff0000, v226
    v_mul_f32 v244, v244, v248
    v_mul_f32 v245, v245, v248
    v_cvt_pk_bf16_f32 v3, v244, v245
    v_lshlrev_b32 v244, 16, v3
    v_and_b32 v245, 0xffff0000, v3
    v_lshlrev_b32 v246, 16, v227
    v_and_b32 v247, 0xffff0000, v227
    v_mul_f32 v246, v246, v248
    v_mul_f32 v247, v247, v248
    v_cvt_pk_bf16_f32 v3, v246, v247
    v_lshlrev_b32 v246, 16, v3
    v_and_b32 v247, 0xffff0000, v3
    s_cmp_lg_u32 s3, 0
    s_cbranch_scc1 C_nh
    s_mov_b32 s65, 0
    v_lshrrev_b32 v155, 4, v2
H_hl:
    v_max3_u32 v153, v156, v157, v158
    v_max3_u32 v153, v159, v160, v153
    v_max3_u32 v153, v161, v162, v153
    v_max3_u32 v153, v163, v164, v153
    v_max3_u32 v153, v165, v166, v153
    v_max3_u32 v153, v167, v168, v153
    v_max3_u32 v153, v169, v170, v153
    v_max3_u32 v153, v171, v172, v153
    v_max3_u32 v153, v173, v174, v153
    v_max3_u32 v153, v175, v176, v153
    v_max3_u32 v153, v177, v178, v153
    v_max3_u32 v153, v179, v180, v153
    v_max3_u32 v153, v181, v182, v153
    v_max3_u32 v153, v183, v184, v153
    v_max3_u32 v153, v185, v186, v153
    v_max3_u32 v153, v187, v188, v153
    v_max3_u32 v153, v189, v190, v153
    v_max3_u32 v153, v191, v192, v153
    v_max3_u32 v153, v193, v194, v153
    v_max3_u32 v153, v195, v196, v153
    v_max3_u32 v153, v197, v198, v153
    v_max3_u32 v153, v199, v200, v153
    v_max3_u32 v153, v201, v202, v153
    v_max3_u32 v153, v203, v204, v153
    v_max3_u32 v153, v205, v206, v153
    v_max3_u32 v153, v207, v208, v153
    v_max3_u32 v153, v209, v210, v153
    v_max3_u32 v153, v211, v212, v153
    v_max3_u32 v153, v213, v214, v153
    v_max3_u32 v153, v215, v216, v153
    v_max3_u32 v153, v217, v218, v153
    v_max_u32 v153, v219, v153
    s_mov_b32 exec_lo, 0x3fff3fff
    s_mov_b32 exec_hi, 0x3fff3fff
    v_cmp_eq_u32 vcc, -1, v153
    s_mov_b64 exec, -1
    s_cbranch_vccz H_hok
    s_add_u32 s65, s65, 1
    s_cmp_ge_u32 s65, 100000
    s_cbranch_scc1 H_hok
    s_sleep 8
    s_lshr_b32 s64, s2, 2
    s_lshl_b32 s64, s64, 14
    s_add_u32 s64, s64, 5398528
    v_lshl_add_u32 v152, v2, 4, s64
    s_mov_b32 s64, 0
    buffer_load_dwordx4 v[156:159], v152, s[16:19], s64 offen offset:0 sc1
    s_mov_b32 s64, 0
    buffer_load_dwordx4 v[160:163], v152, s[16:19], s64 offen offset:1024 sc1
    s_mov_b32 s64, 0
    buffer_load_dwordx4 v[164:167], v152, s[16:19], s64 offen offset:2048 sc1
    s_mov_b32 s64, 0
    buffer_load_dwordx4 v[168:171], v152, s[16:19], s64 offen offset:3072 sc1
    s_mov_b32 s64, 4096
    buffer_load_dwordx4 v[172:175], v152, s[16:19], s64 offen offset:0 sc1
    s_mov_b32 s64, 4096
    buffer_load_dwordx4 v[176:179], v152, s[16:19], s64 offen offset:1024 sc1
    s_mov_b32 s64, 4096
    buffer_load_dwordx4 v[180:183], v152, s[16:19], s64 offen offset:2048 sc1
    s_mov_b32 s64, 4096
    buffer_load_dwordx4 v[184:187], v152, s[16:19], s64 offen offset:3072 sc1
    s_mov_b32 s64, 8192
    buffer_load_dwordx4 v[188:191], v152, s[16:19], s64 offen offset:0 sc1
    s_mov_b32 s64, 8192
    buffer_load_dwordx4 v[192:195], v152, s[16:19], s64 offen offset:1024 sc1
    s_mov_b32 s64, 8192
    buffer_load_dwordx4 v[196:199], v152, s[16:19], s64 offen offset:2048 sc1
    s_mov_b32 s64, 8192
    buffer_load_dwordx4 v[200:203], v152, s[16:19], s64 offen offset:3072 sc1
    s_mov_b32 s64, 12288
    buffer_load_dwordx4 v[204:207], v152, s[16:19], s64 offen offset:0 sc1
    s_mov_b32 s64, 12288
    buffer_load_dwordx4 v[208:211], v152, s[16:19], s64 offen offset:1024 sc1
    s_mov_b32 s64, 12288
    buffer_load_dwordx4 v[212:215], v152, s[16:19], s64 offen offset:2048 sc1
    s_mov_b32 s64, 12288
    buffer_load_dwordx4 v[216:219], v152, s[16:19], s64 offen offset:3072 sc1
    s_waitcnt vmcnt(0)
    s_branch H_hl
H_hok:
    v_add_f32 v156, v156, v160
    v_add_f32 v157, v157, v161
    v_add_f32 v158, v158, v162
    v_add_f32 v159, v159, v163
    v_add_f32 v156, v156, v164
    v_add_f32 v157, v157, v165
    v_add_f32 v158, v158, v166
    v_add_f32 v159, v159, v167
    v_add_f32 v156, v156, v168
    v_add_f32 v157, v157, v169
    v_add_f32 v158, v158, v170
    v_add_f32 v159, v159, v171
    v_add_f32 v156, v156, v172
    v_add_f32 v157, v157, v173
    v_add_f32 v158, v158, v174
    v_add_f32 v159, v159, v175
    v_add_f32 v156, v156, v176
    v_add_f32 v157, v157, v177
    v_add_f32 v158, v158, v178
    v_add_f32 v159, v159, v179
    v_add_f32 v156, v156, v180
    v_add_f32 v157, v157, v181
    v_add_f32 v158, v158, v182
    v_add_f32 v159, v159, v183
    v_add_f32 v156, v156, v184
    v_add_f32 v157, v157, v185
    v_add_f32 v158, v158, v186
    v_add_f32 v159, v159, v187
    v_add_f32 v188, v188, v192
    v_add_f32 v189, v189, v193
    v_add_f32 v190, v190, v194
    v_add_f32 v191, v191, v195
    v_add_f32 v188, v188, v196
    v_add_f32 v189, v189, v197
    v_add_f32 v190, v190, v198
    v_add_f32 v191, v191, v199
    v_add_f32 v188, v188, v200
    v_add_f32 v189, v189, v201
    v_add_f32 v190, v190, v202
    v_add_f32 v191, v191, v203
    v_add_f32 v188, v188, v204
    v_add_f32 v189, v189, v205
    v_add_f32 v190, v190, v206
    v_add_f32 v191, v191, v207
    v_add_f32 v188, v188, v208
    v_add_f32 v189, v189, v209
    v_add_f32 v190, v190, v210
    v_add_f32 v191, v191, v211
    v_add_f32 v188, v188, v212
    v_add_f32 v189, v189, v213
    v_add_f32 v190, v190, v214
    v_add_f32 v191, v191, v215
    v_add_f32 v188, v188, v216
    v_add_f32 v189, v189, v217
    v_add_f32 v190, v190, v218
    v_add_f32 v191, v191, v219
    s_nop 1
    v_permlane16_swap_b32 v156, v188
    v_permlane16_swap_b32 v157, v189
    v_permlane16_swap_b32 v158, v190
    v_permlane16_swap_b32 v159, v191
    v_add_f32 v156, v156, v188
    v_add_f32 v157, v157, v189
    v_add_f32 v158, v158, v190
    v_add_f32 v159, v159, v191
    s_nop 1
    v_permlane32_swap_b32 v156, v158
    v_permlane32_swap_b32 v157, v159
    v_add_f32 v156, v156, v158
    v_add_f32 v157, v157, v159
    s_nop 1
    v_permlane16_swap_b32 v156, v157
    v_cvt_pk_bf16_f32 v158, v156, v157
    v_lshlrev_b32 v156, 16, v158
    v_and_b32 v157, 0xffff0000, v158
    v_mul_f32 v158, s72, v156
    v_exp_f32 v158, -v158
    v_and_b32 v154, 15, v2
    v_add_f32 v158, 1.0, v158
    v_rcp_f32 v158, v158
    v_lshl_add_u32 v154, v154, 2, v155
    v_mul_f32 v158, v158, v156
    v_cvt_pk_bf16_f32 v158, v158, v158
    v_lshlrev_b32 v158, 16, v158
    v_mul_f32 v158, v158, v157
    v_cvt_pk_bf16_f32 v158, v158, v158
    v_lshlrev_b32 v158, 16, v158
    v_lshlrev_b32 v154, 2, v154
    ds_write_b32 v154, v158 offset:4352
    s_waitcnt lgkmcnt(0)
C_nh:
    v_lshlrev_b32 v3, 4, v2
    s_barrier
    ds_read_b128 v[24:27], v5 offset:4096
    ds_read_b128 v[16:19], v4 offset:0
    ds_read_b128 v[20:23], v4 offset:1024
    s_waitcnt lgkmcnt(2)
    v_mfma_f32_16x16x32_bf16 v[96:99], v[24:27], v[32:35], 0
    v_mfma_f32_16x16x32_bf16 v[100:103], v[24:27], v[36:39], 0
    v_mfma_f32_16x16x32_bf16 v[104:107], v[24:27], v[40:43], 0
    v_mfma_f32_16x16x32_bf16 v[108:111], v[24:27], v[44:47], 0
    s_waitcnt lgkmcnt(0)
    v_mfma_f32_16x16x32_bf16 v[64:67], v[16:19], v[32:35], 0
    v_mfma_f32_16x16x32_bf16 v[68:71], v[20:23], v[32:35], 0
    v_mfma_f32_16x16x32_bf16 v[72:75], v[16:19], v[36:39], 0
    v_mfma_f32_16x16x32_bf16 v[76:79], v[20:23], v[36:39], 0
    v_mfma_f32_16x16x32_bf16 v[80:83], v[16:19], v[40:43], 0
    v_mfma_f32_16x16x32_bf16 v[84:87], v[20:23], v[40:43], 0
    v_mfma_f32_16x16x32_bf16 v[88:91], v[16:19], v[44:47], 0
    v_mfma_f32_16x16x32_bf16 v[92:95], v[20:23], v[44:47], 0
    v_cvt_pk_bf16_f32 v48, v96, v96
    v_cvt_pk_bf16_f32 v49, v100, v100
    v_cvt_pk_bf16_f32 v50, v104, v104
    v_cvt_pk_bf16_f32 v51, v108, v108
    v_lshlrev_b32 v48, 16, v48
    v_lshlrev_b32 v49, 16, v49
    v_lshlrev_b32 v50, 16, v50
    v_lshlrev_b32 v51, 16, v51
    v_add_f32 v48, s73, v48
    v_add_f32 v49, s73, v49
    v_add_f32 v50, s73, v50
    v_add_f32 v51, s73, v51
    v_cvt_pk_bf16_f32 v48, v48, v48
    v_cvt_pk_bf16_f32 v49, v49, v49
    v_cvt_pk_bf16_f32 v50, v50, v50
    v_cvt_pk_bf16_f32 v51, v51, v51
    v_lshlrev_b32 v48, 16, v48
    v_lshlrev_b32 v49, 16, v49
    v_lshlrev_b32 v50, 16, v50
    v_lshlrev_b32 v51, 16, v51
    v_rcp_f32 v48, v48
    v_rcp_f32 v49, v49
    v_rcp_f32 v50, v50
    v_rcp_f32 v51, v51
    s_nop 0
    v_mul_f32 v64, v64, v48
    v_mul_f32 v65, v65, v48
    v_cvt_pk_bf16_f32 v128, v64, v65
    v_mul_f32 v66, v66, v48
    v_mul_f32 v67, v67, v48
    v_cvt_pk_bf16_f32 v129, v66, v67
    v_mul_f32 v68, v68, v48
    v_mul_f32 v69, v69, v48
    v_cvt_pk_bf16_f32 v130, v68, v69
    v_mul_f32 v70, v70, v48
    v_mul_f32 v71, v71, v48
    v_cvt_pk_bf16_f32 v131, v70, v71
    buffer_store_dwordx4 v[128:131], v1, s[16:19], s42 offen offset:0 sc0 sc1
    v_mul_f32 v72, v72, v49
    v_mul_f32 v73, v73, v49
    v_cvt_pk_bf16_f32 v132, v72, v73
    v_mul_f32 v74, v74, v49
    v_mul_f32 v75, v75, v49
    v_cvt_pk_bf16_f32 v133, v74, v75
    v_mul_f32 v76, v76, v49
    v_mul_f32 v77, v77, v49
    v_cvt_pk_bf16_f32 v134, v76, v77
    v_mul_f32 v78, v78, v49
    v_mul_f32 v79, v79, v49
    v_cvt_pk_bf16_f32 v135, v78, v79
    buffer_store_dwordx4 v[132:135], v1, s[16:19], s42 offen offset:1024 sc0 sc1
    s_add_u32 s42, s42, 65536
    v_mul_f32 v80, v80, v50
    v_mul_f32 v81, v81, v50
    v_cvt_pk_bf16_f32 v136, v80, v81
    v_mul_f32 v82, v82, v50
    v_mul_f32 v83, v83, v50
    v_cvt_pk_bf16_f32 v137, v82, v83
    v_mul_f32 v84, v84, v50
    v_mul_f32 v85, v85, v50
    v_cvt_pk_bf16_f32 v138, v84, v85
    v_mul_f32 v86, v86, v50
    v_mul_f32 v87, v87, v50
    v_cvt_pk_bf16_f32 v139, v86, v87
    buffer_store_dwordx4 v[136:139], v1, s[16:19], s42 offen offset:0 sc0 sc1
    v_mul_f32 v88, v88, v51
    v_mul_f32 v89, v89, v51
    v_cvt_pk_bf16_f32 v140, v88, v89
    v_mul_f32 v90, v90, v51
    v_mul_f32 v91, v91, v51
    v_cvt_pk_bf16_f32 v141, v90, v91
    v_mul_f32 v92, v92, v51
    v_mul_f32 v93, v93, v51
    v_cvt_pk_bf16_f32 v142, v92, v93
    v_mul_f32 v94, v94, v51
    v_mul_f32 v95, v95, v51
    v_cvt_pk_bf16_f32 v143, v94, v95
    buffer_store_dwordx4 v[140:143], v1, s[16:19], s42 offen offset:1024 sc0 sc1
    s_lshl_b32 s64, s4, 3
    s_add_u32 s64, s64, s3
    s_lshl_b32 s64, s64, 7
    s_add_u32 s64, s64, 5382144
    v_mov_b32 v14, s64
    s_mov_b64 exec, 1
    v_mov_b32 v15, 0
    buffer_atomic_or v15, v14, s[16:19], 0 offen sc0
    s_mov_b64 exec, -1
P2_start:
    s_and_b32 s6, s3, 3
    s_lshr_b32 s7, s3, 2
    s_mov_b32 s20, s58
    s_mov_b32 s21, s59
    s_mov_b32 s22, 0x400000
    s_mov_b32 s23, 0x00020000
    s_and_b32 s67, s75, 0x7ff
    s_sub_u32 s67, 2047, s67
    s_lshl_b32 s64, s4, 2
    s_add_u32 s64, s64, s6
    s_lshl_b32 s64, s64, 16
    s_lshl_b32 s65, s7, 15
    s_add_u32 s64, s64, s65
    s_lshl_b32 s65, s7, 10
    s_add_u32 s66, s64, s65
    s_xor_b32 s64, s66, 1024
    v_lshlrev_b32 v12, 4, v2
    v_add_u32 v4, s66, v12
    v_add_u32 v12, s64, v12
    v_lshrrev_b32 v10, 4, v2
    v_bfe_u32 v11, v2, 2, 2
    v_lshl_add_u32 v10, v10, 2, v11
    v_bfe_u32 v13, v10, 1, 2
    v_lshlrev_b32 v10, 7, v10
    v_lshl_add_u32 v10, v13, 5, v10
    v_and_b32 v13, 3, v2
    v_lshl_add_u32 v5, v13, 3, v10
    v_xor_b32 v6, 32, v5
    v_xor_b32 v1, 64, v5
    v_xor_b32 v3, 96, v5
    s_and_b32 s74, s5, 7
    s_lshl_b32 s74, s74, 1
    s_cmp_eq_u32 s7, 0
    s_mov_b32 s64, 147456
    s_cselect_b32 s64, 131072, s64
    s_sub_u32 m0, 16, s74
    s_and_b32 m0, m0, 15
    v_writelane_b32 v7, s64, m0
    s_cmp_eq_u32 s7, 0
    s_mov_b32 s64, 155648
    s_cselect_b32 s64, 139264, s64
    s_sub_u32 m0, 18, s74
    s_and_b32 m0, m0, 15
    v_writelane_b32 v7, s64, m0
    s_cmp_eq_u32 s7, 0
    s_mov_b32 s64, 81920
    s_cselect_b32 s64, 73728, s64
    s_sub_u32 m0, 20, s74
    s_and_b32 m0, m0, 15
    v_writelane_b32 v7, s64, m0
    s_cmp_eq_u32 s7, 0
    s_mov_b32 s64, 122880
    s_cselect_b32 s64, 114688, s64
    s_sub_u32 m0, 22, s74
    s_and_b32 m0, m0, 15
    v_writelane_b32 v7, s64, m0
    s_cmp_eq_u32 s7, 0
    s_mov_b32 s64, 49152
    s_cselect_b32 s64, 40960, s64
    s_sub_u32 m0, 24, s74
    s_and_b32 m0, m0, 15
    v_writelane_b32 v7, s64, m0
    s_cmp_eq_u32 s7, 0
    s_mov_b32 s64, 57344
    s_cselect_b32 s64, 8192, s64
    s_sub_u32 m0, 26, s74
    s_and_b32 m0, m0, 15
    v_writelane_b32 v7, s64, m0
    s_cmp_eq_u32 s7, 0
    s_mov_b32 s64, 65536
    s_cselect_b32 s64, 16384, s64
    s_sub_u32 m0, 28, s74
    s_and_b32 m0, m0, 15
    v_writelane_b32 v7, s64, m0
    s_cmp_eq_u32 s7, 0
    s_mov_b32 s64, 90112
    s_cselect_b32 s64, 98304, s64
    s_sub_u32 m0, 30, s74
    s_and_b32 m0, m0, 15
    v_writelane_b32 v7, s64, m0
    s_cmp_eq_u32 s7, 0
    v_mov_b32 v16, 0
    v_mov_b32 v17, 0
    v_mov_b32 v18, 0
    v_mov_b32 v19, 0
    v_mov_b32 v20, 0
    v_mov_b32 v21, 0
    v_mov_b32 v22, 0
    v_mov_b32 v23, 0
    v_mov_b32 v24, 0
    v_mov_b32 v25, 0
    v_mov_b32 v26, 0
    v_mov_b32 v27, 0
    v_mov_b32 v28, 0
    v_mov_b32 v29, 0
    v_mov_b32 v30, 0
    v_mov_b32 v31, 0
    v_mov_b32 v32, 0
    v_mov_b32 v33, 0
    v_mov_b32 v34, 0
    v_mov_b32 v35, 0
    v_mov_b32 v36, 0
    v_mov_b32 v37, 0
    v_mov_b32 v38, 0
    v_mov_b32 v39, 0
    v_mov_b32 v40, 0
    v_mov_b32 v41, 0
    v_mov_b32 v42, 0
    v_mov_b32 v43, 0
    v_mov_b32 v44, 0
    v_mov_b32 v45, 0
    v_mov_b32 v46, 0
    v_mov_b32 v47, 0
    v_mov_b32 v209, 0
    v_mov_b32 v215, 0
    s_lshr_b32 s46, s67, 7
    s_xor_b32 s46, s46, s4
    s_or_b32 s46, s46, s7
    s_mov_b32 s47, 0
    s_cbranch_scc0 P2_ys
P2_ysd:
    s_mov_b32 s66, 0x5555
    s_mov_b32 s65, 0
    s_cmp_lt_u32 s3, 4
    s_cbranch_scc0 D_wait
    s_waitcnt vmcnt(1)
    s_mov_b64 exec, 3
    buffer_atomic_or v255, v254, s[16:19], 0 offen
    s_mov_b64 exec, -1
    s_waitcnt vmcnt(1)
    s_branch D_got
D_wait:
    s_waitcnt vmcnt(0)
D_got:
    v_readfirstlane_b32 s68, v15
    s_mul_i32 s68, s68, 0x10001
    s_lshr_b32 s68, s68, s74
    s_lshr_b32 s64, s68, 1
    s_and_b32 s68, s68, s64
    s_and_b32 s68, s68, s66
    s_cbranch_scc1 D_go
    s_add_u32 s65, s65, 1
    s_cmp_ge_u32 s65, 40000
    s_cbranch_scc1 D_end
    s_sleep 1
    s_mov_b64 exec, 1
    v_mov_b32 v15, 0
    buffer_atomic_or v15, v14, s[16:19], 0 offen sc0
    s_mov_b64 exec, -1
    s_branch D_wait
D_go:
    s_andn2_b32 s66, s66, s68
    s_bcnt1_i32_b32 s70, s68
    s_or_b32 s64, s46, s66
    s_cbranch_scc0 P2_yl
P2_nyl:
    s_cmp_gt_u32 s70, 4
    s_cbranch_scc1 D_t58
    s_cmp_gt_u32 s70, 2
    s_cbranch_scc1 D_t34
    s_cmp_eq_u32 s70, 2
    s_cbranch_scc1 D_e2
D_e1:
    s_ff1_i32_b32 s64, s68
    s_bitset0_b32 s68, s64
    v_readlane_b32 s32, v7, s64
    s_add_u32 s69, s64, s74
    s_and_b32 s69, s69, 15
    s_lshl_b32 s69, s69, 11
    buffer_load_dwordx4 v[80:83], v4, s[16:19], s69 offen sc1
    buffer_load_dwordx4 v[84:87], v12, s[16:19], s69 offen sc1
    s_add_u32 s69, s69, 2048
    buffer_load_dwordx4 v[88:91], v4, s[16:19], s69 offen sc1
    buffer_load_dwordx4 v[92:95], v12, s[16:19], s69 offen sc1
    s_mov_b64 exec, 1
    v_mov_b32 v15, 0
    buffer_atomic_or v15, v14, s[16:19], 0 offen sc0
    s_mov_b64 exec, -1
    v_add_u32 v8, s32, v5
    ds_read_b64_tr_b16 v[48:49], v8 offset:0
    ds_read_b64_tr_b16 v[50:51], v8 offset:2048
    v_add_u32 v9, s32, v6
    ds_read_b64_tr_b16 v[52:53], v9 offset:0
    ds_read_b64_tr_b16 v[54:55], v9 offset:2048
    v_add_u32 v10, s32, v1
    ds_read_b64_tr_b16 v[56:57], v10 offset:0
    ds_read_b64_tr_b16 v[58:59], v10 offset:2048
    v_add_u32 v11, s32, v3
    ds_read_b64_tr_b16 v[60:61], v11 offset:0
    ds_read_b64_tr_b16 v[62:63], v11 offset:2048
    s_branch D_p0
D_e2:
    s_ff1_i32_b32 s64, s68
    s_bitset0_b32 s68, s64
    v_readlane_b32 s33, v7, s64
    s_add_u32 s69, s64, s74
    s_and_b32 s69, s69, 15
    s_lshl_b32 s69, s69, 11
    buffer_load_dwordx4 v[96:99], v4, s[16:19], s69 offen sc1
    buffer_load_dwordx4 v[100:103], v12, s[16:19], s69 offen sc1
    s_add_u32 s69, s69, 2048
    buffer_load_dwordx4 v[104:107], v4, s[16:19], s69 offen sc1
    buffer_load_dwordx4 v[108:111], v12, s[16:19], s69 offen sc1
    s_ff1_i32_b32 s64, s68
    s_bitset0_b32 s68, s64
    v_readlane_b32 s32, v7, s64
    s_add_u32 s69, s64, s74
    s_and_b32 s69, s69, 15
    s_lshl_b32 s69, s69, 11
    buffer_load_dwordx4 v[80:83], v4, s[16:19], s69 offen sc1
    buffer_load_dwordx4 v[84:87], v12, s[16:19], s69 offen sc1
    s_add_u32 s69, s69, 2048
    buffer_load_dwordx4 v[88:91], v4, s[16:19], s69 offen sc1
    buffer_load_dwordx4 v[92:95], v12, s[16:19], s69 offen sc1
    s_mov_b64 exec, 1
    v_mov_b32 v15, 0
    buffer_atomic_or v15, v14, s[16:19], 0 offen sc0
    s_mov_b64 exec, -1
    v_add_u32 v8, s33, v5
    ds_read_b64_tr_b16 v[48:49], v8 offset:0
    ds_read_b64_tr_b16 v[50:51], v8 offset:2048
    v_add_u32 v9, s33, v6
    ds_read_b64_tr_b16 v[52:53], v9 offset:0
    ds_read_b64_tr_b16 v[54:55], v9 offset:2048
    v_add_u32 v10, s33, v1
    ds_read_b64_tr_b16 v[56:57], v10 offset:0
    ds_read_b64_tr_b16 v[58:59], v10 offset:2048
    v_add_u32 v11, s33, v3
    ds_read_b64_tr_b16 v[60:61], v11 offset:0
    ds_read_b64_tr_b16 v[62:63], v11 offset:2048
    s_branch D_p1
D_t34:
    s_cmp_eq_u32 s70, 4
    s_cbranch_scc1 D_e4
D_e3:
    s_ff1_i32_b32 s64, s68
    s_bitset0_b32 s68, s64
    v_readlane_b32 s34, v7, s64
    s_add_u32 s69, s64, s74
    s_and_b32 s69, s69, 15
    s_lshl_b32 s69, s69, 11
    buffer_load_dwordx4 v[112:115], v4, s[16:19], s69 offen sc1
    buffer_load_dwordx4 v[116:119], v12, s[16:19], s69 offen sc1
    s_add_u32 s69, s69, 2048
    buffer_load_dwordx4 v[120:123], v4, s[16:19], s69 offen sc1
    buffer_load_dwordx4 v[124:127], v12, s[16:19], s69 offen sc1
    s_ff1_i32_b32 s64, s68
    s_bitset0_b32 s68, s64
    v_readlane_b32 s33, v7, s64
    s_add_u32 s69, s64, s74
    s_and_b32 s69, s69, 15
    s_lshl_b32 s69, s69, 11
    buffer_load_dwordx4 v[96:99], v4, s[16:19], s69 offen sc1
    buffer_load_dwordx4 v[100:103], v12, s[16:19], s69 offen sc1
    s_add_u32 s69, s69, 2048
    buffer_load_dwordx4 v[104:107], v4, s[16:19], s69 offen sc1
    buffer_load_dwordx4 v[108:111], v12, s[16:19], s69 offen sc1
    v_add_u32 v8, s34, v5
    ds_read_b64_tr_b16 v[48:49], v8 offset:0
    ds_read_b64_tr_b16 v[50:51], v8 offset:2048
    v_add_u32 v9, s34, v6
    ds_read_b64_tr_b16 v[52:53], v9 offset:0
    ds_read_b64_tr_b16 v[54:55], v9 offset:2048
    v_add_u32 v10, s34, v1
    ds_read_b64_tr_b16 v[56:57], v10 offset:0
    ds_read_b64_tr_b16 v[58:59], v10 offset:2048
    v_add_u32 v11, s34, v3
    ds_read_b64_tr_b16 v[60:61], v11 offset:0
    ds_read_b64_tr_b16 v[62:63], v11 offset:2048
    s_branch D_p2
D_e4:
    s_ff1_i32_b32 s64, s68
    s_bitset0_b32 s68, s64
    v_readlane_b32 s35, v7, s64
    s_add_u32 s69, s64, s74
    s_and_b32 s69, s69, 15
    s_lshl_b32 s69, s69, 11
    buffer_load_dwordx4 v[128:131], v4, s[16:19], s69 offen sc1
    buffer_load_dwordx4 v[132:135], v12, s[16:19], s69 offen sc1
    s_add_u32 s69, s69, 2048
    buffer_load_dwordx4 v[136:139], v4, s[16:19], s69 offen sc1
    buffer_load_dwordx4 v[140:143], v12, s[16:19], s69 offen sc1
    s_ff1_i32_b32 s64, s68
    s_bitset0_b32 s68, s64
    v_readlane_b32 s34, v7, s64
    s_add_u32 s69, s64, s74
    s_and_b32 s69, s69, 15
    s_lshl_b32 s69, s69, 11
    buffer_load_dwordx4 v[112:115], v4, s[16:19], s69 offen sc1
    buffer_load_dwordx4 v[116:119], v12, s[16:19], s69 offen sc1
    s_add_u32 s69, s69, 2048
    buffer_load_dwordx4 v[120:123], v4, s[16:19], s69 offen sc1
    buffer_load_dwordx4 v[124:127], v12, s[16:19], s69 offen sc1
    v_add_u32 v8, s35, v5
    ds_read_b64_tr_b16 v[48:49], v8 offset:0
    ds_read_b64_tr_b16 v[50:51], v8 offset:2048
    v_add_u32 v9, s35, v6
    ds_read_b64_tr_b16 v[52:53], v9 offset:0
    ds_read_b64_tr_b16 v[54:55], v9 offset:2048
    v_add_u32 v10, s35, v1
    ds_read_b64_tr_b16 v[56:57], v10 offset:0
    ds_read_b64_tr_b16 v[58:59], v10 offset:2048
    v_add_u32 v11, s35, v3
    ds_read_b64_tr_b16 v[60:61], v11 offset:0
    ds_read_b64_tr_b16 v[62:63], v11 offset:2048
    s_branch D_p3
D_t58:
    s_cmp_gt_u32 s70, 6
    s_cbranch_scc1 D_t78
    s_cmp_eq_u32 s70, 6
    s_cbranch_scc1 D_e6
D_e5:
    s_ff1_i32_b32 s64, s68
    s_bitset0_b32 s68, s64
    v_readlane_b32 s36, v7, s64
    s_add_u32 s69, s64, s74
    s_and_b32 s69, s69, 15
    s_lshl_b32 s69, s69, 11
    buffer_load_dwordx4 v[144:147], v4, s[16:19], s69 offen sc1
    buffer_load_dwordx4 v[148:151], v12, s[16:19], s69 offen sc1
    s_add_u32 s69, s69, 2048
    buffer_load_dwordx4 v[152:155], v4, s[16:19], s69 offen sc1
    buffer_load_dwordx4 v[156:159], v12, s[16:19], s69 offen sc1
    s_ff1_i32_b32 s64, s68
    s_bitset0_b32 s68, s64
    v_readlane_b32 s35, v7, s64
    s_add_u32 s69, s64, s74
    s_and_b32 s69, s69, 15
    s_lshl_b32 s69, s69, 11
    buffer_load_dwordx4 v[128:131], v4, s[16:19], s69 offen sc1
    buffer_load_dwordx4 v[132:135], v12, s[16:19], s69 offen sc1
    s_add_u32 s69, s69, 2048
    buffer_load_dwordx4 v[136:139], v4, s[16:19], s69 offen sc1
    buffer_load_dwordx4 v[140:143], v12, s[16:19], s69 offen sc1
    v_add_u32 v8, s36, v5
    ds_read_b64_tr_b16 v[48:49], v8 offset:0
    ds_read_b64_tr_b16 v[50:51], v8 offset:2048
    v_add_u32 v9, s36, v6
    ds_read_b64_tr_b16 v[52:53], v9 offset:0
    ds_read_b64_tr_b16 v[54:55], v9 offset:2048
    v_add_u32 v10, s36, v1
    ds_read_b64_tr_b16 v[56:57], v10 offset:0
    ds_read_b64_tr_b16 v[58:59], v10 offset:2048
    v_add_u32 v11, s36, v3
    ds_read_b64_tr_b16 v[60:61], v11 offset:0
    ds_read_b64_tr_b16 v[62:63], v11 offset:2048
    s_branch D_p4
D_e6:
    s_ff1_i32_b32 s64, s68
    s_bitset0_b32 s68, s64
    v_readlane_b32 s37, v7, s64
    s_add_u32 s69, s64, s74
    s_and_b32 s69, s69, 15
    s_lshl_b32 s69, s69, 11
    buffer_load_dwordx4 v[160:163], v4, s[16:19], s69 offen sc1
    buffer_load_dwordx4 v[164:167], v12, s[16:19], s69 offen sc1
    s_add_u32 s69, s69, 2048
    buffer_load_dwordx4 v[168:171], v4, s[16:19], s69 offen sc1
    buffer_load_dwordx4 v[172:175], v12, s[16:19], s69 offen sc1
    s_ff1_i32_b32 s64, s68
    s_bitset0_b32 s68, s64
    v_readlane_b32 s36, v7, s64
    s_add_u32 s69, s64, s74
    s_and_b32 s69, s69, 15
    s_lshl_b32 s69, s69, 11
    buffer_load_dwordx4 v[144:147], v4, s[16:19], s69 offen sc1
    buffer_load_dwordx4 v[148:151], v12, s[16:19], s69 offen sc1
    s_add_u32 s69, s69, 2048
    buffer_load_dwordx4 v[152:155], v4, s[16:19], s69 offen sc1
    buffer_load_dwordx4 v[156:159], v12, s[16:19], s69 offen sc1
    v_add_u32 v8, s37, v5
    ds_read_b64_tr_b16 v[48:49], v8 offset:0
    ds_read_b64_tr_b16 v[50:51], v8 offset:2048
    v_add_u32 v9, s37, v6
    ds_read_b64_tr_b16 v[52:53], v9 offset:0
    ds_read_b64_tr_b16 v[54:55], v9 offset:2048
    v_add_u32 v10, s37, v1
    ds_read_b64_tr_b16 v[56:57], v10 offset:0
    ds_read_b64_tr_b16 v[58:59], v10 offset:2048
    v_add_u32 v11, s37, v3
    ds_read_b64_tr_b16 v[60:61], v11 offset:0
    ds_read_b64_tr_b16 v[62:63], v11 offset:2048
    s_branch D_p5
D_t78:
    s_cmp_eq_u32 s70, 8
    s_cbranch_scc1 D_e8
D_e7:
    s_ff1_i32_b32 s64, s68
    s_bitset0_b32 s68, s64
    v_readlane_b32 s38, v7, s64
    s_add_u32 s69, s64, s74
    s_and_b32 s69, s69, 15
    s_lshl_b32 s69, s69, 11
    buffer_load_dwordx4 v[176:179], v4, s[16:19], s69 offen sc1
    buffer_load_dwordx4 v[180:183], v12, s[16:19], s69 offen sc1
    s_add_u32 s69, s69, 2048
    buffer_load_dwordx4 v[184:187], v4, s[16:19], s69 offen sc1
    buffer_load_dwordx4 v[188:191], v12, s[16:19], s69 offen sc1
    s_ff1_i32_b32 s64, s68
    s_bitset0_b32 s68, s64
    v_readlane_b32 s37, v7, s64
    s_add_u32 s69, s64, s74
    s_and_b32 s69, s69, 15
    s_lshl_b32 s69, s69, 11
    buffer_load_dwordx4 v[160:163], v4, s[16:19], s69 offen sc1
    buffer_load_dwordx4 v[164:167], v12, s[16:19], s69 offen sc1
    s_add_u32 s69, s69, 2048
    buffer_load_dwordx4 v[168:171], v4, s[16:19], s69 offen sc1
    buffer_load_dwordx4 v[172:175], v12, s[16:19], s69 offen sc1
    v_add_u32 v8, s38, v5
    ds_read_b64_tr_b16 v[48:49], v8 offset:0
    ds_read_b64_tr_b16 v[50:51], v8 offset:2048
    v_add_u32 v9, s38, v6
    ds_read_b64_tr_b16 v[52:53], v9 offset:0
    ds_read_b64_tr_b16 v[54:55], v9 offset:2048
    v_add_u32 v10, s38, v1
    ds_read_b64_tr_b16 v[56:57], v10 offset:0
    ds_read_b64_tr_b16 v[58:59], v10 offset:2048
    v_add_u32 v11, s38, v3
    ds_read_b64_tr_b16 v[60:61], v11 offset:0
    ds_read_b64_tr_b16 v[62:63], v11 offset:2048
    s_branch D_p6
D_e8:
    s_ff1_i32_b32 s64, s68
    s_bitset0_b32 s68, s64
    v_readlane_b32 s39, v7, s64
    s_add_u32 s69, s64, s74
    s_and_b32 s69, s69, 15
    s_lshl_b32 s69, s69, 11
    buffer_load_dwordx4 v[192:195], v4, s[16:19], s69 offen sc1
    buffer_load_dwordx4 v[196:199], v12, s[16:19], s69 offen sc1
    s_add_u32 s69, s69, 2048
    buffer_load_dwordx4 v[200:203], v4, s[16:19], s69 offen sc1
    buffer_load_dwordx4 v[204:207], v12, s[16:19], s69 offen sc1
    s_ff1_i32_b32 s64, s68
    s_bitset0_b32 s68, s64
    v_readlane_b32 s38, v7, s64
    s_add_u32 s69, s64, s74
    s_and_b32 s69, s69, 15
    s_lshl_b32 s69, s69, 11
    buffer_load_dwordx4 v[176:179], v4, s[16:19], s69 offen sc1
    buffer_load_dwordx4 v[180:183], v12, s[16:19], s69 offen sc1
    s_add_u32 s69, s69, 2048
    buffer_load_dwordx4 v[184:187], v4, s[16:19], s69 offen sc1
    buffer_load_dwordx4 v[188:191], v12, s[16:19], s69 offen sc1
    v_add_u32 v8, s39, v5
    ds_read_b64_tr_b16 v[48:49], v8 offset:0
    ds_read_b64_tr_b16 v[50:51], v8 offset:2048
    v_add_u32 v9, s39, v6
    ds_read_b64_tr_b16 v[52:53], v9 offset:0
    ds_read_b64_tr_b16 v[54:55], v9 offset:2048
    v_add_u32 v10, s39, v1
    ds_read_b64_tr_b16 v[56:57], v10 offset:0
    ds_read_b64_tr_b16 v[58:59], v10 offset:2048
    v_add_u32 v11, s39, v3
    ds_read_b64_tr_b16 v[60:61], v11 offset:0
    ds_read_b64_tr_b16 v[62:63], v11 offset:2048
D_p7:
    s_waitcnt vmcnt(4) lgkmcnt(0)
    v_mfma_f32_16x16x32_bf16 v[16:19], v[48:51], v[192:195], v[16:19]
    ds_read_b64_tr_b16 v[64:65], v8 offset:4096
    ds_read_b64_tr_b16 v[66:67], v8 offset:6144
    v_mfma_f32_16x16x32_bf16 v[32:35], v[48:51], v[196:199], v[32:35]
    ds_read_b64_tr_b16 v[68:69], v9 offset:4096
    ds_read_b64_tr_b16 v[70:71], v9 offset:6144
    v_mfma_f32_16x16x32_bf16 v[20:23], v[52:55], v[192:195], v[20:23]
    ds_read_b64_tr_b16 v[72:73], v10 offset:4096
    ds_read_b64_tr_b16 v[74:75], v10 offset:6144
    v_mfma_f32_16x16x32_bf16 v[36:39], v[52:55], v[196:199], v[36:39]
    ds_read_b64_tr_b16 v[76:77], v11 offset:4096
    ds_read_b64_tr_b16 v[78:79], v11 offset:6144
    s_ff1_i32_b32 s64, s68
    s_bitset0_b32 s68, s64
    v_readlane_b32 s37, v7, s64
    s_add_u32 s69, s64, s74
    s_and_b32 s69, s69, 15
    s_lshl_b32 s69, s69, 11
    buffer_load_dwordx4 v[160:163], v4, s[16:19], s69 offen sc1
    v_mfma_f32_16x16x32_bf16 v[24:27], v[56:59], v[192:195], v[24:27]
    v_mfma_f32_16x16x32_bf16 v[40:43], v[56:59], v[196:199], v[40:43]
    v_mfma_f32_16x16x32_bf16 v[28:31], v[60:63], v[192:195], v[28:31]
    buffer_load_dwordx4 v[164:167], v12, s[16:19], s69 offen sc1
    v_mfma_f32_16x16x32_bf16 v[44:47], v[60:63], v[196:199], v[44:47]
    s_waitcnt lgkmcnt(0)
    v_mfma_f32_16x16x32_bf16 v[16:19], v[64:67], v[200:203], v[16:19]
    v_add_u32 v8, s38, v5
    ds_read_b64_tr_b16 v[48:49], v8 offset:0
    v_mfma_f32_16x16x32_bf16 v[32:35], v[64:67], v[204:207], v[32:35]
    ds_read_b64_tr_b16 v[50:51], v8 offset:2048
    v_add_u32 v9, s38, v6
    v_mfma_f32_16x16x32_bf16 v[20:23], v[68:71], v[200:203], v[20:23]
    ds_read_b64_tr_b16 v[52:53], v9 offset:0
    ds_read_b64_tr_b16 v[54:55], v9 offset:2048
    v_mfma_f32_16x16x32_bf16 v[36:39], v[68:71], v[204:207], v[36:39]
    v_add_u32 v10, s38, v1
    ds_read_b64_tr_b16 v[56:57], v10 offset:0
    s_add_u32 s69, s69, 2048
    buffer_load_dwordx4 v[168:171], v4, s[16:19], s69 offen sc1
    v_mfma_f32_16x16x32_bf16 v[24:27], v[72:75], v[200:203], v[24:27]
    ds_read_b64_tr_b16 v[58:59], v10 offset:2048
    v_add_u32 v11, s38, v3
    v_mfma_f32_16x16x32_bf16 v[40:43], v[72:75], v[204:207], v[40:43]
    ds_read_b64_tr_b16 v[60:61], v11 offset:0
    ds_read_b64_tr_b16 v[62:63], v11 offset:2048
    v_mfma_f32_16x16x32_bf16 v[28:31], v[76:79], v[200:203], v[28:31]
    buffer_load_dwordx4 v[172:175], v12, s[16:19], s69 offen sc1
    v_mfma_f32_16x16x32_bf16 v[44:47], v[76:79], v[204:207], v[44:47]
D_p6:
    s_waitcnt vmcnt(4) lgkmcnt(0)
    v_mfma_f32_16x16x32_bf16 v[16:19], v[48:51], v[176:179], v[16:19]
    ds_read_b64_tr_b16 v[64:65], v8 offset:4096
    ds_read_b64_tr_b16 v[66:67], v8 offset:6144
    v_mfma_f32_16x16x32_bf16 v[32:35], v[48:51], v[180:183], v[32:35]
    ds_read_b64_tr_b16 v[68:69], v9 offset:4096
    ds_read_b64_tr_b16 v[70:71], v9 offset:6144
    v_mfma_f32_16x16x32_bf16 v[20:23], v[52:55], v[176:179], v[20:23]
    ds_read_b64_tr_b16 v[72:73], v10 offset:4096
    ds_read_b64_tr_b16 v[74:75], v10 offset:6144
    v_mfma_f32_16x16x32_bf16 v[36:39], v[52:55], v[180:183], v[36:39]
    ds_read_b64_tr_b16 v[76:77], v11 offset:4096
    ds_read_b64_tr_b16 v[78:79], v11 offset:6144
    s_ff1_i32_b32 s64, s68
    s_bitset0_b32 s68, s64
    v_readlane_b32 s36, v7, s64
    s_add_u32 s69, s64, s74
    s_and_b32 s69, s69, 15
    s_lshl_b32 s69, s69, 11
    buffer_load_dwordx4 v[144:147], v4, s[16:19], s69 offen sc1
    v_mfma_f32_16x16x32_bf16 v[24:27], v[56:59], v[176:179], v[24:27]
    v_mfma_f32_16x16x32_bf16 v[40:43], v[56:59], v[180:183], v[40:43]
    v_mfma_f32_16x16x32_bf16 v[28:31], v[60:63], v[176:179], v[28:31]
    buffer_load_dwordx4 v[148:151], v12, s[16:19], s69 offen sc1
    v_mfma_f32_16x16x32_bf16 v[44:47], v[60:63], v[180:183], v[44:47]
    s_waitcnt lgkmcnt(0)
    v_mfma_f32_16x16x32_bf16 v[16:19], v[64:67], v[184:187], v[16:19]
    v_add_u32 v8, s37, v5
    ds_read_b64_tr_b16 v[48:49], v8 offset:0
    v_mfma_f32_16x16x32_bf16 v[32:35], v[64:67], v[188:191], v[32:35]
    ds_read_b64_tr_b16 v[50:51], v8 offset:2048
    v_add_u32 v9, s37, v6
    v_mfma_f32_16x16x32_bf16 v[20:23], v[68:71], v[184:187], v[20:23]
    ds_read_b64_tr_b16 v[52:53], v9 offset:0
    ds_read_b64_tr_b16 v[54:55], v9 offset:2048
    v_mfma_f32_16x16x32_bf16 v[36:39], v[68:71], v[188:191], v[36:39]
    v_add_u32 v10, s37, v1
    ds_read_b64_tr_b16 v[56:57], v10 offset:0
    s_add_u32 s69, s69, 2048
    buffer_load_dwordx4 v[152:155], v4, s[16:19], s69 offen sc1
    v_mfma_f32_16x16x32_bf16 v[24:27], v[72:75], v[184:187], v[24:27]
    ds_read_b64_tr_b16 v[58:59], v10 offset:2048
    v_add_u32 v11, s37, v3
    v_mfma_f32_16x16x32_bf16 v[40:43], v[72:75], v[188:191], v[40:43]
    ds_read_b64_tr_b16 v[60:61], v11 offset:0
    ds_read_b64_tr_b16 v[62:63], v11 offset:2048
    v_mfma_f32_16x16x32_bf16 v[28:31], v[76:79], v[184:187], v[28:31]
    buffer_load_dwordx4 v[156:159], v12, s[16:19], s69 offen sc1
    v_mfma_f32_16x16x32_bf16 v[44:47], v[76:79], v[188:191], v[44:47]
D_p5:
    s_waitcnt vmcnt(4) lgkmcnt(0)
    v_mfma_f32_16x16x32_bf16 v[16:19], v[48:51], v[160:163], v[16:19]
    ds_read_b64_tr_b16 v[64:65], v8 offset:4096
    ds_read_b64_tr_b16 v[66:67], v8 offset:6144
    v_mfma_f32_16x16x32_bf16 v[32:35], v[48:51], v[164:167], v[32:35]
    ds_read_b64_tr_b16 v[68:69], v9 offset:4096
    ds_read_b64_tr_b16 v[70:71], v9 offset:6144
    v_mfma_f32_16x16x32_bf16 v[20:23], v[52:55], v[160:163], v[20:23]
    ds_read_b64_tr_b16 v[72:73], v10 offset:4096
    ds_read_b64_tr_b16 v[74:75], v10 offset:6144
    v_mfma_f32_16x16x32_bf16 v[36:39], v[52:55], v[164:167], v[36:39]
    ds_read_b64_tr_b16 v[76:77], v11 offset:4096
    ds_read_b64_tr_b16 v[78:79], v11 offset:6144
    s_ff1_i32_b32 s64, s68
    s_bitset0_b32 s68, s64
    v_readlane_b32 s35, v7, s64
    s_add_u32 s69, s64, s74
    s_and_b32 s69, s69, 15
    s_lshl_b32 s69, s69, 11
    buffer_load_dwordx4 v[128:131], v4, s[16:19], s69 offen sc1
    v_mfma_f32_16x16x32_bf16 v[24:27], v[56:59], v[160:163], v[24:27]
    v_mfma_f32_16x16x32_bf16 v[40:43], v[56:59], v[164:167], v[40:43]
    v_mfma_f32_16x16x32_bf16 v[28:31], v[60:63], v[160:163], v[28:31]
    buffer_load_dwordx4 v[132:135], v12, s[16:19], s69 offen sc1
    v_mfma_f32_16x16x32_bf16 v[44:47], v[60:63], v[164:167], v[44:47]
    s_waitcnt lgkmcnt(0)
    v_mfma_f32_16x16x32_bf16 v[16:19], v[64:67], v[168:171], v[16:19]
    v_add_u32 v8, s36, v5
    ds_read_b64_tr_b16 v[48:49], v8 offset:0
    v_mfma_f32_16x16x32_bf16 v[32:35], v[64:67], v[172:175], v[32:35]
    ds_read_b64_tr_b16 v[50:51], v8 offset:2048
    v_add_u32 v9, s36, v6
    v_mfma_f32_16x16x32_bf16 v[20:23], v[68:71], v[168:171], v[20:23]
    ds_read_b64_tr_b16 v[52:53], v9 offset:0
    ds_read_b64_tr_b16 v[54:55], v9 offset:2048
    v_mfma_f32_16x16x32_bf16 v[36:39], v[68:71], v[172:175], v[36:39]
    v_add_u32 v10, s36, v1
    ds_read_b64_tr_b16 v[56:57], v10 offset:0
    s_add_u32 s69, s69, 2048
    buffer_load_dwordx4 v[136:139], v4, s[16:19], s69 offen sc1
    v_mfma_f32_16x16x32_bf16 v[24:27], v[72:75], v[168:171], v[24:27]
    ds_read_b64_tr_b16 v[58:59], v10 offset:2048
    v_add_u32 v11, s36, v3
    v_mfma_f32_16x16x32_bf16 v[40:43], v[72:75], v[172:175], v[40:43]
    ds_read_b64_tr_b16 v[60:61], v11 offset:0
    ds_read_b64_tr_b16 v[62:63], v11 offset:2048
    v_mfma_f32_16x16x32_bf16 v[28:31], v[76:79], v[168:171], v[28:31]
    buffer_load_dwordx4 v[140:143], v12, s[16:19], s69 offen sc1
    v_mfma_f32_16x16x32_bf16 v[44:47], v[76:79], v[172:175], v[44:47]
D_p4:
    s_waitcnt vmcnt(4) lgkmcnt(0)
    v_mfma_f32_16x16x32_bf16 v[16:19], v[48:51], v[144:147], v[16:19]
    ds_read_b64_tr_b16 v[64:65], v8 offset:4096
    ds_read_b64_tr_b16 v[66:67], v8 offset:6144
    v_mfma_f32_16x16x32_bf16 v[32:35], v[48:51], v[148:151], v[32:35]
    ds_read_b64_tr_b16 v[68:69], v9 offset:4096
    ds_read_b64_tr_b16 v[70:71], v9 offset:6144
    v_mfma_f32_16x16x32_bf16 v[20:23], v[52:55], v[144:147], v[20:23]
    ds_read_b64_tr_b16 v[72:73], v10 offset:4096
    ds_read_b64_tr_b16 v[74:75], v10 offset:6144
    v_mfma_f32_16x16x32_bf16 v[36:39], v[52:55], v[148:151], v[36:39]
    ds_read_b64_tr_b16 v[76:77], v11 offset:4096
    ds_read_b64_tr_b16 v[78:79], v11 offset:6144
    s_ff1_i32_b32 s64, s68
    s_bitset0_b32 s68, s64
    v_readlane_b32 s34, v7, s64
    s_add_u32 s69, s64, s74
    s_and_b32 s69, s69, 15
    s_lshl_b32 s69, s69, 11
    buffer_load_dwordx4 v[112:115], v4, s[16:19], s69 offen sc1
    v_mfma_f32_16x16x32_bf16 v[24:27], v[56:59], v[144:147], v[24:27]
    v_mfma_f32_16x16x32_bf16 v[40:43], v[56:59], v[148:151], v[40:43]
    v_mfma_f32_16x16x32_bf16 v[28:31], v[60:63], v[144:147], v[28:31]
    buffer_load_dwordx4 v[116:119], v12, s[16:19], s69 offen sc1
    v_mfma_f32_16x16x32_bf16 v[44:47], v[60:63], v[148:151], v[44:47]
    s_waitcnt lgkmcnt(0)
    v_mfma_f32_16x16x32_bf16 v[16:19], v[64:67], v[152:155], v[16:19]
    v_add_u32 v8, s35, v5
    ds_read_b64_tr_b16 v[48:49], v8 offset:0
    v_mfma_f32_16x16x32_bf16 v[32:35], v[64:67], v[156:159], v[32:35]
    ds_read_b64_tr_b16 v[50:51], v8 offset:2048
    v_add_u32 v9, s35, v6
    v_mfma_f32_16x16x32_bf16 v[20:23], v[68:71], v[152:155], v[20:23]
    ds_read_b64_tr_b16 v[52:53], v9 offset:0
    ds_read_b64_tr_b16 v[54:55], v9 offset:2048
    v_mfma_f32_16x16x32_bf16 v[36:39], v[68:71], v[156:159], v[36:39]
    v_add_u32 v10, s35, v1
    ds_read_b64_tr_b16 v[56:57], v10 offset:0
    s_add_u32 s69, s69, 2048
    buffer_load_dwordx4 v[120:123], v4, s[16:19], s69 offen sc1
    v_mfma_f32_16x16x32_bf16 v[24:27], v[72:75], v[152:155], v[24:27]
    ds_read_b64_tr_b16 v[58:59], v10 offset:2048
    v_add_u32 v11, s35, v3
    v_mfma_f32_16x16x32_bf16 v[40:43], v[72:75], v[156:159], v[40:43]
    ds_read_b64_tr_b16 v[60:61], v11 offset:0
    ds_read_b64_tr_b16 v[62:63], v11 offset:2048
    v_mfma_f32_16x16x32_bf16 v[28:31], v[76:79], v[152:155], v[28:31]
    buffer_load_dwordx4 v[124:127], v12, s[16:19], s69 offen sc1
    v_mfma_f32_16x16x32_bf16 v[44:47], v[76:79], v[156:159], v[44:47]
D_p3:
    s_waitcnt vmcnt(4) lgkmcnt(0)
    v_mfma_f32_16x16x32_bf16 v[16:19], v[48:51], v[128:131], v[16:19]
    ds_read_b64_tr_b16 v[64:65], v8 offset:4096
    ds_read_b64_tr_b16 v[66:67], v8 offset:6144
    v_mfma_f32_16x16x32_bf16 v[32:35], v[48:51], v[132:135], v[32:35]
    ds_read_b64_tr_b16 v[68:69], v9 offset:4096
    ds_read_b64_tr_b16 v[70:71], v9 offset:6144
    v_mfma_f32_16x16x32_bf16 v[20:23], v[52:55], v[128:131], v[20:23]
    ds_read_b64_tr_b16 v[72:73], v10 offset:4096
    ds_read_b64_tr_b16 v[74:75], v10 offset:6144
    v_mfma_f32_16x16x32_bf16 v[36:39], v[52:55], v[132:135], v[36:39]
    ds_read_b64_tr_b16 v[76:77], v11 offset:4096
    ds_read_b64_tr_b16 v[78:79], v11 offset:6144
    s_ff1_i32_b32 s64, s68
    s_bitset0_b32 s68, s64
    v_readlane_b32 s33, v7, s64
    s_add_u32 s69, s64, s74
    s_and_b32 s69, s69, 15
    s_lshl_b32 s69, s69, 11
    buffer_load_dwordx4 v[96:99], v4, s[16:19], s69 offen sc1
    v_mfma_f32_16x16x32_bf16 v[24:27], v[56:59], v[128:131], v[24:27]
    v_mfma_f32_16x16x32_bf16 v[40:43], v[56:59], v[132:135], v[40:43]
    v_mfma_f32_16x16x32_bf16 v[28:31], v[60:63], v[128:131], v[28:31]
    buffer_load_dwordx4 v[100:103], v12, s[16:19], s69 offen sc1
    v_mfma_f32_16x16x32_bf16 v[44:47], v[60:63], v[132:135], v[44:47]
    s_waitcnt lgkmcnt(0)
    v_mfma_f32_16x16x32_bf16 v[16:19], v[64:67], v[136:139], v[16:19]
    v_add_u32 v8, s34, v5
    ds_read_b64_tr_b16 v[48:49], v8 offset:0
    v_mfma_f32_16x16x32_bf16 v[32:35], v[64:67], v[140:143], v[32:35]
    ds_read_b64_tr_b16 v[50:51], v8 offset:2048
    v_add_u32 v9, s34, v6
    v_mfma_f32_16x16x32_bf16 v[20:23], v[68:71], v[136:139], v[20:23]
    ds_read_b64_tr_b16 v[52:53], v9 offset:0
    ds_read_b64_tr_b16 v[54:55], v9 offset:2048
    v_mfma_f32_16x16x32_bf16 v[36:39], v[68:71], v[140:143], v[36:39]
    v_add_u32 v10, s34, v1
    ds_read_b64_tr_b16 v[56:57], v10 offset:0
    s_add_u32 s69, s69, 2048
    buffer_load_dwordx4 v[104:107], v4, s[16:19], s69 offen sc1
    v_mfma_f32_16x16x32_bf16 v[24:27], v[72:75], v[136:139], v[24:27]
    ds_read_b64_tr_b16 v[58:59], v10 offset:2048
    v_add_u32 v11, s34, v3
    v_mfma_f32_16x16x32_bf16 v[40:43], v[72:75], v[140:143], v[40:43]
    ds_read_b64_tr_b16 v[60:61], v11 offset:0
    ds_read_b64_tr_b16 v[62:63], v11 offset:2048
    v_mfma_f32_16x16x32_bf16 v[28:31], v[76:79], v[136:139], v[28:31]
    buffer_load_dwordx4 v[108:111], v12, s[16:19], s69 offen sc1
    v_mfma_f32_16x16x32_bf16 v[44:47], v[76:79], v[140:143], v[44:47]
D_p2:
    s_waitcnt vmcnt(4) lgkmcnt(0)
    v_mfma_f32_16x16x32_bf16 v[16:19], v[48:51], v[112:115], v[16:19]
    ds_read_b64_tr_b16 v[64:65], v8 offset:4096
    ds_read_b64_tr_b16 v[66:67], v8 offset:6144
    v_mfma_f32_16x16x32_bf16 v[32:35], v[48:51], v[116:119], v[32:35]
    ds_read_b64_tr_b16 v[68:69], v9 offset:4096
    ds_read_b64_tr_b16 v[70:71], v9 offset:6144
    v_mfma_f32_16x16x32_bf16 v[20:23], v[52:55], v[112:115], v[20:23]
    ds_read_b64_tr_b16 v[72:73], v10 offset:4096
    ds_read_b64_tr_b16 v[74:75], v10 offset:6144
    v_mfma_f32_16x16x32_bf16 v[36:39], v[52:55], v[116:119], v[36:39]
    ds_read_b64_tr_b16 v[76:77], v11 offset:4096
    ds_read_b64_tr_b16 v[78:79], v11 offset:6144
    s_ff1_i32_b32 s64, s68
    s_bitset0_b32 s68, s64
    v_readlane_b32 s32, v7, s64
    s_add_u32 s69, s64, s74
    s_and_b32 s69, s69, 15
    s_lshl_b32 s69, s69, 11
    buffer_load_dwordx4 v[80:83], v4, s[16:19], s69 offen sc1
    v_mfma_f32_16x16x32_bf16 v[24:27], v[56:59], v[112:115], v[24:27]
    v_mfma_f32_16x16x32_bf16 v[40:43], v[56:59], v[116:119], v[40:43]
    v_mfma_f32_16x16x32_bf16 v[28:31], v[60:63], v[112:115], v[28:31]
    buffer_load_dwordx4 v[84:87], v12, s[16:19], s69 offen sc1
    v_mfma_f32_16x16x32_bf16 v[44:47], v[60:63], v[116:119], v[44:47]
    s_waitcnt lgkmcnt(0)
    v_mfma_f32_16x16x32_bf16 v[16:19], v[64:67], v[120:123], v[16:19]
    v_add_u32 v8, s33, v5
    ds_read_b64_tr_b16 v[48:49], v8 offset:0
    v_mfma_f32_16x16x32_bf16 v[32:35], v[64:67], v[124:127], v[32:35]
    ds_read_b64_tr_b16 v[50:51], v8 offset:2048
    v_add_u32 v9, s33, v6
    v_mfma_f32_16x16x32_bf16 v[20:23], v[68:71], v[120:123], v[20:23]
    ds_read_b64_tr_b16 v[52:53], v9 offset:0
    ds_read_b64_tr_b16 v[54:55], v9 offset:2048
    v_mfma_f32_16x16x32_bf16 v[36:39], v[68:71], v[124:127], v[36:39]
    v_add_u32 v10, s33, v1
    ds_read_b64_tr_b16 v[56:57], v10 offset:0
    s_add_u32 s69, s69, 2048
    buffer_load_dwordx4 v[88:91], v4, s[16:19], s69 offen sc1
    v_mfma_f32_16x16x32_bf16 v[24:27], v[72:75], v[120:123], v[24:27]
    ds_read_b64_tr_b16 v[58:59], v10 offset:2048
    v_add_u32 v11, s33, v3
    v_mfma_f32_16x16x32_bf16 v[40:43], v[72:75], v[124:127], v[40:43]
    ds_read_b64_tr_b16 v[60:61], v11 offset:0
    ds_read_b64_tr_b16 v[62:63], v11 offset:2048
    v_mfma_f32_16x16x32_bf16 v[28:31], v[76:79], v[120:123], v[28:31]
    buffer_load_dwordx4 v[92:95], v12, s[16:19], s69 offen sc1
    s_mov_b64 exec, 1
    v_mov_b32 v15, 0
    buffer_atomic_or v15, v14, s[16:19], 0 offen sc0
    s_mov_b64 exec, -1
    v_mfma_f32_16x16x32_bf16 v[44:47], v[76:79], v[124:127], v[44:47]
D_p1:
    s_waitcnt vmcnt(5) lgkmcnt(0)
    v_mfma_f32_16x16x32_bf16 v[16:19], v[48:51], v[96:99], v[16:19]
    ds_read_b64_tr_b16 v[64:65], v8 offset:4096
    ds_read_b64_tr_b16 v[66:67], v8 offset:6144
    v_mfma_f32_16x16x32_bf16 v[32:35], v[48:51], v[100:103], v[32:35]
    ds_read_b64_tr_b16 v[68:69], v9 offset:4096
    ds_read_b64_tr_b16 v[70:71], v9 offset:6144
    v_mfma_f32_16x16x32_bf16 v[20:23], v[52:55], v[96:99], v[20:23]
    ds_read_b64_tr_b16 v[72:73], v10 offset:4096
    ds_read_b64_tr_b16 v[74:75], v10 offset:6144
    v_mfma_f32_16x16x32_bf16 v[36:39], v[52:55], v[100:103], v[36:39]
    ds_read_b64_tr_b16 v[76:77], v11 offset:4096
    ds_read_b64_tr_b16 v[78:79], v11 offset:6144
    v_mfma_f32_16x16x32_bf16 v[24:27], v[56:59], v[96:99], v[24:27]
    v_mfma_f32_16x16x32_bf16 v[40:43], v[56:59], v[100:103], v[40:43]
    v_mfma_f32_16x16x32_bf16 v[28:31], v[60:63], v[96:99], v[28:31]
    v_mfma_f32_16x16x32_bf16 v[44:47], v[60:63], v[100:103], v[44:47]
    s_waitcnt lgkmcnt(0)
    v_mfma_f32_16x16x32_bf16 v[16:19], v[64:67], v[104:107], v[16:19]
    v_add_u32 v8, s32, v5
    ds_read_b64_tr_b16 v[48:49], v8 offset:0
    v_mfma_f32_16x16x32_bf16 v[32:35], v[64:67], v[108:111], v[32:35]
    ds_read_b64_tr_b16 v[50:51], v8 offset:2048
    v_add_u32 v9, s32, v6
    v_mfma_f32_16x16x32_bf16 v[20:23], v[68:71], v[104:107], v[20:23]
    ds_read_b64_tr_b16 v[52:53], v9 offset:0
    ds_read_b64_tr_b16 v[54:55], v9 offset:2048
    v_mfma_f32_16x16x32_bf16 v[36:39], v[68:71], v[108:111], v[36:39]
    v_add_u32 v10, s32, v1
    ds_read_b64_tr_b16 v[56:57], v10 offset:0
    v_mfma_f32_16x16x32_bf16 v[24:27], v[72:75], v[104:107], v[24:27]
    ds_read_b64_tr_b16 v[58:59], v10 offset:2048
    v_add_u32 v11, s32, v3
    v_mfma_f32_16x16x32_bf16 v[40:43], v[72:75], v[108:111], v[40:43]
    ds_read_b64_tr_b16 v[60:61], v11 offset:0
    ds_read_b64_tr_b16 v[62:63], v11 offset:2048
    v_mfma_f32_16x16x32_bf16 v[28:31], v[76:79], v[104:107], v[28:31]
    v_mfma_f32_16x16x32_bf16 v[44:47], v[76:79], v[108:111], v[44:47]
D_p0:
    s_waitcnt vmcnt(1) lgkmcnt(0)
    v_mfma_f32_16x16x32_bf16 v[16:19], v[48:51], v[80:83], v[16:19]
    ds_read_b64_tr_b16 v[64:65], v8 offset:4096
    ds_read_b64_tr_b16 v[66:67], v8 offset:6144
    v_mfma_f32_16x16x32_bf16 v[32:35], v[48:51], v[84:87], v[32:35]
    ds_read_b64_tr_b16 v[68:69], v9 offset:4096
    ds_read_b64_tr_b16 v[70:71], v9 offset:6144
    v_mfma_f32_16x16x32_bf16 v[20:23], v[52:55], v[80:83], v[20:23]
    ds_read_b64_tr_b16 v[72:73], v10 offset:4096
    ds_read_b64_tr_b16 v[74:75], v10 offset:6144
    v_mfma_f32_16x16x32_bf16 v[36:39], v[52:55], v[84:87], v[36:39]
    ds_read_b64_tr_b16 v[76:77], v11 offset:4096
    ds_read_b64_tr_b16 v[78:79], v11 offset:6144
    v_mfma_f32_16x16x32_bf16 v[24:27], v[56:59], v[80:83], v[24:27]
    v_mfma_f32_16x16x32_bf16 v[40:43], v[56:59], v[84:87], v[40:43]
    v_mfma_f32_16x16x32_bf16 v[28:31], v[60:63], v[80:83], v[28:31]
    v_mfma_f32_16x16x32_bf16 v[44:47], v[60:63], v[84:87], v[44:47]
    s_waitcnt lgkmcnt(0)
    v_mfma_f32_16x16x32_bf16 v[16:19], v[64:67], v[88:91], v[16:19]
    v_mfma_f32_16x16x32_bf16 v[32:35], v[64:67], v[92:95], v[32:35]
    v_mfma_f32_16x16x32_bf16 v[20:23], v[68:71], v[88:91], v[20:23]
    v_mfma_f32_16x16x32_bf16 v[36:39], v[68:71], v[92:95], v[36:39]
    v_mfma_f32_16x16x32_bf16 v[24:27], v[72:75], v[88:91], v[24:27]
    v_mfma_f32_16x16x32_bf16 v[40:43], v[72:75], v[92:95], v[40:43]
    v_mfma_f32_16x16x32_bf16 v[28:31], v[76:79], v[88:91], v[28:31]
    v_mfma_f32_16x16x32_bf16 v[44:47], v[76:79], v[92:95], v[44:47]
    s_cmp_lg_u32 s66, 0
    s_cbranch_scc1 D_wait
D_end:
    s_lshl_b32 s64, s3, 12
    s_add_u32 s64, s64, 8192
    v_lshl_add_u32 v8, v2, 4, s64
    s_xor_b32 s65, s3, 4
    s_lshl_b32 s65, s65, 12
    s_add_u32 s65, s65, 8192
    v_lshl_add_u32 v5, v2, 4, s65
    v_lshlrev_b32 v9, 1, v229
    v_cmp_eq_u32 s[70:71], s67, v230
    s_cmp_eq_u32 s46, 0
    s_cbranch_scc1 P2_y
P2_ny:
    s_barrier
    ds_write_b128 v8, v[32:35] offset:0
    ds_write_b128 v8, v[36:39] offset:1024
    ds_write_b128 v8, v[40:43] offset:2048
    ds_write_b128 v8, v[44:47] offset:3072
    s_cmp_lg_u64 s[70:71], 0
    s_cbranch_scc1 P2_fix
P2_nr:
    s_waitcnt lgkmcnt(0)
    s_barrier
    ds_read_b128 v[64:67], v5 offset:0
    ds_read_b128 v[68:71], v5 offset:1024
    ds_read_b128 v[72:75], v5 offset:2048
    ds_read_b128 v[76:79], v5 offset:3072
    s_waitcnt lgkmcnt(2)
    v_pk_add_f32 v[16:17], v[16:17], v[64:65]
    v_pk_add_f32 v[18:19], v[18:19], v[66:67]
    v_pk_add_f32 v[20:21], v[20:21], v[68:69]
    v_pk_add_f32 v[22:23], v[22:23], v[70:71]
    v_cvt_pk_bf16_f32 v48, v16, v17
    v_cvt_pk_bf16_f32 v49, v18, v19
    v_cvt_pk_bf16_f32 v50, v20, v21
    v_cvt_pk_bf16_f32 v51, v22, v23
    s_nop 0
    v_permlane16_swap_b32 v48, v50
    v_permlane16_swap_b32 v49, v51
    v_lshlrev_b32 v16, 16, v48
    v_and_b32 v17, 0xffff0000, v48
    v_lshlrev_b32 v18, 16, v49
    v_and_b32 v19, 0xffff0000, v49
    v_lshlrev_b32 v20, 16, v50
    v_and_b32 v21, 0xffff0000, v50
    v_lshlrev_b32 v22, 16, v51
    v_and_b32 v23, 0xffff0000, v51
    v_pk_mul_f32 v[16:17], v[16:17], v[228:229] op_sel_hi:[1,0]
    v_pk_mul_f32 v[18:19], v[18:19], v[228:229] op_sel_hi:[1,0]
    v_pk_mul_f32 v[20:21], v[20:21], v[228:229] op_sel_hi:[1,0]
    v_pk_mul_f32 v[22:23], v[22:23], v[228:229] op_sel_hi:[1,0]
    v_cvt_pk_bf16_f32 v48, v16, v17
    v_cvt_pk_bf16_f32 v49, v18, v19
    v_cvt_pk_bf16_f32 v50, v20, v21
    v_cvt_pk_bf16_f32 v51, v22, v23
    v_lshlrev_b32 v16, 16, v48
    v_and_b32 v17, 0xffff0000, v48
    v_lshlrev_b32 v18, 16, v49
    v_and_b32 v19, 0xffff0000, v49
    v_lshlrev_b32 v20, 16, v50
    v_and_b32 v21, 0xffff0000, v50
    v_lshlrev_b32 v22, 16, v51
    v_and_b32 v23, 0xffff0000, v51
    v_pk_add_f32 v[16:17], v[16:17], v[232:233]
    v_pk_add_f32 v[18:19], v[18:19], v[234:235]
    v_pk_add_f32 v[20:21], v[20:21], v[236:237]
    v_pk_add_f32 v[22:23], v[22:23], v[238:239]
    v_cvt_pk_bf16_f32 v120, v16, v17
    v_cvt_pk_bf16_f32 v121, v18, v19
    v_cvt_pk_bf16_f32 v122, v20, v21
    v_cvt_pk_bf16_f32 v123, v22, v23
    v_and_b32 v6, 1, v2
    v_mul_u32_u24 v6, 1984, v6
    v_sub_u32 v231, v231, v6
    s_mov_b32 vcc_lo, 0x55555555
    s_mov_b32 vcc_hi, 0x55555555
    s_waitcnt lgkmcnt(0)
    v_pk_add_f32 v[24:25], v[24:25], v[72:73]
    v_pk_add_f32 v[26:27], v[26:27], v[74:75]
    v_pk_add_f32 v[28:29], v[28:29], v[76:77]
    v_pk_add_f32 v[30:31], v[30:31], v[78:79]
    v_cvt_pk_bf16_f32 v52, v24, v25
    v_cvt_pk_bf16_f32 v53, v26, v27
    v_cvt_pk_bf16_f32 v54, v28, v29
    v_cvt_pk_bf16_f32 v55, v30, v31
    s_nop 0
    v_permlane16_swap_b32 v52, v54
    v_permlane16_swap_b32 v53, v55
    v_lshlrev_b32 v24, 16, v52
    v_and_b32 v25, 0xffff0000, v52
    v_lshlrev_b32 v26, 16, v53
    v_and_b32 v27, 0xffff0000, v53
    v_lshlrev_b32 v28, 16, v54
    v_and_b32 v29, 0xffff0000, v54
    v_lshlrev_b32 v30, 16, v55
    v_and_b32 v31, 0xffff0000, v55
    v_pk_mul_f32 v[24:25], v[24:25], v[228:229] op_sel_hi:[1,0]
    v_pk_mul_f32 v[26:27], v[26:27], v[228:229] op_sel_hi:[1,0]
    v_pk_mul_f32 v[28:29], v[28:29], v[228:229] op_sel_hi:[1,0]
    v_pk_mul_f32 v[30:31], v[30:31], v[228:229] op_sel_hi:[1,0]
    v_cvt_pk_bf16_f32 v52, v24, v25
    v_cvt_pk_bf16_f32 v53, v26, v27
    v_cvt_pk_bf16_f32 v54, v28, v29
    v_cvt_pk_bf16_f32 v55, v30, v31
    v_lshlrev_b32 v24, 16, v52
    v_and_b32 v25, 0xffff0000, v52
    v_lshlrev_b32 v26, 16, v53
    v_and_b32 v27, 0xffff0000, v53
    v_lshlrev_b32 v28, 16, v54
    v_and_b32 v29, 0xffff0000, v54
    v_lshlrev_b32 v30, 16, v55
    v_and_b32 v31, 0xffff0000, v55
    v_pk_add_f32 v[24:25], v[24:25], v[240:241]
    v_pk_add_f32 v[26:27], v[26:27], v[242:243]
    v_pk_add_f32 v[28:29], v[28:29], v[244:245]
    v_pk_add_f32 v[30:31], v[30:31], v[246:247]
    v_cvt_pk_bf16_f32 v124, v24, v25
    v_cvt_pk_bf16_f32 v125, v26, v27
    v_cvt_pk_bf16_f32 v126, v28, v29
    v_cvt_pk_bf16_f32 v127, v30, v31
    s_nop 1
    v_cndmask_b32_dpp v56, v124, v120, vcc quad_perm:[1,0,3,2] row_mask:0xf bank_mask:0xf
    v_cndmask_b32_dpp v57, v125, v121, vcc quad_perm:[1,0,3,2] row_mask:0xf bank_mask:0xf
    v_cndmask_b32_dpp v58, v126, v122, vcc quad_perm:[1,0,3,2] row_mask:0xf bank_mask:0xf
    v_cndmask_b32_dpp v59, v127, v123, vcc quad_perm:[1,0,3,2] row_mask:0xf bank_mask:0xf
    buffer_store_dwordx4 v[56:59], v231, s[20:23], 0 offen nt
    s_not_b64 vcc, vcc
    v_cndmask_b32_dpp v60, v120, v124, vcc quad_perm:[1,0,3,2] row_mask:0xf bank_mask:0xf
    v_cndmask_b32_dpp v61, v121, v125, vcc quad_perm:[1,0,3,2] row_mask:0xf bank_mask:0xf
    v_cndmask_b32_dpp v62, v122, v126, vcc quad_perm:[1,0,3,2] row_mask:0xf bank_mask:0xf
    v_cndmask_b32_dpp v63, v123, v127, vcc quad_perm:[1,0,3,2] row_mask:0xf bank_mask:0xf
    buffer_store_dwordx4 v[60:63], v231, s[20:23], 0 offen offset:2048 nt
K_end:
    s_endpgm
H_nre:
    s_add_u32 s65, s65, 1
    s_cmp_ge_u32 s65, 200000
    s_cbranch_scc1 H_nok
    s_sleep 4
    buffer_load_dword v78, v79, s[20:23], 0 offen sc1
    s_waitcnt vmcnt(0)
    s_branch H_nspin
H_retry:
    s_add_u32 s65, s65, 1
    s_cmp_ge_u32 s65, 200000
    s_cbranch_scc1 H_nq
    s_sleep 8
    s_mov_b32 s64, 6717440
    buffer_load_dwordx4 v[24:27], v6, s[16:19], s64 offen offset:0 sc1
    buffer_load_dwordx4 v[28:31], v6, s[16:19], s64 offen offset:1024 sc1
    s_waitcnt vmcnt(0)
    s_branch H_spin
G_f15:
    s_bitset1_b32 s66, s55
    s_branch G_q15
G_f14:
    s_bitset1_b32 s66, s54
    s_branch G_q14
G_f13:
    s_bitset1_b32 s66, s53
    s_branch G_q13
G_f12:
    s_bitset1_b32 s66, s52
    s_branch G_q12
G_f11:
    s_bitset1_b32 s66, s51
    s_branch G_q11
G_f10:
    s_bitset1_b32 s66, s50
    s_branch G_q10
G_f9:
    s_bitset1_b32 s66, s49
    s_branch G_q9
G_f8:
    s_bitset1_b32 s66, s48
    s_branch G_q8
G_f7:
    s_bitset1_b32 s66, s47
    s_branch G_q7
G_f6:
    s_bitset1_b32 s66, s46
    s_branch G_q6
G_f5:
    s_bitset1_b32 s66, s45
    s_branch G_q5
G_f4:
    s_bitset1_b32 s66, s44
    s_branch G_q4
G_f3:
    s_bitset1_b32 s66, s43
    s_branch G_q3
G_f2:
    s_bitset1_b32 s66, s42
    s_branch G_q2
G_f1:
    s_bitset1_b32 s66, s41
    s_branch G_q1
G_f0:
    s_bitset1_b32 s66, s40
    s_branch G_q0
phi_16_fix:
    v_lshlrev_b32 v32, 16, v16
    v_and_b32 v33, 0xffff0000, v16
    v_add_f32 v32, s73, v32
    v_add_f32 v33, s73, v33
    v_cvt_pk_bf16_f32 v16, v32, v33
    v_lshlrev_b32 v32, 16, v17
    v_and_b32 v33, 0xffff0000, v17
    v_add_f32 v32, s73, v32
    v_add_f32 v33, s73, v33
    v_cvt_pk_bf16_f32 v17, v32, v33
    v_lshlrev_b32 v32, 16, v18
    v_and_b32 v33, 0xffff0000, v18
    v_add_f32 v32, s73, v32
    v_add_f32 v33, s73, v33
    v_cvt_pk_bf16_f32 v18, v32, v33
    v_lshlrev_b32 v32, 16, v19
    v_and_b32 v33, 0xffff0000, v19
    v_add_f32 v32, s73, v32
    v_add_f32 v33, s73, v33
    v_cvt_pk_bf16_f32 v19, v32, v33
    v_lshlrev_b32 v32, 16, v20
    v_and_b32 v33, 0xffff0000, v20
    v_add_f32 v32, s73, v32
    v_add_f32 v33, s73, v33
    v_cvt_pk_bf16_f32 v20, v32, v33
    v_lshlrev_b32 v32, 16, v21
    v_and_b32 v33, 0xffff0000, v21
    v_add_f32 v32, s73, v32
    v_add_f32 v33, s73, v33
    v_cvt_pk_bf16_f32 v21, v32, v33
    v_lshlrev_b32 v32, 16, v22
    v_and_b32 v33, 0xffff0000, v22
    v_add_f32 v32, s73, v32
    v_add_f32 v33, s73, v33
    v_cvt_pk_bf16_f32 v22, v32, v33
    v_lshlrev_b32 v32, 16, v23
    v_and_b32 v33, 0xffff0000, v23
    v_add_f32 v32, s73, v32
    v_add_f32 v33, s73, v33
    v_cvt_pk_bf16_f32 v23, v32, v33
    s_branch phi_16_done
phi_17_fix:
    v_lshlrev_b32 v48, 16, v24
    v_and_b32 v49, 0xffff0000, v24
    v_add_f32 v48, s73, v48
    v_add_f32 v49, s73, v49
    v_cvt_pk_bf16_f32 v24, v48, v49
    v_lshlrev_b32 v48, 16, v25
    v_and_b32 v49, 0xffff0000, v25
    v_add_f32 v48, s73, v48
    v_add_f32 v49, s73, v49
    v_cvt_pk_bf16_f32 v25, v48, v49
    v_lshlrev_b32 v48, 16, v26
    v_and_b32 v49, 0xffff0000, v26
    v_add_f32 v48, s73, v48
    v_add_f32 v49, s73, v49
    v_cvt_pk_bf16_f32 v26, v48, v49
    v_lshlrev_b32 v48, 16, v27
    v_and_b32 v49, 0xffff0000, v27
    v_add_f32 v48, s73, v48
    v_add_f32 v49, s73, v49
    v_cvt_pk_bf16_f32 v27, v48, v49
    v_lshlrev_b32 v48, 16, v28
    v_and_b32 v49, 0xffff0000, v28
    v_add_f32 v48, s73, v48
    v_add_f32 v49, s73, v49
    v_cvt_pk_bf16_f32 v28, v48, v49
    v_lshlrev_b32 v48, 16, v29
    v_and_b32 v49, 0xffff0000, v29
    v_add_f32 v48, s73, v48
    v_add_f32 v49, s73, v49
    v_cvt_pk_bf16_f32 v29, v48, v49
    v_lshlrev_b32 v48, 16, v30
    v_and_b32 v49, 0xffff0000, v30
    v_add_f32 v48, s73, v48
    v_add_f32 v49, s73, v49
    v_cvt_pk_bf16_f32 v30, v48, v49
    v_lshlrev_b32 v48, 16, v31
    v_and_b32 v49, 0xffff0000, v31
    v_add_f32 v48, s73, v48
    v_add_f32 v49, s73, v49
    v_cvt_pk_bf16_f32 v31, v48, v49
    s_branch phi_17_done
C_ex1:
    ds_write_b32 v227, v96 offset:4608
    ds_write_b128 v224, v[240:243] offset:32768
    ds_write_b128 v224, v[244:247] offset:33792
    s_nop 4
    v_mov_b32 v96, v60
    v_mov_b32 v240, v248
    v_mov_b32 v241, v249
    v_mov_b32 v242, v250
    v_mov_b32 v243, v251
    v_mov_b32 v244, v252
    v_mov_b32 v245, v253
    v_mov_b32 v246, v254
    v_mov_b32 v247, v255
    s_branch C_ex2
phi_18_fix:
    v_lshlrev_b32 v48, 16, v32
    v_and_b32 v49, 0xffff0000, v32
    v_add_f32 v48, s73, v48
    v_add_f32 v49, s73, v49
    v_cvt_pk_bf16_f32 v32, v48, v49
    v_lshlrev_b32 v48, 16, v33
    v_and_b32 v49, 0xffff0000, v33
    v_add_f32 v48, s73, v48
    v_add_f32 v49, s73, v49
    v_cvt_pk_bf16_f32 v33, v48, v49
    v_lshlrev_b32 v48, 16, v34
    v_and_b32 v49, 0xffff0000, v34
    v_add_f32 v48, s73, v48
    v_add_f32 v49, s73, v49
    v_cvt_pk_bf16_f32 v34, v48, v49
    v_lshlrev_b32 v48, 16, v35
    v_and_b32 v49, 0xffff0000, v35
    v_add_f32 v48, s73, v48
    v_add_f32 v49, s73, v49
    v_cvt_pk_bf16_f32 v35, v48, v49
    v_lshlrev_b32 v48, 16, v36
    v_and_b32 v49, 0xffff0000, v36
    v_add_f32 v48, s73, v48
    v_add_f32 v49, s73, v49
    v_cvt_pk_bf16_f32 v36, v48, v49
    v_lshlrev_b32 v48, 16, v37
    v_and_b32 v49, 0xffff0000, v37
    v_add_f32 v48, s73, v48
    v_add_f32 v49, s73, v49
    v_cvt_pk_bf16_f32 v37, v48, v49
    v_lshlrev_b32 v48, 16, v38
    v_and_b32 v49, 0xffff0000, v38
    v_add_f32 v48, s73, v48
    v_add_f32 v49, s73, v49
    v_cvt_pk_bf16_f32 v38, v48, v49
    v_lshlrev_b32 v48, 16, v39
    v_and_b32 v49, 0xffff0000, v39
    v_add_f32 v48, s73, v48
    v_add_f32 v49, s73, v49
    v_cvt_pk_bf16_f32 v39, v48, v49
    s_branch phi_18_done
phi_19_fix:
    v_lshlrev_b32 v48, 16, v40
    v_and_b32 v49, 0xffff0000, v40
    v_add_f32 v48, s73, v48
    v_add_f32 v49, s73, v49
    v_cvt_pk_bf16_f32 v40, v48, v49
    v_lshlrev_b32 v48, 16, v41
    v_and_b32 v49, 0xffff0000, v41
    v_add_f32 v48, s73, v48
    v_add_f32 v49, s73, v49
    v_cvt_pk_bf16_f32 v41, v48, v49
    v_lshlrev_b32 v48, 16, v42
    v_and_b32 v49, 0xffff0000, v42
    v_add_f32 v48, s73, v48
    v_add_f32 v49, s73, v49
    v_cvt_pk_bf16_f32 v42, v48, v49
    v_lshlrev_b32 v48, 16, v43
    v_and_b32 v49, 0xffff0000, v43
    v_add_f32 v48, s73, v48
    v_add_f32 v49, s73, v49
    v_cvt_pk_bf16_f32 v43, v48, v49
    v_lshlrev_b32 v48, 16, v44
    v_and_b32 v49, 0xffff0000, v44
    v_add_f32 v48, s73, v48
    v_add_f32 v49, s73, v49
    v_cvt_pk_bf16_f32 v44, v48, v49
    v_lshlrev_b32 v48, 16, v45
    v_and_b32 v49, 0xffff0000, v45
    v_add_f32 v48, s73, v48
    v_add_f32 v49, s73, v49
    v_cvt_pk_bf16_f32 v45, v48, v49
    v_lshlrev_b32 v48, 16, v46
    v_and_b32 v49, 0xffff0000, v46
    v_add_f32 v48, s73, v48
    v_add_f32 v49, s73, v49
    v_cvt_pk_bf16_f32 v46, v48, v49
    v_lshlrev_b32 v48, 16, v47
    v_and_b32 v49, 0xffff0000, v47
    v_add_f32 v48, s73, v48
    v_add_f32 v49, s73, v49
    v_cvt_pk_bf16_f32 v47, v48, v49
    s_branch phi_19_done
P2_ys:
    v_lshrrev_b32 v13, 4, v2
    v_lshlrev_b32 v13, 12, v13
    v_and_b32 v208, 15, v2
    v_lshl_add_u32 v13, v208, 4, v13
    s_lshl_b32 s64, s5, 8
    s_lshl_b32 s65, s3, 16
    s_add_u32 s64, s64, s65
    v_add_u32 v13, s64, v13
    s_lshl_b32 s64, s67, 11
    s_lshl_b32 s65, s5, 7
    s_add_u32 s64, s64, s65
    v_lshl_add_u32 v209, v2, 1, s64
    s_lshl_b32 s64, s67, 2
    s_add_u32 s64, s64, 6709248
    v_mov_b32 v215, s64
    s_branch P2_ysd
P2_yl:
    s_cmp_gt_u32 s70, 7
    s_cbranch_scc1 P2_nyl
    buffer_load_ushort v211, v209, s[8:11], 0 offen
    buffer_load_dword v212, v215, s[16:19], 0 offen sc1
    s_mov_b32 s69, 6447104
    buffer_load_dwordx4 v[192:195], v13, s[16:19], s69 offen sc1
    s_mov_b32 s69, 6463488
    buffer_load_dwordx4 v[196:199], v13, s[16:19], s69 offen sc1
    s_mov_b32 s69, 6479872
    buffer_load_dwordx4 v[200:203], v13, s[16:19], s69 offen sc1
    s_mov_b32 s69, 6496256
    buffer_load_dwordx4 v[204:207], v13, s[16:19], s69 offen sc1
    s_mov_b32 s47, 1
    s_branch P2_nyl
P2_y:
    s_mov_b32 s66, 0
    s_cmp_lg_u32 s47, 0
    s_cbranch_scc1 P2_ychk
P2_yre:
    buffer_load_ushort v211, v209, s[8:11], 0 offen
    buffer_load_dword v212, v215, s[16:19], 0 offen sc1
    s_mov_b32 s69, 6447104
    buffer_load_dwordx4 v[192:195], v13, s[16:19], s69 offen sc1
    s_mov_b32 s69, 6463488
    buffer_load_dwordx4 v[196:199], v13, s[16:19], s69 offen sc1
    s_mov_b32 s69, 6479872
    buffer_load_dwordx4 v[200:203], v13, s[16:19], s69 offen sc1
    s_mov_b32 s69, 6496256
    buffer_load_dwordx4 v[204:207], v13, s[16:19], s69 offen sc1
P2_ychk:
    s_waitcnt vmcnt(0)
    v_max3_u32 v10, v192, v193, v194
    v_max3_u32 v10, v195, v196, v10
    v_max3_u32 v10, v197, v198, v10
    v_max3_u32 v10, v199, v200, v10
    v_max3_u32 v10, v201, v202, v10
    v_max3_u32 v10, v203, v204, v10
    v_max3_u32 v10, v205, v206, v10
    v_max_u32 v10, v207, v10
    v_cmp_eq_u32 vcc, -1, v10
    s_cbranch_vccz P2_yok
    s_add_u32 s66, s66, 1
    s_cmp_ge_u32 s66, 40000
    s_cbranch_scc1 P2_yok
    s_sleep 4
    s_branch P2_yre
P2_yok:
    v_pk_add_f32 v[192:193], v[192:193], v[200:201]
    v_pk_add_f32 v[194:195], v[194:195], v[202:203]
    v_pk_add_f32 v[196:197], v[196:197], v[204:205]
    v_pk_add_f32 v[198:199], v[198:199], v[206:207]
    v_pk_add_f32 v[192:193], v[192:193], v[196:197]
    v_pk_add_f32 v[194:195], v[194:195], v[198:199]
    v_mov_b32 v196, v192
    v_mov_b32 v197, v193
    v_mov_b32 v198, v194
    v_mov_b32 v199, v195
    s_nop 0
    v_permlane16_swap_b32 v192, v196
    v_permlane16_swap_b32 v193, v197
    v_permlane16_swap_b32 v194, v198
    v_permlane16_swap_b32 v195, v199
    v_add_f32 v192, v192, v196
    v_add_f32 v193, v193, v197
    v_add_f32 v194, v194, v198
    v_add_f32 v195, v195, v199
    v_mov_b32 v196, v192
    v_mov_b32 v197, v193
    v_mov_b32 v198, v194
    v_mov_b32 v199, v195
    s_nop 0
    v_permlane32_swap_b32 v192, v196
    v_permlane32_swap_b32 v193, v197
    v_permlane32_swap_b32 v194, v198
    v_permlane32_swap_b32 v195, v199
    v_add_f32 v192, v192, v196
    v_add_f32 v193, v193, v197
    v_add_f32 v194, v194, v198
    v_add_f32 v195, v195, v199
    s_lshl_b32 s64, s3, 8
    v_lshl_add_u32 v208, v208, 4, s64
    ds_write_b128 v208, v[192:195] offset:5888
    v_mov_b32 v208, 0
    v_mov_b32 v214, 1
    s_mov_b64 exec, 1
    ds_add_rtn_u32 v210, v208, v214 offset:4304
    s_mov_b64 exec, -1
    s_and_b32 s64, s75, 0xffff0000
    s_xor_b32 s65, s64, 0x80000000
    s_not_b32 s69, s64
    s_and_b32 s69, s69, 0xffff0000
    s_cmp_ge_u32 s64, 0x80000000
    s_cselect_b32 s64, s65, s69
    v_mov_b32 v213, s64
    v_lshlrev_b32 v208, 2, v2
    s_waitcnt lgkmcnt(0)
    v_readfirstlane_b32 s64, v210
    s_cmp_lg_u32 s64, 3
    s_cbranch_scc1 P2_ny
    ds_read_b32 v192, v208 offset:5888
    ds_read_b32 v193, v208 offset:6144
    ds_read_b32 v194, v208 offset:6400
    ds_read_b32 v195, v208 offset:6656
    v_mul_f32 v213, s72, v213
    v_exp_f32 v213, -v213
    s_nop 0
    v_add_f32 v213, 1.0, v213
    v_rcp_f32 v213, v213
    s_nop 0
    v_cvt_pk_bf16_f32 v213, v213, v213
    v_lshlrev_b32 v213, 16, v213
    v_sub_f32 v214, 1.0, v212
    v_cvt_pk_bf16_f32 v214, v214, v214
    v_lshlrev_b32 v214, 16, v214
    v_lshlrev_b32 v211, 16, v211
    s_waitcnt lgkmcnt(0)
    v_add_f32 v192, v192, v193
    v_add_f32 v194, v194, v195
    v_add_f32 v210, v192, v194
    v_cvt_pk_bf16_f32 v210, v210, v210
    v_lshlrev_b32 v210, 16, v210
    v_mul_f32 v210, v210, v213
    v_cvt_pk_bf16_f32 v210, v210, v210
    v_lshlrev_b32 v210, 16, v210
    v_add_f32 v210, v211, v210
    v_cvt_pk_bf16_f32 v210, v210, v210
    v_lshlrev_b32 v210, 16, v210
    v_mul_f32 v210, v210, v214
    v_cvt_pk_bf16_f32 v210, v210, v210
    v_lshlrev_b32 v210, 16, v210
    ds_write_b32 v208, v210 offset:5632
    s_waitcnt lgkmcnt(0)
    s_branch P2_ny
P2_fix:
    s_mov_b64 exec, s[70:71]
    ds_read_b128 v[232:235], v9 offset:5632
    ds_read_b128 v[236:239], v9 offset:5648
    ds_read_b128 v[240:243], v9 offset:5760
    ds_read_b128 v[244:247], v9 offset:5776
    s_mov_b64 exec, -1
    s_branch P2_nr
CODE_END:
.section .rodata,"a"
.p2align 6
.amdhsa_kernel gated_mix__linear_attn_block__moe_arch_mod__prompt_kernel
  .amdhsa_next_free_vgpr 256
  .amdhsa_next_free_sgpr 102
  .amdhsa_accum_offset 256
  .amdhsa_group_segment_fixed_size 0
  .amdhsa_kernarg_size 96
  .amdhsa_user_sgpr_count 2
  .amdhsa_user_sgpr_kernarg_segment_ptr 1
  .amdhsa_system_sgpr_workgroup_id_x 1
.end_amdhsa_kernel
```
